```python
import torch

def _softmax(x, axis=-1):
    return torch.softmax(x, dim=axis)
def _gelu(x):
    return torch.nn.functional.gelu(x, approximate="tanh")
def _silu(x):
    return torch.nn.functional.silu(x)
def _sigmoid(x):
    return torch.sigmoid(x)
def _layernorm(x, axis=-1, eps=1e-5):
    m = x.mean(dim=axis, keepdim=True)
    v = x.var(dim=axis, keepdim=True, unbiased=False)
    return (x - m) / torch.sqrt(v + eps)
def _scatter_add(tgt, idx, src, axis=0):
    return tgt.clone().index_add_(axis, idx, src)
def _segment_sum(src, seg, n):
    out = torch.zeros((n,) + src.shape[1:], dtype=src.dtype)
    return out.index_add_(0, seg, src)
def _pad(x, pw):
    flat = tuple(v for pair in reversed(pw) for v in pair)
    return torch.nn.functional.pad(x, flat)

kernel_name = 'interleave_layers__sliding_local_dilated__dense_activation_squared_relu__prompt'

def setup_inputs():

    _w = (lambda a: (lambda t: t.to(torch.bfloat16) if t.is_floating_point() else t)(torch.as_tensor(a)))
    def _A_setup():
        B, S, D = 1, 2048, 1024
        return {
            "x": _w((lambda *s: torch.randn(*s, dtype=torch.bfloat16) * 0.05)(B, S, D)),
            "wqkv": _w((lambda *s: torch.randn(*s, dtype=torch.bfloat16) * 0.05)(D, 3 * D)),
            "wo": _w((lambda *s: torch.randn(*s, dtype=torch.bfloat16) * 0.05)(D, D)),
        }
    _A_in = _A_setup()

    def _B_setup():
        B, S, D, F = 1, 2048, 1024, 3584
        return {
            "x": _w((lambda *s: torch.randn(*s, dtype=torch.bfloat16) * 0.05)(B, S, D)),
            "w1": _w((lambda *s: torch.randn(*s, dtype=torch.bfloat16) * 0.05)(D, F)),
            "b1": _w((lambda *s: torch.randn(*s, dtype=torch.bfloat16) * 0.2)(F)),
            "w2": _w((lambda *s: torch.randn(*s, dtype=torch.bfloat16) * 0.05)(F, D)),
            "b2": _w((lambda *s: torch.randn(*s, dtype=torch.bfloat16) * 1.6)(D)),
        }
    _B_in = _B_setup()

    return {
        "A_x": _A_in["x"],
        "A_wqkv": _A_in["wqkv"],
        "A_wo": _A_in["wo"],
        "B_x": _B_in["x"],
        "B_w1": _B_in["w1"],
        "B_b1": _B_in["b1"],
        "B_w2": _B_in["w2"],
        "B_b2": _B_in["b2"],
    }

def reference(A_x, A_wqkv, A_wo, B_x, B_w1, B_b1, B_w2, B_b2):
    def _A_ref(x, wqkv, wo):
        B, S, D = x.shape
        H = 32; Dh = D // H
        W, dil = 8, 2
        qkv = (lambda x, *d: x.permute(*d))((x @ wqkv).reshape(B, S, 3, H, Dh), 2, 0, 3, 1, 4)
        q, k, v = qkv[0], qkv[1], qkv[2]
        scale = Dh ** -0.5
        pos = torch.arange(S)
        off = torch.arange(W) * dil
        idx = pos[:, None] - off[None, :]
        mask = idx >= 0
        idx_c = torch.where(mask, idx, 0).reshape(-1)
        kg = k[:, :, idx_c, :].reshape(B, H, S, W, Dh)
        vg = v[:, :, idx_c, :].reshape(B, H, S, W, Dh)
        logits = torch.einsum("bhsd,bhswd->bhsw", q, kg) * scale
        logits = torch.where(mask[None, None, :, :], logits, -1e9)
        attn = _softmax(logits, axis=-1)
        o = torch.einsum("bhsw,bhswd->bhsd", attn, vg)
        return (lambda x, *d: x.permute(*d))(o, 0, 2, 1, 3).reshape(B, S, D) @ wo

    def _B_ref(x, w1, b1, w2, b2):
        h = torch.einsum("bsd,df->bsf", x, w1) + b1
        zero = torch.zeros_like(h)
        r = torch.where(h > zero, h, zero)
        h = r * r
        out = torch.einsum("bsf,fd->bsd", h, w2) + b2
        return out

    x = A_x
    x = x + _A_ref(_layernorm(x, axis=-1), A_wqkv, A_wo)
    x = x + _B_ref(_layernorm(x, axis=-1), B_w1, B_b1, B_w2, B_b2)
    x = x + _A_ref(_layernorm(x, axis=-1), A_wqkv, A_wo)
    x = x + _B_ref(_layernorm(x, axis=-1), B_w1, B_b1, B_w2, B_b2)
    return x
```

```asm
; @launch grid=(256,1,1) block=(256,1,1) lds=163840
.amdgcn_target "amdgcn-amd-amdhsa--gfx950"
.text
.globl interleave_layers__sliding_local_dilated__dense_activation_squared_relu__prompt_kernel
.p2align 8
.type interleave_layers__sliding_local_dilated__dense_activation_squared_relu__prompt_kernel,@function
interleave_layers__sliding_local_dilated__dense_activation_squared_relu__prompt_kernel:
    s_load_dwordx16 s[64:79], s[0:1], 0x0
    s_load_dwordx4 s[80:83], s[0:1], 0x40
    s_load_dwordx2 s[84:85], s[0:1], 0x50
    s_cmp_lt_u32 s2, 256
    s_cbranch_scc1 L_go
    s_endpgm
L_go:
    v_lshrrev_b32 v1, 6, v0
    s_nop 0
    v_readfirstlane_b32 s32, v1
    v_and_b32 v0, 63, v0
    v_lshlrev_b32 v1, 4, v0
    s_and_b32 s37, s2, 7
    s_lshr_b32 s38, s2, 3
    s_lshr_b32 s33, s37, 2
    s_lshl_b32 s33, s33, 1
    s_and_b32 s39, s38, 1
    s_add_u32 s33, s33, s39
    s_and_b32 s37, s37, 3
    s_lshl_b32 s37, s37, 4
    s_lshr_b32 s38, s38, 1
    s_add_u32 s37, s37, s38
    s_lshr_b32 s38, s37, 2
    s_cmp_eq_u32 s38, 0
    s_mov_b32 s34, 0x18100100
    s_cmp_eq_u32 s38, 1
    s_cselect_b32 s34, 0x2e2d2c19, s34
    s_cmp_eq_u32 s38, 2
    s_cselect_b32 s34, 0x1a110302, s34
    s_cmp_eq_u32 s38, 3
    s_cselect_b32 s34, 0x302f1c1b, s34
    s_cmp_eq_u32 s38, 4
    s_cselect_b32 s34, 0x1d120504, s34
    s_cmp_eq_u32 s38, 5
    s_cselect_b32 s34, 0x3332311e, s34
    s_cmp_eq_u32 s38, 6
    s_cselect_b32 s34, 0x1f130706, s34
    s_cmp_eq_u32 s38, 7
    s_cselect_b32 s34, 0x35342120, s34
    s_cmp_eq_u32 s38, 8
    s_cselect_b32 s34, 0x22140908, s34
    s_cmp_eq_u32 s38, 9
    s_cselect_b32 s34, 0x38373623, s34
    s_cmp_eq_u32 s38, 10
    s_cselect_b32 s34, 0x24150b0a, s34
    s_cmp_eq_u32 s38, 11
    s_cselect_b32 s34, 0x3a392625, s34
    s_cmp_eq_u32 s38, 12
    s_cselect_b32 s34, 0x27160d0c, s34
    s_cmp_eq_u32 s38, 13
    s_cselect_b32 s34, 0x3d3c3b28, s34
    s_cmp_eq_u32 s38, 14
    s_cselect_b32 s34, 0x29170f0e, s34
    s_cmp_eq_u32 s38, 15
    s_cselect_b32 s34, 0x3f3e2b2a, s34
    s_and_b32 s37, s37, 3
    s_lshl_b32 s37, s37, 3
    s_lshr_b32 s34, s34, s37
    s_and_b32 s34, s34, 63
    s_lshl_b32 s37, s33, 6
    s_add_u32 s37, s37, s34
    s_lshl_b32 s37, s37, 8
    s_add_u32 s37, s37, 0x5500000
    s_add_u32 s91, s37, 262144
    s_cmp_eq_u32 s32, 1
    s_cselect_b32 s91, s91, 0x8100000
    s_lshl_b32 s38, s32, 16
    s_add_u32 s37, s37, s38
    s_sub_u32 s37, s37, 131072
    s_cmp_ge_u32 s32, 2
    s_cselect_b32 s37, s37, 0x8000000
    s_cmp_lt_u32 s34, 16
    s_cselect_b32 s36, 33, 32
    v_subrev_u32 v2, 3, v0
    v_cmp_gt_u32 vcc, s36, v2
    v_lshlrev_b32 v3, 17, v0
    v_min_u32 v124, 1, v0
    v_cndmask_b32 v2, 0, -1, vcc
    v_lshlrev_b32 v124, 30, v124
    s_lshl_b32 s38, s2, 2
    s_add_u32 s38, s38, s32
    s_mul_i32 s38, s38, 384
    s_add_u32 s38, s38, 0x5420000
    s_lshr_b32 s39, s2, 3
    s_lshl_b32 s39, s39, 2
    s_add_u32 s39, s39, s32
    s_mul_i32 s39, s39, 49152
    s_and_b32 s36, s2, 3
    s_lshl_b32 s36, s36, 9
    s_add_u32 s39, s39, s36
    v_lshrrev_b32 v6, 3, v0
    v_mul_u32_u24 v6, 6144, v6
    v_and_b32 v7, 3, v0
    v_lshl_add_u32 v6, v7, 7, v6
    s_getpc_b64 s[8:9]
L_pc:
    s_sub_u32 s8, s8, L_pc-interleave_layers__sliding_local_dilated__dense_activation_squared_relu__prompt_kernel
    s_subb_u32 s9, s9, 0
    s_mov_b32 s10, L_code_end-interleave_layers__sliding_local_dilated__dense_activation_squared_relu__prompt_kernel
    s_mov_b32 s11, 0x00020000
    v_lshlrev_b32 v7, 7, v0
    s_lshl_b32 s54, s32, 13
    v_mov_b32 v8, -1
    v_mov_b32 v9, -1
    v_mov_b32 v10, -1
    v_mov_b32 v11, -1
    s_waitcnt lgkmcnt(0)
    s_mov_b32 s12, s66
    s_mov_b32 s13, s67
    s_mov_b32 s14, 0x600000
    s_mov_b32 s15, 0x00020000
    buffer_load_dword v253, v6, s[12:15], s39 offen offset:0
    buffer_load_dword v254, v6, s[12:15], s39 offen offset:2048
    s_add_u32 s39, s39, 4096
    buffer_load_dword v255, v6, s[12:15], s39 offen offset:0
    s_mov_b32 s16, s84
    s_mov_b32 s17, s85
    s_mov_b32 s18, 0x8000000
    s_mov_b32 s19, 0x00020000
    s_mov_b32 exec_hi, 31
    buffer_store_dword v2, v3, s[16:19], s37 offen sc1
    s_mov_b64 exec, 0xffffff
    buffer_store_dwordx4 v[8:11], v1, s[16:19], s38 offen sc1
    s_mov_b64 exec, -1
    s_cmp_ge_u32 s34, 60
    s_cbranch_scc1 L_role_60
    s_cmp_ge_u32 s34, 44
    s_cbranch_scc1 L_role_44
    s_cmp_ge_u32 s34, 43
    s_cbranch_scc1 L_role_43
    s_cmp_ge_u32 s34, 24
    s_cbranch_scc1 L_role_24
    s_cmp_ge_u32 s34, 16
    s_cbranch_scc1 L_role_16
L_role_0:
    s_sub_u32 s35, s34, 0
    s_add_u32 s54, s54, L_role_0-interleave_layers__sliding_local_dilated__dense_activation_squared_relu__prompt_kernel
    buffer_load_dword v252, v7, s[8:11], s54 offen
    s_lshr_b32 s51, s32, 1
    s_lshl_b32 s50, s33, 5
    s_add_u32 s50, s50, 31
    s_sub_u32 s50, s50, s51
    s_lshl_b32 s41, s50, 15
    s_lshl_b32 s43, s32, 10
    s_mov_b32 s8, s64
    s_mov_b32 s9, s65
    s_mov_b32 s10, 0x400000
    s_mov_b32 s11, 0x00020000
    v_lshrrev_b32 v20, 3, v0
    v_and_b32 v21, 6, v20
    v_and_b32 v22, 7, v0
    v_xor_b32 v21, v21, v22
    v_lshlrev_b32 v21, 4, v21
    s_and_b32 s37, s32, 1
    s_lshl_b32 s37, s37, 14
    v_lshl_add_u32 v6, v20, 11, v21
    v_add_u32 v6, s37, v6
    s_lshl_b32 s54, s35, 7
    s_mov_b32 s12, s66
    s_mov_b32 s13, s67
    s_mov_b32 s14, 0x600000
    s_mov_b32 s15, 0x00020000
    v_lshrrev_b32 v80, 3, v0
    v_and_b32 v81, 2, v80
    v_lshlrev_b32 v81, 1, v81
    v_and_b32 v82, 7, v0
    v_xor_b32 v81, v81, v82
    v_mul_u32_u24 v80, 6144, v80
    v_lshl_add_u32 v80, v81, 4, v80
    s_mul_i32 s38, s32, 6
    s_add_u32 s39, s38, 0
    s_and_b32 s37, s39, 7
    s_mul_i32 s37, s37, 49152
    s_lshr_b32 s39, s39, 3
    s_mul_i32 s39, s39, 2048
    s_add_u32 s39, s39, s37
    v_add_u32 v68, s39, v80
    s_add_u32 s39, s38, 1
    s_and_b32 s37, s39, 7
    s_mul_i32 s37, s37, 49152
    s_lshr_b32 s39, s39, 3
    s_mul_i32 s39, s39, 2048
    s_add_u32 s39, s39, s37
    v_add_u32 v69, s39, v80
    s_add_u32 s39, s38, 2
    s_and_b32 s37, s39, 7
    s_mul_i32 s37, s37, 49152
    s_lshr_b32 s39, s39, 3
    s_mul_i32 s39, s39, 2048
    s_add_u32 s39, s39, s37
    v_add_u32 v70, s39, v80
    s_add_u32 s39, s38, 3
    s_and_b32 s37, s39, 7
    s_mul_i32 s37, s37, 49152
    s_lshr_b32 s39, s39, 3
    s_mul_i32 s39, s39, 2048
    s_add_u32 s39, s39, s37
    v_add_u32 v71, s39, v80
    s_add_u32 s39, s38, 4
    s_and_b32 s37, s39, 7
    s_mul_i32 s37, s37, 49152
    s_lshr_b32 s39, s39, 3
    s_mul_i32 s39, s39, 2048
    s_add_u32 s39, s39, s37
    v_add_u32 v72, s39, v80
    s_add_u32 s39, s38, 5
    s_and_b32 s37, s39, 7
    s_mul_i32 s37, s37, 49152
    s_lshr_b32 s39, s39, 3
    s_mul_i32 s39, s39, 2048
    s_add_u32 s39, s39, s37
    v_add_u32 v73, s39, v80
    s_mul_i32 s42, s32, 6144
    s_add_u32 m0, s42, 0
    s_nop 0
    buffer_load_dwordx4 v68, s[12:15], s54 offen lds
    s_add_u32 m0, s42, 1024
    s_nop 0
    buffer_load_dwordx4 v69, s[12:15], s54 offen lds
    s_add_u32 m0, s42, 2048
    s_nop 0
    buffer_load_dwordx4 v70, s[12:15], s54 offen lds
    s_add_u32 m0, s42, 3072
    s_nop 0
    buffer_load_dwordx4 v71, s[12:15], s54 offen lds
    s_add_u32 m0, s42, 4096
    s_nop 0
    buffer_load_dwordx4 v72, s[12:15], s54 offen lds
    s_add_u32 m0, s42, 5120
    s_nop 0
    buffer_load_dwordx4 v73, s[12:15], s54 offen lds
    s_add_u32 s54, s54, 393216
    s_add_u32 m0, s43, 98304
    s_nop 0
    buffer_load_dwordx4 v6, s[8:11], s41 offen offset:0 sc1 lds
    s_add_u32 m0, s43, 102272
    s_nop 0
    buffer_load_dwordx4 v6, s[8:11], s41 offen offset:128 sc1 lds
    s_add_u32 m0, s43, 106240
    s_nop 0
    buffer_load_dwordx4 v6, s[8:11], s41 offen offset:256 sc1 lds
    s_add_u32 m0, s43, 110208
    s_nop 0
    buffer_load_dwordx4 v6, s[8:11], s41 offen offset:384 sc1 lds
    s_add_u32 m0, s42, 24576
    s_nop 0
    buffer_load_dwordx4 v68, s[12:15], s54 offen lds
    s_add_u32 m0, s42, 25600
    s_nop 0
    buffer_load_dwordx4 v69, s[12:15], s54 offen lds
    s_add_u32 m0, s42, 26624
    s_nop 0
    buffer_load_dwordx4 v70, s[12:15], s54 offen lds
    s_add_u32 m0, s42, 27648
    s_nop 0
    buffer_load_dwordx4 v71, s[12:15], s54 offen lds
    s_add_u32 m0, s42, 28672
    s_nop 0
    buffer_load_dwordx4 v72, s[12:15], s54 offen lds
    s_add_u32 m0, s42, 29696
    s_nop 0
    buffer_load_dwordx4 v73, s[12:15], s54 offen lds
    s_add_u32 s54, s54, 393216
    s_add_u32 m0, s43, 114176
    s_nop 0
    buffer_load_dwordx4 v6, s[8:11], s41 offen offset:512 sc1 lds
    s_add_u32 m0, s43, 118144
    s_nop 0
    buffer_load_dwordx4 v6, s[8:11], s41 offen offset:640 sc1 lds
    s_add_u32 m0, s43, 122112
    s_nop 0
    buffer_load_dwordx4 v6, s[8:11], s41 offen offset:768 sc1 lds
    s_add_u32 m0, s43, 126080
    s_nop 0
    buffer_load_dwordx4 v6, s[8:11], s41 offen offset:896 sc1 lds
    s_add_u32 m0, s42, 49152
    s_nop 0
    buffer_load_dwordx4 v68, s[12:15], s54 offen lds
    s_add_u32 m0, s42, 50176
    s_nop 0
    buffer_load_dwordx4 v69, s[12:15], s54 offen lds
    s_add_u32 m0, s42, 51200
    s_nop 0
    buffer_load_dwordx4 v70, s[12:15], s54 offen lds
    s_add_u32 m0, s42, 52224
    s_nop 0
    buffer_load_dwordx4 v71, s[12:15], s54 offen lds
    s_add_u32 m0, s42, 53248
    s_nop 0
    buffer_load_dwordx4 v72, s[12:15], s54 offen lds
    s_add_u32 m0, s42, 54272
    s_nop 0
    buffer_load_dwordx4 v73, s[12:15], s54 offen lds
    s_add_u32 s54, s54, 393216
    s_add_u32 m0, s43, 130048
    s_nop 0
    buffer_load_dwordx4 v6, s[8:11], s41 offen offset:1024 sc1 lds
    s_add_u32 m0, s43, 134016
    s_nop 0
    buffer_load_dwordx4 v6, s[8:11], s41 offen offset:1152 sc1 lds
    s_add_u32 m0, s43, 137984
    s_nop 0
    buffer_load_dwordx4 v6, s[8:11], s41 offen offset:1280 sc1 lds
    s_add_u32 m0, s43, 141952
    s_nop 0
    buffer_load_dwordx4 v6, s[8:11], s41 offen offset:1408 sc1 lds
    v_lshrrev_b32 v80, 4, v0
    v_bfe_u32 v81, v0, 2, 2
    v_lshl_add_u32 v80, v80, 3, v81
    v_lshlrev_b32 v80, 7, v80
    v_lshrrev_b32 v81, 1, v81
    v_lshl_add_u32 v80, v81, 6, v80
    v_and_b32 v81, 3, v0
    v_lshl_add_u32 v80, v81, 4, v80
    s_lshl_b32 s37, s51, 6
    s_and_b32 s38, s32, 1
    s_lshl_b32 s38, s38, 3
    s_add_u32 s37, s37, s38
    s_add_u32 s37, s37, 0
    v_xor_b32 v74, s37, v80
    s_lshl_b32 s37, s51, 6
    s_and_b32 s38, s32, 1
    s_lshl_b32 s38, s38, 3
    s_add_u32 s37, s37, s38
    s_add_u32 s37, s37, 8192
    v_xor_b32 v75, s37, v80
    s_lshl_b32 s37, s51, 6
    s_and_b32 s38, s32, 1
    s_lshl_b32 s38, s38, 3
    s_add_u32 s37, s37, s38
    s_add_u32 s37, s37, 16384
    v_xor_b32 v76, s37, v80
    v_mov_b32 v80, 0x3f803f80
    v_mov_b32 v81, 0x3f803f80
    v_mov_b32 v82, 0x3f803f80
    v_mov_b32 v83, 0x3f803f80
    s_add_u32 s88, s84, 0x5000000
    s_addc_u32 s89, s85, 0
    s_sub_u32 s97, 15, s51
    s_and_b32 s38, s32, 1
    v_and_b32 v20, 15, v0
    v_lshrrev_b32 v21, 4, v0
    v_and_b32 v22, 6, v20
    v_xor_b32 v22, v21, v22
    v_lshlrev_b32 v22, 4, v22
    v_lshl_add_u32 v2, v20, 7, v22
    v_xor_b32 v3, 64, v2
    v_add_u32 v4, 98304, v2
    v_add_u32 v5, 98304, v3
    v_lshlrev_b32 v24, 1, v0
    v_and_b32 v24, 0x30, v24
    v_xor_b32 v24, v24, v1
    s_mul_i32 s37, s51, 3072
    s_add_u32 s37, s37, 65536
    s_lshl_b32 s39, s38, 3
    s_add_u32 s39, s39, s37
    v_add_u32 v7, s39, v24
    v_bfe_u32 v22, v0, 1, 2
    v_xor_b32 v22, v22, v21
    v_lshlrev_b32 v22, 4, v22
    v_lshl_add_u32 v22, v20, 6, v22
    v_add_u32 v8, s39, v22
    s_mul_i32 s39, s38, 6144
    s_add_u32 s39, s39, s37
    v_add_u32 v9, s39, v24
    s_cmp_eq_u32 s38, 0
    s_cselect_b32 s39, 18432, 0
    s_add_u32 s39, s39, s37
    v_add_u32 v10, s39, v24
    s_sub_u32 s39, s33, 1
    s_max_i32 s39, s39, 0
    v_mov_b32 v22, s33
    v_mov_b32 v23, s39
    v_mov_b32 v12, 2097152
    v_mov_b32 v25, 262144
    v_cmp_lt_u32 vcc, 15, v0
    s_nop 1
    v_cndmask_b32 v22, v22, v23, vcc
    v_cndmask_b32 v12, v12, v25, vcc
    v_lshl_add_u32 v22, v22, 6, v20
    v_add_u32 v22, 349484, v22
    v_lshlrev_b32 v11, 8, v22
    s_cmp_eq_u32 s32, 0
    s_cselect_b32 s37, 32, 0
    v_cmp_le_u32 vcc, s37, v0
    s_nop 1
    v_cndmask_b32 v11, v11, 2.0, vcc
    v_mov_b32 v116, 0
    v_mov_b32 v117, v11
    s_mov_b32 s45, -1703936
    v_and_b32 v13, 15, v0
    v_lshlrev_b32 v13, 3, v13
    v_lshrrev_b32 v22, 5, v0
    v_lshl_add_u32 v13, v22, 9, v13
    v_and_b32 v22, 16, v0
    v_mul_u32_u24 v23, 6144, v22
    v_add_u32 v19, v23, v13
    v_lshl_add_u32 v13, v22, 6, v13
    s_sub_u32 s46, 3, s33
    s_lshl_b32 s46, s46, 15
    s_add_u32 s46, s46, 0x5400000
    s_mov_b32 s56, 0xaaaaaaaa
    s_mov_b32 s57, 0xaaaaaaaa
    s_mov_b32 s58, 0xfff0ffff
    s_mov_b32 s59, 0xf000ff00
    s_mov_b32 s60, 0xffc0fffc
    s_mov_b32 s61, 0xc000fc00
    s_mov_b32 s86, 0x3e8293ee
    v_mov_b32 v22, 0x0c0c0c0c
    v_mov_b32 v20, 0xc0c0100
    v_mov_b32 v21, 0x1000c0c
    v_cndmask_b32 v20, v20, v21, s[56:57]
    v_cndmask_b32 v14, v20, v22, s[58:59]
    v_cndmask_b32 v16, v22, v20, s[58:59]
    v_mov_b32 v20, 0xc0c0302
    v_mov_b32 v21, 0x3020c0c
    v_cndmask_b32 v20, v20, v21, s[56:57]
    v_cndmask_b32 v15, v20, v22, s[60:61]
    v_cndmask_b32 v17, v22, v20, s[60:61]
    v_mov_b32 v18, 0xff800000
    s_mul_i32 s90, s33, 2097152
    s_add_u32 s90, s90, 0xfffe0400
    s_lshl_b32 s37, s35, 1
    s_add_u32 s37, s37, s51
    s_lshl_b32 s37, s37, 11
    s_add_u32 s90, s90, s37
    s_mul_i32 s37, s38, 64512
    s_add_u32 s90, s90, s37
    s_cmp_eq_u32 s38, 0
    s_cselect_b32 s87, 63488, 0
    s_cselect_b32 s24, -2, 0xfffeffff
    s_cselect_b32 s26, 0x10000, 0
    s_cselect_b32 s27, 0, 1
    s_add_u32 s87, s87, 1024
    s_mov_b32 s25, -1
    s_cmp_eq_u32 s33, 0
    s_cselect_b64 s[26:27], s[26:27], 0
    s_mov_b32 s44, 0x8000000
    s_mov_b64 s[62:63], -1
    v_add_u32 v77, 0, v74
    v_add_u32 v78, 0, v75
    v_add_u32 v79, 0, v76
    s_waitcnt vmcnt(24)
    s_barrier
    s_cmp_lg_u32 s32, 3
    s_cbranch_scc1 L_arr1
    s_mov_b32 s20, s82
    s_mov_b32 s21, s83
    s_mov_b32 s22, 0x100
    s_mov_b32 s23, 0x00020000
    s_and_b32 s37, s2, 15
    s_lshl_b32 s37, s37, 4
    v_mov_b32 v123, 1
    buffer_atomic_add v123, v124, s[20:23], s37 offen
L_arr1:
    ds_read_b64_tr_b16 a[0:1], v77 offset:0
    ds_read_b64_tr_b16 a[2:3], v77 offset:512
    ds_read_b64_tr_b16 a[4:5], v78 offset:0
    ds_read_b64_tr_b16 a[6:7], v78 offset:512
    ds_read_b64_tr_b16 a[8:9], v79 offset:0
    ds_read_b64_tr_b16 a[10:11], v79 offset:512
    ds_read_b64_tr_b16 a[12:13], v77 offset:4096
    ds_read_b64_tr_b16 a[14:15], v77 offset:4608
    ds_read_b64_tr_b16 a[16:17], v78 offset:4096
    ds_read_b64_tr_b16 a[18:19], v78 offset:4608
    ds_read_b64_tr_b16 a[20:21], v79 offset:4096
    ds_read_b64_tr_b16 a[22:23], v79 offset:4608
    s_add_u32 m0, s42, 73728
    s_nop 0
    buffer_load_dwordx4 v68, s[12:15], s54 offen lds
    s_add_u32 m0, s42, 74752
    s_nop 0
    buffer_load_dwordx4 v69, s[12:15], s54 offen lds
    s_add_u32 m0, s42, 75776
    s_nop 0
    buffer_load_dwordx4 v70, s[12:15], s54 offen lds
    s_add_u32 m0, s42, 76800
    s_nop 0
    buffer_load_dwordx4 v71, s[12:15], s54 offen lds
    s_add_u32 m0, s42, 77824
    s_nop 0
    buffer_load_dwordx4 v72, s[12:15], s54 offen lds
    s_add_u32 m0, s42, 78848
    s_nop 0
    buffer_load_dwordx4 v73, s[12:15], s54 offen lds
    s_add_u32 s54, s54, 393216
    s_add_u32 m0, s43, 145920
    s_nop 0
    buffer_load_dwordx4 v6, s[8:11], s41 offen offset:1536 sc1 lds
    s_add_u32 m0, s43, 149888
    s_nop 0
    buffer_load_dwordx4 v6, s[8:11], s41 offen offset:1664 sc1 lds
    s_add_u32 m0, s43, 153856
    s_nop 0
    buffer_load_dwordx4 v6, s[8:11], s41 offen offset:1792 sc1 lds
    s_add_u32 m0, s43, 157824
    s_nop 0
    buffer_load_dwordx4 v6, s[8:11], s41 offen offset:1920 sc1 lds
    s_waitcnt lgkmcnt(0)
    v_mfma_f32_16x16x32_bf16 v[100:103], a[0:3], v[80:83], 0
    v_mfma_f32_16x16x32_bf16 v[104:107], a[4:7], v[80:83], 0
    v_mfma_f32_16x16x32_bf16 v[108:111], a[8:11], v[80:83], 0
    v_mfma_f32_16x16x32_bf16 v[100:103], a[12:15], v[80:83], v[100:103]
    v_mfma_f32_16x16x32_bf16 v[104:107], a[16:19], v[80:83], v[104:107]
    v_mfma_f32_16x16x32_bf16 v[108:111], a[20:23], v[80:83], v[108:111]
    v_add_u32 v77, 24576, v74
    v_add_u32 v78, 24576, v75
    v_add_u32 v79, 24576, v76
    s_waitcnt vmcnt(24)
    s_barrier
    ds_read_b64_tr_b16 a[24:25], v77 offset:0
    ds_read_b64_tr_b16 a[26:27], v77 offset:512
    ds_read_b64_tr_b16 a[28:29], v78 offset:0
    ds_read_b64_tr_b16 a[30:31], v78 offset:512
    ds_read_b64_tr_b16 a[32:33], v79 offset:0
    ds_read_b64_tr_b16 a[34:35], v79 offset:512
    ds_read_b64_tr_b16 a[36:37], v77 offset:4096
    ds_read_b64_tr_b16 a[38:39], v77 offset:4608
    ds_read_b64_tr_b16 a[40:41], v78 offset:4096
    ds_read_b64_tr_b16 a[42:43], v78 offset:4608
    ds_read_b64_tr_b16 a[44:45], v79 offset:4096
    ds_read_b64_tr_b16 a[46:47], v79 offset:4608
    s_add_u32 m0, s42, 0
    s_nop 0
    buffer_load_dwordx4 v68, s[12:15], s54 offen lds
    s_add_u32 m0, s42, 1024
    s_nop 0
    buffer_load_dwordx4 v69, s[12:15], s54 offen lds
    s_add_u32 m0, s42, 2048
    s_nop 0
    buffer_load_dwordx4 v70, s[12:15], s54 offen lds
    s_add_u32 m0, s42, 3072
    s_nop 0
    buffer_load_dwordx4 v71, s[12:15], s54 offen lds
    s_add_u32 m0, s42, 4096
    s_nop 0
    buffer_load_dwordx4 v72, s[12:15], s54 offen lds
    s_add_u32 m0, s42, 5120
    s_nop 0
    buffer_load_dwordx4 v73, s[12:15], s54 offen lds
    s_add_u32 s54, s54, 393216
    s_waitcnt lgkmcnt(0)
    v_mfma_f32_16x16x32_bf16 v[100:103], a[24:27], v[80:83], v[100:103]
    v_mfma_f32_16x16x32_bf16 v[104:107], a[28:31], v[80:83], v[104:107]
    v_mfma_f32_16x16x32_bf16 v[108:111], a[32:35], v[80:83], v[108:111]
    v_mfma_f32_16x16x32_bf16 v[100:103], a[36:39], v[80:83], v[100:103]
    v_mfma_f32_16x16x32_bf16 v[104:107], a[40:43], v[80:83], v[104:107]
    v_mfma_f32_16x16x32_bf16 v[108:111], a[44:47], v[80:83], v[108:111]
    v_add_u32 v77, 49152, v74
    v_add_u32 v78, 49152, v75
    v_add_u32 v79, 49152, v76
    s_waitcnt vmcnt(20)
    s_barrier
    ds_read_b64_tr_b16 a[48:49], v77 offset:0
    ds_read_b64_tr_b16 a[50:51], v77 offset:512
    ds_read_b64_tr_b16 a[52:53], v78 offset:0
    ds_read_b64_tr_b16 a[54:55], v78 offset:512
    ds_read_b64_tr_b16 a[56:57], v79 offset:0
    ds_read_b64_tr_b16 a[58:59], v79 offset:512
    ds_read_b64_tr_b16 a[60:61], v77 offset:4096
    ds_read_b64_tr_b16 a[62:63], v77 offset:4608
    ds_read_b64_tr_b16 a[64:65], v78 offset:4096
    ds_read_b64_tr_b16 a[66:67], v78 offset:4608
    ds_read_b64_tr_b16 a[68:69], v79 offset:4096
    ds_read_b64_tr_b16 a[70:71], v79 offset:4608
    s_add_u32 m0, s42, 24576
    s_nop 0
    buffer_load_dwordx4 v68, s[12:15], s54 offen lds
    s_add_u32 m0, s42, 25600
    s_nop 0
    buffer_load_dwordx4 v69, s[12:15], s54 offen lds
    s_add_u32 m0, s42, 26624
    s_nop 0
    buffer_load_dwordx4 v70, s[12:15], s54 offen lds
    s_add_u32 m0, s42, 27648
    s_nop 0
    buffer_load_dwordx4 v71, s[12:15], s54 offen lds
    s_add_u32 m0, s42, 28672
    s_nop 0
    buffer_load_dwordx4 v72, s[12:15], s54 offen lds
    s_add_u32 m0, s42, 29696
    s_nop 0
    buffer_load_dwordx4 v73, s[12:15], s54 offen lds
    s_add_u32 s54, s54, 393216
    s_waitcnt lgkmcnt(0)
    v_mfma_f32_16x16x32_bf16 v[100:103], a[48:51], v[80:83], v[100:103]
    v_mfma_f32_16x16x32_bf16 v[104:107], a[52:55], v[80:83], v[104:107]
    v_mfma_f32_16x16x32_bf16 v[108:111], a[56:59], v[80:83], v[108:111]
    v_mfma_f32_16x16x32_bf16 v[100:103], a[60:63], v[80:83], v[100:103]
    v_mfma_f32_16x16x32_bf16 v[104:107], a[64:67], v[80:83], v[104:107]
    v_mfma_f32_16x16x32_bf16 v[108:111], a[68:71], v[80:83], v[108:111]
    v_add_u32 v77, 73728, v74
    v_add_u32 v78, 73728, v75
    v_add_u32 v79, 73728, v76
    s_waitcnt vmcnt(16)
    s_barrier
    ds_read_b64_tr_b16 a[72:73], v77 offset:0
    ds_read_b64_tr_b16 a[74:75], v77 offset:512
    ds_read_b64_tr_b16 a[76:77], v78 offset:0
    ds_read_b64_tr_b16 a[78:79], v78 offset:512
    ds_read_b64_tr_b16 a[80:81], v79 offset:0
    ds_read_b64_tr_b16 a[82:83], v79 offset:512
    ds_read_b64_tr_b16 a[84:85], v77 offset:4096
    ds_read_b64_tr_b16 a[86:87], v77 offset:4608
    ds_read_b64_tr_b16 a[88:89], v78 offset:4096
    ds_read_b64_tr_b16 a[90:91], v78 offset:4608
    ds_read_b64_tr_b16 a[92:93], v79 offset:4096
    ds_read_b64_tr_b16 a[94:95], v79 offset:4608
    s_add_u32 m0, s42, 49152
    s_nop 0
    buffer_load_dwordx4 v68, s[12:15], s54 offen lds
    s_add_u32 m0, s42, 50176
    s_nop 0
    buffer_load_dwordx4 v69, s[12:15], s54 offen lds
    s_add_u32 m0, s42, 51200
    s_nop 0
    buffer_load_dwordx4 v70, s[12:15], s54 offen lds
    s_add_u32 m0, s42, 52224
    s_nop 0
    buffer_load_dwordx4 v71, s[12:15], s54 offen lds
    s_add_u32 m0, s42, 53248
    s_nop 0
    buffer_load_dwordx4 v72, s[12:15], s54 offen lds
    s_add_u32 m0, s42, 54272
    s_nop 0
    buffer_load_dwordx4 v73, s[12:15], s54 offen lds
    s_add_u32 s54, s54, 393216
    s_waitcnt lgkmcnt(0)
    v_mfma_f32_16x16x32_bf16 v[100:103], a[72:75], v[80:83], v[100:103]
    v_mfma_f32_16x16x32_bf16 v[104:107], a[76:79], v[80:83], v[104:107]
    v_mfma_f32_16x16x32_bf16 v[108:111], a[80:83], v[80:83], v[108:111]
    v_mfma_f32_16x16x32_bf16 v[100:103], a[84:87], v[80:83], v[100:103]
    v_mfma_f32_16x16x32_bf16 v[104:107], a[88:91], v[80:83], v[104:107]
    v_mfma_f32_16x16x32_bf16 v[108:111], a[92:95], v[80:83], v[108:111]
    v_add_u32 v77, 0, v74
    v_add_u32 v78, 0, v75
    v_add_u32 v79, 0, v76
    s_waitcnt vmcnt(12)
    s_barrier
    ds_read_b64_tr_b16 a[96:97], v77 offset:0
    ds_read_b64_tr_b16 a[98:99], v77 offset:512
    ds_read_b64_tr_b16 a[100:101], v78 offset:0
    ds_read_b64_tr_b16 a[102:103], v78 offset:512
    ds_read_b64_tr_b16 a[104:105], v79 offset:0
    ds_read_b64_tr_b16 a[106:107], v79 offset:512
    ds_read_b64_tr_b16 a[108:109], v77 offset:4096
    ds_read_b64_tr_b16 a[110:111], v77 offset:4608
    ds_read_b64_tr_b16 a[112:113], v78 offset:4096
    ds_read_b64_tr_b16 a[114:115], v78 offset:4608
    ds_read_b64_tr_b16 a[116:117], v79 offset:4096
    ds_read_b64_tr_b16 a[118:119], v79 offset:4608
    s_add_u32 m0, s42, 73728
    s_nop 0
    buffer_load_dwordx4 v68, s[12:15], s54 offen lds
    s_add_u32 m0, s42, 74752
    s_nop 0
    buffer_load_dwordx4 v69, s[12:15], s54 offen lds
    s_add_u32 m0, s42, 75776
    s_nop 0
    buffer_load_dwordx4 v70, s[12:15], s54 offen lds
    s_add_u32 m0, s42, 76800
    s_nop 0
    buffer_load_dwordx4 v71, s[12:15], s54 offen lds
    s_add_u32 m0, s42, 77824
    s_nop 0
    buffer_load_dwordx4 v72, s[12:15], s54 offen lds
    s_add_u32 m0, s42, 78848
    s_nop 0
    buffer_load_dwordx4 v73, s[12:15], s54 offen lds
    s_add_u32 s54, s54, 393216
    s_waitcnt lgkmcnt(0)
    v_mfma_f32_16x16x32_bf16 v[100:103], a[96:99], v[80:83], v[100:103]
    v_mfma_f32_16x16x32_bf16 v[104:107], a[100:103], v[80:83], v[104:107]
    v_mfma_f32_16x16x32_bf16 v[108:111], a[104:107], v[80:83], v[108:111]
    v_mfma_f32_16x16x32_bf16 v[100:103], a[108:111], v[80:83], v[100:103]
    v_mfma_f32_16x16x32_bf16 v[104:107], a[112:115], v[80:83], v[104:107]
    v_mfma_f32_16x16x32_bf16 v[108:111], a[116:119], v[80:83], v[108:111]
    v_add_u32 v77, 24576, v74
    v_add_u32 v78, 24576, v75
    v_add_u32 v79, 24576, v76
    s_waitcnt vmcnt(12)
    s_barrier
    ds_read_b64_tr_b16 a[120:121], v77 offset:0
    ds_read_b64_tr_b16 a[122:123], v77 offset:512
    ds_read_b64_tr_b16 a[124:125], v78 offset:0
    ds_read_b64_tr_b16 a[126:127], v78 offset:512
    ds_read_b64_tr_b16 a[128:129], v79 offset:0
    ds_read_b64_tr_b16 a[130:131], v79 offset:512
    ds_read_b64_tr_b16 a[132:133], v77 offset:4096
    ds_read_b64_tr_b16 a[134:135], v77 offset:4608
    ds_read_b64_tr_b16 a[136:137], v78 offset:4096
    ds_read_b64_tr_b16 a[138:139], v78 offset:4608
    ds_read_b64_tr_b16 a[140:141], v79 offset:4096
    ds_read_b64_tr_b16 a[142:143], v79 offset:4608
    s_add_u32 m0, s42, 0
    s_nop 0
    buffer_load_dwordx4 v68, s[12:15], s54 offen lds
    s_add_u32 m0, s42, 1024
    s_nop 0
    buffer_load_dwordx4 v69, s[12:15], s54 offen lds
    s_add_u32 m0, s42, 2048
    s_nop 0
    buffer_load_dwordx4 v70, s[12:15], s54 offen lds
    s_add_u32 m0, s42, 3072
    s_nop 0
    buffer_load_dwordx4 v71, s[12:15], s54 offen lds
    s_add_u32 m0, s42, 4096
    s_nop 0
    buffer_load_dwordx4 v72, s[12:15], s54 offen lds
    s_add_u32 m0, s42, 5120
    s_nop 0
    buffer_load_dwordx4 v73, s[12:15], s54 offen lds
    s_add_u32 s54, s54, 393216
    s_waitcnt lgkmcnt(0)
    v_mfma_f32_16x16x32_bf16 v[100:103], a[120:123], v[80:83], v[100:103]
    v_mfma_f32_16x16x32_bf16 v[104:107], a[124:127], v[80:83], v[104:107]
    v_mfma_f32_16x16x32_bf16 v[108:111], a[128:131], v[80:83], v[108:111]
    v_mfma_f32_16x16x32_bf16 v[100:103], a[132:135], v[80:83], v[100:103]
    v_mfma_f32_16x16x32_bf16 v[104:107], a[136:139], v[80:83], v[104:107]
    v_mfma_f32_16x16x32_bf16 v[108:111], a[140:143], v[80:83], v[108:111]
    v_add_u32 v77, 49152, v74
    v_add_u32 v78, 49152, v75
    v_add_u32 v79, 49152, v76
    s_waitcnt vmcnt(12)
    s_barrier
    ds_read_b64_tr_b16 a[144:145], v77 offset:0
    ds_read_b64_tr_b16 a[146:147], v77 offset:512
    ds_read_b64_tr_b16 a[148:149], v78 offset:0
    ds_read_b64_tr_b16 a[150:151], v78 offset:512
    ds_read_b64_tr_b16 a[152:153], v79 offset:0
    ds_read_b64_tr_b16 a[154:155], v79 offset:512
    ds_read_b64_tr_b16 a[156:157], v77 offset:4096
    ds_read_b64_tr_b16 a[158:159], v77 offset:4608
    ds_read_b64_tr_b16 a[160:161], v78 offset:4096
    ds_read_b64_tr_b16 a[162:163], v78 offset:4608
    ds_read_b64_tr_b16 a[164:165], v79 offset:4096
    ds_read_b64_tr_b16 a[166:167], v79 offset:4608
    s_add_u32 m0, s42, 24576
    s_nop 0
    buffer_load_dwordx4 v68, s[12:15], s54 offen lds
    s_add_u32 m0, s42, 25600
    s_nop 0
    buffer_load_dwordx4 v69, s[12:15], s54 offen lds
    s_add_u32 m0, s42, 26624
    s_nop 0
    buffer_load_dwordx4 v70, s[12:15], s54 offen lds
    s_add_u32 m0, s42, 27648
    s_nop 0
    buffer_load_dwordx4 v71, s[12:15], s54 offen lds
    s_add_u32 m0, s42, 28672
    s_nop 0
    buffer_load_dwordx4 v72, s[12:15], s54 offen lds
    s_add_u32 m0, s42, 29696
    s_nop 0
    buffer_load_dwordx4 v73, s[12:15], s54 offen lds
    s_add_u32 s54, s54, 393216
    s_waitcnt lgkmcnt(0)
    v_mfma_f32_16x16x32_bf16 v[100:103], a[144:147], v[80:83], v[100:103]
    v_mfma_f32_16x16x32_bf16 v[104:107], a[148:151], v[80:83], v[104:107]
    v_mfma_f32_16x16x32_bf16 v[108:111], a[152:155], v[80:83], v[108:111]
    v_mfma_f32_16x16x32_bf16 v[100:103], a[156:159], v[80:83], v[100:103]
    v_mfma_f32_16x16x32_bf16 v[104:107], a[160:163], v[80:83], v[104:107]
    v_mfma_f32_16x16x32_bf16 v[108:111], a[164:167], v[80:83], v[108:111]
    v_add_u32 v77, 73728, v74
    v_add_u32 v78, 73728, v75
    v_add_u32 v79, 73728, v76
    s_waitcnt vmcnt(12)
    s_barrier
    ds_read_b64_tr_b16 a[168:169], v77 offset:0
    ds_read_b64_tr_b16 a[170:171], v77 offset:512
    ds_read_b64_tr_b16 a[172:173], v78 offset:0
    ds_read_b64_tr_b16 a[174:175], v78 offset:512
    ds_read_b64_tr_b16 a[176:177], v79 offset:0
    ds_read_b64_tr_b16 a[178:179], v79 offset:512
    ds_read_b64_tr_b16 a[180:181], v77 offset:4096
    ds_read_b64_tr_b16 a[182:183], v77 offset:4608
    ds_read_b64_tr_b16 a[184:185], v78 offset:4096
    ds_read_b64_tr_b16 a[186:187], v78 offset:4608
    ds_read_b64_tr_b16 a[188:189], v79 offset:4096
    ds_read_b64_tr_b16 a[190:191], v79 offset:4608
    s_add_u32 m0, s42, 49152
    s_nop 0
    buffer_load_dwordx4 v68, s[12:15], s54 offen lds
    s_add_u32 m0, s42, 50176
    s_nop 0
    buffer_load_dwordx4 v69, s[12:15], s54 offen lds
    s_add_u32 m0, s42, 51200
    s_nop 0
    buffer_load_dwordx4 v70, s[12:15], s54 offen lds
    s_add_u32 m0, s42, 52224
    s_nop 0
    buffer_load_dwordx4 v71, s[12:15], s54 offen lds
    s_add_u32 m0, s42, 53248
    s_nop 0
    buffer_load_dwordx4 v72, s[12:15], s54 offen lds
    s_add_u32 m0, s42, 54272
    s_nop 0
    buffer_load_dwordx4 v73, s[12:15], s54 offen lds
    s_add_u32 s54, s54, 393216
    s_waitcnt lgkmcnt(0)
    v_mfma_f32_16x16x32_bf16 v[100:103], a[168:171], v[80:83], v[100:103]
    v_mfma_f32_16x16x32_bf16 v[104:107], a[172:175], v[80:83], v[104:107]
    v_mfma_f32_16x16x32_bf16 v[108:111], a[176:179], v[80:83], v[108:111]
    v_mfma_f32_16x16x32_bf16 v[100:103], a[180:183], v[80:83], v[100:103]
    v_mfma_f32_16x16x32_bf16 v[104:107], a[184:187], v[80:83], v[104:107]
    v_mfma_f32_16x16x32_bf16 v[108:111], a[188:191], v[80:83], v[108:111]
    v_add_u32 v77, 0, v74
    v_add_u32 v78, 0, v75
    v_add_u32 v79, 0, v76
    s_waitcnt vmcnt(12)
    s_barrier
    ds_read_b64_tr_b16 a[192:193], v77 offset:0
    ds_read_b64_tr_b16 a[194:195], v77 offset:512
    ds_read_b64_tr_b16 a[196:197], v78 offset:0
    ds_read_b64_tr_b16 a[198:199], v78 offset:512
    ds_read_b64_tr_b16 a[200:201], v79 offset:0
    ds_read_b64_tr_b16 a[202:203], v79 offset:512
    ds_read_b64_tr_b16 a[204:205], v77 offset:4096
    ds_read_b64_tr_b16 a[206:207], v77 offset:4608
    ds_read_b64_tr_b16 a[208:209], v78 offset:4096
    ds_read_b64_tr_b16 a[210:211], v78 offset:4608
    ds_read_b64_tr_b16 a[212:213], v79 offset:4096
    ds_read_b64_tr_b16 a[214:215], v79 offset:4608
    s_add_u32 m0, s42, 73728
    s_nop 0
    buffer_load_dwordx4 v68, s[12:15], s54 offen lds
    s_add_u32 m0, s42, 74752
    s_nop 0
    buffer_load_dwordx4 v69, s[12:15], s54 offen lds
    s_add_u32 m0, s42, 75776
    s_nop 0
    buffer_load_dwordx4 v70, s[12:15], s54 offen lds
    s_add_u32 m0, s42, 76800
    s_nop 0
    buffer_load_dwordx4 v71, s[12:15], s54 offen lds
    s_add_u32 m0, s42, 77824
    s_nop 0
    buffer_load_dwordx4 v72, s[12:15], s54 offen lds
    s_add_u32 m0, s42, 78848
    s_nop 0
    buffer_load_dwordx4 v73, s[12:15], s54 offen lds
    s_add_u32 s54, s54, 393216
    s_waitcnt lgkmcnt(0)
    v_mfma_f32_16x16x32_bf16 v[100:103], a[192:195], v[80:83], v[100:103]
    v_mfma_f32_16x16x32_bf16 v[104:107], a[196:199], v[80:83], v[104:107]
    v_mfma_f32_16x16x32_bf16 v[108:111], a[200:203], v[80:83], v[108:111]
    v_mfma_f32_16x16x32_bf16 v[100:103], a[204:207], v[80:83], v[100:103]
    v_mfma_f32_16x16x32_bf16 v[104:107], a[208:211], v[80:83], v[104:107]
    v_mfma_f32_16x16x32_bf16 v[108:111], a[212:215], v[80:83], v[108:111]
    v_add_u32 v77, 24576, v74
    v_add_u32 v78, 24576, v75
    v_add_u32 v79, 24576, v76
    s_waitcnt vmcnt(12)
    s_barrier
    ds_read_b64_tr_b16 a[216:217], v77 offset:0
    ds_read_b64_tr_b16 a[218:219], v77 offset:512
    ds_read_b64_tr_b16 a[220:221], v78 offset:0
    ds_read_b64_tr_b16 a[222:223], v78 offset:512
    ds_read_b64_tr_b16 a[224:225], v79 offset:0
    ds_read_b64_tr_b16 a[226:227], v79 offset:512
    ds_read_b64_tr_b16 a[228:229], v77 offset:4096
    ds_read_b64_tr_b16 a[230:231], v77 offset:4608
    ds_read_b64_tr_b16 a[232:233], v78 offset:4096
    ds_read_b64_tr_b16 a[234:235], v78 offset:4608
    ds_read_b64_tr_b16 a[236:237], v79 offset:4096
    ds_read_b64_tr_b16 a[238:239], v79 offset:4608
    s_add_u32 m0, s42, 0
    s_nop 0
    buffer_load_dwordx4 v68, s[12:15], s54 offen lds
    s_add_u32 m0, s42, 1024
    s_nop 0
    buffer_load_dwordx4 v69, s[12:15], s54 offen lds
    s_add_u32 m0, s42, 2048
    s_nop 0
    buffer_load_dwordx4 v70, s[12:15], s54 offen lds
    s_add_u32 m0, s42, 3072
    s_nop 0
    buffer_load_dwordx4 v71, s[12:15], s54 offen lds
    s_add_u32 m0, s42, 4096
    s_nop 0
    buffer_load_dwordx4 v72, s[12:15], s54 offen lds
    s_add_u32 m0, s42, 5120
    s_nop 0
    buffer_load_dwordx4 v73, s[12:15], s54 offen lds
    s_add_u32 s54, s54, 393216
    s_waitcnt lgkmcnt(0)
    v_mfma_f32_16x16x32_bf16 v[100:103], a[216:219], v[80:83], v[100:103]
    v_mfma_f32_16x16x32_bf16 v[104:107], a[220:223], v[80:83], v[104:107]
    v_mfma_f32_16x16x32_bf16 v[108:111], a[224:227], v[80:83], v[108:111]
    v_mfma_f32_16x16x32_bf16 v[100:103], a[228:231], v[80:83], v[100:103]
    v_mfma_f32_16x16x32_bf16 v[104:107], a[232:235], v[80:83], v[104:107]
    v_mfma_f32_16x16x32_bf16 v[108:111], a[236:239], v[80:83], v[108:111]
    v_add_u32 v77, 49152, v74
    v_add_u32 v78, 49152, v75
    v_add_u32 v79, 49152, v76
    s_waitcnt vmcnt(12)
    s_barrier
    ds_read_b64_tr_b16 a[240:241], v77 offset:0
    ds_read_b64_tr_b16 a[242:243], v77 offset:512
    ds_read_b64_tr_b16 a[244:245], v78 offset:0
    ds_read_b64_tr_b16 a[246:247], v78 offset:512
    ds_read_b64_tr_b16 a[248:249], v79 offset:0
    ds_read_b64_tr_b16 a[250:251], v79 offset:512
    ds_read_b64_tr_b16 a[252:253], v77 offset:4096
    ds_read_b64_tr_b16 a[254:255], v77 offset:4608
    ds_read_b64_tr_b16 v[128:129], v78 offset:4096
    ds_read_b64_tr_b16 v[130:131], v78 offset:4608
    ds_read_b64_tr_b16 v[132:133], v79 offset:4096
    ds_read_b64_tr_b16 v[134:135], v79 offset:4608
    s_add_u32 m0, s42, 24576
    s_nop 0
    buffer_load_dwordx4 v68, s[12:15], s54 offen lds
    s_add_u32 m0, s42, 25600
    s_nop 0
    buffer_load_dwordx4 v69, s[12:15], s54 offen lds
    s_add_u32 m0, s42, 26624
    s_nop 0
    buffer_load_dwordx4 v70, s[12:15], s54 offen lds
    s_add_u32 m0, s42, 27648
    s_nop 0
    buffer_load_dwordx4 v71, s[12:15], s54 offen lds
    s_add_u32 m0, s42, 28672
    s_nop 0
    buffer_load_dwordx4 v72, s[12:15], s54 offen lds
    s_add_u32 m0, s42, 29696
    s_nop 0
    buffer_load_dwordx4 v73, s[12:15], s54 offen lds
    s_add_u32 s54, s54, 393216
    s_waitcnt lgkmcnt(0)
    v_mfma_f32_16x16x32_bf16 v[100:103], a[240:243], v[80:83], v[100:103]
    v_mfma_f32_16x16x32_bf16 v[104:107], a[244:247], v[80:83], v[104:107]
    v_mfma_f32_16x16x32_bf16 v[108:111], a[248:251], v[80:83], v[108:111]
    v_mfma_f32_16x16x32_bf16 v[100:103], a[252:255], v[80:83], v[100:103]
    v_mfma_f32_16x16x32_bf16 v[104:107], v[128:131], v[80:83], v[104:107]
    v_mfma_f32_16x16x32_bf16 v[108:111], v[132:135], v[80:83], v[108:111]
    v_add_u32 v77, 73728, v74
    v_add_u32 v78, 73728, v75
    v_add_u32 v79, 73728, v76
    s_waitcnt vmcnt(12)
    s_barrier
    ds_read_b64_tr_b16 v[136:137], v77 offset:0
    ds_read_b64_tr_b16 v[138:139], v77 offset:512
    ds_read_b64_tr_b16 v[140:141], v78 offset:0
    ds_read_b64_tr_b16 v[142:143], v78 offset:512
    ds_read_b64_tr_b16 v[144:145], v79 offset:0
    ds_read_b64_tr_b16 v[146:147], v79 offset:512
    ds_read_b64_tr_b16 v[148:149], v77 offset:4096
    ds_read_b64_tr_b16 v[150:151], v77 offset:4608
    ds_read_b64_tr_b16 v[152:153], v78 offset:4096
    ds_read_b64_tr_b16 v[154:155], v78 offset:4608
    ds_read_b64_tr_b16 v[156:157], v79 offset:4096
    ds_read_b64_tr_b16 v[158:159], v79 offset:4608
    s_add_u32 m0, s42, 49152
    s_nop 0
    buffer_load_dwordx4 v68, s[12:15], s54 offen lds
    s_add_u32 m0, s42, 50176
    s_nop 0
    buffer_load_dwordx4 v69, s[12:15], s54 offen lds
    s_add_u32 m0, s42, 51200
    s_nop 0
    buffer_load_dwordx4 v70, s[12:15], s54 offen lds
    s_add_u32 m0, s42, 52224
    s_nop 0
    buffer_load_dwordx4 v71, s[12:15], s54 offen lds
    s_add_u32 m0, s42, 53248
    s_nop 0
    buffer_load_dwordx4 v72, s[12:15], s54 offen lds
    s_add_u32 m0, s42, 54272
    s_nop 0
    buffer_load_dwordx4 v73, s[12:15], s54 offen lds
    s_add_u32 s54, s54, 393216
    s_waitcnt lgkmcnt(0)
    v_mfma_f32_16x16x32_bf16 v[100:103], v[136:139], v[80:83], v[100:103]
    v_mfma_f32_16x16x32_bf16 v[104:107], v[140:143], v[80:83], v[104:107]
    v_mfma_f32_16x16x32_bf16 v[108:111], v[144:147], v[80:83], v[108:111]
    v_mfma_f32_16x16x32_bf16 v[100:103], v[148:151], v[80:83], v[100:103]
    v_mfma_f32_16x16x32_bf16 v[104:107], v[152:155], v[80:83], v[104:107]
    v_mfma_f32_16x16x32_bf16 v[108:111], v[156:159], v[80:83], v[108:111]
    v_add_u32 v77, 0, v74
    v_add_u32 v78, 0, v75
    v_add_u32 v79, 0, v76
    s_waitcnt vmcnt(12)
    s_barrier
    ds_read_b64_tr_b16 v[160:161], v77 offset:0
    ds_read_b64_tr_b16 v[162:163], v77 offset:512
    ds_read_b64_tr_b16 v[164:165], v78 offset:0
    ds_read_b64_tr_b16 v[166:167], v78 offset:512
    ds_read_b64_tr_b16 v[168:169], v79 offset:0
    ds_read_b64_tr_b16 v[170:171], v79 offset:512
    ds_read_b64_tr_b16 v[172:173], v77 offset:4096
    ds_read_b64_tr_b16 v[174:175], v77 offset:4608
    ds_read_b64_tr_b16 v[176:177], v78 offset:4096
    ds_read_b64_tr_b16 v[178:179], v78 offset:4608
    ds_read_b64_tr_b16 v[180:181], v79 offset:4096
    ds_read_b64_tr_b16 v[182:183], v79 offset:4608
    s_add_u32 m0, s42, 73728
    s_nop 0
    buffer_load_dwordx4 v68, s[12:15], s54 offen lds
    s_add_u32 m0, s42, 74752
    s_nop 0
    buffer_load_dwordx4 v69, s[12:15], s54 offen lds
    s_add_u32 m0, s42, 75776
    s_nop 0
    buffer_load_dwordx4 v70, s[12:15], s54 offen lds
    s_add_u32 m0, s42, 76800
    s_nop 0
    buffer_load_dwordx4 v71, s[12:15], s54 offen lds
    s_add_u32 m0, s42, 77824
    s_nop 0
    buffer_load_dwordx4 v72, s[12:15], s54 offen lds
    s_add_u32 m0, s42, 78848
    s_nop 0
    buffer_load_dwordx4 v73, s[12:15], s54 offen lds
    s_add_u32 s54, s54, 393216
    s_waitcnt lgkmcnt(0)
    v_mfma_f32_16x16x32_bf16 v[100:103], v[160:163], v[80:83], v[100:103]
    v_mfma_f32_16x16x32_bf16 v[104:107], v[164:167], v[80:83], v[104:107]
    v_mfma_f32_16x16x32_bf16 v[108:111], v[168:171], v[80:83], v[108:111]
    v_mfma_f32_16x16x32_bf16 v[100:103], v[172:175], v[80:83], v[100:103]
    v_mfma_f32_16x16x32_bf16 v[104:107], v[176:179], v[80:83], v[104:107]
    v_mfma_f32_16x16x32_bf16 v[108:111], v[180:183], v[80:83], v[108:111]
    v_add_u32 v77, 24576, v74
    v_add_u32 v78, 24576, v75
    v_add_u32 v79, 24576, v76
    s_waitcnt vmcnt(12)
    s_barrier
    ds_read_b64_tr_b16 v[184:185], v77 offset:0
    ds_read_b64_tr_b16 v[186:187], v77 offset:512
    ds_read_b64_tr_b16 v[188:189], v78 offset:0
    ds_read_b64_tr_b16 v[190:191], v78 offset:512
    ds_read_b64_tr_b16 v[192:193], v79 offset:0
    ds_read_b64_tr_b16 v[194:195], v79 offset:512
    ds_read_b64_tr_b16 v[196:197], v77 offset:4096
    ds_read_b64_tr_b16 v[198:199], v77 offset:4608
    ds_read_b64_tr_b16 v[200:201], v78 offset:4096
    ds_read_b64_tr_b16 v[202:203], v78 offset:4608
    ds_read_b64_tr_b16 v[204:205], v79 offset:4096
    ds_read_b64_tr_b16 v[206:207], v79 offset:4608
    s_waitcnt lgkmcnt(0)
    v_mfma_f32_16x16x32_bf16 v[100:103], v[184:187], v[80:83], v[100:103]
    v_mfma_f32_16x16x32_bf16 v[104:107], v[188:191], v[80:83], v[104:107]
    v_mfma_f32_16x16x32_bf16 v[108:111], v[192:195], v[80:83], v[108:111]
    v_mfma_f32_16x16x32_bf16 v[100:103], v[196:199], v[80:83], v[100:103]
    v_mfma_f32_16x16x32_bf16 v[104:107], v[200:203], v[80:83], v[104:107]
    v_mfma_f32_16x16x32_bf16 v[108:111], v[204:207], v[80:83], v[108:111]
    v_add_u32 v77, 49152, v74
    v_add_u32 v78, 49152, v75
    v_add_u32 v79, 49152, v76
    s_waitcnt vmcnt(6)
    s_barrier
    ds_read_b64_tr_b16 v[208:209], v77 offset:0
    ds_read_b64_tr_b16 v[210:211], v77 offset:512
    ds_read_b64_tr_b16 v[212:213], v78 offset:0
    ds_read_b64_tr_b16 v[214:215], v78 offset:512
    ds_read_b64_tr_b16 v[216:217], v79 offset:0
    ds_read_b64_tr_b16 v[218:219], v79 offset:512
    ds_read_b64_tr_b16 v[220:221], v77 offset:4096
    ds_read_b64_tr_b16 v[222:223], v77 offset:4608
    ds_read_b64_tr_b16 v[224:225], v78 offset:4096
    ds_read_b64_tr_b16 v[226:227], v78 offset:4608
    ds_read_b64_tr_b16 v[228:229], v79 offset:4096
    ds_read_b64_tr_b16 v[230:231], v79 offset:4608
    s_waitcnt lgkmcnt(0)
    v_mfma_f32_16x16x32_bf16 v[100:103], v[208:211], v[80:83], v[100:103]
    v_mfma_f32_16x16x32_bf16 v[104:107], v[212:215], v[80:83], v[104:107]
    v_mfma_f32_16x16x32_bf16 v[108:111], v[216:219], v[80:83], v[108:111]
    v_mfma_f32_16x16x32_bf16 v[100:103], v[220:223], v[80:83], v[100:103]
    v_mfma_f32_16x16x32_bf16 v[104:107], v[224:227], v[80:83], v[104:107]
    v_mfma_f32_16x16x32_bf16 v[108:111], v[228:231], v[80:83], v[108:111]
    v_add_u32 v77, 73728, v74
    v_add_u32 v78, 73728, v75
    v_add_u32 v79, 73728, v76
    s_waitcnt vmcnt(0)
    s_barrier
    ds_read_b64_tr_b16 v[232:233], v77 offset:0
    ds_read_b64_tr_b16 v[234:235], v77 offset:512
    ds_read_b64_tr_b16 v[236:237], v78 offset:0
    ds_read_b64_tr_b16 v[238:239], v78 offset:512
    ds_read_b64_tr_b16 v[240:241], v79 offset:0
    ds_read_b64_tr_b16 v[242:243], v79 offset:512
    ds_read_b64_tr_b16 v[244:245], v77 offset:4096
    ds_read_b64_tr_b16 v[246:247], v77 offset:4608
    ds_read_b64_tr_b16 v[248:249], v78 offset:4096
    ds_read_b64_tr_b16 v[250:251], v78 offset:4608
    ds_read_b64_tr_b16 v[252:253], v79 offset:4096
    ds_read_b64_tr_b16 v[254:255], v79 offset:4608
    s_waitcnt lgkmcnt(0)
    v_mfma_f32_16x16x32_bf16 v[100:103], v[232:235], v[80:83], v[100:103]
    v_mfma_f32_16x16x32_bf16 v[104:107], v[236:239], v[80:83], v[104:107]
    v_mfma_f32_16x16x32_bf16 v[108:111], v[240:243], v[80:83], v[108:111]
    v_mfma_f32_16x16x32_bf16 v[100:103], v[244:247], v[80:83], v[100:103]
    v_mfma_f32_16x16x32_bf16 v[104:107], v[248:251], v[80:83], v[104:107]
    v_mfma_f32_16x16x32_bf16 v[108:111], v[252:255], v[80:83], v[108:111]
    s_barrier
    s_cmp_lg_u32 s32, 0
    s_cbranch_scc1 L_arv2
    s_mov_b32 s20, s82
    s_mov_b32 s21, s83
    s_mov_b32 s22, 0x100
    s_mov_b32 s23, 0x00020000
    v_and_b32 v20, 15, v0
    v_lshlrev_b32 v20, 4, v20
    buffer_load_dword v21, v20, s[20:23], 0 offen sc1
    s_waitcnt vmcnt(0)
    v_cmp_gt_u32 vcc, 16, v21
    s_cbranch_vccnz L_spin3
L_back4:
L_arv2:
    s_mov_b32 s36, -1
    s_cmp_eq_u32 s36, s97
    s_cselect_b32 s47, 31, -2
    s_cselect_b64 s[8:9], s[88:89], s[8:9]
    s_add_u32 s50, s50, s47
    s_max_i32 s47, s50, 0
    s_lshl_b32 s41, s47, 15
    s_waitcnt vmcnt(0) lgkmcnt(0)
    s_barrier
    ds_read_b128 v[68:71], v4 offset:0
    ds_read_b128 v[72:75], v4 offset:2048
    ds_read_b128 v[76:79], v5 offset:0
    ds_read_b128 v[80:83], v5 offset:2048
    s_mov_b32 s36, 0
    s_waitcnt lgkmcnt(0)
    s_branch L_q_b1
    s_nop 7
L_q_b0:
    s_waitcnt lgkmcnt(0)
    v_mfma_f32_16x16x32_bf16 v[20:23], a[0:3], v[68:71], 0
    ds_read_b128 v[84:87], v2 offset:4096
    v_mul_f32 v44, v44, v114
    v_mfma_f32_16x16x32_bf16 v[24:27], a[0:3], v[72:75], 0
    ds_read_b128 v[88:91], v2 offset:6144
    v_mul_f32 v45, v45, v114
    v_mfma_f32_16x16x32_bf16 v[32:35], a[4:7], v[72:75], 0
    ds_read_b128 v[92:95], v3 offset:4096
    v_mul_f32 v46, v46, v114
    v_mfma_f32_16x16x32_bf16 v[28:31], a[4:7], v[68:71], 0
    ds_read_b128 v[96:99], v3 offset:6144
    v_mul_f32 v47, v47, v114
    v_mfma_f32_16x16x32_bf16 v[36:39], a[8:11], v[68:71], 0
    v_cvt_pk_bf16_f32 v44, v44, v45
    v_cvt_pk_bf16_f32 v45, v46, v47
    v_mfma_f32_16x16x32_bf16 v[40:43], a[8:11], v[72:75], 0
    ds_write_b64 v7, v[44:45] offset:12288
    v_mul_f32 v48, v48, v115
    v_mfma_f32_16x16x32_bf16 v[20:23], a[12:15], v[76:79], v[20:23]
    v_mul_f32 v49, v49, v115
    v_mul_f32 v50, v50, v115
    v_mfma_f32_16x16x32_bf16 v[24:27], a[12:15], v[80:83], v[24:27]
    v_mul_f32 v51, v51, v115
    v_cvt_pk_bf16_f32 v48, v48, v49
    v_mfma_f32_16x16x32_bf16 v[32:35], a[16:19], v[80:83], v[32:35]
    v_cvt_pk_bf16_f32 v49, v50, v51
    ds_write_b64 v7, v[48:49] offset:18432
    v_mfma_f32_16x16x32_bf16 v[28:31], a[16:19], v[76:79], v[28:31]
    v_mul_f32 v52, v52, v114
    v_mul_f32 v53, v53, v114
    v_mfma_f32_16x16x32_bf16 v[36:39], a[20:23], v[76:79], v[36:39]
    v_mul_f32 v54, v54, v114
    v_mul_f32 v55, v55, v114
    v_mfma_f32_16x16x32_bf16 v[40:43], a[20:23], v[80:83], v[40:43]
    v_cvt_pk_bf16_f32 v52, v52, v53
    s_waitcnt lgkmcnt(2)
    v_mfma_f32_16x16x32_bf16 v[20:23], a[24:27], v[84:87], v[20:23]
    ds_read_b128 v[68:71], v2 offset:8192
    v_cvt_pk_bf16_f32 v53, v54, v55
    v_mfma_f32_16x16x32_bf16 v[24:27], a[24:27], v[88:91], v[24:27]
    ds_read_b128 v[72:75], v2 offset:10240
    ds_write_b64 v7, v[52:53] offset:13312
    v_mfma_f32_16x16x32_bf16 v[32:35], a[28:31], v[88:91], v[32:35]
    ds_read_b128 v[76:79], v3 offset:8192
    v_mul_f32 v56, v56, v115
    v_mfma_f32_16x16x32_bf16 v[28:31], a[28:31], v[84:87], v[28:31]
    ds_read_b128 v[80:83], v3 offset:10240
    v_mul_f32 v57, v57, v115
    v_mfma_f32_16x16x32_bf16 v[36:39], a[32:35], v[84:87], v[36:39]
    v_mul_f32 v58, v58, v115
    v_mul_f32 v59, v59, v115
    v_mfma_f32_16x16x32_bf16 v[40:43], a[32:35], v[88:91], v[40:43]
    v_cvt_pk_bf16_f32 v56, v56, v57
    v_cvt_pk_bf16_f32 v57, v58, v59
    v_mfma_f32_16x16x32_bf16 v[20:23], a[36:39], v[92:95], v[20:23]
    ds_write_b64 v7, v[56:57] offset:19456
    v_mul_f32 v60, v60, v114
    v_mfma_f32_16x16x32_bf16 v[24:27], a[36:39], v[96:99], v[24:27]
    v_mul_f32 v61, v61, v114
    v_mul_f32 v62, v62, v114
    v_mfma_f32_16x16x32_bf16 v[32:35], a[40:43], v[96:99], v[32:35]
    v_mul_f32 v63, v63, v114
    v_cvt_pk_bf16_f32 v60, v60, v61
    v_mfma_f32_16x16x32_bf16 v[28:31], a[40:43], v[92:95], v[28:31]
    v_cvt_pk_bf16_f32 v61, v62, v63
    ds_write_b64 v8, v[60:61] offset:14336
    v_mfma_f32_16x16x32_bf16 v[36:39], a[44:47], v[92:95], v[36:39]
    v_mul_f32 v64, v64, v115
    v_mul_f32 v65, v65, v115
    v_mfma_f32_16x16x32_bf16 v[40:43], a[44:47], v[96:99], v[40:43]
    v_mul_f32 v66, v66, v115
    s_waitcnt lgkmcnt(2)
    v_mfma_f32_16x16x32_bf16 v[20:23], a[48:51], v[68:71], v[20:23]
    ds_read_b128 v[84:87], v2 offset:12288
    v_mul_f32 v67, v67, v115
    v_mfma_f32_16x16x32_bf16 v[24:27], a[48:51], v[72:75], v[24:27]
    ds_read_b128 v[88:91], v2 offset:14336
    v_cvt_pk_bf16_f32 v64, v64, v65
    v_mfma_f32_16x16x32_bf16 v[32:35], a[52:55], v[72:75], v[32:35]
    ds_read_b128 v[92:95], v3 offset:12288
    v_cvt_pk_bf16_f32 v65, v66, v67
    v_mfma_f32_16x16x32_bf16 v[28:31], a[52:55], v[68:71], v[28:31]
    ds_read_b128 v[96:99], v3 offset:14336
    ds_write_b64 v8, v[64:65] offset:20480
    v_mfma_f32_16x16x32_bf16 v[36:39], a[56:59], v[68:71], v[36:39]
    v_mfma_f32_16x16x32_bf16 v[40:43], a[56:59], v[72:75], v[40:43]
    v_mfma_f32_16x16x32_bf16 v[20:23], a[60:63], v[76:79], v[20:23]
    s_waitcnt vmcnt(0)
    v_cmp_ne_u32 vcc, 0, v116
    s_cbranch_vccnz L_spin7
L_back8:
    v_mfma_f32_16x16x32_bf16 v[24:27], a[60:63], v[80:83], v[24:27]
    v_mfma_f32_16x16x32_bf16 v[32:35], a[64:67], v[80:83], v[32:35]
    s_waitcnt lgkmcnt(0)
    s_barrier
    v_mfma_f32_16x16x32_bf16 v[28:31], a[64:67], v[76:79], v[28:31]
    s_add_u32 m0, s43, 98304
    ds_read_b128 v[44:47], v9 offset:6144
    v_mfma_f32_16x16x32_bf16 v[36:39], a[68:71], v[76:79], v[36:39]
    buffer_load_dwordx4 v6, s[8:11], s41 offen offset:0 sc1 lds
    ds_read_b128 v[48:51], v9 offset:13312
    v_mfma_f32_16x16x32_bf16 v[40:43], a[68:71], v[80:83], v[40:43]
    ds_read_b128 v[52:55], v9 offset:7168
    s_waitcnt lgkmcnt(4)
    v_mfma_f32_16x16x32_bf16 v[20:23], a[72:75], v[84:87], v[20:23]
    ds_read_b128 v[68:71], v2 offset:16384
    ds_read_b64_tr_b16 v[56:57], v9 offset:14336
    v_mfma_f32_16x16x32_bf16 v[24:27], a[72:75], v[88:91], v[24:27]
    ds_read_b128 v[72:75], v2 offset:18432
    ds_read_b64_tr_b16 v[58:59], v9 offset:8192
    v_mfma_f32_16x16x32_bf16 v[32:35], a[76:79], v[88:91], v[32:35]
    ds_read_b128 v[76:79], v3 offset:16384
    ds_read_b64_tr_b16 v[60:61], v9 offset:14344
    v_mfma_f32_16x16x32_bf16 v[28:31], a[76:79], v[84:87], v[28:31]
    ds_read_b128 v[80:83], v3 offset:18432
    ds_read_b64_tr_b16 v[62:63], v9 offset:8200
    v_mfma_f32_16x16x32_bf16 v[36:39], a[80:83], v[84:87], v[36:39]
    s_add_u32 m0, s43, 102272
    v_mfma_f32_16x16x32_bf16 v[40:43], a[80:83], v[88:91], v[40:43]
    buffer_load_dwordx4 v6, s[8:11], s41 offen offset:128 sc1 lds
    v_mfma_f32_16x16x32_bf16 v[20:23], a[84:87], v[92:95], v[20:23]
    v_mfma_f32_16x16x32_bf16 v[24:27], a[84:87], v[96:99], v[24:27]
    s_waitcnt lgkmcnt(8)
    v_mfma_f32_16x16x32_bf16 v[64:67], v[48:51], v[44:47], 0
    v_mfma_f32_16x16x32_bf16 v[118:121], v[52:55], v[44:47], 0
    v_mfma_f32_16x16x32_bf16 v[32:35], a[88:91], v[96:99], v[32:35]
    v_mfma_f32_16x16x32_bf16 v[28:31], a[88:91], v[92:95], v[28:31]
    v_mfma_f32_16x16x32_bf16 v[36:39], a[92:95], v[92:95], v[36:39]
    v_cndmask_b32 v64, v64, v65, s[56:57]
    v_cndmask_b32 v66, v66, v67, s[56:57]
    v_mfma_f32_16x16x32_bf16 v[40:43], a[92:95], v[96:99], v[40:43]
    s_add_u32 m0, s43, 106240
    s_waitcnt lgkmcnt(1)
    v_mfma_f32_16x16x32_bf16 v[20:23], a[96:99], v[68:71], v[20:23]
    ds_read_b128 v[84:87], v2 offset:20480
    buffer_load_dwordx4 v6, s[8:11], s41 offen offset:256 sc1 lds
    v_mfma_f32_16x16x32_bf16 v[24:27], a[96:99], v[72:75], v[24:27]
    ds_read_b128 v[88:91], v2 offset:22528
    v_cndmask_b32 v118, v118, v119, s[56:57]
    v_mfma_f32_16x16x32_bf16 v[32:35], a[100:103], v[72:75], v[32:35]
    ds_read_b128 v[92:95], v3 offset:20480
    v_cndmask_b32 v120, v120, v121, s[56:57]
    v_mfma_f32_16x16x32_bf16 v[28:31], a[100:103], v[68:71], v[28:31]
    ds_read_b128 v[96:99], v3 offset:22528
    v_cndmask_b32 v64, v18, v64, s[62:63]
    v_mfma_f32_16x16x32_bf16 v[36:39], a[104:107], v[68:71], v[36:39]
    v_cndmask_b32 v66, v18, v66, s[62:63]
    v_cndmask_b32 v46, v64, v118, s[58:59]
    v_mfma_f32_16x16x32_bf16 v[40:43], a[104:107], v[72:75], v[40:43]
    v_cndmask_b32 v47, v66, v120, s[60:61]
    v_max_f32 v44, v46, v47
    v_mfma_f32_16x16x32_bf16 v[20:23], a[108:111], v[76:79], v[20:23]
    s_add_u32 m0, s43, 110208
    v_mov_b32 v45, v44
    v_mfma_f32_16x16x32_bf16 v[24:27], a[108:111], v[80:83], v[24:27]
    buffer_load_dwordx4 v6, s[8:11], s41 offen offset:384 sc1 lds
    v_permlane16_swap_b32 v44, v45
    v_mfma_f32_16x16x32_bf16 v[32:35], a[112:115], v[80:83], v[32:35]
    v_max_f32 v44, v44, v45
    v_mov_b32 v45, v44
    v_mfma_f32_16x16x32_bf16 v[28:31], a[112:115], v[76:79], v[28:31]
    v_permlane32_swap_b32 v44, v45
    v_max_f32 v44, v44, v45
    v_mfma_f32_16x16x32_bf16 v[36:39], a[116:119], v[76:79], v[36:39]
    v_mul_f32 v44, s86, v44
    v_fma_f32 v46, v46, s86, -v44
    v_mfma_f32_16x16x32_bf16 v[40:43], a[116:119], v[80:83], v[40:43]
    v_fma_f32 v47, v47, s86, -v44
    s_waitcnt lgkmcnt(0)
    v_mfma_f32_16x16x32_bf16 v[20:23], a[120:123], v[84:87], v[20:23]
    ds_read_b128 v[68:71], v2 offset:24576
    v_exp_f32 v46, v46
    v_mfma_f32_16x16x32_bf16 v[24:27], a[120:123], v[88:91], v[24:27]
    ds_read_b128 v[72:75], v2 offset:26624
    s_add_u32 m0, s43, 114176
    v_mfma_f32_16x16x32_bf16 v[32:35], a[124:127], v[88:91], v[32:35]
    ds_read_b128 v[76:79], v3 offset:24576
    buffer_load_dwordx4 v6, s[8:11], s41 offen offset:512 sc1 lds
    v_mfma_f32_16x16x32_bf16 v[28:31], a[124:127], v[84:87], v[28:31]
    ds_read_b128 v[80:83], v3 offset:26624
    v_exp_f32 v47, v47
    v_mfma_f32_16x16x32_bf16 v[36:39], a[128:131], v[84:87], v[36:39]
    v_add_f32 v44, v46, v47
    v_mov_b32 v45, v44
    v_mfma_f32_16x16x32_bf16 v[40:43], a[128:131], v[88:91], v[40:43]
    v_permlane16_swap_b32 v44, v45
    v_add_f32 v44, v44, v45
    v_mfma_f32_16x16x32_bf16 v[20:23], a[132:135], v[92:95], v[20:23]
    v_mov_b32 v45, v44
    v_mfma_f32_16x16x32_bf16 v[24:27], a[132:135], v[96:99], v[24:27]
    v_permlane32_swap_b32 v44, v45
    v_add_f32 v44, v44, v45
    v_mfma_f32_16x16x32_bf16 v[32:35], a[136:139], v[96:99], v[32:35]
    s_add_u32 m0, s43, 118144
    v_rcp_f32 v44, v44
    v_mfma_f32_16x16x32_bf16 v[28:31], a[136:139], v[92:95], v[28:31]
    buffer_load_dwordx4 v6, s[8:11], s41 offen offset:640 sc1 lds
    v_mul_f32 v46, v46, v44
    v_mfma_f32_16x16x32_bf16 v[36:39], a[140:143], v[92:95], v[36:39]
    v_mul_f32 v47, v47, v44
    v_cvt_pk_bf16_f32 v45, v46, v47
    v_mfma_f32_16x16x32_bf16 v[40:43], a[140:143], v[96:99], v[40:43]
    v_perm_b32 v48, v45, v45, v14
    s_waitcnt lgkmcnt(0)
    v_mfma_f32_16x16x32_bf16 v[20:23], a[144:147], v[68:71], v[20:23]
    ds_read_b128 v[84:87], v2 offset:28672
    v_perm_b32 v49, v45, v45, v15
    v_mfma_f32_16x16x32_bf16 v[24:27], a[144:147], v[72:75], v[24:27]
    ds_read_b128 v[88:91], v2 offset:30720
    v_perm_b32 v50, v45, v45, v16
    v_mfma_f32_16x16x32_bf16 v[32:35], a[148:151], v[72:75], v[32:35]
    ds_read_b128 v[92:95], v3 offset:28672
    v_perm_b32 v51, v45, v45, v17
    v_mfma_f32_16x16x32_bf16 v[28:31], a[148:151], v[68:71], v[28:31]
    ds_read_b128 v[96:99], v3 offset:30720
    s_add_u32 m0, s43, 122112
    v_mfma_f32_16x16x32_bf16 v[36:39], a[152:155], v[68:71], v[36:39]
    buffer_load_dwordx4 v6, s[8:11], s41 offen offset:768 sc1 lds
    v_mfma_f32_16x16x32_bf16 v[64:67], v[56:59], v[48:51], 0
    v_mfma_f32_16x16x32_bf16 v[118:121], v[60:63], v[48:51], 0
    v_mfma_f32_16x16x32_bf16 v[40:43], a[152:155], v[72:75], v[40:43]
    v_mfma_f32_16x16x32_bf16 v[20:23], a[156:159], v[76:79], v[20:23]
    v_mfma_f32_16x16x32_bf16 v[24:27], a[156:159], v[80:83], v[24:27]
    v_cvt_pk_bf16_f32 v52, v64, v65
    v_cvt_pk_bf16_f32 v53, v66, v67
    v_mfma_f32_16x16x32_bf16 v[32:35], a[160:163], v[80:83], v[32:35]
    v_cvt_pk_bf16_f32 v54, v118, v119
    v_cvt_pk_bf16_f32 v55, v120, v121
    v_mfma_f32_16x16x32_bf16 v[28:31], a[160:163], v[76:79], v[28:31]
    buffer_store_dwordx4 v[52:55], v1, s[16:19], s44 offen sc1
    s_cmp_eq_u32 s36, 16
    s_cselect_b64 s[98:99], -1, 0
    s_cselect_b32 s38, 97280, 0
    v_mfma_f32_16x16x32_bf16 v[36:39], a[164:167], v[76:79], v[36:39]
    s_add_u32 m0, s43, 126080
    v_cndmask_b32 v66, v13, v19, s[98:99]
    v_mfma_f32_16x16x32_bf16 v[40:43], a[164:167], v[80:83], v[40:43]
    buffer_load_dwordx4 v6, s[8:11], s41 offen offset:896 sc1 lds
    s_waitcnt lgkmcnt(0)
    v_mfma_f32_16x16x32_bf16 v[20:23], a[168:171], v[84:87], v[20:23]
    ds_read_b128 v[68:71], v2 offset:32768
    buffer_load_dwordx2 v[56:57], v66, s[16:19], s46 offen offset:0 sc1
    v_mfma_f32_16x16x32_bf16 v[24:27], a[168:171], v[88:91], v[24:27]
    ds_read_b128 v[72:75], v2 offset:34816
    buffer_load_dwordx2 v[58:59], v66, s[16:19], s46 offen offset:128 sc1
    v_mfma_f32_16x16x32_bf16 v[32:35], a[172:175], v[88:91], v[32:35]
    ds_read_b128 v[76:79], v3 offset:32768
    buffer_load_dwordx2 v[60:61], v66, s[16:19], s46 offen offset:256 sc1
    v_mfma_f32_16x16x32_bf16 v[28:31], a[172:175], v[84:87], v[28:31]
    ds_read_b128 v[80:83], v3 offset:34816
    buffer_load_dwordx2 v[62:63], v66, s[16:19], s46 offen offset:384 sc1
    v_mfma_f32_16x16x32_bf16 v[36:39], a[176:179], v[84:87], v[36:39]
    s_cmp_eq_u32 s36, 17
    s_cselect_b32 s49, s87, 0x10000
    v_mfma_f32_16x16x32_bf16 v[40:43], a[176:179], v[88:91], v[40:43]
    s_add_u32 m0, s43, 130048
    s_add_u32 s90, s90, s49
    v_mfma_f32_16x16x32_bf16 v[20:23], a[180:183], v[92:95], v[20:23]
    buffer_load_dwordx4 v6, s[8:11], s41 offen offset:1024 sc1 lds
    s_bitcmp1_b64 s[24:25], s36
    s_cselect_b32 s44, s90, 0x8000000
    v_mfma_f32_16x16x32_bf16 v[24:27], a[180:183], v[96:99], v[24:27]
    s_bitcmp1_b64 s[26:27], s36
    s_cselect_b64 s[62:63], 0, -1
    v_mfma_f32_16x16x32_bf16 v[32:35], a[184:187], v[96:99], v[32:35]
    v_mfma_f32_16x16x32_bf16 v[28:31], a[184:187], v[92:95], v[28:31]
    v_mfma_f32_16x16x32_bf16 v[36:39], a[188:191], v[92:95], v[36:39]
    v_mfma_f32_16x16x32_bf16 v[40:43], a[188:191], v[96:99], v[40:43]
    s_waitcnt lgkmcnt(0)
    v_mfma_f32_16x16x32_bf16 v[20:23], a[192:195], v[68:71], v[20:23]
    ds_read_b128 v[84:87], v2 offset:36864
    s_add_u32 m0, s43, 134016
    v_mfma_f32_16x16x32_bf16 v[24:27], a[192:195], v[72:75], v[24:27]
    ds_read_b128 v[88:91], v2 offset:38912
    buffer_load_dwordx4 v6, s[8:11], s41 offen offset:1152 sc1 lds
    v_mfma_f32_16x16x32_bf16 v[32:35], a[196:199], v[72:75], v[32:35]
    ds_read_b128 v[92:95], v3 offset:36864
    v_mfma_f32_16x16x32_bf16 v[28:31], a[196:199], v[68:71], v[28:31]
    ds_read_b128 v[96:99], v3 offset:38912
    v_mfma_f32_16x16x32_bf16 v[36:39], a[200:203], v[68:71], v[36:39]
    v_mfma_f32_16x16x32_bf16 v[40:43], a[200:203], v[72:75], v[40:43]
    v_mfma_f32_16x16x32_bf16 v[20:23], a[204:207], v[76:79], v[20:23]
    v_mfma_f32_16x16x32_bf16 v[24:27], a[204:207], v[80:83], v[24:27]
    s_add_u32 m0, s43, 137984
    v_mfma_f32_16x16x32_bf16 v[32:35], a[208:211], v[80:83], v[32:35]
    buffer_load_dwordx4 v6, s[8:11], s41 offen offset:1280 sc1 lds
    v_mfma_f32_16x16x32_bf16 v[28:31], a[208:211], v[76:79], v[28:31]
    v_mfma_f32_16x16x32_bf16 v[36:39], a[212:215], v[76:79], v[36:39]
    v_mfma_f32_16x16x32_bf16 v[40:43], a[212:215], v[80:83], v[40:43]
    s_waitcnt lgkmcnt(0)
    v_mfma_f32_16x16x32_bf16 v[20:23], a[216:219], v[84:87], v[20:23]
    ds_read_b128 v[68:71], v2 offset:40960
    v_mfma_f32_16x16x32_bf16 v[24:27], a[216:219], v[88:91], v[24:27]
    ds_read_b128 v[72:75], v2 offset:43008
    v_mfma_f32_16x16x32_bf16 v[32:35], a[220:223], v[88:91], v[32:35]
    ds_read_b128 v[76:79], v3 offset:40960
    s_add_u32 m0, s43, 141952
    v_mfma_f32_16x16x32_bf16 v[28:31], a[220:223], v[84:87], v[28:31]
    ds_read_b128 v[80:83], v3 offset:43008
    buffer_load_dwordx4 v6, s[8:11], s41 offen offset:1408 sc1 lds
    v_mfma_f32_16x16x32_bf16 v[36:39], a[224:227], v[84:87], v[36:39]
    v_mfma_f32_16x16x32_bf16 v[40:43], a[224:227], v[88:91], v[40:43]
    v_mfma_f32_16x16x32_bf16 v[20:23], a[228:231], v[92:95], v[20:23]
    v_mfma_f32_16x16x32_bf16 v[24:27], a[228:231], v[96:99], v[24:27]
    v_mfma_f32_16x16x32_bf16 v[32:35], a[232:235], v[96:99], v[32:35]
    v_mfma_f32_16x16x32_bf16 v[28:31], a[232:235], v[92:95], v[28:31]
    s_add_u32 m0, s43, 145920
    v_mfma_f32_16x16x32_bf16 v[36:39], a[236:239], v[92:95], v[36:39]
    buffer_load_dwordx4 v6, s[8:11], s41 offen offset:1536 sc1 lds
    v_mfma_f32_16x16x32_bf16 v[40:43], a[236:239], v[96:99], v[40:43]
    s_waitcnt lgkmcnt(0)
    v_mfma_f32_16x16x32_bf16 v[20:23], a[240:243], v[68:71], v[20:23]
    ds_read_b128 v[84:87], v2 offset:45056
    v_mfma_f32_16x16x32_bf16 v[24:27], a[240:243], v[72:75], v[24:27]
    ds_read_b128 v[88:91], v2 offset:47104
    v_mfma_f32_16x16x32_bf16 v[32:35], a[244:247], v[72:75], v[32:35]
    ds_read_b128 v[92:95], v3 offset:45056
    v_mfma_f32_16x16x32_bf16 v[28:31], a[244:247], v[68:71], v[28:31]
    ds_read_b128 v[96:99], v3 offset:47104
    v_mfma_f32_16x16x32_bf16 v[36:39], a[248:251], v[68:71], v[36:39]
    s_add_u32 m0, s43, 149888
    v_mfma_f32_16x16x32_bf16 v[40:43], a[248:251], v[72:75], v[40:43]
    buffer_load_dwordx4 v6, s[8:11], s41 offen offset:1664 sc1 lds
    v_mfma_f32_16x16x32_bf16 v[20:23], a[252:255], v[76:79], v[20:23]
    v_mfma_f32_16x16x32_bf16 v[24:27], a[252:255], v[80:83], v[24:27]
    v_mfma_f32_16x16x32_bf16 v[32:35], v[128:131], v[80:83], v[32:35]
    v_mfma_f32_16x16x32_bf16 v[28:31], v[128:131], v[76:79], v[28:31]
    v_mfma_f32_16x16x32_bf16 v[36:39], v[132:135], v[76:79], v[36:39]
    v_mfma_f32_16x16x32_bf16 v[40:43], v[132:135], v[80:83], v[40:43]
    s_add_u32 m0, s43, 153856
    s_waitcnt lgkmcnt(0)
    v_mfma_f32_16x16x32_bf16 v[20:23], v[136:139], v[84:87], v[20:23]
    ds_read_b128 v[68:71], v2 offset:49152
    buffer_load_dwordx4 v6, s[8:11], s41 offen offset:1792 sc1 lds
    v_mfma_f32_16x16x32_bf16 v[24:27], v[136:139], v[88:91], v[24:27]
    ds_read_b128 v[72:75], v2 offset:51200
    v_mfma_f32_16x16x32_bf16 v[32:35], v[140:143], v[88:91], v[32:35]
    ds_read_b128 v[76:79], v3 offset:49152
    v_mfma_f32_16x16x32_bf16 v[28:31], v[140:143], v[84:87], v[28:31]
    ds_read_b128 v[80:83], v3 offset:51200
    v_mfma_f32_16x16x32_bf16 v[36:39], v[144:147], v[84:87], v[36:39]
    v_mfma_f32_16x16x32_bf16 v[40:43], v[144:147], v[88:91], v[40:43]
    v_mfma_f32_16x16x32_bf16 v[20:23], v[148:151], v[92:95], v[20:23]
    s_add_u32 m0, s43, 157824
    v_mfma_f32_16x16x32_bf16 v[24:27], v[148:151], v[96:99], v[24:27]
    buffer_load_dwordx4 v6, s[8:11], s41 offen offset:1920 sc1 lds
    v_mfma_f32_16x16x32_bf16 v[32:35], v[152:155], v[96:99], v[32:35]
    v_mfma_f32_16x16x32_bf16 v[28:31], v[152:155], v[92:95], v[28:31]
    v_mfma_f32_16x16x32_bf16 v[36:39], v[156:159], v[92:95], v[36:39]
    s_waitcnt vmcnt(8)
    s_barrier
    v_mfma_f32_16x16x32_bf16 v[40:43], v[156:159], v[96:99], v[40:43]
    buffer_store_dword v124, v124, s[16:19], s91 offen sc1
    s_waitcnt lgkmcnt(0)
    v_mfma_f32_16x16x32_bf16 v[20:23], v[160:163], v[68:71], v[20:23]
    ds_read_b128 v[84:87], v2 offset:53248
    s_add_u32 s91, s91, 131072
    v_mfma_f32_16x16x32_bf16 v[24:27], v[160:163], v[72:75], v[24:27]
    ds_read_b128 v[88:91], v2 offset:55296
    v_med3_i32 v117, s45, 0, v12
    v_mfma_f32_16x16x32_bf16 v[32:35], v[164:167], v[72:75], v[32:35]
    ds_read_b128 v[92:95], v3 offset:53248
    v_add_u32 v117, v117, v11
    v_mfma_f32_16x16x32_bf16 v[28:31], v[164:167], v[68:71], v[28:31]
    ds_read_b128 v[96:99], v3 offset:55296
    s_add_u32 s45, s45, 131072
    v_mfma_f32_16x16x32_bf16 v[36:39], v[168:171], v[68:71], v[36:39]
    buffer_load_dword v116, v117, s[16:19], 0 offen sc1
    v_max3_u32 v64, v56, v57, v58
    v_mfma_f32_16x16x32_bf16 v[40:43], v[168:171], v[72:75], v[40:43]
    v_max3_u32 v65, v59, v60, v61
    v_max3_u32 v64, v64, v62, v63
    v_mfma_f32_16x16x32_bf16 v[20:23], v[172:175], v[76:79], v[20:23]
    v_max_u32 v64, v64, v65
    v_cmp_eq_u32 vcc, -1, v64
    s_cbranch_vccnz L_sspin5
L_sback6:
    v_mfma_f32_16x16x32_bf16 v[24:27], v[172:175], v[80:83], v[24:27]
    v_add_f32 v64, v60, v62
    v_add_f32 v65, v61, v63
    v_mfma_f32_16x16x32_bf16 v[32:35], v[176:179], v[80:83], v[32:35]
    v_add_f32 v56, v56, v58
    v_add_f32 v57, v57, v59
    v_mfma_f32_16x16x32_bf16 v[28:31], v[176:179], v[76:79], v[28:31]
    v_add_f32 v56, v56, v64
    v_add_f32 v57, v57, v65
    v_mfma_f32_16x16x32_bf16 v[36:39], v[180:183], v[76:79], v[36:39]
    v_mov_b32 v64, v56
    v_mov_b32 v65, v57
    v_mfma_f32_16x16x32_bf16 v[40:43], v[180:183], v[80:83], v[40:43]
    v_permlane32_swap_b32 v56, v64
    s_waitcnt lgkmcnt(0)
    v_mfma_f32_16x16x32_bf16 v[20:23], v[184:187], v[84:87], v[20:23]
    ds_read_b128 v[68:71], v2 offset:57344
    v_permlane32_swap_b32 v57, v65
    v_mfma_f32_16x16x32_bf16 v[24:27], v[184:187], v[88:91], v[24:27]
    ds_read_b128 v[72:75], v2 offset:59392
    v_add_f32 v56, v56, v64
    v_mfma_f32_16x16x32_bf16 v[32:35], v[188:191], v[88:91], v[32:35]
    ds_read_b128 v[76:79], v3 offset:57344
    v_add_f32 v57, v57, v65
    v_mfma_f32_16x16x32_bf16 v[28:31], v[188:191], v[84:87], v[28:31]
    ds_read_b128 v[80:83], v3 offset:59392
    v_mul_f32 v112, 0xba800000, v56
    v_mfma_f32_16x16x32_bf16 v[36:39], v[192:195], v[84:87], v[36:39]
    v_mul_f32 v57, 0x3a800000, v57
    v_fma_f32 v57, -v112, v112, v57
    v_mfma_f32_16x16x32_bf16 v[40:43], v[192:195], v[88:91], v[40:43]
    v_mov_b32 v113, v112
    v_max_f32 v57, 0, v57
    v_mfma_f32_16x16x32_bf16 v[20:23], v[196:199], v[92:95], v[20:23]
    v_add_f32 v57, 0x3727c5ac, v57
    v_rsq_f32 v114, v57
    v_mfma_f32_16x16x32_bf16 v[24:27], v[196:199], v[96:99], v[24:27]
    v_permlane16_swap_b32 v112, v113
    v_mov_b32 v115, v114
    v_mfma_f32_16x16x32_bf16 v[32:35], v[200:203], v[96:99], v[32:35]
    v_permlane16_swap_b32 v114, v115
    s_add_u32 s46, s46, 2048
    v_mfma_f32_16x16x32_bf16 v[28:31], v[200:203], v[92:95], v[28:31]
    s_add_u32 s46, s46, s38
    v_fmac_f32 v20, v112, v100
    v_mfma_f32_16x16x32_bf16 v[36:39], v[204:207], v[92:95], v[36:39]
    v_fmac_f32 v21, v112, v101
    v_fmac_f32 v22, v112, v102
    v_mfma_f32_16x16x32_bf16 v[40:43], v[204:207], v[96:99], v[40:43]
    v_fmac_f32 v24, v113, v100
    s_waitcnt lgkmcnt(0)
    v_mfma_f32_16x16x32_bf16 v[20:23], v[208:211], v[68:71], v[20:23]
    ds_read_b128 v[84:87], v2 offset:61440
    v_fmac_f32 v28, v112, v104
    v_mfma_f32_16x16x32_bf16 v[24:27], v[208:211], v[72:75], v[24:27]
    ds_read_b128 v[88:91], v2 offset:63488
    v_fmac_f32 v29, v112, v105
    v_mfma_f32_16x16x32_bf16 v[32:35], v[212:215], v[72:75], v[32:35]
    ds_read_b128 v[92:95], v3 offset:61440
    v_fmac_f32 v23, v112, v103
    v_mfma_f32_16x16x32_bf16 v[28:31], v[212:215], v[68:71], v[28:31]
    ds_read_b128 v[96:99], v3 offset:63488
    v_fmac_f32 v25, v113, v101
    v_mfma_f32_16x16x32_bf16 v[36:39], v[216:219], v[68:71], v[36:39]
    v_fmac_f32 v26, v113, v102
    v_fmac_f32 v27, v113, v103
    v_mfma_f32_16x16x32_bf16 v[40:43], v[216:219], v[72:75], v[40:43]
    v_fmac_f32 v30, v112, v106
    v_fmac_f32 v31, v112, v107
    v_mfma_f32_16x16x32_bf16 v[20:23], v[220:223], v[76:79], v[20:23]
    v_fmac_f32 v32, v113, v104
    v_fmac_f32 v33, v113, v105
    v_mfma_f32_16x16x32_bf16 v[24:27], v[220:223], v[80:83], v[24:27]
    v_fmac_f32 v36, v112, v108
    v_fmac_f32 v37, v112, v109
    v_mfma_f32_16x16x32_bf16 v[32:35], v[224:227], v[80:83], v[32:35]
    v_fmac_f32 v38, v112, v110
    v_fmac_f32 v39, v112, v111
    v_mfma_f32_16x16x32_bf16 v[28:31], v[224:227], v[76:79], v[28:31]
    v_fmac_f32 v40, v113, v108
    v_fmac_f32 v41, v113, v109
    v_mfma_f32_16x16x32_bf16 v[36:39], v[228:231], v[76:79], v[36:39]
    v_fmac_f32 v34, v113, v106
    v_fmac_f32 v35, v113, v107
    v_mfma_f32_16x16x32_bf16 v[40:43], v[228:231], v[80:83], v[40:43]
    s_cmp_eq_u32 s36, s97
    s_cselect_b32 s47, 31, -2
    s_cselect_b64 s[8:9], s[88:89], s[8:9]
    s_waitcnt lgkmcnt(0)
    v_mfma_f32_16x16x32_bf16 v[20:23], v[232:235], v[84:87], v[20:23]
    ds_read_b128 v[68:71], v4 offset:0
    s_add_u32 s50, s50, s47
    v_mfma_f32_16x16x32_bf16 v[24:27], v[232:235], v[88:91], v[24:27]
    ds_read_b128 v[72:75], v4 offset:2048
    v_fmac_f32 v42, v113, v110
    v_mfma_f32_16x16x32_bf16 v[32:35], v[236:239], v[88:91], v[32:35]
    ds_read_b128 v[76:79], v5 offset:0
    v_fmac_f32 v43, v113, v111
    v_mfma_f32_16x16x32_bf16 v[28:31], v[236:239], v[84:87], v[28:31]
    ds_read_b128 v[80:83], v5 offset:2048
    s_max_i32 s47, s50, 0
    v_mfma_f32_16x16x32_bf16 v[36:39], v[240:243], v[84:87], v[36:39]
    s_lshl_b32 s41, s47, 15
    v_mfma_f32_16x16x32_bf16 v[40:43], v[240:243], v[88:91], v[40:43]
    v_mfma_f32_16x16x32_bf16 v[20:23], v[244:247], v[92:95], v[20:23]
    v_mfma_f32_16x16x32_bf16 v[24:27], v[244:247], v[96:99], v[24:27]
    v_mfma_f32_16x16x32_bf16 v[32:35], v[248:251], v[96:99], v[32:35]
    v_mfma_f32_16x16x32_bf16 v[28:31], v[248:251], v[92:95], v[28:31]
    v_mfma_f32_16x16x32_bf16 v[36:39], v[252:255], v[92:95], v[36:39]
    v_mfma_f32_16x16x32_bf16 v[40:43], v[252:255], v[96:99], v[40:43]
    s_add_u32 s36, s36, 1
L_q_b1:
    s_waitcnt lgkmcnt(0)
    v_mfma_f32_16x16x32_bf16 v[44:47], a[0:3], v[68:71], 0
    ds_read_b128 v[84:87], v4 offset:4096
    v_mul_f32 v20, v20, v114
    v_mfma_f32_16x16x32_bf16 v[48:51], a[0:3], v[72:75], 0
    ds_read_b128 v[88:91], v4 offset:6144
    v_mul_f32 v21, v21, v114
    v_mfma_f32_16x16x32_bf16 v[56:59], a[4:7], v[72:75], 0
    ds_read_b128 v[92:95], v5 offset:4096
    v_mul_f32 v22, v22, v114
    v_mfma_f32_16x16x32_bf16 v[52:55], a[4:7], v[68:71], 0
    ds_read_b128 v[96:99], v5 offset:6144
    v_mul_f32 v23, v23, v114
    v_mfma_f32_16x16x32_bf16 v[60:63], a[8:11], v[68:71], 0
    v_cvt_pk_bf16_f32 v20, v20, v21
    v_cvt_pk_bf16_f32 v21, v22, v23
    v_mfma_f32_16x16x32_bf16 v[64:67], a[8:11], v[72:75], 0
    ds_write_b64 v7, v[20:21] offset:0
    v_mul_f32 v24, v24, v115
    v_mfma_f32_16x16x32_bf16 v[44:47], a[12:15], v[76:79], v[44:47]
    v_mul_f32 v25, v25, v115
    v_mul_f32 v26, v26, v115
    v_mfma_f32_16x16x32_bf16 v[48:51], a[12:15], v[80:83], v[48:51]
    v_mul_f32 v27, v27, v115
    v_cvt_pk_bf16_f32 v24, v24, v25
    v_mfma_f32_16x16x32_bf16 v[56:59], a[16:19], v[80:83], v[56:59]
    v_cvt_pk_bf16_f32 v25, v26, v27
    ds_write_b64 v7, v[24:25] offset:6144
    v_mfma_f32_16x16x32_bf16 v[52:55], a[16:19], v[76:79], v[52:55]
    v_mul_f32 v28, v28, v114
    v_mul_f32 v29, v29, v114
    v_mfma_f32_16x16x32_bf16 v[60:63], a[20:23], v[76:79], v[60:63]
    v_mul_f32 v30, v30, v114
    v_mul_f32 v31, v31, v114
    v_mfma_f32_16x16x32_bf16 v[64:67], a[20:23], v[80:83], v[64:67]
    v_cvt_pk_bf16_f32 v28, v28, v29
    s_waitcnt lgkmcnt(2)
    v_mfma_f32_16x16x32_bf16 v[44:47], a[24:27], v[84:87], v[44:47]
    ds_read_b128 v[68:71], v4 offset:8192
    v_cvt_pk_bf16_f32 v29, v30, v31
    v_mfma_f32_16x16x32_bf16 v[48:51], a[24:27], v[88:91], v[48:51]
    ds_read_b128 v[72:75], v4 offset:10240
    ds_write_b64 v7, v[28:29] offset:1024
    v_mfma_f32_16x16x32_bf16 v[56:59], a[28:31], v[88:91], v[56:59]
    ds_read_b128 v[76:79], v5 offset:8192
    v_mul_f32 v32, v32, v115
    v_mfma_f32_16x16x32_bf16 v[52:55], a[28:31], v[84:87], v[52:55]
    ds_read_b128 v[80:83], v5 offset:10240
    v_mul_f32 v33, v33, v115
    v_mfma_f32_16x16x32_bf16 v[60:63], a[32:35], v[84:87], v[60:63]
    v_mul_f32 v34, v34, v115
    v_mul_f32 v35, v35, v115
    v_mfma_f32_16x16x32_bf16 v[64:67], a[32:35], v[88:91], v[64:67]
    v_cvt_pk_bf16_f32 v32, v32, v33
    v_cvt_pk_bf16_f32 v33, v34, v35
    v_mfma_f32_16x16x32_bf16 v[44:47], a[36:39], v[92:95], v[44:47]
    ds_write_b64 v7, v[32:33] offset:7168
    v_mul_f32 v36, v36, v114
    v_mfma_f32_16x16x32_bf16 v[48:51], a[36:39], v[96:99], v[48:51]
    v_mul_f32 v37, v37, v114
    v_mul_f32 v38, v38, v114
    v_mfma_f32_16x16x32_bf16 v[56:59], a[40:43], v[96:99], v[56:59]
    v_mul_f32 v39, v39, v114
    v_cvt_pk_bf16_f32 v36, v36, v37
    v_mfma_f32_16x16x32_bf16 v[52:55], a[40:43], v[92:95], v[52:55]
    v_cvt_pk_bf16_f32 v37, v38, v39
    ds_write_b64 v8, v[36:37] offset:2048
    v_mfma_f32_16x16x32_bf16 v[60:63], a[44:47], v[92:95], v[60:63]
    v_mul_f32 v40, v40, v115
    v_mul_f32 v41, v41, v115
    v_mfma_f32_16x16x32_bf16 v[64:67], a[44:47], v[96:99], v[64:67]
    v_mul_f32 v42, v42, v115
    s_waitcnt lgkmcnt(2)
    v_mfma_f32_16x16x32_bf16 v[44:47], a[48:51], v[68:71], v[44:47]
    ds_read_b128 v[84:87], v4 offset:12288
    v_mul_f32 v43, v43, v115
    v_mfma_f32_16x16x32_bf16 v[48:51], a[48:51], v[72:75], v[48:51]
    ds_read_b128 v[88:91], v4 offset:14336
    v_cvt_pk_bf16_f32 v40, v40, v41
    v_mfma_f32_16x16x32_bf16 v[56:59], a[52:55], v[72:75], v[56:59]
    ds_read_b128 v[92:95], v5 offset:12288
    v_cvt_pk_bf16_f32 v41, v42, v43
    v_mfma_f32_16x16x32_bf16 v[52:55], a[52:55], v[68:71], v[52:55]
    ds_read_b128 v[96:99], v5 offset:14336
    ds_write_b64 v8, v[40:41] offset:8192
    v_mfma_f32_16x16x32_bf16 v[60:63], a[56:59], v[68:71], v[60:63]
    v_mfma_f32_16x16x32_bf16 v[64:67], a[56:59], v[72:75], v[64:67]
    v_mfma_f32_16x16x32_bf16 v[44:47], a[60:63], v[76:79], v[44:47]
    s_waitcnt vmcnt(0)
    v_cmp_ne_u32 vcc, 0, v116
    s_cbranch_vccnz L_spin11
L_back12:
    v_mfma_f32_16x16x32_bf16 v[48:51], a[60:63], v[80:83], v[48:51]
    v_mfma_f32_16x16x32_bf16 v[56:59], a[64:67], v[80:83], v[56:59]
    s_waitcnt lgkmcnt(0)
    s_barrier
    v_mfma_f32_16x16x32_bf16 v[52:55], a[64:67], v[76:79], v[52:55]
    s_add_u32 m0, s43, 0
    ds_read_b128 v[20:23], v10 offset:0
    v_mfma_f32_16x16x32_bf16 v[60:63], a[68:71], v[76:79], v[60:63]
    buffer_load_dwordx4 v6, s[8:11], s41 offen offset:0 sc1 lds
    ds_read_b128 v[24:27], v9 offset:1024
    v_mfma_f32_16x16x32_bf16 v[64:67], a[68:71], v[80:83], v[64:67]
    ds_read_b128 v[28:31], v10 offset:1024
    s_waitcnt lgkmcnt(4)
    v_mfma_f32_16x16x32_bf16 v[44:47], a[72:75], v[84:87], v[44:47]
    ds_read_b128 v[68:71], v4 offset:16384
    ds_read_b64_tr_b16 v[32:33], v9 offset:2048
    v_mfma_f32_16x16x32_bf16 v[48:51], a[72:75], v[88:91], v[48:51]
    ds_read_b128 v[72:75], v4 offset:18432
    ds_read_b64_tr_b16 v[34:35], v10 offset:2048
    v_mfma_f32_16x16x32_bf16 v[56:59], a[76:79], v[88:91], v[56:59]
    ds_read_b128 v[76:79], v5 offset:16384
    ds_read_b64_tr_b16 v[36:37], v9 offset:2056
    v_mfma_f32_16x16x32_bf16 v[52:55], a[76:79], v[84:87], v[52:55]
    ds_read_b128 v[80:83], v5 offset:18432
    ds_read_b64_tr_b16 v[38:39], v10 offset:2056
    v_mfma_f32_16x16x32_bf16 v[60:63], a[80:83], v[84:87], v[60:63]
    s_add_u32 m0, s43, 3968
    v_mfma_f32_16x16x32_bf16 v[64:67], a[80:83], v[88:91], v[64:67]
    buffer_load_dwordx4 v6, s[8:11], s41 offen offset:128 sc1 lds
    v_mfma_f32_16x16x32_bf16 v[44:47], a[84:87], v[92:95], v[44:47]
    v_mfma_f32_16x16x32_bf16 v[48:51], a[84:87], v[96:99], v[48:51]
    s_waitcnt lgkmcnt(8)
    v_mfma_f32_16x16x32_bf16 v[40:43], v[24:27], v[20:23], 0
    v_mfma_f32_16x16x32_bf16 v[118:121], v[28:31], v[20:23], 0
    v_mfma_f32_16x16x32_bf16 v[56:59], a[88:91], v[96:99], v[56:59]
    v_mfma_f32_16x16x32_bf16 v[52:55], a[88:91], v[92:95], v[52:55]
    v_mfma_f32_16x16x32_bf16 v[60:63], a[92:95], v[92:95], v[60:63]
    v_cndmask_b32 v40, v40, v41, s[56:57]
    v_cndmask_b32 v42, v42, v43, s[56:57]
    v_mfma_f32_16x16x32_bf16 v[64:67], a[92:95], v[96:99], v[64:67]
    s_add_u32 m0, s43, 7936
    s_waitcnt lgkmcnt(1)
    v_mfma_f32_16x16x32_bf16 v[44:47], a[96:99], v[68:71], v[44:47]
    ds_read_b128 v[84:87], v4 offset:20480
    buffer_load_dwordx4 v6, s[8:11], s41 offen offset:256 sc1 lds
    v_mfma_f32_16x16x32_bf16 v[48:51], a[96:99], v[72:75], v[48:51]
    ds_read_b128 v[88:91], v4 offset:22528
    v_cndmask_b32 v118, v118, v119, s[56:57]
    v_mfma_f32_16x16x32_bf16 v[56:59], a[100:103], v[72:75], v[56:59]
    ds_read_b128 v[92:95], v5 offset:20480
    v_cndmask_b32 v120, v120, v121, s[56:57]
    v_mfma_f32_16x16x32_bf16 v[52:55], a[100:103], v[68:71], v[52:55]
    ds_read_b128 v[96:99], v5 offset:22528
    v_cndmask_b32 v40, v18, v40, s[62:63]
    v_mfma_f32_16x16x32_bf16 v[60:63], a[104:107], v[68:71], v[60:63]
    v_cndmask_b32 v42, v18, v42, s[62:63]
    v_cndmask_b32 v22, v40, v118, s[58:59]
    v_mfma_f32_16x16x32_bf16 v[64:67], a[104:107], v[72:75], v[64:67]
    v_cndmask_b32 v23, v42, v120, s[60:61]
    v_max_f32 v20, v22, v23
    v_mfma_f32_16x16x32_bf16 v[44:47], a[108:111], v[76:79], v[44:47]
    s_add_u32 m0, s43, 11904
    v_mov_b32 v21, v20
    v_mfma_f32_16x16x32_bf16 v[48:51], a[108:111], v[80:83], v[48:51]
    buffer_load_dwordx4 v6, s[8:11], s41 offen offset:384 sc1 lds
    v_permlane16_swap_b32 v20, v21
    v_mfma_f32_16x16x32_bf16 v[56:59], a[112:115], v[80:83], v[56:59]
    v_max_f32 v20, v20, v21
    v_mov_b32 v21, v20
    v_mfma_f32_16x16x32_bf16 v[52:55], a[112:115], v[76:79], v[52:55]
    v_permlane32_swap_b32 v20, v21
    v_max_f32 v20, v20, v21
    v_mfma_f32_16x16x32_bf16 v[60:63], a[116:119], v[76:79], v[60:63]
    v_mul_f32 v20, s86, v20
    v_fma_f32 v22, v22, s86, -v20
    v_mfma_f32_16x16x32_bf16 v[64:67], a[116:119], v[80:83], v[64:67]
    v_fma_f32 v23, v23, s86, -v20
    s_waitcnt lgkmcnt(0)
    v_mfma_f32_16x16x32_bf16 v[44:47], a[120:123], v[84:87], v[44:47]
    ds_read_b128 v[68:71], v4 offset:24576
    v_exp_f32 v22, v22
    v_mfma_f32_16x16x32_bf16 v[48:51], a[120:123], v[88:91], v[48:51]
    ds_read_b128 v[72:75], v4 offset:26624
    s_add_u32 m0, s43, 15872
    v_mfma_f32_16x16x32_bf16 v[56:59], a[124:127], v[88:91], v[56:59]
    ds_read_b128 v[76:79], v5 offset:24576
    buffer_load_dwordx4 v6, s[8:11], s41 offen offset:512 sc1 lds
    v_mfma_f32_16x16x32_bf16 v[52:55], a[124:127], v[84:87], v[52:55]
    ds_read_b128 v[80:83], v5 offset:26624
    v_exp_f32 v23, v23
    v_mfma_f32_16x16x32_bf16 v[60:63], a[128:131], v[84:87], v[60:63]
    v_add_f32 v20, v22, v23
    v_mov_b32 v21, v20
    v_mfma_f32_16x16x32_bf16 v[64:67], a[128:131], v[88:91], v[64:67]
    v_permlane16_swap_b32 v20, v21
    v_add_f32 v20, v20, v21
    v_mfma_f32_16x16x32_bf16 v[44:47], a[132:135], v[92:95], v[44:47]
    v_mov_b32 v21, v20
    v_mfma_f32_16x16x32_bf16 v[48:51], a[132:135], v[96:99], v[48:51]
    v_permlane32_swap_b32 v20, v21
    v_add_f32 v20, v20, v21
    v_mfma_f32_16x16x32_bf16 v[56:59], a[136:139], v[96:99], v[56:59]
    s_add_u32 m0, s43, 19840
    v_rcp_f32 v20, v20
    v_mfma_f32_16x16x32_bf16 v[52:55], a[136:139], v[92:95], v[52:55]
    buffer_load_dwordx4 v6, s[8:11], s41 offen offset:640 sc1 lds
    v_mul_f32 v22, v22, v20
    v_mfma_f32_16x16x32_bf16 v[60:63], a[140:143], v[92:95], v[60:63]
    v_mul_f32 v23, v23, v20
    v_cvt_pk_bf16_f32 v21, v22, v23
    v_mfma_f32_16x16x32_bf16 v[64:67], a[140:143], v[96:99], v[64:67]
    v_perm_b32 v24, v21, v21, v14
    s_waitcnt lgkmcnt(0)
    v_mfma_f32_16x16x32_bf16 v[44:47], a[144:147], v[68:71], v[44:47]
    ds_read_b128 v[84:87], v4 offset:28672
    v_perm_b32 v25, v21, v21, v15
    v_mfma_f32_16x16x32_bf16 v[48:51], a[144:147], v[72:75], v[48:51]
    ds_read_b128 v[88:91], v4 offset:30720
    v_perm_b32 v26, v21, v21, v16
    v_mfma_f32_16x16x32_bf16 v[56:59], a[148:151], v[72:75], v[56:59]
    ds_read_b128 v[92:95], v5 offset:28672
    v_perm_b32 v27, v21, v21, v17
    v_mfma_f32_16x16x32_bf16 v[52:55], a[148:151], v[68:71], v[52:55]
    ds_read_b128 v[96:99], v5 offset:30720
    s_add_u32 m0, s43, 23808
    v_mfma_f32_16x16x32_bf16 v[60:63], a[152:155], v[68:71], v[60:63]
    buffer_load_dwordx4 v6, s[8:11], s41 offen offset:768 sc1 lds
    v_mfma_f32_16x16x32_bf16 v[40:43], v[32:35], v[24:27], 0
    v_mfma_f32_16x16x32_bf16 v[118:121], v[36:39], v[24:27], 0
    v_mfma_f32_16x16x32_bf16 v[64:67], a[152:155], v[72:75], v[64:67]
    v_mfma_f32_16x16x32_bf16 v[44:47], a[156:159], v[76:79], v[44:47]
    v_mfma_f32_16x16x32_bf16 v[48:51], a[156:159], v[80:83], v[48:51]
    v_cvt_pk_bf16_f32 v28, v40, v41
    v_cvt_pk_bf16_f32 v29, v42, v43
    v_mfma_f32_16x16x32_bf16 v[56:59], a[160:163], v[80:83], v[56:59]
    v_cvt_pk_bf16_f32 v30, v118, v119
    v_cvt_pk_bf16_f32 v31, v120, v121
    v_mfma_f32_16x16x32_bf16 v[52:55], a[160:163], v[76:79], v[52:55]
    buffer_store_dwordx4 v[28:31], v1, s[16:19], s44 offen sc1
    s_cmp_eq_u32 s36, 16
    s_cselect_b64 s[98:99], -1, 0
    s_cselect_b32 s38, 97280, 0
    v_mfma_f32_16x16x32_bf16 v[60:63], a[164:167], v[76:79], v[60:63]
    s_add_u32 m0, s43, 27776
    v_cndmask_b32 v42, v13, v19, s[98:99]
    v_mfma_f32_16x16x32_bf16 v[64:67], a[164:167], v[80:83], v[64:67]
    buffer_load_dwordx4 v6, s[8:11], s41 offen offset:896 sc1 lds
    s_waitcnt lgkmcnt(0)
    v_mfma_f32_16x16x32_bf16 v[44:47], a[168:171], v[84:87], v[44:47]
    ds_read_b128 v[68:71], v4 offset:32768
    buffer_load_dwordx2 v[32:33], v42, s[16:19], s46 offen offset:0 sc1
    v_mfma_f32_16x16x32_bf16 v[48:51], a[168:171], v[88:91], v[48:51]
    ds_read_b128 v[72:75], v4 offset:34816
    buffer_load_dwordx2 v[34:35], v42, s[16:19], s46 offen offset:128 sc1
    v_mfma_f32_16x16x32_bf16 v[56:59], a[172:175], v[88:91], v[56:59]
    ds_read_b128 v[76:79], v5 offset:32768
    buffer_load_dwordx2 v[36:37], v42, s[16:19], s46 offen offset:256 sc1
    v_mfma_f32_16x16x32_bf16 v[52:55], a[172:175], v[84:87], v[52:55]
    ds_read_b128 v[80:83], v5 offset:34816
    buffer_load_dwordx2 v[38:39], v42, s[16:19], s46 offen offset:384 sc1
    v_mfma_f32_16x16x32_bf16 v[60:63], a[176:179], v[84:87], v[60:63]
    s_cmp_eq_u32 s36, 17
    s_cselect_b32 s49, s87, 0x10000
    v_mfma_f32_16x16x32_bf16 v[64:67], a[176:179], v[88:91], v[64:67]
    s_add_u32 m0, s43, 31744
    s_add_u32 s90, s90, s49
    v_mfma_f32_16x16x32_bf16 v[44:47], a[180:183], v[92:95], v[44:47]
    buffer_load_dwordx4 v6, s[8:11], s41 offen offset:1024 sc1 lds
    s_bitcmp1_b64 s[24:25], s36
    s_cselect_b32 s44, s90, 0x8000000
    v_mfma_f32_16x16x32_bf16 v[48:51], a[180:183], v[96:99], v[48:51]
    s_bitcmp1_b64 s[26:27], s36
    s_cselect_b64 s[62:63], 0, -1
    v_mfma_f32_16x16x32_bf16 v[56:59], a[184:187], v[96:99], v[56:59]
    v_mfma_f32_16x16x32_bf16 v[52:55], a[184:187], v[92:95], v[52:55]
    v_mfma_f32_16x16x32_bf16 v[60:63], a[188:191], v[92:95], v[60:63]
    v_mfma_f32_16x16x32_bf16 v[64:67], a[188:191], v[96:99], v[64:67]
    s_waitcnt lgkmcnt(0)
    v_mfma_f32_16x16x32_bf16 v[44:47], a[192:195], v[68:71], v[44:47]
    ds_read_b128 v[84:87], v4 offset:36864
    s_add_u32 m0, s43, 35712
    v_mfma_f32_16x16x32_bf16 v[48:51], a[192:195], v[72:75], v[48:51]
    ds_read_b128 v[88:91], v4 offset:38912
    buffer_load_dwordx4 v6, s[8:11], s41 offen offset:1152 sc1 lds
    v_mfma_f32_16x16x32_bf16 v[56:59], a[196:199], v[72:75], v[56:59]
    ds_read_b128 v[92:95], v5 offset:36864
    v_mfma_f32_16x16x32_bf16 v[52:55], a[196:199], v[68:71], v[52:55]
    ds_read_b128 v[96:99], v5 offset:38912
    v_mfma_f32_16x16x32_bf16 v[60:63], a[200:203], v[68:71], v[60:63]
    v_mfma_f32_16x16x32_bf16 v[64:67], a[200:203], v[72:75], v[64:67]
    v_mfma_f32_16x16x32_bf16 v[44:47], a[204:207], v[76:79], v[44:47]
    v_mfma_f32_16x16x32_bf16 v[48:51], a[204:207], v[80:83], v[48:51]
    s_add_u32 m0, s43, 39680
    v_mfma_f32_16x16x32_bf16 v[56:59], a[208:211], v[80:83], v[56:59]
    buffer_load_dwordx4 v6, s[8:11], s41 offen offset:1280 sc1 lds
    v_mfma_f32_16x16x32_bf16 v[52:55], a[208:211], v[76:79], v[52:55]
    v_mfma_f32_16x16x32_bf16 v[60:63], a[212:215], v[76:79], v[60:63]
    v_mfma_f32_16x16x32_bf16 v[64:67], a[212:215], v[80:83], v[64:67]
    s_waitcnt lgkmcnt(0)
    v_mfma_f32_16x16x32_bf16 v[44:47], a[216:219], v[84:87], v[44:47]
    ds_read_b128 v[68:71], v4 offset:40960
    v_mfma_f32_16x16x32_bf16 v[48:51], a[216:219], v[88:91], v[48:51]
    ds_read_b128 v[72:75], v4 offset:43008
    v_mfma_f32_16x16x32_bf16 v[56:59], a[220:223], v[88:91], v[56:59]
    ds_read_b128 v[76:79], v5 offset:40960
    s_add_u32 m0, s43, 43648
    v_mfma_f32_16x16x32_bf16 v[52:55], a[220:223], v[84:87], v[52:55]
    ds_read_b128 v[80:83], v5 offset:43008
    buffer_load_dwordx4 v6, s[8:11], s41 offen offset:1408 sc1 lds
    v_mfma_f32_16x16x32_bf16 v[60:63], a[224:227], v[84:87], v[60:63]
    v_mfma_f32_16x16x32_bf16 v[64:67], a[224:227], v[88:91], v[64:67]
    v_mfma_f32_16x16x32_bf16 v[44:47], a[228:231], v[92:95], v[44:47]
    v_mfma_f32_16x16x32_bf16 v[48:51], a[228:231], v[96:99], v[48:51]
    v_mfma_f32_16x16x32_bf16 v[56:59], a[232:235], v[96:99], v[56:59]
    v_mfma_f32_16x16x32_bf16 v[52:55], a[232:235], v[92:95], v[52:55]
    s_add_u32 m0, s43, 47616
    v_mfma_f32_16x16x32_bf16 v[60:63], a[236:239], v[92:95], v[60:63]
    buffer_load_dwordx4 v6, s[8:11], s41 offen offset:1536 sc1 lds
    v_mfma_f32_16x16x32_bf16 v[64:67], a[236:239], v[96:99], v[64:67]
    s_waitcnt lgkmcnt(0)
    v_mfma_f32_16x16x32_bf16 v[44:47], a[240:243], v[68:71], v[44:47]
    ds_read_b128 v[84:87], v4 offset:45056
    v_mfma_f32_16x16x32_bf16 v[48:51], a[240:243], v[72:75], v[48:51]
    ds_read_b128 v[88:91], v4 offset:47104
    v_mfma_f32_16x16x32_bf16 v[56:59], a[244:247], v[72:75], v[56:59]
    ds_read_b128 v[92:95], v5 offset:45056
    v_mfma_f32_16x16x32_bf16 v[52:55], a[244:247], v[68:71], v[52:55]
    ds_read_b128 v[96:99], v5 offset:47104
    v_mfma_f32_16x16x32_bf16 v[60:63], a[248:251], v[68:71], v[60:63]
    s_add_u32 m0, s43, 51584
    v_mfma_f32_16x16x32_bf16 v[64:67], a[248:251], v[72:75], v[64:67]
    buffer_load_dwordx4 v6, s[8:11], s41 offen offset:1664 sc1 lds
    v_mfma_f32_16x16x32_bf16 v[44:47], a[252:255], v[76:79], v[44:47]
    v_mfma_f32_16x16x32_bf16 v[48:51], a[252:255], v[80:83], v[48:51]
    v_mfma_f32_16x16x32_bf16 v[56:59], v[128:131], v[80:83], v[56:59]
    v_mfma_f32_16x16x32_bf16 v[52:55], v[128:131], v[76:79], v[52:55]
    v_mfma_f32_16x16x32_bf16 v[60:63], v[132:135], v[76:79], v[60:63]
    v_mfma_f32_16x16x32_bf16 v[64:67], v[132:135], v[80:83], v[64:67]
    s_add_u32 m0, s43, 55552
    s_waitcnt lgkmcnt(0)
    v_mfma_f32_16x16x32_bf16 v[44:47], v[136:139], v[84:87], v[44:47]
    ds_read_b128 v[68:71], v4 offset:49152
    buffer_load_dwordx4 v6, s[8:11], s41 offen offset:1792 sc1 lds
    v_mfma_f32_16x16x32_bf16 v[48:51], v[136:139], v[88:91], v[48:51]
    ds_read_b128 v[72:75], v4 offset:51200
    v_mfma_f32_16x16x32_bf16 v[56:59], v[140:143], v[88:91], v[56:59]
    ds_read_b128 v[76:79], v5 offset:49152
    v_mfma_f32_16x16x32_bf16 v[52:55], v[140:143], v[84:87], v[52:55]
    ds_read_b128 v[80:83], v5 offset:51200
    v_mfma_f32_16x16x32_bf16 v[60:63], v[144:147], v[84:87], v[60:63]
    v_mfma_f32_16x16x32_bf16 v[64:67], v[144:147], v[88:91], v[64:67]
    v_mfma_f32_16x16x32_bf16 v[44:47], v[148:151], v[92:95], v[44:47]
    s_add_u32 m0, s43, 59520
    v_mfma_f32_16x16x32_bf16 v[48:51], v[148:151], v[96:99], v[48:51]
    buffer_load_dwordx4 v6, s[8:11], s41 offen offset:1920 sc1 lds
    v_mfma_f32_16x16x32_bf16 v[56:59], v[152:155], v[96:99], v[56:59]
    v_mfma_f32_16x16x32_bf16 v[52:55], v[152:155], v[92:95], v[52:55]
    v_mfma_f32_16x16x32_bf16 v[60:63], v[156:159], v[92:95], v[60:63]
    s_waitcnt vmcnt(8)
    s_barrier
    v_mfma_f32_16x16x32_bf16 v[64:67], v[156:159], v[96:99], v[64:67]
    buffer_store_dword v124, v124, s[16:19], s91 offen sc1
    s_waitcnt lgkmcnt(0)
    v_mfma_f32_16x16x32_bf16 v[44:47], v[160:163], v[68:71], v[44:47]
    ds_read_b128 v[84:87], v4 offset:53248
    s_add_u32 s91, s91, 131072
    v_mfma_f32_16x16x32_bf16 v[48:51], v[160:163], v[72:75], v[48:51]
    ds_read_b128 v[88:91], v4 offset:55296
    v_med3_i32 v117, s45, 0, v12
    v_mfma_f32_16x16x32_bf16 v[56:59], v[164:167], v[72:75], v[56:59]
    ds_read_b128 v[92:95], v5 offset:53248
    v_add_u32 v117, v117, v11
    v_mfma_f32_16x16x32_bf16 v[52:55], v[164:167], v[68:71], v[52:55]
    ds_read_b128 v[96:99], v5 offset:55296
    s_add_u32 s45, s45, 131072
    v_mfma_f32_16x16x32_bf16 v[60:63], v[168:171], v[68:71], v[60:63]
    buffer_load_dword v116, v117, s[16:19], 0 offen sc1
    v_max3_u32 v40, v32, v33, v34
    v_mfma_f32_16x16x32_bf16 v[64:67], v[168:171], v[72:75], v[64:67]
    v_max3_u32 v41, v35, v36, v37
    v_max3_u32 v40, v40, v38, v39
    v_mfma_f32_16x16x32_bf16 v[44:47], v[172:175], v[76:79], v[44:47]
    v_max_u32 v40, v40, v41
    v_cmp_eq_u32 vcc, -1, v40
    s_cbranch_vccnz L_sspin9
L_sback10:
    v_mfma_f32_16x16x32_bf16 v[48:51], v[172:175], v[80:83], v[48:51]
    v_add_f32 v40, v36, v38
    v_add_f32 v41, v37, v39
    v_mfma_f32_16x16x32_bf16 v[56:59], v[176:179], v[80:83], v[56:59]
    v_add_f32 v32, v32, v34
    v_add_f32 v33, v33, v35
    v_mfma_f32_16x16x32_bf16 v[52:55], v[176:179], v[76:79], v[52:55]
    v_add_f32 v32, v32, v40
    v_add_f32 v33, v33, v41
    v_mfma_f32_16x16x32_bf16 v[60:63], v[180:183], v[76:79], v[60:63]
    v_mov_b32 v40, v32
    v_mov_b32 v41, v33
    v_mfma_f32_16x16x32_bf16 v[64:67], v[180:183], v[80:83], v[64:67]
    v_permlane32_swap_b32 v32, v40
    s_waitcnt lgkmcnt(0)
    v_mfma_f32_16x16x32_bf16 v[44:47], v[184:187], v[84:87], v[44:47]
    ds_read_b128 v[68:71], v4 offset:57344
    v_permlane32_swap_b32 v33, v41
    v_mfma_f32_16x16x32_bf16 v[48:51], v[184:187], v[88:91], v[48:51]
    ds_read_b128 v[72:75], v4 offset:59392
    v_add_f32 v32, v32, v40
    v_mfma_f32_16x16x32_bf16 v[56:59], v[188:191], v[88:91], v[56:59]
    ds_read_b128 v[76:79], v5 offset:57344
    v_add_f32 v33, v33, v41
    v_mfma_f32_16x16x32_bf16 v[52:55], v[188:191], v[84:87], v[52:55]
    ds_read_b128 v[80:83], v5 offset:59392
    v_mul_f32 v112, 0xba800000, v32
    v_mfma_f32_16x16x32_bf16 v[60:63], v[192:195], v[84:87], v[60:63]
    v_mul_f32 v33, 0x3a800000, v33
    v_fma_f32 v33, -v112, v112, v33
    v_mfma_f32_16x16x32_bf16 v[64:67], v[192:195], v[88:91], v[64:67]
    v_mov_b32 v113, v112
    v_max_f32 v33, 0, v33
    v_mfma_f32_16x16x32_bf16 v[44:47], v[196:199], v[92:95], v[44:47]
    v_add_f32 v33, 0x3727c5ac, v33
    v_rsq_f32 v114, v33
    v_mfma_f32_16x16x32_bf16 v[48:51], v[196:199], v[96:99], v[48:51]
    v_permlane16_swap_b32 v112, v113
    v_mov_b32 v115, v114
    v_mfma_f32_16x16x32_bf16 v[56:59], v[200:203], v[96:99], v[56:59]
    v_permlane16_swap_b32 v114, v115
    s_add_u32 s46, s46, 2048
    v_mfma_f32_16x16x32_bf16 v[52:55], v[200:203], v[92:95], v[52:55]
    s_add_u32 s46, s46, s38
    v_fmac_f32 v44, v112, v100
    v_mfma_f32_16x16x32_bf16 v[60:63], v[204:207], v[92:95], v[60:63]
    v_fmac_f32 v45, v112, v101
    v_fmac_f32 v46, v112, v102
    v_mfma_f32_16x16x32_bf16 v[64:67], v[204:207], v[96:99], v[64:67]
    v_fmac_f32 v48, v113, v100
    s_waitcnt lgkmcnt(0)
    v_mfma_f32_16x16x32_bf16 v[44:47], v[208:211], v[68:71], v[44:47]
    ds_read_b128 v[84:87], v4 offset:61440
    v_fmac_f32 v52, v112, v104
    v_mfma_f32_16x16x32_bf16 v[48:51], v[208:211], v[72:75], v[48:51]
    ds_read_b128 v[88:91], v4 offset:63488
    v_fmac_f32 v53, v112, v105
    v_mfma_f32_16x16x32_bf16 v[56:59], v[212:215], v[72:75], v[56:59]
    ds_read_b128 v[92:95], v5 offset:61440
    v_fmac_f32 v47, v112, v103
    v_mfma_f32_16x16x32_bf16 v[52:55], v[212:215], v[68:71], v[52:55]
    ds_read_b128 v[96:99], v5 offset:63488
    v_fmac_f32 v49, v113, v101
    v_mfma_f32_16x16x32_bf16 v[60:63], v[216:219], v[68:71], v[60:63]
    v_fmac_f32 v50, v113, v102
    v_fmac_f32 v51, v113, v103
    v_mfma_f32_16x16x32_bf16 v[64:67], v[216:219], v[72:75], v[64:67]
    v_fmac_f32 v54, v112, v106
    v_fmac_f32 v55, v112, v107
    v_mfma_f32_16x16x32_bf16 v[44:47], v[220:223], v[76:79], v[44:47]
    v_fmac_f32 v56, v113, v104
    v_fmac_f32 v57, v113, v105
    v_mfma_f32_16x16x32_bf16 v[48:51], v[220:223], v[80:83], v[48:51]
    v_fmac_f32 v60, v112, v108
    v_fmac_f32 v61, v112, v109
    v_mfma_f32_16x16x32_bf16 v[56:59], v[224:227], v[80:83], v[56:59]
    v_fmac_f32 v62, v112, v110
    v_fmac_f32 v63, v112, v111
    v_mfma_f32_16x16x32_bf16 v[52:55], v[224:227], v[76:79], v[52:55]
    v_fmac_f32 v64, v113, v108
    v_fmac_f32 v65, v113, v109
    v_mfma_f32_16x16x32_bf16 v[60:63], v[228:231], v[76:79], v[60:63]
    v_fmac_f32 v58, v113, v106
    v_fmac_f32 v59, v113, v107
    v_mfma_f32_16x16x32_bf16 v[64:67], v[228:231], v[80:83], v[64:67]
    s_cmp_eq_u32 s36, s97
    s_cselect_b32 s47, 31, -2
    s_cselect_b64 s[8:9], s[88:89], s[8:9]
    s_waitcnt lgkmcnt(0)
    v_mfma_f32_16x16x32_bf16 v[44:47], v[232:235], v[84:87], v[44:47]
    ds_read_b128 v[68:71], v2 offset:0
    s_add_u32 s50, s50, s47
    v_mfma_f32_16x16x32_bf16 v[48:51], v[232:235], v[88:91], v[48:51]
    ds_read_b128 v[72:75], v2 offset:2048
    v_fmac_f32 v66, v113, v110
    v_mfma_f32_16x16x32_bf16 v[56:59], v[236:239], v[88:91], v[56:59]
    ds_read_b128 v[76:79], v3 offset:0
    v_fmac_f32 v67, v113, v111
    v_mfma_f32_16x16x32_bf16 v[52:55], v[236:239], v[84:87], v[52:55]
    ds_read_b128 v[80:83], v3 offset:2048
    s_max_i32 s47, s50, 0
    v_mfma_f32_16x16x32_bf16 v[60:63], v[240:243], v[84:87], v[60:63]
    s_lshl_b32 s41, s47, 15
    v_mfma_f32_16x16x32_bf16 v[64:67], v[240:243], v[88:91], v[64:67]
    v_mfma_f32_16x16x32_bf16 v[44:47], v[244:247], v[92:95], v[44:47]
    v_mfma_f32_16x16x32_bf16 v[48:51], v[244:247], v[96:99], v[48:51]
    v_mfma_f32_16x16x32_bf16 v[56:59], v[248:251], v[96:99], v[56:59]
    v_mfma_f32_16x16x32_bf16 v[52:55], v[248:251], v[92:95], v[52:55]
    v_mfma_f32_16x16x32_bf16 v[60:63], v[252:255], v[92:95], v[60:63]
    v_mfma_f32_16x16x32_bf16 v[64:67], v[252:255], v[96:99], v[64:67]
    s_add_u32 s36, s36, 1
    s_cmp_lt_u32 s36, 33
    s_cbranch_scc1 L_q_b0
    s_nop 7
    v_mul_f32 v44, v44, v114
    v_mul_f32 v45, v45, v114
    v_mul_f32 v46, v46, v114
    v_mul_f32 v47, v47, v114
    v_cvt_pk_bf16_f32 v44, v44, v45
    v_cvt_pk_bf16_f32 v45, v46, v47
    ds_write_b64 v7, v[44:45] offset:12288
    v_mul_f32 v48, v48, v115
    v_mul_f32 v49, v49, v115
    v_mul_f32 v50, v50, v115
    v_mul_f32 v51, v51, v115
    v_cvt_pk_bf16_f32 v48, v48, v49
    v_cvt_pk_bf16_f32 v49, v50, v51
    ds_write_b64 v7, v[48:49] offset:18432
    v_mul_f32 v52, v52, v114
    v_mul_f32 v53, v53, v114
    v_mul_f32 v54, v54, v114
    v_mul_f32 v55, v55, v114
    v_cvt_pk_bf16_f32 v52, v52, v53
    v_cvt_pk_bf16_f32 v53, v54, v55
    ds_write_b64 v7, v[52:53] offset:13312
    v_mul_f32 v56, v56, v115
    v_mul_f32 v57, v57, v115
    v_mul_f32 v58, v58, v115
    v_mul_f32 v59, v59, v115
    v_cvt_pk_bf16_f32 v56, v56, v57
    v_cvt_pk_bf16_f32 v57, v58, v59
    ds_write_b64 v7, v[56:57] offset:19456
    v_mul_f32 v60, v60, v114
    v_mul_f32 v61, v61, v114
    v_mul_f32 v62, v62, v114
    v_mul_f32 v63, v63, v114
    v_cvt_pk_bf16_f32 v60, v60, v61
    v_cvt_pk_bf16_f32 v61, v62, v63
    ds_write_b64 v8, v[60:61] offset:14336
    v_mul_f32 v64, v64, v115
    v_mul_f32 v65, v65, v115
    v_mul_f32 v66, v66, v115
    v_mul_f32 v67, v67, v115
    v_cvt_pk_bf16_f32 v64, v64, v65
    v_cvt_pk_bf16_f32 v65, v66, v67
    ds_write_b64 v8, v[64:65] offset:20480
    s_waitcnt lgkmcnt(0)
    s_barrier
    ds_read_b128 v[44:47], v9 offset:6144
    ds_read_b128 v[48:51], v9 offset:13312
    ds_read_b128 v[52:55], v9 offset:7168
    ds_read_b64_tr_b16 v[56:57], v9 offset:14336
    ds_read_b64_tr_b16 v[58:59], v9 offset:8192
    ds_read_b64_tr_b16 v[60:61], v9 offset:14344
    ds_read_b64_tr_b16 v[62:63], v9 offset:8200
    s_waitcnt lgkmcnt(4)
    v_mfma_f32_16x16x32_bf16 v[64:67], v[48:51], v[44:47], 0
    v_mfma_f32_16x16x32_bf16 v[118:121], v[52:55], v[44:47], 0
    s_nop 5
    v_cndmask_b32 v64, v64, v65, s[56:57]
    v_cndmask_b32 v66, v66, v67, s[56:57]
    v_cndmask_b32 v118, v118, v119, s[56:57]
    v_cndmask_b32 v120, v120, v121, s[56:57]
    v_cndmask_b32 v64, v18, v64, s[62:63]
    v_cndmask_b32 v66, v18, v66, s[62:63]
    v_cndmask_b32 v46, v64, v118, s[58:59]
    v_cndmask_b32 v47, v66, v120, s[60:61]
    v_max_f32 v44, v46, v47
    v_mov_b32 v45, v44
    s_nop 1
    v_permlane16_swap_b32 v44, v45
    v_max_f32 v44, v44, v45
    v_mov_b32 v45, v44
    s_nop 1
    v_permlane32_swap_b32 v44, v45
    v_max_f32 v44, v44, v45
    v_mul_f32 v44, s86, v44
    v_fma_f32 v46, v46, s86, -v44
    v_fma_f32 v47, v47, s86, -v44
    v_exp_f32 v46, v46
    v_exp_f32 v47, v47
    s_nop 0
    v_add_f32 v44, v46, v47
    v_mov_b32 v45, v44
    s_nop 1
    v_permlane16_swap_b32 v44, v45
    v_add_f32 v44, v44, v45
    v_mov_b32 v45, v44
    s_nop 1
    v_permlane32_swap_b32 v44, v45
    v_add_f32 v44, v44, v45
    v_rcp_f32 v44, v44
    s_nop 0
    v_mul_f32 v46, v46, v44
    v_mul_f32 v47, v47, v44
    v_cvt_pk_bf16_f32 v45, v46, v47
    v_perm_b32 v48, v45, v45, v14
    v_perm_b32 v49, v45, v45, v15
    v_perm_b32 v50, v45, v45, v16
    v_perm_b32 v51, v45, v45, v17
    s_waitcnt lgkmcnt(0)
    s_nop 0
    v_mfma_f32_16x16x32_bf16 v[64:67], v[56:59], v[48:51], 0
    v_mfma_f32_16x16x32_bf16 v[118:121], v[60:63], v[48:51], 0
    s_nop 5
    v_cvt_pk_bf16_f32 v52, v64, v65
    v_cvt_pk_bf16_f32 v53, v66, v67
    v_cvt_pk_bf16_f32 v54, v118, v119
    v_cvt_pk_bf16_f32 v55, v120, v121
    buffer_store_dwordx4 v[52:55], v1, s[16:19], s44 offen sc1
    s_waitcnt vmcnt(0)
    s_barrier
    buffer_store_dword v124, v124, s[16:19], s91 offen sc1
    s_add_u32 s91, s91, 131072
    s_waitcnt vmcnt(0)
    s_endpgm
L_spin3:
    s_mov_b32 s40, 0x20000
L_spin3_l:
    buffer_load_dword v21, v20, s[20:23], 0 offen sc1
    s_sub_u32 s40, s40, 1
    s_waitcnt vmcnt(0)
    v_cmp_gt_u32 vcc, 16, v21
    s_cbranch_scc1 L_back4
    s_cbranch_vccz L_back4
    s_sleep 2
    s_branch L_spin3_l
L_sspin5:
    s_mov_b32 s40, 0x20000
L_sspin5_l:
    s_sleep 1
    buffer_load_dwordx2 v[56:57], v66, s[16:19], s46 offen offset:0 sc1
    buffer_load_dwordx2 v[58:59], v66, s[16:19], s46 offen offset:128 sc1
    buffer_load_dwordx2 v[60:61], v66, s[16:19], s46 offen offset:256 sc1
    buffer_load_dwordx2 v[62:63], v66, s[16:19], s46 offen offset:384 sc1
    s_sub_u32 s40, s40, 1
    s_waitcnt vmcnt(0)
    v_max3_u32 v64, v56, v57, v58
    v_max3_u32 v65, v59, v60, v61
    v_max3_u32 v64, v64, v62, v63
    v_max_u32 v64, v64, v65
    v_cmp_eq_u32 vcc, -1, v64
    s_cbranch_scc1 L_sback6
    s_cbranch_vccnz L_sspin5_l
    s_branch L_sback6
L_spin7:
    s_mov_b32 s40, 0x20000
L_spin7_l:
    buffer_load_dword v116, v117, s[16:19], 0 offen sc1
    s_sub_u32 s40, s40, 1
    s_waitcnt vmcnt(0)
    v_cmp_ne_u32 vcc, 0, v116
    s_cbranch_scc1 L_back8
    s_cbranch_vccz L_back8
    s_sleep 2
    s_branch L_spin7_l
L_sspin9:
    s_mov_b32 s40, 0x20000
L_sspin9_l:
    s_sleep 1
    buffer_load_dwordx2 v[32:33], v42, s[16:19], s46 offen offset:0 sc1
    buffer_load_dwordx2 v[34:35], v42, s[16:19], s46 offen offset:128 sc1
    buffer_load_dwordx2 v[36:37], v42, s[16:19], s46 offen offset:256 sc1
    buffer_load_dwordx2 v[38:39], v42, s[16:19], s46 offen offset:384 sc1
    s_sub_u32 s40, s40, 1
    s_waitcnt vmcnt(0)
    v_max3_u32 v40, v32, v33, v34
    v_max3_u32 v41, v35, v36, v37
    v_max3_u32 v40, v40, v38, v39
    v_max_u32 v40, v40, v41
    v_cmp_eq_u32 vcc, -1, v40
    s_cbranch_scc1 L_sback10
    s_cbranch_vccnz L_sspin9_l
    s_branch L_sback10
L_spin11:
    s_mov_b32 s40, 0x20000
L_spin11_l:
    buffer_load_dword v116, v117, s[16:19], 0 offen sc1
    s_sub_u32 s40, s40, 1
    s_waitcnt vmcnt(0)
    v_cmp_ne_u32 vcc, 0, v116
    s_cbranch_scc1 L_back12
    s_cbranch_vccz L_back12
    s_sleep 2
    s_branch L_spin11_l
L_role_16:
    s_sub_u32 s35, s34, 16
    s_add_u32 s54, s54, L_role_16-interleave_layers__sliding_local_dilated__dense_activation_squared_relu__prompt_kernel
    buffer_load_dword v252, v7, s[8:11], s54 offen
    s_lshl_b32 s54, s35, 8
    s_mov_b32 s12, s68
    s_mov_b32 s13, s69
    s_mov_b32 s14, 0x200000
    s_mov_b32 s15, 0x00020000
    v_lshrrev_b32 v52, 3, v0
    v_and_b32 v53, 2, v52
    v_lshlrev_b32 v53, 1, v53
    v_and_b32 v54, 7, v0
    v_xor_b32 v53, v53, v54
    v_mul_u32_u24 v52, 2048, v52
    v_lshl_add_u32 v52, v53, 4, v52
    s_mul_i32 s38, s32, 4
    s_add_u32 s39, s38, 0
    s_and_b32 s37, s39, 7
    s_mul_i32 s37, s37, 16384
    s_lshr_b32 s39, s39, 3
    s_mul_i32 s39, s39, 128
    s_add_u32 s39, s39, s37
    v_add_u32 v44, s39, v52
    s_add_u32 s39, s38, 1
    s_and_b32 s37, s39, 7
    s_mul_i32 s37, s37, 16384
    s_lshr_b32 s39, s39, 3
    s_mul_i32 s39, s39, 128
    s_add_u32 s39, s39, s37
    v_add_u32 v45, s39, v52
    s_add_u32 s39, s38, 2
    s_and_b32 s37, s39, 7
    s_mul_i32 s37, s37, 16384
    s_lshr_b32 s39, s39, 3
    s_mul_i32 s39, s39, 128
    s_add_u32 s39, s39, s37
    v_add_u32 v46, s39, v52
    s_add_u32 s39, s38, 3
    s_and_b32 s37, s39, 7
    s_mul_i32 s37, s37, 16384
    s_lshr_b32 s39, s39, 3
    s_mul_i32 s39, s39, 128
    s_add_u32 s39, s39, s37
    v_add_u32 v47, s39, v52
    s_mul_i32 s42, s32, 4096
    s_add_u32 m0, s42, 0
    s_nop 0
    buffer_load_dwordx4 v44, s[12:15], s54 offen lds
    s_add_u32 m0, s42, 1024
    s_nop 0
    buffer_load_dwordx4 v45, s[12:15], s54 offen lds
    s_add_u32 m0, s42, 2048
    s_nop 0
    buffer_load_dwordx4 v46, s[12:15], s54 offen lds
    s_add_u32 m0, s42, 3072
    s_nop 0
    buffer_load_dwordx4 v47, s[12:15], s54 offen lds
    s_add_u32 s54, s54, 131072
    s_add_u32 m0, s42, 16384
    s_nop 0
    buffer_load_dwordx4 v44, s[12:15], s54 offen lds
    s_add_u32 m0, s42, 17408
    s_nop 0
    buffer_load_dwordx4 v45, s[12:15], s54 offen lds
    s_add_u32 m0, s42, 18432
    s_nop 0
    buffer_load_dwordx4 v46, s[12:15], s54 offen lds
    s_add_u32 m0, s42, 19456
    s_nop 0
    buffer_load_dwordx4 v47, s[12:15], s54 offen lds
    s_add_u32 s54, s54, 131072
    s_add_u32 m0, s42, 32768
    s_nop 0
    buffer_load_dwordx4 v44, s[12:15], s54 offen lds
    s_add_u32 m0, s42, 33792
    s_nop 0
    buffer_load_dwordx4 v45, s[12:15], s54 offen lds
    s_add_u32 m0, s42, 34816
    s_nop 0
    buffer_load_dwordx4 v46, s[12:15], s54 offen lds
    s_add_u32 m0, s42, 35840
    s_nop 0
    buffer_load_dwordx4 v47, s[12:15], s54 offen lds
    s_add_u32 s54, s54, 131072
    s_add_u32 m0, s42, 49152
    s_nop 0
    buffer_load_dwordx4 v44, s[12:15], s54 offen lds
    s_add_u32 m0, s42, 50176
    s_nop 0
    buffer_load_dwordx4 v45, s[12:15], s54 offen lds
    s_add_u32 m0, s42, 51200
    s_nop 0
    buffer_load_dwordx4 v46, s[12:15], s54 offen lds
    s_add_u32 m0, s42, 52224
    s_nop 0
    buffer_load_dwordx4 v47, s[12:15], s54 offen lds
    s_add_u32 s54, s54, 131072
    s_add_u32 m0, s42, 65536
    s_nop 0
    buffer_load_dwordx4 v44, s[12:15], s54 offen lds
    s_add_u32 m0, s42, 66560
    s_nop 0
    buffer_load_dwordx4 v45, s[12:15], s54 offen lds
    s_add_u32 m0, s42, 67584
    s_nop 0
    buffer_load_dwordx4 v46, s[12:15], s54 offen lds
    s_add_u32 m0, s42, 68608
    s_nop 0
    buffer_load_dwordx4 v47, s[12:15], s54 offen lds
    s_add_u32 s54, s54, 131072
    v_lshrrev_b32 v52, 4, v0
    v_bfe_u32 v53, v0, 2, 2
    v_lshl_add_u32 v52, v52, 3, v53
    v_lshlrev_b32 v52, 7, v52
    v_lshrrev_b32 v53, 1, v53
    v_lshl_add_u32 v52, v53, 6, v52
    v_and_b32 v53, 3, v0
    v_lshl_add_u32 v52, v53, 4, v52
    s_lshr_b32 s37, s32, 1
    s_lshl_b32 s37, s37, 13
    s_and_b32 s38, s32, 1
    s_lshl_b32 s38, s38, 6
    s_add_u32 s37, s37, s38
    s_add_u32 s37, s37, 0
    v_xor_b32 v48, s37, v52
    s_lshr_b32 s37, s32, 1
    s_lshl_b32 s37, s37, 13
    s_and_b32 s38, s32, 1
    s_lshl_b32 s38, s38, 6
    s_add_u32 s37, s37, s38
    s_add_u32 s37, s37, 8
    v_xor_b32 v49, s37, v52
    v_add_u32 v2, 98304, v1
    v_mov_b32 v108, 0
    v_mov_b32 v109, 0
    v_mov_b32 v110, 0
    v_mov_b32 v111, 0
    v_mov_b32 v112, 0
    v_mov_b32 v113, 0
    v_mov_b32 v114, 0
    v_mov_b32 v115, 0
    v_mov_b32 v13, 0x3f80
    v_and_b32 v12, 1, v0
    v_lshlrev_b32 v12, 4, v12
    v_lshlrev_b32 v12, v12, v13
    s_mov_b32 exec_lo, 0x300003
    s_mov_b32 exec_hi, 0x30000300
    v_mov_b32 v108, v12
    v_mov_b32 v114, v12
    s_mov_b32 exec_lo, 0xc0000c
    s_mov_b32 exec_hi, 0xc0000c00
    v_mov_b32 v109, v12
    v_mov_b32 v115, v12
    s_mov_b64 exec, -1
    s_lshl_b32 s37, s33, 6
    s_add_u32 s37, s37, 0
    s_lshl_b32 s37, s37, 8
    v_lshl_add_u32 v4, v0, 8, s37
    s_cmp_eq_u32 s32, 0
    s_cselect_b32 s37, 16, 0
    v_cmp_le_u32 vcc, s37, v0
    s_nop 1
    v_cndmask_b32 v4, v4, 2.0, vcc
    s_mov_b32 s86, 0x3f803f80
    s_lshl_b32 s43, s32, 12
    s_mul_i32 s41, s33, 2097152
    s_add_u32 s41, s41, 0x0
    s_add_u32 s41, s41, s43
    s_lshl_b32 s38, s35, 2
    s_add_u32 s38, s38, s32
    s_mul_i32 s90, s33, 2097152
    s_add_u32 s90, s90, 0x7f0000
    s_lshl_b32 s37, s38, 11
    s_add_u32 s90, s90, s37
    v_and_b32 v12, 15, v0
    v_and_b32 v13, 0x30, v0
    v_lshl_add_u32 v3, v12, 11, v13
    s_lshl_b32 s37, s38, 6
    v_add_u32 v3, s37, v3
    s_lshl_b32 s50, s33, 20
    s_add_u32 s50, s50, 983040
    s_add_u32 s88, s84, 0x5000000
    s_addc_u32 s89, s85, 0
    s_mov_b32 s8, s64
    s_mov_b32 s9, s65
    s_mov_b32 s10, 0x400000
    s_mov_b32 s11, 0x00020000
    v_bfe_u32 v13, v0, 4, 1
    v_lshl_add_u32 v12, v12, 1, v13
    s_lshl_b32 s37, s32, 2
    s_add_u32 s37, s37, 65536
    v_lshl_add_u32 v6, v12, 4, s37
    v_add_u32 v7, 65536, v1
    v_and_b32 v12, 31, v0
    v_lshrrev_b32 v13, 5, v0
    v_lshlrev_b32 v12, 2, v12
    v_lshl_add_u32 v8, v13, 10, v12
    s_mul_i32 s46, s33, 65536
    s_add_u32 s46, s46, 0x543f800
    s_lshl_b32 s37, s35, 7
    s_add_u32 s46, s46, s37
    s_cmp_eq_u32 s32, 2
    s_cselect_b32 s46, s46, 0x8000000
    s_mov_b32 s36, -1
    v_add_u32 v50, 0, v48
    v_add_u32 v51, 0, v49
    s_waitcnt vmcnt(16)
    s_barrier
    s_cmp_lg_u32 s32, 3
    s_cbranch_scc1 L_arr13
    s_mov_b32 s20, s82
    s_mov_b32 s21, s83
    s_mov_b32 s22, 0x100
    s_mov_b32 s23, 0x00020000
    s_and_b32 s37, s2, 15
    s_lshl_b32 s37, s37, 4
    v_mov_b32 v123, 1
    buffer_atomic_add v123, v124, s[20:23], s37 offen
L_arr13:
    ds_read_b64_tr_b16 a[0:1], v50 offset:0
    ds_read_b64_tr_b16 a[2:3], v50 offset:512
    ds_read_b64_tr_b16 a[4:5], v51 offset:0
    ds_read_b64_tr_b16 a[6:7], v51 offset:512
    ds_read_b64_tr_b16 a[8:9], v50 offset:4096
    ds_read_b64_tr_b16 a[10:11], v50 offset:4608
    ds_read_b64_tr_b16 a[12:13], v51 offset:4096
    ds_read_b64_tr_b16 a[14:15], v51 offset:4608
    s_add_u32 m0, s42, 81920
    s_nop 0
    buffer_load_dwordx4 v44, s[12:15], s54 offen lds
    s_add_u32 m0, s42, 82944
    s_nop 0
    buffer_load_dwordx4 v45, s[12:15], s54 offen lds
    s_add_u32 m0, s42, 83968
    s_nop 0
    buffer_load_dwordx4 v46, s[12:15], s54 offen lds
    s_add_u32 m0, s42, 84992
    s_nop 0
    buffer_load_dwordx4 v47, s[12:15], s54 offen lds
    s_add_u32 s54, s54, 131072
    s_waitcnt lgkmcnt(0)
    v_add_u32 v50, 16384, v48
    v_add_u32 v51, 16384, v49
    s_waitcnt vmcnt(16)
    s_barrier
    ds_read_b64_tr_b16 a[16:17], v50 offset:0
    ds_read_b64_tr_b16 a[18:19], v50 offset:512
    ds_read_b64_tr_b16 a[20:21], v51 offset:0
    ds_read_b64_tr_b16 a[22:23], v51 offset:512
    ds_read_b64_tr_b16 a[24:25], v50 offset:4096
    ds_read_b64_tr_b16 a[26:27], v50 offset:4608
    ds_read_b64_tr_b16 a[28:29], v51 offset:4096
    ds_read_b64_tr_b16 a[30:31], v51 offset:4608
    s_add_u32 m0, s42, 0
    s_nop 0
    buffer_load_dwordx4 v44, s[12:15], s54 offen lds
    s_add_u32 m0, s42, 1024
    s_nop 0
    buffer_load_dwordx4 v45, s[12:15], s54 offen lds
    s_add_u32 m0, s42, 2048
    s_nop 0
    buffer_load_dwordx4 v46, s[12:15], s54 offen lds
    s_add_u32 m0, s42, 3072
    s_nop 0
    buffer_load_dwordx4 v47, s[12:15], s54 offen lds
    s_add_u32 s54, s54, 131072
    s_waitcnt lgkmcnt(0)
    v_add_u32 v50, 32768, v48
    v_add_u32 v51, 32768, v49
    s_waitcnt vmcnt(16)
    s_barrier
    ds_read_b64_tr_b16 a[32:33], v50 offset:0
    ds_read_b64_tr_b16 a[34:35], v50 offset:512
    ds_read_b64_tr_b16 a[36:37], v51 offset:0
    ds_read_b64_tr_b16 a[38:39], v51 offset:512
    ds_read_b64_tr_b16 a[40:41], v50 offset:4096
    ds_read_b64_tr_b16 a[42:43], v50 offset:4608
    ds_read_b64_tr_b16 a[44:45], v51 offset:4096
    ds_read_b64_tr_b16 a[46:47], v51 offset:4608
    s_add_u32 m0, s42, 16384
    s_nop 0
    buffer_load_dwordx4 v44, s[12:15], s54 offen lds
    s_add_u32 m0, s42, 17408
    s_nop 0
    buffer_load_dwordx4 v45, s[12:15], s54 offen lds
    s_add_u32 m0, s42, 18432
    s_nop 0
    buffer_load_dwordx4 v46, s[12:15], s54 offen lds
    s_add_u32 m0, s42, 19456
    s_nop 0
    buffer_load_dwordx4 v47, s[12:15], s54 offen lds
    s_add_u32 s54, s54, 131072
    s_waitcnt lgkmcnt(0)
    v_add_u32 v50, 49152, v48
    v_add_u32 v51, 49152, v49
    s_waitcnt vmcnt(16)
    s_barrier
    ds_read_b64_tr_b16 a[48:49], v50 offset:0
    ds_read_b64_tr_b16 a[50:51], v50 offset:512
    ds_read_b64_tr_b16 a[52:53], v51 offset:0
    ds_read_b64_tr_b16 a[54:55], v51 offset:512
    ds_read_b64_tr_b16 a[56:57], v50 offset:4096
    ds_read_b64_tr_b16 a[58:59], v50 offset:4608
    ds_read_b64_tr_b16 a[60:61], v51 offset:4096
    ds_read_b64_tr_b16 a[62:63], v51 offset:4608
    s_add_u32 m0, s42, 32768
    s_nop 0
    buffer_load_dwordx4 v44, s[12:15], s54 offen lds
    s_add_u32 m0, s42, 33792
    s_nop 0
    buffer_load_dwordx4 v45, s[12:15], s54 offen lds
    s_add_u32 m0, s42, 34816
    s_nop 0
    buffer_load_dwordx4 v46, s[12:15], s54 offen lds
    s_add_u32 m0, s42, 35840
    s_nop 0
    buffer_load_dwordx4 v47, s[12:15], s54 offen lds
    s_add_u32 s54, s54, 131072
    s_waitcnt lgkmcnt(0)
    v_add_u32 v50, 65536, v48
    v_add_u32 v51, 65536, v49
    s_waitcnt vmcnt(16)
    s_barrier
    ds_read_b64_tr_b16 a[64:65], v50 offset:0
    ds_read_b64_tr_b16 a[66:67], v50 offset:512
    ds_read_b64_tr_b16 a[68:69], v51 offset:0
    ds_read_b64_tr_b16 a[70:71], v51 offset:512
    ds_read_b64_tr_b16 a[72:73], v50 offset:4096
    ds_read_b64_tr_b16 a[74:75], v50 offset:4608
    ds_read_b64_tr_b16 a[76:77], v51 offset:4096
    ds_read_b64_tr_b16 a[78:79], v51 offset:4608
    s_add_u32 m0, s42, 49152
    s_nop 0
    buffer_load_dwordx4 v44, s[12:15], s54 offen lds
    s_add_u32 m0, s42, 50176
    s_nop 0
    buffer_load_dwordx4 v45, s[12:15], s54 offen lds
    s_add_u32 m0, s42, 51200
    s_nop 0
    buffer_load_dwordx4 v46, s[12:15], s54 offen lds
    s_add_u32 m0, s42, 52224
    s_nop 0
    buffer_load_dwordx4 v47, s[12:15], s54 offen lds
    s_add_u32 s54, s54, 131072
    s_waitcnt lgkmcnt(0)
    v_add_u32 v50, 81920, v48
    v_add_u32 v51, 81920, v49
    s_waitcnt vmcnt(16)
    s_barrier
    ds_read_b64_tr_b16 a[80:81], v50 offset:0
    ds_read_b64_tr_b16 a[82:83], v50 offset:512
    ds_read_b64_tr_b16 a[84:85], v51 offset:0
    ds_read_b64_tr_b16 a[86:87], v51 offset:512
    ds_read_b64_tr_b16 a[88:89], v50 offset:4096
    ds_read_b64_tr_b16 a[90:91], v50 offset:4608
    ds_read_b64_tr_b16 a[92:93], v51 offset:4096
    ds_read_b64_tr_b16 a[94:95], v51 offset:4608
    s_add_u32 m0, s42, 65536
    s_nop 0
    buffer_load_dwordx4 v44, s[12:15], s54 offen lds
    s_add_u32 m0, s42, 66560
    s_nop 0
    buffer_load_dwordx4 v45, s[12:15], s54 offen lds
    s_add_u32 m0, s42, 67584
    s_nop 0
    buffer_load_dwordx4 v46, s[12:15], s54 offen lds
    s_add_u32 m0, s42, 68608
    s_nop 0
    buffer_load_dwordx4 v47, s[12:15], s54 offen lds
    s_add_u32 s54, s54, 131072
    s_waitcnt lgkmcnt(0)
    v_add_u32 v50, 0, v48
    v_add_u32 v51, 0, v49
    s_waitcnt vmcnt(16)
    s_barrier
    ds_read_b64_tr_b16 a[96:97], v50 offset:0
    ds_read_b64_tr_b16 a[98:99], v50 offset:512
    ds_read_b64_tr_b16 a[100:101], v51 offset:0
    ds_read_b64_tr_b16 a[102:103], v51 offset:512
    ds_read_b64_tr_b16 a[104:105], v50 offset:4096
    ds_read_b64_tr_b16 a[106:107], v50 offset:4608
    ds_read_b64_tr_b16 a[108:109], v51 offset:4096
    ds_read_b64_tr_b16 a[110:111], v51 offset:4608
    s_add_u32 m0, s42, 81920
    s_nop 0
    buffer_load_dwordx4 v44, s[12:15], s54 offen lds
    s_add_u32 m0, s42, 82944
    s_nop 0
    buffer_load_dwordx4 v45, s[12:15], s54 offen lds
    s_add_u32 m0, s42, 83968
    s_nop 0
    buffer_load_dwordx4 v46, s[12:15], s54 offen lds
    s_add_u32 m0, s42, 84992
    s_nop 0
    buffer_load_dwordx4 v47, s[12:15], s54 offen lds
    s_add_u32 s54, s54, 131072
    s_waitcnt lgkmcnt(0)
    v_add_u32 v50, 16384, v48
    v_add_u32 v51, 16384, v49
    s_waitcnt vmcnt(16)
    s_barrier
    ds_read_b64_tr_b16 a[112:113], v50 offset:0
    ds_read_b64_tr_b16 a[114:115], v50 offset:512
    ds_read_b64_tr_b16 a[116:117], v51 offset:0
    ds_read_b64_tr_b16 a[118:119], v51 offset:512
    ds_read_b64_tr_b16 a[120:121], v50 offset:4096
    ds_read_b64_tr_b16 a[122:123], v50 offset:4608
    ds_read_b64_tr_b16 a[124:125], v51 offset:4096
    ds_read_b64_tr_b16 a[126:127], v51 offset:4608
    s_add_u32 m0, s42, 0
    s_nop 0
    buffer_load_dwordx4 v44, s[12:15], s54 offen lds
    s_add_u32 m0, s42, 1024
    s_nop 0
    buffer_load_dwordx4 v45, s[12:15], s54 offen lds
    s_add_u32 m0, s42, 2048
    s_nop 0
    buffer_load_dwordx4 v46, s[12:15], s54 offen lds
    s_add_u32 m0, s42, 3072
    s_nop 0
    buffer_load_dwordx4 v47, s[12:15], s54 offen lds
    s_add_u32 s54, s54, 131072
    s_waitcnt lgkmcnt(0)
    v_add_u32 v50, 32768, v48
    v_add_u32 v51, 32768, v49
    s_waitcnt vmcnt(16)
    s_barrier
    ds_read_b64_tr_b16 a[128:129], v50 offset:0
    ds_read_b64_tr_b16 a[130:131], v50 offset:512
    ds_read_b64_tr_b16 a[132:133], v51 offset:0
    ds_read_b64_tr_b16 a[134:135], v51 offset:512
    ds_read_b64_tr_b16 a[136:137], v50 offset:4096
    ds_read_b64_tr_b16 a[138:139], v50 offset:4608
    ds_read_b64_tr_b16 a[140:141], v51 offset:4096
    ds_read_b64_tr_b16 a[142:143], v51 offset:4608
    s_add_u32 m0, s42, 16384
    s_nop 0
    buffer_load_dwordx4 v44, s[12:15], s54 offen lds
    s_add_u32 m0, s42, 17408
    s_nop 0
    buffer_load_dwordx4 v45, s[12:15], s54 offen lds
    s_add_u32 m0, s42, 18432
    s_nop 0
    buffer_load_dwordx4 v46, s[12:15], s54 offen lds
    s_add_u32 m0, s42, 19456
    s_nop 0
    buffer_load_dwordx4 v47, s[12:15], s54 offen lds
    s_add_u32 s54, s54, 131072
    s_waitcnt lgkmcnt(0)
    v_add_u32 v50, 49152, v48
    v_add_u32 v51, 49152, v49
    s_waitcnt vmcnt(16)
    s_barrier
    ds_read_b64_tr_b16 a[144:145], v50 offset:0
    ds_read_b64_tr_b16 a[146:147], v50 offset:512
    ds_read_b64_tr_b16 a[148:149], v51 offset:0
    ds_read_b64_tr_b16 a[150:151], v51 offset:512
    ds_read_b64_tr_b16 a[152:153], v50 offset:4096
    ds_read_b64_tr_b16 a[154:155], v50 offset:4608
    ds_read_b64_tr_b16 a[156:157], v51 offset:4096
    ds_read_b64_tr_b16 a[158:159], v51 offset:4608
    s_add_u32 m0, s42, 32768
    s_nop 0
    buffer_load_dwordx4 v44, s[12:15], s54 offen lds
    s_add_u32 m0, s42, 33792
    s_nop 0
    buffer_load_dwordx4 v45, s[12:15], s54 offen lds
    s_add_u32 m0, s42, 34816
    s_nop 0
    buffer_load_dwordx4 v46, s[12:15], s54 offen lds
    s_add_u32 m0, s42, 35840
    s_nop 0
    buffer_load_dwordx4 v47, s[12:15], s54 offen lds
    s_add_u32 s54, s54, 131072
    s_waitcnt lgkmcnt(0)
    v_add_u32 v50, 65536, v48
    v_add_u32 v51, 65536, v49
    s_waitcnt vmcnt(16)
    s_barrier
    ds_read_b64_tr_b16 a[160:161], v50 offset:0
    ds_read_b64_tr_b16 a[162:163], v50 offset:512
    ds_read_b64_tr_b16 a[164:165], v51 offset:0
    ds_read_b64_tr_b16 a[166:167], v51 offset:512
    ds_read_b64_tr_b16 a[168:169], v50 offset:4096
    ds_read_b64_tr_b16 a[170:171], v50 offset:4608
    ds_read_b64_tr_b16 a[172:173], v51 offset:4096
    ds_read_b64_tr_b16 a[174:175], v51 offset:4608
    s_add_u32 m0, s42, 49152
    s_nop 0
    buffer_load_dwordx4 v44, s[12:15], s54 offen lds
    s_add_u32 m0, s42, 50176
    s_nop 0
    buffer_load_dwordx4 v45, s[12:15], s54 offen lds
    s_add_u32 m0, s42, 51200
    s_nop 0
    buffer_load_dwordx4 v46, s[12:15], s54 offen lds
    s_add_u32 m0, s42, 52224
    s_nop 0
    buffer_load_dwordx4 v47, s[12:15], s54 offen lds
    s_add_u32 s54, s54, 131072
    s_waitcnt lgkmcnt(0)
    v_add_u32 v50, 81920, v48
    v_add_u32 v51, 81920, v49
    s_waitcnt vmcnt(16)
    s_barrier
    ds_read_b64_tr_b16 a[176:177], v50 offset:0
    ds_read_b64_tr_b16 a[178:179], v50 offset:512
    ds_read_b64_tr_b16 a[180:181], v51 offset:0
    ds_read_b64_tr_b16 a[182:183], v51 offset:512
    ds_read_b64_tr_b16 a[184:185], v50 offset:4096
    ds_read_b64_tr_b16 a[186:187], v50 offset:4608
    ds_read_b64_tr_b16 a[188:189], v51 offset:4096
    ds_read_b64_tr_b16 a[190:191], v51 offset:4608
    s_waitcnt lgkmcnt(0)
    v_add_u32 v50, 0, v48
    v_add_u32 v51, 0, v49
    s_waitcnt vmcnt(12)
    s_barrier
    ds_read_b64_tr_b16 a[192:193], v50 offset:0
    ds_read_b64_tr_b16 a[194:195], v50 offset:512
    ds_read_b64_tr_b16 a[196:197], v51 offset:0
    ds_read_b64_tr_b16 a[198:199], v51 offset:512
    ds_read_b64_tr_b16 a[200:201], v50 offset:4096
    ds_read_b64_tr_b16 a[202:203], v50 offset:4608
    ds_read_b64_tr_b16 a[204:205], v51 offset:4096
    ds_read_b64_tr_b16 a[206:207], v51 offset:4608
    s_waitcnt lgkmcnt(0)
    v_add_u32 v50, 16384, v48
    v_add_u32 v51, 16384, v49
    s_waitcnt vmcnt(8)
    s_barrier
    ds_read_b64_tr_b16 a[208:209], v50 offset:0
    ds_read_b64_tr_b16 a[210:211], v50 offset:512
    ds_read_b64_tr_b16 a[212:213], v51 offset:0
    ds_read_b64_tr_b16 a[214:215], v51 offset:512
    ds_read_b64_tr_b16 a[216:217], v50 offset:4096
    ds_read_b64_tr_b16 a[218:219], v50 offset:4608
    ds_read_b64_tr_b16 a[220:221], v51 offset:4096
    ds_read_b64_tr_b16 a[222:223], v51 offset:4608
    s_waitcnt lgkmcnt(0)
    v_add_u32 v50, 32768, v48
    v_add_u32 v51, 32768, v49
    s_waitcnt vmcnt(4)
    s_barrier
    ds_read_b64_tr_b16 a[224:225], v50 offset:0
    ds_read_b64_tr_b16 a[226:227], v50 offset:512
    ds_read_b64_tr_b16 a[228:229], v51 offset:0
    ds_read_b64_tr_b16 a[230:231], v51 offset:512
    ds_read_b64_tr_b16 a[232:233], v50 offset:4096
    ds_read_b64_tr_b16 a[234:235], v50 offset:4608
    ds_read_b64_tr_b16 a[236:237], v51 offset:4096
    ds_read_b64_tr_b16 a[238:239], v51 offset:4608
    s_waitcnt lgkmcnt(0)
    v_add_u32 v50, 49152, v48
    v_add_u32 v51, 49152, v49
    s_waitcnt vmcnt(0)
    s_barrier
    ds_read_b64_tr_b16 a[240:241], v50 offset:0
    ds_read_b64_tr_b16 a[242:243], v50 offset:512
    ds_read_b64_tr_b16 a[244:245], v51 offset:0
    ds_read_b64_tr_b16 a[246:247], v51 offset:512
    ds_read_b64_tr_b16 a[248:249], v50 offset:4096
    ds_read_b64_tr_b16 a[250:251], v50 offset:4608
    ds_read_b64_tr_b16 a[252:253], v51 offset:4096
    ds_read_b64_tr_b16 a[254:255], v51 offset:4608
    s_waitcnt lgkmcnt(0)
    s_barrier
    s_cmp_lg_u32 s32, 0
    s_cbranch_scc1 L_arv14
    s_mov_b32 s20, s82
    s_mov_b32 s21, s83
    s_mov_b32 s22, 0x100
    s_mov_b32 s23, 0x00020000
    v_and_b32 v12, 15, v0
    v_lshlrev_b32 v12, 4, v12
    buffer_load_dword v13, v12, s[20:23], 0 offen sc1
    s_waitcnt vmcnt(0)
    v_cmp_gt_u32 vcc, 16, v13
    s_cbranch_vccnz L_spin15
L_back16:
L_arv14:
    s_add_u32 s96, s41, 2031616
    s_mov_b32 s45, 0x5580000
    buffer_load_dword v136, v4, s[16:19], s45 offen sc1
    s_waitcnt vmcnt(0)
    v_cmp_ne_u32 vcc, 0, v136
    s_cbranch_vccnz L_spin17
L_back18:
    s_barrier
    s_add_u32 m0, s43, 0
    s_add_u32 s42, s41, 0
    buffer_load_dwordx4 v1, s[16:19], s42 offen offset:0 sc1 lds
    buffer_load_dwordx4 v1, s[16:19], s42 offen offset:1024 sc1 lds
    buffer_load_dwordx4 v1, s[16:19], s42 offen offset:2048 sc1 lds
    buffer_load_dwordx4 v1, s[16:19], s42 offen offset:3072 sc1 lds
    s_add_u32 m0, s43, 16384
    s_add_u32 s42, s41, 16384
    buffer_load_dwordx4 v1, s[16:19], s42 offen offset:0 sc1 lds
    buffer_load_dwordx4 v1, s[16:19], s42 offen offset:1024 sc1 lds
    buffer_load_dwordx4 v1, s[16:19], s42 offen offset:2048 sc1 lds
    buffer_load_dwordx4 v1, s[16:19], s42 offen offset:3072 sc1 lds
    s_add_u32 s45, s45, 131072
    s_add_u32 s47, s36, 1
    s_min_u32 s47, s47, 31
    s_cmp_ge_u32 s47, 16
    s_cselect_b32 s8, s88, s64
    s_cselect_b32 s9, s89, s65
    s_and_b32 s47, s47, 15
    s_lshl_b32 s47, s47, 16
    s_sub_u32 s47, s50, s47
    s_add_u32 s48, s47, 32768
    buffer_load_dwordx4 v[128:131], v3, s[8:11], s48 offen sc1
    buffer_load_dwordx4 v[132:135], v3, s[8:11], s47 offen sc1
    s_waitcnt vmcnt(0) lgkmcnt(0)
    s_barrier
    v_mfma_f32_16x16x32_bf16 v[12:15], v[108:111], v[128:131], 0
    v_mfma_f32_16x16x32_bf16 v[16:19], v[112:115], v[128:131], 0
    v_mfma_f32_16x16x32_bf16 v[20:23], v[108:111], v[132:135], 0
    v_mfma_f32_16x16x32_bf16 v[24:27], v[112:115], v[132:135], 0
    ds_read_b128 v[44:47], v1 offset:0
    ds_read_b128 v[48:51], v1 offset:1024
    ds_read_b128 v[52:55], v1 offset:2048
    ds_read_b128 v[56:59], v1 offset:3072
    s_mov_b32 s36, 0
    s_waitcnt lgkmcnt(0)
    s_nop 7
L_o_b0:
    s_waitcnt lgkmcnt(0)
    v_mfma_f32_16x16x32_bf16 v[12:15], a[0:3], v[44:47], v[12:15]
    ds_read_b128 v[60:63], v1 offset:4096
    s_cmp_eq_u32 s36, 0
    s_cselect_b32 s44, 0x8000000, s90
    s_cselect_b32 s49, 0x8000000, s46
    v_mfma_f32_16x16x32_bf16 v[20:23], a[0:3], v[48:51], v[20:23]
    ds_read_b128 v[64:67], v1 offset:5120
    v_cvt_pk_bf16_f32 v28, v28, v29
    v_mfma_f32_16x16x32_bf16 v[24:27], a[4:7], v[48:51], v[24:27]
    ds_read_b128 v[68:71], v1 offset:6144
    v_cvt_pk_bf16_f32 v29, v30, v31
    v_mfma_f32_16x16x32_bf16 v[16:19], a[4:7], v[44:47], v[16:19]
    ds_read_b128 v[72:75], v1 offset:7168
    v_cvt_pk_bf16_f32 v30, v32, v33
    v_mfma_f32_16x16x32_bf16 v[12:15], a[8:11], v[52:55], v[12:15]
    v_cvt_pk_bf16_f32 v31, v34, v35
    buffer_store_dwordx4 v[28:31], v1, s[16:19], s44 offen offset:0 sc1
    v_mfma_f32_16x16x32_bf16 v[20:23], a[8:11], v[56:59], v[20:23]
    v_cvt_pk_bf16_f32 v36, v36, v37
    v_cvt_pk_bf16_f32 v37, v38, v39
    v_mfma_f32_16x16x32_bf16 v[24:27], a[12:15], v[56:59], v[24:27]
    v_cvt_pk_bf16_f32 v38, v40, v41
    v_cvt_pk_bf16_f32 v39, v42, v43
    v_mfma_f32_16x16x32_bf16 v[16:19], a[12:15], v[52:55], v[16:19]
    buffer_store_dwordx4 v[36:39], v1, s[16:19], s44 offen offset:1024 sc1
    s_waitcnt lgkmcnt(0)
    v_mfma_f32_16x16x32_bf16 v[12:15], a[16:19], v[60:63], v[12:15]
    ds_read_b128 v[44:47], v1 offset:8192
    s_add_u32 m0, s43, 32768
    v_mfma_f32_16x16x32_bf16 v[20:23], a[16:19], v[64:67], v[20:23]
    ds_read_b128 v[48:51], v1 offset:9216
    s_add_u32 s42, s41, 32768
    v_mfma_f32_16x16x32_bf16 v[24:27], a[20:23], v[64:67], v[24:27]
    ds_read_b128 v[52:55], v1 offset:10240
    buffer_load_dwordx4 v1, s[16:19], s42 offen offset:0 sc1 lds
    v_mfma_f32_16x16x32_bf16 v[16:19], a[20:23], v[60:63], v[16:19]
    ds_read_b128 v[56:59], v1 offset:11264
    v_dot2_f32_bf16 v140, v28, s86, 0
    v_mfma_f32_16x16x32_bf16 v[12:15], a[24:27], v[68:71], v[12:15]
    v_dot2_f32_bf16 v141, v28, v28, 0
    v_dot2_f32_bf16 v140, v29, s86, v140
    v_mfma_f32_16x16x32_bf16 v[20:23], a[24:27], v[72:75], v[20:23]
    v_dot2_f32_bf16 v141, v29, v29, v141
    v_dot2_f32_bf16 v140, v30, s86, v140
    v_mfma_f32_16x16x32_bf16 v[24:27], a[28:31], v[72:75], v[24:27]
    buffer_load_dwordx4 v1, s[16:19], s42 offen offset:1024 sc1 lds
    v_dot2_f32_bf16 v141, v30, v30, v141
    v_mfma_f32_16x16x32_bf16 v[16:19], a[28:31], v[68:71], v[16:19]
    v_dot2_f32_bf16 v140, v31, s86, v140
    s_waitcnt lgkmcnt(0)
    v_mfma_f32_16x16x32_bf16 v[12:15], a[32:35], v[44:47], v[12:15]
    ds_read_b128 v[60:63], v1 offset:12288
    v_dot2_f32_bf16 v141, v31, v31, v141
    v_mfma_f32_16x16x32_bf16 v[20:23], a[32:35], v[48:51], v[20:23]
    ds_read_b128 v[64:67], v1 offset:13312
    v_permlane16_swap_b32 v140, v141
    v_mfma_f32_16x16x32_bf16 v[24:27], a[36:39], v[48:51], v[24:27]
    ds_read_b128 v[68:71], v1 offset:14336
    buffer_load_dwordx4 v1, s[16:19], s42 offen offset:2048 sc1 lds
    v_mfma_f32_16x16x32_bf16 v[16:19], a[36:39], v[44:47], v[16:19]
    ds_read_b128 v[72:75], v1 offset:15360
    v_add_f32 v140, v140, v141
    v_mfma_f32_16x16x32_bf16 v[12:15], a[40:43], v[52:55], v[12:15]
    v_mov_b32 v142, v140
    s_add_u32 s47, s36, 1
    v_mfma_f32_16x16x32_bf16 v[20:23], a[40:43], v[56:59], v[20:23]
    v_permlane32_swap_b32 v140, v142
    v_add_f32 v140, v140, v142
    v_mfma_f32_16x16x32_bf16 v[24:27], a[44:47], v[56:59], v[24:27]
    buffer_load_dwordx4 v1, s[16:19], s42 offen offset:3072 sc1 lds
    ds_write_b32 v6, v140 offset:1024
    v_mfma_f32_16x16x32_bf16 v[16:19], a[44:47], v[52:55], v[16:19]
    s_waitcnt vmcnt(6) lgkmcnt(1)
    s_barrier
    v_mfma_f32_16x16x32_bf16 v[12:15], a[48:51], v[60:63], v[12:15]
    ds_read_b128 v[44:47], v1 offset:16384
    v_dot2_f32_bf16 v144, v36, s86, 0
    v_mfma_f32_16x16x32_bf16 v[20:23], a[48:51], v[64:67], v[20:23]
    ds_read_b128 v[48:51], v1 offset:17408
    s_add_u32 m0, s43, 49152
    v_mfma_f32_16x16x32_bf16 v[24:27], a[52:55], v[64:67], v[24:27]
    ds_read_b128 v[52:55], v1 offset:18432
    s_add_u32 s42, s41, 49152
    v_mfma_f32_16x16x32_bf16 v[16:19], a[52:55], v[60:63], v[16:19]
    ds_read_b128 v[56:59], v1 offset:19456
    buffer_load_dwordx4 v1, s[16:19], s42 offen offset:0 sc1 lds
    v_mfma_f32_16x16x32_bf16 v[12:15], a[56:59], v[68:71], v[12:15]
    v_dot2_f32_bf16 v145, v36, v36, 0
    v_dot2_f32_bf16 v144, v37, s86, v144
    v_mfma_f32_16x16x32_bf16 v[20:23], a[56:59], v[72:75], v[20:23]
    v_dot2_f32_bf16 v145, v37, v37, v145
    v_dot2_f32_bf16 v144, v38, s86, v144
    v_mfma_f32_16x16x32_bf16 v[24:27], a[60:63], v[72:75], v[24:27]
    buffer_load_dword v136, v4, s[16:19], s45 offen sc1
    v_dot2_f32_bf16 v145, v38, v38, v145
    v_mfma_f32_16x16x32_bf16 v[16:19], a[60:63], v[68:71], v[16:19]
    buffer_load_dwordx4 v1, s[16:19], s42 offen offset:1024 sc1 lds
    s_waitcnt lgkmcnt(0)
    v_mfma_f32_16x16x32_bf16 v[12:15], a[64:67], v[44:47], v[12:15]
    ds_read_b128 v[60:63], v1 offset:20480
    v_dot2_f32_bf16 v144, v39, s86, v144
    v_mfma_f32_16x16x32_bf16 v[20:23], a[64:67], v[48:51], v[20:23]
    ds_read_b128 v[64:67], v1 offset:21504
    v_dot2_f32_bf16 v145, v39, v39, v145
    v_mfma_f32_16x16x32_bf16 v[24:27], a[68:71], v[48:51], v[24:27]
    ds_read_b128 v[68:71], v1 offset:22528
    v_permlane16_swap_b32 v144, v145
    v_mfma_f32_16x16x32_bf16 v[16:19], a[68:71], v[44:47], v[16:19]
    ds_read_b128 v[72:75], v1 offset:23552
    buffer_load_dwordx4 v1, s[16:19], s42 offen offset:2048 sc1 lds
    v_mfma_f32_16x16x32_bf16 v[12:15], a[72:75], v[52:55], v[12:15]
    v_add_f32 v144, v144, v145
    v_mov_b32 v146, v144
    v_mfma_f32_16x16x32_bf16 v[20:23], a[72:75], v[56:59], v[20:23]
    v_permlane32_swap_b32 v144, v146
    v_add_f32 v144, v144, v146
    v_mfma_f32_16x16x32_bf16 v[24:27], a[76:79], v[56:59], v[24:27]
    ds_write_b32 v6, v144 offset:1536
    s_min_u32 s47, s47, 31
    v_mfma_f32_16x16x32_bf16 v[16:19], a[76:79], v[52:55], v[16:19]
    buffer_load_dwordx4 v1, s[16:19], s42 offen offset:3072 sc1 lds
    s_waitcnt lgkmcnt(1)
    v_mfma_f32_16x16x32_bf16 v[12:15], a[80:83], v[60:63], v[12:15]
    ds_read_b128 v[44:47], v1 offset:24576
    s_add_u32 s41, s41, 65536
    v_mfma_f32_16x16x32_bf16 v[20:23], a[80:83], v[64:67], v[20:23]
    ds_read_b128 v[48:51], v1 offset:25600
    s_min_u32 s41, s41, s96
    v_mfma_f32_16x16x32_bf16 v[24:27], a[84:87], v[64:67], v[24:27]
    ds_read_b128 v[52:55], v1 offset:26624
    s_cmp_ge_u32 s47, 16
    s_cselect_b32 s8, s88, s64
    s_cselect_b32 s9, s89, s65
    v_mfma_f32_16x16x32_bf16 v[16:19], a[84:87], v[60:63], v[16:19]
    ds_read_b128 v[56:59], v1 offset:27648
    s_and_b32 s47, s47, 15
    v_mfma_f32_16x16x32_bf16 v[12:15], a[88:91], v[68:71], v[12:15]
    s_lshl_b32 s47, s47, 16
    s_sub_u32 s47, s50, s47
    v_mfma_f32_16x16x32_bf16 v[20:23], a[88:91], v[72:75], v[20:23]
    s_add_u32 s48, s47, 32768
    buffer_load_dwordx4 v[128:131], v3, s[8:11], s48 offen sc1
    v_mfma_f32_16x16x32_bf16 v[24:27], a[92:95], v[72:75], v[24:27]
    buffer_load_dwordx4 v[132:135], v3, s[8:11], s47 offen sc1
    v_mfma_f32_16x16x32_bf16 v[16:19], a[92:95], v[68:71], v[16:19]
    s_waitcnt lgkmcnt(0)
    v_mfma_f32_16x16x32_bf16 v[12:15], a[96:99], v[44:47], v[12:15]
    ds_read_b128 v[60:63], v1 offset:28672
    v_mfma_f32_16x16x32_bf16 v[20:23], a[96:99], v[48:51], v[20:23]
    ds_read_b128 v[64:67], v1 offset:29696
    v_mfma_f32_16x16x32_bf16 v[24:27], a[100:103], v[48:51], v[24:27]
    ds_read_b128 v[68:71], v1 offset:30720
    v_mfma_f32_16x16x32_bf16 v[16:19], a[100:103], v[44:47], v[16:19]
    ds_read_b128 v[72:75], v1 offset:31744
    v_mfma_f32_16x16x32_bf16 v[12:15], a[104:107], v[52:55], v[12:15]
    v_mfma_f32_16x16x32_bf16 v[20:23], a[104:107], v[56:59], v[20:23]
    v_mfma_f32_16x16x32_bf16 v[24:27], a[108:111], v[56:59], v[24:27]
    v_mfma_f32_16x16x32_bf16 v[16:19], a[108:111], v[52:55], v[16:19]
    s_waitcnt vmcnt(7) lgkmcnt(0)
    s_barrier
    v_mfma_f32_16x16x32_bf16 v[12:15], a[112:115], v[60:63], v[12:15]
    ds_read_b128 v[44:47], v1 offset:32768
    ds_read_b128 v[140:143], v7 offset:1024
    v_mfma_f32_16x16x32_bf16 v[20:23], a[112:115], v[64:67], v[20:23]
    ds_read_b128 v[48:51], v1 offset:33792
    v_mfma_f32_16x16x32_bf16 v[24:27], a[116:119], v[64:67], v[24:27]
    ds_read_b128 v[52:55], v1 offset:34816
    v_mfma_f32_16x16x32_bf16 v[16:19], a[116:119], v[60:63], v[16:19]
    ds_read_b128 v[56:59], v1 offset:35840
    v_mfma_f32_16x16x32_bf16 v[12:15], a[120:123], v[68:71], v[12:15]
    s_waitcnt lgkmcnt(3)
    v_add_f32 v140, v140, v141
    v_mfma_f32_16x16x32_bf16 v[20:23], a[120:123], v[72:75], v[20:23]
    v_add_f32 v142, v142, v143
    v_add_f32 v140, v140, v142
    v_mfma_f32_16x16x32_bf16 v[24:27], a[124:127], v[72:75], v[24:27]
    v_min_u32 v140, -2, v140
    buffer_store_dword v140, v8, s[16:19], s49 offen sc1
    v_mfma_f32_16x16x32_bf16 v[16:19], a[124:127], v[68:71], v[16:19]
    s_add_u32 s90, s90, 65536
    s_waitcnt lgkmcnt(0)
    v_mfma_f32_16x16x32_bf16 v[12:15], a[128:131], v[44:47], v[12:15]
    ds_read_b128 v[60:63], v1 offset:36864
    s_add_u32 s46, s46, 2048
    v_mfma_f32_16x16x32_bf16 v[20:23], a[128:131], v[48:51], v[20:23]
    ds_read_b128 v[64:67], v1 offset:37888
    v_mfma_f32_16x16x32_bf16 v[24:27], a[132:135], v[48:51], v[24:27]
    ds_read_b128 v[68:71], v1 offset:38912
    v_mfma_f32_16x16x32_bf16 v[16:19], a[132:135], v[44:47], v[16:19]
    ds_read_b128 v[72:75], v1 offset:39936
    v_mfma_f32_16x16x32_bf16 v[12:15], a[136:139], v[52:55], v[12:15]
    v_mfma_f32_16x16x32_bf16 v[20:23], a[136:139], v[56:59], v[20:23]
    v_mfma_f32_16x16x32_bf16 v[24:27], a[140:143], v[56:59], v[24:27]
    v_mfma_f32_16x16x32_bf16 v[16:19], a[140:143], v[52:55], v[16:19]
    s_waitcnt lgkmcnt(0)
    v_mfma_f32_16x16x32_bf16 v[12:15], a[144:147], v[60:63], v[12:15]
    ds_read_b128 v[44:47], v1 offset:40960
    v_mfma_f32_16x16x32_bf16 v[20:23], a[144:147], v[64:67], v[20:23]
    ds_read_b128 v[48:51], v1 offset:41984
    v_mfma_f32_16x16x32_bf16 v[24:27], a[148:151], v[64:67], v[24:27]
    ds_read_b128 v[52:55], v1 offset:43008
    s_waitcnt vmcnt(3)
    v_mfma_f32_16x16x32_bf16 v[16:19], a[148:151], v[60:63], v[16:19]
    ds_read_b128 v[56:59], v1 offset:44032
    s_barrier
    v_mfma_f32_16x16x32_bf16 v[12:15], a[152:155], v[68:71], v[12:15]
    buffer_store_dword v124, v124, s[16:19], s91 offen sc1
    s_add_u32 s91, s91, 131072
    v_mfma_f32_16x16x32_bf16 v[20:23], a[152:155], v[72:75], v[20:23]
    v_cmp_ne_u32 vcc, 0, v136
    s_cbranch_vccnz L_spin19
L_back20:
    v_mfma_f32_16x16x32_bf16 v[24:27], a[156:159], v[72:75], v[24:27]
    s_barrier
    s_add_u32 m0, s43, 98304
    v_mfma_f32_16x16x32_bf16 v[16:19], a[156:159], v[68:71], v[16:19]
    s_add_u32 s42, s41, 0
    s_waitcnt lgkmcnt(0)
    v_mfma_f32_16x16x32_bf16 v[12:15], a[160:163], v[44:47], v[12:15]
    ds_read_b128 v[60:63], v1 offset:45056
    buffer_load_dwordx4 v1, s[16:19], s42 offen offset:0 sc1 lds
    v_mfma_f32_16x16x32_bf16 v[20:23], a[160:163], v[48:51], v[20:23]
    ds_read_b128 v[64:67], v1 offset:46080
    v_mfma_f32_16x16x32_bf16 v[24:27], a[164:167], v[48:51], v[24:27]
    ds_read_b128 v[68:71], v1 offset:47104
    buffer_load_dwordx4 v1, s[16:19], s42 offen offset:1024 sc1 lds
    v_mfma_f32_16x16x32_bf16 v[16:19], a[164:167], v[44:47], v[16:19]
    ds_read_b128 v[72:75], v1 offset:48128
    v_mfma_f32_16x16x32_bf16 v[12:15], a[168:171], v[52:55], v[12:15]
    buffer_load_dwordx4 v1, s[16:19], s42 offen offset:2048 sc1 lds
    v_mfma_f32_16x16x32_bf16 v[20:23], a[168:171], v[56:59], v[20:23]
    v_mfma_f32_16x16x32_bf16 v[24:27], a[172:175], v[56:59], v[24:27]
    buffer_load_dwordx4 v1, s[16:19], s42 offen offset:3072 sc1 lds
    v_mfma_f32_16x16x32_bf16 v[16:19], a[172:175], v[52:55], v[16:19]
    s_waitcnt lgkmcnt(0)
    v_mfma_f32_16x16x32_bf16 v[12:15], a[176:179], v[60:63], v[12:15]
    ds_read_b128 v[44:47], v1 offset:49152
    v_mfma_f32_16x16x32_bf16 v[20:23], a[176:179], v[64:67], v[20:23]
    ds_read_b128 v[48:51], v1 offset:50176
    v_mfma_f32_16x16x32_bf16 v[24:27], a[180:183], v[64:67], v[24:27]
    ds_read_b128 v[52:55], v1 offset:51200
    s_add_u32 m0, s43, 114688
    v_mfma_f32_16x16x32_bf16 v[16:19], a[180:183], v[60:63], v[16:19]
    ds_read_b128 v[56:59], v1 offset:52224
    s_add_u32 s42, s41, 16384
    v_mfma_f32_16x16x32_bf16 v[12:15], a[184:187], v[68:71], v[12:15]
    buffer_load_dwordx4 v1, s[16:19], s42 offen offset:0 sc1 lds
    v_mfma_f32_16x16x32_bf16 v[20:23], a[184:187], v[72:75], v[20:23]
    v_mfma_f32_16x16x32_bf16 v[24:27], a[188:191], v[72:75], v[24:27]
    v_mfma_f32_16x16x32_bf16 v[16:19], a[188:191], v[68:71], v[16:19]
    s_waitcnt lgkmcnt(0)
    v_mfma_f32_16x16x32_bf16 v[12:15], a[192:195], v[44:47], v[12:15]
    ds_read_b128 v[60:63], v1 offset:53248
    v_mfma_f32_16x16x32_bf16 v[20:23], a[192:195], v[48:51], v[20:23]
    ds_read_b128 v[64:67], v1 offset:54272
    buffer_load_dwordx4 v1, s[16:19], s42 offen offset:1024 sc1 lds
    v_mfma_f32_16x16x32_bf16 v[24:27], a[196:199], v[48:51], v[24:27]
    ds_read_b128 v[68:71], v1 offset:55296
    v_mfma_f32_16x16x32_bf16 v[16:19], a[196:199], v[44:47], v[16:19]
    ds_read_b128 v[72:75], v1 offset:56320
    v_mfma_f32_16x16x32_bf16 v[12:15], a[200:203], v[52:55], v[12:15]
    v_mfma_f32_16x16x32_bf16 v[20:23], a[200:203], v[56:59], v[20:23]
    v_mfma_f32_16x16x32_bf16 v[24:27], a[204:207], v[56:59], v[24:27]
    buffer_load_dwordx4 v1, s[16:19], s42 offen offset:2048 sc1 lds
    v_mfma_f32_16x16x32_bf16 v[16:19], a[204:207], v[52:55], v[16:19]
    s_waitcnt lgkmcnt(0)
    v_mfma_f32_16x16x32_bf16 v[12:15], a[208:211], v[60:63], v[12:15]
    ds_read_b128 v[44:47], v1 offset:57344
    v_mfma_f32_16x16x32_bf16 v[20:23], a[208:211], v[64:67], v[20:23]
    ds_read_b128 v[48:51], v1 offset:58368
    v_mfma_f32_16x16x32_bf16 v[24:27], a[212:215], v[64:67], v[24:27]
    ds_read_b128 v[52:55], v1 offset:59392
    v_mfma_f32_16x16x32_bf16 v[16:19], a[212:215], v[60:63], v[16:19]
    ds_read_b128 v[56:59], v1 offset:60416
    buffer_load_dwordx4 v1, s[16:19], s42 offen offset:3072 sc1 lds
    v_mfma_f32_16x16x32_bf16 v[12:15], a[216:219], v[68:71], v[12:15]
    s_add_u32 s45, s45, 131072
    v_mfma_f32_16x16x32_bf16 v[20:23], a[216:219], v[72:75], v[20:23]
    v_mfma_f32_16x16x32_bf16 v[24:27], a[220:223], v[72:75], v[24:27]
    s_waitcnt vmcnt(10)
    v_mfma_f32_16x16x32_bf16 v[28:31], v[108:111], v[128:131], 0
    v_mfma_f32_16x16x32_bf16 v[32:35], v[112:115], v[128:131], 0
    v_mfma_f32_16x16x32_bf16 v[36:39], v[108:111], v[132:135], 0
    v_mfma_f32_16x16x32_bf16 v[40:43], v[112:115], v[132:135], 0
    v_mfma_f32_16x16x32_bf16 v[16:19], a[220:223], v[68:71], v[16:19]
    s_waitcnt lgkmcnt(0)
    v_mfma_f32_16x16x32_bf16 v[12:15], a[224:227], v[44:47], v[12:15]
    ds_read_b128 v[60:63], v1 offset:61440
    v_mfma_f32_16x16x32_bf16 v[20:23], a[224:227], v[48:51], v[20:23]
    ds_read_b128 v[64:67], v1 offset:62464
    v_mfma_f32_16x16x32_bf16 v[24:27], a[228:231], v[48:51], v[24:27]
    ds_read_b128 v[68:71], v1 offset:63488
    v_mfma_f32_16x16x32_bf16 v[16:19], a[228:231], v[44:47], v[16:19]
    ds_read_b128 v[72:75], v1 offset:64512
    v_mfma_f32_16x16x32_bf16 v[12:15], a[232:235], v[52:55], v[12:15]
    v_mfma_f32_16x16x32_bf16 v[20:23], a[232:235], v[56:59], v[20:23]
    v_mfma_f32_16x16x32_bf16 v[24:27], a[236:239], v[56:59], v[24:27]
    v_mfma_f32_16x16x32_bf16 v[16:19], a[236:239], v[52:55], v[16:19]
    s_waitcnt vmcnt(4) lgkmcnt(0)
    s_barrier
    v_mfma_f32_16x16x32_bf16 v[12:15], a[240:243], v[60:63], v[12:15]
    ds_read_b128 v[44:47], v2 offset:0
    v_mfma_f32_16x16x32_bf16 v[20:23], a[240:243], v[64:67], v[20:23]
    ds_read_b128 v[48:51], v2 offset:1024
    v_mfma_f32_16x16x32_bf16 v[24:27], a[244:247], v[64:67], v[24:27]
    ds_read_b128 v[52:55], v2 offset:2048
    v_mfma_f32_16x16x32_bf16 v[16:19], a[244:247], v[60:63], v[16:19]
    ds_read_b128 v[56:59], v2 offset:3072
    v_mfma_f32_16x16x32_bf16 v[12:15], a[248:251], v[68:71], v[12:15]
    v_mfma_f32_16x16x32_bf16 v[20:23], a[248:251], v[72:75], v[20:23]
    v_mfma_f32_16x16x32_bf16 v[24:27], a[252:255], v[72:75], v[24:27]
    v_mfma_f32_16x16x32_bf16 v[16:19], a[252:255], v[68:71], v[16:19]
    s_add_u32 s36, s36, 1
L_o_b1:
    s_waitcnt lgkmcnt(0)
    v_mfma_f32_16x16x32_bf16 v[28:31], a[0:3], v[44:47], v[28:31]
    ds_read_b128 v[60:63], v2 offset:4096
    s_cmp_eq_u32 s36, 0
    s_cselect_b32 s44, 0x8000000, s90
    s_cselect_b32 s49, 0x8000000, s46
    v_mfma_f32_16x16x32_bf16 v[36:39], a[0:3], v[48:51], v[36:39]
    ds_read_b128 v[64:67], v2 offset:5120
    v_cvt_pk_bf16_f32 v12, v12, v13
    v_mfma_f32_16x16x32_bf16 v[40:43], a[4:7], v[48:51], v[40:43]
    ds_read_b128 v[68:71], v2 offset:6144
    v_cvt_pk_bf16_f32 v13, v14, v15
    v_mfma_f32_16x16x32_bf16 v[32:35], a[4:7], v[44:47], v[32:35]
    ds_read_b128 v[72:75], v2 offset:7168
    v_cvt_pk_bf16_f32 v14, v16, v17
    v_mfma_f32_16x16x32_bf16 v[28:31], a[8:11], v[52:55], v[28:31]
    v_cvt_pk_bf16_f32 v15, v18, v19
    buffer_store_dwordx4 v[12:15], v1, s[16:19], s44 offen offset:0 sc1
    v_mfma_f32_16x16x32_bf16 v[36:39], a[8:11], v[56:59], v[36:39]
    v_cvt_pk_bf16_f32 v20, v20, v21
    v_cvt_pk_bf16_f32 v21, v22, v23
    v_mfma_f32_16x16x32_bf16 v[40:43], a[12:15], v[56:59], v[40:43]
    v_cvt_pk_bf16_f32 v22, v24, v25
    v_cvt_pk_bf16_f32 v23, v26, v27
    v_mfma_f32_16x16x32_bf16 v[32:35], a[12:15], v[52:55], v[32:35]
    buffer_store_dwordx4 v[20:23], v1, s[16:19], s44 offen offset:1024 sc1
    s_waitcnt lgkmcnt(0)
    v_mfma_f32_16x16x32_bf16 v[28:31], a[16:19], v[60:63], v[28:31]
    ds_read_b128 v[44:47], v2 offset:8192
    s_add_u32 m0, s43, 131072
    v_mfma_f32_16x16x32_bf16 v[36:39], a[16:19], v[64:67], v[36:39]
    ds_read_b128 v[48:51], v2 offset:9216
    s_add_u32 s42, s41, 32768
    v_mfma_f32_16x16x32_bf16 v[40:43], a[20:23], v[64:67], v[40:43]
    ds_read_b128 v[52:55], v2 offset:10240
    buffer_load_dwordx4 v1, s[16:19], s42 offen offset:0 sc1 lds
    v_mfma_f32_16x16x32_bf16 v[32:35], a[20:23], v[60:63], v[32:35]
    ds_read_b128 v[56:59], v2 offset:11264
    v_dot2_f32_bf16 v140, v12, s86, 0
    v_mfma_f32_16x16x32_bf16 v[28:31], a[24:27], v[68:71], v[28:31]
    v_dot2_f32_bf16 v141, v12, v12, 0
    v_dot2_f32_bf16 v140, v13, s86, v140
    v_mfma_f32_16x16x32_bf16 v[36:39], a[24:27], v[72:75], v[36:39]
    v_dot2_f32_bf16 v141, v13, v13, v141
    v_dot2_f32_bf16 v140, v14, s86, v140
    v_mfma_f32_16x16x32_bf16 v[40:43], a[28:31], v[72:75], v[40:43]
    buffer_load_dwordx4 v1, s[16:19], s42 offen offset:1024 sc1 lds
    v_dot2_f32_bf16 v141, v14, v14, v141
    v_mfma_f32_16x16x32_bf16 v[32:35], a[28:31], v[68:71], v[32:35]
    v_dot2_f32_bf16 v140, v15, s86, v140
    s_waitcnt lgkmcnt(0)
    v_mfma_f32_16x16x32_bf16 v[28:31], a[32:35], v[44:47], v[28:31]
    ds_read_b128 v[60:63], v2 offset:12288
    v_dot2_f32_bf16 v141, v15, v15, v141
    v_mfma_f32_16x16x32_bf16 v[36:39], a[32:35], v[48:51], v[36:39]
    ds_read_b128 v[64:67], v2 offset:13312
    v_permlane16_swap_b32 v140, v141
    v_mfma_f32_16x16x32_bf16 v[40:43], a[36:39], v[48:51], v[40:43]
    ds_read_b128 v[68:71], v2 offset:14336
    buffer_load_dwordx4 v1, s[16:19], s42 offen offset:2048 sc1 lds
    v_mfma_f32_16x16x32_bf16 v[32:35], a[36:39], v[44:47], v[32:35]
    ds_read_b128 v[72:75], v2 offset:15360
    v_add_f32 v140, v140, v141
    v_mfma_f32_16x16x32_bf16 v[28:31], a[40:43], v[52:55], v[28:31]
    v_mov_b32 v142, v140
    s_add_u32 s47, s36, 1
    v_mfma_f32_16x16x32_bf16 v[36:39], a[40:43], v[56:59], v[36:39]
    v_permlane32_swap_b32 v140, v142
    v_add_f32 v140, v140, v142
    v_mfma_f32_16x16x32_bf16 v[40:43], a[44:47], v[56:59], v[40:43]
    buffer_load_dwordx4 v1, s[16:19], s42 offen offset:3072 sc1 lds
    ds_write_b32 v6, v140 offset:0
    v_mfma_f32_16x16x32_bf16 v[32:35], a[44:47], v[52:55], v[32:35]
    s_waitcnt vmcnt(6) lgkmcnt(1)
    s_barrier
    v_mfma_f32_16x16x32_bf16 v[28:31], a[48:51], v[60:63], v[28:31]
    ds_read_b128 v[44:47], v2 offset:16384
    v_dot2_f32_bf16 v144, v20, s86, 0
    v_mfma_f32_16x16x32_bf16 v[36:39], a[48:51], v[64:67], v[36:39]
    ds_read_b128 v[48:51], v2 offset:17408
    s_add_u32 m0, s43, 147456
    v_mfma_f32_16x16x32_bf16 v[40:43], a[52:55], v[64:67], v[40:43]
    ds_read_b128 v[52:55], v2 offset:18432
    s_add_u32 s42, s41, 49152
    v_mfma_f32_16x16x32_bf16 v[32:35], a[52:55], v[60:63], v[32:35]
    ds_read_b128 v[56:59], v2 offset:19456
    buffer_load_dwordx4 v1, s[16:19], s42 offen offset:0 sc1 lds
    v_mfma_f32_16x16x32_bf16 v[28:31], a[56:59], v[68:71], v[28:31]
    v_dot2_f32_bf16 v145, v20, v20, 0
    v_dot2_f32_bf16 v144, v21, s86, v144
    v_mfma_f32_16x16x32_bf16 v[36:39], a[56:59], v[72:75], v[36:39]
    v_dot2_f32_bf16 v145, v21, v21, v145
    v_dot2_f32_bf16 v144, v22, s86, v144
    v_mfma_f32_16x16x32_bf16 v[40:43], a[60:63], v[72:75], v[40:43]
    buffer_load_dword v136, v4, s[16:19], s45 offen sc1
    v_dot2_f32_bf16 v145, v22, v22, v145
    v_mfma_f32_16x16x32_bf16 v[32:35], a[60:63], v[68:71], v[32:35]
    buffer_load_dwordx4 v1, s[16:19], s42 offen offset:1024 sc1 lds
    s_waitcnt lgkmcnt(0)
    v_mfma_f32_16x16x32_bf16 v[28:31], a[64:67], v[44:47], v[28:31]
    ds_read_b128 v[60:63], v2 offset:20480
    v_dot2_f32_bf16 v144, v23, s86, v144
    v_mfma_f32_16x16x32_bf16 v[36:39], a[64:67], v[48:51], v[36:39]
    ds_read_b128 v[64:67], v2 offset:21504
    v_dot2_f32_bf16 v145, v23, v23, v145
    v_mfma_f32_16x16x32_bf16 v[40:43], a[68:71], v[48:51], v[40:43]
    ds_read_b128 v[68:71], v2 offset:22528
    v_permlane16_swap_b32 v144, v145
    v_mfma_f32_16x16x32_bf16 v[32:35], a[68:71], v[44:47], v[32:35]
    ds_read_b128 v[72:75], v2 offset:23552
    buffer_load_dwordx4 v1, s[16:19], s42 offen offset:2048 sc1 lds
    v_mfma_f32_16x16x32_bf16 v[28:31], a[72:75], v[52:55], v[28:31]
    v_add_f32 v144, v144, v145
    v_mov_b32 v146, v144
    v_mfma_f32_16x16x32_bf16 v[36:39], a[72:75], v[56:59], v[36:39]
    v_permlane32_swap_b32 v144, v146
    v_add_f32 v144, v144, v146
    v_mfma_f32_16x16x32_bf16 v[40:43], a[76:79], v[56:59], v[40:43]
    ds_write_b32 v6, v144 offset:512
    s_min_u32 s47, s47, 31
    v_mfma_f32_16x16x32_bf16 v[32:35], a[76:79], v[52:55], v[32:35]
    buffer_load_dwordx4 v1, s[16:19], s42 offen offset:3072 sc1 lds
    s_waitcnt lgkmcnt(1)
    v_mfma_f32_16x16x32_bf16 v[28:31], a[80:83], v[60:63], v[28:31]
    ds_read_b128 v[44:47], v2 offset:24576
    s_add_u32 s41, s41, 65536
    v_mfma_f32_16x16x32_bf16 v[36:39], a[80:83], v[64:67], v[36:39]
    ds_read_b128 v[48:51], v2 offset:25600
    s_min_u32 s41, s41, s96
    v_mfma_f32_16x16x32_bf16 v[40:43], a[84:87], v[64:67], v[40:43]
    ds_read_b128 v[52:55], v2 offset:26624
    s_cmp_ge_u32 s47, 16
    s_cselect_b32 s8, s88, s64
    s_cselect_b32 s9, s89, s65
    v_mfma_f32_16x16x32_bf16 v[32:35], a[84:87], v[60:63], v[32:35]
    ds_read_b128 v[56:59], v2 offset:27648
    s_and_b32 s47, s47, 15
    v_mfma_f32_16x16x32_bf16 v[28:31], a[88:91], v[68:71], v[28:31]
    s_lshl_b32 s47, s47, 16
    s_sub_u32 s47, s50, s47
    v_mfma_f32_16x16x32_bf16 v[36:39], a[88:91], v[72:75], v[36:39]
    s_add_u32 s48, s47, 32768
    buffer_load_dwordx4 v[128:131], v3, s[8:11], s48 offen sc1
    v_mfma_f32_16x16x32_bf16 v[40:43], a[92:95], v[72:75], v[40:43]
    buffer_load_dwordx4 v[132:135], v3, s[8:11], s47 offen sc1
    v_mfma_f32_16x16x32_bf16 v[32:35], a[92:95], v[68:71], v[32:35]
    s_waitcnt lgkmcnt(0)
    v_mfma_f32_16x16x32_bf16 v[28:31], a[96:99], v[44:47], v[28:31]
    ds_read_b128 v[60:63], v2 offset:28672
    v_mfma_f32_16x16x32_bf16 v[36:39], a[96:99], v[48:51], v[36:39]
    ds_read_b128 v[64:67], v2 offset:29696
    v_mfma_f32_16x16x32_bf16 v[40:43], a[100:103], v[48:51], v[40:43]
    ds_read_b128 v[68:71], v2 offset:30720
    v_mfma_f32_16x16x32_bf16 v[32:35], a[100:103], v[44:47], v[32:35]
    ds_read_b128 v[72:75], v2 offset:31744
    v_mfma_f32_16x16x32_bf16 v[28:31], a[104:107], v[52:55], v[28:31]
    v_mfma_f32_16x16x32_bf16 v[36:39], a[104:107], v[56:59], v[36:39]
    v_mfma_f32_16x16x32_bf16 v[40:43], a[108:111], v[56:59], v[40:43]
    v_mfma_f32_16x16x32_bf16 v[32:35], a[108:111], v[52:55], v[32:35]
    s_waitcnt vmcnt(7) lgkmcnt(0)
    s_barrier
    v_mfma_f32_16x16x32_bf16 v[28:31], a[112:115], v[60:63], v[28:31]
    ds_read_b128 v[44:47], v2 offset:32768
    ds_read_b128 v[140:143], v7 offset:0
    v_mfma_f32_16x16x32_bf16 v[36:39], a[112:115], v[64:67], v[36:39]
    ds_read_b128 v[48:51], v2 offset:33792
    v_mfma_f32_16x16x32_bf16 v[40:43], a[116:119], v[64:67], v[40:43]
    ds_read_b128 v[52:55], v2 offset:34816
    v_mfma_f32_16x16x32_bf16 v[32:35], a[116:119], v[60:63], v[32:35]
    ds_read_b128 v[56:59], v2 offset:35840
    v_mfma_f32_16x16x32_bf16 v[28:31], a[120:123], v[68:71], v[28:31]
    s_waitcnt lgkmcnt(3)
    v_add_f32 v140, v140, v141
    v_mfma_f32_16x16x32_bf16 v[36:39], a[120:123], v[72:75], v[36:39]
    v_add_f32 v142, v142, v143
    v_add_f32 v140, v140, v142
    v_mfma_f32_16x16x32_bf16 v[40:43], a[124:127], v[72:75], v[40:43]
    v_min_u32 v140, -2, v140
    buffer_store_dword v140, v8, s[16:19], s49 offen sc1
    v_mfma_f32_16x16x32_bf16 v[32:35], a[124:127], v[68:71], v[32:35]
    s_add_u32 s90, s90, 65536
    s_waitcnt lgkmcnt(0)
    v_mfma_f32_16x16x32_bf16 v[28:31], a[128:131], v[44:47], v[28:31]
    ds_read_b128 v[60:63], v2 offset:36864
    s_add_u32 s46, s46, 2048
    v_mfma_f32_16x16x32_bf16 v[36:39], a[128:131], v[48:51], v[36:39]
    ds_read_b128 v[64:67], v2 offset:37888
    v_mfma_f32_16x16x32_bf16 v[40:43], a[132:135], v[48:51], v[40:43]
    ds_read_b128 v[68:71], v2 offset:38912
    v_mfma_f32_16x16x32_bf16 v[32:35], a[132:135], v[44:47], v[32:35]
    ds_read_b128 v[72:75], v2 offset:39936
    v_mfma_f32_16x16x32_bf16 v[28:31], a[136:139], v[52:55], v[28:31]
    v_mfma_f32_16x16x32_bf16 v[36:39], a[136:139], v[56:59], v[36:39]
    v_mfma_f32_16x16x32_bf16 v[40:43], a[140:143], v[56:59], v[40:43]
    v_mfma_f32_16x16x32_bf16 v[32:35], a[140:143], v[52:55], v[32:35]
    s_waitcnt lgkmcnt(0)
    v_mfma_f32_16x16x32_bf16 v[28:31], a[144:147], v[60:63], v[28:31]
    ds_read_b128 v[44:47], v2 offset:40960
    v_mfma_f32_16x16x32_bf16 v[36:39], a[144:147], v[64:67], v[36:39]
    ds_read_b128 v[48:51], v2 offset:41984
    v_mfma_f32_16x16x32_bf16 v[40:43], a[148:151], v[64:67], v[40:43]
    ds_read_b128 v[52:55], v2 offset:43008
    s_waitcnt vmcnt(3)
    v_mfma_f32_16x16x32_bf16 v[32:35], a[148:151], v[60:63], v[32:35]
    ds_read_b128 v[56:59], v2 offset:44032
    s_barrier
    v_mfma_f32_16x16x32_bf16 v[28:31], a[152:155], v[68:71], v[28:31]
    buffer_store_dword v124, v124, s[16:19], s91 offen sc1
    s_add_u32 s91, s91, 131072
    v_mfma_f32_16x16x32_bf16 v[36:39], a[152:155], v[72:75], v[36:39]
    v_cmp_ne_u32 vcc, 0, v136
    s_cbranch_vccnz L_spin21
L_back22:
    v_mfma_f32_16x16x32_bf16 v[40:43], a[156:159], v[72:75], v[40:43]
    s_barrier
    s_add_u32 m0, s43, 0
    v_mfma_f32_16x16x32_bf16 v[32:35], a[156:159], v[68:71], v[32:35]
    s_add_u32 s42, s41, 0
    s_waitcnt lgkmcnt(0)
    v_mfma_f32_16x16x32_bf16 v[28:31], a[160:163], v[44:47], v[28:31]
    ds_read_b128 v[60:63], v2 offset:45056
    buffer_load_dwordx4 v1, s[16:19], s42 offen offset:0 sc1 lds
    v_mfma_f32_16x16x32_bf16 v[36:39], a[160:163], v[48:51], v[36:39]
    ds_read_b128 v[64:67], v2 offset:46080
    v_mfma_f32_16x16x32_bf16 v[40:43], a[164:167], v[48:51], v[40:43]
    ds_read_b128 v[68:71], v2 offset:47104
    buffer_load_dwordx4 v1, s[16:19], s42 offen offset:1024 sc1 lds
    v_mfma_f32_16x16x32_bf16 v[32:35], a[164:167], v[44:47], v[32:35]
    ds_read_b128 v[72:75], v2 offset:48128
    v_mfma_f32_16x16x32_bf16 v[28:31], a[168:171], v[52:55], v[28:31]
    buffer_load_dwordx4 v1, s[16:19], s42 offen offset:2048 sc1 lds
    v_mfma_f32_16x16x32_bf16 v[36:39], a[168:171], v[56:59], v[36:39]
    v_mfma_f32_16x16x32_bf16 v[40:43], a[172:175], v[56:59], v[40:43]
    buffer_load_dwordx4 v1, s[16:19], s42 offen offset:3072 sc1 lds
    v_mfma_f32_16x16x32_bf16 v[32:35], a[172:175], v[52:55], v[32:35]
    s_waitcnt lgkmcnt(0)
    v_mfma_f32_16x16x32_bf16 v[28:31], a[176:179], v[60:63], v[28:31]
    ds_read_b128 v[44:47], v2 offset:49152
    v_mfma_f32_16x16x32_bf16 v[36:39], a[176:179], v[64:67], v[36:39]
    ds_read_b128 v[48:51], v2 offset:50176
    v_mfma_f32_16x16x32_bf16 v[40:43], a[180:183], v[64:67], v[40:43]
    ds_read_b128 v[52:55], v2 offset:51200
    s_add_u32 m0, s43, 16384
    v_mfma_f32_16x16x32_bf16 v[32:35], a[180:183], v[60:63], v[32:35]
    ds_read_b128 v[56:59], v2 offset:52224
    s_add_u32 s42, s41, 16384
    v_mfma_f32_16x16x32_bf16 v[28:31], a[184:187], v[68:71], v[28:31]
    buffer_load_dwordx4 v1, s[16:19], s42 offen offset:0 sc1 lds
    v_mfma_f32_16x16x32_bf16 v[36:39], a[184:187], v[72:75], v[36:39]
    v_mfma_f32_16x16x32_bf16 v[40:43], a[188:191], v[72:75], v[40:43]
    v_mfma_f32_16x16x32_bf16 v[32:35], a[188:191], v[68:71], v[32:35]
    s_waitcnt lgkmcnt(0)
    v_mfma_f32_16x16x32_bf16 v[28:31], a[192:195], v[44:47], v[28:31]
    ds_read_b128 v[60:63], v2 offset:53248
    v_mfma_f32_16x16x32_bf16 v[36:39], a[192:195], v[48:51], v[36:39]
    ds_read_b128 v[64:67], v2 offset:54272
    buffer_load_dwordx4 v1, s[16:19], s42 offen offset:1024 sc1 lds
    v_mfma_f32_16x16x32_bf16 v[40:43], a[196:199], v[48:51], v[40:43]
    ds_read_b128 v[68:71], v2 offset:55296
    v_mfma_f32_16x16x32_bf16 v[32:35], a[196:199], v[44:47], v[32:35]
    ds_read_b128 v[72:75], v2 offset:56320
    v_mfma_f32_16x16x32_bf16 v[28:31], a[200:203], v[52:55], v[28:31]
    v_mfma_f32_16x16x32_bf16 v[36:39], a[200:203], v[56:59], v[36:39]
    v_mfma_f32_16x16x32_bf16 v[40:43], a[204:207], v[56:59], v[40:43]
    buffer_load_dwordx4 v1, s[16:19], s42 offen offset:2048 sc1 lds
    v_mfma_f32_16x16x32_bf16 v[32:35], a[204:207], v[52:55], v[32:35]
    s_waitcnt lgkmcnt(0)
    v_mfma_f32_16x16x32_bf16 v[28:31], a[208:211], v[60:63], v[28:31]
    ds_read_b128 v[44:47], v2 offset:57344
    v_mfma_f32_16x16x32_bf16 v[36:39], a[208:211], v[64:67], v[36:39]
    ds_read_b128 v[48:51], v2 offset:58368
    v_mfma_f32_16x16x32_bf16 v[40:43], a[212:215], v[64:67], v[40:43]
    ds_read_b128 v[52:55], v2 offset:59392
    v_mfma_f32_16x16x32_bf16 v[32:35], a[212:215], v[60:63], v[32:35]
    ds_read_b128 v[56:59], v2 offset:60416
    buffer_load_dwordx4 v1, s[16:19], s42 offen offset:3072 sc1 lds
    v_mfma_f32_16x16x32_bf16 v[28:31], a[216:219], v[68:71], v[28:31]
    s_add_u32 s45, s45, 131072
    v_mfma_f32_16x16x32_bf16 v[36:39], a[216:219], v[72:75], v[36:39]
    v_mfma_f32_16x16x32_bf16 v[40:43], a[220:223], v[72:75], v[40:43]
    s_waitcnt vmcnt(10)
    v_mfma_f32_16x16x32_bf16 v[12:15], v[108:111], v[128:131], 0
    v_mfma_f32_16x16x32_bf16 v[16:19], v[112:115], v[128:131], 0
    v_mfma_f32_16x16x32_bf16 v[20:23], v[108:111], v[132:135], 0
    v_mfma_f32_16x16x32_bf16 v[24:27], v[112:115], v[132:135], 0
    v_mfma_f32_16x16x32_bf16 v[32:35], a[220:223], v[68:71], v[32:35]
    s_waitcnt lgkmcnt(0)
    v_mfma_f32_16x16x32_bf16 v[28:31], a[224:227], v[44:47], v[28:31]
    ds_read_b128 v[60:63], v2 offset:61440
    v_mfma_f32_16x16x32_bf16 v[36:39], a[224:227], v[48:51], v[36:39]
    ds_read_b128 v[64:67], v2 offset:62464
    v_mfma_f32_16x16x32_bf16 v[40:43], a[228:231], v[48:51], v[40:43]
    ds_read_b128 v[68:71], v2 offset:63488
    v_mfma_f32_16x16x32_bf16 v[32:35], a[228:231], v[44:47], v[32:35]
    ds_read_b128 v[72:75], v2 offset:64512
    v_mfma_f32_16x16x32_bf16 v[28:31], a[232:235], v[52:55], v[28:31]
    v_mfma_f32_16x16x32_bf16 v[36:39], a[232:235], v[56:59], v[36:39]
    v_mfma_f32_16x16x32_bf16 v[40:43], a[236:239], v[56:59], v[40:43]
    v_mfma_f32_16x16x32_bf16 v[32:35], a[236:239], v[52:55], v[32:35]
    s_waitcnt vmcnt(4) lgkmcnt(0)
    s_barrier
    v_mfma_f32_16x16x32_bf16 v[28:31], a[240:243], v[60:63], v[28:31]
    ds_read_b128 v[44:47], v1 offset:0
    v_mfma_f32_16x16x32_bf16 v[36:39], a[240:243], v[64:67], v[36:39]
    ds_read_b128 v[48:51], v1 offset:1024
    v_mfma_f32_16x16x32_bf16 v[40:43], a[244:247], v[64:67], v[40:43]
    ds_read_b128 v[52:55], v1 offset:2048
    v_mfma_f32_16x16x32_bf16 v[32:35], a[244:247], v[60:63], v[32:35]
    ds_read_b128 v[56:59], v1 offset:3072
    v_mfma_f32_16x16x32_bf16 v[28:31], a[248:251], v[68:71], v[28:31]
    v_mfma_f32_16x16x32_bf16 v[36:39], a[248:251], v[72:75], v[36:39]
    v_mfma_f32_16x16x32_bf16 v[40:43], a[252:255], v[72:75], v[40:43]
    v_mfma_f32_16x16x32_bf16 v[32:35], a[252:255], v[68:71], v[32:35]
    s_add_u32 s36, s36, 1
    s_cmp_lt_u32 s36, 32
    s_cbranch_scc1 L_o_b0
    s_nop 7
    s_cmp_eq_u32 s36, 0
    s_cselect_b32 s44, 0x8000000, s90
    s_cselect_b32 s49, 0x8000000, s46
    v_cvt_pk_bf16_f32 v28, v28, v29
    v_cvt_pk_bf16_f32 v29, v30, v31
    v_cvt_pk_bf16_f32 v30, v32, v33
    v_cvt_pk_bf16_f32 v31, v34, v35
    buffer_store_dwordx4 v[28:31], v1, s[16:19], s44 offen offset:0 sc1
    v_cvt_pk_bf16_f32 v36, v36, v37
    v_cvt_pk_bf16_f32 v37, v38, v39
    v_cvt_pk_bf16_f32 v38, v40, v41
    v_cvt_pk_bf16_f32 v39, v42, v43
    buffer_store_dwordx4 v[36:39], v1, s[16:19], s44 offen offset:1024 sc1
    v_dot2_f32_bf16 v140, v28, s86, 0
    v_dot2_f32_bf16 v141, v28, v28, 0
    v_dot2_f32_bf16 v140, v29, s86, v140
    v_dot2_f32_bf16 v141, v29, v29, v141
    v_dot2_f32_bf16 v140, v30, s86, v140
    v_dot2_f32_bf16 v141, v30, v30, v141
    v_dot2_f32_bf16 v140, v31, s86, v140
    v_dot2_f32_bf16 v141, v31, v31, v141
    s_nop 2
    v_permlane16_swap_b32 v140, v141
    v_add_f32 v140, v140, v141
    v_mov_b32 v142, v140
    s_nop 1
    v_permlane32_swap_b32 v140, v142
    v_add_f32 v140, v140, v142
    ds_write_b32 v6, v140 offset:1024
    v_dot2_f32_bf16 v144, v36, s86, 0
    v_dot2_f32_bf16 v145, v36, v36, 0
    v_dot2_f32_bf16 v144, v37, s86, v144
    v_dot2_f32_bf16 v145, v37, v37, v145
    v_dot2_f32_bf16 v144, v38, s86, v144
    v_dot2_f32_bf16 v145, v38, v38, v145
    v_dot2_f32_bf16 v144, v39, s86, v144
    v_dot2_f32_bf16 v145, v39, v39, v145
    s_nop 2
    v_permlane16_swap_b32 v144, v145
    v_add_f32 v144, v144, v145
    v_mov_b32 v146, v144
    s_nop 1
    v_permlane32_swap_b32 v144, v146
    v_add_f32 v144, v144, v146
    ds_write_b32 v6, v144 offset:1536
    s_waitcnt lgkmcnt(0)
    s_barrier
    ds_read_b128 v[140:143], v7 offset:1024
    s_waitcnt lgkmcnt(0)
    v_add_f32 v140, v140, v141
    v_add_f32 v142, v142, v143
    v_add_f32 v140, v140, v142
    v_min_u32 v140, -2, v140
    buffer_store_dword v140, v8, s[16:19], s49 offen sc1
    s_add_u32 s90, s90, 65536
    s_add_u32 s46, s46, 2048
    s_waitcnt vmcnt(1)
    s_barrier
    buffer_store_dword v124, v124, s[16:19], s91 offen sc1
    s_add_u32 s91, s91, 131072
    s_waitcnt vmcnt(0)
    s_endpgm
L_spin15:
    s_mov_b32 s40, 0x20000
L_spin15_l:
    buffer_load_dword v13, v12, s[20:23], 0 offen sc1
    s_sub_u32 s40, s40, 1
    s_waitcnt vmcnt(0)
    v_cmp_gt_u32 vcc, 16, v13
    s_cbranch_scc1 L_back16
    s_cbranch_vccz L_back16
    s_sleep 2
    s_branch L_spin15_l
L_spin17:
    s_mov_b32 s40, 0x20000
L_spin17_l:
    buffer_load_dword v136, v4, s[16:19], s45 offen sc1
    s_sub_u32 s40, s40, 1
    s_waitcnt vmcnt(0)
    v_cmp_ne_u32 vcc, 0, v136
    s_cbranch_scc1 L_back18
    s_cbranch_vccz L_back18
    s_sleep 2
    s_branch L_spin17_l
L_spin19:
    s_mov_b32 s40, 0x20000
L_spin19_l:
    buffer_load_dword v136, v4, s[16:19], s45 offen sc1
    s_sub_u32 s40, s40, 1
    s_waitcnt vmcnt(0)
    v_cmp_ne_u32 vcc, 0, v136
    s_cbranch_scc1 L_back20
    s_cbranch_vccz L_back20
    s_sleep 2
    s_branch L_spin19_l
L_spin21:
    s_mov_b32 s40, 0x20000
L_spin21_l:
    buffer_load_dword v136, v4, s[16:19], s45 offen sc1
    s_sub_u32 s40, s40, 1
    s_waitcnt vmcnt(0)
    v_cmp_ne_u32 vcc, 0, v136
    s_cbranch_scc1 L_back22
    s_cbranch_vccz L_back22
    s_sleep 2
    s_branch L_spin21_l
L_role_24:
    s_sub_u32 s35, s34, 24
    s_add_u32 s54, s54, L_role_24-interleave_layers__sliding_local_dilated__dense_activation_squared_relu__prompt_kernel
    buffer_load_dword v252, v7, s[8:11], s54 offen
    s_mov_b32 s86, 0x3f803f80
    s_mov_b32 s8, s64
    s_mov_b32 s9, s65
    s_mov_b32 s10, 0x400000
    s_mov_b32 s11, 0x00020000
    s_min_u32 s46, s35, 15
    s_lshl_b32 s46, s46, 1
    s_lshl_b32 s37, s33, 5
    s_add_u32 s46, s46, s37
    s_add_u32 s46, s46, 0
    s_lshl_b32 s37, s46, 15
    s_lshl_b32 s38, s32, 9
    s_add_u32 s37, s37, s38
    s_add_u32 s38, s37, 16384
    v_lshrrev_b32 v48, 3, v0
    v_and_b32 v49, 7, v0
    v_lshlrev_b32 v49, 4, v49
    v_lshl_add_u32 v48, v48, 11, v49
    buffer_load_dwordx4 v[16:19], v48, s[8:11], s37 offen offset:0
    buffer_load_dwordx4 v[20:23], v48, s[8:11], s37 offen offset:128
    buffer_load_dwordx4 v[24:27], v48, s[8:11], s37 offen offset:256
    buffer_load_dwordx4 v[28:31], v48, s[8:11], s37 offen offset:384
    buffer_load_dwordx4 v[32:35], v48, s[8:11], s38 offen offset:0
    buffer_load_dwordx4 v[36:39], v48, s[8:11], s38 offen offset:128
    buffer_load_dwordx4 v[40:43], v48, s[8:11], s38 offen offset:256
    buffer_load_dwordx4 v[44:47], v48, s[8:11], s38 offen offset:384
    s_waitcnt vmcnt(0)
    v_dot2_f32_bf16 v48, v16, s86, 0
    v_dot2_f32_bf16 v49, v16, v16, 0
    v_dot2_f32_bf16 v48, v17, s86, v48
    v_dot2_f32_bf16 v49, v17, v17, v49
    v_dot2_f32_bf16 v48, v18, s86, v48
    v_dot2_f32_bf16 v49, v18, v18, v49
    v_dot2_f32_bf16 v48, v19, s86, v48
    v_dot2_f32_bf16 v49, v19, v19, v49
    v_dot2_f32_bf16 v48, v20, s86, v48
    v_dot2_f32_bf16 v49, v20, v20, v49
    v_dot2_f32_bf16 v48, v21, s86, v48
    v_dot2_f32_bf16 v49, v21, v21, v49
    v_dot2_f32_bf16 v48, v22, s86, v48
    v_dot2_f32_bf16 v49, v22, v22, v49
    v_dot2_f32_bf16 v48, v23, s86, v48
    v_dot2_f32_bf16 v49, v23, v23, v49
    v_dot2_f32_bf16 v50, v24, s86, 0
    v_dot2_f32_bf16 v51, v24, v24, 0
    v_dot2_f32_bf16 v50, v25, s86, v50
    v_dot2_f32_bf16 v51, v25, v25, v51
    v_dot2_f32_bf16 v50, v26, s86, v50
    v_dot2_f32_bf16 v51, v26, v26, v51
    v_dot2_f32_bf16 v50, v27, s86, v50
    v_dot2_f32_bf16 v51, v27, v27, v51
    v_dot2_f32_bf16 v50, v28, s86, v50
    v_dot2_f32_bf16 v51, v28, v28, v51
    v_dot2_f32_bf16 v50, v29, s86, v50
    v_dot2_f32_bf16 v51, v29, v29, v51
    v_dot2_f32_bf16 v50, v30, s86, v50
    v_dot2_f32_bf16 v51, v30, v30, v51
    v_dot2_f32_bf16 v50, v31, s86, v50
    v_dot2_f32_bf16 v51, v31, v31, v51
    v_dot2_f32_bf16 v52, v32, s86, 0
    v_dot2_f32_bf16 v53, v32, v32, 0
    v_dot2_f32_bf16 v52, v33, s86, v52
    v_dot2_f32_bf16 v53, v33, v33, v53
    v_dot2_f32_bf16 v52, v34, s86, v52
    v_dot2_f32_bf16 v53, v34, v34, v53
    v_dot2_f32_bf16 v52, v35, s86, v52
    v_dot2_f32_bf16 v53, v35, v35, v53
    v_dot2_f32_bf16 v52, v36, s86, v52
    v_dot2_f32_bf16 v53, v36, v36, v53
    v_dot2_f32_bf16 v52, v37, s86, v52
    v_dot2_f32_bf16 v53, v37, v37, v53
    v_dot2_f32_bf16 v52, v38, s86, v52
    v_dot2_f32_bf16 v53, v38, v38, v53
    v_dot2_f32_bf16 v52, v39, s86, v52
    v_dot2_f32_bf16 v53, v39, v39, v53
    v_dot2_f32_bf16 v54, v40, s86, 0
    v_dot2_f32_bf16 v55, v40, v40, 0
    v_dot2_f32_bf16 v54, v41, s86, v54
    v_dot2_f32_bf16 v55, v41, v41, v55
    v_dot2_f32_bf16 v54, v42, s86, v54
    v_dot2_f32_bf16 v55, v42, v42, v55
    v_dot2_f32_bf16 v54, v43, s86, v54
    v_dot2_f32_bf16 v55, v43, v43, v55
    v_dot2_f32_bf16 v54, v44, s86, v54
    v_dot2_f32_bf16 v55, v44, v44, v55
    v_dot2_f32_bf16 v54, v45, s86, v54
    v_dot2_f32_bf16 v55, v45, v45, v55
    v_dot2_f32_bf16 v54, v46, s86, v54
    v_dot2_f32_bf16 v55, v46, v46, v55
    v_dot2_f32_bf16 v54, v47, s86, v54
    v_dot2_f32_bf16 v55, v47, v47, v55
    v_add_f32_dpp v48, v48, v48 quad_perm:[1,0,3,2] row_mask:0xf bank_mask:0xf
    v_add_f32_dpp v49, v49, v49 quad_perm:[1,0,3,2] row_mask:0xf bank_mask:0xf
    v_add_f32_dpp v50, v50, v50 quad_perm:[1,0,3,2] row_mask:0xf bank_mask:0xf
    v_add_f32_dpp v51, v51, v51 quad_perm:[1,0,3,2] row_mask:0xf bank_mask:0xf
    v_add_f32_dpp v52, v52, v52 quad_perm:[1,0,3,2] row_mask:0xf bank_mask:0xf
    v_add_f32_dpp v53, v53, v53 quad_perm:[1,0,3,2] row_mask:0xf bank_mask:0xf
    v_add_f32_dpp v54, v54, v54 quad_perm:[1,0,3,2] row_mask:0xf bank_mask:0xf
    v_add_f32_dpp v55, v55, v55 quad_perm:[1,0,3,2] row_mask:0xf bank_mask:0xf
    v_add_f32_dpp v48, v48, v48 quad_perm:[2,3,0,1] row_mask:0xf bank_mask:0xf
    v_add_f32_dpp v49, v49, v49 quad_perm:[2,3,0,1] row_mask:0xf bank_mask:0xf
    v_add_f32_dpp v50, v50, v50 quad_perm:[2,3,0,1] row_mask:0xf bank_mask:0xf
    v_add_f32_dpp v51, v51, v51 quad_perm:[2,3,0,1] row_mask:0xf bank_mask:0xf
    v_add_f32_dpp v52, v52, v52 quad_perm:[2,3,0,1] row_mask:0xf bank_mask:0xf
    v_add_f32_dpp v53, v53, v53 quad_perm:[2,3,0,1] row_mask:0xf bank_mask:0xf
    v_add_f32_dpp v54, v54, v54 quad_perm:[2,3,0,1] row_mask:0xf bank_mask:0xf
    v_add_f32_dpp v55, v55, v55 quad_perm:[2,3,0,1] row_mask:0xf bank_mask:0xf
    v_add_f32_dpp v48, v48, v48 row_half_mirror row_mask:0xf bank_mask:0xf
    v_add_f32_dpp v49, v49, v49 row_half_mirror row_mask:0xf bank_mask:0xf
    v_add_f32_dpp v50, v50, v50 row_half_mirror row_mask:0xf bank_mask:0xf
    v_add_f32_dpp v51, v51, v51 row_half_mirror row_mask:0xf bank_mask:0xf
    v_add_f32_dpp v52, v52, v52 row_half_mirror row_mask:0xf bank_mask:0xf
    v_add_f32_dpp v53, v53, v53 row_half_mirror row_mask:0xf bank_mask:0xf
    v_add_f32_dpp v54, v54, v54 row_half_mirror row_mask:0xf bank_mask:0xf
    v_add_f32_dpp v55, v55, v55 row_half_mirror row_mask:0xf bank_mask:0xf
    s_mov_b32 exec_lo, 0x2020202
    s_mov_b32 exec_hi, 0x2020202
    v_mov_b32 v48, v50
    v_mov_b32 v49, v51
    s_mov_b32 exec_lo, 0x4040404
    s_mov_b32 exec_hi, 0x4040404
    v_mov_b32 v48, v52
    v_mov_b32 v49, v53
    s_mov_b32 exec_lo, 0x8080808
    s_mov_b32 exec_hi, 0x8080808
    v_mov_b32 v48, v54
    v_mov_b32 v49, v55
    s_mov_b64 exec, -1
    v_min_u32 v48, -2, v48
    v_min_u32 v49, -2, v49
    v_and_b32 v50, 1, v0
    v_lshlrev_b32 v50, 7, v50
    v_bfe_u32 v51, v0, 1, 1
    v_lshl_add_u32 v50, v51, 6, v50
    v_and_b32 v51, 0x38, v0
    v_add_u32 v50, v51, v50
    s_sub_u32 s46, 127, s46
    s_lshl_b32 s46, s46, 10
    s_lshl_b32 s37, s32, 8
    s_add_u32 s46, s46, s37
    s_add_u32 s46, s46, 0x5400000
    s_cmp_lt_u32 s35, 16
    s_cselect_b32 s46, s46, 0x8000000
    s_mov_b32 exec_lo, 0x0f0f0f0f
    s_mov_b32 exec_hi, 0x0f0f0f0f
    buffer_store_dwordx2 v[48:49], v50, s[16:19], s46 offen sc1
    s_mov_b64 exec, -1
    s_mul_i32 s51, s35, 6
    s_min_u32 s51, s51, 106
    s_lshl_b32 s54, s51, 6
    s_mov_b32 s12, s72
    s_mov_b32 s13, s73
    s_mov_b32 s14, 0x700000
    s_mov_b32 s15, 0x00020000
    v_lshrrev_b32 v68, 3, v0
    v_and_b32 v69, 2, v68
    v_lshlrev_b32 v69, 1, v69
    v_and_b32 v70, 7, v0
    v_xor_b32 v69, v69, v70
    v_mul_u32_u24 v68, 7168, v68
    v_lshl_add_u32 v68, v69, 4, v68
    s_mul_i32 s38, s32, 6
    s_add_u32 s39, s38, 0
    s_and_b32 s37, s39, 7
    s_mul_i32 s37, s37, 57344
    s_lshr_b32 s39, s39, 3
    s_mul_i32 s39, s39, 128
    s_add_u32 s39, s39, s37
    v_add_u32 v56, s39, v68
    s_add_u32 s39, s38, 1
    s_and_b32 s37, s39, 7
    s_mul_i32 s37, s37, 57344
    s_lshr_b32 s39, s39, 3
    s_mul_i32 s39, s39, 128
    s_add_u32 s39, s39, s37
    v_add_u32 v57, s39, v68
    s_add_u32 s39, s38, 2
    s_and_b32 s37, s39, 7
    s_mul_i32 s37, s37, 57344
    s_lshr_b32 s39, s39, 3
    s_mul_i32 s39, s39, 128
    s_add_u32 s39, s39, s37
    v_add_u32 v58, s39, v68
    s_add_u32 s39, s38, 3
    s_and_b32 s37, s39, 7
    s_mul_i32 s37, s37, 57344
    s_lshr_b32 s39, s39, 3
    s_mul_i32 s39, s39, 128
    s_add_u32 s39, s39, s37
    v_add_u32 v59, s39, v68
    s_add_u32 s39, s38, 4
    s_and_b32 s37, s39, 7
    s_mul_i32 s37, s37, 57344
    s_lshr_b32 s39, s39, 3
    s_mul_i32 s39, s39, 128
    s_add_u32 s39, s39, s37
    v_add_u32 v60, s39, v68
    s_add_u32 s39, s38, 5
    s_and_b32 s37, s39, 7
    s_mul_i32 s37, s37, 57344
    s_lshr_b32 s39, s39, 3
    s_mul_i32 s39, s39, 128
    s_add_u32 s39, s39, s37
    v_add_u32 v61, s39, v68
    s_mul_i32 s42, s32, 6144
    s_add_u32 m0, s42, 0
    s_nop 0
    buffer_load_dwordx4 v56, s[12:15], s54 offen lds
    s_add_u32 m0, s42, 1024
    s_nop 0
    buffer_load_dwordx4 v57, s[12:15], s54 offen lds
    s_add_u32 m0, s42, 2048
    s_nop 0
    buffer_load_dwordx4 v58, s[12:15], s54 offen lds
    s_add_u32 m0, s42, 3072
    s_nop 0
    buffer_load_dwordx4 v59, s[12:15], s54 offen lds
    s_add_u32 m0, s42, 4096
    s_nop 0
    buffer_load_dwordx4 v60, s[12:15], s54 offen lds
    s_add_u32 m0, s42, 5120
    s_nop 0
    buffer_load_dwordx4 v61, s[12:15], s54 offen lds
    s_add_u32 s54, s54, 458752
    s_add_u32 m0, s42, 24576
    s_nop 0
    buffer_load_dwordx4 v56, s[12:15], s54 offen lds
    s_add_u32 m0, s42, 25600
    s_nop 0
    buffer_load_dwordx4 v57, s[12:15], s54 offen lds
    s_add_u32 m0, s42, 26624
    s_nop 0
    buffer_load_dwordx4 v58, s[12:15], s54 offen lds
    s_add_u32 m0, s42, 27648
    s_nop 0
    buffer_load_dwordx4 v59, s[12:15], s54 offen lds
    s_add_u32 m0, s42, 28672
    s_nop 0
    buffer_load_dwordx4 v60, s[12:15], s54 offen lds
    s_add_u32 m0, s42, 29696
    s_nop 0
    buffer_load_dwordx4 v61, s[12:15], s54 offen lds
    s_add_u32 s54, s54, 458752
    s_add_u32 m0, s42, 49152
    s_nop 0
    buffer_load_dwordx4 v56, s[12:15], s54 offen lds
    s_add_u32 m0, s42, 50176
    s_nop 0
    buffer_load_dwordx4 v57, s[12:15], s54 offen lds
    s_add_u32 m0, s42, 51200
    s_nop 0
    buffer_load_dwordx4 v58, s[12:15], s54 offen lds
    s_add_u32 m0, s42, 52224
    s_nop 0
    buffer_load_dwordx4 v59, s[12:15], s54 offen lds
    s_add_u32 m0, s42, 53248
    s_nop 0
    buffer_load_dwordx4 v60, s[12:15], s54 offen lds
    s_add_u32 m0, s42, 54272
    s_nop 0
    buffer_load_dwordx4 v61, s[12:15], s54 offen lds
    s_add_u32 s54, s54, 458752
    s_add_u32 m0, s42, 73728
    s_nop 0
    buffer_load_dwordx4 v56, s[12:15], s54 offen lds
    s_add_u32 m0, s42, 74752
    s_nop 0
    buffer_load_dwordx4 v57, s[12:15], s54 offen lds
    s_add_u32 m0, s42, 75776
    s_nop 0
    buffer_load_dwordx4 v58, s[12:15], s54 offen lds
    s_add_u32 m0, s42, 76800
    s_nop 0
    buffer_load_dwordx4 v59, s[12:15], s54 offen lds
    s_add_u32 m0, s42, 77824
    s_nop 0
    buffer_load_dwordx4 v60, s[12:15], s54 offen lds
    s_add_u32 m0, s42, 78848
    s_nop 0
    buffer_load_dwordx4 v61, s[12:15], s54 offen lds
    s_add_u32 s54, s54, 458752
    s_add_u32 m0, s42, 98304
    s_nop 0
    buffer_load_dwordx4 v56, s[12:15], s54 offen lds
    s_add_u32 m0, s42, 99328
    s_nop 0
    buffer_load_dwordx4 v57, s[12:15], s54 offen lds
    s_add_u32 m0, s42, 100352
    s_nop 0
    buffer_load_dwordx4 v58, s[12:15], s54 offen lds
    s_add_u32 m0, s42, 101376
    s_nop 0
    buffer_load_dwordx4 v59, s[12:15], s54 offen lds
    s_add_u32 m0, s42, 102400
    s_nop 0
    buffer_load_dwordx4 v60, s[12:15], s54 offen lds
    s_add_u32 m0, s42, 103424
    s_nop 0
    buffer_load_dwordx4 v61, s[12:15], s54 offen lds
    s_add_u32 s54, s54, 458752
    v_lshrrev_b32 v68, 4, v0
    v_bfe_u32 v69, v0, 2, 2
    v_lshl_add_u32 v68, v68, 3, v69
    v_lshlrev_b32 v68, 7, v68
    v_lshrrev_b32 v69, 1, v69
    v_lshl_add_u32 v68, v69, 6, v68
    v_and_b32 v69, 3, v0
    v_lshl_add_u32 v68, v69, 4, v68
    s_lshr_b32 s37, s32, 1
    s_lshl_b32 s37, s37, 13
    s_and_b32 s38, s32, 1
    s_lshl_b32 s38, s38, 6
    s_add_u32 s37, s37, s38
    s_add_u32 s37, s37, 0
    v_xor_b32 v62, s37, v68
    s_lshr_b32 s37, s32, 1
    s_lshl_b32 s37, s37, 13
    s_and_b32 s38, s32, 1
    s_lshl_b32 s38, s38, 6
    s_add_u32 s37, s37, s38
    s_add_u32 s37, s37, 8
    v_xor_b32 v63, s37, v68
    s_lshr_b32 s37, s32, 1
    s_lshl_b32 s37, s37, 6
    s_and_b32 s38, s32, 1
    s_lshl_b32 s38, s38, 3
    s_add_u32 s37, s37, s38
    s_add_u32 s37, s37, 16384
    v_xor_b32 v64, s37, v68
    v_mov_b32 v68, 0x3f803f80
    v_mov_b32 v69, 0x3f803f80
    v_mov_b32 v70, 0x3f803f80
    v_mov_b32 v71, 0x3f803f80
    v_add_u32 v2, 98304, v1
    s_lshl_b32 s37, s33, 6
    s_add_u32 s37, s37, 16
    s_lshl_b32 s37, s37, 8
    v_lshl_add_u32 v5, v0, 8, s37
    s_cmp_eq_u32 s32, 0
    s_cselect_b32 s37, 8, 0
    v_cmp_le_u32 vcc, s37, v0
    s_nop 1
    v_cndmask_b32 v5, v5, 2.0, vcc
    s_lshl_b32 s43, s32, 12
    s_mul_i32 s41, s33, 2097152
    s_add_u32 s41, s41, 0x800000
    s_add_u32 s41, s41, s43
    s_mul_i32 s90, s33, 7340032
    s_add_u32 s90, s90, 0xfc8000
    s_add_u32 s37, s51, s32
    s_lshl_b32 s37, s37, 11
    s_add_u32 s90, s90, s37
    s_lshl_b32 s37, s32, 10
    s_sub_u32 s87, 8192, s37
    s_lshl_b32 s38, s35, 1
    s_lshr_b32 s39, s32, 1
    s_add_u32 s38, s38, s39
    s_cmp_eq_u32 s38, 36
    s_cselect_b32 s88, 0x8000000, 0
    s_and_b32 s38, s32, 1
    s_lshl_b32 s38, s38, 3
    s_and_b32 s39, s32, 2
    s_lshl_b32 s39, s39, 10
    s_add_u32 s38, s38, s39
    s_add_u32 s38, s38, 65536
    v_add_u32 v3, s38, v1
    s_add_u32 s37, s37, 65536
    v_add_u32 v4, s37, v1
    v_and_b32 v6, 15, v0
    v_lshlrev_b32 v6, 3, v6
    v_lshrrev_b32 v8, 5, v0
    v_lshl_add_u32 v6, v8, 9, v6
    v_and_b32 v8, 16, v0
    v_lshl_add_u32 v6, v8, 6, v6
    s_mul_i32 s46, s33, 65536
    s_add_u32 s46, s46, 0x5440000
    s_mov_b32 s8, s74
    s_mov_b32 s9, s75
    s_mov_b32 s10, 0x1c00
    s_mov_b32 s11, 0x00020000
    v_and_b32 v8, 0x30, v0
    s_add_u32 s37, s51, s32
    s_lshl_b32 s37, s37, 6
    buffer_load_dwordx4 v[16:19], v8, s[8:11], s37 offen
    s_lshr_b32 s37, s32, 1
    s_add_u32 s37, s37, s51
    s_lshl_b32 s37, s37, 6
    s_and_b32 s38, s32, 1
    s_lshl_b32 s38, s38, 3
    s_add_u32 s37, s37, s38
    buffer_load_dwordx2 v[20:21], v8, s[8:11], s37 offen offset:256
    v_add_u32 v65, 0, v62
    v_add_u32 v66, 0, v63
    v_add_u32 v67, 0, v64
    s_waitcnt vmcnt(26)
    s_barrier
    s_cmp_lg_u32 s32, 3
    s_cbranch_scc1 L_arr23
    s_mov_b32 s20, s82
    s_mov_b32 s21, s83
    s_mov_b32 s22, 0x100
    s_mov_b32 s23, 0x00020000
    s_and_b32 s37, s2, 15
    s_lshl_b32 s37, s37, 4
    v_mov_b32 v123, 1
    buffer_atomic_add v123, v124, s[20:23], s37 offen
L_arr23:
    ds_read_b64_tr_b16 a[0:1], v65 offset:0
    ds_read_b64_tr_b16 a[2:3], v65 offset:512
    ds_read_b64_tr_b16 a[4:5], v66 offset:0
    ds_read_b64_tr_b16 a[6:7], v66 offset:512
    ds_read_b64_tr_b16 a[8:9], v67 offset:0
    ds_read_b64_tr_b16 a[10:11], v67 offset:512
    ds_read_b64_tr_b16 a[12:13], v65 offset:4096
    ds_read_b64_tr_b16 a[14:15], v65 offset:4608
    ds_read_b64_tr_b16 a[16:17], v66 offset:4096
    ds_read_b64_tr_b16 a[18:19], v66 offset:4608
    ds_read_b64_tr_b16 a[20:21], v67 offset:4096
    ds_read_b64_tr_b16 a[22:23], v67 offset:4608
    s_add_u32 m0, s42, 122880
    s_nop 0
    buffer_load_dwordx4 v56, s[12:15], s54 offen lds
    s_add_u32 m0, s42, 123904
    s_nop 0
    buffer_load_dwordx4 v57, s[12:15], s54 offen lds
    s_add_u32 m0, s42, 124928
    s_nop 0
    buffer_load_dwordx4 v58, s[12:15], s54 offen lds
    s_add_u32 m0, s42, 125952
    s_nop 0
    buffer_load_dwordx4 v59, s[12:15], s54 offen lds
    s_add_u32 m0, s42, 126976
    s_nop 0
    buffer_load_dwordx4 v60, s[12:15], s54 offen lds
    s_add_u32 m0, s42, 128000
    s_nop 0
    buffer_load_dwordx4 v61, s[12:15], s54 offen lds
    s_add_u32 s54, s54, 458752
    s_waitcnt lgkmcnt(0)
    v_mfma_f32_16x16x32_bf16 v[88:91], a[0:3], v[68:71], 0
    v_mfma_f32_16x16x32_bf16 v[92:95], a[4:7], v[68:71], 0
    v_mfma_f32_16x16x32_bf16 v[96:99], a[8:11], v[68:71], 0
    v_mfma_f32_16x16x32_bf16 v[88:91], a[12:15], v[68:71], v[88:91]
    v_mfma_f32_16x16x32_bf16 v[92:95], a[16:19], v[68:71], v[92:95]
    v_mfma_f32_16x16x32_bf16 v[96:99], a[20:23], v[68:71], v[96:99]
    v_add_u32 v65, 24576, v62
    v_add_u32 v66, 24576, v63
    v_add_u32 v67, 24576, v64
    s_waitcnt vmcnt(26)
    s_barrier
    ds_read_b64_tr_b16 a[24:25], v65 offset:0
    ds_read_b64_tr_b16 a[26:27], v65 offset:512
    ds_read_b64_tr_b16 a[28:29], v66 offset:0
    ds_read_b64_tr_b16 a[30:31], v66 offset:512
    ds_read_b64_tr_b16 a[32:33], v67 offset:0
    ds_read_b64_tr_b16 a[34:35], v67 offset:512
    ds_read_b64_tr_b16 a[36:37], v65 offset:4096
    ds_read_b64_tr_b16 a[38:39], v65 offset:4608
    ds_read_b64_tr_b16 a[40:41], v66 offset:4096
    ds_read_b64_tr_b16 a[42:43], v66 offset:4608
    ds_read_b64_tr_b16 a[44:45], v67 offset:4096
    ds_read_b64_tr_b16 a[46:47], v67 offset:4608
    s_add_u32 m0, s42, 0
    s_nop 0
    buffer_load_dwordx4 v56, s[12:15], s54 offen lds
    s_add_u32 m0, s42, 1024
    s_nop 0
    buffer_load_dwordx4 v57, s[12:15], s54 offen lds
    s_add_u32 m0, s42, 2048
    s_nop 0
    buffer_load_dwordx4 v58, s[12:15], s54 offen lds
    s_add_u32 m0, s42, 3072
    s_nop 0
    buffer_load_dwordx4 v59, s[12:15], s54 offen lds
    s_add_u32 m0, s42, 4096
    s_nop 0
    buffer_load_dwordx4 v60, s[12:15], s54 offen lds
    s_add_u32 m0, s42, 5120
    s_nop 0
    buffer_load_dwordx4 v61, s[12:15], s54 offen lds
    s_add_u32 s54, s54, 458752
    s_waitcnt lgkmcnt(0)
    v_mfma_f32_16x16x32_bf16 v[88:91], a[24:27], v[68:71], v[88:91]
    v_mfma_f32_16x16x32_bf16 v[92:95], a[28:31], v[68:71], v[92:95]
    v_mfma_f32_16x16x32_bf16 v[96:99], a[32:35], v[68:71], v[96:99]
    v_mfma_f32_16x16x32_bf16 v[88:91], a[36:39], v[68:71], v[88:91]
    v_mfma_f32_16x16x32_bf16 v[92:95], a[40:43], v[68:71], v[92:95]
    v_mfma_f32_16x16x32_bf16 v[96:99], a[44:47], v[68:71], v[96:99]
    v_add_u32 v65, 49152, v62
    v_add_u32 v66, 49152, v63
    v_add_u32 v67, 49152, v64
    s_waitcnt vmcnt(26)
    s_barrier
    ds_read_b64_tr_b16 a[48:49], v65 offset:0
    ds_read_b64_tr_b16 a[50:51], v65 offset:512
    ds_read_b64_tr_b16 a[52:53], v66 offset:0
    ds_read_b64_tr_b16 a[54:55], v66 offset:512
    ds_read_b64_tr_b16 a[56:57], v67 offset:0
    ds_read_b64_tr_b16 a[58:59], v67 offset:512
    ds_read_b64_tr_b16 a[60:61], v65 offset:4096
    ds_read_b64_tr_b16 a[62:63], v65 offset:4608
    ds_read_b64_tr_b16 a[64:65], v66 offset:4096
    ds_read_b64_tr_b16 a[66:67], v66 offset:4608
    ds_read_b64_tr_b16 a[68:69], v67 offset:4096
    ds_read_b64_tr_b16 a[70:71], v67 offset:4608
    s_add_u32 m0, s42, 24576
    s_nop 0
    buffer_load_dwordx4 v56, s[12:15], s54 offen lds
    s_add_u32 m0, s42, 25600
    s_nop 0
    buffer_load_dwordx4 v57, s[12:15], s54 offen lds
    s_add_u32 m0, s42, 26624
    s_nop 0
    buffer_load_dwordx4 v58, s[12:15], s54 offen lds
    s_add_u32 m0, s42, 27648
    s_nop 0
    buffer_load_dwordx4 v59, s[12:15], s54 offen lds
    s_add_u32 m0, s42, 28672
    s_nop 0
    buffer_load_dwordx4 v60, s[12:15], s54 offen lds
    s_add_u32 m0, s42, 29696
    s_nop 0
    buffer_load_dwordx4 v61, s[12:15], s54 offen lds
    s_add_u32 s54, s54, 458752
    s_waitcnt lgkmcnt(0)
    v_mfma_f32_16x16x32_bf16 v[88:91], a[48:51], v[68:71], v[88:91]
    v_mfma_f32_16x16x32_bf16 v[92:95], a[52:55], v[68:71], v[92:95]
    v_mfma_f32_16x16x32_bf16 v[96:99], a[56:59], v[68:71], v[96:99]
    v_mfma_f32_16x16x32_bf16 v[88:91], a[60:63], v[68:71], v[88:91]
    v_mfma_f32_16x16x32_bf16 v[92:95], a[64:67], v[68:71], v[92:95]
    v_mfma_f32_16x16x32_bf16 v[96:99], a[68:71], v[68:71], v[96:99]
    v_add_u32 v65, 73728, v62
    v_add_u32 v66, 73728, v63
    v_add_u32 v67, 73728, v64
    s_waitcnt vmcnt(26)
    s_barrier
    ds_read_b64_tr_b16 a[72:73], v65 offset:0
    ds_read_b64_tr_b16 a[74:75], v65 offset:512
    ds_read_b64_tr_b16 a[76:77], v66 offset:0
    ds_read_b64_tr_b16 a[78:79], v66 offset:512
    ds_read_b64_tr_b16 a[80:81], v67 offset:0
    ds_read_b64_tr_b16 a[82:83], v67 offset:512
    ds_read_b64_tr_b16 a[84:85], v65 offset:4096
    ds_read_b64_tr_b16 a[86:87], v65 offset:4608
    ds_read_b64_tr_b16 a[88:89], v66 offset:4096
    ds_read_b64_tr_b16 a[90:91], v66 offset:4608
    ds_read_b64_tr_b16 a[92:93], v67 offset:4096
    ds_read_b64_tr_b16 a[94:95], v67 offset:4608
    s_add_u32 m0, s42, 49152
    s_nop 0
    buffer_load_dwordx4 v56, s[12:15], s54 offen lds
    s_add_u32 m0, s42, 50176
    s_nop 0
    buffer_load_dwordx4 v57, s[12:15], s54 offen lds
    s_add_u32 m0, s42, 51200
    s_nop 0
    buffer_load_dwordx4 v58, s[12:15], s54 offen lds
    s_add_u32 m0, s42, 52224
    s_nop 0
    buffer_load_dwordx4 v59, s[12:15], s54 offen lds
    s_add_u32 m0, s42, 53248
    s_nop 0
    buffer_load_dwordx4 v60, s[12:15], s54 offen lds
    s_add_u32 m0, s42, 54272
    s_nop 0
    buffer_load_dwordx4 v61, s[12:15], s54 offen lds
    s_add_u32 s54, s54, 458752
    s_waitcnt lgkmcnt(0)
    v_mfma_f32_16x16x32_bf16 v[88:91], a[72:75], v[68:71], v[88:91]
    v_mfma_f32_16x16x32_bf16 v[92:95], a[76:79], v[68:71], v[92:95]
    v_mfma_f32_16x16x32_bf16 v[96:99], a[80:83], v[68:71], v[96:99]
    v_mfma_f32_16x16x32_bf16 v[88:91], a[84:87], v[68:71], v[88:91]
    v_mfma_f32_16x16x32_bf16 v[92:95], a[88:91], v[68:71], v[92:95]
    v_mfma_f32_16x16x32_bf16 v[96:99], a[92:95], v[68:71], v[96:99]
    v_add_u32 v65, 98304, v62
    v_add_u32 v66, 98304, v63
    v_add_u32 v67, 98304, v64
    s_waitcnt vmcnt(26)
    s_barrier
    ds_read_b64_tr_b16 a[96:97], v65 offset:0
    ds_read_b64_tr_b16 a[98:99], v65 offset:512
    ds_read_b64_tr_b16 a[100:101], v66 offset:0
    ds_read_b64_tr_b16 a[102:103], v66 offset:512
    ds_read_b64_tr_b16 a[104:105], v67 offset:0
    ds_read_b64_tr_b16 a[106:107], v67 offset:512
    ds_read_b64_tr_b16 a[108:109], v65 offset:4096
    ds_read_b64_tr_b16 a[110:111], v65 offset:4608
    ds_read_b64_tr_b16 a[112:113], v66 offset:4096
    ds_read_b64_tr_b16 a[114:115], v66 offset:4608
    ds_read_b64_tr_b16 a[116:117], v67 offset:4096
    ds_read_b64_tr_b16 a[118:119], v67 offset:4608
    s_add_u32 m0, s42, 73728
    s_nop 0
    buffer_load_dwordx4 v56, s[12:15], s54 offen lds
    s_add_u32 m0, s42, 74752
    s_nop 0
    buffer_load_dwordx4 v57, s[12:15], s54 offen lds
    s_add_u32 m0, s42, 75776
    s_nop 0
    buffer_load_dwordx4 v58, s[12:15], s54 offen lds
    s_add_u32 m0, s42, 76800
    s_nop 0
    buffer_load_dwordx4 v59, s[12:15], s54 offen lds
    s_add_u32 m0, s42, 77824
    s_nop 0
    buffer_load_dwordx4 v60, s[12:15], s54 offen lds
    s_add_u32 m0, s42, 78848
    s_nop 0
    buffer_load_dwordx4 v61, s[12:15], s54 offen lds
    s_add_u32 s54, s54, 458752
    s_waitcnt lgkmcnt(0)
    v_mfma_f32_16x16x32_bf16 v[88:91], a[96:99], v[68:71], v[88:91]
    v_mfma_f32_16x16x32_bf16 v[92:95], a[100:103], v[68:71], v[92:95]
    v_mfma_f32_16x16x32_bf16 v[96:99], a[104:107], v[68:71], v[96:99]
    v_mfma_f32_16x16x32_bf16 v[88:91], a[108:111], v[68:71], v[88:91]
    v_mfma_f32_16x16x32_bf16 v[92:95], a[112:115], v[68:71], v[92:95]
    v_mfma_f32_16x16x32_bf16 v[96:99], a[116:119], v[68:71], v[96:99]
    v_add_u32 v65, 122880, v62
    v_add_u32 v66, 122880, v63
    v_add_u32 v67, 122880, v64
    s_waitcnt vmcnt(24)
    s_barrier
    ds_read_b64_tr_b16 a[120:121], v65 offset:0
    ds_read_b64_tr_b16 a[122:123], v65 offset:512
    ds_read_b64_tr_b16 a[124:125], v66 offset:0
    ds_read_b64_tr_b16 a[126:127], v66 offset:512
    ds_read_b64_tr_b16 a[128:129], v67 offset:0
    ds_read_b64_tr_b16 a[130:131], v67 offset:512
    ds_read_b64_tr_b16 a[132:133], v65 offset:4096
    ds_read_b64_tr_b16 a[134:135], v65 offset:4608
    ds_read_b64_tr_b16 a[136:137], v66 offset:4096
    ds_read_b64_tr_b16 a[138:139], v66 offset:4608
    ds_read_b64_tr_b16 a[140:141], v67 offset:4096
    ds_read_b64_tr_b16 a[142:143], v67 offset:4608
    s_add_u32 m0, s42, 98304
    s_nop 0
    buffer_load_dwordx4 v56, s[12:15], s54 offen lds
    s_add_u32 m0, s42, 99328
    s_nop 0
    buffer_load_dwordx4 v57, s[12:15], s54 offen lds
    s_add_u32 m0, s42, 100352
    s_nop 0
    buffer_load_dwordx4 v58, s[12:15], s54 offen lds
    s_add_u32 m0, s42, 101376
    s_nop 0
    buffer_load_dwordx4 v59, s[12:15], s54 offen lds
    s_add_u32 m0, s42, 102400
    s_nop 0
    buffer_load_dwordx4 v60, s[12:15], s54 offen lds
    s_add_u32 m0, s42, 103424
    s_nop 0
    buffer_load_dwordx4 v61, s[12:15], s54 offen lds
    s_add_u32 s54, s54, 458752
    s_waitcnt lgkmcnt(0)
    v_mfma_f32_16x16x32_bf16 v[88:91], a[120:123], v[68:71], v[88:91]
    v_mfma_f32_16x16x32_bf16 v[92:95], a[124:127], v[68:71], v[92:95]
    v_mfma_f32_16x16x32_bf16 v[96:99], a[128:131], v[68:71], v[96:99]
    v_mfma_f32_16x16x32_bf16 v[88:91], a[132:135], v[68:71], v[88:91]
    v_mfma_f32_16x16x32_bf16 v[92:95], a[136:139], v[68:71], v[92:95]
    v_mfma_f32_16x16x32_bf16 v[96:99], a[140:143], v[68:71], v[96:99]
    v_add_u32 v65, 0, v62
    v_add_u32 v66, 0, v63
    v_add_u32 v67, 0, v64
    s_waitcnt vmcnt(24)
    s_barrier
    ds_read_b64_tr_b16 a[144:145], v65 offset:0
    ds_read_b64_tr_b16 a[146:147], v65 offset:512
    ds_read_b64_tr_b16 a[148:149], v66 offset:0
    ds_read_b64_tr_b16 a[150:151], v66 offset:512
    ds_read_b64_tr_b16 a[152:153], v67 offset:0
    ds_read_b64_tr_b16 a[154:155], v67 offset:512
    ds_read_b64_tr_b16 a[156:157], v65 offset:4096
    ds_read_b64_tr_b16 a[158:159], v65 offset:4608
    ds_read_b64_tr_b16 a[160:161], v66 offset:4096
    ds_read_b64_tr_b16 a[162:163], v66 offset:4608
    ds_read_b64_tr_b16 a[164:165], v67 offset:4096
    ds_read_b64_tr_b16 a[166:167], v67 offset:4608
    s_add_u32 m0, s42, 122880
    s_nop 0
    buffer_load_dwordx4 v56, s[12:15], s54 offen lds
    s_add_u32 m0, s42, 123904
    s_nop 0
    buffer_load_dwordx4 v57, s[12:15], s54 offen lds
    s_add_u32 m0, s42, 124928
    s_nop 0
    buffer_load_dwordx4 v58, s[12:15], s54 offen lds
    s_add_u32 m0, s42, 125952
    s_nop 0
    buffer_load_dwordx4 v59, s[12:15], s54 offen lds
    s_add_u32 m0, s42, 126976
    s_nop 0
    buffer_load_dwordx4 v60, s[12:15], s54 offen lds
    s_add_u32 m0, s42, 128000
    s_nop 0
    buffer_load_dwordx4 v61, s[12:15], s54 offen lds
    s_add_u32 s54, s54, 458752
    s_waitcnt lgkmcnt(0)
    v_mfma_f32_16x16x32_bf16 v[88:91], a[144:147], v[68:71], v[88:91]
    v_mfma_f32_16x16x32_bf16 v[92:95], a[148:151], v[68:71], v[92:95]
    v_mfma_f32_16x16x32_bf16 v[96:99], a[152:155], v[68:71], v[96:99]
    v_mfma_f32_16x16x32_bf16 v[88:91], a[156:159], v[68:71], v[88:91]
    v_mfma_f32_16x16x32_bf16 v[92:95], a[160:163], v[68:71], v[92:95]
    v_mfma_f32_16x16x32_bf16 v[96:99], a[164:167], v[68:71], v[96:99]
    v_add_u32 v65, 24576, v62
    v_add_u32 v66, 24576, v63
    v_add_u32 v67, 24576, v64
    s_waitcnt vmcnt(24)
    s_barrier
    ds_read_b64_tr_b16 a[168:169], v65 offset:0
    ds_read_b64_tr_b16 a[170:171], v65 offset:512
    ds_read_b64_tr_b16 a[172:173], v66 offset:0
    ds_read_b64_tr_b16 a[174:175], v66 offset:512
    ds_read_b64_tr_b16 a[176:177], v67 offset:0
    ds_read_b64_tr_b16 a[178:179], v67 offset:512
    ds_read_b64_tr_b16 a[180:181], v65 offset:4096
    ds_read_b64_tr_b16 a[182:183], v65 offset:4608
    ds_read_b64_tr_b16 a[184:185], v66 offset:4096
    ds_read_b64_tr_b16 a[186:187], v66 offset:4608
    ds_read_b64_tr_b16 a[188:189], v67 offset:4096
    ds_read_b64_tr_b16 a[190:191], v67 offset:4608
    s_add_u32 m0, s42, 0
    s_nop 0
    buffer_load_dwordx4 v56, s[12:15], s54 offen lds
    s_add_u32 m0, s42, 1024
    s_nop 0
    buffer_load_dwordx4 v57, s[12:15], s54 offen lds
    s_add_u32 m0, s42, 2048
    s_nop 0
    buffer_load_dwordx4 v58, s[12:15], s54 offen lds
    s_add_u32 m0, s42, 3072
    s_nop 0
    buffer_load_dwordx4 v59, s[12:15], s54 offen lds
    s_add_u32 m0, s42, 4096
    s_nop 0
    buffer_load_dwordx4 v60, s[12:15], s54 offen lds
    s_add_u32 m0, s42, 5120
    s_nop 0
    buffer_load_dwordx4 v61, s[12:15], s54 offen lds
    s_add_u32 s54, s54, 458752
    s_waitcnt lgkmcnt(0)
    v_mfma_f32_16x16x32_bf16 v[88:91], a[168:171], v[68:71], v[88:91]
    v_mfma_f32_16x16x32_bf16 v[92:95], a[172:175], v[68:71], v[92:95]
    v_mfma_f32_16x16x32_bf16 v[96:99], a[176:179], v[68:71], v[96:99]
    v_mfma_f32_16x16x32_bf16 v[88:91], a[180:183], v[68:71], v[88:91]
    v_mfma_f32_16x16x32_bf16 v[92:95], a[184:187], v[68:71], v[92:95]
    v_mfma_f32_16x16x32_bf16 v[96:99], a[188:191], v[68:71], v[96:99]
    v_add_u32 v65, 49152, v62
    v_add_u32 v66, 49152, v63
    v_add_u32 v67, 49152, v64
    s_waitcnt vmcnt(24)
    s_barrier
    ds_read_b64_tr_b16 a[192:193], v65 offset:0
    ds_read_b64_tr_b16 a[194:195], v65 offset:512
    ds_read_b64_tr_b16 a[196:197], v66 offset:0
    ds_read_b64_tr_b16 a[198:199], v66 offset:512
    ds_read_b64_tr_b16 a[200:201], v67 offset:0
    ds_read_b64_tr_b16 a[202:203], v67 offset:512
    ds_read_b64_tr_b16 a[204:205], v65 offset:4096
    ds_read_b64_tr_b16 a[206:207], v65 offset:4608
    ds_read_b64_tr_b16 a[208:209], v66 offset:4096
    ds_read_b64_tr_b16 a[210:211], v66 offset:4608
    ds_read_b64_tr_b16 a[212:213], v67 offset:4096
    ds_read_b64_tr_b16 a[214:215], v67 offset:4608
    s_add_u32 m0, s42, 24576
    s_nop 0
    buffer_load_dwordx4 v56, s[12:15], s54 offen lds
    s_add_u32 m0, s42, 25600
    s_nop 0
    buffer_load_dwordx4 v57, s[12:15], s54 offen lds
    s_add_u32 m0, s42, 26624
    s_nop 0
    buffer_load_dwordx4 v58, s[12:15], s54 offen lds
    s_add_u32 m0, s42, 27648
    s_nop 0
    buffer_load_dwordx4 v59, s[12:15], s54 offen lds
    s_add_u32 m0, s42, 28672
    s_nop 0
    buffer_load_dwordx4 v60, s[12:15], s54 offen lds
    s_add_u32 m0, s42, 29696
    s_nop 0
    buffer_load_dwordx4 v61, s[12:15], s54 offen lds
    s_add_u32 s54, s54, 458752
    s_waitcnt lgkmcnt(0)
    v_mfma_f32_16x16x32_bf16 v[88:91], a[192:195], v[68:71], v[88:91]
    v_mfma_f32_16x16x32_bf16 v[92:95], a[196:199], v[68:71], v[92:95]
    v_mfma_f32_16x16x32_bf16 v[96:99], a[200:203], v[68:71], v[96:99]
    v_mfma_f32_16x16x32_bf16 v[88:91], a[204:207], v[68:71], v[88:91]
    v_mfma_f32_16x16x32_bf16 v[92:95], a[208:211], v[68:71], v[92:95]
    v_mfma_f32_16x16x32_bf16 v[96:99], a[212:215], v[68:71], v[96:99]
    v_add_u32 v65, 73728, v62
    v_add_u32 v66, 73728, v63
    v_add_u32 v67, 73728, v64
    s_waitcnt vmcnt(24)
    s_barrier
    ds_read_b64_tr_b16 a[216:217], v65 offset:0
    ds_read_b64_tr_b16 a[218:219], v65 offset:512
    ds_read_b64_tr_b16 a[220:221], v66 offset:0
    ds_read_b64_tr_b16 a[222:223], v66 offset:512
    ds_read_b64_tr_b16 a[224:225], v67 offset:0
    ds_read_b64_tr_b16 a[226:227], v67 offset:512
    ds_read_b64_tr_b16 a[228:229], v65 offset:4096
    ds_read_b64_tr_b16 a[230:231], v65 offset:4608
    ds_read_b64_tr_b16 a[232:233], v66 offset:4096
    ds_read_b64_tr_b16 a[234:235], v66 offset:4608
    ds_read_b64_tr_b16 a[236:237], v67 offset:4096
    ds_read_b64_tr_b16 a[238:239], v67 offset:4608
    s_add_u32 m0, s42, 49152
    s_nop 0
    buffer_load_dwordx4 v56, s[12:15], s54 offen lds
    s_add_u32 m0, s42, 50176
    s_nop 0
    buffer_load_dwordx4 v57, s[12:15], s54 offen lds
    s_add_u32 m0, s42, 51200
    s_nop 0
    buffer_load_dwordx4 v58, s[12:15], s54 offen lds
    s_add_u32 m0, s42, 52224
    s_nop 0
    buffer_load_dwordx4 v59, s[12:15], s54 offen lds
    s_add_u32 m0, s42, 53248
    s_nop 0
    buffer_load_dwordx4 v60, s[12:15], s54 offen lds
    s_add_u32 m0, s42, 54272
    s_nop 0
    buffer_load_dwordx4 v61, s[12:15], s54 offen lds
    s_add_u32 s54, s54, 458752
    s_waitcnt lgkmcnt(0)
    v_mfma_f32_16x16x32_bf16 v[88:91], a[216:219], v[68:71], v[88:91]
    v_mfma_f32_16x16x32_bf16 v[92:95], a[220:223], v[68:71], v[92:95]
    v_mfma_f32_16x16x32_bf16 v[96:99], a[224:227], v[68:71], v[96:99]
    v_mfma_f32_16x16x32_bf16 v[88:91], a[228:231], v[68:71], v[88:91]
    v_mfma_f32_16x16x32_bf16 v[92:95], a[232:235], v[68:71], v[92:95]
    v_mfma_f32_16x16x32_bf16 v[96:99], a[236:239], v[68:71], v[96:99]
    v_add_u32 v65, 98304, v62
    v_add_u32 v66, 98304, v63
    v_add_u32 v67, 98304, v64
    s_waitcnt vmcnt(24)
    s_barrier
    ds_read_b64_tr_b16 a[240:241], v65 offset:0
    ds_read_b64_tr_b16 a[242:243], v65 offset:512
    ds_read_b64_tr_b16 a[244:245], v66 offset:0
    ds_read_b64_tr_b16 a[246:247], v66 offset:512
    ds_read_b64_tr_b16 a[248:249], v67 offset:0
    ds_read_b64_tr_b16 a[250:251], v67 offset:512
    ds_read_b64_tr_b16 a[252:253], v65 offset:4096
    ds_read_b64_tr_b16 a[254:255], v65 offset:4608
    ds_read_b64_tr_b16 v[128:129], v66 offset:4096
    ds_read_b64_tr_b16 v[130:131], v66 offset:4608
    ds_read_b64_tr_b16 v[132:133], v67 offset:4096
    ds_read_b64_tr_b16 v[134:135], v67 offset:4608
    s_add_u32 m0, s42, 73728
    s_nop 0
    buffer_load_dwordx4 v56, s[12:15], s54 offen lds
    s_add_u32 m0, s42, 74752
    s_nop 0
    buffer_load_dwordx4 v57, s[12:15], s54 offen lds
    s_add_u32 m0, s42, 75776
    s_nop 0
    buffer_load_dwordx4 v58, s[12:15], s54 offen lds
    s_add_u32 m0, s42, 76800
    s_nop 0
    buffer_load_dwordx4 v59, s[12:15], s54 offen lds
    s_add_u32 m0, s42, 77824
    s_nop 0
    buffer_load_dwordx4 v60, s[12:15], s54 offen lds
    s_add_u32 m0, s42, 78848
    s_nop 0
    buffer_load_dwordx4 v61, s[12:15], s54 offen lds
    s_add_u32 s54, s54, 458752
    s_waitcnt lgkmcnt(0)
    v_mfma_f32_16x16x32_bf16 v[88:91], a[240:243], v[68:71], v[88:91]
    v_mfma_f32_16x16x32_bf16 v[92:95], a[244:247], v[68:71], v[92:95]
    v_mfma_f32_16x16x32_bf16 v[96:99], a[248:251], v[68:71], v[96:99]
    v_mfma_f32_16x16x32_bf16 v[88:91], a[252:255], v[68:71], v[88:91]
    v_mfma_f32_16x16x32_bf16 v[92:95], v[128:131], v[68:71], v[92:95]
    v_mfma_f32_16x16x32_bf16 v[96:99], v[132:135], v[68:71], v[96:99]
    v_add_u32 v65, 122880, v62
    v_add_u32 v66, 122880, v63
    v_add_u32 v67, 122880, v64
    s_waitcnt vmcnt(24)
    s_barrier
    ds_read_b64_tr_b16 v[136:137], v65 offset:0
    ds_read_b64_tr_b16 v[138:139], v65 offset:512
    ds_read_b64_tr_b16 v[140:141], v66 offset:0
    ds_read_b64_tr_b16 v[142:143], v66 offset:512
    ds_read_b64_tr_b16 v[144:145], v67 offset:0
    ds_read_b64_tr_b16 v[146:147], v67 offset:512
    ds_read_b64_tr_b16 v[148:149], v65 offset:4096
    ds_read_b64_tr_b16 v[150:151], v65 offset:4608
    ds_read_b64_tr_b16 v[152:153], v66 offset:4096
    ds_read_b64_tr_b16 v[154:155], v66 offset:4608
    ds_read_b64_tr_b16 v[156:157], v67 offset:4096
    ds_read_b64_tr_b16 v[158:159], v67 offset:4608
    s_waitcnt lgkmcnt(0)
    v_mfma_f32_16x16x32_bf16 v[88:91], v[136:139], v[68:71], v[88:91]
    v_mfma_f32_16x16x32_bf16 v[92:95], v[140:143], v[68:71], v[92:95]
    v_mfma_f32_16x16x32_bf16 v[96:99], v[144:147], v[68:71], v[96:99]
    v_mfma_f32_16x16x32_bf16 v[88:91], v[148:151], v[68:71], v[88:91]
    v_mfma_f32_16x16x32_bf16 v[92:95], v[152:155], v[68:71], v[92:95]
    v_mfma_f32_16x16x32_bf16 v[96:99], v[156:159], v[68:71], v[96:99]
    v_add_u32 v65, 0, v62
    v_add_u32 v66, 0, v63
    v_add_u32 v67, 0, v64
    s_waitcnt vmcnt(18)
    s_barrier
    ds_read_b64_tr_b16 v[160:161], v65 offset:0
    ds_read_b64_tr_b16 v[162:163], v65 offset:512
    ds_read_b64_tr_b16 v[164:165], v66 offset:0
    ds_read_b64_tr_b16 v[166:167], v66 offset:512
    ds_read_b64_tr_b16 v[168:169], v67 offset:0
    ds_read_b64_tr_b16 v[170:171], v67 offset:512
    ds_read_b64_tr_b16 v[172:173], v65 offset:4096
    ds_read_b64_tr_b16 v[174:175], v65 offset:4608
    ds_read_b64_tr_b16 v[176:177], v66 offset:4096
    ds_read_b64_tr_b16 v[178:179], v66 offset:4608
    ds_read_b64_tr_b16 v[180:181], v67 offset:4096
    ds_read_b64_tr_b16 v[182:183], v67 offset:4608
    s_waitcnt lgkmcnt(0)
    v_mfma_f32_16x16x32_bf16 v[88:91], v[160:163], v[68:71], v[88:91]
    v_mfma_f32_16x16x32_bf16 v[92:95], v[164:167], v[68:71], v[92:95]
    v_mfma_f32_16x16x32_bf16 v[96:99], v[168:171], v[68:71], v[96:99]
    v_mfma_f32_16x16x32_bf16 v[88:91], v[172:175], v[68:71], v[88:91]
    v_mfma_f32_16x16x32_bf16 v[92:95], v[176:179], v[68:71], v[92:95]
    v_mfma_f32_16x16x32_bf16 v[96:99], v[180:183], v[68:71], v[96:99]
    v_add_u32 v65, 24576, v62
    v_add_u32 v66, 24576, v63
    v_add_u32 v67, 24576, v64
    s_waitcnt vmcnt(12)
    s_barrier
    ds_read_b64_tr_b16 v[184:185], v65 offset:0
    ds_read_b64_tr_b16 v[186:187], v65 offset:512
    ds_read_b64_tr_b16 v[188:189], v66 offset:0
    ds_read_b64_tr_b16 v[190:191], v66 offset:512
    ds_read_b64_tr_b16 v[192:193], v67 offset:0
    ds_read_b64_tr_b16 v[194:195], v67 offset:512
    ds_read_b64_tr_b16 v[196:197], v65 offset:4096
    ds_read_b64_tr_b16 v[198:199], v65 offset:4608
    ds_read_b64_tr_b16 v[200:201], v66 offset:4096
    ds_read_b64_tr_b16 v[202:203], v66 offset:4608
    ds_read_b64_tr_b16 v[204:205], v67 offset:4096
    ds_read_b64_tr_b16 v[206:207], v67 offset:4608
    s_waitcnt lgkmcnt(0)
    v_mfma_f32_16x16x32_bf16 v[88:91], v[184:187], v[68:71], v[88:91]
    v_mfma_f32_16x16x32_bf16 v[92:95], v[188:191], v[68:71], v[92:95]
    v_mfma_f32_16x16x32_bf16 v[96:99], v[192:195], v[68:71], v[96:99]
    v_mfma_f32_16x16x32_bf16 v[88:91], v[196:199], v[68:71], v[88:91]
    v_mfma_f32_16x16x32_bf16 v[92:95], v[200:203], v[68:71], v[92:95]
    v_mfma_f32_16x16x32_bf16 v[96:99], v[204:207], v[68:71], v[96:99]
    v_add_u32 v65, 49152, v62
    v_add_u32 v66, 49152, v63
    v_add_u32 v67, 49152, v64
    s_waitcnt vmcnt(6)
    s_barrier
    ds_read_b64_tr_b16 v[208:209], v65 offset:0
    ds_read_b64_tr_b16 v[210:211], v65 offset:512
    ds_read_b64_tr_b16 v[212:213], v66 offset:0
    ds_read_b64_tr_b16 v[214:215], v66 offset:512
    ds_read_b64_tr_b16 v[216:217], v67 offset:0
    ds_read_b64_tr_b16 v[218:219], v67 offset:512
    ds_read_b64_tr_b16 v[220:221], v65 offset:4096
    ds_read_b64_tr_b16 v[222:223], v65 offset:4608
    ds_read_b64_tr_b16 v[224:225], v66 offset:4096
    ds_read_b64_tr_b16 v[226:227], v66 offset:4608
    ds_read_b64_tr_b16 v[228:229], v67 offset:4096
    ds_read_b64_tr_b16 v[230:231], v67 offset:4608
    s_waitcnt lgkmcnt(0)
    v_mfma_f32_16x16x32_bf16 v[88:91], v[208:211], v[68:71], v[88:91]
    v_mfma_f32_16x16x32_bf16 v[92:95], v[212:215], v[68:71], v[92:95]
    v_mfma_f32_16x16x32_bf16 v[96:99], v[216:219], v[68:71], v[96:99]
    v_mfma_f32_16x16x32_bf16 v[88:91], v[220:223], v[68:71], v[88:91]
    v_mfma_f32_16x16x32_bf16 v[92:95], v[224:227], v[68:71], v[92:95]
    v_mfma_f32_16x16x32_bf16 v[96:99], v[228:231], v[68:71], v[96:99]
    v_add_u32 v65, 73728, v62
    v_add_u32 v66, 73728, v63
    v_add_u32 v67, 73728, v64
    s_waitcnt vmcnt(0)
    s_barrier
    ds_read_b64_tr_b16 v[232:233], v65 offset:0
    ds_read_b64_tr_b16 v[234:235], v65 offset:512
    ds_read_b64_tr_b16 v[236:237], v66 offset:0
    ds_read_b64_tr_b16 v[238:239], v66 offset:512
    ds_read_b64_tr_b16 v[240:241], v67 offset:0
    ds_read_b64_tr_b16 v[242:243], v67 offset:512
    ds_read_b64_tr_b16 v[244:245], v65 offset:4096
    ds_read_b64_tr_b16 v[246:247], v65 offset:4608
    ds_read_b64_tr_b16 v[248:249], v66 offset:4096
    ds_read_b64_tr_b16 v[250:251], v66 offset:4608
    ds_read_b64_tr_b16 v[252:253], v67 offset:4096
    ds_read_b64_tr_b16 v[254:255], v67 offset:4608
    s_waitcnt lgkmcnt(0)
    v_mfma_f32_16x16x32_bf16 v[88:91], v[232:235], v[68:71], v[88:91]
    v_mfma_f32_16x16x32_bf16 v[92:95], v[236:239], v[68:71], v[92:95]
    v_mfma_f32_16x16x32_bf16 v[96:99], v[240:243], v[68:71], v[96:99]
    v_mfma_f32_16x16x32_bf16 v[88:91], v[244:247], v[68:71], v[88:91]
    v_mfma_f32_16x16x32_bf16 v[92:95], v[248:251], v[68:71], v[92:95]
    v_mfma_f32_16x16x32_bf16 v[96:99], v[252:255], v[68:71], v[96:99]
    s_barrier
    s_mov_b32 s37, 0xffff0000
    v_lshlrev_b32 v100, 16, v16
    v_and_b32 v101, s37, v16
    v_lshlrev_b32 v102, 16, v17
    v_and_b32 v103, s37, v17
    v_lshlrev_b32 v104, 16, v18
    v_and_b32 v105, s37, v18
    v_lshlrev_b32 v106, 16, v19
    v_and_b32 v107, s37, v19
    v_lshlrev_b32 v108, 16, v20
    v_and_b32 v109, s37, v20
    v_lshlrev_b32 v110, 16, v21
    v_and_b32 v111, s37, v21
    s_cmp_lg_u32 s32, 0
    s_cbranch_scc1 L_arv24
    s_mov_b32 s20, s82
    s_mov_b32 s21, s83
    s_mov_b32 s22, 0x100
    s_mov_b32 s23, 0x00020000
    v_and_b32 v56, 15, v0
    v_lshlrev_b32 v56, 4, v56
    buffer_load_dword v57, v56, s[20:23], 0 offen sc1
    s_waitcnt vmcnt(0)
    v_cmp_gt_u32 vcc, 16, v57
    s_cbranch_vccnz L_spin25
L_back26:
L_arv24:
    s_add_u32 s96, s41, 2031616
    s_mov_b32 s45, 0x5560000
    buffer_load_dword v7, v5, s[16:19], s45 offen sc1
    s_waitcnt vmcnt(0)
    v_cmp_ne_u32 vcc, 0, v7
    s_cbranch_vccnz L_spin27
L_back28:
    s_barrier
    s_add_u32 m0, s43, 0
    s_add_u32 s42, s41, 0
    buffer_load_dwordx4 v1, s[16:19], s42 offen offset:0 sc1 lds
    buffer_load_dwordx4 v1, s[16:19], s42 offen offset:1024 sc1 lds
    buffer_load_dwordx4 v1, s[16:19], s42 offen offset:2048 sc1 lds
    buffer_load_dwordx4 v1, s[16:19], s42 offen offset:3072 sc1 lds
    s_add_u32 m0, s43, 16384
    s_add_u32 s42, s41, 16384
    buffer_load_dwordx4 v1, s[16:19], s42 offen offset:0 sc1 lds
    buffer_load_dwordx4 v1, s[16:19], s42 offen offset:1024 sc1 lds
    buffer_load_dwordx4 v1, s[16:19], s42 offen offset:2048 sc1 lds
    buffer_load_dwordx4 v1, s[16:19], s42 offen offset:3072 sc1 lds
    s_add_u32 m0, s43, 32768
    s_add_u32 s42, s41, 32768
    buffer_load_dwordx4 v1, s[16:19], s42 offen offset:0 sc1 lds
    buffer_load_dwordx4 v1, s[16:19], s42 offen offset:1024 sc1 lds
    buffer_load_dwordx4 v1, s[16:19], s42 offen offset:2048 sc1 lds
    buffer_load_dwordx4 v1, s[16:19], s42 offen offset:3072 sc1 lds
    s_add_u32 s45, s45, 131072
    s_waitcnt vmcnt(0) lgkmcnt(0)
    s_barrier
    ds_read_b128 v[56:59], v1 offset:0
    ds_read_b128 v[60:63], v1 offset:1024
    ds_read_b128 v[64:67], v1 offset:2048
    ds_read_b128 v[68:71], v1 offset:3072
    s_mov_b32 s36, 0
    s_waitcnt lgkmcnt(0)
    s_nop 7
L_a_b0:
    s_waitcnt lgkmcnt(0)
    v_mfma_f32_16x16x32_bf16 v[8:11], a[0:3], v[56:59], 0
    ds_read_b128 v[72:75], v1 offset:4096
    s_cmp_eq_u32 s36, 0
    s_cselect_b32 s44, 0x8000000, s90
    v_mfma_f32_16x16x32_bf16 v[16:19], a[0:3], v[60:63], 0
    ds_read_b128 v[76:79], v1 offset:5120
    s_add_u32 s49, s44, s87
    v_mfma_f32_16x16x32_bf16 v[20:23], a[4:7], v[60:63], 0
    ds_read_b128 v[80:83], v1 offset:6144
    s_max_u32 s44, s44, s88
    v_mfma_f32_16x16x32_bf16 v[12:15], a[4:7], v[56:59], 0
    ds_read_b128 v[84:87], v1 offset:7168
    s_add_u32 s90, s90, 229376
    v_mfma_f32_16x16x32_bf16 v[24:27], a[8:11], v[56:59], 0
    v_mul_f32 v48, v48, v116
    v_mul_f32 v49, v49, v116
    v_mfma_f32_16x16x32_bf16 v[28:31], a[8:11], v[60:63], 0
    v_mul_f32 v50, v50, v116
    v_mul_f32 v51, v51, v116
    v_mfma_f32_16x16x32_bf16 v[8:11], a[12:15], v[64:67], v[8:11]
    v_max_f32 v48, 0, v48
    v_max_f32 v49, 0, v49
    v_mfma_f32_16x16x32_bf16 v[16:19], a[12:15], v[68:71], v[16:19]
    v_max_f32 v50, 0, v50
    v_max_f32 v51, 0, v51
    v_mfma_f32_16x16x32_bf16 v[20:23], a[16:19], v[68:71], v[20:23]
    v_mul_f32 v48, v48, v48
    v_mul_f32 v49, v49, v49
    v_mfma_f32_16x16x32_bf16 v[12:15], a[16:19], v[64:67], v[12:15]
    v_mul_f32 v50, v50, v50
    v_mul_f32 v51, v51, v51
    v_mfma_f32_16x16x32_bf16 v[24:27], a[20:23], v[64:67], v[24:27]
    v_cvt_pk_bf16_f32 v48, v48, v49
    v_cvt_pk_bf16_f32 v49, v50, v51
    v_mfma_f32_16x16x32_bf16 v[28:31], a[20:23], v[68:71], v[28:31]
    ds_write_b64 v3, v[48:49] offset:4096
    s_waitcnt lgkmcnt(1)
    v_mfma_f32_16x16x32_bf16 v[8:11], a[24:27], v[72:75], v[8:11]
    ds_read_b128 v[56:59], v1 offset:8192
    v_mul_f32 v52, v52, v117
    v_mfma_f32_16x16x32_bf16 v[16:19], a[24:27], v[76:79], v[16:19]
    ds_read_b128 v[60:63], v1 offset:9216
    v_mul_f32 v53, v53, v117
    v_mfma_f32_16x16x32_bf16 v[20:23], a[28:31], v[76:79], v[20:23]
    ds_read_b128 v[64:67], v1 offset:10240
    v_mul_f32 v54, v54, v117
    v_mfma_f32_16x16x32_bf16 v[12:15], a[28:31], v[72:75], v[12:15]
    ds_read_b128 v[68:71], v1 offset:11264
    v_mul_f32 v55, v55, v117
    v_mfma_f32_16x16x32_bf16 v[24:27], a[32:35], v[72:75], v[24:27]
    v_max_f32 v52, 0, v52
    v_max_f32 v53, 0, v53
    v_mfma_f32_16x16x32_bf16 v[28:31], a[32:35], v[76:79], v[28:31]
    v_max_f32 v54, 0, v54
    v_max_f32 v55, 0, v55
    v_mfma_f32_16x16x32_bf16 v[8:11], a[36:39], v[80:83], v[8:11]
    v_mul_f32 v52, v52, v52
    v_mul_f32 v53, v53, v53
    v_mfma_f32_16x16x32_bf16 v[16:19], a[36:39], v[84:87], v[16:19]
    v_mul_f32 v54, v54, v54
    v_mul_f32 v55, v55, v55
    v_mfma_f32_16x16x32_bf16 v[20:23], a[40:43], v[84:87], v[20:23]
    v_cvt_pk_bf16_f32 v52, v52, v53
    v_cvt_pk_bf16_f32 v53, v54, v55
    v_mfma_f32_16x16x32_bf16 v[12:15], a[40:43], v[80:83], v[12:15]
    ds_write_b64 v3, v[52:53] offset:5120
    buffer_load_dwordx2 v[52:53], v6, s[16:19], s46 offen offset:0 sc1
    v_mfma_f32_16x16x32_bf16 v[24:27], a[44:47], v[80:83], v[24:27]
    buffer_load_dwordx2 v[54:55], v6, s[16:19], s46 offen offset:128 sc1
    buffer_load_dwordx2 v[118:119], v6, s[16:19], s46 offen offset:256 sc1
    v_mfma_f32_16x16x32_bf16 v[28:31], a[44:47], v[84:87], v[28:31]
    buffer_load_dwordx2 v[120:121], v6, s[16:19], s46 offen offset:384 sc1
    s_waitcnt lgkmcnt(1)
    v_mfma_f32_16x16x32_bf16 v[8:11], a[48:51], v[56:59], v[8:11]
    ds_read_b128 v[72:75], v1 offset:12288
    v_mul_f32 v32, v32, v116
    v_mfma_f32_16x16x32_bf16 v[16:19], a[48:51], v[60:63], v[16:19]
    ds_read_b128 v[76:79], v1 offset:13312
    v_mul_f32 v33, v33, v116
    v_mfma_f32_16x16x32_bf16 v[20:23], a[52:55], v[60:63], v[20:23]
    ds_read_b128 v[80:83], v1 offset:14336
    v_mul_f32 v34, v34, v116
    v_mfma_f32_16x16x32_bf16 v[12:15], a[52:55], v[56:59], v[12:15]
    ds_read_b128 v[84:87], v1 offset:15360
    v_mul_f32 v35, v35, v116
    v_mfma_f32_16x16x32_bf16 v[24:27], a[56:59], v[56:59], v[24:27]
    v_max_f32 v32, 0, v32
    v_max_f32 v33, 0, v33
    v_mfma_f32_16x16x32_bf16 v[28:31], a[56:59], v[60:63], v[28:31]
    v_max_f32 v34, 0, v34
    v_max_f32 v35, 0, v35
    v_mfma_f32_16x16x32_bf16 v[8:11], a[60:63], v[64:67], v[8:11]
    v_mul_f32 v32, v32, v32
    v_mul_f32 v33, v33, v33
    v_mfma_f32_16x16x32_bf16 v[16:19], a[60:63], v[68:71], v[16:19]
    v_mul_f32 v34, v34, v34
    v_mul_f32 v35, v35, v35
    v_mfma_f32_16x16x32_bf16 v[20:23], a[64:67], v[68:71], v[20:23]
    v_cvt_pk_bf16_f32 v32, v32, v33
    v_cvt_pk_bf16_f32 v33, v34, v35
    v_mfma_f32_16x16x32_bf16 v[12:15], a[64:67], v[64:67], v[12:15]
    v_mul_f32 v36, v36, v116
    v_mul_f32 v37, v37, v116
    v_mfma_f32_16x16x32_bf16 v[24:27], a[68:71], v[64:67], v[24:27]
    v_mul_f32 v38, v38, v116
    v_mul_f32 v39, v39, v116
    v_mfma_f32_16x16x32_bf16 v[28:31], a[68:71], v[68:71], v[28:31]
    s_waitcnt vmcnt(8) lgkmcnt(0)
    s_barrier
    v_mfma_f32_16x16x32_bf16 v[8:11], a[72:75], v[72:75], v[8:11]
    ds_read_b128 v[56:59], v1 offset:16384
    ds_read_b128 v[48:51], v4 offset:4096
    v_mfma_f32_16x16x32_bf16 v[16:19], a[72:75], v[76:79], v[16:19]
    ds_read_b128 v[60:63], v1 offset:17408
    v_max_f32 v36, 0, v36
    v_mfma_f32_16x16x32_bf16 v[20:23], a[76:79], v[76:79], v[20:23]
    ds_read_b128 v[64:67], v1 offset:18432
    v_max_f32 v37, 0, v37
    v_mfma_f32_16x16x32_bf16 v[12:15], a[76:79], v[72:75], v[12:15]
    ds_read_b128 v[68:71], v1 offset:19456
    v_max_f32 v38, 0, v38
    v_mfma_f32_16x16x32_bf16 v[24:27], a[80:83], v[72:75], v[24:27]
    v_max_f32 v39, 0, v39
    v_mul_f32 v36, v36, v36
    v_mfma_f32_16x16x32_bf16 v[28:31], a[80:83], v[76:79], v[28:31]
    s_waitcnt lgkmcnt(3)
    buffer_store_dwordx4 v[48:51], v1, s[16:19], s49 offen sc1
    v_mfma_f32_16x16x32_bf16 v[8:11], a[84:87], v[80:83], v[8:11]
    v_mul_f32 v37, v37, v37
    v_mul_f32 v38, v38, v38
    v_mfma_f32_16x16x32_bf16 v[16:19], a[84:87], v[84:87], v[16:19]
    v_mul_f32 v39, v39, v39
    v_cvt_pk_bf16_f32 v34, v36, v37
    v_mfma_f32_16x16x32_bf16 v[20:23], a[88:91], v[84:87], v[20:23]
    v_cvt_pk_bf16_f32 v35, v38, v39
    buffer_store_dwordx4 v[32:35], v1, s[16:19], s44 offen offset:0 sc1
    v_mfma_f32_16x16x32_bf16 v[12:15], a[88:91], v[80:83], v[12:15]
    v_mul_f32 v40, v40, v117
    v_mul_f32 v41, v41, v117
    v_mfma_f32_16x16x32_bf16 v[24:27], a[92:95], v[80:83], v[24:27]
    v_mul_f32 v42, v42, v117
    v_mul_f32 v43, v43, v117
    v_mfma_f32_16x16x32_bf16 v[28:31], a[92:95], v[84:87], v[28:31]
    v_max_f32 v40, 0, v40
    s_waitcnt lgkmcnt(0)
    v_mfma_f32_16x16x32_bf16 v[8:11], a[96:99], v[56:59], v[8:11]
    ds_read_b128 v[72:75], v1 offset:20480
    v_max_f32 v41, 0, v41
    v_mfma_f32_16x16x32_bf16 v[16:19], a[96:99], v[60:63], v[16:19]
    ds_read_b128 v[76:79], v1 offset:21504
    v_max_f32 v42, 0, v42
    v_mfma_f32_16x16x32_bf16 v[20:23], a[100:103], v[60:63], v[20:23]
    ds_read_b128 v[80:83], v1 offset:22528
    v_max_f32 v43, 0, v43
    v_mfma_f32_16x16x32_bf16 v[12:15], a[100:103], v[56:59], v[12:15]
    ds_read_b128 v[84:87], v1 offset:23552
    v_mul_f32 v40, v40, v40
    v_mfma_f32_16x16x32_bf16 v[24:27], a[104:107], v[56:59], v[24:27]
    v_mul_f32 v41, v41, v41
    v_mul_f32 v42, v42, v42
    v_mfma_f32_16x16x32_bf16 v[28:31], a[104:107], v[60:63], v[28:31]
    v_mul_f32 v43, v43, v43
    v_cvt_pk_bf16_f32 v40, v40, v41
    v_mfma_f32_16x16x32_bf16 v[8:11], a[108:111], v[64:67], v[8:11]
    v_cvt_pk_bf16_f32 v41, v42, v43
    v_mul_f32 v44, v44, v117
    v_mfma_f32_16x16x32_bf16 v[16:19], a[108:111], v[68:71], v[16:19]
    v_mul_f32 v45, v45, v117
    v_mul_f32 v46, v46, v117
    v_mfma_f32_16x16x32_bf16 v[20:23], a[112:115], v[68:71], v[20:23]
    v_mul_f32 v47, v47, v117
    v_max_f32 v44, 0, v44
    v_mfma_f32_16x16x32_bf16 v[12:15], a[112:115], v[64:67], v[12:15]
    v_max_f32 v45, 0, v45
    v_max_f32 v46, 0, v46
    v_mfma_f32_16x16x32_bf16 v[24:27], a[116:119], v[64:67], v[24:27]
    v_max_f32 v47, 0, v47
    v_mul_f32 v44, v44, v44
    v_mfma_f32_16x16x32_bf16 v[28:31], a[116:119], v[68:71], v[28:31]
    v_mul_f32 v45, v45, v45
    s_waitcnt lgkmcnt(0)
    v_mfma_f32_16x16x32_bf16 v[8:11], a[120:123], v[72:75], v[8:11]
    ds_read_b128 v[56:59], v1 offset:24576
    v_mul_f32 v46, v46, v46
    v_mfma_f32_16x16x32_bf16 v[16:19], a[120:123], v[76:79], v[16:19]
    ds_read_b128 v[60:63], v1 offset:25600
    v_mul_f32 v47, v47, v47
    v_mfma_f32_16x16x32_bf16 v[20:23], a[124:127], v[76:79], v[20:23]
    ds_read_b128 v[64:67], v1 offset:26624
    s_add_u32 m0, s43, 49152
    v_mfma_f32_16x16x32_bf16 v[12:15], a[124:127], v[72:75], v[12:15]
    ds_read_b128 v[68:71], v1 offset:27648
    s_add_u32 s42, s41, 49152
    v_mfma_f32_16x16x32_bf16 v[24:27], a[128:131], v[72:75], v[24:27]
    buffer_load_dwordx4 v1, s[16:19], s42 offen offset:0 sc1 lds
    v_cvt_pk_bf16_f32 v42, v44, v45
    v_mfma_f32_16x16x32_bf16 v[28:31], a[128:131], v[76:79], v[28:31]
    v_cvt_pk_bf16_f32 v43, v46, v47
    buffer_store_dwordx4 v[40:43], v1, s[16:19], s44 offen offset:1024 sc1
    v_mfma_f32_16x16x32_bf16 v[8:11], a[132:135], v[80:83], v[8:11]
    v_mfma_f32_16x16x32_bf16 v[16:19], a[132:135], v[84:87], v[16:19]
    buffer_load_dwordx4 v1, s[16:19], s42 offen offset:1024 sc1 lds
    v_mfma_f32_16x16x32_bf16 v[20:23], a[136:139], v[84:87], v[20:23]
    v_mfma_f32_16x16x32_bf16 v[12:15], a[136:139], v[80:83], v[12:15]
    v_mfma_f32_16x16x32_bf16 v[24:27], a[140:143], v[80:83], v[24:27]
    buffer_load_dwordx4 v1, s[16:19], s42 offen offset:2048 sc1 lds
    v_mfma_f32_16x16x32_bf16 v[28:31], a[140:143], v[84:87], v[28:31]
    s_waitcnt lgkmcnt(0)
    v_mfma_f32_16x16x32_bf16 v[8:11], a[144:147], v[56:59], v[8:11]
    ds_read_b128 v[72:75], v1 offset:28672
    v_mfma_f32_16x16x32_bf16 v[16:19], a[144:147], v[60:63], v[16:19]
    ds_read_b128 v[76:79], v1 offset:29696
    buffer_load_dwordx4 v1, s[16:19], s42 offen offset:3072 sc1 lds
    v_mfma_f32_16x16x32_bf16 v[20:23], a[148:151], v[60:63], v[20:23]
    ds_read_b128 v[80:83], v1 offset:30720
    s_add_u32 s41, s41, 65536
    v_mfma_f32_16x16x32_bf16 v[12:15], a[148:151], v[56:59], v[12:15]
    ds_read_b128 v[84:87], v1 offset:31744
    s_min_u32 s41, s41, s96
    v_mfma_f32_16x16x32_bf16 v[24:27], a[152:155], v[56:59], v[24:27]
    s_waitcnt vmcnt(7)
    v_max3_u32 v122, v52, v53, v54
    v_mfma_f32_16x16x32_bf16 v[28:31], a[152:155], v[60:63], v[28:31]
    v_max3_u32 v123, v55, v118, v119
    v_max3_u32 v122, v122, v120, v121
    v_mfma_f32_16x16x32_bf16 v[8:11], a[156:159], v[64:67], v[8:11]
    v_max_u32 v122, v122, v123
    v_cmp_eq_u32 vcc, -1, v122
    s_cbranch_vccnz L_sspin31
L_sback32:
    v_mfma_f32_16x16x32_bf16 v[16:19], a[156:159], v[68:71], v[16:19]
    v_add_f32 v122, v118, v120
    v_add_f32 v123, v119, v121
    v_mfma_f32_16x16x32_bf16 v[20:23], a[160:163], v[68:71], v[20:23]
    v_add_f32 v52, v52, v54
    v_add_f32 v53, v53, v55
    v_mfma_f32_16x16x32_bf16 v[12:15], a[160:163], v[64:67], v[12:15]
    v_add_f32 v52, v52, v122
    v_add_f32 v53, v53, v123
    v_mfma_f32_16x16x32_bf16 v[24:27], a[164:167], v[64:67], v[24:27]
    v_mov_b32 v122, v52
    v_mov_b32 v123, v53
    v_mfma_f32_16x16x32_bf16 v[28:31], a[164:167], v[68:71], v[28:31]
    s_waitcnt vmcnt(11) lgkmcnt(0)
    s_barrier
    v_mfma_f32_16x16x32_bf16 v[8:11], a[168:171], v[72:75], v[8:11]
    ds_read_b128 v[56:59], v1 offset:32768
    buffer_load_dword v7, v5, s[16:19], s45 offen sc1
    v_mfma_f32_16x16x32_bf16 v[16:19], a[168:171], v[76:79], v[16:19]
    ds_read_b128 v[60:63], v1 offset:33792
    v_permlane32_swap_b32 v52, v122
    v_mfma_f32_16x16x32_bf16 v[20:23], a[172:175], v[76:79], v[20:23]
    ds_read_b128 v[64:67], v1 offset:34816
    v_permlane32_swap_b32 v53, v123
    v_mfma_f32_16x16x32_bf16 v[12:15], a[172:175], v[72:75], v[12:15]
    ds_read_b128 v[68:71], v1 offset:35840
    v_add_f32 v52, v52, v122
    v_mfma_f32_16x16x32_bf16 v[24:27], a[176:179], v[72:75], v[24:27]
    v_add_f32 v53, v53, v123
    v_mul_f32 v112, 0xba800000, v52
    v_mfma_f32_16x16x32_bf16 v[28:31], a[176:179], v[76:79], v[28:31]
    v_mul_f32 v53, 0x3a800000, v53
    v_fma_f32 v53, -v112, v112, v53
    v_mfma_f32_16x16x32_bf16 v[8:11], a[180:183], v[80:83], v[8:11]
    v_mov_b32 v113, v112
    v_max_f32 v53, 0, v53
    v_mfma_f32_16x16x32_bf16 v[16:19], a[180:183], v[84:87], v[16:19]
    v_add_f32 v53, 0x3727c5ac, v53
    v_rsq_f32 v116, v53
    v_mfma_f32_16x16x32_bf16 v[20:23], a[184:187], v[84:87], v[20:23]
    v_permlane16_swap_b32 v112, v113
    v_mul_f32 v114, v53, v116
    v_mfma_f32_16x16x32_bf16 v[12:15], a[184:187], v[80:83], v[12:15]
    v_mov_b32 v117, v116
    v_mov_b32 v115, v114
    v_mfma_f32_16x16x32_bf16 v[24:27], a[188:191], v[80:83], v[24:27]
    v_permlane16_swap_b32 v116, v117
    v_permlane16_swap_b32 v114, v115
    v_mfma_f32_16x16x32_bf16 v[28:31], a[188:191], v[84:87], v[28:31]
    s_add_u32 s46, s46, 2048
    s_waitcnt lgkmcnt(0)
    v_mfma_f32_16x16x32_bf16 v[8:11], a[192:195], v[56:59], v[8:11]
    ds_read_b128 v[72:75], v1 offset:36864
    v_fmac_f32 v12, v112, v92
    v_mfma_f32_16x16x32_bf16 v[16:19], a[192:195], v[60:63], v[16:19]
    ds_read_b128 v[76:79], v1 offset:37888
    v_fmac_f32 v13, v112, v93
    v_mfma_f32_16x16x32_bf16 v[20:23], a[196:199], v[60:63], v[20:23]
    ds_read_b128 v[80:83], v1 offset:38912
    v_fmac_f32 v8, v112, v88
    v_mfma_f32_16x16x32_bf16 v[12:15], a[196:199], v[56:59], v[12:15]
    ds_read_b128 v[84:87], v1 offset:39936
    v_fmac_f32 v9, v112, v89
    v_mfma_f32_16x16x32_bf16 v[24:27], a[200:203], v[56:59], v[24:27]
    v_fmac_f32 v10, v112, v90
    v_fmac_f32 v11, v112, v91
    v_mfma_f32_16x16x32_bf16 v[28:31], a[200:203], v[60:63], v[28:31]
    v_fmac_f32 v16, v113, v88
    v_fmac_f32 v17, v113, v89
    v_mfma_f32_16x16x32_bf16 v[8:11], a[204:207], v[64:67], v[8:11]
    v_fmac_f32 v14, v112, v94
    v_fmac_f32 v15, v112, v95
    v_mfma_f32_16x16x32_bf16 v[16:19], a[204:207], v[68:71], v[16:19]
    v_fmac_f32 v12, v114, v104
    v_fmac_f32 v13, v114, v105
    v_mfma_f32_16x16x32_bf16 v[20:23], a[208:211], v[68:71], v[20:23]
    v_fmac_f32 v8, v114, v100
    v_fmac_f32 v9, v114, v101
    v_mfma_f32_16x16x32_bf16 v[12:15], a[208:211], v[64:67], v[12:15]
    v_fmac_f32 v10, v114, v102
    v_fmac_f32 v11, v114, v103
    v_mfma_f32_16x16x32_bf16 v[24:27], a[212:215], v[64:67], v[24:27]
    v_fmac_f32 v18, v113, v90
    v_fmac_f32 v19, v113, v91
    v_mfma_f32_16x16x32_bf16 v[28:31], a[212:215], v[68:71], v[28:31]
    v_fmac_f32 v16, v115, v100
    s_waitcnt lgkmcnt(0)
    v_mfma_f32_16x16x32_bf16 v[8:11], a[216:219], v[72:75], v[8:11]
    ds_read_b128 v[56:59], v1 offset:40960
    v_fmac_f32 v14, v114, v106
    v_mfma_f32_16x16x32_bf16 v[16:19], a[216:219], v[76:79], v[16:19]
    ds_read_b128 v[60:63], v1 offset:41984
    v_fmac_f32 v15, v114, v107
    v_mfma_f32_16x16x32_bf16 v[20:23], a[220:223], v[76:79], v[20:23]
    ds_read_b128 v[64:67], v1 offset:43008
    v_fmac_f32 v24, v112, v96
    v_mfma_f32_16x16x32_bf16 v[12:15], a[220:223], v[72:75], v[12:15]
    ds_read_b128 v[68:71], v1 offset:44032
    v_fmac_f32 v17, v115, v101
    v_mfma_f32_16x16x32_bf16 v[24:27], a[224:227], v[72:75], v[24:27]
    v_fmac_f32 v18, v115, v102
    v_fmac_f32 v19, v115, v103
    v_mfma_f32_16x16x32_bf16 v[28:31], a[224:227], v[76:79], v[28:31]
    v_fmac_f32 v20, v113, v92
    v_fmac_f32 v21, v113, v93
    v_mfma_f32_16x16x32_bf16 v[8:11], a[228:231], v[80:83], v[8:11]
    v_fmac_f32 v22, v113, v94
    v_fmac_f32 v23, v113, v95
    v_mfma_f32_16x16x32_bf16 v[16:19], a[228:231], v[84:87], v[16:19]
    v_fmac_f32 v25, v112, v97
    v_fmac_f32 v26, v112, v98
    v_mfma_f32_16x16x32_bf16 v[20:23], a[232:235], v[84:87], v[20:23]
    v_fmac_f32 v27, v112, v99
    v_fmac_f32 v24, v114, v108
    v_mfma_f32_16x16x32_bf16 v[12:15], a[232:235], v[80:83], v[12:15]
    v_fmac_f32 v28, v113, v96
    v_fmac_f32 v29, v113, v97
    v_mfma_f32_16x16x32_bf16 v[24:27], a[236:239], v[80:83], v[24:27]
    v_fmac_f32 v20, v115, v104
    v_fmac_f32 v21, v115, v105
    v_mfma_f32_16x16x32_bf16 v[28:31], a[236:239], v[84:87], v[28:31]
    v_fmac_f32 v22, v115, v106
    s_waitcnt lgkmcnt(0)
    v_mfma_f32_16x16x32_bf16 v[8:11], a[240:243], v[56:59], v[8:11]
    ds_read_b128 v[72:75], v1 offset:45056
    v_fmac_f32 v23, v115, v107
    v_mfma_f32_16x16x32_bf16 v[16:19], a[240:243], v[60:63], v[16:19]
    ds_read_b128 v[76:79], v1 offset:46080
    v_fmac_f32 v25, v114, v109
    v_mfma_f32_16x16x32_bf16 v[20:23], a[244:247], v[60:63], v[20:23]
    ds_read_b128 v[80:83], v1 offset:47104
    v_fmac_f32 v26, v114, v110
    v_mfma_f32_16x16x32_bf16 v[12:15], a[244:247], v[56:59], v[12:15]
    ds_read_b128 v[84:87], v1 offset:48128
    v_fmac_f32 v30, v113, v98
    v_mfma_f32_16x16x32_bf16 v[24:27], a[248:251], v[56:59], v[24:27]
    v_mfma_f32_16x16x32_bf16 v[28:31], a[248:251], v[60:63], v[28:31]
    v_mfma_f32_16x16x32_bf16 v[8:11], a[252:255], v[64:67], v[8:11]
    s_waitcnt vmcnt(0)
    v_cmp_ne_u32 vcc, 0, v7
    s_cbranch_vccnz L_spin29
L_back30:
    v_mfma_f32_16x16x32_bf16 v[16:19], a[252:255], v[68:71], v[16:19]
    s_barrier
    buffer_store_dword v124, v124, s[16:19], s91 offen sc1
    v_mfma_f32_16x16x32_bf16 v[20:23], v[128:131], v[68:71], v[20:23]
    s_add_u32 s91, s91, 131072
    s_add_u32 m0, s43, 98304
    v_mfma_f32_16x16x32_bf16 v[12:15], v[128:131], v[64:67], v[12:15]
    s_add_u32 s42, s41, 0
    buffer_load_dwordx4 v1, s[16:19], s42 offen offset:0 sc1 lds
    v_mfma_f32_16x16x32_bf16 v[24:27], v[132:135], v[64:67], v[24:27]
    v_mfma_f32_16x16x32_bf16 v[28:31], v[132:135], v[68:71], v[28:31]
    buffer_load_dwordx4 v1, s[16:19], s42 offen offset:1024 sc1 lds
    s_waitcnt lgkmcnt(0)
    v_mfma_f32_16x16x32_bf16 v[8:11], v[136:139], v[72:75], v[8:11]
    ds_read_b128 v[56:59], v1 offset:49152
    v_mfma_f32_16x16x32_bf16 v[16:19], v[136:139], v[76:79], v[16:19]
    ds_read_b128 v[60:63], v1 offset:50176
    buffer_load_dwordx4 v1, s[16:19], s42 offen offset:2048 sc1 lds
    v_mfma_f32_16x16x32_bf16 v[20:23], v[140:143], v[76:79], v[20:23]
    ds_read_b128 v[64:67], v1 offset:51200
    v_fmac_f32 v27, v114, v111
    v_mfma_f32_16x16x32_bf16 v[12:15], v[140:143], v[72:75], v[12:15]
    ds_read_b128 v[68:71], v1 offset:52224
    buffer_load_dwordx4 v1, s[16:19], s42 offen offset:3072 sc1 lds
    v_mfma_f32_16x16x32_bf16 v[24:27], v[144:147], v[72:75], v[24:27]
    v_mfma_f32_16x16x32_bf16 v[28:31], v[144:147], v[76:79], v[28:31]
    v_mfma_f32_16x16x32_bf16 v[8:11], v[148:151], v[80:83], v[8:11]
    v_mfma_f32_16x16x32_bf16 v[16:19], v[148:151], v[84:87], v[16:19]
    s_add_u32 m0, s43, 114688
    s_add_u32 s42, s41, 16384
    v_mfma_f32_16x16x32_bf16 v[20:23], v[152:155], v[84:87], v[20:23]
    buffer_load_dwordx4 v1, s[16:19], s42 offen offset:0 sc1 lds
    v_fmac_f32 v31, v113, v99
    v_mfma_f32_16x16x32_bf16 v[12:15], v[152:155], v[80:83], v[12:15]
    v_fmac_f32 v28, v115, v108
    v_fmac_f32 v29, v115, v109
    v_mfma_f32_16x16x32_bf16 v[24:27], v[156:159], v[80:83], v[24:27]
    v_mfma_f32_16x16x32_bf16 v[28:31], v[156:159], v[84:87], v[28:31]
    s_waitcnt lgkmcnt(0)
    v_mfma_f32_16x16x32_bf16 v[8:11], v[160:163], v[56:59], v[8:11]
    ds_read_b128 v[72:75], v1 offset:53248
    v_mfma_f32_16x16x32_bf16 v[16:19], v[160:163], v[60:63], v[16:19]
    ds_read_b128 v[76:79], v1 offset:54272
    buffer_load_dwordx4 v1, s[16:19], s42 offen offset:1024 sc1 lds
    v_mfma_f32_16x16x32_bf16 v[20:23], v[164:167], v[60:63], v[20:23]
    ds_read_b128 v[80:83], v1 offset:55296
    v_fmac_f32 v30, v115, v110
    v_mfma_f32_16x16x32_bf16 v[12:15], v[164:167], v[56:59], v[12:15]
    ds_read_b128 v[84:87], v1 offset:56320
    v_fmac_f32 v31, v115, v111
    v_mfma_f32_16x16x32_bf16 v[24:27], v[168:171], v[56:59], v[24:27]
    v_mfma_f32_16x16x32_bf16 v[28:31], v[168:171], v[60:63], v[28:31]
    v_mfma_f32_16x16x32_bf16 v[8:11], v[172:175], v[64:67], v[8:11]
    buffer_load_dwordx4 v1, s[16:19], s42 offen offset:2048 sc1 lds
    v_mfma_f32_16x16x32_bf16 v[16:19], v[172:175], v[68:71], v[16:19]
    v_mfma_f32_16x16x32_bf16 v[20:23], v[176:179], v[68:71], v[20:23]
    v_mfma_f32_16x16x32_bf16 v[12:15], v[176:179], v[64:67], v[12:15]
    v_mfma_f32_16x16x32_bf16 v[24:27], v[180:183], v[64:67], v[24:27]
    v_mfma_f32_16x16x32_bf16 v[28:31], v[180:183], v[68:71], v[28:31]
    buffer_load_dwordx4 v1, s[16:19], s42 offen offset:3072 sc1 lds
    s_waitcnt lgkmcnt(0)
    v_mfma_f32_16x16x32_bf16 v[8:11], v[184:187], v[72:75], v[8:11]
    ds_read_b128 v[56:59], v1 offset:57344
    v_mfma_f32_16x16x32_bf16 v[16:19], v[184:187], v[76:79], v[16:19]
    ds_read_b128 v[60:63], v1 offset:58368
    v_mfma_f32_16x16x32_bf16 v[20:23], v[188:191], v[76:79], v[20:23]
    ds_read_b128 v[64:67], v1 offset:59392
    v_mfma_f32_16x16x32_bf16 v[12:15], v[188:191], v[72:75], v[12:15]
    ds_read_b128 v[68:71], v1 offset:60416
    s_add_u32 m0, s43, 131072
    v_mfma_f32_16x16x32_bf16 v[24:27], v[192:195], v[72:75], v[24:27]
    s_add_u32 s42, s41, 32768
    buffer_load_dwordx4 v1, s[16:19], s42 offen offset:0 sc1 lds
    v_mfma_f32_16x16x32_bf16 v[28:31], v[192:195], v[76:79], v[28:31]
    v_mfma_f32_16x16x32_bf16 v[8:11], v[196:199], v[80:83], v[8:11]
    v_mfma_f32_16x16x32_bf16 v[16:19], v[196:199], v[84:87], v[16:19]
    v_mfma_f32_16x16x32_bf16 v[20:23], v[200:203], v[84:87], v[20:23]
    v_mfma_f32_16x16x32_bf16 v[12:15], v[200:203], v[80:83], v[12:15]
    buffer_load_dwordx4 v1, s[16:19], s42 offen offset:1024 sc1 lds
    v_mfma_f32_16x16x32_bf16 v[24:27], v[204:207], v[80:83], v[24:27]
    v_mfma_f32_16x16x32_bf16 v[28:31], v[204:207], v[84:87], v[28:31]
    s_waitcnt lgkmcnt(0)
    v_mfma_f32_16x16x32_bf16 v[8:11], v[208:211], v[56:59], v[8:11]
    ds_read_b128 v[72:75], v1 offset:61440
    v_mfma_f32_16x16x32_bf16 v[16:19], v[208:211], v[60:63], v[16:19]
    ds_read_b128 v[76:79], v1 offset:62464
    v_mfma_f32_16x16x32_bf16 v[20:23], v[212:215], v[60:63], v[20:23]
    ds_read_b128 v[80:83], v1 offset:63488
    buffer_load_dwordx4 v1, s[16:19], s42 offen offset:2048 sc1 lds
    v_mfma_f32_16x16x32_bf16 v[12:15], v[212:215], v[56:59], v[12:15]
    ds_read_b128 v[84:87], v1 offset:64512
    v_mfma_f32_16x16x32_bf16 v[24:27], v[216:219], v[56:59], v[24:27]
    v_mfma_f32_16x16x32_bf16 v[28:31], v[216:219], v[60:63], v[28:31]
    v_mfma_f32_16x16x32_bf16 v[8:11], v[220:223], v[64:67], v[8:11]
    v_mfma_f32_16x16x32_bf16 v[16:19], v[220:223], v[68:71], v[16:19]
    buffer_load_dwordx4 v1, s[16:19], s42 offen offset:3072 sc1 lds
    s_add_u32 s45, s45, 131072
    v_mfma_f32_16x16x32_bf16 v[20:23], v[224:227], v[68:71], v[20:23]
    v_mfma_f32_16x16x32_bf16 v[12:15], v[224:227], v[64:67], v[12:15]
    v_mfma_f32_16x16x32_bf16 v[24:27], v[228:231], v[64:67], v[24:27]
    v_mfma_f32_16x16x32_bf16 v[28:31], v[228:231], v[68:71], v[28:31]
    s_waitcnt vmcnt(8) lgkmcnt(0)
    s_barrier
    v_mfma_f32_16x16x32_bf16 v[8:11], v[232:235], v[72:75], v[8:11]
    ds_read_b128 v[56:59], v2 offset:0
    v_mfma_f32_16x16x32_bf16 v[16:19], v[232:235], v[76:79], v[16:19]
    ds_read_b128 v[60:63], v2 offset:1024
    v_mfma_f32_16x16x32_bf16 v[20:23], v[236:239], v[76:79], v[20:23]
    ds_read_b128 v[64:67], v2 offset:2048
    v_mfma_f32_16x16x32_bf16 v[12:15], v[236:239], v[72:75], v[12:15]
    ds_read_b128 v[68:71], v2 offset:3072
    v_mfma_f32_16x16x32_bf16 v[24:27], v[240:243], v[72:75], v[24:27]
    v_mfma_f32_16x16x32_bf16 v[28:31], v[240:243], v[76:79], v[28:31]
    v_mfma_f32_16x16x32_bf16 v[8:11], v[244:247], v[80:83], v[8:11]
    v_mfma_f32_16x16x32_bf16 v[16:19], v[244:247], v[84:87], v[16:19]
    v_mfma_f32_16x16x32_bf16 v[20:23], v[248:251], v[84:87], v[20:23]
    v_mfma_f32_16x16x32_bf16 v[12:15], v[248:251], v[80:83], v[12:15]
    v_mfma_f32_16x16x32_bf16 v[24:27], v[252:255], v[80:83], v[24:27]
    v_mfma_f32_16x16x32_bf16 v[28:31], v[252:255], v[84:87], v[28:31]
    s_add_u32 s36, s36, 1
L_a_b1:
    s_waitcnt lgkmcnt(0)
    v_mfma_f32_16x16x32_bf16 v[32:35], a[0:3], v[56:59], 0
    ds_read_b128 v[72:75], v2 offset:4096
    s_cmp_eq_u32 s36, 0
    s_cselect_b32 s44, 0x8000000, s90
    v_mfma_f32_16x16x32_bf16 v[40:43], a[0:3], v[60:63], 0
    ds_read_b128 v[76:79], v2 offset:5120
    s_add_u32 s49, s44, s87
    v_mfma_f32_16x16x32_bf16 v[44:47], a[4:7], v[60:63], 0
    ds_read_b128 v[80:83], v2 offset:6144
    s_max_u32 s44, s44, s88
    v_mfma_f32_16x16x32_bf16 v[36:39], a[4:7], v[56:59], 0
    ds_read_b128 v[84:87], v2 offset:7168
    s_add_u32 s90, s90, 229376
    v_mfma_f32_16x16x32_bf16 v[48:51], a[8:11], v[56:59], 0
    v_mul_f32 v24, v24, v116
    v_mul_f32 v25, v25, v116
    v_mfma_f32_16x16x32_bf16 v[52:55], a[8:11], v[60:63], 0
    v_mul_f32 v26, v26, v116
    v_mul_f32 v27, v27, v116
    v_mfma_f32_16x16x32_bf16 v[32:35], a[12:15], v[64:67], v[32:35]
    v_max_f32 v24, 0, v24
    v_max_f32 v25, 0, v25
    v_mfma_f32_16x16x32_bf16 v[40:43], a[12:15], v[68:71], v[40:43]
    v_max_f32 v26, 0, v26
    v_max_f32 v27, 0, v27
    v_mfma_f32_16x16x32_bf16 v[44:47], a[16:19], v[68:71], v[44:47]
    v_mul_f32 v24, v24, v24
    v_mul_f32 v25, v25, v25
    v_mfma_f32_16x16x32_bf16 v[36:39], a[16:19], v[64:67], v[36:39]
    v_mul_f32 v26, v26, v26
    v_mul_f32 v27, v27, v27
    v_mfma_f32_16x16x32_bf16 v[48:51], a[20:23], v[64:67], v[48:51]
    v_cvt_pk_bf16_f32 v24, v24, v25
    v_cvt_pk_bf16_f32 v25, v26, v27
    v_mfma_f32_16x16x32_bf16 v[52:55], a[20:23], v[68:71], v[52:55]
    ds_write_b64 v3, v[24:25] offset:0
    s_waitcnt lgkmcnt(1)
    v_mfma_f32_16x16x32_bf16 v[32:35], a[24:27], v[72:75], v[32:35]
    ds_read_b128 v[56:59], v2 offset:8192
    v_mul_f32 v28, v28, v117
    v_mfma_f32_16x16x32_bf16 v[40:43], a[24:27], v[76:79], v[40:43]
    ds_read_b128 v[60:63], v2 offset:9216
    v_mul_f32 v29, v29, v117
    v_mfma_f32_16x16x32_bf16 v[44:47], a[28:31], v[76:79], v[44:47]
    ds_read_b128 v[64:67], v2 offset:10240
    v_mul_f32 v30, v30, v117
    v_mfma_f32_16x16x32_bf16 v[36:39], a[28:31], v[72:75], v[36:39]
    ds_read_b128 v[68:71], v2 offset:11264
    v_mul_f32 v31, v31, v117
    v_mfma_f32_16x16x32_bf16 v[48:51], a[32:35], v[72:75], v[48:51]
    v_max_f32 v28, 0, v28
    v_max_f32 v29, 0, v29
    v_mfma_f32_16x16x32_bf16 v[52:55], a[32:35], v[76:79], v[52:55]
    v_max_f32 v30, 0, v30
    v_max_f32 v31, 0, v31
    v_mfma_f32_16x16x32_bf16 v[32:35], a[36:39], v[80:83], v[32:35]
    v_mul_f32 v28, v28, v28
    v_mul_f32 v29, v29, v29
    v_mfma_f32_16x16x32_bf16 v[40:43], a[36:39], v[84:87], v[40:43]
    v_mul_f32 v30, v30, v30
    v_mul_f32 v31, v31, v31
    v_mfma_f32_16x16x32_bf16 v[44:47], a[40:43], v[84:87], v[44:47]
    v_cvt_pk_bf16_f32 v28, v28, v29
    v_cvt_pk_bf16_f32 v29, v30, v31
    v_mfma_f32_16x16x32_bf16 v[36:39], a[40:43], v[80:83], v[36:39]
    ds_write_b64 v3, v[28:29] offset:1024
    buffer_load_dwordx2 v[28:29], v6, s[16:19], s46 offen offset:0 sc1
    v_mfma_f32_16x16x32_bf16 v[48:51], a[44:47], v[80:83], v[48:51]
    buffer_load_dwordx2 v[30:31], v6, s[16:19], s46 offen offset:128 sc1
    buffer_load_dwordx2 v[118:119], v6, s[16:19], s46 offen offset:256 sc1
    v_mfma_f32_16x16x32_bf16 v[52:55], a[44:47], v[84:87], v[52:55]
    buffer_load_dwordx2 v[120:121], v6, s[16:19], s46 offen offset:384 sc1
    s_waitcnt lgkmcnt(1)
    v_mfma_f32_16x16x32_bf16 v[32:35], a[48:51], v[56:59], v[32:35]
    ds_read_b128 v[72:75], v2 offset:12288
    v_mul_f32 v8, v8, v116
    v_mfma_f32_16x16x32_bf16 v[40:43], a[48:51], v[60:63], v[40:43]
    ds_read_b128 v[76:79], v2 offset:13312
    v_mul_f32 v9, v9, v116
    v_mfma_f32_16x16x32_bf16 v[44:47], a[52:55], v[60:63], v[44:47]
    ds_read_b128 v[80:83], v2 offset:14336
    v_mul_f32 v10, v10, v116
    v_mfma_f32_16x16x32_bf16 v[36:39], a[52:55], v[56:59], v[36:39]
    ds_read_b128 v[84:87], v2 offset:15360
    v_mul_f32 v11, v11, v116
    v_mfma_f32_16x16x32_bf16 v[48:51], a[56:59], v[56:59], v[48:51]
    v_max_f32 v8, 0, v8
    v_max_f32 v9, 0, v9
    v_mfma_f32_16x16x32_bf16 v[52:55], a[56:59], v[60:63], v[52:55]
    v_max_f32 v10, 0, v10
    v_max_f32 v11, 0, v11
    v_mfma_f32_16x16x32_bf16 v[32:35], a[60:63], v[64:67], v[32:35]
    v_mul_f32 v8, v8, v8
    v_mul_f32 v9, v9, v9
    v_mfma_f32_16x16x32_bf16 v[40:43], a[60:63], v[68:71], v[40:43]
    v_mul_f32 v10, v10, v10
    v_mul_f32 v11, v11, v11
    v_mfma_f32_16x16x32_bf16 v[44:47], a[64:67], v[68:71], v[44:47]
    v_cvt_pk_bf16_f32 v8, v8, v9
    v_cvt_pk_bf16_f32 v9, v10, v11
    v_mfma_f32_16x16x32_bf16 v[36:39], a[64:67], v[64:67], v[36:39]
    v_mul_f32 v12, v12, v116
    v_mul_f32 v13, v13, v116
    v_mfma_f32_16x16x32_bf16 v[48:51], a[68:71], v[64:67], v[48:51]
    v_mul_f32 v14, v14, v116
    v_mul_f32 v15, v15, v116
    v_mfma_f32_16x16x32_bf16 v[52:55], a[68:71], v[68:71], v[52:55]
    s_waitcnt vmcnt(8) lgkmcnt(0)
    s_barrier
    v_mfma_f32_16x16x32_bf16 v[32:35], a[72:75], v[72:75], v[32:35]
    ds_read_b128 v[56:59], v2 offset:16384
    ds_read_b128 v[24:27], v4 offset:0
    v_mfma_f32_16x16x32_bf16 v[40:43], a[72:75], v[76:79], v[40:43]
    ds_read_b128 v[60:63], v2 offset:17408
    v_max_f32 v12, 0, v12
    v_mfma_f32_16x16x32_bf16 v[44:47], a[76:79], v[76:79], v[44:47]
    ds_read_b128 v[64:67], v2 offset:18432
    v_max_f32 v13, 0, v13
    v_mfma_f32_16x16x32_bf16 v[36:39], a[76:79], v[72:75], v[36:39]
    ds_read_b128 v[68:71], v2 offset:19456
    v_max_f32 v14, 0, v14
    v_mfma_f32_16x16x32_bf16 v[48:51], a[80:83], v[72:75], v[48:51]
    v_max_f32 v15, 0, v15
    v_mul_f32 v12, v12, v12
    v_mfma_f32_16x16x32_bf16 v[52:55], a[80:83], v[76:79], v[52:55]
    s_waitcnt lgkmcnt(3)
    buffer_store_dwordx4 v[24:27], v1, s[16:19], s49 offen sc1
    v_mfma_f32_16x16x32_bf16 v[32:35], a[84:87], v[80:83], v[32:35]
    v_mul_f32 v13, v13, v13
    v_mul_f32 v14, v14, v14
    v_mfma_f32_16x16x32_bf16 v[40:43], a[84:87], v[84:87], v[40:43]
    v_mul_f32 v15, v15, v15
    v_cvt_pk_bf16_f32 v10, v12, v13
    v_mfma_f32_16x16x32_bf16 v[44:47], a[88:91], v[84:87], v[44:47]
    v_cvt_pk_bf16_f32 v11, v14, v15
    buffer_store_dwordx4 v[8:11], v1, s[16:19], s44 offen offset:0 sc1
    v_mfma_f32_16x16x32_bf16 v[36:39], a[88:91], v[80:83], v[36:39]
    v_mul_f32 v16, v16, v117
    v_mul_f32 v17, v17, v117
    v_mfma_f32_16x16x32_bf16 v[48:51], a[92:95], v[80:83], v[48:51]
    v_mul_f32 v18, v18, v117
    v_mul_f32 v19, v19, v117
    v_mfma_f32_16x16x32_bf16 v[52:55], a[92:95], v[84:87], v[52:55]
    v_max_f32 v16, 0, v16
    s_waitcnt lgkmcnt(0)
    v_mfma_f32_16x16x32_bf16 v[32:35], a[96:99], v[56:59], v[32:35]
    ds_read_b128 v[72:75], v2 offset:20480
    v_max_f32 v17, 0, v17
    v_mfma_f32_16x16x32_bf16 v[40:43], a[96:99], v[60:63], v[40:43]
    ds_read_b128 v[76:79], v2 offset:21504
    v_max_f32 v18, 0, v18
    v_mfma_f32_16x16x32_bf16 v[44:47], a[100:103], v[60:63], v[44:47]
    ds_read_b128 v[80:83], v2 offset:22528
    v_max_f32 v19, 0, v19
    v_mfma_f32_16x16x32_bf16 v[36:39], a[100:103], v[56:59], v[36:39]
    ds_read_b128 v[84:87], v2 offset:23552
    v_mul_f32 v16, v16, v16
    v_mfma_f32_16x16x32_bf16 v[48:51], a[104:107], v[56:59], v[48:51]
    v_mul_f32 v17, v17, v17
    v_mul_f32 v18, v18, v18
    v_mfma_f32_16x16x32_bf16 v[52:55], a[104:107], v[60:63], v[52:55]
    v_mul_f32 v19, v19, v19
    v_cvt_pk_bf16_f32 v16, v16, v17
    v_mfma_f32_16x16x32_bf16 v[32:35], a[108:111], v[64:67], v[32:35]
    v_cvt_pk_bf16_f32 v17, v18, v19
    v_mul_f32 v20, v20, v117
    v_mfma_f32_16x16x32_bf16 v[40:43], a[108:111], v[68:71], v[40:43]
    v_mul_f32 v21, v21, v117
    v_mul_f32 v22, v22, v117
    v_mfma_f32_16x16x32_bf16 v[44:47], a[112:115], v[68:71], v[44:47]
    v_mul_f32 v23, v23, v117
    v_max_f32 v20, 0, v20
    v_mfma_f32_16x16x32_bf16 v[36:39], a[112:115], v[64:67], v[36:39]
    v_max_f32 v21, 0, v21
    v_max_f32 v22, 0, v22
    v_mfma_f32_16x16x32_bf16 v[48:51], a[116:119], v[64:67], v[48:51]
    v_max_f32 v23, 0, v23
    v_mul_f32 v20, v20, v20
    v_mfma_f32_16x16x32_bf16 v[52:55], a[116:119], v[68:71], v[52:55]
    v_mul_f32 v21, v21, v21
    s_waitcnt lgkmcnt(0)
    v_mfma_f32_16x16x32_bf16 v[32:35], a[120:123], v[72:75], v[32:35]
    ds_read_b128 v[56:59], v2 offset:24576
    v_mul_f32 v22, v22, v22
    v_mfma_f32_16x16x32_bf16 v[40:43], a[120:123], v[76:79], v[40:43]
    ds_read_b128 v[60:63], v2 offset:25600
    v_mul_f32 v23, v23, v23
    v_mfma_f32_16x16x32_bf16 v[44:47], a[124:127], v[76:79], v[44:47]
    ds_read_b128 v[64:67], v2 offset:26624
    s_add_u32 m0, s43, 147456
    v_mfma_f32_16x16x32_bf16 v[36:39], a[124:127], v[72:75], v[36:39]
    ds_read_b128 v[68:71], v2 offset:27648
    s_add_u32 s42, s41, 49152
    v_mfma_f32_16x16x32_bf16 v[48:51], a[128:131], v[72:75], v[48:51]
    buffer_load_dwordx4 v1, s[16:19], s42 offen offset:0 sc1 lds
    v_cvt_pk_bf16_f32 v18, v20, v21
    v_mfma_f32_16x16x32_bf16 v[52:55], a[128:131], v[76:79], v[52:55]
    v_cvt_pk_bf16_f32 v19, v22, v23
    buffer_store_dwordx4 v[16:19], v1, s[16:19], s44 offen offset:1024 sc1
    v_mfma_f32_16x16x32_bf16 v[32:35], a[132:135], v[80:83], v[32:35]
    v_mfma_f32_16x16x32_bf16 v[40:43], a[132:135], v[84:87], v[40:43]
    buffer_load_dwordx4 v1, s[16:19], s42 offen offset:1024 sc1 lds
    v_mfma_f32_16x16x32_bf16 v[44:47], a[136:139], v[84:87], v[44:47]
    v_mfma_f32_16x16x32_bf16 v[36:39], a[136:139], v[80:83], v[36:39]
    v_mfma_f32_16x16x32_bf16 v[48:51], a[140:143], v[80:83], v[48:51]
    buffer_load_dwordx4 v1, s[16:19], s42 offen offset:2048 sc1 lds
    v_mfma_f32_16x16x32_bf16 v[52:55], a[140:143], v[84:87], v[52:55]
    s_waitcnt lgkmcnt(0)
    v_mfma_f32_16x16x32_bf16 v[32:35], a[144:147], v[56:59], v[32:35]
    ds_read_b128 v[72:75], v2 offset:28672
    v_mfma_f32_16x16x32_bf16 v[40:43], a[144:147], v[60:63], v[40:43]
    ds_read_b128 v[76:79], v2 offset:29696
    buffer_load_dwordx4 v1, s[16:19], s42 offen offset:3072 sc1 lds
    v_mfma_f32_16x16x32_bf16 v[44:47], a[148:151], v[60:63], v[44:47]
    ds_read_b128 v[80:83], v2 offset:30720
    s_add_u32 s41, s41, 65536
    v_mfma_f32_16x16x32_bf16 v[36:39], a[148:151], v[56:59], v[36:39]
    ds_read_b128 v[84:87], v2 offset:31744
    s_min_u32 s41, s41, s96
    v_mfma_f32_16x16x32_bf16 v[48:51], a[152:155], v[56:59], v[48:51]
    s_waitcnt vmcnt(7)
    v_max3_u32 v122, v28, v29, v30
    v_mfma_f32_16x16x32_bf16 v[52:55], a[152:155], v[60:63], v[52:55]
    v_max3_u32 v123, v31, v118, v119
    v_max3_u32 v122, v122, v120, v121
    v_mfma_f32_16x16x32_bf16 v[32:35], a[156:159], v[64:67], v[32:35]
    v_max_u32 v122, v122, v123
    v_cmp_eq_u32 vcc, -1, v122
    s_cbranch_vccnz L_sspin35
L_sback36:
    v_mfma_f32_16x16x32_bf16 v[40:43], a[156:159], v[68:71], v[40:43]
    v_add_f32 v122, v118, v120
    v_add_f32 v123, v119, v121
    v_mfma_f32_16x16x32_bf16 v[44:47], a[160:163], v[68:71], v[44:47]
    v_add_f32 v28, v28, v30
    v_add_f32 v29, v29, v31
    v_mfma_f32_16x16x32_bf16 v[36:39], a[160:163], v[64:67], v[36:39]
    v_add_f32 v28, v28, v122
    v_add_f32 v29, v29, v123
    v_mfma_f32_16x16x32_bf16 v[48:51], a[164:167], v[64:67], v[48:51]
    v_mov_b32 v122, v28
    v_mov_b32 v123, v29
    v_mfma_f32_16x16x32_bf16 v[52:55], a[164:167], v[68:71], v[52:55]
    s_waitcnt vmcnt(11) lgkmcnt(0)
    s_barrier
    v_mfma_f32_16x16x32_bf16 v[32:35], a[168:171], v[72:75], v[32:35]
    ds_read_b128 v[56:59], v2 offset:32768
    buffer_load_dword v7, v5, s[16:19], s45 offen sc1
    v_mfma_f32_16x16x32_bf16 v[40:43], a[168:171], v[76:79], v[40:43]
    ds_read_b128 v[60:63], v2 offset:33792
    v_permlane32_swap_b32 v28, v122
    v_mfma_f32_16x16x32_bf16 v[44:47], a[172:175], v[76:79], v[44:47]
    ds_read_b128 v[64:67], v2 offset:34816
    v_permlane32_swap_b32 v29, v123
    v_mfma_f32_16x16x32_bf16 v[36:39], a[172:175], v[72:75], v[36:39]
    ds_read_b128 v[68:71], v2 offset:35840
    v_add_f32 v28, v28, v122
    v_mfma_f32_16x16x32_bf16 v[48:51], a[176:179], v[72:75], v[48:51]
    v_add_f32 v29, v29, v123
    v_mul_f32 v112, 0xba800000, v28
    v_mfma_f32_16x16x32_bf16 v[52:55], a[176:179], v[76:79], v[52:55]
    v_mul_f32 v29, 0x3a800000, v29
    v_fma_f32 v29, -v112, v112, v29
    v_mfma_f32_16x16x32_bf16 v[32:35], a[180:183], v[80:83], v[32:35]
    v_mov_b32 v113, v112
    v_max_f32 v29, 0, v29
    v_mfma_f32_16x16x32_bf16 v[40:43], a[180:183], v[84:87], v[40:43]
    v_add_f32 v29, 0x3727c5ac, v29
    v_rsq_f32 v116, v29
    v_mfma_f32_16x16x32_bf16 v[44:47], a[184:187], v[84:87], v[44:47]
    v_permlane16_swap_b32 v112, v113
    v_mul_f32 v114, v29, v116
    v_mfma_f32_16x16x32_bf16 v[36:39], a[184:187], v[80:83], v[36:39]
    v_mov_b32 v117, v116
    v_mov_b32 v115, v114
    v_mfma_f32_16x16x32_bf16 v[48:51], a[188:191], v[80:83], v[48:51]
    v_permlane16_swap_b32 v116, v117
    v_permlane16_swap_b32 v114, v115
    v_mfma_f32_16x16x32_bf16 v[52:55], a[188:191], v[84:87], v[52:55]
    s_add_u32 s46, s46, 2048
    s_waitcnt lgkmcnt(0)
    v_mfma_f32_16x16x32_bf16 v[32:35], a[192:195], v[56:59], v[32:35]
    ds_read_b128 v[72:75], v2 offset:36864
    v_fmac_f32 v36, v112, v92
    v_mfma_f32_16x16x32_bf16 v[40:43], a[192:195], v[60:63], v[40:43]
    ds_read_b128 v[76:79], v2 offset:37888
    v_fmac_f32 v37, v112, v93
    v_mfma_f32_16x16x32_bf16 v[44:47], a[196:199], v[60:63], v[44:47]
    ds_read_b128 v[80:83], v2 offset:38912
    v_fmac_f32 v32, v112, v88
    v_mfma_f32_16x16x32_bf16 v[36:39], a[196:199], v[56:59], v[36:39]
    ds_read_b128 v[84:87], v2 offset:39936
    v_fmac_f32 v33, v112, v89
    v_mfma_f32_16x16x32_bf16 v[48:51], a[200:203], v[56:59], v[48:51]
    v_fmac_f32 v34, v112, v90
    v_fmac_f32 v35, v112, v91
    v_mfma_f32_16x16x32_bf16 v[52:55], a[200:203], v[60:63], v[52:55]
    v_fmac_f32 v40, v113, v88
    v_fmac_f32 v41, v113, v89
    v_mfma_f32_16x16x32_bf16 v[32:35], a[204:207], v[64:67], v[32:35]
    v_fmac_f32 v38, v112, v94
    v_fmac_f32 v39, v112, v95
    v_mfma_f32_16x16x32_bf16 v[40:43], a[204:207], v[68:71], v[40:43]
    v_fmac_f32 v36, v114, v104
    v_fmac_f32 v37, v114, v105
    v_mfma_f32_16x16x32_bf16 v[44:47], a[208:211], v[68:71], v[44:47]
    v_fmac_f32 v32, v114, v100
    v_fmac_f32 v33, v114, v101
    v_mfma_f32_16x16x32_bf16 v[36:39], a[208:211], v[64:67], v[36:39]
    v_fmac_f32 v34, v114, v102
    v_fmac_f32 v35, v114, v103
    v_mfma_f32_16x16x32_bf16 v[48:51], a[212:215], v[64:67], v[48:51]
    v_fmac_f32 v42, v113, v90
    v_fmac_f32 v43, v113, v91
    v_mfma_f32_16x16x32_bf16 v[52:55], a[212:215], v[68:71], v[52:55]
    v_fmac_f32 v40, v115, v100
    s_waitcnt lgkmcnt(0)
    v_mfma_f32_16x16x32_bf16 v[32:35], a[216:219], v[72:75], v[32:35]
    ds_read_b128 v[56:59], v2 offset:40960
    v_fmac_f32 v38, v114, v106
    v_mfma_f32_16x16x32_bf16 v[40:43], a[216:219], v[76:79], v[40:43]
    ds_read_b128 v[60:63], v2 offset:41984
    v_fmac_f32 v39, v114, v107
    v_mfma_f32_16x16x32_bf16 v[44:47], a[220:223], v[76:79], v[44:47]
    ds_read_b128 v[64:67], v2 offset:43008
    v_fmac_f32 v48, v112, v96
    v_mfma_f32_16x16x32_bf16 v[36:39], a[220:223], v[72:75], v[36:39]
    ds_read_b128 v[68:71], v2 offset:44032
    v_fmac_f32 v41, v115, v101
    v_mfma_f32_16x16x32_bf16 v[48:51], a[224:227], v[72:75], v[48:51]
    v_fmac_f32 v42, v115, v102
    v_fmac_f32 v43, v115, v103
    v_mfma_f32_16x16x32_bf16 v[52:55], a[224:227], v[76:79], v[52:55]
    v_fmac_f32 v44, v113, v92
    v_fmac_f32 v45, v113, v93
    v_mfma_f32_16x16x32_bf16 v[32:35], a[228:231], v[80:83], v[32:35]
    v_fmac_f32 v46, v113, v94
    v_fmac_f32 v47, v113, v95
    v_mfma_f32_16x16x32_bf16 v[40:43], a[228:231], v[84:87], v[40:43]
    v_fmac_f32 v49, v112, v97
    v_fmac_f32 v50, v112, v98
    v_mfma_f32_16x16x32_bf16 v[44:47], a[232:235], v[84:87], v[44:47]
    v_fmac_f32 v51, v112, v99
    v_fmac_f32 v48, v114, v108
    v_mfma_f32_16x16x32_bf16 v[36:39], a[232:235], v[80:83], v[36:39]
    v_fmac_f32 v52, v113, v96
    v_fmac_f32 v53, v113, v97
    v_mfma_f32_16x16x32_bf16 v[48:51], a[236:239], v[80:83], v[48:51]
    v_fmac_f32 v44, v115, v104
    v_fmac_f32 v45, v115, v105
    v_mfma_f32_16x16x32_bf16 v[52:55], a[236:239], v[84:87], v[52:55]
    v_fmac_f32 v46, v115, v106
    s_waitcnt lgkmcnt(0)
    v_mfma_f32_16x16x32_bf16 v[32:35], a[240:243], v[56:59], v[32:35]
    ds_read_b128 v[72:75], v2 offset:45056
    v_fmac_f32 v47, v115, v107
    v_mfma_f32_16x16x32_bf16 v[40:43], a[240:243], v[60:63], v[40:43]
    ds_read_b128 v[76:79], v2 offset:46080
    v_fmac_f32 v49, v114, v109
    v_mfma_f32_16x16x32_bf16 v[44:47], a[244:247], v[60:63], v[44:47]
    ds_read_b128 v[80:83], v2 offset:47104
    v_fmac_f32 v50, v114, v110
    v_mfma_f32_16x16x32_bf16 v[36:39], a[244:247], v[56:59], v[36:39]
    ds_read_b128 v[84:87], v2 offset:48128
    v_fmac_f32 v54, v113, v98
    v_mfma_f32_16x16x32_bf16 v[48:51], a[248:251], v[56:59], v[48:51]
    v_mfma_f32_16x16x32_bf16 v[52:55], a[248:251], v[60:63], v[52:55]
    v_mfma_f32_16x16x32_bf16 v[32:35], a[252:255], v[64:67], v[32:35]
    s_waitcnt vmcnt(0)
    v_cmp_ne_u32 vcc, 0, v7
    s_cbranch_vccnz L_spin33
L_back34:
    v_mfma_f32_16x16x32_bf16 v[40:43], a[252:255], v[68:71], v[40:43]
    s_barrier
    buffer_store_dword v124, v124, s[16:19], s91 offen sc1
    v_mfma_f32_16x16x32_bf16 v[44:47], v[128:131], v[68:71], v[44:47]
    s_add_u32 s91, s91, 131072
    s_add_u32 m0, s43, 0
    v_mfma_f32_16x16x32_bf16 v[36:39], v[128:131], v[64:67], v[36:39]
    s_add_u32 s42, s41, 0
    buffer_load_dwordx4 v1, s[16:19], s42 offen offset:0 sc1 lds
    v_mfma_f32_16x16x32_bf16 v[48:51], v[132:135], v[64:67], v[48:51]
    v_mfma_f32_16x16x32_bf16 v[52:55], v[132:135], v[68:71], v[52:55]
    buffer_load_dwordx4 v1, s[16:19], s42 offen offset:1024 sc1 lds
    s_waitcnt lgkmcnt(0)
    v_mfma_f32_16x16x32_bf16 v[32:35], v[136:139], v[72:75], v[32:35]
    ds_read_b128 v[56:59], v2 offset:49152
    v_mfma_f32_16x16x32_bf16 v[40:43], v[136:139], v[76:79], v[40:43]
    ds_read_b128 v[60:63], v2 offset:50176
    buffer_load_dwordx4 v1, s[16:19], s42 offen offset:2048 sc1 lds
    v_mfma_f32_16x16x32_bf16 v[44:47], v[140:143], v[76:79], v[44:47]
    ds_read_b128 v[64:67], v2 offset:51200
    v_fmac_f32 v51, v114, v111
    v_mfma_f32_16x16x32_bf16 v[36:39], v[140:143], v[72:75], v[36:39]
    ds_read_b128 v[68:71], v2 offset:52224
    buffer_load_dwordx4 v1, s[16:19], s42 offen offset:3072 sc1 lds
    v_mfma_f32_16x16x32_bf16 v[48:51], v[144:147], v[72:75], v[48:51]
    v_mfma_f32_16x16x32_bf16 v[52:55], v[144:147], v[76:79], v[52:55]
    v_mfma_f32_16x16x32_bf16 v[32:35], v[148:151], v[80:83], v[32:35]
    v_mfma_f32_16x16x32_bf16 v[40:43], v[148:151], v[84:87], v[40:43]
    s_add_u32 m0, s43, 16384
    s_add_u32 s42, s41, 16384
    v_mfma_f32_16x16x32_bf16 v[44:47], v[152:155], v[84:87], v[44:47]
    buffer_load_dwordx4 v1, s[16:19], s42 offen offset:0 sc1 lds
    v_fmac_f32 v55, v113, v99
    v_mfma_f32_16x16x32_bf16 v[36:39], v[152:155], v[80:83], v[36:39]
    v_fmac_f32 v52, v115, v108
    v_fmac_f32 v53, v115, v109
    v_mfma_f32_16x16x32_bf16 v[48:51], v[156:159], v[80:83], v[48:51]
    v_mfma_f32_16x16x32_bf16 v[52:55], v[156:159], v[84:87], v[52:55]
    s_waitcnt lgkmcnt(0)
    v_mfma_f32_16x16x32_bf16 v[32:35], v[160:163], v[56:59], v[32:35]
    ds_read_b128 v[72:75], v2 offset:53248
    v_mfma_f32_16x16x32_bf16 v[40:43], v[160:163], v[60:63], v[40:43]
    ds_read_b128 v[76:79], v2 offset:54272
    buffer_load_dwordx4 v1, s[16:19], s42 offen offset:1024 sc1 lds
    v_mfma_f32_16x16x32_bf16 v[44:47], v[164:167], v[60:63], v[44:47]
    ds_read_b128 v[80:83], v2 offset:55296
    v_fmac_f32 v54, v115, v110
    v_mfma_f32_16x16x32_bf16 v[36:39], v[164:167], v[56:59], v[36:39]
    ds_read_b128 v[84:87], v2 offset:56320
    v_fmac_f32 v55, v115, v111
    v_mfma_f32_16x16x32_bf16 v[48:51], v[168:171], v[56:59], v[48:51]
    v_mfma_f32_16x16x32_bf16 v[52:55], v[168:171], v[60:63], v[52:55]
    v_mfma_f32_16x16x32_bf16 v[32:35], v[172:175], v[64:67], v[32:35]
    buffer_load_dwordx4 v1, s[16:19], s42 offen offset:2048 sc1 lds
    v_mfma_f32_16x16x32_bf16 v[40:43], v[172:175], v[68:71], v[40:43]
    v_mfma_f32_16x16x32_bf16 v[44:47], v[176:179], v[68:71], v[44:47]
    v_mfma_f32_16x16x32_bf16 v[36:39], v[176:179], v[64:67], v[36:39]
    v_mfma_f32_16x16x32_bf16 v[48:51], v[180:183], v[64:67], v[48:51]
    v_mfma_f32_16x16x32_bf16 v[52:55], v[180:183], v[68:71], v[52:55]
    buffer_load_dwordx4 v1, s[16:19], s42 offen offset:3072 sc1 lds
    s_waitcnt lgkmcnt(0)
    v_mfma_f32_16x16x32_bf16 v[32:35], v[184:187], v[72:75], v[32:35]
    ds_read_b128 v[56:59], v2 offset:57344
    v_mfma_f32_16x16x32_bf16 v[40:43], v[184:187], v[76:79], v[40:43]
    ds_read_b128 v[60:63], v2 offset:58368
    v_mfma_f32_16x16x32_bf16 v[44:47], v[188:191], v[76:79], v[44:47]
    ds_read_b128 v[64:67], v2 offset:59392
    v_mfma_f32_16x16x32_bf16 v[36:39], v[188:191], v[72:75], v[36:39]
    ds_read_b128 v[68:71], v2 offset:60416
    s_add_u32 m0, s43, 32768
    v_mfma_f32_16x16x32_bf16 v[48:51], v[192:195], v[72:75], v[48:51]
    s_add_u32 s42, s41, 32768
    buffer_load_dwordx4 v1, s[16:19], s42 offen offset:0 sc1 lds
    v_mfma_f32_16x16x32_bf16 v[52:55], v[192:195], v[76:79], v[52:55]
    v_mfma_f32_16x16x32_bf16 v[32:35], v[196:199], v[80:83], v[32:35]
    v_mfma_f32_16x16x32_bf16 v[40:43], v[196:199], v[84:87], v[40:43]
    v_mfma_f32_16x16x32_bf16 v[44:47], v[200:203], v[84:87], v[44:47]
    v_mfma_f32_16x16x32_bf16 v[36:39], v[200:203], v[80:83], v[36:39]
    buffer_load_dwordx4 v1, s[16:19], s42 offen offset:1024 sc1 lds
    v_mfma_f32_16x16x32_bf16 v[48:51], v[204:207], v[80:83], v[48:51]
    v_mfma_f32_16x16x32_bf16 v[52:55], v[204:207], v[84:87], v[52:55]
    s_waitcnt lgkmcnt(0)
    v_mfma_f32_16x16x32_bf16 v[32:35], v[208:211], v[56:59], v[32:35]
    ds_read_b128 v[72:75], v2 offset:61440
    v_mfma_f32_16x16x32_bf16 v[40:43], v[208:211], v[60:63], v[40:43]
    ds_read_b128 v[76:79], v2 offset:62464
    v_mfma_f32_16x16x32_bf16 v[44:47], v[212:215], v[60:63], v[44:47]
    ds_read_b128 v[80:83], v2 offset:63488
    buffer_load_dwordx4 v1, s[16:19], s42 offen offset:2048 sc1 lds
    v_mfma_f32_16x16x32_bf16 v[36:39], v[212:215], v[56:59], v[36:39]
    ds_read_b128 v[84:87], v2 offset:64512
    v_mfma_f32_16x16x32_bf16 v[48:51], v[216:219], v[56:59], v[48:51]
    v_mfma_f32_16x16x32_bf16 v[52:55], v[216:219], v[60:63], v[52:55]
    v_mfma_f32_16x16x32_bf16 v[32:35], v[220:223], v[64:67], v[32:35]
    v_mfma_f32_16x16x32_bf16 v[40:43], v[220:223], v[68:71], v[40:43]
    buffer_load_dwordx4 v1, s[16:19], s42 offen offset:3072 sc1 lds
    s_add_u32 s45, s45, 131072
    v_mfma_f32_16x16x32_bf16 v[44:47], v[224:227], v[68:71], v[44:47]
    v_mfma_f32_16x16x32_bf16 v[36:39], v[224:227], v[64:67], v[36:39]
    v_mfma_f32_16x16x32_bf16 v[48:51], v[228:231], v[64:67], v[48:51]
    v_mfma_f32_16x16x32_bf16 v[52:55], v[228:231], v[68:71], v[52:55]
    s_waitcnt vmcnt(8) lgkmcnt(0)
    s_barrier
    v_mfma_f32_16x16x32_bf16 v[32:35], v[232:235], v[72:75], v[32:35]
    ds_read_b128 v[56:59], v1 offset:0
    v_mfma_f32_16x16x32_bf16 v[40:43], v[232:235], v[76:79], v[40:43]
    ds_read_b128 v[60:63], v1 offset:1024
    v_mfma_f32_16x16x32_bf16 v[44:47], v[236:239], v[76:79], v[44:47]
    ds_read_b128 v[64:67], v1 offset:2048
    v_mfma_f32_16x16x32_bf16 v[36:39], v[236:239], v[72:75], v[36:39]
    ds_read_b128 v[68:71], v1 offset:3072
    v_mfma_f32_16x16x32_bf16 v[48:51], v[240:243], v[72:75], v[48:51]
    v_mfma_f32_16x16x32_bf16 v[52:55], v[240:243], v[76:79], v[52:55]
    v_mfma_f32_16x16x32_bf16 v[32:35], v[244:247], v[80:83], v[32:35]
    v_mfma_f32_16x16x32_bf16 v[40:43], v[244:247], v[84:87], v[40:43]
    v_mfma_f32_16x16x32_bf16 v[44:47], v[248:251], v[84:87], v[44:47]
    v_mfma_f32_16x16x32_bf16 v[36:39], v[248:251], v[80:83], v[36:39]
    v_mfma_f32_16x16x32_bf16 v[48:51], v[252:255], v[80:83], v[48:51]
    v_mfma_f32_16x16x32_bf16 v[52:55], v[252:255], v[84:87], v[52:55]
    s_add_u32 s36, s36, 1
    s_cmp_lt_u32 s36, 32
    s_cbranch_scc1 L_a_b0
    s_nop 7
    s_cmp_eq_u32 s36, 0
    s_cselect_b32 s44, 0x8000000, s90
    s_add_u32 s49, s44, s87
    s_max_u32 s44, s44, s88
    s_add_u32 s90, s90, 229376
    v_mul_f32 v48, v48, v116
    v_mul_f32 v49, v49, v116
    v_mul_f32 v50, v50, v116
    v_mul_f32 v51, v51, v116
    v_max_f32 v48, 0, v48
    v_max_f32 v49, 0, v49
    v_max_f32 v50, 0, v50
    v_max_f32 v51, 0, v51
    v_mul_f32 v48, v48, v48
    v_mul_f32 v49, v49, v49
    v_mul_f32 v50, v50, v50
    v_mul_f32 v51, v51, v51
    v_cvt_pk_bf16_f32 v48, v48, v49
    v_cvt_pk_bf16_f32 v49, v50, v51
    ds_write_b64 v3, v[48:49] offset:4096
    v_mul_f32 v52, v52, v117
    v_mul_f32 v53, v53, v117
    v_mul_f32 v54, v54, v117
    v_mul_f32 v55, v55, v117
    v_max_f32 v52, 0, v52
    v_max_f32 v53, 0, v53
    v_max_f32 v54, 0, v54
    v_max_f32 v55, 0, v55
    v_mul_f32 v52, v52, v52
    v_mul_f32 v53, v53, v53
    v_mul_f32 v54, v54, v54
    v_mul_f32 v55, v55, v55
    v_cvt_pk_bf16_f32 v52, v52, v53
    v_cvt_pk_bf16_f32 v53, v54, v55
    ds_write_b64 v3, v[52:53] offset:5120
    v_mul_f32 v32, v32, v116
    v_mul_f32 v33, v33, v116
    v_mul_f32 v34, v34, v116
    v_mul_f32 v35, v35, v116
    v_max_f32 v32, 0, v32
    v_max_f32 v33, 0, v33
    v_max_f32 v34, 0, v34
    v_max_f32 v35, 0, v35
    v_mul_f32 v32, v32, v32
    v_mul_f32 v33, v33, v33
    v_mul_f32 v34, v34, v34
    v_mul_f32 v35, v35, v35
    v_cvt_pk_bf16_f32 v32, v32, v33
    v_cvt_pk_bf16_f32 v33, v34, v35
    v_mul_f32 v36, v36, v116
    v_mul_f32 v37, v37, v116
    v_mul_f32 v38, v38, v116
    v_mul_f32 v39, v39, v116
    v_max_f32 v36, 0, v36
    v_max_f32 v37, 0, v37
    v_max_f32 v38, 0, v38
    v_max_f32 v39, 0, v39
    v_mul_f32 v36, v36, v36
    v_mul_f32 v37, v37, v37
    v_mul_f32 v38, v38, v38
    v_mul_f32 v39, v39, v39
    v_cvt_pk_bf16_f32 v34, v36, v37
    v_cvt_pk_bf16_f32 v35, v38, v39
    buffer_store_dwordx4 v[32:35], v1, s[16:19], s44 offen offset:0 sc1
    v_mul_f32 v40, v40, v117
    v_mul_f32 v41, v41, v117
    v_mul_f32 v42, v42, v117
    v_mul_f32 v43, v43, v117
    v_max_f32 v40, 0, v40
    v_max_f32 v41, 0, v41
    s_waitcnt lgkmcnt(0)
    s_barrier
    ds_read_b128 v[48:51], v4 offset:4096
    v_max_f32 v42, 0, v42
    v_max_f32 v43, 0, v43
    v_mul_f32 v40, v40, v40
    v_mul_f32 v41, v41, v41
    v_mul_f32 v42, v42, v42
    v_mul_f32 v43, v43, v43
    v_cvt_pk_bf16_f32 v40, v40, v41
    v_cvt_pk_bf16_f32 v41, v42, v43
    v_mul_f32 v44, v44, v117
    s_waitcnt lgkmcnt(0)
    buffer_store_dwordx4 v[48:51], v1, s[16:19], s49 offen sc1
    v_mul_f32 v45, v45, v117
    v_mul_f32 v46, v46, v117
    v_mul_f32 v47, v47, v117
    v_max_f32 v44, 0, v44
    v_max_f32 v45, 0, v45
    v_max_f32 v46, 0, v46
    v_max_f32 v47, 0, v47
    v_mul_f32 v44, v44, v44
    v_mul_f32 v45, v45, v45
    v_mul_f32 v46, v46, v46
    v_mul_f32 v47, v47, v47
    v_cvt_pk_bf16_f32 v42, v44, v45
    v_cvt_pk_bf16_f32 v43, v46, v47
    buffer_store_dwordx4 v[40:43], v1, s[16:19], s44 offen offset:1024 sc1
    s_waitcnt vmcnt(0)
    s_barrier
    buffer_store_dword v124, v124, s[16:19], s91 offen sc1
    s_add_u32 s91, s91, 131072
    s_waitcnt vmcnt(0)
    s_endpgm
L_spin25:
    s_mov_b32 s40, 0x20000
L_spin25_l:
    buffer_load_dword v57, v56, s[20:23], 0 offen sc1
    s_sub_u32 s40, s40, 1
    s_waitcnt vmcnt(0)
    v_cmp_gt_u32 vcc, 16, v57
    s_cbranch_scc1 L_back26
    s_cbranch_vccz L_back26
    s_sleep 2
    s_branch L_spin25_l
L_spin27:
    s_mov_b32 s40, 0x20000
L_spin27_l:
    buffer_load_dword v7, v5, s[16:19], s45 offen sc1
    s_sub_u32 s40, s40, 1
    s_waitcnt vmcnt(0)
    v_cmp_ne_u32 vcc, 0, v7
    s_cbranch_scc1 L_back28
    s_cbranch_vccz L_back28
    s_sleep 2
    s_branch L_spin27_l
L_spin29:
    s_mov_b32 s40, 0x20000
L_spin29_l:
    buffer_load_dword v7, v5, s[16:19], s45 offen sc1
    s_sub_u32 s40, s40, 1
    s_waitcnt vmcnt(0)
    v_cmp_ne_u32 vcc, 0, v7
    s_cbranch_scc1 L_back30
    s_cbranch_vccz L_back30
    s_sleep 2
    s_branch L_spin29_l
L_sspin31:
    s_mov_b32 s40, 0x20000
L_sspin31_l:
    s_sleep 1
    buffer_load_dwordx2 v[52:53], v6, s[16:19], s46 offen offset:0 sc1
    buffer_load_dwordx2 v[54:55], v6, s[16:19], s46 offen offset:128 sc1
    buffer_load_dwordx2 v[118:119], v6, s[16:19], s46 offen offset:256 sc1
    buffer_load_dwordx2 v[120:121], v6, s[16:19], s46 offen offset:384 sc1
    s_sub_u32 s40, s40, 1
    s_waitcnt vmcnt(0)
    v_max3_u32 v122, v52, v53, v54
    v_max3_u32 v123, v55, v118, v119
    v_max3_u32 v122, v122, v120, v121
    v_max_u32 v122, v122, v123
    v_cmp_eq_u32 vcc, -1, v122
    s_cbranch_scc1 L_sback32
    s_cbranch_vccnz L_sspin31_l
    s_branch L_sback32
L_spin33:
    s_mov_b32 s40, 0x20000
L_spin33_l:
    buffer_load_dword v7, v5, s[16:19], s45 offen sc1
    s_sub_u32 s40, s40, 1
    s_waitcnt vmcnt(0)
    v_cmp_ne_u32 vcc, 0, v7
    s_cbranch_scc1 L_back34
    s_cbranch_vccz L_back34
    s_sleep 2
    s_branch L_spin33_l
L_sspin35:
    s_mov_b32 s40, 0x20000
L_sspin35_l:
    s_sleep 1
    buffer_load_dwordx2 v[28:29], v6, s[16:19], s46 offen offset:0 sc1
    buffer_load_dwordx2 v[30:31], v6, s[16:19], s46 offen offset:128 sc1
    buffer_load_dwordx2 v[118:119], v6, s[16:19], s46 offen offset:256 sc1
    buffer_load_dwordx2 v[120:121], v6, s[16:19], s46 offen offset:384 sc1
    s_sub_u32 s40, s40, 1
    s_waitcnt vmcnt(0)
    v_max3_u32 v122, v28, v29, v30
    v_max3_u32 v123, v31, v118, v119
    v_max3_u32 v122, v122, v120, v121
    v_max_u32 v122, v122, v123
    v_cmp_eq_u32 vcc, -1, v122
    s_cbranch_scc1 L_sback36
    s_cbranch_vccnz L_sspin35_l
    s_branch L_sback36
L_role_43:
    s_sub_u32 s35, s34, 43
    s_waitcnt vmcnt(0)
    s_barrier
    s_cmp_lg_u32 s32, 3
    s_cbranch_scc1 L_arr37
    s_mov_b32 s20, s82
    s_mov_b32 s21, s83
    s_mov_b32 s22, 0x100
    s_mov_b32 s23, 0x00020000
    s_and_b32 s37, s2, 15
    s_lshl_b32 s37, s37, 4
    v_mov_b32 v123, 1
    buffer_atomic_add v123, v124, s[20:23], s37 offen
L_arr37:
    s_endpgm
L_role_44:
    s_sub_u32 s35, s34, 44
    s_add_u32 s54, s54, L_role_44-interleave_layers__sliding_local_dilated__dense_activation_squared_relu__prompt_kernel
    buffer_load_dword v252, v7, s[8:11], s54 offen
    s_mov_b32 s86, 0x3f803f80
    s_mov_b32 s8, s64
    s_mov_b32 s9, s65
    s_mov_b32 s10, 0x400000
    s_mov_b32 s11, 0x00020000
    s_min_u32 s46, s35, 15
    s_lshl_b32 s46, s46, 1
    s_lshl_b32 s37, s33, 5
    s_add_u32 s46, s46, s37
    s_add_u32 s46, s46, 1
    s_lshl_b32 s37, s46, 15
    s_lshl_b32 s38, s32, 9
    s_add_u32 s37, s37, s38
    s_add_u32 s38, s37, 16384
    v_lshrrev_b32 v48, 3, v0
    v_and_b32 v49, 7, v0
    v_lshlrev_b32 v49, 4, v49
    v_lshl_add_u32 v48, v48, 11, v49
    buffer_load_dwordx4 v[16:19], v48, s[8:11], s37 offen offset:0
    buffer_load_dwordx4 v[20:23], v48, s[8:11], s37 offen offset:128
    buffer_load_dwordx4 v[24:27], v48, s[8:11], s37 offen offset:256
    buffer_load_dwordx4 v[28:31], v48, s[8:11], s37 offen offset:384
    buffer_load_dwordx4 v[32:35], v48, s[8:11], s38 offen offset:0
    buffer_load_dwordx4 v[36:39], v48, s[8:11], s38 offen offset:128
    buffer_load_dwordx4 v[40:43], v48, s[8:11], s38 offen offset:256
    buffer_load_dwordx4 v[44:47], v48, s[8:11], s38 offen offset:384
    s_waitcnt vmcnt(0)
    v_dot2_f32_bf16 v48, v16, s86, 0
    v_dot2_f32_bf16 v49, v16, v16, 0
    v_dot2_f32_bf16 v48, v17, s86, v48
    v_dot2_f32_bf16 v49, v17, v17, v49
    v_dot2_f32_bf16 v48, v18, s86, v48
    v_dot2_f32_bf16 v49, v18, v18, v49
    v_dot2_f32_bf16 v48, v19, s86, v48
    v_dot2_f32_bf16 v49, v19, v19, v49
    v_dot2_f32_bf16 v48, v20, s86, v48
    v_dot2_f32_bf16 v49, v20, v20, v49
    v_dot2_f32_bf16 v48, v21, s86, v48
    v_dot2_f32_bf16 v49, v21, v21, v49
    v_dot2_f32_bf16 v48, v22, s86, v48
    v_dot2_f32_bf16 v49, v22, v22, v49
    v_dot2_f32_bf16 v48, v23, s86, v48
    v_dot2_f32_bf16 v49, v23, v23, v49
    v_dot2_f32_bf16 v50, v24, s86, 0
    v_dot2_f32_bf16 v51, v24, v24, 0
    v_dot2_f32_bf16 v50, v25, s86, v50
    v_dot2_f32_bf16 v51, v25, v25, v51
    v_dot2_f32_bf16 v50, v26, s86, v50
    v_dot2_f32_bf16 v51, v26, v26, v51
    v_dot2_f32_bf16 v50, v27, s86, v50
    v_dot2_f32_bf16 v51, v27, v27, v51
    v_dot2_f32_bf16 v50, v28, s86, v50
    v_dot2_f32_bf16 v51, v28, v28, v51
    v_dot2_f32_bf16 v50, v29, s86, v50
    v_dot2_f32_bf16 v51, v29, v29, v51
    v_dot2_f32_bf16 v50, v30, s86, v50
    v_dot2_f32_bf16 v51, v30, v30, v51
    v_dot2_f32_bf16 v50, v31, s86, v50
    v_dot2_f32_bf16 v51, v31, v31, v51
    v_dot2_f32_bf16 v52, v32, s86, 0
    v_dot2_f32_bf16 v53, v32, v32, 0
    v_dot2_f32_bf16 v52, v33, s86, v52
    v_dot2_f32_bf16 v53, v33, v33, v53
    v_dot2_f32_bf16 v52, v34, s86, v52
    v_dot2_f32_bf16 v53, v34, v34, v53
    v_dot2_f32_bf16 v52, v35, s86, v52
    v_dot2_f32_bf16 v53, v35, v35, v53
    v_dot2_f32_bf16 v52, v36, s86, v52
    v_dot2_f32_bf16 v53, v36, v36, v53
    v_dot2_f32_bf16 v52, v37, s86, v52
    v_dot2_f32_bf16 v53, v37, v37, v53
    v_dot2_f32_bf16 v52, v38, s86, v52
    v_dot2_f32_bf16 v53, v38, v38, v53
    v_dot2_f32_bf16 v52, v39, s86, v52
    v_dot2_f32_bf16 v53, v39, v39, v53
    v_dot2_f32_bf16 v54, v40, s86, 0
    v_dot2_f32_bf16 v55, v40, v40, 0
    v_dot2_f32_bf16 v54, v41, s86, v54
    v_dot2_f32_bf16 v55, v41, v41, v55
    v_dot2_f32_bf16 v54, v42, s86, v54
    v_dot2_f32_bf16 v55, v42, v42, v55
    v_dot2_f32_bf16 v54, v43, s86, v54
    v_dot2_f32_bf16 v55, v43, v43, v55
    v_dot2_f32_bf16 v54, v44, s86, v54
    v_dot2_f32_bf16 v55, v44, v44, v55
    v_dot2_f32_bf16 v54, v45, s86, v54
    v_dot2_f32_bf16 v55, v45, v45, v55
    v_dot2_f32_bf16 v54, v46, s86, v54
    v_dot2_f32_bf16 v55, v46, v46, v55
    v_dot2_f32_bf16 v54, v47, s86, v54
    v_dot2_f32_bf16 v55, v47, v47, v55
    v_add_f32_dpp v48, v48, v48 quad_perm:[1,0,3,2] row_mask:0xf bank_mask:0xf
    v_add_f32_dpp v49, v49, v49 quad_perm:[1,0,3,2] row_mask:0xf bank_mask:0xf
    v_add_f32_dpp v50, v50, v50 quad_perm:[1,0,3,2] row_mask:0xf bank_mask:0xf
    v_add_f32_dpp v51, v51, v51 quad_perm:[1,0,3,2] row_mask:0xf bank_mask:0xf
    v_add_f32_dpp v52, v52, v52 quad_perm:[1,0,3,2] row_mask:0xf bank_mask:0xf
    v_add_f32_dpp v53, v53, v53 quad_perm:[1,0,3,2] row_mask:0xf bank_mask:0xf
    v_add_f32_dpp v54, v54, v54 quad_perm:[1,0,3,2] row_mask:0xf bank_mask:0xf
    v_add_f32_dpp v55, v55, v55 quad_perm:[1,0,3,2] row_mask:0xf bank_mask:0xf
    v_add_f32_dpp v48, v48, v48 quad_perm:[2,3,0,1] row_mask:0xf bank_mask:0xf
    v_add_f32_dpp v49, v49, v49 quad_perm:[2,3,0,1] row_mask:0xf bank_mask:0xf
    v_add_f32_dpp v50, v50, v50 quad_perm:[2,3,0,1] row_mask:0xf bank_mask:0xf
    v_add_f32_dpp v51, v51, v51 quad_perm:[2,3,0,1] row_mask:0xf bank_mask:0xf
    v_add_f32_dpp v52, v52, v52 quad_perm:[2,3,0,1] row_mask:0xf bank_mask:0xf
    v_add_f32_dpp v53, v53, v53 quad_perm:[2,3,0,1] row_mask:0xf bank_mask:0xf
    v_add_f32_dpp v54, v54, v54 quad_perm:[2,3,0,1] row_mask:0xf bank_mask:0xf
    v_add_f32_dpp v55, v55, v55 quad_perm:[2,3,0,1] row_mask:0xf bank_mask:0xf
    v_add_f32_dpp v48, v48, v48 row_half_mirror row_mask:0xf bank_mask:0xf
    v_add_f32_dpp v49, v49, v49 row_half_mirror row_mask:0xf bank_mask:0xf
    v_add_f32_dpp v50, v50, v50 row_half_mirror row_mask:0xf bank_mask:0xf
    v_add_f32_dpp v51, v51, v51 row_half_mirror row_mask:0xf bank_mask:0xf
    v_add_f32_dpp v52, v52, v52 row_half_mirror row_mask:0xf bank_mask:0xf
    v_add_f32_dpp v53, v53, v53 row_half_mirror row_mask:0xf bank_mask:0xf
    v_add_f32_dpp v54, v54, v54 row_half_mirror row_mask:0xf bank_mask:0xf
    v_add_f32_dpp v55, v55, v55 row_half_mirror row_mask:0xf bank_mask:0xf
    s_mov_b32 exec_lo, 0x2020202
    s_mov_b32 exec_hi, 0x2020202
    v_mov_b32 v48, v50
    v_mov_b32 v49, v51
    s_mov_b32 exec_lo, 0x4040404
    s_mov_b32 exec_hi, 0x4040404
    v_mov_b32 v48, v52
    v_mov_b32 v49, v53
    s_mov_b32 exec_lo, 0x8080808
    s_mov_b32 exec_hi, 0x8080808
    v_mov_b32 v48, v54
    v_mov_b32 v49, v55
    s_mov_b64 exec, -1
    v_min_u32 v48, -2, v48
    v_min_u32 v49, -2, v49
    v_and_b32 v50, 1, v0
    v_lshlrev_b32 v50, 7, v50
    v_bfe_u32 v51, v0, 1, 1
    v_lshl_add_u32 v50, v51, 6, v50
    v_and_b32 v51, 0x38, v0
    v_add_u32 v50, v51, v50
    s_sub_u32 s46, 127, s46
    s_lshl_b32 s46, s46, 10
    s_lshl_b32 s37, s32, 8
    s_add_u32 s46, s46, s37
    s_add_u32 s46, s46, 0x5400000
    s_cmp_lt_u32 s35, 16
    s_cselect_b32 s46, s46, 0x8000000
    s_mov_b32 exec_lo, 0x0f0f0f0f
    s_mov_b32 exec_hi, 0x0f0f0f0f
    buffer_store_dwordx2 v[48:49], v50, s[16:19], s46 offen sc1
    s_mov_b64 exec, -1
    s_lshr_b32 s51, s35, 2
    s_and_b32 s87, s35, 3
    s_mul_i32 s54, s51, 1441792
    s_lshl_b32 s37, s87, 9
    s_add_u32 s54, s54, s37
    s_mov_b32 s12, s76
    s_mov_b32 s13, s77
    s_mov_b32 s14, 0x700000
    s_mov_b32 s15, 0x00020000
    v_lshrrev_b32 v64, 3, v0
    v_and_b32 v65, 2, v64
    v_lshlrev_b32 v65, 1, v65
    v_and_b32 v66, 7, v0
    v_xor_b32 v65, v65, v66
    v_mul_u32_u24 v64, 2048, v64
    v_lshl_add_u32 v64, v65, 4, v64
    s_mul_i32 s38, s32, 8
    s_add_u32 s39, s38, 0
    s_and_b32 s37, s39, 7
    s_mul_i32 s37, s37, 16384
    s_lshr_b32 s39, s39, 3
    s_mul_i32 s39, s39, 128
    s_add_u32 s39, s39, s37
    v_add_u32 v48, s39, v64
    s_add_u32 s39, s38, 1
    s_and_b32 s37, s39, 7
    s_mul_i32 s37, s37, 16384
    s_lshr_b32 s39, s39, 3
    s_mul_i32 s39, s39, 128
    s_add_u32 s39, s39, s37
    v_add_u32 v49, s39, v64
    s_add_u32 s39, s38, 2
    s_and_b32 s37, s39, 7
    s_mul_i32 s37, s37, 16384
    s_lshr_b32 s39, s39, 3
    s_mul_i32 s39, s39, 128
    s_add_u32 s39, s39, s37
    v_add_u32 v50, s39, v64
    s_add_u32 s39, s38, 3
    s_and_b32 s37, s39, 7
    s_mul_i32 s37, s37, 16384
    s_lshr_b32 s39, s39, 3
    s_mul_i32 s39, s39, 128
    s_add_u32 s39, s39, s37
    v_add_u32 v51, s39, v64
    s_add_u32 s39, s38, 4
    s_and_b32 s37, s39, 7
    s_mul_i32 s37, s37, 16384
    s_lshr_b32 s39, s39, 3
    s_mul_i32 s39, s39, 128
    s_add_u32 s39, s39, s37
    v_add_u32 v52, s39, v64
    s_add_u32 s39, s38, 5
    s_and_b32 s37, s39, 7
    s_mul_i32 s37, s37, 16384
    s_lshr_b32 s39, s39, 3
    s_mul_i32 s39, s39, 128
    s_add_u32 s39, s39, s37
    v_add_u32 v53, s39, v64
    s_add_u32 s39, s38, 6
    s_and_b32 s37, s39, 7
    s_mul_i32 s37, s37, 16384
    s_lshr_b32 s39, s39, 3
    s_mul_i32 s39, s39, 128
    s_add_u32 s39, s39, s37
    v_add_u32 v54, s39, v64
    s_add_u32 s39, s38, 7
    s_and_b32 s37, s39, 7
    s_mul_i32 s37, s37, 16384
    s_lshr_b32 s39, s39, 3
    s_mul_i32 s39, s39, 128
    s_add_u32 s39, s39, s37
    v_add_u32 v55, s39, v64
    s_mul_i32 s42, s32, 8192
    s_add_u32 m0, s42, 0
    s_nop 0
    buffer_load_dwordx4 v48, s[12:15], s54 offen lds
    s_add_u32 m0, s42, 1024
    s_nop 0
    buffer_load_dwordx4 v49, s[12:15], s54 offen lds
    s_add_u32 m0, s42, 2048
    s_nop 0
    buffer_load_dwordx4 v50, s[12:15], s54 offen lds
    s_add_u32 m0, s42, 3072
    s_nop 0
    buffer_load_dwordx4 v51, s[12:15], s54 offen lds
    s_add_u32 m0, s42, 4096
    s_nop 0
    buffer_load_dwordx4 v52, s[12:15], s54 offen lds
    s_add_u32 m0, s42, 5120
    s_nop 0
    buffer_load_dwordx4 v53, s[12:15], s54 offen lds
    s_add_u32 m0, s42, 6144
    s_nop 0
    buffer_load_dwordx4 v54, s[12:15], s54 offen lds
    s_add_u32 m0, s42, 7168
    s_nop 0
    buffer_load_dwordx4 v55, s[12:15], s54 offen lds
    s_add_u32 s54, s54, 131072
    s_add_u32 m0, s42, 32768
    s_nop 0
    buffer_load_dwordx4 v48, s[12:15], s54 offen lds
    s_add_u32 m0, s42, 33792
    s_nop 0
    buffer_load_dwordx4 v49, s[12:15], s54 offen lds
    s_add_u32 m0, s42, 34816
    s_nop 0
    buffer_load_dwordx4 v50, s[12:15], s54 offen lds
    s_add_u32 m0, s42, 35840
    s_nop 0
    buffer_load_dwordx4 v51, s[12:15], s54 offen lds
    s_add_u32 m0, s42, 36864
    s_nop 0
    buffer_load_dwordx4 v52, s[12:15], s54 offen lds
    s_add_u32 m0, s42, 37888
    s_nop 0
    buffer_load_dwordx4 v53, s[12:15], s54 offen lds
    s_add_u32 m0, s42, 38912
    s_nop 0
    buffer_load_dwordx4 v54, s[12:15], s54 offen lds
    s_add_u32 m0, s42, 39936
    s_nop 0
    buffer_load_dwordx4 v55, s[12:15], s54 offen lds
    s_add_u32 s54, s54, 131072
    s_add_u32 m0, s42, 65536
    s_nop 0
    buffer_load_dwordx4 v48, s[12:15], s54 offen lds
    s_add_u32 m0, s42, 66560
    s_nop 0
    buffer_load_dwordx4 v49, s[12:15], s54 offen lds
    s_add_u32 m0, s42, 67584
    s_nop 0
    buffer_load_dwordx4 v50, s[12:15], s54 offen lds
    s_add_u32 m0, s42, 68608
    s_nop 0
    buffer_load_dwordx4 v51, s[12:15], s54 offen lds
    s_add_u32 m0, s42, 69632
    s_nop 0
    buffer_load_dwordx4 v52, s[12:15], s54 offen lds
    s_add_u32 m0, s42, 70656
    s_nop 0
    buffer_load_dwordx4 v53, s[12:15], s54 offen lds
    s_add_u32 m0, s42, 71680
    s_nop 0
    buffer_load_dwordx4 v54, s[12:15], s54 offen lds
    s_add_u32 m0, s42, 72704
    s_nop 0
    buffer_load_dwordx4 v55, s[12:15], s54 offen lds
    s_add_u32 s54, s54, 131072
    s_add_u32 m0, s42, 98304
    s_nop 0
    buffer_load_dwordx4 v48, s[12:15], s54 offen lds
    s_add_u32 m0, s42, 99328
    s_nop 0
    buffer_load_dwordx4 v49, s[12:15], s54 offen lds
    s_add_u32 m0, s42, 100352
    s_nop 0
    buffer_load_dwordx4 v50, s[12:15], s54 offen lds
    s_add_u32 m0, s42, 101376
    s_nop 0
    buffer_load_dwordx4 v51, s[12:15], s54 offen lds
    s_add_u32 m0, s42, 102400
    s_nop 0
    buffer_load_dwordx4 v52, s[12:15], s54 offen lds
    s_add_u32 m0, s42, 103424
    s_nop 0
    buffer_load_dwordx4 v53, s[12:15], s54 offen lds
    s_add_u32 m0, s42, 104448
    s_nop 0
    buffer_load_dwordx4 v54, s[12:15], s54 offen lds
    s_add_u32 m0, s42, 105472
    s_nop 0
    buffer_load_dwordx4 v55, s[12:15], s54 offen lds
    s_add_u32 s54, s54, 131072
    v_lshrrev_b32 v64, 4, v0
    v_bfe_u32 v65, v0, 2, 2
    v_lshl_add_u32 v64, v64, 3, v65
    v_lshlrev_b32 v64, 7, v64
    v_lshrrev_b32 v65, 1, v65
    v_lshl_add_u32 v64, v65, 6, v64
    v_and_b32 v65, 3, v0
    v_lshl_add_u32 v64, v65, 4, v64
    s_lshl_b32 s37, s32, 13
    s_and_b32 s38, s51, 2
    s_lshl_b32 s38, s38, 5
    s_xor_b32 s38, s38, 0
    s_add_u32 s37, s37, s38
    v_xor_b32 v56, s37, v64
    s_lshl_b32 s37, s32, 13
    s_and_b32 s38, s51, 2
    s_lshl_b32 s38, s38, 5
    s_xor_b32 s38, s38, 8
    s_add_u32 s37, s37, s38
    v_xor_b32 v57, s37, v64
    s_lshl_b32 s37, s32, 13
    s_and_b32 s38, s51, 2
    s_lshl_b32 s38, s38, 5
    s_xor_b32 s38, s38, 64
    s_add_u32 s37, s37, s38
    v_xor_b32 v58, s37, v64
    s_lshl_b32 s37, s32, 13
    s_and_b32 s38, s51, 2
    s_lshl_b32 s38, s38, 5
    s_xor_b32 s38, s38, 72
    s_add_u32 s37, s37, s38
    v_xor_b32 v59, s37, v64
    s_and_b32 s39, s51, 1
    s_lshl_b32 s37, s39, 10
    v_add_u32 v2, s37, v1
    v_xor_b32 v3, 1024, v2
    v_add_u32 v4, 98304, v2
    v_add_u32 v5, 98304, v3
    s_mul_i32 s38, s51, 11*43
    s_lshr_b32 s38, s38, 7
    s_add_u32 s38, s38, 24
    s_lshl_b32 s37, s33, 6
    s_add_u32 s37, s37, s38
    s_lshl_b32 s37, s37, 8
    v_lshl_add_u32 v6, v0, 8, s37
    s_cmp_eq_u32 s32, 0
    s_cselect_b32 s37, 5, 0
    v_cmp_le_u32 vcc, s37, v0
    s_nop 1
    v_cndmask_b32 v6, v6, 2.0, vcc
    s_mul_i32 s43, s32, 3072
    s_lshl_b32 s88, s32, 11
    s_sub_u32 s89, s88, s43
    s_mul_i32 s41, s33, 7340032
    s_add_u32 s41, s41, 0x1000000
    s_mul_i32 s37, s51, 45056
    s_add_u32 s41, s41, s37
    s_add_u32 s41, s41, s43
    s_mul_i32 s90, s33, 8388608
    s_add_u32 s90, s90, 0x2fc0000
    s_lshl_b32 s37, s87, 16
    s_add_u32 s90, s90, s37
    s_lshl_b32 s37, s32, 12
    s_add_u32 s90, s90, s37
    s_and_b32 s37, s51, 3
    s_lshl_b32 s37, s37, 14
    s_add_u32 s90, s90, s37
    v_mov_b32 v104, 0
    v_mov_b32 v105, 0
    v_mov_b32 v106, 0
    v_mov_b32 v107, 0
    v_mov_b32 v108, 0
    v_mov_b32 v109, 0
    v_mov_b32 v110, 0
    v_mov_b32 v111, 0
    v_mov_b32 v17, 0x3f80
    v_and_b32 v16, 1, v0
    v_lshlrev_b32 v16, 4, v16
    v_lshlrev_b32 v16, v16, v17
    s_mov_b32 exec_lo, 0x300003
    s_mov_b32 exec_hi, 0x30000300
    v_mov_b32 v104, v16
    v_mov_b32 v110, v16
    s_mov_b32 exec_lo, 0xc0000c
    s_mov_b32 exec_hi, 0xc0000c00
    v_mov_b32 v105, v16
    v_mov_b32 v111, v16
    s_mov_b64 exec, -1
    s_add_u32 s38, s87, 44
    s_lshl_b32 s37, s33, 6
    s_add_u32 s37, s37, s38
    s_lshl_b32 s37, s37, 8
    v_lshl_add_u32 v8, v0, 10, s37
    s_cmp_eq_u32 s32, 0
    s_cselect_b32 s37, 5, 0
    v_cmp_le_u32 vcc, s37, v0
    s_nop 1
    v_cndmask_b32 v8, v8, 2.0, vcc
    s_lshl_b32 s38, s87, 2
    s_add_u32 s38, s38, s32
    s_lshl_b32 s38, s38, 1
    s_lshr_b32 s37, s51, 1
    s_add_u32 s38, s38, s37
    s_mul_i32 s53, s33, 2097152
    s_add_u32 s53, s53, 0x7f0000
    s_lshl_b32 s37, s38, 11
    s_add_u32 s53, s53, s37
    s_lshl_b32 s37, s39, 10
    s_add_u32 s53, s53, s37
    v_and_b32 v16, 15, v0
    v_and_b32 v17, 0x30, v0
    s_lshl_b32 s38, s38, 6
    s_mov_b32 s8, s78
    s_mov_b32 s9, s79
    s_mov_b32 s10, 0x800
    s_mov_b32 s11, 0x00020000
    buffer_load_dwordx4 v[24:27], v17, s[8:11], s38 offen
    v_lshl_add_u32 v9, v16, 11, v17
    v_add_u32 v9, s38, v9
    s_lshl_b32 s50, s33, 5
    s_add_u32 s50, s50, 31
    s_sub_u32 s50, s50, s39
    v_bfe_u32 v17, v0, 4, 1
    v_lshl_add_u32 v16, v16, 1, v17
    s_lshl_b32 s37, s32, 2
    s_add_u32 s37, s37, 65536
    v_lshl_add_u32 v10, v16, 4, s37
    v_and_b32 v16, 31, v0
    v_lshrrev_b32 v12, 5, v0
    v_lshlrev_b32 v12, 30, v12
    v_lshl_add_u32 v12, v16, 2, v12
    v_lshlrev_b32 v16, 4, v16
    v_add_u32 v11, 65536, v16
    s_lshl_b32 s37, s87, 1
    s_lshr_b32 s38, s51, 1
    s_add_u32 s37, s37, s38
    s_lshl_b32 s37, s37, 7
    s_add_u32 s55, s37, 0x543fc00
    s_cmp_eq_u32 s32, 2
    s_cselect_b32 s55, s55, 0x8100000
    v_add_u32 v60, 0, v56
    v_add_u32 v61, 0, v57
    v_add_u32 v62, 0, v58
    v_add_u32 v63, 0, v59
    s_waitcnt vmcnt(25)
    s_barrier
    s_cmp_lg_u32 s32, 3
    s_cbranch_scc1 L_arr38
    s_mov_b32 s20, s82
    s_mov_b32 s21, s83
    s_mov_b32 s22, 0x100
    s_mov_b32 s23, 0x00020000
    s_and_b32 s37, s2, 15
    s_lshl_b32 s37, s37, 4
    v_mov_b32 v123, 1
    buffer_atomic_add v123, v124, s[20:23], s37 offen
L_arr38:
    ds_read_b64_tr_b16 a[0:1], v60 offset:0
    ds_read_b64_tr_b16 a[2:3], v60 offset:512
    ds_read_b64_tr_b16 a[4:5], v61 offset:0
    ds_read_b64_tr_b16 a[6:7], v61 offset:512
    ds_read_b64_tr_b16 a[8:9], v62 offset:0
    ds_read_b64_tr_b16 a[10:11], v62 offset:512
    ds_read_b64_tr_b16 a[12:13], v63 offset:0
    ds_read_b64_tr_b16 a[14:15], v63 offset:512
    ds_read_b64_tr_b16 a[16:17], v60 offset:4096
    ds_read_b64_tr_b16 a[18:19], v60 offset:4608
    ds_read_b64_tr_b16 a[20:21], v61 offset:4096
    ds_read_b64_tr_b16 a[22:23], v61 offset:4608
    ds_read_b64_tr_b16 a[24:25], v62 offset:4096
    ds_read_b64_tr_b16 a[26:27], v62 offset:4608
    ds_read_b64_tr_b16 a[28:29], v63 offset:4096
    ds_read_b64_tr_b16 a[30:31], v63 offset:4608
    s_add_u32 m0, s42, 131072
    s_nop 0
    buffer_load_dwordx4 v48, s[12:15], s54 offen lds
    s_add_u32 m0, s42, 132096
    s_nop 0
    buffer_load_dwordx4 v49, s[12:15], s54 offen lds
    s_add_u32 m0, s42, 133120
    s_nop 0
    buffer_load_dwordx4 v50, s[12:15], s54 offen lds
    s_add_u32 m0, s42, 134144
    s_nop 0
    buffer_load_dwordx4 v51, s[12:15], s54 offen lds
    s_add_u32 m0, s42, 135168
    s_nop 0
    buffer_load_dwordx4 v52, s[12:15], s54 offen lds
    s_add_u32 m0, s42, 136192
    s_nop 0
    buffer_load_dwordx4 v53, s[12:15], s54 offen lds
    s_add_u32 m0, s42, 137216
    s_nop 0
    buffer_load_dwordx4 v54, s[12:15], s54 offen lds
    s_add_u32 m0, s42, 138240
    s_nop 0
    buffer_load_dwordx4 v55, s[12:15], s54 offen lds
    s_add_u32 s54, s54, 131072
    s_waitcnt lgkmcnt(0)
    v_add_u32 v60, 32768, v56
    v_add_u32 v61, 32768, v57
    v_add_u32 v62, 32768, v58
    v_add_u32 v63, 32768, v59
    s_waitcnt vmcnt(25)
    s_barrier
    ds_read_b64_tr_b16 a[32:33], v60 offset:0
    ds_read_b64_tr_b16 a[34:35], v60 offset:512
    ds_read_b64_tr_b16 a[36:37], v61 offset:0
    ds_read_b64_tr_b16 a[38:39], v61 offset:512
    ds_read_b64_tr_b16 a[40:41], v62 offset:0
    ds_read_b64_tr_b16 a[42:43], v62 offset:512
    ds_read_b64_tr_b16 a[44:45], v63 offset:0
    ds_read_b64_tr_b16 a[46:47], v63 offset:512
    ds_read_b64_tr_b16 a[48:49], v60 offset:4096
    ds_read_b64_tr_b16 a[50:51], v60 offset:4608
    ds_read_b64_tr_b16 a[52:53], v61 offset:4096
    ds_read_b64_tr_b16 a[54:55], v61 offset:4608
    ds_read_b64_tr_b16 a[56:57], v62 offset:4096
    ds_read_b64_tr_b16 a[58:59], v62 offset:4608
    ds_read_b64_tr_b16 a[60:61], v63 offset:4096
    ds_read_b64_tr_b16 a[62:63], v63 offset:4608
    s_add_u32 m0, s42, 0
    s_nop 0
    buffer_load_dwordx4 v48, s[12:15], s54 offen lds
    s_add_u32 m0, s42, 1024
    s_nop 0
    buffer_load_dwordx4 v49, s[12:15], s54 offen lds
    s_add_u32 m0, s42, 2048
    s_nop 0
    buffer_load_dwordx4 v50, s[12:15], s54 offen lds
    s_add_u32 m0, s42, 3072
    s_nop 0
    buffer_load_dwordx4 v51, s[12:15], s54 offen lds
    s_add_u32 m0, s42, 4096
    s_nop 0
    buffer_load_dwordx4 v52, s[12:15], s54 offen lds
    s_add_u32 m0, s42, 5120
    s_nop 0
    buffer_load_dwordx4 v53, s[12:15], s54 offen lds
    s_add_u32 m0, s42, 6144
    s_nop 0
    buffer_load_dwordx4 v54, s[12:15], s54 offen lds
    s_add_u32 m0, s42, 7168
    s_nop 0
    buffer_load_dwordx4 v55, s[12:15], s54 offen lds
    s_add_u32 s54, s54, 131072
    s_waitcnt lgkmcnt(0)
    v_add_u32 v60, 65536, v56
    v_add_u32 v61, 65536, v57
    v_add_u32 v62, 65536, v58
    v_add_u32 v63, 65536, v59
    s_waitcnt vmcnt(25)
    s_barrier
    ds_read_b64_tr_b16 a[64:65], v60 offset:0
    ds_read_b64_tr_b16 a[66:67], v60 offset:512
    ds_read_b64_tr_b16 a[68:69], v61 offset:0
    ds_read_b64_tr_b16 a[70:71], v61 offset:512
    ds_read_b64_tr_b16 a[72:73], v62 offset:0
    ds_read_b64_tr_b16 a[74:75], v62 offset:512
    ds_read_b64_tr_b16 a[76:77], v63 offset:0
    ds_read_b64_tr_b16 a[78:79], v63 offset:512
    ds_read_b64_tr_b16 a[80:81], v60 offset:4096
    ds_read_b64_tr_b16 a[82:83], v60 offset:4608
    ds_read_b64_tr_b16 a[84:85], v61 offset:4096
    ds_read_b64_tr_b16 a[86:87], v61 offset:4608
    ds_read_b64_tr_b16 a[88:89], v62 offset:4096
    ds_read_b64_tr_b16 a[90:91], v62 offset:4608
    ds_read_b64_tr_b16 a[92:93], v63 offset:4096
    ds_read_b64_tr_b16 a[94:95], v63 offset:4608
    s_add_u32 m0, s42, 32768
    s_nop 0
    buffer_load_dwordx4 v48, s[12:15], s54 offen lds
    s_add_u32 m0, s42, 33792
    s_nop 0
    buffer_load_dwordx4 v49, s[12:15], s54 offen lds
    s_add_u32 m0, s42, 34816
    s_nop 0
    buffer_load_dwordx4 v50, s[12:15], s54 offen lds
    s_add_u32 m0, s42, 35840
    s_nop 0
    buffer_load_dwordx4 v51, s[12:15], s54 offen lds
    s_add_u32 m0, s42, 36864
    s_nop 0
    buffer_load_dwordx4 v52, s[12:15], s54 offen lds
    s_add_u32 m0, s42, 37888
    s_nop 0
    buffer_load_dwordx4 v53, s[12:15], s54 offen lds
    s_add_u32 m0, s42, 38912
    s_nop 0
    buffer_load_dwordx4 v54, s[12:15], s54 offen lds
    s_add_u32 m0, s42, 39936
    s_nop 0
    buffer_load_dwordx4 v55, s[12:15], s54 offen lds
    s_add_u32 s54, s54, 131072
    s_waitcnt lgkmcnt(0)
    v_add_u32 v60, 98304, v56
    v_add_u32 v61, 98304, v57
    v_add_u32 v62, 98304, v58
    v_add_u32 v63, 98304, v59
    s_waitcnt vmcnt(25)
    s_barrier
    ds_read_b64_tr_b16 a[96:97], v60 offset:0
    ds_read_b64_tr_b16 a[98:99], v60 offset:512
    ds_read_b64_tr_b16 a[100:101], v61 offset:0
    ds_read_b64_tr_b16 a[102:103], v61 offset:512
    ds_read_b64_tr_b16 a[104:105], v62 offset:0
    ds_read_b64_tr_b16 a[106:107], v62 offset:512
    ds_read_b64_tr_b16 a[108:109], v63 offset:0
    ds_read_b64_tr_b16 a[110:111], v63 offset:512
    ds_read_b64_tr_b16 a[112:113], v60 offset:4096
    ds_read_b64_tr_b16 a[114:115], v60 offset:4608
    ds_read_b64_tr_b16 a[116:117], v61 offset:4096
    ds_read_b64_tr_b16 a[118:119], v61 offset:4608
    ds_read_b64_tr_b16 a[120:121], v62 offset:4096
    ds_read_b64_tr_b16 a[122:123], v62 offset:4608
    ds_read_b64_tr_b16 a[124:125], v63 offset:4096
    ds_read_b64_tr_b16 a[126:127], v63 offset:4608
    s_add_u32 m0, s42, 65536
    s_nop 0
    buffer_load_dwordx4 v48, s[12:15], s54 offen lds
    s_add_u32 m0, s42, 66560
    s_nop 0
    buffer_load_dwordx4 v49, s[12:15], s54 offen lds
    s_add_u32 m0, s42, 67584
    s_nop 0
    buffer_load_dwordx4 v50, s[12:15], s54 offen lds
    s_add_u32 m0, s42, 68608
    s_nop 0
    buffer_load_dwordx4 v51, s[12:15], s54 offen lds
    s_add_u32 m0, s42, 69632
    s_nop 0
    buffer_load_dwordx4 v52, s[12:15], s54 offen lds
    s_add_u32 m0, s42, 70656
    s_nop 0
    buffer_load_dwordx4 v53, s[12:15], s54 offen lds
    s_add_u32 m0, s42, 71680
    s_nop 0
    buffer_load_dwordx4 v54, s[12:15], s54 offen lds
    s_add_u32 m0, s42, 72704
    s_nop 0
    buffer_load_dwordx4 v55, s[12:15], s54 offen lds
    s_add_u32 s54, s54, 131072
    s_waitcnt lgkmcnt(0)
    v_add_u32 v60, 131072, v56
    v_add_u32 v61, 131072, v57
    v_add_u32 v62, 131072, v58
    v_add_u32 v63, 131072, v59
    s_waitcnt vmcnt(24)
    s_barrier
    ds_read_b64_tr_b16 a[128:129], v60 offset:0
    ds_read_b64_tr_b16 a[130:131], v60 offset:512
    ds_read_b64_tr_b16 a[132:133], v61 offset:0
    ds_read_b64_tr_b16 a[134:135], v61 offset:512
    ds_read_b64_tr_b16 a[136:137], v62 offset:0
    ds_read_b64_tr_b16 a[138:139], v62 offset:512
    ds_read_b64_tr_b16 a[140:141], v63 offset:0
    ds_read_b64_tr_b16 a[142:143], v63 offset:512
    ds_read_b64_tr_b16 a[144:145], v60 offset:4096
    ds_read_b64_tr_b16 a[146:147], v60 offset:4608
    ds_read_b64_tr_b16 a[148:149], v61 offset:4096
    ds_read_b64_tr_b16 a[150:151], v61 offset:4608
    ds_read_b64_tr_b16 a[152:153], v62 offset:4096
    ds_read_b64_tr_b16 a[154:155], v62 offset:4608
    ds_read_b64_tr_b16 a[156:157], v63 offset:4096
    ds_read_b64_tr_b16 a[158:159], v63 offset:4608
    s_add_u32 m0, s42, 98304
    s_nop 0
    buffer_load_dwordx4 v48, s[12:15], s54 offen lds
    s_add_u32 m0, s42, 99328
    s_nop 0
    buffer_load_dwordx4 v49, s[12:15], s54 offen lds
    s_add_u32 m0, s42, 100352
    s_nop 0
    buffer_load_dwordx4 v50, s[12:15], s54 offen lds
    s_add_u32 m0, s42, 101376
    s_nop 0
    buffer_load_dwordx4 v51, s[12:15], s54 offen lds
    s_add_u32 m0, s42, 102400
    s_nop 0
    buffer_load_dwordx4 v52, s[12:15], s54 offen lds
    s_add_u32 m0, s42, 103424
    s_nop 0
    buffer_load_dwordx4 v53, s[12:15], s54 offen lds
    s_add_u32 m0, s42, 104448
    s_nop 0
    buffer_load_dwordx4 v54, s[12:15], s54 offen lds
    s_add_u32 m0, s42, 105472
    s_nop 0
    buffer_load_dwordx4 v55, s[12:15], s54 offen lds
    s_add_u32 s54, s54, 131072
    s_waitcnt lgkmcnt(0)
    v_add_u32 v60, 0, v56
    v_add_u32 v61, 0, v57
    v_add_u32 v62, 0, v58
    v_add_u32 v63, 0, v59
    s_waitcnt vmcnt(24)
    s_barrier
    ds_read_b64_tr_b16 a[160:161], v60 offset:0
    ds_read_b64_tr_b16 a[162:163], v60 offset:512
    ds_read_b64_tr_b16 a[164:165], v61 offset:0
    ds_read_b64_tr_b16 a[166:167], v61 offset:512
    ds_read_b64_tr_b16 a[168:169], v62 offset:0
    ds_read_b64_tr_b16 a[170:171], v62 offset:512
    ds_read_b64_tr_b16 a[172:173], v63 offset:0
    ds_read_b64_tr_b16 a[174:175], v63 offset:512
    ds_read_b64_tr_b16 a[176:177], v60 offset:4096
    ds_read_b64_tr_b16 a[178:179], v60 offset:4608
    ds_read_b64_tr_b16 a[180:181], v61 offset:4096
    ds_read_b64_tr_b16 a[182:183], v61 offset:4608
    ds_read_b64_tr_b16 a[184:185], v62 offset:4096
    ds_read_b64_tr_b16 a[186:187], v62 offset:4608
    ds_read_b64_tr_b16 a[188:189], v63 offset:4096
    ds_read_b64_tr_b16 a[190:191], v63 offset:4608
    s_add_u32 m0, s42, 131072
    s_nop 0
    buffer_load_dwordx4 v48, s[12:15], s54 offen lds
    s_add_u32 m0, s42, 132096
    s_nop 0
    buffer_load_dwordx4 v49, s[12:15], s54 offen lds
    s_add_u32 m0, s42, 133120
    s_nop 0
    buffer_load_dwordx4 v50, s[12:15], s54 offen lds
    s_add_u32 m0, s42, 134144
    s_nop 0
    buffer_load_dwordx4 v51, s[12:15], s54 offen lds
    s_add_u32 m0, s42, 135168
    s_nop 0
    buffer_load_dwordx4 v52, s[12:15], s54 offen lds
    s_add_u32 m0, s42, 136192
    s_nop 0
    buffer_load_dwordx4 v53, s[12:15], s54 offen lds
    s_add_u32 m0, s42, 137216
    s_nop 0
    buffer_load_dwordx4 v54, s[12:15], s54 offen lds
    s_add_u32 m0, s42, 138240
    s_nop 0
    buffer_load_dwordx4 v55, s[12:15], s54 offen lds
    s_add_u32 s54, s54, 131072
    s_waitcnt lgkmcnt(0)
    v_add_u32 v60, 32768, v56
    v_add_u32 v61, 32768, v57
    v_add_u32 v62, 32768, v58
    v_add_u32 v63, 32768, v59
    s_waitcnt vmcnt(24)
    s_barrier
    ds_read_b64_tr_b16 a[192:193], v60 offset:0
    ds_read_b64_tr_b16 a[194:195], v60 offset:512
    ds_read_b64_tr_b16 a[196:197], v61 offset:0
    ds_read_b64_tr_b16 a[198:199], v61 offset:512
    ds_read_b64_tr_b16 a[200:201], v62 offset:0
    ds_read_b64_tr_b16 a[202:203], v62 offset:512
    ds_read_b64_tr_b16 a[204:205], v63 offset:0
    ds_read_b64_tr_b16 a[206:207], v63 offset:512
    ds_read_b64_tr_b16 a[208:209], v60 offset:4096
    ds_read_b64_tr_b16 a[210:211], v60 offset:4608
    ds_read_b64_tr_b16 a[212:213], v61 offset:4096
    ds_read_b64_tr_b16 a[214:215], v61 offset:4608
    ds_read_b64_tr_b16 a[216:217], v62 offset:4096
    ds_read_b64_tr_b16 a[218:219], v62 offset:4608
    ds_read_b64_tr_b16 a[220:221], v63 offset:4096
    ds_read_b64_tr_b16 a[222:223], v63 offset:4608
    s_add_u32 m0, s42, 0
    s_nop 0
    buffer_load_dwordx4 v48, s[12:15], s54 offen lds
    s_add_u32 m0, s42, 1024
    s_nop 0
    buffer_load_dwordx4 v49, s[12:15], s54 offen lds
    s_add_u32 m0, s42, 2048
    s_nop 0
    buffer_load_dwordx4 v50, s[12:15], s54 offen lds
    s_add_u32 m0, s42, 3072
    s_nop 0
    buffer_load_dwordx4 v51, s[12:15], s54 offen lds
    s_add_u32 m0, s42, 4096
    s_nop 0
    buffer_load_dwordx4 v52, s[12:15], s54 offen lds
    s_add_u32 m0, s42, 5120
    s_nop 0
    buffer_load_dwordx4 v53, s[12:15], s54 offen lds
    s_add_u32 m0, s42, 6144
    s_nop 0
    buffer_load_dwordx4 v54, s[12:15], s54 offen lds
    s_add_u32 m0, s42, 7168
    s_nop 0
    buffer_load_dwordx4 v55, s[12:15], s54 offen lds
    s_add_u32 s54, s54, 131072
    s_waitcnt lgkmcnt(0)
    v_add_u32 v60, 65536, v56
    v_add_u32 v61, 65536, v57
    v_add_u32 v62, 65536, v58
    v_add_u32 v63, 65536, v59
    s_waitcnt vmcnt(24)
    s_barrier
    ds_read_b64_tr_b16 a[224:225], v60 offset:0
    ds_read_b64_tr_b16 a[226:227], v60 offset:512
    ds_read_b64_tr_b16 a[228:229], v61 offset:0
    ds_read_b64_tr_b16 a[230:231], v61 offset:512
    ds_read_b64_tr_b16 a[232:233], v62 offset:0
    ds_read_b64_tr_b16 a[234:235], v62 offset:512
    ds_read_b64_tr_b16 a[236:237], v63 offset:0
    ds_read_b64_tr_b16 a[238:239], v63 offset:512
    ds_read_b64_tr_b16 a[240:241], v60 offset:4096
    ds_read_b64_tr_b16 a[242:243], v60 offset:4608
    ds_read_b64_tr_b16 a[244:245], v61 offset:4096
    ds_read_b64_tr_b16 a[246:247], v61 offset:4608
    ds_read_b64_tr_b16 a[248:249], v62 offset:4096
    ds_read_b64_tr_b16 a[250:251], v62 offset:4608
    ds_read_b64_tr_b16 a[252:253], v63 offset:4096
    ds_read_b64_tr_b16 a[254:255], v63 offset:4608
    s_waitcnt lgkmcnt(0)
    v_add_u32 v60, 98304, v56
    v_add_u32 v61, 98304, v57
    v_add_u32 v62, 98304, v58
    v_add_u32 v63, 98304, v59
    s_waitcnt vmcnt(16)
    s_barrier
    ds_read_b64_tr_b16 v[160:161], v60 offset:0
    ds_read_b64_tr_b16 v[162:163], v60 offset:512
    ds_read_b64_tr_b16 v[164:165], v61 offset:0
    ds_read_b64_tr_b16 v[166:167], v61 offset:512
    ds_read_b64_tr_b16 v[168:169], v62 offset:0
    ds_read_b64_tr_b16 v[170:171], v62 offset:512
    ds_read_b64_tr_b16 v[172:173], v63 offset:0
    ds_read_b64_tr_b16 v[174:175], v63 offset:512
    ds_read_b64_tr_b16 v[176:177], v60 offset:4096
    ds_read_b64_tr_b16 v[178:179], v60 offset:4608
    ds_read_b64_tr_b16 v[180:181], v61 offset:4096
    ds_read_b64_tr_b16 v[182:183], v61 offset:4608
    ds_read_b64_tr_b16 v[184:185], v62 offset:4096
    ds_read_b64_tr_b16 v[186:187], v62 offset:4608
    ds_read_b64_tr_b16 v[188:189], v63 offset:4096
    ds_read_b64_tr_b16 v[190:191], v63 offset:4608
    s_waitcnt lgkmcnt(0)
    v_add_u32 v60, 131072, v56
    v_add_u32 v61, 131072, v57
    v_add_u32 v62, 131072, v58
    v_add_u32 v63, 131072, v59
    s_waitcnt vmcnt(8)
    s_barrier
    ds_read_b64_tr_b16 v[192:193], v60 offset:0
    ds_read_b64_tr_b16 v[194:195], v60 offset:512
    ds_read_b64_tr_b16 v[196:197], v61 offset:0
    ds_read_b64_tr_b16 v[198:199], v61 offset:512
    ds_read_b64_tr_b16 v[200:201], v62 offset:0
    ds_read_b64_tr_b16 v[202:203], v62 offset:512
    ds_read_b64_tr_b16 v[204:205], v63 offset:0
    ds_read_b64_tr_b16 v[206:207], v63 offset:512
    ds_read_b64_tr_b16 v[208:209], v60 offset:4096
    ds_read_b64_tr_b16 v[210:211], v60 offset:4608
    ds_read_b64_tr_b16 v[212:213], v61 offset:4096
    ds_read_b64_tr_b16 v[214:215], v61 offset:4608
    ds_read_b64_tr_b16 v[216:217], v62 offset:4096
    ds_read_b64_tr_b16 v[218:219], v62 offset:4608
    ds_read_b64_tr_b16 v[220:221], v63 offset:4096
    ds_read_b64_tr_b16 v[222:223], v63 offset:4608
    s_waitcnt lgkmcnt(0)
    v_add_u32 v60, 0, v56
    v_add_u32 v61, 0, v57
    v_add_u32 v62, 0, v58
    v_add_u32 v63, 0, v59
    s_waitcnt vmcnt(0)
    s_barrier
    ds_read_b64_tr_b16 v[224:225], v60 offset:0
    ds_read_b64_tr_b16 v[226:227], v60 offset:512
    ds_read_b64_tr_b16 v[228:229], v61 offset:0
    ds_read_b64_tr_b16 v[230:231], v61 offset:512
    ds_read_b64_tr_b16 v[232:233], v62 offset:0
    ds_read_b64_tr_b16 v[234:235], v62 offset:512
    ds_read_b64_tr_b16 v[236:237], v63 offset:0
    ds_read_b64_tr_b16 v[238:239], v63 offset:512
    ds_read_b64_tr_b16 v[240:241], v60 offset:4096
    ds_read_b64_tr_b16 v[242:243], v60 offset:4608
    ds_read_b64_tr_b16 v[244:245], v61 offset:4096
    ds_read_b64_tr_b16 v[246:247], v61 offset:4608
    ds_read_b64_tr_b16 v[248:249], v62 offset:4096
    ds_read_b64_tr_b16 v[250:251], v62 offset:4608
    ds_read_b64_tr_b16 v[252:253], v63 offset:4096
    ds_read_b64_tr_b16 v[254:255], v63 offset:4608
    s_waitcnt lgkmcnt(0)
    s_barrier
    s_mov_b32 s37, 0xffff0000
    v_lshlrev_b32 v112, 16, v24
    v_and_b32 v113, s37, v24
    v_lshlrev_b32 v114, 16, v25
    v_and_b32 v115, s37, v25
    v_lshlrev_b32 v116, 16, v26
    v_and_b32 v117, s37, v26
    v_lshlrev_b32 v118, 16, v27
    v_and_b32 v119, s37, v27
    s_cmp_lg_u32 s32, 0
    s_cbranch_scc1 L_arv39
    s_mov_b32 s20, s82
    s_mov_b32 s21, s83
    s_mov_b32 s22, 0x100
    s_mov_b32 s23, 0x00020000
    v_and_b32 v80, 15, v0
    v_lshlrev_b32 v80, 4, v80
    buffer_load_dword v81, v80, s[20:23], 0 offen sc1
    s_waitcnt vmcnt(0)
    v_cmp_gt_u32 vcc, 16, v81
    s_cbranch_vccnz L_spin40
L_back41:
L_arv39:
    s_add_u32 s96, s41, 7110656
    s_mov_b32 s45, 0x5560000
    buffer_load_dword v96, v6, s[16:19], s45 offen sc1
    s_waitcnt vmcnt(0)
    v_cmp_ne_u32 vcc, 0, v96
    s_cbranch_vccnz L_spin42
L_back43:
    s_barrier
    s_add_u32 m0, s43, 0
    s_add_u32 s42, s41, 0
    buffer_load_dwordx4 v1, s[16:19], s42 offen offset:0 sc1 lds
    buffer_load_dwordx4 v1, s[16:19], s42 offen offset:1024 sc1 lds
    buffer_load_dwordx4 v1, s[16:19], s42 offen offset:2048 sc1 lds
    s_add_u32 m0, s43, 12288
    s_add_u32 s42, s41, 12288
    buffer_load_dwordx4 v1, s[16:19], s42 offen offset:0 sc1 lds
    buffer_load_dwordx4 v1, s[16:19], s42 offen offset:1024 sc1 lds
    buffer_load_dwordx4 v1, s[16:19], s42 offen offset:2048 sc1 lds
    s_add_u32 m0, s43, 24576
    s_add_u32 s42, s41, 24576
    buffer_load_dwordx4 v1, s[16:19], s42 offen offset:0 sc1 lds
    buffer_load_dwordx4 v1, s[16:19], s42 offen offset:1024 sc1 lds
    buffer_load_dwordx4 v1, s[16:19], s42 offen offset:2048 sc1 lds
    s_add_u32 s45, s45, 131072
    s_waitcnt vmcnt(0) lgkmcnt(0)
    s_barrier
    s_mov_b32 s52, 0x8000000
    s_add_u32 s20, s84, 0x8000000
    s_addc_u32 s21, s85, 0
    s_mov_b32 s22, 0x400000
    s_mov_b32 s23, 0x00020000
    ds_read_b128 v[80:83], v2 offset:0
    ds_read_b128 v[84:87], v3 offset:0
    s_mov_b32 s36, 0
    s_waitcnt lgkmcnt(0)
    s_nop 7
L_bf_b0:
    s_waitcnt lgkmcnt(0)
    v_mfma_f32_16x16x32_bf16 v[16:19], a[0:3], v[80:83], v[112:115]
    ds_read_b128 v[88:91], v2 offset:2048
    s_sub_u32 s47, s45, 393216
    v_mfma_f32_16x16x32_bf16 v[24:27], a[0:3], v[84:87], 0
    ds_read_b128 v[92:95], v3 offset:2048
    buffer_load_dword v13, v8, s[16:19], s47 offen sc1
    v_mfma_f32_16x16x32_bf16 v[28:31], a[4:7], v[84:87], 0
    s_cmp_eq_u32 s36, 0
    s_cselect_b32 s38, 0x8000000, s53
    v_mfma_f32_16x16x32_bf16 v[20:23], a[4:7], v[80:83], v[116:119]
    buffer_load_dwordx4 v[136:139], v1, s[16:19], s38 offen sc1
    s_add_u32 s53, s53, 65536
    v_mfma_f32_16x16x32_bf16 v[32:35], a[8:11], v[80:83], 0
    s_cmp_eq_u32 s36, 0
    s_cselect_b32 s44, 0x8000000, s90
    v_mfma_f32_16x16x32_bf16 v[40:43], a[8:11], v[84:87], 0
    s_xor_b32 s49, s44, 16384
    v_cvt_pk_bf16_f32 v56, v56, v57
    v_mfma_f32_16x16x32_bf16 v[44:47], a[12:15], v[84:87], 0
    v_cvt_pk_bf16_f32 v57, v58, v59
    v_cvt_pk_bf16_f32 v58, v60, v61
    v_mfma_f32_16x16x32_bf16 v[36:39], a[12:15], v[80:83], 0
    v_cvt_pk_bf16_f32 v59, v62, v63
    s_waitcnt lgkmcnt(0)
    v_mfma_f32_16x16x32_bf16 v[16:19], a[16:19], v[88:91], v[16:19]
    ds_read_b128 v[80:83], v2 offset:4096
    buffer_store_dwordx4 v[56:59], v1, s[16:19], s49 offen offset:0 sc1
    v_mfma_f32_16x16x32_bf16 v[24:27], a[16:19], v[92:95], v[24:27]
    ds_read_b128 v[84:87], v3 offset:4096
    s_xor_b32 s49, s44, 32768
    v_mfma_f32_16x16x32_bf16 v[28:31], a[20:23], v[92:95], v[28:31]
    v_cvt_pk_bf16_f32 v64, v64, v65
    v_cvt_pk_bf16_f32 v65, v66, v67
    v_mfma_f32_16x16x32_bf16 v[20:23], a[20:23], v[88:91], v[20:23]
    v_cvt_pk_bf16_f32 v66, v68, v69
    v_cvt_pk_bf16_f32 v67, v70, v71
    v_mfma_f32_16x16x32_bf16 v[32:35], a[24:27], v[88:91], v[32:35]
    buffer_store_dwordx4 v[64:67], v1, s[16:19], s49 offen offset:1024 sc1
    s_xor_b32 s49, s44, 49152
    v_mfma_f32_16x16x32_bf16 v[40:43], a[24:27], v[92:95], v[40:43]
    v_cvt_pk_bf16_f32 v72, v72, v73
    v_cvt_pk_bf16_f32 v73, v74, v75
    v_mfma_f32_16x16x32_bf16 v[44:47], a[28:31], v[92:95], v[44:47]
    v_cvt_pk_bf16_f32 v74, v76, v77
    v_cvt_pk_bf16_f32 v75, v78, v79
    v_mfma_f32_16x16x32_bf16 v[36:39], a[28:31], v[88:91], v[36:39]
    buffer_store_dwordx4 v[72:75], v1, s[16:19], s49 offen offset:2048 sc1
    s_waitcnt lgkmcnt(0)
    v_mfma_f32_16x16x32_bf16 v[16:19], a[32:35], v[80:83], v[16:19]
    ds_read_b128 v[88:91], v2 offset:6144
    s_add_u32 s90, s90, 262144
    v_mfma_f32_16x16x32_bf16 v[24:27], a[32:35], v[84:87], v[24:27]
    ds_read_b128 v[92:95], v3 offset:6144
    s_add_u32 m0, s88, 36864
    v_mfma_f32_16x16x32_bf16 v[28:31], a[36:39], v[84:87], v[28:31]
    s_add_u32 s42, s41, 36864
    s_add_u32 s42, s42, s89
    v_mfma_f32_16x16x32_bf16 v[20:23], a[36:39], v[80:83], v[20:23]
    buffer_load_dwordx4 v1, s[16:19], s42 offen offset:0 sc1 lds
    v_mfma_f32_16x16x32_bf16 v[32:35], a[40:43], v[80:83], v[32:35]
    v_mfma_f32_16x16x32_bf16 v[40:43], a[40:43], v[84:87], v[40:43]
    v_mfma_f32_16x16x32_bf16 v[44:47], a[44:47], v[84:87], v[44:47]
    v_mfma_f32_16x16x32_bf16 v[36:39], a[44:47], v[80:83], v[36:39]
    s_waitcnt lgkmcnt(0)
    v_mfma_f32_16x16x32_bf16 v[16:19], a[48:51], v[88:91], v[16:19]
    ds_read_b128 v[80:83], v2 offset:8192
    v_mfma_f32_16x16x32_bf16 v[24:27], a[48:51], v[92:95], v[24:27]
    ds_read_b128 v[84:87], v3 offset:8192
    buffer_load_dwordx4 v1, s[16:19], s42 offen offset:1024 sc1 lds
    v_mfma_f32_16x16x32_bf16 v[28:31], a[52:55], v[92:95], v[28:31]
    s_add_u32 s41, s41, 229376
    s_min_u32 s41, s41, s96
    v_mfma_f32_16x16x32_bf16 v[20:23], a[52:55], v[88:91], v[20:23]
    v_mfma_f32_16x16x32_bf16 v[32:35], a[56:59], v[88:91], v[32:35]
    v_mfma_f32_16x16x32_bf16 v[40:43], a[56:59], v[92:95], v[40:43]
    v_mfma_f32_16x16x32_bf16 v[44:47], a[60:63], v[92:95], v[44:47]
    v_mfma_f32_16x16x32_bf16 v[36:39], a[60:63], v[88:91], v[36:39]
    s_waitcnt lgkmcnt(0)
    v_mfma_f32_16x16x32_bf16 v[16:19], a[64:67], v[80:83], v[16:19]
    ds_read_b128 v[88:91], v2 offset:10240
    v_mfma_f32_16x16x32_bf16 v[24:27], a[64:67], v[84:87], v[24:27]
    ds_read_b128 v[92:95], v3 offset:10240
    v_mfma_f32_16x16x32_bf16 v[28:31], a[68:71], v[84:87], v[28:31]
    v_mfma_f32_16x16x32_bf16 v[20:23], a[68:71], v[80:83], v[20:23]
    v_mfma_f32_16x16x32_bf16 v[32:35], a[72:75], v[80:83], v[32:35]
    v_mfma_f32_16x16x32_bf16 v[40:43], a[72:75], v[84:87], v[40:43]
    s_waitcnt vmcnt(6)
    v_cmp_ne_u32 vcc, 0, v13
    s_cbranch_vccnz L_spin44
L_back45:
    v_mfma_f32_16x16x32_bf16 v[44:47], a[76:79], v[84:87], v[44:47]
    v_mfma_f32_16x16x32_bf16 v[36:39], a[76:79], v[80:83], v[36:39]
    s_waitcnt vmcnt(8) lgkmcnt(0)
    s_barrier
    v_mfma_f32_16x16x32_bf16 v[16:19], a[80:83], v[88:91], v[16:19]
    ds_read_b128 v[80:83], v2 offset:12288
    s_sub_u32 s48, s90, 524288
    v_mfma_f32_16x16x32_bf16 v[24:27], a[80:83], v[92:95], v[24:27]
    ds_read_b128 v[84:87], v3 offset:12288
    s_cmp_lt_u32 s36, 2
    s_cselect_b32 s48, s52, s48
    v_mfma_f32_16x16x32_bf16 v[28:31], a[84:87], v[92:95], v[28:31]
    buffer_load_dwordx4 v[140:143], v1, s[16:19], s48 offen offset:0 sc1
    buffer_load_dwordx4 v[144:147], v1, s[16:19], s48 offen offset:1024 sc1
    v_mfma_f32_16x16x32_bf16 v[20:23], a[84:87], v[88:91], v[20:23]
    buffer_load_dwordx4 v[148:151], v1, s[16:19], s48 offen offset:2048 sc1
    buffer_load_dwordx4 v[152:155], v1, s[16:19], s48 offen offset:3072 sc1
    v_mfma_f32_16x16x32_bf16 v[32:35], a[88:91], v[88:91], v[32:35]
    s_sub_u32 s47, s36, 2
    s_cmp_lt_u32 s47, 16
    s_cselect_b32 s48, 0x5000000, s52
    v_mfma_f32_16x16x32_bf16 v[40:43], a[88:91], v[92:95], v[40:43]
    s_add_u32 s20, s84, s48
    s_addc_u32 s21, s85, 0
    v_mfma_f32_16x16x32_bf16 v[44:47], a[92:95], v[92:95], v[44:47]
    s_cmp_ge_i32 s47, 16
    s_cselect_b32 s20, s80, s20
    s_cselect_b32 s21, s81, s21
    v_mfma_f32_16x16x32_bf16 v[36:39], a[92:95], v[88:91], v[36:39]
    s_and_b32 s48, s47, 15
    s_waitcnt lgkmcnt(0)
    v_mfma_f32_16x16x32_bf16 v[16:19], a[96:99], v[80:83], v[16:19]
    ds_read_b128 v[88:91], v2 offset:14336
    s_lshl_b32 s48, s48, 1
    v_mfma_f32_16x16x32_bf16 v[24:27], a[96:99], v[84:87], v[24:27]
    ds_read_b128 v[92:95], v3 offset:14336
    s_sub_u32 s48, s50, s48
    v_mfma_f32_16x16x32_bf16 v[28:31], a[100:103], v[84:87], v[28:31]
    s_lshl_b32 s46, s48, 10
    s_sub_u32 s46, s55, s46
    v_mfma_f32_16x16x32_bf16 v[20:23], a[100:103], v[80:83], v[20:23]
    s_cmp_lt_u32 s47, 16
    s_cselect_b32 s46, s46, s52
    v_mfma_f32_16x16x32_bf16 v[32:35], a[104:107], v[80:83], v[32:35]
    s_lshl_b32 s48, s48, 15
    v_mfma_f32_16x16x32_bf16 v[40:43], a[104:107], v[84:87], v[40:43]
    v_mfma_f32_16x16x32_bf16 v[44:47], a[108:111], v[84:87], v[44:47]
    v_mfma_f32_16x16x32_bf16 v[36:39], a[108:111], v[80:83], v[36:39]
    s_waitcnt lgkmcnt(0)
    v_mfma_f32_16x16x32_bf16 v[16:19], a[112:115], v[88:91], v[16:19]
    ds_read_b128 v[80:83], v2 offset:16384
    v_mfma_f32_16x16x32_bf16 v[24:27], a[112:115], v[92:95], v[24:27]
    ds_read_b128 v[84:87], v3 offset:16384
    v_mfma_f32_16x16x32_bf16 v[28:31], a[116:119], v[92:95], v[28:31]
    buffer_load_dword v96, v6, s[16:19], s45 offen sc1
    v_mfma_f32_16x16x32_bf16 v[20:23], a[116:119], v[88:91], v[20:23]
    v_mfma_f32_16x16x32_bf16 v[32:35], a[120:123], v[88:91], v[32:35]
    v_mfma_f32_16x16x32_bf16 v[40:43], a[120:123], v[92:95], v[40:43]
    v_mfma_f32_16x16x32_bf16 v[44:47], a[124:127], v[92:95], v[44:47]
    v_mfma_f32_16x16x32_bf16 v[36:39], a[124:127], v[88:91], v[36:39]
    s_waitcnt lgkmcnt(0)
    v_mfma_f32_16x16x32_bf16 v[16:19], a[128:131], v[80:83], v[16:19]
    ds_read_b128 v[88:91], v2 offset:18432
    v_mfma_f32_16x16x32_bf16 v[24:27], a[128:131], v[84:87], v[24:27]
    ds_read_b128 v[92:95], v3 offset:18432
    v_mfma_f32_16x16x32_bf16 v[28:31], a[132:135], v[84:87], v[28:31]
    v_mfma_f32_16x16x32_bf16 v[20:23], a[132:135], v[80:83], v[20:23]
    v_mfma_f32_16x16x32_bf16 v[32:35], a[136:139], v[80:83], v[32:35]
    v_mfma_f32_16x16x32_bf16 v[40:43], a[136:139], v[84:87], v[40:43]
    v_mfma_f32_16x16x32_bf16 v[44:47], a[140:143], v[84:87], v[44:47]
    v_mfma_f32_16x16x32_bf16 v[36:39], a[140:143], v[80:83], v[36:39]
    s_waitcnt lgkmcnt(0)
    v_mfma_f32_16x16x32_bf16 v[16:19], a[144:147], v[88:91], v[16:19]
    ds_read_b128 v[80:83], v2 offset:20480
    v_mfma_f32_16x16x32_bf16 v[24:27], a[144:147], v[92:95], v[24:27]
    ds_read_b128 v[84:87], v3 offset:20480
    v_mfma_f32_16x16x32_bf16 v[28:31], a[148:151], v[92:95], v[28:31]
    v_mfma_f32_16x16x32_bf16 v[20:23], a[148:151], v[88:91], v[20:23]
    v_mfma_f32_16x16x32_bf16 v[32:35], a[152:155], v[88:91], v[32:35]
    v_mfma_f32_16x16x32_bf16 v[40:43], a[152:155], v[92:95], v[40:43]
    v_mfma_f32_16x16x32_bf16 v[44:47], a[156:159], v[92:95], v[44:47]
    v_mfma_f32_16x16x32_bf16 v[36:39], a[156:159], v[88:91], v[36:39]
    s_waitcnt lgkmcnt(0)
    v_mfma_f32_16x16x32_bf16 v[16:19], a[160:163], v[80:83], v[16:19]
    ds_read_b128 v[88:91], v2 offset:22528
    v_mfma_f32_16x16x32_bf16 v[24:27], a[160:163], v[84:87], v[24:27]
    ds_read_b128 v[92:95], v3 offset:22528
    v_mfma_f32_16x16x32_bf16 v[28:31], a[164:167], v[84:87], v[28:31]
    v_mfma_f32_16x16x32_bf16 v[20:23], a[164:167], v[80:83], v[20:23]
    v_mfma_f32_16x16x32_bf16 v[32:35], a[168:171], v[80:83], v[32:35]
    v_mfma_f32_16x16x32_bf16 v[40:43], a[168:171], v[84:87], v[40:43]
    v_mfma_f32_16x16x32_bf16 v[44:47], a[172:175], v[84:87], v[44:47]
    v_mfma_f32_16x16x32_bf16 v[36:39], a[172:175], v[80:83], v[36:39]
    s_waitcnt lgkmcnt(0)
    v_mfma_f32_16x16x32_bf16 v[16:19], a[176:179], v[88:91], v[16:19]
    ds_read_b128 v[80:83], v2 offset:24576
    v_mfma_f32_16x16x32_bf16 v[24:27], a[176:179], v[92:95], v[24:27]
    ds_read_b128 v[84:87], v3 offset:24576
    v_mfma_f32_16x16x32_bf16 v[28:31], a[180:183], v[92:95], v[28:31]
    v_mfma_f32_16x16x32_bf16 v[20:23], a[180:183], v[88:91], v[20:23]
    v_mfma_f32_16x16x32_bf16 v[32:35], a[184:187], v[88:91], v[32:35]
    v_mfma_f32_16x16x32_bf16 v[40:43], a[184:187], v[92:95], v[40:43]
    v_mfma_f32_16x16x32_bf16 v[44:47], a[188:191], v[92:95], v[44:47]
    v_mfma_f32_16x16x32_bf16 v[36:39], a[188:191], v[88:91], v[36:39]
    s_waitcnt lgkmcnt(0)
    v_mfma_f32_16x16x32_bf16 v[16:19], a[192:195], v[80:83], v[16:19]
    ds_read_b128 v[88:91], v2 offset:26624
    v_mfma_f32_16x16x32_bf16 v[24:27], a[192:195], v[84:87], v[24:27]
    ds_read_b128 v[92:95], v3 offset:26624
    v_mfma_f32_16x16x32_bf16 v[28:31], a[196:199], v[84:87], v[28:31]
    v_mfma_f32_16x16x32_bf16 v[20:23], a[196:199], v[80:83], v[20:23]
    v_mfma_f32_16x16x32_bf16 v[32:35], a[200:203], v[80:83], v[32:35]
    v_mfma_f32_16x16x32_bf16 v[40:43], a[200:203], v[84:87], v[40:43]
    v_mfma_f32_16x16x32_bf16 v[44:47], a[204:207], v[84:87], v[44:47]
    v_mfma_f32_16x16x32_bf16 v[36:39], a[204:207], v[80:83], v[36:39]
    s_waitcnt lgkmcnt(0)
    v_mfma_f32_16x16x32_bf16 v[16:19], a[208:211], v[88:91], v[16:19]
    ds_read_b128 v[80:83], v2 offset:28672
    s_waitcnt vmcnt(0)
    v_mfma_f32_16x16x32_bf16 v[24:27], a[208:211], v[92:95], v[24:27]
    ds_read_b128 v[84:87], v3 offset:28672
    v_cmp_ne_u32 vcc, 0, v96
    s_cbranch_vccnz L_spin46
L_back47:
    v_mfma_f32_16x16x32_bf16 v[28:31], a[212:215], v[92:95], v[28:31]
    s_barrier
    buffer_store_dword v124, v124, s[16:19], s91 offen sc1
    v_mfma_f32_16x16x32_bf16 v[20:23], a[212:215], v[88:91], v[20:23]
    s_add_u32 s91, s91, 131072
    s_add_u32 m0, s43, 98304
    v_mfma_f32_16x16x32_bf16 v[32:35], a[216:219], v[88:91], v[32:35]
    s_add_u32 s42, s41, 0
    buffer_load_dwordx4 v1, s[16:19], s42 offen offset:0 sc1 lds
    v_mfma_f32_16x16x32_bf16 v[40:43], a[216:219], v[92:95], v[40:43]
    v_mfma_f32_16x16x32_bf16 v[44:47], a[220:223], v[92:95], v[44:47]
    buffer_load_dwordx4 v1, s[16:19], s42 offen offset:1024 sc1 lds
    v_mfma_f32_16x16x32_bf16 v[36:39], a[220:223], v[88:91], v[36:39]
    s_waitcnt lgkmcnt(0)
    v_mfma_f32_16x16x32_bf16 v[16:19], a[224:227], v[80:83], v[16:19]
    ds_read_b128 v[88:91], v2 offset:30720
    buffer_load_dwordx4 v1, s[16:19], s42 offen offset:2048 sc1 lds
    v_mfma_f32_16x16x32_bf16 v[24:27], a[224:227], v[84:87], v[24:27]
    ds_read_b128 v[92:95], v3 offset:30720
    s_add_u32 s39, s91, -327680
    v_mfma_f32_16x16x32_bf16 v[28:31], a[228:231], v[84:87], v[28:31]
    buffer_store_dword v124, v124, s[16:19], s39 offen sc1
    v_mfma_f32_16x16x32_bf16 v[20:23], a[228:231], v[80:83], v[20:23]
    v_mfma_f32_16x16x32_bf16 v[32:35], a[232:235], v[80:83], v[32:35]
    s_waitcnt vmcnt(6)
    v_mfma_f32_16x16x32_bf16 v[128:131], v[104:107], v[140:143], v[128:131]
    v_mfma_f32_16x16x32_bf16 v[132:135], v[108:111], v[140:143], v[132:135]
    v_mfma_f32_16x16x32_bf16 v[128:131], v[104:107], v[144:147], v[128:131]
    v_mfma_f32_16x16x32_bf16 v[132:135], v[108:111], v[144:147], v[132:135]
    v_mfma_f32_16x16x32_bf16 v[128:131], v[104:107], v[148:151], v[128:131]
    v_mfma_f32_16x16x32_bf16 v[132:135], v[108:111], v[148:151], v[132:135]
    v_mfma_f32_16x16x32_bf16 v[128:131], v[104:107], v[152:155], v[128:131]
    v_mfma_f32_16x16x32_bf16 v[132:135], v[108:111], v[152:155], v[132:135]
    v_mfma_f32_16x16x32_bf16 v[40:43], a[232:235], v[84:87], v[40:43]
    s_add_u32 m0, s43, 110592
    s_add_u32 s42, s41, 12288
    v_mfma_f32_16x16x32_bf16 v[44:47], a[236:239], v[84:87], v[44:47]
    buffer_load_dwordx4 v1, s[16:19], s42 offen offset:0 sc1 lds
    v_cvt_pk_bf16_f32 v140, v128, v129
    v_mfma_f32_16x16x32_bf16 v[36:39], a[236:239], v[80:83], v[36:39]
    v_cvt_pk_bf16_f32 v141, v130, v131
    s_waitcnt lgkmcnt(0)
    v_mfma_f32_16x16x32_bf16 v[16:19], a[240:243], v[88:91], v[16:19]
    ds_read_b128 v[80:83], v2 offset:32768
    v_cvt_pk_bf16_f32 v142, v132, v133
    v_mfma_f32_16x16x32_bf16 v[24:27], a[240:243], v[92:95], v[24:27]
    ds_read_b128 v[84:87], v3 offset:32768
    v_cvt_pk_bf16_f32 v143, v134, v135
    v_mfma_f32_16x16x32_bf16 v[28:31], a[244:247], v[92:95], v[28:31]
    buffer_store_dwordx4 v[140:143], v9, s[20:23], s48 offen sc1
    v_dot2_f32_bf16 v100, v140, s86, 0
    v_mfma_f32_16x16x32_bf16 v[20:23], a[244:247], v[88:91], v[20:23]
    v_dot2_f32_bf16 v101, v140, v140, 0
    v_dot2_f32_bf16 v100, v141, s86, v100
    v_mfma_f32_16x16x32_bf16 v[32:35], a[248:251], v[88:91], v[32:35]
    buffer_load_dwordx4 v1, s[16:19], s42 offen offset:1024 sc1 lds
    v_dot2_f32_bf16 v101, v141, v141, v101
    v_mfma_f32_16x16x32_bf16 v[40:43], a[248:251], v[92:95], v[40:43]
    v_dot2_f32_bf16 v100, v142, s86, v100
    v_dot2_f32_bf16 v101, v142, v142, v101
    v_mfma_f32_16x16x32_bf16 v[44:47], a[252:255], v[92:95], v[44:47]
    v_dot2_f32_bf16 v100, v143, s86, v100
    v_dot2_f32_bf16 v101, v143, v143, v101
    v_mfma_f32_16x16x32_bf16 v[36:39], a[252:255], v[88:91], v[36:39]
    s_waitcnt lgkmcnt(0)
    v_mfma_f32_16x16x32_bf16 v[16:19], v[160:163], v[80:83], v[16:19]
    ds_read_b128 v[88:91], v2 offset:34816
    v_permlane16_swap_b32 v100, v101
    v_mfma_f32_16x16x32_bf16 v[24:27], v[160:163], v[84:87], v[24:27]
    ds_read_b128 v[92:95], v3 offset:34816
    v_add_f32 v100, v100, v101
    v_mfma_f32_16x16x32_bf16 v[28:31], v[164:167], v[84:87], v[28:31]
    buffer_load_dwordx4 v1, s[16:19], s42 offen offset:2048 sc1 lds
    v_mov_b32 v102, v100
    v_mfma_f32_16x16x32_bf16 v[20:23], v[164:167], v[80:83], v[20:23]
    v_permlane32_swap_b32 v100, v102
    v_add_f32 v100, v100, v102
    v_mfma_f32_16x16x32_bf16 v[32:35], v[168:171], v[80:83], v[32:35]
    ds_write_b32 v10, v100 offset:512
    s_waitcnt vmcnt(19)
    v_mfma_f32_16x16x32_bf16 v[40:43], v[168:171], v[84:87], v[40:43]
    v_mfma_f32_16x16x32_bf16 v[128:131], v[104:107], v[136:139], v[48:51]
    v_mfma_f32_16x16x32_bf16 v[132:135], v[108:111], v[136:139], v[52:55]
    v_mfma_f32_16x16x32_bf16 v[44:47], v[172:175], v[84:87], v[44:47]
    v_mfma_f32_16x16x32_bf16 v[36:39], v[172:175], v[80:83], v[36:39]
    s_add_u32 m0, s43, 122880
    s_waitcnt lgkmcnt(1)
    v_mfma_f32_16x16x32_bf16 v[16:19], v[176:179], v[88:91], v[16:19]
    ds_read_b128 v[80:83], v2 offset:36864
    s_add_u32 s42, s41, 24576
    v_mfma_f32_16x16x32_bf16 v[24:27], v[176:179], v[92:95], v[24:27]
    ds_read_b128 v[84:87], v3 offset:36864
    buffer_load_dwordx4 v1, s[16:19], s42 offen offset:0 sc1 lds
    v_mfma_f32_16x16x32_bf16 v[28:31], v[180:183], v[92:95], v[28:31]
    v_mfma_f32_16x16x32_bf16 v[20:23], v[180:183], v[88:91], v[20:23]
    v_mfma_f32_16x16x32_bf16 v[32:35], v[184:187], v[88:91], v[32:35]
    v_mfma_f32_16x16x32_bf16 v[40:43], v[184:187], v[92:95], v[40:43]
    v_mfma_f32_16x16x32_bf16 v[44:47], v[188:191], v[92:95], v[44:47]
    v_mfma_f32_16x16x32_bf16 v[36:39], v[188:191], v[88:91], v[36:39]
    buffer_load_dwordx4 v1, s[16:19], s42 offen offset:1024 sc1 lds
    s_waitcnt lgkmcnt(0)
    v_mfma_f32_16x16x32_bf16 v[16:19], v[192:195], v[80:83], v[16:19]
    ds_read_b128 v[88:91], v2 offset:38912
    v_mfma_f32_16x16x32_bf16 v[24:27], v[192:195], v[84:87], v[24:27]
    ds_read_b128 v[92:95], v3 offset:38912
    v_mfma_f32_16x16x32_bf16 v[28:31], v[196:199], v[84:87], v[28:31]
    v_mfma_f32_16x16x32_bf16 v[20:23], v[196:199], v[80:83], v[20:23]
    v_mfma_f32_16x16x32_bf16 v[32:35], v[200:203], v[80:83], v[32:35]
    v_mfma_f32_16x16x32_bf16 v[40:43], v[200:203], v[84:87], v[40:43]
    buffer_load_dwordx4 v1, s[16:19], s42 offen offset:2048 sc1 lds
    s_add_u32 s45, s45, 131072
    v_mfma_f32_16x16x32_bf16 v[44:47], v[204:207], v[84:87], v[44:47]
    v_mfma_f32_16x16x32_bf16 v[36:39], v[204:207], v[80:83], v[36:39]
    s_waitcnt lgkmcnt(0)
    v_mfma_f32_16x16x32_bf16 v[16:19], v[208:211], v[88:91], v[16:19]
    ds_read_b128 v[80:83], v2 offset:40960
    v_mfma_f32_16x16x32_bf16 v[24:27], v[208:211], v[92:95], v[24:27]
    ds_read_b128 v[84:87], v3 offset:40960
    v_mfma_f32_16x16x32_bf16 v[28:31], v[212:215], v[92:95], v[28:31]
    v_mfma_f32_16x16x32_bf16 v[20:23], v[212:215], v[88:91], v[20:23]
    v_mfma_f32_16x16x32_bf16 v[32:35], v[216:219], v[88:91], v[32:35]
    v_mfma_f32_16x16x32_bf16 v[40:43], v[216:219], v[92:95], v[40:43]
    v_mfma_f32_16x16x32_bf16 v[44:47], v[220:223], v[92:95], v[44:47]
    v_mfma_f32_16x16x32_bf16 v[36:39], v[220:223], v[88:91], v[36:39]
    s_waitcnt lgkmcnt(0)
    v_mfma_f32_16x16x32_bf16 v[16:19], v[224:227], v[80:83], v[16:19]
    ds_read_b128 v[88:91], v2 offset:43008
    v_mfma_f32_16x16x32_bf16 v[24:27], v[224:227], v[84:87], v[24:27]
    ds_read_b128 v[92:95], v3 offset:43008
    v_mfma_f32_16x16x32_bf16 v[28:31], v[228:231], v[84:87], v[28:31]
    v_mfma_f32_16x16x32_bf16 v[20:23], v[228:231], v[80:83], v[20:23]
    v_mfma_f32_16x16x32_bf16 v[32:35], v[232:235], v[80:83], v[32:35]
    v_mfma_f32_16x16x32_bf16 v[40:43], v[232:235], v[84:87], v[40:43]
    v_mfma_f32_16x16x32_bf16 v[44:47], v[236:239], v[84:87], v[44:47]
    v_mfma_f32_16x16x32_bf16 v[36:39], v[236:239], v[80:83], v[36:39]
    s_waitcnt vmcnt(8) lgkmcnt(0)
    s_barrier
    v_mfma_f32_16x16x32_bf16 v[16:19], v[240:243], v[88:91], v[16:19]
    ds_read_b128 v[80:83], v4 offset:0
    ds_read_b128 v[144:147], v11 offset:512
    v_mfma_f32_16x16x32_bf16 v[24:27], v[240:243], v[92:95], v[24:27]
    ds_read_b128 v[84:87], v5 offset:0
    s_waitcnt lgkmcnt(1)
    v_mfma_f32_16x16x32_bf16 v[28:31], v[244:247], v[92:95], v[28:31]
    v_add_f32 v144, v144, v145
    v_add_f32 v146, v146, v147
    v_mfma_f32_16x16x32_bf16 v[20:23], v[244:247], v[88:91], v[20:23]
    v_add_f32 v144, v144, v146
    v_min_u32 v144, -2, v144
    v_mfma_f32_16x16x32_bf16 v[32:35], v[248:251], v[88:91], v[32:35]
    buffer_store_dword v144, v12, s[16:19], s46 offen sc1
    v_mfma_f32_16x16x32_bf16 v[40:43], v[248:251], v[92:95], v[40:43]
    v_mfma_f32_16x16x32_bf16 v[44:47], v[252:255], v[92:95], v[44:47]
    v_mfma_f32_16x16x32_bf16 v[36:39], v[252:255], v[88:91], v[36:39]
    s_add_u32 s36, s36, 1
L_bf_b1:
    s_waitcnt lgkmcnt(0)
    v_mfma_f32_16x16x32_bf16 v[48:51], a[0:3], v[80:83], v[112:115]
    ds_read_b128 v[88:91], v4 offset:2048
    s_sub_u32 s47, s45, 393216
    v_mfma_f32_16x16x32_bf16 v[56:59], a[0:3], v[84:87], 0
    ds_read_b128 v[92:95], v5 offset:2048
    buffer_load_dword v13, v8, s[16:19], s47 offen sc1
    v_mfma_f32_16x16x32_bf16 v[60:63], a[4:7], v[84:87], 0
    s_cmp_eq_u32 s36, 0
    s_cselect_b32 s38, 0x8000000, s53
    v_mfma_f32_16x16x32_bf16 v[52:55], a[4:7], v[80:83], v[116:119]
    buffer_load_dwordx4 v[136:139], v1, s[16:19], s38 offen sc1
    s_add_u32 s53, s53, 65536
    v_mfma_f32_16x16x32_bf16 v[64:67], a[8:11], v[80:83], 0
    s_cmp_eq_u32 s36, 0
    s_cselect_b32 s44, 0x8000000, s90
    v_mfma_f32_16x16x32_bf16 v[72:75], a[8:11], v[84:87], 0
    s_xor_b32 s49, s44, 16384
    v_cvt_pk_bf16_f32 v24, v24, v25
    v_mfma_f32_16x16x32_bf16 v[76:79], a[12:15], v[84:87], 0
    v_cvt_pk_bf16_f32 v25, v26, v27
    v_cvt_pk_bf16_f32 v26, v28, v29
    v_mfma_f32_16x16x32_bf16 v[68:71], a[12:15], v[80:83], 0
    v_cvt_pk_bf16_f32 v27, v30, v31
    s_waitcnt lgkmcnt(0)
    v_mfma_f32_16x16x32_bf16 v[48:51], a[16:19], v[88:91], v[48:51]
    ds_read_b128 v[80:83], v4 offset:4096
    buffer_store_dwordx4 v[24:27], v1, s[16:19], s49 offen offset:0 sc1
    v_mfma_f32_16x16x32_bf16 v[56:59], a[16:19], v[92:95], v[56:59]
    ds_read_b128 v[84:87], v5 offset:4096
    s_xor_b32 s49, s44, 32768
    v_mfma_f32_16x16x32_bf16 v[60:63], a[20:23], v[92:95], v[60:63]
    v_cvt_pk_bf16_f32 v32, v32, v33
    v_cvt_pk_bf16_f32 v33, v34, v35
    v_mfma_f32_16x16x32_bf16 v[52:55], a[20:23], v[88:91], v[52:55]
    v_cvt_pk_bf16_f32 v34, v36, v37
    v_cvt_pk_bf16_f32 v35, v38, v39
    v_mfma_f32_16x16x32_bf16 v[64:67], a[24:27], v[88:91], v[64:67]
    buffer_store_dwordx4 v[32:35], v1, s[16:19], s49 offen offset:1024 sc1
    s_xor_b32 s49, s44, 49152
    v_mfma_f32_16x16x32_bf16 v[72:75], a[24:27], v[92:95], v[72:75]
    v_cvt_pk_bf16_f32 v40, v40, v41
    v_cvt_pk_bf16_f32 v41, v42, v43
    v_mfma_f32_16x16x32_bf16 v[76:79], a[28:31], v[92:95], v[76:79]
    v_cvt_pk_bf16_f32 v42, v44, v45
    v_cvt_pk_bf16_f32 v43, v46, v47
    v_mfma_f32_16x16x32_bf16 v[68:71], a[28:31], v[88:91], v[68:71]
    buffer_store_dwordx4 v[40:43], v1, s[16:19], s49 offen offset:2048 sc1
    s_waitcnt lgkmcnt(0)
    v_mfma_f32_16x16x32_bf16 v[48:51], a[32:35], v[80:83], v[48:51]
    ds_read_b128 v[88:91], v4 offset:6144
    s_add_u32 s90, s90, 262144
    v_mfma_f32_16x16x32_bf16 v[56:59], a[32:35], v[84:87], v[56:59]
    ds_read_b128 v[92:95], v5 offset:6144
    s_add_u32 m0, s88, 135168
    v_mfma_f32_16x16x32_bf16 v[60:63], a[36:39], v[84:87], v[60:63]
    s_add_u32 s42, s41, 36864
    s_add_u32 s42, s42, s89
    v_mfma_f32_16x16x32_bf16 v[52:55], a[36:39], v[80:83], v[52:55]
    buffer_load_dwordx4 v1, s[16:19], s42 offen offset:0 sc1 lds
    v_mfma_f32_16x16x32_bf16 v[64:67], a[40:43], v[80:83], v[64:67]
    v_mfma_f32_16x16x32_bf16 v[72:75], a[40:43], v[84:87], v[72:75]
    v_mfma_f32_16x16x32_bf16 v[76:79], a[44:47], v[84:87], v[76:79]
    v_mfma_f32_16x16x32_bf16 v[68:71], a[44:47], v[80:83], v[68:71]
    s_waitcnt lgkmcnt(0)
    v_mfma_f32_16x16x32_bf16 v[48:51], a[48:51], v[88:91], v[48:51]
    ds_read_b128 v[80:83], v4 offset:8192
    v_mfma_f32_16x16x32_bf16 v[56:59], a[48:51], v[92:95], v[56:59]
    ds_read_b128 v[84:87], v5 offset:8192
    buffer_load_dwordx4 v1, s[16:19], s42 offen offset:1024 sc1 lds
    v_mfma_f32_16x16x32_bf16 v[60:63], a[52:55], v[92:95], v[60:63]
    s_add_u32 s41, s41, 229376
    s_min_u32 s41, s41, s96
    v_mfma_f32_16x16x32_bf16 v[52:55], a[52:55], v[88:91], v[52:55]
    v_mfma_f32_16x16x32_bf16 v[64:67], a[56:59], v[88:91], v[64:67]
    v_mfma_f32_16x16x32_bf16 v[72:75], a[56:59], v[92:95], v[72:75]
    v_mfma_f32_16x16x32_bf16 v[76:79], a[60:63], v[92:95], v[76:79]
    v_mfma_f32_16x16x32_bf16 v[68:71], a[60:63], v[88:91], v[68:71]
    s_waitcnt lgkmcnt(0)
    v_mfma_f32_16x16x32_bf16 v[48:51], a[64:67], v[80:83], v[48:51]
    ds_read_b128 v[88:91], v4 offset:10240
    v_mfma_f32_16x16x32_bf16 v[56:59], a[64:67], v[84:87], v[56:59]
    ds_read_b128 v[92:95], v5 offset:10240
    v_mfma_f32_16x16x32_bf16 v[60:63], a[68:71], v[84:87], v[60:63]
    v_mfma_f32_16x16x32_bf16 v[52:55], a[68:71], v[80:83], v[52:55]
    v_mfma_f32_16x16x32_bf16 v[64:67], a[72:75], v[80:83], v[64:67]
    v_mfma_f32_16x16x32_bf16 v[72:75], a[72:75], v[84:87], v[72:75]
    s_waitcnt vmcnt(6)
    v_cmp_ne_u32 vcc, 0, v13
    s_cbranch_vccnz L_spin48
L_back49:
    v_mfma_f32_16x16x32_bf16 v[76:79], a[76:79], v[84:87], v[76:79]
    v_mfma_f32_16x16x32_bf16 v[68:71], a[76:79], v[80:83], v[68:71]
    s_waitcnt vmcnt(8) lgkmcnt(0)
    s_barrier
    v_mfma_f32_16x16x32_bf16 v[48:51], a[80:83], v[88:91], v[48:51]
    ds_read_b128 v[80:83], v4 offset:12288
    s_sub_u32 s48, s90, 524288
    v_mfma_f32_16x16x32_bf16 v[56:59], a[80:83], v[92:95], v[56:59]
    ds_read_b128 v[84:87], v5 offset:12288
    s_cmp_lt_u32 s36, 2
    s_cselect_b32 s48, s52, s48
    v_mfma_f32_16x16x32_bf16 v[60:63], a[84:87], v[92:95], v[60:63]
    buffer_load_dwordx4 v[140:143], v1, s[16:19], s48 offen offset:0 sc1
    buffer_load_dwordx4 v[144:147], v1, s[16:19], s48 offen offset:1024 sc1
    v_mfma_f32_16x16x32_bf16 v[52:55], a[84:87], v[88:91], v[52:55]
    buffer_load_dwordx4 v[148:151], v1, s[16:19], s48 offen offset:2048 sc1
    buffer_load_dwordx4 v[152:155], v1, s[16:19], s48 offen offset:3072 sc1
    v_mfma_f32_16x16x32_bf16 v[64:67], a[88:91], v[88:91], v[64:67]
    s_sub_u32 s47, s36, 2
    s_cmp_lt_u32 s47, 16
    s_cselect_b32 s48, 0x5000000, s52
    v_mfma_f32_16x16x32_bf16 v[72:75], a[88:91], v[92:95], v[72:75]
    s_add_u32 s20, s84, s48
    s_addc_u32 s21, s85, 0
    v_mfma_f32_16x16x32_bf16 v[76:79], a[92:95], v[92:95], v[76:79]
    s_cmp_ge_i32 s47, 16
    s_cselect_b32 s20, s80, s20
    s_cselect_b32 s21, s81, s21
    v_mfma_f32_16x16x32_bf16 v[68:71], a[92:95], v[88:91], v[68:71]
    s_and_b32 s48, s47, 15
    s_waitcnt lgkmcnt(0)
    v_mfma_f32_16x16x32_bf16 v[48:51], a[96:99], v[80:83], v[48:51]
    ds_read_b128 v[88:91], v4 offset:14336
    s_lshl_b32 s48, s48, 1
    v_mfma_f32_16x16x32_bf16 v[56:59], a[96:99], v[84:87], v[56:59]
    ds_read_b128 v[92:95], v5 offset:14336
    s_sub_u32 s48, s50, s48
    v_mfma_f32_16x16x32_bf16 v[60:63], a[100:103], v[84:87], v[60:63]
    s_lshl_b32 s46, s48, 10
    s_sub_u32 s46, s55, s46
    v_mfma_f32_16x16x32_bf16 v[52:55], a[100:103], v[80:83], v[52:55]
    s_cmp_lt_u32 s47, 16
    s_cselect_b32 s46, s46, s52
    v_mfma_f32_16x16x32_bf16 v[64:67], a[104:107], v[80:83], v[64:67]
    s_lshl_b32 s48, s48, 15
    v_mfma_f32_16x16x32_bf16 v[72:75], a[104:107], v[84:87], v[72:75]
    v_mfma_f32_16x16x32_bf16 v[76:79], a[108:111], v[84:87], v[76:79]
    v_mfma_f32_16x16x32_bf16 v[68:71], a[108:111], v[80:83], v[68:71]
    s_waitcnt lgkmcnt(0)
    v_mfma_f32_16x16x32_bf16 v[48:51], a[112:115], v[88:91], v[48:51]
    ds_read_b128 v[80:83], v4 offset:16384
    v_mfma_f32_16x16x32_bf16 v[56:59], a[112:115], v[92:95], v[56:59]
    ds_read_b128 v[84:87], v5 offset:16384
    v_mfma_f32_16x16x32_bf16 v[60:63], a[116:119], v[92:95], v[60:63]
    buffer_load_dword v96, v6, s[16:19], s45 offen sc1
    v_mfma_f32_16x16x32_bf16 v[52:55], a[116:119], v[88:91], v[52:55]
    v_mfma_f32_16x16x32_bf16 v[64:67], a[120:123], v[88:91], v[64:67]
    v_mfma_f32_16x16x32_bf16 v[72:75], a[120:123], v[92:95], v[72:75]
    v_mfma_f32_16x16x32_bf16 v[76:79], a[124:127], v[92:95], v[76:79]
    v_mfma_f32_16x16x32_bf16 v[68:71], a[124:127], v[88:91], v[68:71]
    s_waitcnt lgkmcnt(0)
    v_mfma_f32_16x16x32_bf16 v[48:51], a[128:131], v[80:83], v[48:51]
    ds_read_b128 v[88:91], v4 offset:18432
    v_mfma_f32_16x16x32_bf16 v[56:59], a[128:131], v[84:87], v[56:59]
    ds_read_b128 v[92:95], v5 offset:18432
    v_mfma_f32_16x16x32_bf16 v[60:63], a[132:135], v[84:87], v[60:63]
    v_mfma_f32_16x16x32_bf16 v[52:55], a[132:135], v[80:83], v[52:55]
    v_mfma_f32_16x16x32_bf16 v[64:67], a[136:139], v[80:83], v[64:67]
    v_mfma_f32_16x16x32_bf16 v[72:75], a[136:139], v[84:87], v[72:75]
    v_mfma_f32_16x16x32_bf16 v[76:79], a[140:143], v[84:87], v[76:79]
    v_mfma_f32_16x16x32_bf16 v[68:71], a[140:143], v[80:83], v[68:71]
    s_waitcnt lgkmcnt(0)
    v_mfma_f32_16x16x32_bf16 v[48:51], a[144:147], v[88:91], v[48:51]
    ds_read_b128 v[80:83], v4 offset:20480
    v_mfma_f32_16x16x32_bf16 v[56:59], a[144:147], v[92:95], v[56:59]
    ds_read_b128 v[84:87], v5 offset:20480
    v_mfma_f32_16x16x32_bf16 v[60:63], a[148:151], v[92:95], v[60:63]
    v_mfma_f32_16x16x32_bf16 v[52:55], a[148:151], v[88:91], v[52:55]
    v_mfma_f32_16x16x32_bf16 v[64:67], a[152:155], v[88:91], v[64:67]
    v_mfma_f32_16x16x32_bf16 v[72:75], a[152:155], v[92:95], v[72:75]
    v_mfma_f32_16x16x32_bf16 v[76:79], a[156:159], v[92:95], v[76:79]
    v_mfma_f32_16x16x32_bf16 v[68:71], a[156:159], v[88:91], v[68:71]
    s_waitcnt lgkmcnt(0)
    v_mfma_f32_16x16x32_bf16 v[48:51], a[160:163], v[80:83], v[48:51]
    ds_read_b128 v[88:91], v4 offset:22528
    v_mfma_f32_16x16x32_bf16 v[56:59], a[160:163], v[84:87], v[56:59]
    ds_read_b128 v[92:95], v5 offset:22528
    v_mfma_f32_16x16x32_bf16 v[60:63], a[164:167], v[84:87], v[60:63]
    v_mfma_f32_16x16x32_bf16 v[52:55], a[164:167], v[80:83], v[52:55]
    v_mfma_f32_16x16x32_bf16 v[64:67], a[168:171], v[80:83], v[64:67]
    v_mfma_f32_16x16x32_bf16 v[72:75], a[168:171], v[84:87], v[72:75]
    v_mfma_f32_16x16x32_bf16 v[76:79], a[172:175], v[84:87], v[76:79]
    v_mfma_f32_16x16x32_bf16 v[68:71], a[172:175], v[80:83], v[68:71]
    s_waitcnt lgkmcnt(0)
    v_mfma_f32_16x16x32_bf16 v[48:51], a[176:179], v[88:91], v[48:51]
    ds_read_b128 v[80:83], v4 offset:24576
    v_mfma_f32_16x16x32_bf16 v[56:59], a[176:179], v[92:95], v[56:59]
    ds_read_b128 v[84:87], v5 offset:24576
    v_mfma_f32_16x16x32_bf16 v[60:63], a[180:183], v[92:95], v[60:63]
    v_mfma_f32_16x16x32_bf16 v[52:55], a[180:183], v[88:91], v[52:55]
    v_mfma_f32_16x16x32_bf16 v[64:67], a[184:187], v[88:91], v[64:67]
    v_mfma_f32_16x16x32_bf16 v[72:75], a[184:187], v[92:95], v[72:75]
    v_mfma_f32_16x16x32_bf16 v[76:79], a[188:191], v[92:95], v[76:79]
    v_mfma_f32_16x16x32_bf16 v[68:71], a[188:191], v[88:91], v[68:71]
    s_waitcnt lgkmcnt(0)
    v_mfma_f32_16x16x32_bf16 v[48:51], a[192:195], v[80:83], v[48:51]
    ds_read_b128 v[88:91], v4 offset:26624
    v_mfma_f32_16x16x32_bf16 v[56:59], a[192:195], v[84:87], v[56:59]
    ds_read_b128 v[92:95], v5 offset:26624
    v_mfma_f32_16x16x32_bf16 v[60:63], a[196:199], v[84:87], v[60:63]
    v_mfma_f32_16x16x32_bf16 v[52:55], a[196:199], v[80:83], v[52:55]
    v_mfma_f32_16x16x32_bf16 v[64:67], a[200:203], v[80:83], v[64:67]
    v_mfma_f32_16x16x32_bf16 v[72:75], a[200:203], v[84:87], v[72:75]
    v_mfma_f32_16x16x32_bf16 v[76:79], a[204:207], v[84:87], v[76:79]
    v_mfma_f32_16x16x32_bf16 v[68:71], a[204:207], v[80:83], v[68:71]
    s_waitcnt lgkmcnt(0)
    v_mfma_f32_16x16x32_bf16 v[48:51], a[208:211], v[88:91], v[48:51]
    ds_read_b128 v[80:83], v4 offset:28672
    s_waitcnt vmcnt(0)
    v_mfma_f32_16x16x32_bf16 v[56:59], a[208:211], v[92:95], v[56:59]
    ds_read_b128 v[84:87], v5 offset:28672
    v_cmp_ne_u32 vcc, 0, v96
    s_cbranch_vccnz L_spin50
L_back51:
    v_mfma_f32_16x16x32_bf16 v[60:63], a[212:215], v[92:95], v[60:63]
    s_barrier
    buffer_store_dword v124, v124, s[16:19], s91 offen sc1
    v_mfma_f32_16x16x32_bf16 v[52:55], a[212:215], v[88:91], v[52:55]
    s_add_u32 s91, s91, 131072
    s_add_u32 m0, s43, 0
    v_mfma_f32_16x16x32_bf16 v[64:67], a[216:219], v[88:91], v[64:67]
    s_add_u32 s42, s41, 0
    buffer_load_dwordx4 v1, s[16:19], s42 offen offset:0 sc1 lds
    v_mfma_f32_16x16x32_bf16 v[72:75], a[216:219], v[92:95], v[72:75]
    v_mfma_f32_16x16x32_bf16 v[76:79], a[220:223], v[92:95], v[76:79]
    buffer_load_dwordx4 v1, s[16:19], s42 offen offset:1024 sc1 lds
    v_mfma_f32_16x16x32_bf16 v[68:71], a[220:223], v[88:91], v[68:71]
    s_waitcnt lgkmcnt(0)
    v_mfma_f32_16x16x32_bf16 v[48:51], a[224:227], v[80:83], v[48:51]
    ds_read_b128 v[88:91], v4 offset:30720
    buffer_load_dwordx4 v1, s[16:19], s42 offen offset:2048 sc1 lds
    v_mfma_f32_16x16x32_bf16 v[56:59], a[224:227], v[84:87], v[56:59]
    ds_read_b128 v[92:95], v5 offset:30720
    s_add_u32 s39, s91, -327680
    v_mfma_f32_16x16x32_bf16 v[60:63], a[228:231], v[84:87], v[60:63]
    buffer_store_dword v124, v124, s[16:19], s39 offen sc1
    v_mfma_f32_16x16x32_bf16 v[52:55], a[228:231], v[80:83], v[52:55]
    v_mfma_f32_16x16x32_bf16 v[64:67], a[232:235], v[80:83], v[64:67]
    s_waitcnt vmcnt(6)
    v_mfma_f32_16x16x32_bf16 v[128:131], v[104:107], v[140:143], v[128:131]
    v_mfma_f32_16x16x32_bf16 v[132:135], v[108:111], v[140:143], v[132:135]
    v_mfma_f32_16x16x32_bf16 v[128:131], v[104:107], v[144:147], v[128:131]
    v_mfma_f32_16x16x32_bf16 v[132:135], v[108:111], v[144:147], v[132:135]
    v_mfma_f32_16x16x32_bf16 v[128:131], v[104:107], v[148:151], v[128:131]
    v_mfma_f32_16x16x32_bf16 v[132:135], v[108:111], v[148:151], v[132:135]
    v_mfma_f32_16x16x32_bf16 v[128:131], v[104:107], v[152:155], v[128:131]
    v_mfma_f32_16x16x32_bf16 v[132:135], v[108:111], v[152:155], v[132:135]
    v_mfma_f32_16x16x32_bf16 v[72:75], a[232:235], v[84:87], v[72:75]
    s_add_u32 m0, s43, 12288
    s_add_u32 s42, s41, 12288
    v_mfma_f32_16x16x32_bf16 v[76:79], a[236:239], v[84:87], v[76:79]
    buffer_load_dwordx4 v1, s[16:19], s42 offen offset:0 sc1 lds
    v_cvt_pk_bf16_f32 v140, v128, v129
    v_mfma_f32_16x16x32_bf16 v[68:71], a[236:239], v[80:83], v[68:71]
    v_cvt_pk_bf16_f32 v141, v130, v131
    s_waitcnt lgkmcnt(0)
    v_mfma_f32_16x16x32_bf16 v[48:51], a[240:243], v[88:91], v[48:51]
    ds_read_b128 v[80:83], v4 offset:32768
    v_cvt_pk_bf16_f32 v142, v132, v133
    v_mfma_f32_16x16x32_bf16 v[56:59], a[240:243], v[92:95], v[56:59]
    ds_read_b128 v[84:87], v5 offset:32768
    v_cvt_pk_bf16_f32 v143, v134, v135
    v_mfma_f32_16x16x32_bf16 v[60:63], a[244:247], v[92:95], v[60:63]
    buffer_store_dwordx4 v[140:143], v9, s[20:23], s48 offen sc1
    v_dot2_f32_bf16 v100, v140, s86, 0
    v_mfma_f32_16x16x32_bf16 v[52:55], a[244:247], v[88:91], v[52:55]
    v_dot2_f32_bf16 v101, v140, v140, 0
    v_dot2_f32_bf16 v100, v141, s86, v100
    v_mfma_f32_16x16x32_bf16 v[64:67], a[248:251], v[88:91], v[64:67]
    buffer_load_dwordx4 v1, s[16:19], s42 offen offset:1024 sc1 lds
    v_dot2_f32_bf16 v101, v141, v141, v101
    v_mfma_f32_16x16x32_bf16 v[72:75], a[248:251], v[92:95], v[72:75]
    v_dot2_f32_bf16 v100, v142, s86, v100
    v_dot2_f32_bf16 v101, v142, v142, v101
    v_mfma_f32_16x16x32_bf16 v[76:79], a[252:255], v[92:95], v[76:79]
    v_dot2_f32_bf16 v100, v143, s86, v100
    v_dot2_f32_bf16 v101, v143, v143, v101
    v_mfma_f32_16x16x32_bf16 v[68:71], a[252:255], v[88:91], v[68:71]
    s_waitcnt lgkmcnt(0)
    v_mfma_f32_16x16x32_bf16 v[48:51], v[160:163], v[80:83], v[48:51]
    ds_read_b128 v[88:91], v4 offset:34816
    v_permlane16_swap_b32 v100, v101
    v_mfma_f32_16x16x32_bf16 v[56:59], v[160:163], v[84:87], v[56:59]
    ds_read_b128 v[92:95], v5 offset:34816
    v_add_f32 v100, v100, v101
    v_mfma_f32_16x16x32_bf16 v[60:63], v[164:167], v[84:87], v[60:63]
    buffer_load_dwordx4 v1, s[16:19], s42 offen offset:2048 sc1 lds
    v_mov_b32 v102, v100
    v_mfma_f32_16x16x32_bf16 v[52:55], v[164:167], v[80:83], v[52:55]
    v_permlane32_swap_b32 v100, v102
    v_add_f32 v100, v100, v102
    v_mfma_f32_16x16x32_bf16 v[64:67], v[168:171], v[80:83], v[64:67]
    ds_write_b32 v10, v100 offset:0
    s_waitcnt vmcnt(19)
    v_mfma_f32_16x16x32_bf16 v[72:75], v[168:171], v[84:87], v[72:75]
    v_mfma_f32_16x16x32_bf16 v[128:131], v[104:107], v[136:139], v[16:19]
    v_mfma_f32_16x16x32_bf16 v[132:135], v[108:111], v[136:139], v[20:23]
    v_mfma_f32_16x16x32_bf16 v[76:79], v[172:175], v[84:87], v[76:79]
    v_mfma_f32_16x16x32_bf16 v[68:71], v[172:175], v[80:83], v[68:71]
    s_add_u32 m0, s43, 24576
    s_waitcnt lgkmcnt(1)
    v_mfma_f32_16x16x32_bf16 v[48:51], v[176:179], v[88:91], v[48:51]
    ds_read_b128 v[80:83], v4 offset:36864
    s_add_u32 s42, s41, 24576
    v_mfma_f32_16x16x32_bf16 v[56:59], v[176:179], v[92:95], v[56:59]
    ds_read_b128 v[84:87], v5 offset:36864
    buffer_load_dwordx4 v1, s[16:19], s42 offen offset:0 sc1 lds
    v_mfma_f32_16x16x32_bf16 v[60:63], v[180:183], v[92:95], v[60:63]
    v_mfma_f32_16x16x32_bf16 v[52:55], v[180:183], v[88:91], v[52:55]
    v_mfma_f32_16x16x32_bf16 v[64:67], v[184:187], v[88:91], v[64:67]
    v_mfma_f32_16x16x32_bf16 v[72:75], v[184:187], v[92:95], v[72:75]
    v_mfma_f32_16x16x32_bf16 v[76:79], v[188:191], v[92:95], v[76:79]
    v_mfma_f32_16x16x32_bf16 v[68:71], v[188:191], v[88:91], v[68:71]
    buffer_load_dwordx4 v1, s[16:19], s42 offen offset:1024 sc1 lds
    s_waitcnt lgkmcnt(0)
    v_mfma_f32_16x16x32_bf16 v[48:51], v[192:195], v[80:83], v[48:51]
    ds_read_b128 v[88:91], v4 offset:38912
    v_mfma_f32_16x16x32_bf16 v[56:59], v[192:195], v[84:87], v[56:59]
    ds_read_b128 v[92:95], v5 offset:38912
    v_mfma_f32_16x16x32_bf16 v[60:63], v[196:199], v[84:87], v[60:63]
    v_mfma_f32_16x16x32_bf16 v[52:55], v[196:199], v[80:83], v[52:55]
    v_mfma_f32_16x16x32_bf16 v[64:67], v[200:203], v[80:83], v[64:67]
    v_mfma_f32_16x16x32_bf16 v[72:75], v[200:203], v[84:87], v[72:75]
    buffer_load_dwordx4 v1, s[16:19], s42 offen offset:2048 sc1 lds
    s_add_u32 s45, s45, 131072
    v_mfma_f32_16x16x32_bf16 v[76:79], v[204:207], v[84:87], v[76:79]
    v_mfma_f32_16x16x32_bf16 v[68:71], v[204:207], v[80:83], v[68:71]
    s_waitcnt lgkmcnt(0)
    v_mfma_f32_16x16x32_bf16 v[48:51], v[208:211], v[88:91], v[48:51]
    ds_read_b128 v[80:83], v4 offset:40960
    v_mfma_f32_16x16x32_bf16 v[56:59], v[208:211], v[92:95], v[56:59]
    ds_read_b128 v[84:87], v5 offset:40960
    v_mfma_f32_16x16x32_bf16 v[60:63], v[212:215], v[92:95], v[60:63]
    v_mfma_f32_16x16x32_bf16 v[52:55], v[212:215], v[88:91], v[52:55]
    v_mfma_f32_16x16x32_bf16 v[64:67], v[216:219], v[88:91], v[64:67]
    v_mfma_f32_16x16x32_bf16 v[72:75], v[216:219], v[92:95], v[72:75]
    v_mfma_f32_16x16x32_bf16 v[76:79], v[220:223], v[92:95], v[76:79]
    v_mfma_f32_16x16x32_bf16 v[68:71], v[220:223], v[88:91], v[68:71]
    s_waitcnt lgkmcnt(0)
    v_mfma_f32_16x16x32_bf16 v[48:51], v[224:227], v[80:83], v[48:51]
    ds_read_b128 v[88:91], v4 offset:43008
    v_mfma_f32_16x16x32_bf16 v[56:59], v[224:227], v[84:87], v[56:59]
    ds_read_b128 v[92:95], v5 offset:43008
    v_mfma_f32_16x16x32_bf16 v[60:63], v[228:231], v[84:87], v[60:63]
    v_mfma_f32_16x16x32_bf16 v[52:55], v[228:231], v[80:83], v[52:55]
    v_mfma_f32_16x16x32_bf16 v[64:67], v[232:235], v[80:83], v[64:67]
    v_mfma_f32_16x16x32_bf16 v[72:75], v[232:235], v[84:87], v[72:75]
    v_mfma_f32_16x16x32_bf16 v[76:79], v[236:239], v[84:87], v[76:79]
    v_mfma_f32_16x16x32_bf16 v[68:71], v[236:239], v[80:83], v[68:71]
    s_waitcnt vmcnt(8) lgkmcnt(0)
    s_barrier
    v_mfma_f32_16x16x32_bf16 v[48:51], v[240:243], v[88:91], v[48:51]
    ds_read_b128 v[80:83], v2 offset:0
    ds_read_b128 v[144:147], v11 offset:0
    v_mfma_f32_16x16x32_bf16 v[56:59], v[240:243], v[92:95], v[56:59]
    ds_read_b128 v[84:87], v3 offset:0
    s_waitcnt lgkmcnt(1)
    v_mfma_f32_16x16x32_bf16 v[60:63], v[244:247], v[92:95], v[60:63]
    v_add_f32 v144, v144, v145
    v_add_f32 v146, v146, v147
    v_mfma_f32_16x16x32_bf16 v[52:55], v[244:247], v[88:91], v[52:55]
    v_add_f32 v144, v144, v146
    v_min_u32 v144, -2, v144
    v_mfma_f32_16x16x32_bf16 v[64:67], v[248:251], v[88:91], v[64:67]
    buffer_store_dword v144, v12, s[16:19], s46 offen sc1
    v_mfma_f32_16x16x32_bf16 v[72:75], v[248:251], v[92:95], v[72:75]
    v_mfma_f32_16x16x32_bf16 v[76:79], v[252:255], v[92:95], v[76:79]
    v_mfma_f32_16x16x32_bf16 v[68:71], v[252:255], v[88:91], v[68:71]
    s_add_u32 s36, s36, 1
    s_cmp_lt_u32 s36, 32
    s_cbranch_scc1 L_bf_b0
    s_nop 7
    s_sub_u32 s47, s45, 393216
    buffer_load_dword v13, v8, s[16:19], s47 offen sc1
    s_cmp_eq_u32 s36, 0
    s_cselect_b32 s38, 0x8000000, s53
    buffer_load_dwordx4 v[136:139], v1, s[16:19], s38 offen sc1
    s_add_u32 s53, s53, 65536
    s_cmp_eq_u32 s36, 0
    s_cselect_b32 s44, 0x8000000, s90
    s_xor_b32 s49, s44, 16384
    v_cvt_pk_bf16_f32 v56, v56, v57
    v_cvt_pk_bf16_f32 v57, v58, v59
    v_cvt_pk_bf16_f32 v58, v60, v61
    v_cvt_pk_bf16_f32 v59, v62, v63
    buffer_store_dwordx4 v[56:59], v1, s[16:19], s49 offen offset:0 sc1
    s_xor_b32 s49, s44, 32768
    v_cvt_pk_bf16_f32 v64, v64, v65
    v_cvt_pk_bf16_f32 v65, v66, v67
    v_cvt_pk_bf16_f32 v66, v68, v69
    v_cvt_pk_bf16_f32 v67, v70, v71
    buffer_store_dwordx4 v[64:67], v1, s[16:19], s49 offen offset:1024 sc1
    s_xor_b32 s49, s44, 49152
    v_cvt_pk_bf16_f32 v72, v72, v73
    v_cvt_pk_bf16_f32 v73, v74, v75
    v_cvt_pk_bf16_f32 v74, v76, v77
    v_cvt_pk_bf16_f32 v75, v78, v79
    buffer_store_dwordx4 v[72:75], v1, s[16:19], s49 offen offset:2048 sc1
    s_add_u32 s90, s90, 262144
    s_waitcnt vmcnt(4)
    v_cmp_ne_u32 vcc, 0, v13
    s_cbranch_vccnz L_spin52
L_back53:
    s_barrier
    s_sub_u32 s48, s90, 524288
    s_cmp_lt_u32 s36, 2
    s_cselect_b32 s48, s52, s48
    buffer_load_dwordx4 v[140:143], v1, s[16:19], s48 offen offset:0 sc1
    buffer_load_dwordx4 v[144:147], v1, s[16:19], s48 offen offset:1024 sc1
    buffer_load_dwordx4 v[148:151], v1, s[16:19], s48 offen offset:2048 sc1
    buffer_load_dwordx4 v[152:155], v1, s[16:19], s48 offen offset:3072 sc1
    s_sub_u32 s47, s36, 2
    s_cmp_lt_u32 s47, 16
    s_cselect_b32 s48, 0x5000000, s52
    s_add_u32 s20, s84, s48
    s_addc_u32 s21, s85, 0
    s_cmp_ge_i32 s47, 16
    s_cselect_b32 s20, s80, s20
    s_cselect_b32 s21, s81, s21
    s_and_b32 s48, s47, 15
    s_lshl_b32 s48, s48, 1
    s_sub_u32 s48, s50, s48
    s_lshl_b32 s46, s48, 10
    s_sub_u32 s46, s55, s46
    s_cmp_lt_u32 s47, 16
    s_cselect_b32 s46, s46, s52
    s_lshl_b32 s48, s48, 15
    s_waitcnt vmcnt(4)
    s_barrier
    buffer_store_dword v124, v124, s[16:19], s91 offen sc1
    s_add_u32 s91, s91, 131072
    s_waitcnt vmcnt(1)
    v_mfma_f32_16x16x32_bf16 v[128:131], v[104:107], v[140:143], v[128:131]
    v_mfma_f32_16x16x32_bf16 v[132:135], v[108:111], v[140:143], v[132:135]
    v_mfma_f32_16x16x32_bf16 v[128:131], v[104:107], v[144:147], v[128:131]
    v_mfma_f32_16x16x32_bf16 v[132:135], v[108:111], v[144:147], v[132:135]
    v_mfma_f32_16x16x32_bf16 v[128:131], v[104:107], v[148:151], v[128:131]
    v_mfma_f32_16x16x32_bf16 v[132:135], v[108:111], v[148:151], v[132:135]
    v_mfma_f32_16x16x32_bf16 v[128:131], v[104:107], v[152:155], v[128:131]
    v_mfma_f32_16x16x32_bf16 v[132:135], v[108:111], v[152:155], v[132:135]
    s_nop 5
    v_cvt_pk_bf16_f32 v140, v128, v129
    v_cvt_pk_bf16_f32 v141, v130, v131
    v_cvt_pk_bf16_f32 v142, v132, v133
    v_cvt_pk_bf16_f32 v143, v134, v135
    buffer_store_dwordx4 v[140:143], v9, s[20:23], s48 offen sc1
    s_waitcnt vmcnt(9)
    v_mfma_f32_16x16x32_bf16 v[128:131], v[104:107], v[136:139], v[48:51]
    v_mfma_f32_16x16x32_bf16 v[132:135], v[108:111], v[136:139], v[52:55]
    s_sub_u32 s47, s45, 262144
    buffer_load_dword v13, v8, s[16:19], s47 offen sc1
    s_waitcnt vmcnt(0)
    v_cmp_ne_u32 vcc, 0, v13
    s_cbranch_vccnz L_spin54
L_back55:
    s_barrier
    s_sub_u32 s48, s90, 262144
    s_cmp_lt_u32 s36, 1
    s_cselect_b32 s48, s52, s48
    buffer_load_dwordx4 v[140:143], v1, s[16:19], s48 offen offset:0 sc1
    buffer_load_dwordx4 v[144:147], v1, s[16:19], s48 offen offset:1024 sc1
    buffer_load_dwordx4 v[148:151], v1, s[16:19], s48 offen offset:2048 sc1
    buffer_load_dwordx4 v[152:155], v1, s[16:19], s48 offen offset:3072 sc1
    s_sub_u32 s47, s36, 1
    s_cmp_lt_u32 s47, 16
    s_cselect_b32 s48, 0x5000000, s52
    s_add_u32 s20, s84, s48
    s_addc_u32 s21, s85, 0
    s_cmp_ge_i32 s47, 16
    s_cselect_b32 s20, s80, s20
    s_cselect_b32 s21, s81, s21
    s_and_b32 s48, s47, 15
    s_lshl_b32 s48, s48, 1
    s_sub_u32 s48, s50, s48
    s_lshl_b32 s46, s48, 10
    s_sub_u32 s46, s55, s46
    s_cmp_lt_u32 s47, 16
    s_cselect_b32 s46, s46, s52
    s_lshl_b32 s48, s48, 15
    s_waitcnt vmcnt(0)
    v_mfma_f32_16x16x32_bf16 v[128:131], v[104:107], v[140:143], v[128:131]
    v_mfma_f32_16x16x32_bf16 v[132:135], v[108:111], v[140:143], v[132:135]
    v_mfma_f32_16x16x32_bf16 v[128:131], v[104:107], v[144:147], v[128:131]
    v_mfma_f32_16x16x32_bf16 v[132:135], v[108:111], v[144:147], v[132:135]
    v_mfma_f32_16x16x32_bf16 v[128:131], v[104:107], v[148:151], v[128:131]
    v_mfma_f32_16x16x32_bf16 v[132:135], v[108:111], v[148:151], v[132:135]
    v_mfma_f32_16x16x32_bf16 v[128:131], v[104:107], v[152:155], v[128:131]
    v_mfma_f32_16x16x32_bf16 v[132:135], v[108:111], v[152:155], v[132:135]
    s_nop 5
    v_cvt_pk_bf16_f32 v140, v128, v129
    v_cvt_pk_bf16_f32 v141, v130, v131
    v_cvt_pk_bf16_f32 v142, v132, v133
    v_cvt_pk_bf16_f32 v143, v134, v135
    buffer_store_dwordx4 v[140:143], v9, s[20:23], s48 offen sc1
    s_waitcnt vmcnt(0)
    s_endpgm
L_spin40:
    s_mov_b32 s40, 0x20000
L_spin40_l:
    buffer_load_dword v81, v80, s[20:23], 0 offen sc1
    s_sub_u32 s40, s40, 1
    s_waitcnt vmcnt(0)
    v_cmp_gt_u32 vcc, 16, v81
    s_cbranch_scc1 L_back41
    s_cbranch_vccz L_back41
    s_sleep 2
    s_branch L_spin40_l
L_spin42:
    s_mov_b32 s40, 0x20000
L_spin42_l:
    buffer_load_dword v96, v6, s[16:19], s45 offen sc1
    s_sub_u32 s40, s40, 1
    s_waitcnt vmcnt(0)
    v_cmp_ne_u32 vcc, 0, v96
    s_cbranch_scc1 L_back43
    s_cbranch_vccz L_back43
    s_sleep 2
    s_branch L_spin42_l
L_spin44:
    s_mov_b32 s40, 0x20000
L_spin44_l:
    buffer_load_dword v13, v8, s[16:19], s47 offen sc1
    s_sub_u32 s40, s40, 1
    s_waitcnt vmcnt(0)
    v_cmp_ne_u32 vcc, 0, v13
    s_cbranch_scc1 L_back45
    s_cbranch_vccz L_back45
    s_sleep 2
    s_branch L_spin44_l
L_spin46:
    s_mov_b32 s40, 0x20000
L_spin46_l:
    buffer_load_dword v96, v6, s[16:19], s45 offen sc1
    s_sub_u32 s40, s40, 1
    s_waitcnt vmcnt(0)
    v_cmp_ne_u32 vcc, 0, v96
    s_cbranch_scc1 L_back47
    s_cbranch_vccz L_back47
    s_sleep 2
    s_branch L_spin46_l
L_spin48:
    s_mov_b32 s40, 0x20000
L_spin48_l:
    buffer_load_dword v13, v8, s[16:19], s47 offen sc1
    s_sub_u32 s40, s40, 1
    s_waitcnt vmcnt(0)
    v_cmp_ne_u32 vcc, 0, v13
    s_cbranch_scc1 L_back49
    s_cbranch_vccz L_back49
    s_sleep 2
    s_branch L_spin48_l
L_spin50:
    s_mov_b32 s40, 0x20000
L_spin50_l:
    buffer_load_dword v96, v6, s[16:19], s45 offen sc1
    s_sub_u32 s40, s40, 1
    s_waitcnt vmcnt(0)
    v_cmp_ne_u32 vcc, 0, v96
    s_cbranch_scc1 L_back51
    s_cbranch_vccz L_back51
    s_sleep 2
    s_branch L_spin50_l
L_spin52:
    s_mov_b32 s40, 0x20000
L_spin52_l:
    buffer_load_dword v13, v8, s[16:19], s47 offen sc1
    s_sub_u32 s40, s40, 1
    s_waitcnt vmcnt(0)
    v_cmp_ne_u32 vcc, 0, v13
    s_cbranch_scc1 L_back53
    s_cbranch_vccz L_back53
    s_sleep 2
    s_branch L_spin52_l
L_spin54:
    s_mov_b32 s40, 0x20000
L_spin54_l:
    buffer_load_dword v13, v8, s[16:19], s47 offen sc1
    s_sub_u32 s40, s40, 1
    s_waitcnt vmcnt(0)
    v_cmp_ne_u32 vcc, 0, v13
    s_cbranch_scc1 L_back55
    s_cbranch_vccz L_back55
    s_sleep 2
    s_branch L_spin54_l
L_role_60:
    s_sub_u32 s35, s34, 44
    s_add_u32 s54, s54, L_role_60-interleave_layers__sliding_local_dilated__dense_activation_squared_relu__prompt_kernel
    buffer_load_dword v252, v7, s[8:11], s54 offen
    s_mov_b32 s86, 0x3f803f80
    s_mov_b32 s8, s64
    s_mov_b32 s9, s65
    s_mov_b32 s10, 0x400000
    s_mov_b32 s11, 0x00020000
    s_min_u32 s46, s35, 15
    s_lshl_b32 s46, s46, 1
    s_lshl_b32 s37, s33, 5
    s_add_u32 s46, s46, s37
    s_add_u32 s46, s46, 1
    s_lshl_b32 s37, s46, 15
    s_lshl_b32 s38, s32, 9
    s_add_u32 s37, s37, s38
    s_add_u32 s38, s37, 16384
    v_lshrrev_b32 v48, 3, v0
    v_and_b32 v49, 7, v0
    v_lshlrev_b32 v49, 4, v49
    v_lshl_add_u32 v48, v48, 11, v49
    buffer_load_dwordx4 v[16:19], v48, s[8:11], s37 offen offset:0
    buffer_load_dwordx4 v[20:23], v48, s[8:11], s37 offen offset:128
    buffer_load_dwordx4 v[24:27], v48, s[8:11], s37 offen offset:256
    buffer_load_dwordx4 v[28:31], v48, s[8:11], s37 offen offset:384
    buffer_load_dwordx4 v[32:35], v48, s[8:11], s38 offen offset:0
    buffer_load_dwordx4 v[36:39], v48, s[8:11], s38 offen offset:128
    buffer_load_dwordx4 v[40:43], v48, s[8:11], s38 offen offset:256
    buffer_load_dwordx4 v[44:47], v48, s[8:11], s38 offen offset:384
    s_waitcnt vmcnt(0)
    v_dot2_f32_bf16 v48, v16, s86, 0
    v_dot2_f32_bf16 v49, v16, v16, 0
    v_dot2_f32_bf16 v48, v17, s86, v48
    v_dot2_f32_bf16 v49, v17, v17, v49
    v_dot2_f32_bf16 v48, v18, s86, v48
    v_dot2_f32_bf16 v49, v18, v18, v49
    v_dot2_f32_bf16 v48, v19, s86, v48
    v_dot2_f32_bf16 v49, v19, v19, v49
    v_dot2_f32_bf16 v48, v20, s86, v48
    v_dot2_f32_bf16 v49, v20, v20, v49
    v_dot2_f32_bf16 v48, v21, s86, v48
    v_dot2_f32_bf16 v49, v21, v21, v49
    v_dot2_f32_bf16 v48, v22, s86, v48
    v_dot2_f32_bf16 v49, v22, v22, v49
    v_dot2_f32_bf16 v48, v23, s86, v48
    v_dot2_f32_bf16 v49, v23, v23, v49
    v_dot2_f32_bf16 v50, v24, s86, 0
    v_dot2_f32_bf16 v51, v24, v24, 0
    v_dot2_f32_bf16 v50, v25, s86, v50
    v_dot2_f32_bf16 v51, v25, v25, v51
    v_dot2_f32_bf16 v50, v26, s86, v50
    v_dot2_f32_bf16 v51, v26, v26, v51
    v_dot2_f32_bf16 v50, v27, s86, v50
    v_dot2_f32_bf16 v51, v27, v27, v51
    v_dot2_f32_bf16 v50, v28, s86, v50
    v_dot2_f32_bf16 v51, v28, v28, v51
    v_dot2_f32_bf16 v50, v29, s86, v50
    v_dot2_f32_bf16 v51, v29, v29, v51
    v_dot2_f32_bf16 v50, v30, s86, v50
    v_dot2_f32_bf16 v51, v30, v30, v51
    v_dot2_f32_bf16 v50, v31, s86, v50
    v_dot2_f32_bf16 v51, v31, v31, v51
    v_dot2_f32_bf16 v52, v32, s86, 0
    v_dot2_f32_bf16 v53, v32, v32, 0
    v_dot2_f32_bf16 v52, v33, s86, v52
    v_dot2_f32_bf16 v53, v33, v33, v53
    v_dot2_f32_bf16 v52, v34, s86, v52
    v_dot2_f32_bf16 v53, v34, v34, v53
    v_dot2_f32_bf16 v52, v35, s86, v52
    v_dot2_f32_bf16 v53, v35, v35, v53
    v_dot2_f32_bf16 v52, v36, s86, v52
    v_dot2_f32_bf16 v53, v36, v36, v53
    v_dot2_f32_bf16 v52, v37, s86, v52
    v_dot2_f32_bf16 v53, v37, v37, v53
    v_dot2_f32_bf16 v52, v38, s86, v52
    v_dot2_f32_bf16 v53, v38, v38, v53
    v_dot2_f32_bf16 v52, v39, s86, v52
    v_dot2_f32_bf16 v53, v39, v39, v53
    v_dot2_f32_bf16 v54, v40, s86, 0
    v_dot2_f32_bf16 v55, v40, v40, 0
    v_dot2_f32_bf16 v54, v41, s86, v54
    v_dot2_f32_bf16 v55, v41, v41, v55
    v_dot2_f32_bf16 v54, v42, s86, v54
    v_dot2_f32_bf16 v55, v42, v42, v55
    v_dot2_f32_bf16 v54, v43, s86, v54
    v_dot2_f32_bf16 v55, v43, v43, v55
    v_dot2_f32_bf16 v54, v44, s86, v54
    v_dot2_f32_bf16 v55, v44, v44, v55
    v_dot2_f32_bf16 v54, v45, s86, v54
    v_dot2_f32_bf16 v55, v45, v45, v55
    v_dot2_f32_bf16 v54, v46, s86, v54
    v_dot2_f32_bf16 v55, v46, v46, v55
    v_dot2_f32_bf16 v54, v47, s86, v54
    v_dot2_f32_bf16 v55, v47, v47, v55
    v_add_f32_dpp v48, v48, v48 quad_perm:[1,0,3,2] row_mask:0xf bank_mask:0xf
    v_add_f32_dpp v49, v49, v49 quad_perm:[1,0,3,2] row_mask:0xf bank_mask:0xf
    v_add_f32_dpp v50, v50, v50 quad_perm:[1,0,3,2] row_mask:0xf bank_mask:0xf
    v_add_f32_dpp v51, v51, v51 quad_perm:[1,0,3,2] row_mask:0xf bank_mask:0xf
    v_add_f32_dpp v52, v52, v52 quad_perm:[1,0,3,2] row_mask:0xf bank_mask:0xf
    v_add_f32_dpp v53, v53, v53 quad_perm:[1,0,3,2] row_mask:0xf bank_mask:0xf
    v_add_f32_dpp v54, v54, v54 quad_perm:[1,0,3,2] row_mask:0xf bank_mask:0xf
    v_add_f32_dpp v55, v55, v55 quad_perm:[1,0,3,2] row_mask:0xf bank_mask:0xf
    v_add_f32_dpp v48, v48, v48 quad_perm:[2,3,0,1] row_mask:0xf bank_mask:0xf
    v_add_f32_dpp v49, v49, v49 quad_perm:[2,3,0,1] row_mask:0xf bank_mask:0xf
    v_add_f32_dpp v50, v50, v50 quad_perm:[2,3,0,1] row_mask:0xf bank_mask:0xf
    v_add_f32_dpp v51, v51, v51 quad_perm:[2,3,0,1] row_mask:0xf bank_mask:0xf
    v_add_f32_dpp v52, v52, v52 quad_perm:[2,3,0,1] row_mask:0xf bank_mask:0xf
    v_add_f32_dpp v53, v53, v53 quad_perm:[2,3,0,1] row_mask:0xf bank_mask:0xf
    v_add_f32_dpp v54, v54, v54 quad_perm:[2,3,0,1] row_mask:0xf bank_mask:0xf
    v_add_f32_dpp v55, v55, v55 quad_perm:[2,3,0,1] row_mask:0xf bank_mask:0xf
    v_add_f32_dpp v48, v48, v48 row_half_mirror row_mask:0xf bank_mask:0xf
    v_add_f32_dpp v49, v49, v49 row_half_mirror row_mask:0xf bank_mask:0xf
    v_add_f32_dpp v50, v50, v50 row_half_mirror row_mask:0xf bank_mask:0xf
    v_add_f32_dpp v51, v51, v51 row_half_mirror row_mask:0xf bank_mask:0xf
    v_add_f32_dpp v52, v52, v52 row_half_mirror row_mask:0xf bank_mask:0xf
    v_add_f32_dpp v53, v53, v53 row_half_mirror row_mask:0xf bank_mask:0xf
    v_add_f32_dpp v54, v54, v54 row_half_mirror row_mask:0xf bank_mask:0xf
    v_add_f32_dpp v55, v55, v55 row_half_mirror row_mask:0xf bank_mask:0xf
    s_mov_b32 exec_lo, 0x2020202
    s_mov_b32 exec_hi, 0x2020202
    v_mov_b32 v48, v50
    v_mov_b32 v49, v51
    s_mov_b32 exec_lo, 0x4040404
    s_mov_b32 exec_hi, 0x4040404
    v_mov_b32 v48, v52
    v_mov_b32 v49, v53
    s_mov_b32 exec_lo, 0x8080808
    s_mov_b32 exec_hi, 0x8080808
    v_mov_b32 v48, v54
    v_mov_b32 v49, v55
    s_mov_b64 exec, -1
    v_min_u32 v48, -2, v48
    v_min_u32 v49, -2, v49
    v_and_b32 v50, 1, v0
    v_lshlrev_b32 v50, 7, v50
    v_bfe_u32 v51, v0, 1, 1
    v_lshl_add_u32 v50, v51, 6, v50
    v_and_b32 v51, 0x38, v0
    v_add_u32 v50, v51, v50
    s_sub_u32 s46, 127, s46
    s_lshl_b32 s46, s46, 10
    s_lshl_b32 s37, s32, 8
    s_add_u32 s46, s46, s37
    s_add_u32 s46, s46, 0x5400000
    s_cmp_lt_u32 s35, 16
    s_cselect_b32 s46, s46, 0x8000000
    s_mov_b32 exec_lo, 0x0f0f0f0f
    s_mov_b32 exec_hi, 0x0f0f0f0f
    buffer_store_dwordx2 v[48:49], v50, s[16:19], s46 offen sc1
    s_mov_b64 exec, -1
    s_lshr_b32 s51, s35, 2
    s_and_b32 s87, s35, 3
    s_mul_i32 s54, s51, 1441792
    s_lshl_b32 s37, s87, 9
    s_add_u32 s54, s54, s37
    s_mov_b32 s12, s76
    s_mov_b32 s13, s77
    s_mov_b32 s14, 0x700000
    s_mov_b32 s15, 0x00020000
    v_lshrrev_b32 v64, 3, v0
    v_and_b32 v65, 2, v64
    v_lshlrev_b32 v65, 1, v65
    v_and_b32 v66, 7, v0
    v_xor_b32 v65, v65, v66
    v_mul_u32_u24 v64, 2048, v64
    v_lshl_add_u32 v64, v65, 4, v64
    s_mul_i32 s38, s32, 8
    s_add_u32 s39, s38, 0
    s_and_b32 s37, s39, 7
    s_mul_i32 s37, s37, 16384
    s_lshr_b32 s39, s39, 3
    s_mul_i32 s39, s39, 128
    s_add_u32 s39, s39, s37
    v_add_u32 v48, s39, v64
    s_add_u32 s39, s38, 1
    s_and_b32 s37, s39, 7
    s_mul_i32 s37, s37, 16384
    s_lshr_b32 s39, s39, 3
    s_mul_i32 s39, s39, 128
    s_add_u32 s39, s39, s37
    v_add_u32 v49, s39, v64
    s_add_u32 s39, s38, 2
    s_and_b32 s37, s39, 7
    s_mul_i32 s37, s37, 16384
    s_lshr_b32 s39, s39, 3
    s_mul_i32 s39, s39, 128
    s_add_u32 s39, s39, s37
    v_add_u32 v50, s39, v64
    s_add_u32 s39, s38, 3
    s_and_b32 s37, s39, 7
    s_mul_i32 s37, s37, 16384
    s_lshr_b32 s39, s39, 3
    s_mul_i32 s39, s39, 128
    s_add_u32 s39, s39, s37
    v_add_u32 v51, s39, v64
    s_add_u32 s39, s38, 4
    s_and_b32 s37, s39, 7
    s_mul_i32 s37, s37, 16384
    s_lshr_b32 s39, s39, 3
    s_mul_i32 s39, s39, 128
    s_add_u32 s39, s39, s37
    v_add_u32 v52, s39, v64
    s_add_u32 s39, s38, 5
    s_and_b32 s37, s39, 7
    s_mul_i32 s37, s37, 16384
    s_lshr_b32 s39, s39, 3
    s_mul_i32 s39, s39, 128
    s_add_u32 s39, s39, s37
    v_add_u32 v53, s39, v64
    s_add_u32 s39, s38, 6
    s_and_b32 s37, s39, 7
    s_mul_i32 s37, s37, 16384
    s_lshr_b32 s39, s39, 3
    s_mul_i32 s39, s39, 128
    s_add_u32 s39, s39, s37
    v_add_u32 v54, s39, v64
    s_add_u32 s39, s38, 7
    s_and_b32 s37, s39, 7
    s_mul_i32 s37, s37, 16384
    s_lshr_b32 s39, s39, 3
    s_mul_i32 s39, s39, 128
    s_add_u32 s39, s39, s37
    v_add_u32 v55, s39, v64
    s_mul_i32 s42, s32, 8192
    s_add_u32 m0, s42, 0
    s_nop 0
    buffer_load_dwordx4 v48, s[12:15], s54 offen lds
    s_add_u32 m0, s42, 1024
    s_nop 0
    buffer_load_dwordx4 v49, s[12:15], s54 offen lds
    s_add_u32 m0, s42, 2048
    s_nop 0
    buffer_load_dwordx4 v50, s[12:15], s54 offen lds
    s_add_u32 m0, s42, 3072
    s_nop 0
    buffer_load_dwordx4 v51, s[12:15], s54 offen lds
    s_add_u32 m0, s42, 4096
    s_nop 0
    buffer_load_dwordx4 v52, s[12:15], s54 offen lds
    s_add_u32 m0, s42, 5120
    s_nop 0
    buffer_load_dwordx4 v53, s[12:15], s54 offen lds
    s_add_u32 m0, s42, 6144
    s_nop 0
    buffer_load_dwordx4 v54, s[12:15], s54 offen lds
    s_add_u32 m0, s42, 7168
    s_nop 0
    buffer_load_dwordx4 v55, s[12:15], s54 offen lds
    s_add_u32 s54, s54, 131072
    s_add_u32 m0, s42, 32768
    s_nop 0
    buffer_load_dwordx4 v48, s[12:15], s54 offen lds
    s_add_u32 m0, s42, 33792
    s_nop 0
    buffer_load_dwordx4 v49, s[12:15], s54 offen lds
    s_add_u32 m0, s42, 34816
    s_nop 0
    buffer_load_dwordx4 v50, s[12:15], s54 offen lds
    s_add_u32 m0, s42, 35840
    s_nop 0
    buffer_load_dwordx4 v51, s[12:15], s54 offen lds
    s_add_u32 m0, s42, 36864
    s_nop 0
    buffer_load_dwordx4 v52, s[12:15], s54 offen lds
    s_add_u32 m0, s42, 37888
    s_nop 0
    buffer_load_dwordx4 v53, s[12:15], s54 offen lds
    s_add_u32 m0, s42, 38912
    s_nop 0
    buffer_load_dwordx4 v54, s[12:15], s54 offen lds
    s_add_u32 m0, s42, 39936
    s_nop 0
    buffer_load_dwordx4 v55, s[12:15], s54 offen lds
    s_add_u32 s54, s54, 131072
    s_add_u32 m0, s42, 65536
    s_nop 0
    buffer_load_dwordx4 v48, s[12:15], s54 offen lds
    s_add_u32 m0, s42, 66560
    s_nop 0
    buffer_load_dwordx4 v49, s[12:15], s54 offen lds
    s_add_u32 m0, s42, 67584
    s_nop 0
    buffer_load_dwordx4 v50, s[12:15], s54 offen lds
    s_add_u32 m0, s42, 68608
    s_nop 0
    buffer_load_dwordx4 v51, s[12:15], s54 offen lds
    s_add_u32 m0, s42, 69632
    s_nop 0
    buffer_load_dwordx4 v52, s[12:15], s54 offen lds
    s_add_u32 m0, s42, 70656
    s_nop 0
    buffer_load_dwordx4 v53, s[12:15], s54 offen lds
    s_add_u32 m0, s42, 71680
    s_nop 0
    buffer_load_dwordx4 v54, s[12:15], s54 offen lds
    s_add_u32 m0, s42, 72704
    s_nop 0
    buffer_load_dwordx4 v55, s[12:15], s54 offen lds
    s_add_u32 s54, s54, 131072
    s_add_u32 m0, s42, 98304
    s_nop 0
    buffer_load_dwordx4 v48, s[12:15], s54 offen lds
    s_add_u32 m0, s42, 99328
    s_nop 0
    buffer_load_dwordx4 v49, s[12:15], s54 offen lds
    s_add_u32 m0, s42, 100352
    s_nop 0
    buffer_load_dwordx4 v50, s[12:15], s54 offen lds
    s_add_u32 m0, s42, 101376
    s_nop 0
    buffer_load_dwordx4 v51, s[12:15], s54 offen lds
    s_add_u32 m0, s42, 102400
    s_nop 0
    buffer_load_dwordx4 v52, s[12:15], s54 offen lds
    s_add_u32 m0, s42, 103424
    s_nop 0
    buffer_load_dwordx4 v53, s[12:15], s54 offen lds
    s_add_u32 m0, s42, 104448
    s_nop 0
    buffer_load_dwordx4 v54, s[12:15], s54 offen lds
    s_add_u32 m0, s42, 105472
    s_nop 0
    buffer_load_dwordx4 v55, s[12:15], s54 offen lds
    s_add_u32 s54, s54, 131072
    v_lshrrev_b32 v64, 4, v0
    v_bfe_u32 v65, v0, 2, 2
    v_lshl_add_u32 v64, v64, 3, v65
    v_lshlrev_b32 v64, 7, v64
    v_lshrrev_b32 v65, 1, v65
    v_lshl_add_u32 v64, v65, 6, v64
    v_and_b32 v65, 3, v0
    v_lshl_add_u32 v64, v65, 4, v64
    s_lshl_b32 s37, s32, 13
    s_and_b32 s38, s51, 2
    s_lshl_b32 s38, s38, 5
    s_xor_b32 s38, s38, 0
    s_add_u32 s37, s37, s38
    v_xor_b32 v56, s37, v64
    s_lshl_b32 s37, s32, 13
    s_and_b32 s38, s51, 2
    s_lshl_b32 s38, s38, 5
    s_xor_b32 s38, s38, 8
    s_add_u32 s37, s37, s38
    v_xor_b32 v57, s37, v64
    s_lshl_b32 s37, s32, 13
    s_and_b32 s38, s51, 2
    s_lshl_b32 s38, s38, 5
    s_xor_b32 s38, s38, 64
    s_add_u32 s37, s37, s38
    v_xor_b32 v58, s37, v64
    s_lshl_b32 s37, s32, 13
    s_and_b32 s38, s51, 2
    s_lshl_b32 s38, s38, 5
    s_xor_b32 s38, s38, 72
    s_add_u32 s37, s37, s38
    v_xor_b32 v59, s37, v64
    s_and_b32 s39, s51, 1
    s_lshl_b32 s37, s39, 10
    v_add_u32 v2, s37, v1
    v_xor_b32 v3, 1024, v2
    v_add_u32 v4, 98304, v2
    v_add_u32 v5, 98304, v3
    s_mul_i32 s38, s51, 11*43
    s_lshr_b32 s38, s38, 7
    s_add_u32 s38, s38, 24
    s_lshl_b32 s37, s33, 6
    s_add_u32 s37, s37, s38
    s_lshl_b32 s37, s37, 8
    v_lshl_add_u32 v6, v0, 8, s37
    s_cmp_eq_u32 s32, 0
    s_cselect_b32 s37, 5, 0
    v_cmp_le_u32 vcc, s37, v0
    s_nop 1
    v_cndmask_b32 v6, v6, 2.0, vcc
    s_mul_i32 s43, s32, 3072
    s_lshl_b32 s88, s32, 11
    s_sub_u32 s89, s88, s43
    s_mul_i32 s41, s33, 7340032
    s_add_u32 s41, s41, 0x1000000
    s_mul_i32 s37, s51, 45056
    s_add_u32 s41, s41, s37
    s_add_u32 s41, s41, s43
    s_mul_i32 s90, s33, 8388608
    s_add_u32 s90, s90, 0x2fc0000
    s_lshl_b32 s37, s87, 16
    s_add_u32 s90, s90, s37
    s_lshl_b32 s37, s32, 12
    s_add_u32 s90, s90, s37
    s_and_b32 s37, s51, 3
    s_lshl_b32 s37, s37, 14
    s_add_u32 s90, s90, s37
    v_add_u32 v60, 0, v56
    v_add_u32 v61, 0, v57
    v_add_u32 v62, 0, v58
    v_add_u32 v63, 0, v59
    s_waitcnt vmcnt(24)
    s_barrier
    s_cmp_lg_u32 s32, 3
    s_cbranch_scc1 L_arr56
    s_mov_b32 s20, s82
    s_mov_b32 s21, s83
    s_mov_b32 s22, 0x100
    s_mov_b32 s23, 0x00020000
    s_and_b32 s37, s2, 15
    s_lshl_b32 s37, s37, 4
    v_mov_b32 v123, 1
    buffer_atomic_add v123, v124, s[20:23], s37 offen
L_arr56:
    ds_read_b64_tr_b16 a[0:1], v60 offset:0
    ds_read_b64_tr_b16 a[2:3], v60 offset:512
    ds_read_b64_tr_b16 a[4:5], v61 offset:0
    ds_read_b64_tr_b16 a[6:7], v61 offset:512
    ds_read_b64_tr_b16 a[8:9], v62 offset:0
    ds_read_b64_tr_b16 a[10:11], v62 offset:512
    ds_read_b64_tr_b16 a[12:13], v63 offset:0
    ds_read_b64_tr_b16 a[14:15], v63 offset:512
    ds_read_b64_tr_b16 a[16:17], v60 offset:4096
    ds_read_b64_tr_b16 a[18:19], v60 offset:4608
    ds_read_b64_tr_b16 a[20:21], v61 offset:4096
    ds_read_b64_tr_b16 a[22:23], v61 offset:4608
    ds_read_b64_tr_b16 a[24:25], v62 offset:4096
    ds_read_b64_tr_b16 a[26:27], v62 offset:4608
    ds_read_b64_tr_b16 a[28:29], v63 offset:4096
    ds_read_b64_tr_b16 a[30:31], v63 offset:4608
    s_add_u32 m0, s42, 131072
    s_nop 0
    buffer_load_dwordx4 v48, s[12:15], s54 offen lds
    s_add_u32 m0, s42, 132096
    s_nop 0
    buffer_load_dwordx4 v49, s[12:15], s54 offen lds
    s_add_u32 m0, s42, 133120
    s_nop 0
    buffer_load_dwordx4 v50, s[12:15], s54 offen lds
    s_add_u32 m0, s42, 134144
    s_nop 0
    buffer_load_dwordx4 v51, s[12:15], s54 offen lds
    s_add_u32 m0, s42, 135168
    s_nop 0
    buffer_load_dwordx4 v52, s[12:15], s54 offen lds
    s_add_u32 m0, s42, 136192
    s_nop 0
    buffer_load_dwordx4 v53, s[12:15], s54 offen lds
    s_add_u32 m0, s42, 137216
    s_nop 0
    buffer_load_dwordx4 v54, s[12:15], s54 offen lds
    s_add_u32 m0, s42, 138240
    s_nop 0
    buffer_load_dwordx4 v55, s[12:15], s54 offen lds
    s_add_u32 s54, s54, 131072
    s_waitcnt lgkmcnt(0)
    v_add_u32 v60, 32768, v56
    v_add_u32 v61, 32768, v57
    v_add_u32 v62, 32768, v58
    v_add_u32 v63, 32768, v59
    s_waitcnt vmcnt(24)
    s_barrier
    ds_read_b64_tr_b16 a[32:33], v60 offset:0
    ds_read_b64_tr_b16 a[34:35], v60 offset:512
    ds_read_b64_tr_b16 a[36:37], v61 offset:0
    ds_read_b64_tr_b16 a[38:39], v61 offset:512
    ds_read_b64_tr_b16 a[40:41], v62 offset:0
    ds_read_b64_tr_b16 a[42:43], v62 offset:512
    ds_read_b64_tr_b16 a[44:45], v63 offset:0
    ds_read_b64_tr_b16 a[46:47], v63 offset:512
    ds_read_b64_tr_b16 a[48:49], v60 offset:4096
    ds_read_b64_tr_b16 a[50:51], v60 offset:4608
    ds_read_b64_tr_b16 a[52:53], v61 offset:4096
    ds_read_b64_tr_b16 a[54:55], v61 offset:4608
    ds_read_b64_tr_b16 a[56:57], v62 offset:4096
    ds_read_b64_tr_b16 a[58:59], v62 offset:4608
    ds_read_b64_tr_b16 a[60:61], v63 offset:4096
    ds_read_b64_tr_b16 a[62:63], v63 offset:4608
    s_add_u32 m0, s42, 0
    s_nop 0
    buffer_load_dwordx4 v48, s[12:15], s54 offen lds
    s_add_u32 m0, s42, 1024
    s_nop 0
    buffer_load_dwordx4 v49, s[12:15], s54 offen lds
    s_add_u32 m0, s42, 2048
    s_nop 0
    buffer_load_dwordx4 v50, s[12:15], s54 offen lds
    s_add_u32 m0, s42, 3072
    s_nop 0
    buffer_load_dwordx4 v51, s[12:15], s54 offen lds
    s_add_u32 m0, s42, 4096
    s_nop 0
    buffer_load_dwordx4 v52, s[12:15], s54 offen lds
    s_add_u32 m0, s42, 5120
    s_nop 0
    buffer_load_dwordx4 v53, s[12:15], s54 offen lds
    s_add_u32 m0, s42, 6144
    s_nop 0
    buffer_load_dwordx4 v54, s[12:15], s54 offen lds
    s_add_u32 m0, s42, 7168
    s_nop 0
    buffer_load_dwordx4 v55, s[12:15], s54 offen lds
    s_add_u32 s54, s54, 131072
    s_waitcnt lgkmcnt(0)
    v_add_u32 v60, 65536, v56
    v_add_u32 v61, 65536, v57
    v_add_u32 v62, 65536, v58
    v_add_u32 v63, 65536, v59
    s_waitcnt vmcnt(24)
    s_barrier
    ds_read_b64_tr_b16 a[64:65], v60 offset:0
    ds_read_b64_tr_b16 a[66:67], v60 offset:512
    ds_read_b64_tr_b16 a[68:69], v61 offset:0
    ds_read_b64_tr_b16 a[70:71], v61 offset:512
    ds_read_b64_tr_b16 a[72:73], v62 offset:0
    ds_read_b64_tr_b16 a[74:75], v62 offset:512
    ds_read_b64_tr_b16 a[76:77], v63 offset:0
    ds_read_b64_tr_b16 a[78:79], v63 offset:512
    ds_read_b64_tr_b16 a[80:81], v60 offset:4096
    ds_read_b64_tr_b16 a[82:83], v60 offset:4608
    ds_read_b64_tr_b16 a[84:85], v61 offset:4096
    ds_read_b64_tr_b16 a[86:87], v61 offset:4608
    ds_read_b64_tr_b16 a[88:89], v62 offset:4096
    ds_read_b64_tr_b16 a[90:91], v62 offset:4608
    ds_read_b64_tr_b16 a[92:93], v63 offset:4096
    ds_read_b64_tr_b16 a[94:95], v63 offset:4608
    s_add_u32 m0, s42, 32768
    s_nop 0
    buffer_load_dwordx4 v48, s[12:15], s54 offen lds
    s_add_u32 m0, s42, 33792
    s_nop 0
    buffer_load_dwordx4 v49, s[12:15], s54 offen lds
    s_add_u32 m0, s42, 34816
    s_nop 0
    buffer_load_dwordx4 v50, s[12:15], s54 offen lds
    s_add_u32 m0, s42, 35840
    s_nop 0
    buffer_load_dwordx4 v51, s[12:15], s54 offen lds
    s_add_u32 m0, s42, 36864
    s_nop 0
    buffer_load_dwordx4 v52, s[12:15], s54 offen lds
    s_add_u32 m0, s42, 37888
    s_nop 0
    buffer_load_dwordx4 v53, s[12:15], s54 offen lds
    s_add_u32 m0, s42, 38912
    s_nop 0
    buffer_load_dwordx4 v54, s[12:15], s54 offen lds
    s_add_u32 m0, s42, 39936
    s_nop 0
    buffer_load_dwordx4 v55, s[12:15], s54 offen lds
    s_add_u32 s54, s54, 131072
    s_waitcnt lgkmcnt(0)
    v_add_u32 v60, 98304, v56
    v_add_u32 v61, 98304, v57
    v_add_u32 v62, 98304, v58
    v_add_u32 v63, 98304, v59
    s_waitcnt vmcnt(24)
    s_barrier
    ds_read_b64_tr_b16 a[96:97], v60 offset:0
    ds_read_b64_tr_b16 a[98:99], v60 offset:512
    ds_read_b64_tr_b16 a[100:101], v61 offset:0
    ds_read_b64_tr_b16 a[102:103], v61 offset:512
    ds_read_b64_tr_b16 a[104:105], v62 offset:0
    ds_read_b64_tr_b16 a[106:107], v62 offset:512
    ds_read_b64_tr_b16 a[108:109], v63 offset:0
    ds_read_b64_tr_b16 a[110:111], v63 offset:512
    ds_read_b64_tr_b16 a[112:113], v60 offset:4096
    ds_read_b64_tr_b16 a[114:115], v60 offset:4608
    ds_read_b64_tr_b16 a[116:117], v61 offset:4096
    ds_read_b64_tr_b16 a[118:119], v61 offset:4608
    ds_read_b64_tr_b16 a[120:121], v62 offset:4096
    ds_read_b64_tr_b16 a[122:123], v62 offset:4608
    ds_read_b64_tr_b16 a[124:125], v63 offset:4096
    ds_read_b64_tr_b16 a[126:127], v63 offset:4608
    s_add_u32 m0, s42, 65536
    s_nop 0
    buffer_load_dwordx4 v48, s[12:15], s54 offen lds
    s_add_u32 m0, s42, 66560
    s_nop 0
    buffer_load_dwordx4 v49, s[12:15], s54 offen lds
    s_add_u32 m0, s42, 67584
    s_nop 0
    buffer_load_dwordx4 v50, s[12:15], s54 offen lds
    s_add_u32 m0, s42, 68608
    s_nop 0
    buffer_load_dwordx4 v51, s[12:15], s54 offen lds
    s_add_u32 m0, s42, 69632
    s_nop 0
    buffer_load_dwordx4 v52, s[12:15], s54 offen lds
    s_add_u32 m0, s42, 70656
    s_nop 0
    buffer_load_dwordx4 v53, s[12:15], s54 offen lds
    s_add_u32 m0, s42, 71680
    s_nop 0
    buffer_load_dwordx4 v54, s[12:15], s54 offen lds
    s_add_u32 m0, s42, 72704
    s_nop 0
    buffer_load_dwordx4 v55, s[12:15], s54 offen lds
    s_add_u32 s54, s54, 131072
    s_waitcnt lgkmcnt(0)
    v_add_u32 v60, 131072, v56
    v_add_u32 v61, 131072, v57
    v_add_u32 v62, 131072, v58
    v_add_u32 v63, 131072, v59
    s_waitcnt vmcnt(24)
    s_barrier
    ds_read_b64_tr_b16 a[128:129], v60 offset:0
    ds_read_b64_tr_b16 a[130:131], v60 offset:512
    ds_read_b64_tr_b16 a[132:133], v61 offset:0
    ds_read_b64_tr_b16 a[134:135], v61 offset:512
    ds_read_b64_tr_b16 a[136:137], v62 offset:0
    ds_read_b64_tr_b16 a[138:139], v62 offset:512
    ds_read_b64_tr_b16 a[140:141], v63 offset:0
    ds_read_b64_tr_b16 a[142:143], v63 offset:512
    ds_read_b64_tr_b16 a[144:145], v60 offset:4096
    ds_read_b64_tr_b16 a[146:147], v60 offset:4608
    ds_read_b64_tr_b16 a[148:149], v61 offset:4096
    ds_read_b64_tr_b16 a[150:151], v61 offset:4608
    ds_read_b64_tr_b16 a[152:153], v62 offset:4096
    ds_read_b64_tr_b16 a[154:155], v62 offset:4608
    ds_read_b64_tr_b16 a[156:157], v63 offset:4096
    ds_read_b64_tr_b16 a[158:159], v63 offset:4608
    s_add_u32 m0, s42, 98304
    s_nop 0
    buffer_load_dwordx4 v48, s[12:15], s54 offen lds
    s_add_u32 m0, s42, 99328
    s_nop 0
    buffer_load_dwordx4 v49, s[12:15], s54 offen lds
    s_add_u32 m0, s42, 100352
    s_nop 0
    buffer_load_dwordx4 v50, s[12:15], s54 offen lds
    s_add_u32 m0, s42, 101376
    s_nop 0
    buffer_load_dwordx4 v51, s[12:15], s54 offen lds
    s_add_u32 m0, s42, 102400
    s_nop 0
    buffer_load_dwordx4 v52, s[12:15], s54 offen lds
    s_add_u32 m0, s42, 103424
    s_nop 0
    buffer_load_dwordx4 v53, s[12:15], s54 offen lds
    s_add_u32 m0, s42, 104448
    s_nop 0
    buffer_load_dwordx4 v54, s[12:15], s54 offen lds
    s_add_u32 m0, s42, 105472
    s_nop 0
    buffer_load_dwordx4 v55, s[12:15], s54 offen lds
    s_add_u32 s54, s54, 131072
    s_waitcnt lgkmcnt(0)
    v_add_u32 v60, 0, v56
    v_add_u32 v61, 0, v57
    v_add_u32 v62, 0, v58
    v_add_u32 v63, 0, v59
    s_waitcnt vmcnt(24)
    s_barrier
    ds_read_b64_tr_b16 a[160:161], v60 offset:0
    ds_read_b64_tr_b16 a[162:163], v60 offset:512
    ds_read_b64_tr_b16 a[164:165], v61 offset:0
    ds_read_b64_tr_b16 a[166:167], v61 offset:512
    ds_read_b64_tr_b16 a[168:169], v62 offset:0
    ds_read_b64_tr_b16 a[170:171], v62 offset:512
    ds_read_b64_tr_b16 a[172:173], v63 offset:0
    ds_read_b64_tr_b16 a[174:175], v63 offset:512
    ds_read_b64_tr_b16 a[176:177], v60 offset:4096
    ds_read_b64_tr_b16 a[178:179], v60 offset:4608
    ds_read_b64_tr_b16 a[180:181], v61 offset:4096
    ds_read_b64_tr_b16 a[182:183], v61 offset:4608
    ds_read_b64_tr_b16 a[184:185], v62 offset:4096
    ds_read_b64_tr_b16 a[186:187], v62 offset:4608
    ds_read_b64_tr_b16 a[188:189], v63 offset:4096
    ds_read_b64_tr_b16 a[190:191], v63 offset:4608
    s_add_u32 m0, s42, 131072
    s_nop 0
    buffer_load_dwordx4 v48, s[12:15], s54 offen lds
    s_add_u32 m0, s42, 132096
    s_nop 0
    buffer_load_dwordx4 v49, s[12:15], s54 offen lds
    s_add_u32 m0, s42, 133120
    s_nop 0
    buffer_load_dwordx4 v50, s[12:15], s54 offen lds
    s_add_u32 m0, s42, 134144
    s_nop 0
    buffer_load_dwordx4 v51, s[12:15], s54 offen lds
    s_add_u32 m0, s42, 135168
    s_nop 0
    buffer_load_dwordx4 v52, s[12:15], s54 offen lds
    s_add_u32 m0, s42, 136192
    s_nop 0
    buffer_load_dwordx4 v53, s[12:15], s54 offen lds
    s_add_u32 m0, s42, 137216
    s_nop 0
    buffer_load_dwordx4 v54, s[12:15], s54 offen lds
    s_add_u32 m0, s42, 138240
    s_nop 0
    buffer_load_dwordx4 v55, s[12:15], s54 offen lds
    s_add_u32 s54, s54, 131072
    s_waitcnt lgkmcnt(0)
    v_add_u32 v60, 32768, v56
    v_add_u32 v61, 32768, v57
    v_add_u32 v62, 32768, v58
    v_add_u32 v63, 32768, v59
    s_waitcnt vmcnt(24)
    s_barrier
    ds_read_b64_tr_b16 a[192:193], v60 offset:0
    ds_read_b64_tr_b16 a[194:195], v60 offset:512
    ds_read_b64_tr_b16 a[196:197], v61 offset:0
    ds_read_b64_tr_b16 a[198:199], v61 offset:512
    ds_read_b64_tr_b16 a[200:201], v62 offset:0
    ds_read_b64_tr_b16 a[202:203], v62 offset:512
    ds_read_b64_tr_b16 a[204:205], v63 offset:0
    ds_read_b64_tr_b16 a[206:207], v63 offset:512
    ds_read_b64_tr_b16 a[208:209], v60 offset:4096
    ds_read_b64_tr_b16 a[210:211], v60 offset:4608
    ds_read_b64_tr_b16 a[212:213], v61 offset:4096
    ds_read_b64_tr_b16 a[214:215], v61 offset:4608
    ds_read_b64_tr_b16 a[216:217], v62 offset:4096
    ds_read_b64_tr_b16 a[218:219], v62 offset:4608
    ds_read_b64_tr_b16 a[220:221], v63 offset:4096
    ds_read_b64_tr_b16 a[222:223], v63 offset:4608
    s_add_u32 m0, s42, 0
    s_nop 0
    buffer_load_dwordx4 v48, s[12:15], s54 offen lds
    s_add_u32 m0, s42, 1024
    s_nop 0
    buffer_load_dwordx4 v49, s[12:15], s54 offen lds
    s_add_u32 m0, s42, 2048
    s_nop 0
    buffer_load_dwordx4 v50, s[12:15], s54 offen lds
    s_add_u32 m0, s42, 3072
    s_nop 0
    buffer_load_dwordx4 v51, s[12:15], s54 offen lds
    s_add_u32 m0, s42, 4096
    s_nop 0
    buffer_load_dwordx4 v52, s[12:15], s54 offen lds
    s_add_u32 m0, s42, 5120
    s_nop 0
    buffer_load_dwordx4 v53, s[12:15], s54 offen lds
    s_add_u32 m0, s42, 6144
    s_nop 0
    buffer_load_dwordx4 v54, s[12:15], s54 offen lds
    s_add_u32 m0, s42, 7168
    s_nop 0
    buffer_load_dwordx4 v55, s[12:15], s54 offen lds
    s_add_u32 s54, s54, 131072
    s_waitcnt lgkmcnt(0)
    v_add_u32 v60, 65536, v56
    v_add_u32 v61, 65536, v57
    v_add_u32 v62, 65536, v58
    v_add_u32 v63, 65536, v59
    s_waitcnt vmcnt(24)
    s_barrier
    ds_read_b64_tr_b16 a[224:225], v60 offset:0
    ds_read_b64_tr_b16 a[226:227], v60 offset:512
    ds_read_b64_tr_b16 a[228:229], v61 offset:0
    ds_read_b64_tr_b16 a[230:231], v61 offset:512
    ds_read_b64_tr_b16 a[232:233], v62 offset:0
    ds_read_b64_tr_b16 a[234:235], v62 offset:512
    ds_read_b64_tr_b16 a[236:237], v63 offset:0
    ds_read_b64_tr_b16 a[238:239], v63 offset:512
    ds_read_b64_tr_b16 a[240:241], v60 offset:4096
    ds_read_b64_tr_b16 a[242:243], v60 offset:4608
    ds_read_b64_tr_b16 a[244:245], v61 offset:4096
    ds_read_b64_tr_b16 a[246:247], v61 offset:4608
    ds_read_b64_tr_b16 a[248:249], v62 offset:4096
    ds_read_b64_tr_b16 a[250:251], v62 offset:4608
    ds_read_b64_tr_b16 a[252:253], v63 offset:4096
    ds_read_b64_tr_b16 a[254:255], v63 offset:4608
    s_add_u32 m0, s42, 32768
    s_nop 0
    buffer_load_dwordx4 v48, s[12:15], s54 offen lds
    s_add_u32 m0, s42, 33792
    s_nop 0
    buffer_load_dwordx4 v49, s[12:15], s54 offen lds
    s_add_u32 m0, s42, 34816
    s_nop 0
    buffer_load_dwordx4 v50, s[12:15], s54 offen lds
    s_add_u32 m0, s42, 35840
    s_nop 0
    buffer_load_dwordx4 v51, s[12:15], s54 offen lds
    s_add_u32 m0, s42, 36864
    s_nop 0
    buffer_load_dwordx4 v52, s[12:15], s54 offen lds
    s_add_u32 m0, s42, 37888
    s_nop 0
    buffer_load_dwordx4 v53, s[12:15], s54 offen lds
    s_add_u32 m0, s42, 38912
    s_nop 0
    buffer_load_dwordx4 v54, s[12:15], s54 offen lds
    s_add_u32 m0, s42, 39936
    s_nop 0
    buffer_load_dwordx4 v55, s[12:15], s54 offen lds
    s_add_u32 s54, s54, 131072
    s_waitcnt lgkmcnt(0)
    v_add_u32 v60, 98304, v56
    v_add_u32 v61, 98304, v57
    v_add_u32 v62, 98304, v58
    v_add_u32 v63, 98304, v59
    s_waitcnt vmcnt(24)
    s_barrier
    ds_read_b64_tr_b16 v[128:129], v60 offset:0
    ds_read_b64_tr_b16 v[130:131], v60 offset:512
    ds_read_b64_tr_b16 v[132:133], v61 offset:0
    ds_read_b64_tr_b16 v[134:135], v61 offset:512
    ds_read_b64_tr_b16 v[136:137], v62 offset:0
    ds_read_b64_tr_b16 v[138:139], v62 offset:512
    ds_read_b64_tr_b16 v[140:141], v63 offset:0
    ds_read_b64_tr_b16 v[142:143], v63 offset:512
    ds_read_b64_tr_b16 v[144:145], v60 offset:4096
    ds_read_b64_tr_b16 v[146:147], v60 offset:4608
    ds_read_b64_tr_b16 v[148:149], v61 offset:4096
    ds_read_b64_tr_b16 v[150:151], v61 offset:4608
    ds_read_b64_tr_b16 v[152:153], v62 offset:4096
    ds_read_b64_tr_b16 v[154:155], v62 offset:4608
    ds_read_b64_tr_b16 v[156:157], v63 offset:4096
    ds_read_b64_tr_b16 v[158:159], v63 offset:4608
    s_waitcnt lgkmcnt(0)
    v_add_u32 v60, 131072, v56
    v_add_u32 v61, 131072, v57
    v_add_u32 v62, 131072, v58
    v_add_u32 v63, 131072, v59
    s_waitcnt vmcnt(16)
    s_barrier
    ds_read_b64_tr_b16 v[160:161], v60 offset:0
    ds_read_b64_tr_b16 v[162:163], v60 offset:512
    ds_read_b64_tr_b16 v[164:165], v61 offset:0
    ds_read_b64_tr_b16 v[166:167], v61 offset:512
    ds_read_b64_tr_b16 v[168:169], v62 offset:0
    ds_read_b64_tr_b16 v[170:171], v62 offset:512
    ds_read_b64_tr_b16 v[172:173], v63 offset:0
    ds_read_b64_tr_b16 v[174:175], v63 offset:512
    ds_read_b64_tr_b16 v[176:177], v60 offset:4096
    ds_read_b64_tr_b16 v[178:179], v60 offset:4608
    ds_read_b64_tr_b16 v[180:181], v61 offset:4096
    ds_read_b64_tr_b16 v[182:183], v61 offset:4608
    ds_read_b64_tr_b16 v[184:185], v62 offset:4096
    ds_read_b64_tr_b16 v[186:187], v62 offset:4608
    ds_read_b64_tr_b16 v[188:189], v63 offset:4096
    ds_read_b64_tr_b16 v[190:191], v63 offset:4608
    s_waitcnt lgkmcnt(0)
    v_add_u32 v60, 0, v56
    v_add_u32 v61, 0, v57
    v_add_u32 v62, 0, v58
    v_add_u32 v63, 0, v59
    s_waitcnt vmcnt(8)
    s_barrier
    ds_read_b64_tr_b16 v[192:193], v60 offset:0
    ds_read_b64_tr_b16 v[194:195], v60 offset:512
    ds_read_b64_tr_b16 v[196:197], v61 offset:0
    ds_read_b64_tr_b16 v[198:199], v61 offset:512
    ds_read_b64_tr_b16 v[200:201], v62 offset:0
    ds_read_b64_tr_b16 v[202:203], v62 offset:512
    ds_read_b64_tr_b16 v[204:205], v63 offset:0
    ds_read_b64_tr_b16 v[206:207], v63 offset:512
    ds_read_b64_tr_b16 v[208:209], v60 offset:4096
    ds_read_b64_tr_b16 v[210:211], v60 offset:4608
    ds_read_b64_tr_b16 v[212:213], v61 offset:4096
    ds_read_b64_tr_b16 v[214:215], v61 offset:4608
    ds_read_b64_tr_b16 v[216:217], v62 offset:4096
    ds_read_b64_tr_b16 v[218:219], v62 offset:4608
    ds_read_b64_tr_b16 v[220:221], v63 offset:4096
    ds_read_b64_tr_b16 v[222:223], v63 offset:4608
    s_waitcnt lgkmcnt(0)
    v_add_u32 v60, 32768, v56
    v_add_u32 v61, 32768, v57
    v_add_u32 v62, 32768, v58
    v_add_u32 v63, 32768, v59
    s_waitcnt vmcnt(0)
    s_barrier
    ds_read_b64_tr_b16 v[224:225], v60 offset:0
    ds_read_b64_tr_b16 v[226:227], v60 offset:512
    ds_read_b64_tr_b16 v[228:229], v61 offset:0
    ds_read_b64_tr_b16 v[230:231], v61 offset:512
    ds_read_b64_tr_b16 v[232:233], v62 offset:0
    ds_read_b64_tr_b16 v[234:235], v62 offset:512
    ds_read_b64_tr_b16 v[236:237], v63 offset:0
    ds_read_b64_tr_b16 v[238:239], v63 offset:512
    ds_read_b64_tr_b16 v[240:241], v60 offset:4096
    ds_read_b64_tr_b16 v[242:243], v60 offset:4608
    ds_read_b64_tr_b16 v[244:245], v61 offset:4096
    ds_read_b64_tr_b16 v[246:247], v61 offset:4608
    ds_read_b64_tr_b16 v[248:249], v62 offset:4096
    ds_read_b64_tr_b16 v[250:251], v62 offset:4608
    ds_read_b64_tr_b16 v[252:253], v63 offset:4096
    ds_read_b64_tr_b16 v[254:255], v63 offset:4608
    s_waitcnt lgkmcnt(0)
    s_barrier
    s_cmp_lg_u32 s32, 0
    s_cbranch_scc1 L_arv57
    s_mov_b32 s20, s82
    s_mov_b32 s21, s83
    s_mov_b32 s22, 0x100
    s_mov_b32 s23, 0x00020000
    v_and_b32 v80, 15, v0
    v_lshlrev_b32 v80, 4, v80
    buffer_load_dword v81, v80, s[20:23], 0 offen sc1
    s_waitcnt vmcnt(0)
    v_cmp_gt_u32 vcc, 16, v81
    s_cbranch_vccnz L_spin58
L_back59:
L_arv57:
    s_add_u32 s96, s41, 7110656
    s_mov_b32 s45, 0x5560000
    buffer_load_dword v96, v6, s[16:19], s45 offen sc1
    s_waitcnt vmcnt(0)
    v_cmp_ne_u32 vcc, 0, v96
    s_cbranch_vccnz L_spin60
L_back61:
    s_barrier
    s_add_u32 m0, s43, 0
    s_add_u32 s42, s41, 0
    buffer_load_dwordx4 v1, s[16:19], s42 offen offset:0 sc1 lds
    buffer_load_dwordx4 v1, s[16:19], s42 offen offset:1024 sc1 lds
    buffer_load_dwordx4 v1, s[16:19], s42 offen offset:2048 sc1 lds
    s_add_u32 m0, s43, 12288
    s_add_u32 s42, s41, 12288
    buffer_load_dwordx4 v1, s[16:19], s42 offen offset:0 sc1 lds
    buffer_load_dwordx4 v1, s[16:19], s42 offen offset:1024 sc1 lds
    buffer_load_dwordx4 v1, s[16:19], s42 offen offset:2048 sc1 lds
    s_add_u32 m0, s43, 24576
    s_add_u32 s42, s41, 24576
    buffer_load_dwordx4 v1, s[16:19], s42 offen offset:0 sc1 lds
    buffer_load_dwordx4 v1, s[16:19], s42 offen offset:1024 sc1 lds
    buffer_load_dwordx4 v1, s[16:19], s42 offen offset:2048 sc1 lds
    s_add_u32 s45, s45, 131072
    s_waitcnt vmcnt(0) lgkmcnt(0)
    s_barrier
    s_mov_b32 s52, 0x8000000
    s_add_u32 s20, s84, 0x8000000
    s_addc_u32 s21, s85, 0
    s_mov_b32 s22, 0x400000
    s_mov_b32 s23, 0x00020000
    ds_read_b128 v[80:83], v2 offset:0
    ds_read_b128 v[84:87], v3 offset:0
    s_mov_b32 s36, 0
    s_waitcnt lgkmcnt(0)
    s_nop 7
L_bs_b0:
    s_waitcnt lgkmcnt(0)
    v_mfma_f32_16x16x32_bf16 v[16:19], a[0:3], v[80:83], 0
    ds_read_b128 v[88:91], v2 offset:2048
    s_cmp_eq_u32 s36, 0
    s_cselect_b32 s44, 0x8000000, s90
    v_mfma_f32_16x16x32_bf16 v[24:27], a[0:3], v[84:87], 0
    ds_read_b128 v[92:95], v3 offset:2048
    s_xor_b32 s49, s44, 0
    v_mfma_f32_16x16x32_bf16 v[28:31], a[4:7], v[84:87], 0
    v_cvt_pk_bf16_f32 v48, v48, v49
    v_cvt_pk_bf16_f32 v49, v50, v51
    v_mfma_f32_16x16x32_bf16 v[20:23], a[4:7], v[80:83], 0
    v_cvt_pk_bf16_f32 v50, v52, v53
    v_cvt_pk_bf16_f32 v51, v54, v55
    v_mfma_f32_16x16x32_bf16 v[32:35], a[8:11], v[80:83], 0
    buffer_store_dwordx4 v[48:51], v1, s[16:19], s49 offen offset:3072 sc1
    s_xor_b32 s49, s44, 16384
    v_mfma_f32_16x16x32_bf16 v[40:43], a[8:11], v[84:87], 0
    v_cvt_pk_bf16_f32 v56, v56, v57
    v_cvt_pk_bf16_f32 v57, v58, v59
    v_mfma_f32_16x16x32_bf16 v[44:47], a[12:15], v[84:87], 0
    v_cvt_pk_bf16_f32 v58, v60, v61
    v_cvt_pk_bf16_f32 v59, v62, v63
    v_mfma_f32_16x16x32_bf16 v[36:39], a[12:15], v[80:83], 0
    buffer_store_dwordx4 v[56:59], v1, s[16:19], s49 offen offset:3072 sc1
    s_waitcnt lgkmcnt(0)
    v_mfma_f32_16x16x32_bf16 v[16:19], a[16:19], v[88:91], v[16:19]
    ds_read_b128 v[80:83], v2 offset:4096
    s_xor_b32 s49, s44, 32768
    v_mfma_f32_16x16x32_bf16 v[24:27], a[16:19], v[92:95], v[24:27]
    ds_read_b128 v[84:87], v3 offset:4096
    v_cvt_pk_bf16_f32 v64, v64, v65
    v_mfma_f32_16x16x32_bf16 v[28:31], a[20:23], v[92:95], v[28:31]
    v_cvt_pk_bf16_f32 v65, v66, v67
    v_cvt_pk_bf16_f32 v66, v68, v69
    v_mfma_f32_16x16x32_bf16 v[20:23], a[20:23], v[88:91], v[20:23]
    v_cvt_pk_bf16_f32 v67, v70, v71
    buffer_store_dwordx4 v[64:67], v1, s[16:19], s49 offen offset:3072 sc1
    v_mfma_f32_16x16x32_bf16 v[32:35], a[24:27], v[88:91], v[32:35]
    s_xor_b32 s49, s44, 49152
    v_cvt_pk_bf16_f32 v72, v72, v73
    v_mfma_f32_16x16x32_bf16 v[40:43], a[24:27], v[92:95], v[40:43]
    v_cvt_pk_bf16_f32 v73, v74, v75
    v_cvt_pk_bf16_f32 v74, v76, v77
    v_mfma_f32_16x16x32_bf16 v[44:47], a[28:31], v[92:95], v[44:47]
    v_cvt_pk_bf16_f32 v75, v78, v79
    buffer_store_dwordx4 v[72:75], v1, s[16:19], s49 offen offset:3072 sc1
    v_mfma_f32_16x16x32_bf16 v[36:39], a[28:31], v[88:91], v[36:39]
    s_add_u32 s90, s90, 262144
    s_waitcnt lgkmcnt(0)
    v_mfma_f32_16x16x32_bf16 v[16:19], a[32:35], v[80:83], v[16:19]
    ds_read_b128 v[88:91], v2 offset:6144
    s_add_u32 m0, s43, 36864
    v_mfma_f32_16x16x32_bf16 v[24:27], a[32:35], v[84:87], v[24:27]
    ds_read_b128 v[92:95], v3 offset:6144
    s_add_u32 s42, s41, 36864
    v_mfma_f32_16x16x32_bf16 v[28:31], a[36:39], v[84:87], v[28:31]
    buffer_load_dwordx4 v1, s[16:19], s42 offen offset:0 sc1 lds
    v_mfma_f32_16x16x32_bf16 v[20:23], a[36:39], v[80:83], v[20:23]
    v_mfma_f32_16x16x32_bf16 v[32:35], a[40:43], v[80:83], v[32:35]
    v_mfma_f32_16x16x32_bf16 v[40:43], a[40:43], v[84:87], v[40:43]
    v_mfma_f32_16x16x32_bf16 v[44:47], a[44:47], v[84:87], v[44:47]
    v_mfma_f32_16x16x32_bf16 v[36:39], a[44:47], v[80:83], v[36:39]
    s_waitcnt lgkmcnt(0)
    v_mfma_f32_16x16x32_bf16 v[16:19], a[48:51], v[88:91], v[16:19]
    ds_read_b128 v[80:83], v2 offset:8192
    buffer_load_dwordx4 v1, s[16:19], s42 offen offset:1024 sc1 lds
    v_mfma_f32_16x16x32_bf16 v[24:27], a[48:51], v[92:95], v[24:27]
    ds_read_b128 v[84:87], v3 offset:8192
    v_mfma_f32_16x16x32_bf16 v[28:31], a[52:55], v[92:95], v[28:31]
    v_mfma_f32_16x16x32_bf16 v[20:23], a[52:55], v[88:91], v[20:23]
    v_mfma_f32_16x16x32_bf16 v[32:35], a[56:59], v[88:91], v[32:35]
    v_mfma_f32_16x16x32_bf16 v[40:43], a[56:59], v[92:95], v[40:43]
    v_mfma_f32_16x16x32_bf16 v[44:47], a[60:63], v[92:95], v[44:47]
    buffer_load_dwordx4 v1, s[16:19], s42 offen offset:2048 sc1 lds
    s_add_u32 s41, s41, 229376
    v_mfma_f32_16x16x32_bf16 v[36:39], a[60:63], v[88:91], v[36:39]
    s_min_u32 s41, s41, s96
    s_waitcnt lgkmcnt(0)
    v_mfma_f32_16x16x32_bf16 v[16:19], a[64:67], v[80:83], v[16:19]
    ds_read_b128 v[88:91], v2 offset:10240
    v_mfma_f32_16x16x32_bf16 v[24:27], a[64:67], v[84:87], v[24:27]
    ds_read_b128 v[92:95], v3 offset:10240
    v_mfma_f32_16x16x32_bf16 v[28:31], a[68:71], v[84:87], v[28:31]
    v_mfma_f32_16x16x32_bf16 v[20:23], a[68:71], v[80:83], v[20:23]
    v_mfma_f32_16x16x32_bf16 v[32:35], a[72:75], v[80:83], v[32:35]
    v_mfma_f32_16x16x32_bf16 v[40:43], a[72:75], v[84:87], v[40:43]
    v_mfma_f32_16x16x32_bf16 v[44:47], a[76:79], v[84:87], v[44:47]
    v_mfma_f32_16x16x32_bf16 v[36:39], a[76:79], v[80:83], v[36:39]
    s_waitcnt vmcnt(7) lgkmcnt(0)
    s_barrier
    v_mfma_f32_16x16x32_bf16 v[16:19], a[80:83], v[88:91], v[16:19]
    ds_read_b128 v[80:83], v2 offset:12288
    v_mfma_f32_16x16x32_bf16 v[24:27], a[80:83], v[92:95], v[24:27]
    ds_read_b128 v[84:87], v3 offset:12288
    v_mfma_f32_16x16x32_bf16 v[28:31], a[84:87], v[92:95], v[28:31]
    v_mfma_f32_16x16x32_bf16 v[20:23], a[84:87], v[88:91], v[20:23]
    v_mfma_f32_16x16x32_bf16 v[32:35], a[88:91], v[88:91], v[32:35]
    v_mfma_f32_16x16x32_bf16 v[40:43], a[88:91], v[92:95], v[40:43]
    v_mfma_f32_16x16x32_bf16 v[44:47], a[92:95], v[92:95], v[44:47]
    v_mfma_f32_16x16x32_bf16 v[36:39], a[92:95], v[88:91], v[36:39]
    s_waitcnt lgkmcnt(0)
    v_mfma_f32_16x16x32_bf16 v[16:19], a[96:99], v[80:83], v[16:19]
    ds_read_b128 v[88:91], v2 offset:14336
    v_mfma_f32_16x16x32_bf16 v[24:27], a[96:99], v[84:87], v[24:27]
    ds_read_b128 v[92:95], v3 offset:14336
    v_mfma_f32_16x16x32_bf16 v[28:31], a[100:103], v[84:87], v[28:31]
    v_mfma_f32_16x16x32_bf16 v[20:23], a[100:103], v[80:83], v[20:23]
    v_mfma_f32_16x16x32_bf16 v[32:35], a[104:107], v[80:83], v[32:35]
    v_mfma_f32_16x16x32_bf16 v[40:43], a[104:107], v[84:87], v[40:43]
    v_mfma_f32_16x16x32_bf16 v[44:47], a[108:111], v[84:87], v[44:47]
    v_mfma_f32_16x16x32_bf16 v[36:39], a[108:111], v[80:83], v[36:39]
    s_waitcnt lgkmcnt(0)
    v_mfma_f32_16x16x32_bf16 v[16:19], a[112:115], v[88:91], v[16:19]
    ds_read_b128 v[80:83], v2 offset:16384
    v_mfma_f32_16x16x32_bf16 v[24:27], a[112:115], v[92:95], v[24:27]
    ds_read_b128 v[84:87], v3 offset:16384
    v_mfma_f32_16x16x32_bf16 v[28:31], a[116:119], v[92:95], v[28:31]
    v_mfma_f32_16x16x32_bf16 v[20:23], a[116:119], v[88:91], v[20:23]
    v_mfma_f32_16x16x32_bf16 v[32:35], a[120:123], v[88:91], v[32:35]
    v_mfma_f32_16x16x32_bf16 v[40:43], a[120:123], v[92:95], v[40:43]
    v_mfma_f32_16x16x32_bf16 v[44:47], a[124:127], v[92:95], v[44:47]
    v_mfma_f32_16x16x32_bf16 v[36:39], a[124:127], v[88:91], v[36:39]
    s_waitcnt lgkmcnt(0)
    v_mfma_f32_16x16x32_bf16 v[16:19], a[128:131], v[80:83], v[16:19]
    ds_read_b128 v[88:91], v2 offset:18432
    v_mfma_f32_16x16x32_bf16 v[24:27], a[128:131], v[84:87], v[24:27]
    ds_read_b128 v[92:95], v3 offset:18432
    v_mfma_f32_16x16x32_bf16 v[28:31], a[132:135], v[84:87], v[28:31]
    v_mfma_f32_16x16x32_bf16 v[20:23], a[132:135], v[80:83], v[20:23]
    v_mfma_f32_16x16x32_bf16 v[32:35], a[136:139], v[80:83], v[32:35]
    v_mfma_f32_16x16x32_bf16 v[40:43], a[136:139], v[84:87], v[40:43]
    v_mfma_f32_16x16x32_bf16 v[44:47], a[140:143], v[84:87], v[44:47]
    v_mfma_f32_16x16x32_bf16 v[36:39], a[140:143], v[80:83], v[36:39]
    s_waitcnt lgkmcnt(0)
    v_mfma_f32_16x16x32_bf16 v[16:19], a[144:147], v[88:91], v[16:19]
    ds_read_b128 v[80:83], v2 offset:20480
    v_mfma_f32_16x16x32_bf16 v[24:27], a[144:147], v[92:95], v[24:27]
    ds_read_b128 v[84:87], v3 offset:20480
    v_mfma_f32_16x16x32_bf16 v[28:31], a[148:151], v[92:95], v[28:31]
    buffer_load_dword v96, v6, s[16:19], s45 offen sc1
    v_mfma_f32_16x16x32_bf16 v[20:23], a[148:151], v[88:91], v[20:23]
    v_mfma_f32_16x16x32_bf16 v[32:35], a[152:155], v[88:91], v[32:35]
    v_mfma_f32_16x16x32_bf16 v[40:43], a[152:155], v[92:95], v[40:43]
    v_mfma_f32_16x16x32_bf16 v[44:47], a[156:159], v[92:95], v[44:47]
    v_mfma_f32_16x16x32_bf16 v[36:39], a[156:159], v[88:91], v[36:39]
    s_waitcnt lgkmcnt(0)
    v_mfma_f32_16x16x32_bf16 v[16:19], a[160:163], v[80:83], v[16:19]
    ds_read_b128 v[88:91], v2 offset:22528
    v_mfma_f32_16x16x32_bf16 v[24:27], a[160:163], v[84:87], v[24:27]
    ds_read_b128 v[92:95], v3 offset:22528
    v_mfma_f32_16x16x32_bf16 v[28:31], a[164:167], v[84:87], v[28:31]
    v_mfma_f32_16x16x32_bf16 v[20:23], a[164:167], v[80:83], v[20:23]
    v_mfma_f32_16x16x32_bf16 v[32:35], a[168:171], v[80:83], v[32:35]
    v_mfma_f32_16x16x32_bf16 v[40:43], a[168:171], v[84:87], v[40:43]
    v_mfma_f32_16x16x32_bf16 v[44:47], a[172:175], v[84:87], v[44:47]
    v_mfma_f32_16x16x32_bf16 v[36:39], a[172:175], v[80:83], v[36:39]
    s_waitcnt lgkmcnt(0)
    v_mfma_f32_16x16x32_bf16 v[16:19], a[176:179], v[88:91], v[16:19]
    ds_read_b128 v[80:83], v2 offset:24576
    v_mfma_f32_16x16x32_bf16 v[24:27], a[176:179], v[92:95], v[24:27]
    ds_read_b128 v[84:87], v3 offset:24576
    v_mfma_f32_16x16x32_bf16 v[28:31], a[180:183], v[92:95], v[28:31]
    v_mfma_f32_16x16x32_bf16 v[20:23], a[180:183], v[88:91], v[20:23]
    v_mfma_f32_16x16x32_bf16 v[32:35], a[184:187], v[88:91], v[32:35]
    v_mfma_f32_16x16x32_bf16 v[40:43], a[184:187], v[92:95], v[40:43]
    v_mfma_f32_16x16x32_bf16 v[44:47], a[188:191], v[92:95], v[44:47]
    v_mfma_f32_16x16x32_bf16 v[36:39], a[188:191], v[88:91], v[36:39]
    s_waitcnt lgkmcnt(0)
    v_mfma_f32_16x16x32_bf16 v[16:19], a[192:195], v[80:83], v[16:19]
    ds_read_b128 v[88:91], v2 offset:26624
    v_mfma_f32_16x16x32_bf16 v[24:27], a[192:195], v[84:87], v[24:27]
    ds_read_b128 v[92:95], v3 offset:26624
    v_mfma_f32_16x16x32_bf16 v[28:31], a[196:199], v[84:87], v[28:31]
    v_mfma_f32_16x16x32_bf16 v[20:23], a[196:199], v[80:83], v[20:23]
    v_mfma_f32_16x16x32_bf16 v[32:35], a[200:203], v[80:83], v[32:35]
    v_mfma_f32_16x16x32_bf16 v[40:43], a[200:203], v[84:87], v[40:43]
    v_mfma_f32_16x16x32_bf16 v[44:47], a[204:207], v[84:87], v[44:47]
    v_mfma_f32_16x16x32_bf16 v[36:39], a[204:207], v[80:83], v[36:39]
    s_waitcnt lgkmcnt(0)
    v_mfma_f32_16x16x32_bf16 v[16:19], a[208:211], v[88:91], v[16:19]
    ds_read_b128 v[80:83], v2 offset:28672
    v_mfma_f32_16x16x32_bf16 v[24:27], a[208:211], v[92:95], v[24:27]
    ds_read_b128 v[84:87], v3 offset:28672
    v_mfma_f32_16x16x32_bf16 v[28:31], a[212:215], v[92:95], v[28:31]
    v_mfma_f32_16x16x32_bf16 v[20:23], a[212:215], v[88:91], v[20:23]
    v_mfma_f32_16x16x32_bf16 v[32:35], a[216:219], v[88:91], v[32:35]
    v_mfma_f32_16x16x32_bf16 v[40:43], a[216:219], v[92:95], v[40:43]
    v_mfma_f32_16x16x32_bf16 v[44:47], a[220:223], v[92:95], v[44:47]
    v_mfma_f32_16x16x32_bf16 v[36:39], a[220:223], v[88:91], v[36:39]
    s_waitcnt lgkmcnt(0)
    v_mfma_f32_16x16x32_bf16 v[16:19], a[224:227], v[80:83], v[16:19]
    ds_read_b128 v[88:91], v2 offset:30720
    v_mfma_f32_16x16x32_bf16 v[24:27], a[224:227], v[84:87], v[24:27]
    ds_read_b128 v[92:95], v3 offset:30720
    v_mfma_f32_16x16x32_bf16 v[28:31], a[228:231], v[84:87], v[28:31]
    v_mfma_f32_16x16x32_bf16 v[20:23], a[228:231], v[80:83], v[20:23]
    v_mfma_f32_16x16x32_bf16 v[32:35], a[232:235], v[80:83], v[32:35]
    v_mfma_f32_16x16x32_bf16 v[40:43], a[232:235], v[84:87], v[40:43]
    v_mfma_f32_16x16x32_bf16 v[44:47], a[236:239], v[84:87], v[44:47]
    v_mfma_f32_16x16x32_bf16 v[36:39], a[236:239], v[80:83], v[36:39]
    s_waitcnt lgkmcnt(0)
    v_mfma_f32_16x16x32_bf16 v[16:19], a[240:243], v[88:91], v[16:19]
    ds_read_b128 v[80:83], v2 offset:32768
    s_waitcnt vmcnt(0)
    v_mfma_f32_16x16x32_bf16 v[24:27], a[240:243], v[92:95], v[24:27]
    ds_read_b128 v[84:87], v3 offset:32768
    v_cmp_ne_u32 vcc, 0, v96
    s_cbranch_vccnz L_spin62
L_back63:
    v_mfma_f32_16x16x32_bf16 v[28:31], a[244:247], v[92:95], v[28:31]
    s_barrier
    buffer_store_dword v124, v124, s[16:19], s91 offen sc1
    v_mfma_f32_16x16x32_bf16 v[20:23], a[244:247], v[88:91], v[20:23]
    s_add_u32 s91, s91, 131072
    s_add_u32 m0, s43, 98304
    v_mfma_f32_16x16x32_bf16 v[32:35], a[248:251], v[88:91], v[32:35]
    s_add_u32 s42, s41, 0
    buffer_load_dwordx4 v1, s[16:19], s42 offen offset:0 sc1 lds
    v_mfma_f32_16x16x32_bf16 v[40:43], a[248:251], v[92:95], v[40:43]
    v_mfma_f32_16x16x32_bf16 v[44:47], a[252:255], v[92:95], v[44:47]
    buffer_load_dwordx4 v1, s[16:19], s42 offen offset:1024 sc1 lds
    v_mfma_f32_16x16x32_bf16 v[36:39], a[252:255], v[88:91], v[36:39]
    s_waitcnt lgkmcnt(0)
    v_mfma_f32_16x16x32_bf16 v[16:19], v[128:131], v[80:83], v[16:19]
    ds_read_b128 v[88:91], v2 offset:34816
    buffer_load_dwordx4 v1, s[16:19], s42 offen offset:2048 sc1 lds
    v_mfma_f32_16x16x32_bf16 v[24:27], v[128:131], v[84:87], v[24:27]
    ds_read_b128 v[92:95], v3 offset:34816
    v_mfma_f32_16x16x32_bf16 v[28:31], v[132:135], v[84:87], v[28:31]
    v_mfma_f32_16x16x32_bf16 v[20:23], v[132:135], v[80:83], v[20:23]
    v_mfma_f32_16x16x32_bf16 v[32:35], v[136:139], v[80:83], v[32:35]
    v_mfma_f32_16x16x32_bf16 v[40:43], v[136:139], v[84:87], v[40:43]
    s_add_u32 m0, s43, 110592
    s_add_u32 s42, s41, 12288
    v_mfma_f32_16x16x32_bf16 v[44:47], v[140:143], v[84:87], v[44:47]
    buffer_load_dwordx4 v1, s[16:19], s42 offen offset:0 sc1 lds
    v_mfma_f32_16x16x32_bf16 v[36:39], v[140:143], v[80:83], v[36:39]
    s_waitcnt lgkmcnt(0)
    v_mfma_f32_16x16x32_bf16 v[16:19], v[144:147], v[88:91], v[16:19]
    ds_read_b128 v[80:83], v2 offset:36864
    v_mfma_f32_16x16x32_bf16 v[24:27], v[144:147], v[92:95], v[24:27]
    ds_read_b128 v[84:87], v3 offset:36864
    v_mfma_f32_16x16x32_bf16 v[28:31], v[148:151], v[92:95], v[28:31]
    v_mfma_f32_16x16x32_bf16 v[20:23], v[148:151], v[88:91], v[20:23]
    v_mfma_f32_16x16x32_bf16 v[32:35], v[152:155], v[88:91], v[32:35]
    buffer_load_dwordx4 v1, s[16:19], s42 offen offset:1024 sc1 lds
    v_mfma_f32_16x16x32_bf16 v[40:43], v[152:155], v[92:95], v[40:43]
    v_mfma_f32_16x16x32_bf16 v[44:47], v[156:159], v[92:95], v[44:47]
    v_mfma_f32_16x16x32_bf16 v[36:39], v[156:159], v[88:91], v[36:39]
    s_waitcnt lgkmcnt(0)
    v_mfma_f32_16x16x32_bf16 v[16:19], v[160:163], v[80:83], v[16:19]
    ds_read_b128 v[88:91], v2 offset:38912
    v_mfma_f32_16x16x32_bf16 v[24:27], v[160:163], v[84:87], v[24:27]
    ds_read_b128 v[92:95], v3 offset:38912
    v_mfma_f32_16x16x32_bf16 v[28:31], v[164:167], v[84:87], v[28:31]
    buffer_load_dwordx4 v1, s[16:19], s42 offen offset:2048 sc1 lds
    v_mfma_f32_16x16x32_bf16 v[20:23], v[164:167], v[80:83], v[20:23]
    v_mfma_f32_16x16x32_bf16 v[32:35], v[168:171], v[80:83], v[32:35]
    v_mfma_f32_16x16x32_bf16 v[40:43], v[168:171], v[84:87], v[40:43]
    v_mfma_f32_16x16x32_bf16 v[44:47], v[172:175], v[84:87], v[44:47]
    v_mfma_f32_16x16x32_bf16 v[36:39], v[172:175], v[80:83], v[36:39]
    s_add_u32 m0, s43, 122880
    s_waitcnt lgkmcnt(0)
    v_mfma_f32_16x16x32_bf16 v[16:19], v[176:179], v[88:91], v[16:19]
    ds_read_b128 v[80:83], v2 offset:40960
    s_add_u32 s42, s41, 24576
    v_mfma_f32_16x16x32_bf16 v[24:27], v[176:179], v[92:95], v[24:27]
    ds_read_b128 v[84:87], v3 offset:40960
    buffer_load_dwordx4 v1, s[16:19], s42 offen offset:0 sc1 lds
    v_mfma_f32_16x16x32_bf16 v[28:31], v[180:183], v[92:95], v[28:31]
    v_mfma_f32_16x16x32_bf16 v[20:23], v[180:183], v[88:91], v[20:23]
    v_mfma_f32_16x16x32_bf16 v[32:35], v[184:187], v[88:91], v[32:35]
    v_mfma_f32_16x16x32_bf16 v[40:43], v[184:187], v[92:95], v[40:43]
    v_mfma_f32_16x16x32_bf16 v[44:47], v[188:191], v[92:95], v[44:47]
    v_mfma_f32_16x16x32_bf16 v[36:39], v[188:191], v[88:91], v[36:39]
    buffer_load_dwordx4 v1, s[16:19], s42 offen offset:1024 sc1 lds
    s_waitcnt lgkmcnt(0)
    v_mfma_f32_16x16x32_bf16 v[16:19], v[192:195], v[80:83], v[16:19]
    ds_read_b128 v[88:91], v2 offset:43008
    v_mfma_f32_16x16x32_bf16 v[24:27], v[192:195], v[84:87], v[24:27]
    ds_read_b128 v[92:95], v3 offset:43008
    v_mfma_f32_16x16x32_bf16 v[28:31], v[196:199], v[84:87], v[28:31]
    v_mfma_f32_16x16x32_bf16 v[20:23], v[196:199], v[80:83], v[20:23]
    v_mfma_f32_16x16x32_bf16 v[32:35], v[200:203], v[80:83], v[32:35]
    v_mfma_f32_16x16x32_bf16 v[40:43], v[200:203], v[84:87], v[40:43]
    buffer_load_dwordx4 v1, s[16:19], s42 offen offset:2048 sc1 lds
    s_add_u32 s45, s45, 131072
    v_mfma_f32_16x16x32_bf16 v[44:47], v[204:207], v[84:87], v[44:47]
    v_mfma_f32_16x16x32_bf16 v[36:39], v[204:207], v[80:83], v[36:39]
    s_waitcnt lgkmcnt(0)
    v_mfma_f32_16x16x32_bf16 v[16:19], v[208:211], v[88:91], v[16:19]
    ds_read_b128 v[80:83], v2 offset:45056
    v_mfma_f32_16x16x32_bf16 v[24:27], v[208:211], v[92:95], v[24:27]
    ds_read_b128 v[84:87], v3 offset:45056
    v_mfma_f32_16x16x32_bf16 v[28:31], v[212:215], v[92:95], v[28:31]
    v_mfma_f32_16x16x32_bf16 v[20:23], v[212:215], v[88:91], v[20:23]
    v_mfma_f32_16x16x32_bf16 v[32:35], v[216:219], v[88:91], v[32:35]
    v_mfma_f32_16x16x32_bf16 v[40:43], v[216:219], v[92:95], v[40:43]
    v_mfma_f32_16x16x32_bf16 v[44:47], v[220:223], v[92:95], v[44:47]
    v_mfma_f32_16x16x32_bf16 v[36:39], v[220:223], v[88:91], v[36:39]
    s_waitcnt lgkmcnt(0)
    v_mfma_f32_16x16x32_bf16 v[16:19], v[224:227], v[80:83], v[16:19]
    ds_read_b128 v[88:91], v2 offset:47104
    v_mfma_f32_16x16x32_bf16 v[24:27], v[224:227], v[84:87], v[24:27]
    ds_read_b128 v[92:95], v3 offset:47104
    v_mfma_f32_16x16x32_bf16 v[28:31], v[228:231], v[84:87], v[28:31]
    v_mfma_f32_16x16x32_bf16 v[20:23], v[228:231], v[80:83], v[20:23]
    v_mfma_f32_16x16x32_bf16 v[32:35], v[232:235], v[80:83], v[32:35]
    v_mfma_f32_16x16x32_bf16 v[40:43], v[232:235], v[84:87], v[40:43]
    v_mfma_f32_16x16x32_bf16 v[44:47], v[236:239], v[84:87], v[44:47]
    v_mfma_f32_16x16x32_bf16 v[36:39], v[236:239], v[80:83], v[36:39]
    s_waitcnt vmcnt(6) lgkmcnt(0)
    s_barrier
    v_mfma_f32_16x16x32_bf16 v[16:19], v[240:243], v[88:91], v[16:19]
    ds_read_b128 v[80:83], v4 offset:0
    v_mfma_f32_16x16x32_bf16 v[24:27], v[240:243], v[92:95], v[24:27]
    ds_read_b128 v[84:87], v5 offset:0
    v_mfma_f32_16x16x32_bf16 v[28:31], v[244:247], v[92:95], v[28:31]
    v_mfma_f32_16x16x32_bf16 v[20:23], v[244:247], v[88:91], v[20:23]
    v_mfma_f32_16x16x32_bf16 v[32:35], v[248:251], v[88:91], v[32:35]
    v_mfma_f32_16x16x32_bf16 v[40:43], v[248:251], v[92:95], v[40:43]
    v_mfma_f32_16x16x32_bf16 v[44:47], v[252:255], v[92:95], v[44:47]
    v_mfma_f32_16x16x32_bf16 v[36:39], v[252:255], v[88:91], v[36:39]
    s_add_u32 s36, s36, 1
L_bs_b1:
    s_waitcnt lgkmcnt(0)
    v_mfma_f32_16x16x32_bf16 v[48:51], a[0:3], v[80:83], 0
    ds_read_b128 v[88:91], v4 offset:2048
    s_cmp_eq_u32 s36, 0
    s_cselect_b32 s44, 0x8000000, s90
    v_mfma_f32_16x16x32_bf16 v[56:59], a[0:3], v[84:87], 0
    ds_read_b128 v[92:95], v5 offset:2048
    s_xor_b32 s49, s44, 0
    v_mfma_f32_16x16x32_bf16 v[60:63], a[4:7], v[84:87], 0
    v_cvt_pk_bf16_f32 v16, v16, v17
    v_cvt_pk_bf16_f32 v17, v18, v19
    v_mfma_f32_16x16x32_bf16 v[52:55], a[4:7], v[80:83], 0
    v_cvt_pk_bf16_f32 v18, v20, v21
    v_cvt_pk_bf16_f32 v19, v22, v23
    v_mfma_f32_16x16x32_bf16 v[64:67], a[8:11], v[80:83], 0
    buffer_store_dwordx4 v[16:19], v1, s[16:19], s49 offen offset:3072 sc1
    s_xor_b32 s49, s44, 16384
    v_mfma_f32_16x16x32_bf16 v[72:75], a[8:11], v[84:87], 0
    v_cvt_pk_bf16_f32 v24, v24, v25
    v_cvt_pk_bf16_f32 v25, v26, v27
    v_mfma_f32_16x16x32_bf16 v[76:79], a[12:15], v[84:87], 0
    v_cvt_pk_bf16_f32 v26, v28, v29
    v_cvt_pk_bf16_f32 v27, v30, v31
    v_mfma_f32_16x16x32_bf16 v[68:71], a[12:15], v[80:83], 0
    buffer_store_dwordx4 v[24:27], v1, s[16:19], s49 offen offset:3072 sc1
    s_waitcnt lgkmcnt(0)
    v_mfma_f32_16x16x32_bf16 v[48:51], a[16:19], v[88:91], v[48:51]
    ds_read_b128 v[80:83], v4 offset:4096
    s_xor_b32 s49, s44, 32768
    v_mfma_f32_16x16x32_bf16 v[56:59], a[16:19], v[92:95], v[56:59]
    ds_read_b128 v[84:87], v5 offset:4096
    v_cvt_pk_bf16_f32 v32, v32, v33
    v_mfma_f32_16x16x32_bf16 v[60:63], a[20:23], v[92:95], v[60:63]
    v_cvt_pk_bf16_f32 v33, v34, v35
    v_cvt_pk_bf16_f32 v34, v36, v37
    v_mfma_f32_16x16x32_bf16 v[52:55], a[20:23], v[88:91], v[52:55]
    v_cvt_pk_bf16_f32 v35, v38, v39
    buffer_store_dwordx4 v[32:35], v1, s[16:19], s49 offen offset:3072 sc1
    v_mfma_f32_16x16x32_bf16 v[64:67], a[24:27], v[88:91], v[64:67]
    s_xor_b32 s49, s44, 49152
    v_cvt_pk_bf16_f32 v40, v40, v41
    v_mfma_f32_16x16x32_bf16 v[72:75], a[24:27], v[92:95], v[72:75]
    v_cvt_pk_bf16_f32 v41, v42, v43
    v_cvt_pk_bf16_f32 v42, v44, v45
    v_mfma_f32_16x16x32_bf16 v[76:79], a[28:31], v[92:95], v[76:79]
    v_cvt_pk_bf16_f32 v43, v46, v47
    buffer_store_dwordx4 v[40:43], v1, s[16:19], s49 offen offset:3072 sc1
    v_mfma_f32_16x16x32_bf16 v[68:71], a[28:31], v[88:91], v[68:71]
    s_add_u32 s90, s90, 262144
    s_waitcnt lgkmcnt(0)
    v_mfma_f32_16x16x32_bf16 v[48:51], a[32:35], v[80:83], v[48:51]
    ds_read_b128 v[88:91], v4 offset:6144
    s_add_u32 m0, s43, 135168
    v_mfma_f32_16x16x32_bf16 v[56:59], a[32:35], v[84:87], v[56:59]
    ds_read_b128 v[92:95], v5 offset:6144
    s_add_u32 s42, s41, 36864
    v_mfma_f32_16x16x32_bf16 v[60:63], a[36:39], v[84:87], v[60:63]
    buffer_load_dwordx4 v1, s[16:19], s42 offen offset:0 sc1 lds
    v_mfma_f32_16x16x32_bf16 v[52:55], a[36:39], v[80:83], v[52:55]
    v_mfma_f32_16x16x32_bf16 v[64:67], a[40:43], v[80:83], v[64:67]
    v_mfma_f32_16x16x32_bf16 v[72:75], a[40:43], v[84:87], v[72:75]
    v_mfma_f32_16x16x32_bf16 v[76:79], a[44:47], v[84:87], v[76:79]
    v_mfma_f32_16x16x32_bf16 v[68:71], a[44:47], v[80:83], v[68:71]
    s_waitcnt lgkmcnt(0)
    v_mfma_f32_16x16x32_bf16 v[48:51], a[48:51], v[88:91], v[48:51]
    ds_read_b128 v[80:83], v4 offset:8192
    buffer_load_dwordx4 v1, s[16:19], s42 offen offset:1024 sc1 lds
    v_mfma_f32_16x16x32_bf16 v[56:59], a[48:51], v[92:95], v[56:59]
    ds_read_b128 v[84:87], v5 offset:8192
    v_mfma_f32_16x16x32_bf16 v[60:63], a[52:55], v[92:95], v[60:63]
    v_mfma_f32_16x16x32_bf16 v[52:55], a[52:55], v[88:91], v[52:55]
    v_mfma_f32_16x16x32_bf16 v[64:67], a[56:59], v[88:91], v[64:67]
    v_mfma_f32_16x16x32_bf16 v[72:75], a[56:59], v[92:95], v[72:75]
    v_mfma_f32_16x16x32_bf16 v[76:79], a[60:63], v[92:95], v[76:79]
    buffer_load_dwordx4 v1, s[16:19], s42 offen offset:2048 sc1 lds
    s_add_u32 s41, s41, 229376
    v_mfma_f32_16x16x32_bf16 v[68:71], a[60:63], v[88:91], v[68:71]
    s_min_u32 s41, s41, s96
    s_waitcnt lgkmcnt(0)
    v_mfma_f32_16x16x32_bf16 v[48:51], a[64:67], v[80:83], v[48:51]
    ds_read_b128 v[88:91], v4 offset:10240
    v_mfma_f32_16x16x32_bf16 v[56:59], a[64:67], v[84:87], v[56:59]
    ds_read_b128 v[92:95], v5 offset:10240
    v_mfma_f32_16x16x32_bf16 v[60:63], a[68:71], v[84:87], v[60:63]
    v_mfma_f32_16x16x32_bf16 v[52:55], a[68:71], v[80:83], v[52:55]
    v_mfma_f32_16x16x32_bf16 v[64:67], a[72:75], v[80:83], v[64:67]
    v_mfma_f32_16x16x32_bf16 v[72:75], a[72:75], v[84:87], v[72:75]
    v_mfma_f32_16x16x32_bf16 v[76:79], a[76:79], v[84:87], v[76:79]
    v_mfma_f32_16x16x32_bf16 v[68:71], a[76:79], v[80:83], v[68:71]
    s_waitcnt vmcnt(7) lgkmcnt(0)
    s_barrier
    v_mfma_f32_16x16x32_bf16 v[48:51], a[80:83], v[88:91], v[48:51]
    ds_read_b128 v[80:83], v4 offset:12288
    v_mfma_f32_16x16x32_bf16 v[56:59], a[80:83], v[92:95], v[56:59]
    ds_read_b128 v[84:87], v5 offset:12288
    v_mfma_f32_16x16x32_bf16 v[60:63], a[84:87], v[92:95], v[60:63]
    v_mfma_f32_16x16x32_bf16 v[52:55], a[84:87], v[88:91], v[52:55]
    v_mfma_f32_16x16x32_bf16 v[64:67], a[88:91], v[88:91], v[64:67]
    v_mfma_f32_16x16x32_bf16 v[72:75], a[88:91], v[92:95], v[72:75]
    v_mfma_f32_16x16x32_bf16 v[76:79], a[92:95], v[92:95], v[76:79]
    v_mfma_f32_16x16x32_bf16 v[68:71], a[92:95], v[88:91], v[68:71]
    s_waitcnt lgkmcnt(0)
    v_mfma_f32_16x16x32_bf16 v[48:51], a[96:99], v[80:83], v[48:51]
    ds_read_b128 v[88:91], v4 offset:14336
    v_mfma_f32_16x16x32_bf16 v[56:59], a[96:99], v[84:87], v[56:59]
    ds_read_b128 v[92:95], v5 offset:14336
    v_mfma_f32_16x16x32_bf16 v[60:63], a[100:103], v[84:87], v[60:63]
    v_mfma_f32_16x16x32_bf16 v[52:55], a[100:103], v[80:83], v[52:55]
    v_mfma_f32_16x16x32_bf16 v[64:67], a[104:107], v[80:83], v[64:67]
    v_mfma_f32_16x16x32_bf16 v[72:75], a[104:107], v[84:87], v[72:75]
    v_mfma_f32_16x16x32_bf16 v[76:79], a[108:111], v[84:87], v[76:79]
    v_mfma_f32_16x16x32_bf16 v[68:71], a[108:111], v[80:83], v[68:71]
    s_waitcnt lgkmcnt(0)
    v_mfma_f32_16x16x32_bf16 v[48:51], a[112:115], v[88:91], v[48:51]
    ds_read_b128 v[80:83], v4 offset:16384
    v_mfma_f32_16x16x32_bf16 v[56:59], a[112:115], v[92:95], v[56:59]
    ds_read_b128 v[84:87], v5 offset:16384
    v_mfma_f32_16x16x32_bf16 v[60:63], a[116:119], v[92:95], v[60:63]
    v_mfma_f32_16x16x32_bf16 v[52:55], a[116:119], v[88:91], v[52:55]
    v_mfma_f32_16x16x32_bf16 v[64:67], a[120:123], v[88:91], v[64:67]
    v_mfma_f32_16x16x32_bf16 v[72:75], a[120:123], v[92:95], v[72:75]
    v_mfma_f32_16x16x32_bf16 v[76:79], a[124:127], v[92:95], v[76:79]
    v_mfma_f32_16x16x32_bf16 v[68:71], a[124:127], v[88:91], v[68:71]
    s_waitcnt lgkmcnt(0)
    v_mfma_f32_16x16x32_bf16 v[48:51], a[128:131], v[80:83], v[48:51]
    ds_read_b128 v[88:91], v4 offset:18432
    v_mfma_f32_16x16x32_bf16 v[56:59], a[128:131], v[84:87], v[56:59]
    ds_read_b128 v[92:95], v5 offset:18432
    v_mfma_f32_16x16x32_bf16 v[60:63], a[132:135], v[84:87], v[60:63]
    v_mfma_f32_16x16x32_bf16 v[52:55], a[132:135], v[80:83], v[52:55]
    v_mfma_f32_16x16x32_bf16 v[64:67], a[136:139], v[80:83], v[64:67]
    v_mfma_f32_16x16x32_bf16 v[72:75], a[136:139], v[84:87], v[72:75]
    v_mfma_f32_16x16x32_bf16 v[76:79], a[140:143], v[84:87], v[76:79]
    v_mfma_f32_16x16x32_bf16 v[68:71], a[140:143], v[80:83], v[68:71]
    s_waitcnt lgkmcnt(0)
    v_mfma_f32_16x16x32_bf16 v[48:51], a[144:147], v[88:91], v[48:51]
    ds_read_b128 v[80:83], v4 offset:20480
    v_mfma_f32_16x16x32_bf16 v[56:59], a[144:147], v[92:95], v[56:59]
    ds_read_b128 v[84:87], v5 offset:20480
    v_mfma_f32_16x16x32_bf16 v[60:63], a[148:151], v[92:95], v[60:63]
    buffer_load_dword v96, v6, s[16:19], s45 offen sc1
    v_mfma_f32_16x16x32_bf16 v[52:55], a[148:151], v[88:91], v[52:55]
    v_mfma_f32_16x16x32_bf16 v[64:67], a[152:155], v[88:91], v[64:67]
    v_mfma_f32_16x16x32_bf16 v[72:75], a[152:155], v[92:95], v[72:75]
    v_mfma_f32_16x16x32_bf16 v[76:79], a[156:159], v[92:95], v[76:79]
    v_mfma_f32_16x16x32_bf16 v[68:71], a[156:159], v[88:91], v[68:71]
    s_waitcnt lgkmcnt(0)
    v_mfma_f32_16x16x32_bf16 v[48:51], a[160:163], v[80:83], v[48:51]
    ds_read_b128 v[88:91], v4 offset:22528
    v_mfma_f32_16x16x32_bf16 v[56:59], a[160:163], v[84:87], v[56:59]
    ds_read_b128 v[92:95], v5 offset:22528
    v_mfma_f32_16x16x32_bf16 v[60:63], a[164:167], v[84:87], v[60:63]
    v_mfma_f32_16x16x32_bf16 v[52:55], a[164:167], v[80:83], v[52:55]
    v_mfma_f32_16x16x32_bf16 v[64:67], a[168:171], v[80:83], v[64:67]
    v_mfma_f32_16x16x32_bf16 v[72:75], a[168:171], v[84:87], v[72:75]
    v_mfma_f32_16x16x32_bf16 v[76:79], a[172:175], v[84:87], v[76:79]
    v_mfma_f32_16x16x32_bf16 v[68:71], a[172:175], v[80:83], v[68:71]
    s_waitcnt lgkmcnt(0)
    v_mfma_f32_16x16x32_bf16 v[48:51], a[176:179], v[88:91], v[48:51]
    ds_read_b128 v[80:83], v4 offset:24576
    v_mfma_f32_16x16x32_bf16 v[56:59], a[176:179], v[92:95], v[56:59]
    ds_read_b128 v[84:87], v5 offset:24576
    v_mfma_f32_16x16x32_bf16 v[60:63], a[180:183], v[92:95], v[60:63]
    v_mfma_f32_16x16x32_bf16 v[52:55], a[180:183], v[88:91], v[52:55]
    v_mfma_f32_16x16x32_bf16 v[64:67], a[184:187], v[88:91], v[64:67]
    v_mfma_f32_16x16x32_bf16 v[72:75], a[184:187], v[92:95], v[72:75]
    v_mfma_f32_16x16x32_bf16 v[76:79], a[188:191], v[92:95], v[76:79]
    v_mfma_f32_16x16x32_bf16 v[68:71], a[188:191], v[88:91], v[68:71]
    s_waitcnt lgkmcnt(0)
    v_mfma_f32_16x16x32_bf16 v[48:51], a[192:195], v[80:83], v[48:51]
    ds_read_b128 v[88:91], v4 offset:26624
    v_mfma_f32_16x16x32_bf16 v[56:59], a[192:195], v[84:87], v[56:59]
    ds_read_b128 v[92:95], v5 offset:26624
    v_mfma_f32_16x16x32_bf16 v[60:63], a[196:199], v[84:87], v[60:63]
    v_mfma_f32_16x16x32_bf16 v[52:55], a[196:199], v[80:83], v[52:55]
    v_mfma_f32_16x16x32_bf16 v[64:67], a[200:203], v[80:83], v[64:67]
    v_mfma_f32_16x16x32_bf16 v[72:75], a[200:203], v[84:87], v[72:75]
    v_mfma_f32_16x16x32_bf16 v[76:79], a[204:207], v[84:87], v[76:79]
    v_mfma_f32_16x16x32_bf16 v[68:71], a[204:207], v[80:83], v[68:71]
    s_waitcnt lgkmcnt(0)
    v_mfma_f32_16x16x32_bf16 v[48:51], a[208:211], v[88:91], v[48:51]
    ds_read_b128 v[80:83], v4 offset:28672
    v_mfma_f32_16x16x32_bf16 v[56:59], a[208:211], v[92:95], v[56:59]
    ds_read_b128 v[84:87], v5 offset:28672
    v_mfma_f32_16x16x32_bf16 v[60:63], a[212:215], v[92:95], v[60:63]
    v_mfma_f32_16x16x32_bf16 v[52:55], a[212:215], v[88:91], v[52:55]
    v_mfma_f32_16x16x32_bf16 v[64:67], a[216:219], v[88:91], v[64:67]
    v_mfma_f32_16x16x32_bf16 v[72:75], a[216:219], v[92:95], v[72:75]
    v_mfma_f32_16x16x32_bf16 v[76:79], a[220:223], v[92:95], v[76:79]
    v_mfma_f32_16x16x32_bf16 v[68:71], a[220:223], v[88:91], v[68:71]
    s_waitcnt lgkmcnt(0)
    v_mfma_f32_16x16x32_bf16 v[48:51], a[224:227], v[80:83], v[48:51]
    ds_read_b128 v[88:91], v4 offset:30720
    v_mfma_f32_16x16x32_bf16 v[56:59], a[224:227], v[84:87], v[56:59]
    ds_read_b128 v[92:95], v5 offset:30720
    v_mfma_f32_16x16x32_bf16 v[60:63], a[228:231], v[84:87], v[60:63]
    v_mfma_f32_16x16x32_bf16 v[52:55], a[228:231], v[80:83], v[52:55]
    v_mfma_f32_16x16x32_bf16 v[64:67], a[232:235], v[80:83], v[64:67]
    v_mfma_f32_16x16x32_bf16 v[72:75], a[232:235], v[84:87], v[72:75]
    v_mfma_f32_16x16x32_bf16 v[76:79], a[236:239], v[84:87], v[76:79]
    v_mfma_f32_16x16x32_bf16 v[68:71], a[236:239], v[80:83], v[68:71]
    s_waitcnt lgkmcnt(0)
    v_mfma_f32_16x16x32_bf16 v[48:51], a[240:243], v[88:91], v[48:51]
    ds_read_b128 v[80:83], v4 offset:32768
    s_waitcnt vmcnt(0)
    v_mfma_f32_16x16x32_bf16 v[56:59], a[240:243], v[92:95], v[56:59]
    ds_read_b128 v[84:87], v5 offset:32768
    v_cmp_ne_u32 vcc, 0, v96
    s_cbranch_vccnz L_spin64
L_back65:
    v_mfma_f32_16x16x32_bf16 v[60:63], a[244:247], v[92:95], v[60:63]
    s_barrier
    buffer_store_dword v124, v124, s[16:19], s91 offen sc1
    v_mfma_f32_16x16x32_bf16 v[52:55], a[244:247], v[88:91], v[52:55]
    s_add_u32 s91, s91, 131072
    s_add_u32 m0, s43, 0
    v_mfma_f32_16x16x32_bf16 v[64:67], a[248:251], v[88:91], v[64:67]
    s_add_u32 s42, s41, 0
    buffer_load_dwordx4 v1, s[16:19], s42 offen offset:0 sc1 lds
    v_mfma_f32_16x16x32_bf16 v[72:75], a[248:251], v[92:95], v[72:75]
    v_mfma_f32_16x16x32_bf16 v[76:79], a[252:255], v[92:95], v[76:79]
    buffer_load_dwordx4 v1, s[16:19], s42 offen offset:1024 sc1 lds
    v_mfma_f32_16x16x32_bf16 v[68:71], a[252:255], v[88:91], v[68:71]
    s_waitcnt lgkmcnt(0)
    v_mfma_f32_16x16x32_bf16 v[48:51], v[128:131], v[80:83], v[48:51]
    ds_read_b128 v[88:91], v4 offset:34816
    buffer_load_dwordx4 v1, s[16:19], s42 offen offset:2048 sc1 lds
    v_mfma_f32_16x16x32_bf16 v[56:59], v[128:131], v[84:87], v[56:59]
    ds_read_b128 v[92:95], v5 offset:34816
    v_mfma_f32_16x16x32_bf16 v[60:63], v[132:135], v[84:87], v[60:63]
    v_mfma_f32_16x16x32_bf16 v[52:55], v[132:135], v[80:83], v[52:55]
    v_mfma_f32_16x16x32_bf16 v[64:67], v[136:139], v[80:83], v[64:67]
    v_mfma_f32_16x16x32_bf16 v[72:75], v[136:139], v[84:87], v[72:75]
    s_add_u32 m0, s43, 12288
    s_add_u32 s42, s41, 12288
    v_mfma_f32_16x16x32_bf16 v[76:79], v[140:143], v[84:87], v[76:79]
    buffer_load_dwordx4 v1, s[16:19], s42 offen offset:0 sc1 lds
    v_mfma_f32_16x16x32_bf16 v[68:71], v[140:143], v[80:83], v[68:71]
    s_waitcnt lgkmcnt(0)
    v_mfma_f32_16x16x32_bf16 v[48:51], v[144:147], v[88:91], v[48:51]
    ds_read_b128 v[80:83], v4 offset:36864
    v_mfma_f32_16x16x32_bf16 v[56:59], v[144:147], v[92:95], v[56:59]
    ds_read_b128 v[84:87], v5 offset:36864
    v_mfma_f32_16x16x32_bf16 v[60:63], v[148:151], v[92:95], v[60:63]
    v_mfma_f32_16x16x32_bf16 v[52:55], v[148:151], v[88:91], v[52:55]
    v_mfma_f32_16x16x32_bf16 v[64:67], v[152:155], v[88:91], v[64:67]
    buffer_load_dwordx4 v1, s[16:19], s42 offen offset:1024 sc1 lds
    v_mfma_f32_16x16x32_bf16 v[72:75], v[152:155], v[92:95], v[72:75]
    v_mfma_f32_16x16x32_bf16 v[76:79], v[156:159], v[92:95], v[76:79]
    v_mfma_f32_16x16x32_bf16 v[68:71], v[156:159], v[88:91], v[68:71]
    s_waitcnt lgkmcnt(0)
    v_mfma_f32_16x16x32_bf16 v[48:51], v[160:163], v[80:83], v[48:51]
    ds_read_b128 v[88:91], v4 offset:38912
    v_mfma_f32_16x16x32_bf16 v[56:59], v[160:163], v[84:87], v[56:59]
    ds_read_b128 v[92:95], v5 offset:38912
    v_mfma_f32_16x16x32_bf16 v[60:63], v[164:167], v[84:87], v[60:63]
    buffer_load_dwordx4 v1, s[16:19], s42 offen offset:2048 sc1 lds
    v_mfma_f32_16x16x32_bf16 v[52:55], v[164:167], v[80:83], v[52:55]
    v_mfma_f32_16x16x32_bf16 v[64:67], v[168:171], v[80:83], v[64:67]
    v_mfma_f32_16x16x32_bf16 v[72:75], v[168:171], v[84:87], v[72:75]
    v_mfma_f32_16x16x32_bf16 v[76:79], v[172:175], v[84:87], v[76:79]
    v_mfma_f32_16x16x32_bf16 v[68:71], v[172:175], v[80:83], v[68:71]
    s_add_u32 m0, s43, 24576
    s_waitcnt lgkmcnt(0)
    v_mfma_f32_16x16x32_bf16 v[48:51], v[176:179], v[88:91], v[48:51]
    ds_read_b128 v[80:83], v4 offset:40960
    s_add_u32 s42, s41, 24576
    v_mfma_f32_16x16x32_bf16 v[56:59], v[176:179], v[92:95], v[56:59]
    ds_read_b128 v[84:87], v5 offset:40960
    buffer_load_dwordx4 v1, s[16:19], s42 offen offset:0 sc1 lds
    v_mfma_f32_16x16x32_bf16 v[60:63], v[180:183], v[92:95], v[60:63]
    v_mfma_f32_16x16x32_bf16 v[52:55], v[180:183], v[88:91], v[52:55]
    v_mfma_f32_16x16x32_bf16 v[64:67], v[184:187], v[88:91], v[64:67]
    v_mfma_f32_16x16x32_bf16 v[72:75], v[184:187], v[92:95], v[72:75]
    v_mfma_f32_16x16x32_bf16 v[76:79], v[188:191], v[92:95], v[76:79]
    v_mfma_f32_16x16x32_bf16 v[68:71], v[188:191], v[88:91], v[68:71]
    buffer_load_dwordx4 v1, s[16:19], s42 offen offset:1024 sc1 lds
    s_waitcnt lgkmcnt(0)
    v_mfma_f32_16x16x32_bf16 v[48:51], v[192:195], v[80:83], v[48:51]
    ds_read_b128 v[88:91], v4 offset:43008
    v_mfma_f32_16x16x32_bf16 v[56:59], v[192:195], v[84:87], v[56:59]
    ds_read_b128 v[92:95], v5 offset:43008
    v_mfma_f32_16x16x32_bf16 v[60:63], v[196:199], v[84:87], v[60:63]
    v_mfma_f32_16x16x32_bf16 v[52:55], v[196:199], v[80:83], v[52:55]
    v_mfma_f32_16x16x32_bf16 v[64:67], v[200:203], v[80:83], v[64:67]
    v_mfma_f32_16x16x32_bf16 v[72:75], v[200:203], v[84:87], v[72:75]
    buffer_load_dwordx4 v1, s[16:19], s42 offen offset:2048 sc1 lds
    s_add_u32 s45, s45, 131072
    v_mfma_f32_16x16x32_bf16 v[76:79], v[204:207], v[84:87], v[76:79]
    v_mfma_f32_16x16x32_bf16 v[68:71], v[204:207], v[80:83], v[68:71]
    s_waitcnt lgkmcnt(0)
    v_mfma_f32_16x16x32_bf16 v[48:51], v[208:211], v[88:91], v[48:51]
    ds_read_b128 v[80:83], v4 offset:45056
    v_mfma_f32_16x16x32_bf16 v[56:59], v[208:211], v[92:95], v[56:59]
    ds_read_b128 v[84:87], v5 offset:45056
    v_mfma_f32_16x16x32_bf16 v[60:63], v[212:215], v[92:95], v[60:63]
    v_mfma_f32_16x16x32_bf16 v[52:55], v[212:215], v[88:91], v[52:55]
    v_mfma_f32_16x16x32_bf16 v[64:67], v[216:219], v[88:91], v[64:67]
    v_mfma_f32_16x16x32_bf16 v[72:75], v[216:219], v[92:95], v[72:75]
    v_mfma_f32_16x16x32_bf16 v[76:79], v[220:223], v[92:95], v[76:79]
    v_mfma_f32_16x16x32_bf16 v[68:71], v[220:223], v[88:91], v[68:71]
    s_waitcnt lgkmcnt(0)
    v_mfma_f32_16x16x32_bf16 v[48:51], v[224:227], v[80:83], v[48:51]
    ds_read_b128 v[88:91], v4 offset:47104
    v_mfma_f32_16x16x32_bf16 v[56:59], v[224:227], v[84:87], v[56:59]
    ds_read_b128 v[92:95], v5 offset:47104
    v_mfma_f32_16x16x32_bf16 v[60:63], v[228:231], v[84:87], v[60:63]
    v_mfma_f32_16x16x32_bf16 v[52:55], v[228:231], v[80:83], v[52:55]
    v_mfma_f32_16x16x32_bf16 v[64:67], v[232:235], v[80:83], v[64:67]
    v_mfma_f32_16x16x32_bf16 v[72:75], v[232:235], v[84:87], v[72:75]
    v_mfma_f32_16x16x32_bf16 v[76:79], v[236:239], v[84:87], v[76:79]
    v_mfma_f32_16x16x32_bf16 v[68:71], v[236:239], v[80:83], v[68:71]
    s_waitcnt vmcnt(6) lgkmcnt(0)
    s_barrier
    v_mfma_f32_16x16x32_bf16 v[48:51], v[240:243], v[88:91], v[48:51]
    ds_read_b128 v[80:83], v2 offset:0
    v_mfma_f32_16x16x32_bf16 v[56:59], v[240:243], v[92:95], v[56:59]
    ds_read_b128 v[84:87], v3 offset:0
    v_mfma_f32_16x16x32_bf16 v[60:63], v[244:247], v[92:95], v[60:63]
    v_mfma_f32_16x16x32_bf16 v[52:55], v[244:247], v[88:91], v[52:55]
    v_mfma_f32_16x16x32_bf16 v[64:67], v[248:251], v[88:91], v[64:67]
    v_mfma_f32_16x16x32_bf16 v[72:75], v[248:251], v[92:95], v[72:75]
    v_mfma_f32_16x16x32_bf16 v[76:79], v[252:255], v[92:95], v[76:79]
    v_mfma_f32_16x16x32_bf16 v[68:71], v[252:255], v[88:91], v[68:71]
    s_add_u32 s36, s36, 1
    s_cmp_lt_u32 s36, 32
    s_cbranch_scc1 L_bs_b0
    s_nop 7
    s_cmp_eq_u32 s36, 0
    s_cselect_b32 s44, 0x8000000, s90
    s_xor_b32 s49, s44, 0
    v_cvt_pk_bf16_f32 v48, v48, v49
    v_cvt_pk_bf16_f32 v49, v50, v51
    v_cvt_pk_bf16_f32 v50, v52, v53
    v_cvt_pk_bf16_f32 v51, v54, v55
    buffer_store_dwordx4 v[48:51], v1, s[16:19], s49 offen offset:3072 sc1
    s_xor_b32 s49, s44, 16384
    v_cvt_pk_bf16_f32 v56, v56, v57
    v_cvt_pk_bf16_f32 v57, v58, v59
    v_cvt_pk_bf16_f32 v58, v60, v61
    v_cvt_pk_bf16_f32 v59, v62, v63
    buffer_store_dwordx4 v[56:59], v1, s[16:19], s49 offen offset:3072 sc1
    s_xor_b32 s49, s44, 32768
    v_cvt_pk_bf16_f32 v64, v64, v65
    v_cvt_pk_bf16_f32 v65, v66, v67
    v_cvt_pk_bf16_f32 v66, v68, v69
    v_cvt_pk_bf16_f32 v67, v70, v71
    buffer_store_dwordx4 v[64:67], v1, s[16:19], s49 offen offset:3072 sc1
    s_xor_b32 s49, s44, 49152
    v_cvt_pk_bf16_f32 v72, v72, v73
    v_cvt_pk_bf16_f32 v73, v74, v75
    v_cvt_pk_bf16_f32 v74, v76, v77
    v_cvt_pk_bf16_f32 v75, v78, v79
    buffer_store_dwordx4 v[72:75], v1, s[16:19], s49 offen offset:3072 sc1
    s_add_u32 s90, s90, 262144
    s_waitcnt vmcnt(0)
    s_barrier
    buffer_store_dword v124, v124, s[16:19], s91 offen sc1
    s_add_u32 s91, s91, 131072
    s_waitcnt vmcnt(0)
    s_endpgm
L_spin58:
    s_mov_b32 s40, 0x20000
L_spin58_l:
    buffer_load_dword v81, v80, s[20:23], 0 offen sc1
    s_sub_u32 s40, s40, 1
    s_waitcnt vmcnt(0)
    v_cmp_gt_u32 vcc, 16, v81
    s_cbranch_scc1 L_back59
    s_cbranch_vccz L_back59
    s_sleep 2
    s_branch L_spin58_l
L_spin60:
    s_mov_b32 s40, 0x20000
L_spin60_l:
    buffer_load_dword v96, v6, s[16:19], s45 offen sc1
    s_sub_u32 s40, s40, 1
    s_waitcnt vmcnt(0)
    v_cmp_ne_u32 vcc, 0, v96
    s_cbranch_scc1 L_back61
    s_cbranch_vccz L_back61
    s_sleep 2
    s_branch L_spin60_l
L_spin62:
    s_mov_b32 s40, 0x20000
L_spin62_l:
    buffer_load_dword v96, v6, s[16:19], s45 offen sc1
    s_sub_u32 s40, s40, 1
    s_waitcnt vmcnt(0)
    v_cmp_ne_u32 vcc, 0, v96
    s_cbranch_scc1 L_back63
    s_cbranch_vccz L_back63
    s_sleep 2
    s_branch L_spin62_l
L_spin64:
    s_mov_b32 s40, 0x20000
L_spin64_l:
    buffer_load_dword v96, v6, s[16:19], s45 offen sc1
    s_sub_u32 s40, s40, 1
    s_waitcnt vmcnt(0)
    v_cmp_ne_u32 vcc, 0, v96
    s_cbranch_scc1 L_back65
    s_cbranch_vccz L_back65
    s_sleep 2
    s_branch L_spin64_l
L_code_end:
    s_endpgm
.section .rodata,"a"
.p2align 6
.amdhsa_kernel interleave_layers__sliding_local_dilated__dense_activation_squared_relu__prompt_kernel
  .amdhsa_next_free_vgpr 512
  .amdhsa_next_free_sgpr 102
  .amdhsa_accum_offset 256
  .amdhsa_group_segment_fixed_size 0
  .amdhsa_kernarg_size 88
  .amdhsa_user_sgpr_count 2
  .amdhsa_user_sgpr_kernarg_segment_ptr 1
  .amdhsa_system_sgpr_workgroup_id_x 1
.end_amdhsa_kernel
```

```asm
; @launch grid=(256,1,1) block=(256,1,1) lds=163840
.amdgcn_target "amdgcn-amd-amdhsa--gfx950"
.text
.globl interleave_layers__sliding_local_dilated__dense_activation_squared_relu__prompt_kernel
.p2align 8
.type interleave_layers__sliding_local_dilated__dense_activation_squared_relu__prompt_kernel,@function
interleave_layers__sliding_local_dilated__dense_activation_squared_relu__prompt_kernel:
    s_load_dwordx16 s[64:79], s[0:1], 0x0
    s_load_dwordx4 s[80:83], s[0:1], 0x40
    s_load_dwordx2 s[84:85], s[0:1], 0x50
    v_lshrrev_b32 v1, 6, v0
    s_cmp_ge_u32 s2, 256
    s_cbranch_scc1 L_code_end
    s_getpc_b64 s[20:21]
L_pc:
    s_mov_b32 s22, L_code_end-L_pc
    s_mov_b32 s23, 0x00020000
    v_lshlrev_b32 v7, 12, v0
    s_lshl_b32 s37, s2, 4
    buffer_load_dword v252, v7, s[20:23], s37 offen
    v_readfirstlane_b32 s32, v1
    v_and_b32 v0, 63, v0
    v_lshlrev_b32 v1, 4, v0
    s_bfe_u32 s33, s2, 0x10002
    s_lshl_b32 s33, s33, 1
    s_bfe_u32 s49, s2, 0x10003
    s_add_u32 s33, s33, s49
    s_and_b32 s48, s2, 3
    s_lshl_b32 s47, s48, 4
    s_lshr_b32 s38, s2, 4
    s_add_u32 s47, s47, s38
    s_and_b32 s37, s47, 6
    s_cbranch_scc1 L_other
    s_lshr_b32 s34, s47, 2
    s_and_b32 s37, s47, 1
    s_add_u32 s34, s34, s37
    s_mov_b32 s35, s34
    s_movk_i32 s39, 6144
    s_lshl_b32 s54, s35, 7
    v_lshrrev_b32 v32, 3, v0
    v_lshlrev_b32 v33, 2, v0
    v_and_b32 v33, 64, v33
    v_and_b32 v34, 0x70, v1
    v_xor_b32 v33, v33, v34
    v_mad_u32_u24 v20, v32, s39, v33
    v_add_u32 v21, 49152, v20
    v_add_u32 v22, 2048, v20
    v_add_u32 v23, 51200, v20
    v_add_u32 v24, 4096, v20
    v_add_u32 v25, 53248, v20
    s_mul_i32 s38, s32, 98304
    s_add_u32 s54, s54, s38
    s_lshl_b32 s42, s32, 11
    s_lshr_b32 s51, s32, 1
    s_lshl_b32 s50, s33, 5
    s_add_u32 s50, s50, 31
    s_sub_u32 s50, s50, s51
    s_lshl_b32 s41, s50, 15
    s_lshl_b32 s43, s32, 10
    v_lshlrev_b32 v37, 1, v0
    v_and_b32 v37, 0x60, v37
    v_xor_b32 v37, v37, v34
    s_and_b32 s37, s32, 1
    s_lshl_b32 s37, s37, 14
    v_lshl_add_u32 v6, v32, 11, v37
    v_add_u32 v6, s37, v6
    s_waitcnt lgkmcnt(0)
    s_mov_b32 s12, s66
    s_mov_b32 s13, s67
    s_mov_b32 s14, 0x600000
    s_mov_b32 s15, 0x00020000
    s_mov_b32 s8, s64
    s_mov_b32 s9, s65
    s_mov_b32 s10, 0x400000
    s_mov_b32 s11, 0x00020000
    s_add_u32 m0, s43, 98304
    s_nop 0
    buffer_load_dwordx4 v6, s[8:11], s41 offen offset:0 sc1 lds
    s_add_u32 m0, s42, 73728
    s_nop 0
    buffer_load_dwordx4 v20, s[12:15], s54 offen lds
    s_add_u32 m0, s42, 74752
    s_nop 0
    buffer_load_dwordx4 v21, s[12:15], s54 offen lds
    s_add_u32 m0, s42, 81920
    s_nop 0
    buffer_load_dwordx4 v22, s[12:15], s54 offen lds
    s_add_u32 m0, s42, 82944
    s_nop 0
    buffer_load_dwordx4 v23, s[12:15], s54 offen lds
    s_add_u32 m0, s42, 90112
    s_nop 0
    buffer_load_dwordx4 v24, s[12:15], s54 offen lds
    s_add_u32 m0, s42, 91136
    s_nop 0
    buffer_load_dwordx4 v25, s[12:15], s54 offen lds
    s_add_u32 s54, s54, 393216
    v_lshrrev_b32 v32, 4, v0
    v_bfe_u32 v33, v0, 2, 2
    v_lshl_add_u32 v32, v32, 3, v33
    v_lshlrev_b32 v32, 7, v32
    v_lshrrev_b32 v33, 1, v33
    v_lshl_add_u32 v32, v33, 6, v32
    v_and_b32 v33, 3, v0
    v_lshl_add_u32 v32, v33, 4, v32
    s_lshl_b32 s37, s51, 6
    s_and_b32 s38, s32, 1
    s_lshl_b32 s38, s38, 3
    s_add_u32 s37, s37, s38
    s_add_u32 s37, s37, 0
    v_xor_b32 v26, s37, v32
    s_lshl_b32 s37, s51, 6
    s_and_b32 s38, s32, 1
    s_lshl_b32 s38, s38, 3
    s_add_u32 s37, s37, s38
    s_add_u32 s37, s37, 8192
    v_xor_b32 v27, s37, v32
    s_lshl_b32 s37, s51, 6
    s_and_b32 s38, s32, 1
    s_lshl_b32 s38, s38, 3
    s_add_u32 s37, s37, s38
    s_add_u32 s37, s37, 16384
    v_xor_b32 v28, s37, v32
    v_mov_b32 v32, 0x3f803f80
    v_mov_b32 v33, 0x3f803f80
    v_mov_b32 v34, 0x3f803f80
    v_mov_b32 v35, 0x3f803f80
    v_and_b32 v36, 15, v0
    v_lshrrev_b32 v37, 4, v0
    v_and_b32 v38, 6, v36
    v_xor_b32 v38, v37, v38
    v_lshlrev_b32 v38, 4, v38
    v_lshl_add_u32 v2, v36, 7, v38
    v_xor_b32 v3, 64, v2
    v_add_u32 v4, 98304, v2
    v_add_u32 v5, 98304, v3
    s_add_u32 m0, s43, 102272
    s_nop 0
    buffer_load_dwordx4 v6, s[8:11], s41 offen offset:128 sc1 lds
    s_add_u32 m0, s42, 0
    s_nop 0
    buffer_load_dwordx4 v20, s[12:15], s54 offen lds
    s_add_u32 m0, s42, 1024
    s_nop 0
    buffer_load_dwordx4 v21, s[12:15], s54 offen lds
    s_add_u32 m0, s42, 8192
    s_nop 0
    buffer_load_dwordx4 v22, s[12:15], s54 offen lds
    s_add_u32 m0, s42, 9216
    s_nop 0
    buffer_load_dwordx4 v23, s[12:15], s54 offen lds
    s_add_u32 m0, s42, 16384
    s_nop 0
    buffer_load_dwordx4 v24, s[12:15], s54 offen lds
    s_add_u32 m0, s42, 17408
    s_nop 0
    buffer_load_dwordx4 v25, s[12:15], s54 offen lds
    s_add_u32 s54, s54, 393216
    s_add_u32 m0, s43, 106240
    s_nop 0
    buffer_load_dwordx4 v6, s[8:11], s41 offen offset:256 sc1 lds
    s_add_u32 m0, s42, 24576
    s_nop 0
    buffer_load_dwordx4 v20, s[12:15], s54 offen lds
    s_add_u32 m0, s42, 25600
    s_nop 0
    buffer_load_dwordx4 v21, s[12:15], s54 offen lds
    s_add_u32 m0, s42, 32768
    s_nop 0
    buffer_load_dwordx4 v22, s[12:15], s54 offen lds
    s_add_u32 m0, s42, 33792
    s_nop 0
    buffer_load_dwordx4 v23, s[12:15], s54 offen lds
    s_add_u32 m0, s42, 40960
    s_nop 0
    buffer_load_dwordx4 v24, s[12:15], s54 offen lds
    s_add_u32 m0, s42, 41984
    s_nop 0
    buffer_load_dwordx4 v25, s[12:15], s54 offen lds
    s_add_u32 s54, s54, 393216
    s_mov_b32 s36, -1
    v_add_u32 v29, 73728, v26
    v_add_u32 v30, 73728, v27
    v_add_u32 v31, 73728, v28
    s_waitcnt vmcnt(14) lgkmcnt(0)
    s_barrier
    s_add_u32 m0, s43, 110208
    ds_read_b128 v[68:71], v4 offset:0
    buffer_load_dwordx4 v6, s[8:11], s41 offen offset:384 sc1 lds
    ds_read_b128 v[72:75], v4 offset:2048
    s_add_u32 m0, s42, 49152
    ds_read_b128 v[76:79], v5 offset:0
    buffer_load_dwordx4 v20, s[12:15], s54 offen lds
    ds_read_b128 v[80:83], v5 offset:2048
    s_add_u32 m0, s42, 50176
    ds_read_b64_tr_b16 a[0:1], v29 offset:0
    buffer_load_dwordx4 v21, s[12:15], s54 offen lds
    ds_read_b64_tr_b16 a[2:3], v29 offset:512
    s_add_u32 m0, s42, 57344
    ds_read_b64_tr_b16 a[4:5], v30 offset:0
    buffer_load_dwordx4 v22, s[12:15], s54 offen lds
    ds_read_b64_tr_b16 a[6:7], v30 offset:512
    s_add_u32 m0, s42, 58368
    ds_read_b64_tr_b16 a[8:9], v31 offset:0
    buffer_load_dwordx4 v23, s[12:15], s54 offen lds
    ds_read_b64_tr_b16 a[10:11], v31 offset:512
    s_add_u32 m0, s42, 65536
    ds_read_b64_tr_b16 a[12:13], v29 offset:4096
    buffer_load_dwordx4 v24, s[12:15], s54 offen lds
    ds_read_b64_tr_b16 a[14:15], v29 offset:4608
    s_add_u32 m0, s42, 66560
    ds_read_b64_tr_b16 a[16:17], v30 offset:4096
    buffer_load_dwordx4 v25, s[12:15], s54 offen lds
    ds_read_b64_tr_b16 a[18:19], v30 offset:4608
    s_add_u32 s54, s54, 393216
    ds_read_b64_tr_b16 a[20:21], v31 offset:4096
    ds_read_b64_tr_b16 a[22:23], v31 offset:4608
    s_mov_b32 s16, s84
    s_mov_b32 s17, s85
    s_mov_b32 s18, 0x5e00000
    s_mov_b32 s19, 0x00020000
    v_min_u32 v124, 1, v0
    v_lshlrev_b32 v124, 30, v124
    s_lshl_b32 s91, s33, 6
    s_add_u32 s91, s91, s34
    s_lshl_b32 s91, s91, 8
    s_add_u32 s91, s91, 0x5540000
    s_cmp_eq_u32 s32, 1
    s_cselect_b32 s91, s91, 0x5f00000
    v_add_u32 v29, 0, v26
    v_add_u32 v30, 0, v27
    v_add_u32 v31, 0, v28
    s_waitcnt vmcnt(14) lgkmcnt(0)
    s_barrier
    v_mfma_f32_16x16x32_bf16 v[44:47], a[0:3], v[68:71], 0
    s_add_u32 m0, s43, 114176
    ds_read_b128 v[84:87], v4 offset:4096
    v_mfma_f32_16x16x32_bf16 v[48:51], a[0:3], v[72:75], 0
    buffer_load_dwordx4 v6, s[8:11], s41 offen offset:512 sc1 lds
    ds_read_b128 v[88:91], v4 offset:6144
    v_mfma_f32_16x16x32_bf16 v[56:59], a[4:7], v[72:75], 0
    s_add_u32 m0, s42, 73728
    ds_read_b128 v[92:95], v5 offset:4096
    v_mfma_f32_16x16x32_bf16 v[52:55], a[4:7], v[68:71], 0
    buffer_load_dwordx4 v20, s[12:15], s54 offen lds
    ds_read_b128 v[96:99], v5 offset:6144
    v_mfma_f32_16x16x32_bf16 v[60:63], a[8:11], v[68:71], 0
    s_add_u32 m0, s42, 74752
    ds_read_b64_tr_b16 a[24:25], v29 offset:0
    v_mfma_f32_16x16x32_bf16 v[64:67], a[8:11], v[72:75], 0
    buffer_load_dwordx4 v21, s[12:15], s54 offen lds
    ds_read_b64_tr_b16 a[26:27], v29 offset:512
    v_mfma_f32_16x16x32_bf16 v[44:47], a[12:15], v[76:79], v[44:47]
    s_add_u32 m0, s42, 81920
    ds_read_b64_tr_b16 a[28:29], v30 offset:0
    v_mfma_f32_16x16x32_bf16 v[48:51], a[12:15], v[80:83], v[48:51]
    buffer_load_dwordx4 v22, s[12:15], s54 offen lds
    ds_read_b64_tr_b16 a[30:31], v30 offset:512
    v_mfma_f32_16x16x32_bf16 v[56:59], a[16:19], v[80:83], v[56:59]
    s_add_u32 m0, s42, 82944
    ds_read_b64_tr_b16 a[32:33], v31 offset:0
    v_mfma_f32_16x16x32_bf16 v[52:55], a[16:19], v[76:79], v[52:55]
    buffer_load_dwordx4 v23, s[12:15], s54 offen lds
    ds_read_b64_tr_b16 a[34:35], v31 offset:512
    v_mfma_f32_16x16x32_bf16 v[60:63], a[20:23], v[76:79], v[60:63]
    s_add_u32 m0, s42, 90112
    ds_read_b64_tr_b16 a[36:37], v29 offset:4096
    v_mfma_f32_16x16x32_bf16 v[64:67], a[20:23], v[80:83], v[64:67]
    buffer_load_dwordx4 v24, s[12:15], s54 offen lds
    ds_read_b64_tr_b16 a[38:39], v29 offset:4608
    v_mfma_f32_16x16x32_bf16 v[100:103], a[0:3], v[32:35], 0
    s_add_u32 m0, s42, 91136
    ds_read_b64_tr_b16 a[40:41], v30 offset:4096
    v_mfma_f32_16x16x32_bf16 v[104:107], a[4:7], v[32:35], 0
    buffer_load_dwordx4 v25, s[12:15], s54 offen lds
    ds_read_b64_tr_b16 a[42:43], v30 offset:4608
    v_mfma_f32_16x16x32_bf16 v[108:111], a[8:11], v[32:35], 0
    s_add_u32 s54, s54, 393216
    ds_read_b64_tr_b16 a[44:45], v31 offset:4096
    v_mfma_f32_16x16x32_bf16 v[100:103], a[12:15], v[32:35], v[100:103]
    ds_read_b64_tr_b16 a[46:47], v31 offset:4608
    v_mfma_f32_16x16x32_bf16 v[104:107], a[16:19], v[32:35], v[104:107]
    v_mfma_f32_16x16x32_bf16 v[108:111], a[20:23], v[32:35], v[108:111]
    s_add_u32 s88, s84, 0x5000000
    s_addc_u32 s89, s85, 0
    s_sub_u32 s97, 15, s51
    s_and_b32 s38, s32, 1
    v_lshlrev_b32 v40, 1, v0
    v_and_b32 v40, 0x30, v40
    v_xor_b32 v40, v40, v1
    s_mul_i32 s37, s51, 3072
    s_add_u32 s37, s37, 65536
    s_lshl_b32 s39, s38, 3
    s_add_u32 s39, s39, s37
    v_add_u32 v29, 24576, v26
    v_add_u32 v30, 24576, v27
    v_add_u32 v31, 24576, v28
    s_waitcnt vmcnt(14) lgkmcnt(0)
    s_barrier
    v_mfma_f32_16x16x32_bf16 v[44:47], a[24:27], v[84:87], v[44:47]
    s_add_u32 m0, s43, 118144
    ds_read_b128 v[68:71], v4 offset:8192
    v_mfma_f32_16x16x32_bf16 v[48:51], a[24:27], v[88:91], v[48:51]
    buffer_load_dwordx4 v6, s[8:11], s41 offen offset:640 sc1 lds
    ds_read_b128 v[72:75], v4 offset:10240
    v_mfma_f32_16x16x32_bf16 v[56:59], a[28:31], v[88:91], v[56:59]
    s_add_u32 m0, s42, 0
    ds_read_b128 v[76:79], v5 offset:8192
    v_mfma_f32_16x16x32_bf16 v[52:55], a[28:31], v[84:87], v[52:55]
    buffer_load_dwordx4 v20, s[12:15], s54 offen lds
    ds_read_b128 v[80:83], v5 offset:10240
    v_mfma_f32_16x16x32_bf16 v[60:63], a[32:35], v[84:87], v[60:63]
    s_add_u32 m0, s42, 1024
    ds_read_b64_tr_b16 a[48:49], v29 offset:0
    v_mfma_f32_16x16x32_bf16 v[64:67], a[32:35], v[88:91], v[64:67]
    buffer_load_dwordx4 v21, s[12:15], s54 offen lds
    ds_read_b64_tr_b16 a[50:51], v29 offset:512
    v_mfma_f32_16x16x32_bf16 v[44:47], a[36:39], v[92:95], v[44:47]
    s_add_u32 m0, s42, 8192
    ds_read_b64_tr_b16 a[52:53], v30 offset:0
    v_mfma_f32_16x16x32_bf16 v[48:51], a[36:39], v[96:99], v[48:51]
    buffer_load_dwordx4 v22, s[12:15], s54 offen lds
    ds_read_b64_tr_b16 a[54:55], v30 offset:512
    v_mfma_f32_16x16x32_bf16 v[56:59], a[40:43], v[96:99], v[56:59]
    s_add_u32 m0, s42, 9216
    ds_read_b64_tr_b16 a[56:57], v31 offset:0
    v_mfma_f32_16x16x32_bf16 v[52:55], a[40:43], v[92:95], v[52:55]
    buffer_load_dwordx4 v23, s[12:15], s54 offen lds
    ds_read_b64_tr_b16 a[58:59], v31 offset:512
    v_mfma_f32_16x16x32_bf16 v[60:63], a[44:47], v[92:95], v[60:63]
    s_add_u32 m0, s42, 16384
    ds_read_b64_tr_b16 a[60:61], v29 offset:4096
    v_mfma_f32_16x16x32_bf16 v[64:67], a[44:47], v[96:99], v[64:67]
    buffer_load_dwordx4 v24, s[12:15], s54 offen lds
    ds_read_b64_tr_b16 a[62:63], v29 offset:4608
    v_mfma_f32_16x16x32_bf16 v[100:103], a[24:27], v[32:35], v[100:103]
    s_add_u32 m0, s42, 17408
    ds_read_b64_tr_b16 a[64:65], v30 offset:4096
    v_mfma_f32_16x16x32_bf16 v[104:107], a[28:31], v[32:35], v[104:107]
    buffer_load_dwordx4 v25, s[12:15], s54 offen lds
    ds_read_b64_tr_b16 a[66:67], v30 offset:4608
    v_mfma_f32_16x16x32_bf16 v[108:111], a[32:35], v[32:35], v[108:111]
    s_add_u32 s54, s54, 393216
    ds_read_b64_tr_b16 a[68:69], v31 offset:4096
    v_mfma_f32_16x16x32_bf16 v[100:103], a[36:39], v[32:35], v[100:103]
    ds_read_b64_tr_b16 a[70:71], v31 offset:4608
    v_mfma_f32_16x16x32_bf16 v[104:107], a[40:43], v[32:35], v[104:107]
    v_mfma_f32_16x16x32_bf16 v[108:111], a[44:47], v[32:35], v[108:111]
    v_add_u32 v7, s39, v40
    v_bfe_u32 v38, v0, 1, 2
    v_xor_b32 v38, v38, v37
    v_lshlrev_b32 v38, 4, v38
    v_lshl_add_u32 v38, v36, 6, v38
    v_add_u32 v8, s39, v38
    s_mul_i32 s39, s38, 6144
    s_add_u32 s39, s39, s37
    v_add_u32 v9, s39, v40
    s_cmp_eq_u32 s38, 0
    s_cselect_b32 s39, 18432, 0
    v_add_u32 v29, 49152, v26
    v_add_u32 v30, 49152, v27
    v_add_u32 v31, 49152, v28
    s_waitcnt vmcnt(14) lgkmcnt(0)
    s_barrier
    v_mfma_f32_16x16x32_bf16 v[44:47], a[48:51], v[68:71], v[44:47]
    s_add_u32 m0, s43, 122112
    ds_read_b128 v[84:87], v4 offset:12288
    v_mfma_f32_16x16x32_bf16 v[48:51], a[48:51], v[72:75], v[48:51]
    buffer_load_dwordx4 v6, s[8:11], s41 offen offset:768 sc1 lds
    ds_read_b128 v[88:91], v4 offset:14336
    v_mfma_f32_16x16x32_bf16 v[56:59], a[52:55], v[72:75], v[56:59]
    s_add_u32 m0, s42, 24576
    ds_read_b128 v[92:95], v5 offset:12288
    v_mfma_f32_16x16x32_bf16 v[52:55], a[52:55], v[68:71], v[52:55]
    buffer_load_dwordx4 v20, s[12:15], s54 offen lds
    ds_read_b128 v[96:99], v5 offset:14336
    v_mfma_f32_16x16x32_bf16 v[60:63], a[56:59], v[68:71], v[60:63]
    s_add_u32 m0, s42, 25600
    ds_read_b64_tr_b16 a[72:73], v29 offset:0
    v_mfma_f32_16x16x32_bf16 v[64:67], a[56:59], v[72:75], v[64:67]
    buffer_load_dwordx4 v21, s[12:15], s54 offen lds
    ds_read_b64_tr_b16 a[74:75], v29 offset:512
    v_mfma_f32_16x16x32_bf16 v[44:47], a[60:63], v[76:79], v[44:47]
    s_add_u32 m0, s42, 32768
    ds_read_b64_tr_b16 a[76:77], v30 offset:0
    v_mfma_f32_16x16x32_bf16 v[48:51], a[60:63], v[80:83], v[48:51]
    buffer_load_dwordx4 v22, s[12:15], s54 offen lds
    ds_read_b64_tr_b16 a[78:79], v30 offset:512
    v_mfma_f32_16x16x32_bf16 v[56:59], a[64:67], v[80:83], v[56:59]
    s_add_u32 m0, s42, 33792
    ds_read_b64_tr_b16 a[80:81], v31 offset:0
    v_mfma_f32_16x16x32_bf16 v[52:55], a[64:67], v[76:79], v[52:55]
    buffer_load_dwordx4 v23, s[12:15], s54 offen lds
    ds_read_b64_tr_b16 a[82:83], v31 offset:512
    v_mfma_f32_16x16x32_bf16 v[60:63], a[68:71], v[76:79], v[60:63]
    s_add_u32 m0, s42, 40960
    ds_read_b64_tr_b16 a[84:85], v29 offset:4096
    v_mfma_f32_16x16x32_bf16 v[64:67], a[68:71], v[80:83], v[64:67]
    buffer_load_dwordx4 v24, s[12:15], s54 offen lds
    ds_read_b64_tr_b16 a[86:87], v29 offset:4608
    v_mfma_f32_16x16x32_bf16 v[100:103], a[48:51], v[32:35], v[100:103]
    s_add_u32 m0, s42, 41984
    ds_read_b64_tr_b16 a[88:89], v30 offset:4096
    v_mfma_f32_16x16x32_bf16 v[104:107], a[52:55], v[32:35], v[104:107]
    buffer_load_dwordx4 v25, s[12:15], s54 offen lds
    ds_read_b64_tr_b16 a[90:91], v30 offset:4608
    v_mfma_f32_16x16x32_bf16 v[108:111], a[56:59], v[32:35], v[108:111]
    s_add_u32 s54, s54, 393216
    ds_read_b64_tr_b16 a[92:93], v31 offset:4096
    v_mfma_f32_16x16x32_bf16 v[100:103], a[60:63], v[32:35], v[100:103]
    ds_read_b64_tr_b16 a[94:95], v31 offset:4608
    v_mfma_f32_16x16x32_bf16 v[104:107], a[64:67], v[32:35], v[104:107]
    v_mfma_f32_16x16x32_bf16 v[108:111], a[68:71], v[32:35], v[108:111]
    s_add_u32 s39, s39, s37
    v_add_u32 v10, s39, v40
    s_sub_u32 s39, s33, 1
    s_max_i32 s39, s39, 0
    v_mov_b32 v38, s33
    v_mov_b32 v39, s39
    v_mov_b32 v12, 2097152
    v_mov_b32 v41, 262144
    v_cmp_lt_u32 vcc, 15, v0
    s_nop 1
    v_cndmask_b32 v38, v38, v39, vcc
    v_cndmask_b32 v12, v12, v41, vcc
    v_add_u32 v29, 73728, v26
    v_add_u32 v30, 73728, v27
    v_add_u32 v31, 73728, v28
    s_waitcnt vmcnt(14) lgkmcnt(0)
    s_barrier
    v_mfma_f32_16x16x32_bf16 v[44:47], a[72:75], v[84:87], v[44:47]
    s_add_u32 m0, s43, 126080
    ds_read_b128 v[68:71], v4 offset:16384
    v_mfma_f32_16x16x32_bf16 v[48:51], a[72:75], v[88:91], v[48:51]
    buffer_load_dwordx4 v6, s[8:11], s41 offen offset:896 sc1 lds
    ds_read_b128 v[72:75], v4 offset:18432
    v_mfma_f32_16x16x32_bf16 v[56:59], a[76:79], v[88:91], v[56:59]
    s_add_u32 m0, s42, 49152
    ds_read_b128 v[76:79], v5 offset:16384
    v_mfma_f32_16x16x32_bf16 v[52:55], a[76:79], v[84:87], v[52:55]
    buffer_load_dwordx4 v20, s[12:15], s54 offen lds
    ds_read_b128 v[80:83], v5 offset:18432
    v_mfma_f32_16x16x32_bf16 v[60:63], a[80:83], v[84:87], v[60:63]
    s_add_u32 m0, s42, 50176
    ds_read_b64_tr_b16 a[96:97], v29 offset:0
    v_mfma_f32_16x16x32_bf16 v[64:67], a[80:83], v[88:91], v[64:67]
    buffer_load_dwordx4 v21, s[12:15], s54 offen lds
    ds_read_b64_tr_b16 a[98:99], v29 offset:512
    v_mfma_f32_16x16x32_bf16 v[44:47], a[84:87], v[92:95], v[44:47]
    s_add_u32 m0, s42, 57344
    ds_read_b64_tr_b16 a[100:101], v30 offset:0
    v_mfma_f32_16x16x32_bf16 v[48:51], a[84:87], v[96:99], v[48:51]
    buffer_load_dwordx4 v22, s[12:15], s54 offen lds
    ds_read_b64_tr_b16 a[102:103], v30 offset:512
    v_mfma_f32_16x16x32_bf16 v[56:59], a[88:91], v[96:99], v[56:59]
    s_add_u32 m0, s42, 58368
    ds_read_b64_tr_b16 a[104:105], v31 offset:0
    v_mfma_f32_16x16x32_bf16 v[52:55], a[88:91], v[92:95], v[52:55]
    buffer_load_dwordx4 v23, s[12:15], s54 offen lds
    ds_read_b64_tr_b16 a[106:107], v31 offset:512
    v_mfma_f32_16x16x32_bf16 v[60:63], a[92:95], v[92:95], v[60:63]
    s_add_u32 m0, s42, 65536
    ds_read_b64_tr_b16 a[108:109], v29 offset:4096
    v_mfma_f32_16x16x32_bf16 v[64:67], a[92:95], v[96:99], v[64:67]
    buffer_load_dwordx4 v24, s[12:15], s54 offen lds
    ds_read_b64_tr_b16 a[110:111], v29 offset:4608
    v_mfma_f32_16x16x32_bf16 v[100:103], a[72:75], v[32:35], v[100:103]
    s_add_u32 m0, s42, 66560
    ds_read_b64_tr_b16 a[112:113], v30 offset:4096
    v_mfma_f32_16x16x32_bf16 v[104:107], a[76:79], v[32:35], v[104:107]
    buffer_load_dwordx4 v25, s[12:15], s54 offen lds
    ds_read_b64_tr_b16 a[114:115], v30 offset:4608
    v_mfma_f32_16x16x32_bf16 v[108:111], a[80:83], v[32:35], v[108:111]
    s_add_u32 s54, s54, 393216
    ds_read_b64_tr_b16 a[116:117], v31 offset:4096
    v_mfma_f32_16x16x32_bf16 v[100:103], a[84:87], v[32:35], v[100:103]
    ds_read_b64_tr_b16 a[118:119], v31 offset:4608
    v_mfma_f32_16x16x32_bf16 v[104:107], a[88:91], v[32:35], v[104:107]
    v_mfma_f32_16x16x32_bf16 v[108:111], a[92:95], v[32:35], v[108:111]
    v_lshl_add_u32 v38, v38, 6, v36
    v_add_u32 v38, 349484, v38
    v_lshlrev_b32 v11, 8, v38
    s_cmp_eq_u32 s32, 0
    s_cselect_b32 s37, 32, 0
    v_cmp_le_u32 vcc, s37, v0
    s_nop 1
    v_cndmask_b32 v11, v11, 2.0, vcc
    v_mov_b32 v116, 0
    v_mov_b32 v117, v11
    s_mov_b32 s45, -1572864
    v_and_b32 v13, 15, v0
    v_add_u32 v29, 0, v26
    v_add_u32 v30, 0, v27
    v_add_u32 v31, 0, v28
    s_waitcnt vmcnt(14) lgkmcnt(0)
    s_barrier
    v_mfma_f32_16x16x32_bf16 v[44:47], a[96:99], v[68:71], v[44:47]
    s_add_u32 m0, s43, 130048
    ds_read_b128 v[84:87], v4 offset:20480
    v_mfma_f32_16x16x32_bf16 v[48:51], a[96:99], v[72:75], v[48:51]
    buffer_load_dwordx4 v6, s[8:11], s41 offen offset:1024 sc1 lds
    ds_read_b128 v[88:91], v4 offset:22528
    v_mfma_f32_16x16x32_bf16 v[56:59], a[100:103], v[72:75], v[56:59]
    s_add_u32 m0, s42, 73728
    ds_read_b128 v[92:95], v5 offset:20480
    v_mfma_f32_16x16x32_bf16 v[52:55], a[100:103], v[68:71], v[52:55]
    buffer_load_dwordx4 v20, s[12:15], s54 offen lds
    ds_read_b128 v[96:99], v5 offset:22528
    v_mfma_f32_16x16x32_bf16 v[60:63], a[104:107], v[68:71], v[60:63]
    s_add_u32 m0, s42, 74752
    ds_read_b64_tr_b16 a[120:121], v29 offset:0
    v_mfma_f32_16x16x32_bf16 v[64:67], a[104:107], v[72:75], v[64:67]
    buffer_load_dwordx4 v21, s[12:15], s54 offen lds
    ds_read_b64_tr_b16 a[122:123], v29 offset:512
    v_mfma_f32_16x16x32_bf16 v[44:47], a[108:111], v[76:79], v[44:47]
    s_add_u32 m0, s42, 81920
    ds_read_b64_tr_b16 a[124:125], v30 offset:0
    v_mfma_f32_16x16x32_bf16 v[48:51], a[108:111], v[80:83], v[48:51]
    buffer_load_dwordx4 v22, s[12:15], s54 offen lds
    ds_read_b64_tr_b16 a[126:127], v30 offset:512
    v_mfma_f32_16x16x32_bf16 v[56:59], a[112:115], v[80:83], v[56:59]
    s_add_u32 m0, s42, 82944
    ds_read_b64_tr_b16 a[128:129], v31 offset:0
    v_mfma_f32_16x16x32_bf16 v[52:55], a[112:115], v[76:79], v[52:55]
    buffer_load_dwordx4 v23, s[12:15], s54 offen lds
    ds_read_b64_tr_b16 a[130:131], v31 offset:512
    v_mfma_f32_16x16x32_bf16 v[60:63], a[116:119], v[76:79], v[60:63]
    s_add_u32 m0, s42, 90112
    ds_read_b64_tr_b16 a[132:133], v29 offset:4096
    v_mfma_f32_16x16x32_bf16 v[64:67], a[116:119], v[80:83], v[64:67]
    buffer_load_dwordx4 v24, s[12:15], s54 offen lds
    ds_read_b64_tr_b16 a[134:135], v29 offset:4608
    v_mfma_f32_16x16x32_bf16 v[100:103], a[96:99], v[32:35], v[100:103]
    s_add_u32 m0, s42, 91136
    ds_read_b64_tr_b16 a[136:137], v30 offset:4096
    v_mfma_f32_16x16x32_bf16 v[104:107], a[100:103], v[32:35], v[104:107]
    buffer_load_dwordx4 v25, s[12:15], s54 offen lds
    ds_read_b64_tr_b16 a[138:139], v30 offset:4608
    v_mfma_f32_16x16x32_bf16 v[108:111], a[104:107], v[32:35], v[108:111]
    s_add_u32 s54, s54, 393216
    ds_read_b64_tr_b16 a[140:141], v31 offset:4096
    v_mfma_f32_16x16x32_bf16 v[100:103], a[108:111], v[32:35], v[100:103]
    ds_read_b64_tr_b16 a[142:143], v31 offset:4608
    v_mfma_f32_16x16x32_bf16 v[104:107], a[112:115], v[32:35], v[104:107]
    v_mfma_f32_16x16x32_bf16 v[108:111], a[116:119], v[32:35], v[108:111]
    v_lshlrev_b32 v13, 3, v13
    v_lshrrev_b32 v38, 5, v0
    v_lshl_add_u32 v13, v38, 9, v13
    v_and_b32 v38, 16, v0
    v_lshl_add_u32 v13, v38, 6, v13
    v_add_u32 v13, 90112, v13
    s_lshl_b32 s52, s51, 10
    s_mov_b32 s55, 0x541fc00
    s_lshl_b32 s46, s50, 10
    s_sub_u32 s46, s55, s46
    s_mov_b32 s56, 0xaaaaaaaa
    v_add_u32 v29, 24576, v26
    v_add_u32 v30, 24576, v27
    v_add_u32 v31, 24576, v28
    s_waitcnt vmcnt(14) lgkmcnt(0)
    s_barrier
    v_mfma_f32_16x16x32_bf16 v[44:47], a[120:123], v[84:87], v[44:47]
    s_add_u32 m0, s43, 134016
    ds_read_b128 v[68:71], v4 offset:24576
    v_mfma_f32_16x16x32_bf16 v[48:51], a[120:123], v[88:91], v[48:51]
    buffer_load_dwordx4 v6, s[8:11], s41 offen offset:1152 sc1 lds
    ds_read_b128 v[72:75], v4 offset:26624
    v_mfma_f32_16x16x32_bf16 v[56:59], a[124:127], v[88:91], v[56:59]
    s_add_u32 m0, s42, 0
    ds_read_b128 v[76:79], v5 offset:24576
    v_mfma_f32_16x16x32_bf16 v[52:55], a[124:127], v[84:87], v[52:55]
    buffer_load_dwordx4 v20, s[12:15], s54 offen lds
    ds_read_b128 v[80:83], v5 offset:26624
    v_mfma_f32_16x16x32_bf16 v[60:63], a[128:131], v[84:87], v[60:63]
    s_add_u32 m0, s42, 1024
    ds_read_b64_tr_b16 a[144:145], v29 offset:0
    v_mfma_f32_16x16x32_bf16 v[64:67], a[128:131], v[88:91], v[64:67]
    buffer_load_dwordx4 v21, s[12:15], s54 offen lds
    ds_read_b64_tr_b16 a[146:147], v29 offset:512
    v_mfma_f32_16x16x32_bf16 v[44:47], a[132:135], v[92:95], v[44:47]
    s_add_u32 m0, s42, 8192
    ds_read_b64_tr_b16 a[148:149], v30 offset:0
    v_mfma_f32_16x16x32_bf16 v[48:51], a[132:135], v[96:99], v[48:51]
    buffer_load_dwordx4 v22, s[12:15], s54 offen lds
    ds_read_b64_tr_b16 a[150:151], v30 offset:512
    v_mfma_f32_16x16x32_bf16 v[56:59], a[136:139], v[96:99], v[56:59]
    s_add_u32 m0, s42, 9216
    ds_read_b64_tr_b16 a[152:153], v31 offset:0
    v_mfma_f32_16x16x32_bf16 v[52:55], a[136:139], v[92:95], v[52:55]
    buffer_load_dwordx4 v23, s[12:15], s54 offen lds
    ds_read_b64_tr_b16 a[154:155], v31 offset:512
    v_mfma_f32_16x16x32_bf16 v[60:63], a[140:143], v[92:95], v[60:63]
    s_add_u32 m0, s42, 16384
    ds_read_b64_tr_b16 a[156:157], v29 offset:4096
    v_mfma_f32_16x16x32_bf16 v[64:67], a[140:143], v[96:99], v[64:67]
    buffer_load_dwordx4 v24, s[12:15], s54 offen lds
    ds_read_b64_tr_b16 a[158:159], v29 offset:4608
    v_mfma_f32_16x16x32_bf16 v[100:103], a[120:123], v[32:35], v[100:103]
    s_add_u32 m0, s42, 17408
    ds_read_b64_tr_b16 a[160:161], v30 offset:4096
    v_mfma_f32_16x16x32_bf16 v[104:107], a[124:127], v[32:35], v[104:107]
    buffer_load_dwordx4 v25, s[12:15], s54 offen lds
    ds_read_b64_tr_b16 a[162:163], v30 offset:4608
    v_mfma_f32_16x16x32_bf16 v[108:111], a[128:131], v[32:35], v[108:111]
    s_add_u32 s54, s54, 393216
    ds_read_b64_tr_b16 a[164:165], v31 offset:4096
    v_mfma_f32_16x16x32_bf16 v[100:103], a[132:135], v[32:35], v[100:103]
    ds_read_b64_tr_b16 a[166:167], v31 offset:4608
    v_mfma_f32_16x16x32_bf16 v[104:107], a[136:139], v[32:35], v[104:107]
    v_mfma_f32_16x16x32_bf16 v[108:111], a[140:143], v[32:35], v[108:111]
    s_mov_b32 s57, 0xaaaaaaaa
    s_mov_b32 s58, 0xfff0ffff
    s_mov_b32 s59, 0xf000ff00
    s_mov_b32 s60, 0xffc0fffc
    s_mov_b32 s61, 0xc000fc00
    s_mov_b32 s86, 0x3e8293ee
    v_mov_b32 v38, 0x0c0c0c0c
    v_mov_b32 v36, 0xc0c0100
    v_mov_b32 v37, 0x1000c0c
    v_cndmask_b32 v36, v36, v37, s[56:57]
    v_cndmask_b32 v14, v36, v38, s[58:59]
    v_add_u32 v29, 49152, v26
    v_add_u32 v30, 49152, v27
    v_add_u32 v31, 49152, v28
    s_waitcnt vmcnt(14) lgkmcnt(0)
    s_barrier
    v_mfma_f32_16x16x32_bf16 v[44:47], a[144:147], v[68:71], v[44:47]
    s_add_u32 m0, s43, 137984
    ds_read_b128 v[84:87], v4 offset:28672
    v_mfma_f32_16x16x32_bf16 v[48:51], a[144:147], v[72:75], v[48:51]
    buffer_load_dwordx4 v6, s[8:11], s41 offen offset:1280 sc1 lds
    ds_read_b128 v[88:91], v4 offset:30720
    v_mfma_f32_16x16x32_bf16 v[56:59], a[148:151], v[72:75], v[56:59]
    s_add_u32 m0, s42, 24576
    ds_read_b128 v[92:95], v5 offset:28672
    v_mfma_f32_16x16x32_bf16 v[52:55], a[148:151], v[68:71], v[52:55]
    buffer_load_dwordx4 v20, s[12:15], s54 offen lds
    ds_read_b128 v[96:99], v5 offset:30720
    v_mfma_f32_16x16x32_bf16 v[60:63], a[152:155], v[68:71], v[60:63]
    s_add_u32 m0, s42, 25600
    ds_read_b64_tr_b16 a[168:169], v29 offset:0
    v_mfma_f32_16x16x32_bf16 v[64:67], a[152:155], v[72:75], v[64:67]
    buffer_load_dwordx4 v21, s[12:15], s54 offen lds
    ds_read_b64_tr_b16 a[170:171], v29 offset:512
    v_mfma_f32_16x16x32_bf16 v[44:47], a[156:159], v[76:79], v[44:47]
    s_add_u32 m0, s42, 32768
    ds_read_b64_tr_b16 a[172:173], v30 offset:0
    v_mfma_f32_16x16x32_bf16 v[48:51], a[156:159], v[80:83], v[48:51]
    buffer_load_dwordx4 v22, s[12:15], s54 offen lds
    ds_read_b64_tr_b16 a[174:175], v30 offset:512
    v_mfma_f32_16x16x32_bf16 v[56:59], a[160:163], v[80:83], v[56:59]
    s_add_u32 m0, s42, 33792
    ds_read_b64_tr_b16 a[176:177], v31 offset:0
    v_mfma_f32_16x16x32_bf16 v[52:55], a[160:163], v[76:79], v[52:55]
    buffer_load_dwordx4 v23, s[12:15], s54 offen lds
    ds_read_b64_tr_b16 a[178:179], v31 offset:512
    v_mfma_f32_16x16x32_bf16 v[60:63], a[164:167], v[76:79], v[60:63]
    s_add_u32 m0, s42, 40960
    ds_read_b64_tr_b16 a[180:181], v29 offset:4096
    v_mfma_f32_16x16x32_bf16 v[64:67], a[164:167], v[80:83], v[64:67]
    buffer_load_dwordx4 v24, s[12:15], s54 offen lds
    ds_read_b64_tr_b16 a[182:183], v29 offset:4608
    v_mfma_f32_16x16x32_bf16 v[100:103], a[144:147], v[32:35], v[100:103]
    s_add_u32 m0, s42, 41984
    ds_read_b64_tr_b16 a[184:185], v30 offset:4096
    v_mfma_f32_16x16x32_bf16 v[104:107], a[148:151], v[32:35], v[104:107]
    buffer_load_dwordx4 v25, s[12:15], s54 offen lds
    ds_read_b64_tr_b16 a[186:187], v30 offset:4608
    v_mfma_f32_16x16x32_bf16 v[108:111], a[152:155], v[32:35], v[108:111]
    s_add_u32 s54, s54, 393216
    ds_read_b64_tr_b16 a[188:189], v31 offset:4096
    v_mfma_f32_16x16x32_bf16 v[100:103], a[156:159], v[32:35], v[100:103]
    ds_read_b64_tr_b16 a[190:191], v31 offset:4608
    v_mfma_f32_16x16x32_bf16 v[104:107], a[160:163], v[32:35], v[104:107]
    v_mfma_f32_16x16x32_bf16 v[108:111], a[164:167], v[32:35], v[108:111]
    v_cndmask_b32 v16, v38, v36, s[58:59]
    v_mov_b32 v36, 0xc0c0302
    v_mov_b32 v37, 0x3020c0c
    v_cndmask_b32 v36, v36, v37, s[56:57]
    v_cndmask_b32 v15, v36, v38, s[60:61]
    v_cndmask_b32 v17, v38, v36, s[60:61]
    v_mov_b32 v18, 0xff800000
    s_mul_i32 s90, s33, 2097152
    s_add_u32 s90, s90, 0xfffe0400
    s_lshl_b32 s37, s35, 1
    s_add_u32 s37, s37, s51
    v_add_u32 v29, 73728, v26
    v_add_u32 v30, 73728, v27
    v_add_u32 v31, 73728, v28
    s_waitcnt vmcnt(14) lgkmcnt(0)
    s_barrier
    v_mfma_f32_16x16x32_bf16 v[44:47], a[168:171], v[84:87], v[44:47]
    s_add_u32 m0, s43, 141952
    ds_read_b128 v[68:71], v4 offset:32768
    v_mfma_f32_16x16x32_bf16 v[48:51], a[168:171], v[88:91], v[48:51]
    buffer_load_dwordx4 v6, s[8:11], s41 offen offset:1408 sc1 lds
    ds_read_b128 v[72:75], v4 offset:34816
    v_mfma_f32_16x16x32_bf16 v[56:59], a[172:175], v[88:91], v[56:59]
    s_add_u32 m0, s42, 49152
    ds_read_b128 v[76:79], v5 offset:32768
    v_mfma_f32_16x16x32_bf16 v[52:55], a[172:175], v[84:87], v[52:55]
    buffer_load_dwordx4 v20, s[12:15], s54 offen lds
    ds_read_b128 v[80:83], v5 offset:34816
    v_mfma_f32_16x16x32_bf16 v[60:63], a[176:179], v[84:87], v[60:63]
    s_add_u32 m0, s42, 50176
    ds_read_b64_tr_b16 a[192:193], v29 offset:0
    v_mfma_f32_16x16x32_bf16 v[64:67], a[176:179], v[88:91], v[64:67]
    buffer_load_dwordx4 v21, s[12:15], s54 offen lds
    ds_read_b64_tr_b16 a[194:195], v29 offset:512
    v_mfma_f32_16x16x32_bf16 v[44:47], a[180:183], v[92:95], v[44:47]
    s_add_u32 m0, s42, 57344
    ds_read_b64_tr_b16 a[196:197], v30 offset:0
    v_mfma_f32_16x16x32_bf16 v[48:51], a[180:183], v[96:99], v[48:51]
    buffer_load_dwordx4 v22, s[12:15], s54 offen lds
    ds_read_b64_tr_b16 a[198:199], v30 offset:512
    v_mfma_f32_16x16x32_bf16 v[56:59], a[184:187], v[96:99], v[56:59]
    s_add_u32 m0, s42, 58368
    ds_read_b64_tr_b16 a[200:201], v31 offset:0
    v_mfma_f32_16x16x32_bf16 v[52:55], a[184:187], v[92:95], v[52:55]
    buffer_load_dwordx4 v23, s[12:15], s54 offen lds
    ds_read_b64_tr_b16 a[202:203], v31 offset:512
    v_mfma_f32_16x16x32_bf16 v[60:63], a[188:191], v[92:95], v[60:63]
    s_add_u32 m0, s42, 65536
    ds_read_b64_tr_b16 a[204:205], v29 offset:4096
    v_mfma_f32_16x16x32_bf16 v[64:67], a[188:191], v[96:99], v[64:67]
    buffer_load_dwordx4 v24, s[12:15], s54 offen lds
    ds_read_b64_tr_b16 a[206:207], v29 offset:4608
    v_mfma_f32_16x16x32_bf16 v[100:103], a[168:171], v[32:35], v[100:103]
    s_add_u32 m0, s42, 66560
    ds_read_b64_tr_b16 a[208:209], v30 offset:4096
    v_mfma_f32_16x16x32_bf16 v[104:107], a[172:175], v[32:35], v[104:107]
    buffer_load_dwordx4 v25, s[12:15], s54 offen lds
    ds_read_b64_tr_b16 a[210:211], v30 offset:4608
    v_mfma_f32_16x16x32_bf16 v[108:111], a[176:179], v[32:35], v[108:111]
    s_add_u32 s54, s54, 393216
    ds_read_b64_tr_b16 a[212:213], v31 offset:4096
    v_mfma_f32_16x16x32_bf16 v[100:103], a[180:183], v[32:35], v[100:103]
    ds_read_b64_tr_b16 a[214:215], v31 offset:4608
    v_mfma_f32_16x16x32_bf16 v[104:107], a[184:187], v[32:35], v[104:107]
    v_mfma_f32_16x16x32_bf16 v[108:111], a[188:191], v[32:35], v[108:111]
    s_lshl_b32 s37, s37, 11
    s_add_u32 s90, s90, s37
    s_mul_i32 s37, s38, 64512
    s_add_u32 s90, s90, s37
    s_cmp_eq_u32 s38, 0
    s_cselect_b32 s87, 63488, 0
    s_cselect_b32 s24, -2, 0xfffeffff
    s_cselect_b32 s26, 0x10000, 0
    s_cselect_b32 s27, 0, 1
    s_add_u32 s87, s87, 1024
    s_mov_b32 s25, -1
    s_cmp_eq_u32 s33, 0
    s_cselect_b64 s[26:27], s[26:27], 0
    s_add_u32 s20, s82, 0x80
    s_addc_u32 s21, s83, 0
    s_mov_b32 s22, 0x4
    s_mov_b32 s23, 0x00020000
    v_lshl_add_u32 v36, s32, 4, v124
    v_add_u32 v29, 0, v26
    v_add_u32 v30, 0, v27
    v_add_u32 v31, 0, v28
    s_waitcnt vmcnt(14) lgkmcnt(0)
    s_barrier
    v_mfma_f32_16x16x32_bf16 v[44:47], a[192:195], v[68:71], v[44:47]
    s_add_u32 m0, s43, 145920
    ds_read_b128 v[84:87], v4 offset:36864
    v_mfma_f32_16x16x32_bf16 v[48:51], a[192:195], v[72:75], v[48:51]
    buffer_load_dwordx4 v6, s[8:11], s41 offen offset:1536 sc1 lds
    ds_read_b128 v[88:91], v4 offset:38912
    v_mfma_f32_16x16x32_bf16 v[56:59], a[196:199], v[72:75], v[56:59]
    s_add_u32 m0, s42, 73728
    ds_read_b128 v[92:95], v5 offset:36864
    v_mfma_f32_16x16x32_bf16 v[52:55], a[196:199], v[68:71], v[52:55]
    buffer_load_dwordx4 v20, s[12:15], s54 offen lds
    ds_read_b128 v[96:99], v5 offset:38912
    v_mfma_f32_16x16x32_bf16 v[60:63], a[200:203], v[68:71], v[60:63]
    s_add_u32 m0, s42, 74752
    ds_read_b64_tr_b16 a[216:217], v29 offset:0
    v_mfma_f32_16x16x32_bf16 v[64:67], a[200:203], v[72:75], v[64:67]
    buffer_load_dwordx4 v21, s[12:15], s54 offen lds
    ds_read_b64_tr_b16 a[218:219], v29 offset:512
    v_mfma_f32_16x16x32_bf16 v[44:47], a[204:207], v[76:79], v[44:47]
    s_add_u32 m0, s42, 81920
    ds_read_b64_tr_b16 a[220:221], v30 offset:0
    v_mfma_f32_16x16x32_bf16 v[48:51], a[204:207], v[80:83], v[48:51]
    buffer_load_dwordx4 v22, s[12:15], s54 offen lds
    ds_read_b64_tr_b16 a[222:223], v30 offset:512
    v_mfma_f32_16x16x32_bf16 v[56:59], a[208:211], v[80:83], v[56:59]
    s_add_u32 m0, s42, 82944
    ds_read_b64_tr_b16 a[224:225], v31 offset:0
    v_mfma_f32_16x16x32_bf16 v[52:55], a[208:211], v[76:79], v[52:55]
    buffer_load_dwordx4 v23, s[12:15], s54 offen lds
    ds_read_b64_tr_b16 a[226:227], v31 offset:512
    v_mfma_f32_16x16x32_bf16 v[60:63], a[212:215], v[76:79], v[60:63]
    s_add_u32 m0, s42, 90112
    ds_read_b64_tr_b16 a[228:229], v29 offset:4096
    v_mfma_f32_16x16x32_bf16 v[64:67], a[212:215], v[80:83], v[64:67]
    buffer_load_dwordx4 v24, s[12:15], s54 offen lds
    ds_read_b64_tr_b16 a[230:231], v29 offset:4608
    v_mfma_f32_16x16x32_bf16 v[100:103], a[192:195], v[32:35], v[100:103]
    s_add_u32 m0, s42, 91136
    ds_read_b64_tr_b16 a[232:233], v30 offset:4096
    v_mfma_f32_16x16x32_bf16 v[104:107], a[196:199], v[32:35], v[104:107]
    buffer_load_dwordx4 v25, s[12:15], s54 offen lds
    ds_read_b64_tr_b16 a[234:235], v30 offset:4608
    v_mfma_f32_16x16x32_bf16 v[108:111], a[200:203], v[32:35], v[108:111]
    s_add_u32 s54, s54, 393216
    ds_read_b64_tr_b16 a[236:237], v31 offset:4096
    v_mfma_f32_16x16x32_bf16 v[100:103], a[204:207], v[32:35], v[100:103]
    ds_read_b64_tr_b16 a[238:239], v31 offset:4608
    v_mfma_f32_16x16x32_bf16 v[104:107], a[208:211], v[32:35], v[104:107]
    v_mfma_f32_16x16x32_bf16 v[108:111], a[212:215], v[32:35], v[108:111]
    v_add_u32 v29, 24576, v26
    v_add_u32 v30, 24576, v27
    v_add_u32 v31, 24576, v28
    s_waitcnt vmcnt(14) lgkmcnt(0)
    s_barrier
    v_mfma_f32_16x16x32_bf16 v[44:47], a[216:219], v[84:87], v[44:47]
    buffer_load_dword v37, v36, s[20:23], 0 offen sc1
    ds_read_b128 v[68:71], v4 offset:40960
    v_mfma_f32_16x16x32_bf16 v[48:51], a[216:219], v[88:91], v[48:51]
    s_add_u32 m0, s43, 149888
    ds_read_b128 v[72:75], v4 offset:43008
    v_mfma_f32_16x16x32_bf16 v[56:59], a[220:223], v[88:91], v[56:59]
    buffer_load_dwordx4 v6, s[8:11], s41 offen offset:1664 sc1 lds
    ds_read_b128 v[76:79], v5 offset:40960
    v_mfma_f32_16x16x32_bf16 v[52:55], a[220:223], v[84:87], v[52:55]
    s_add_u32 m0, s42, 0
    ds_read_b128 v[80:83], v5 offset:43008
    v_mfma_f32_16x16x32_bf16 v[60:63], a[224:227], v[84:87], v[60:63]
    buffer_load_dwordx4 v20, s[12:15], s54 offen lds
    ds_read_b64_tr_b16 a[240:241], v29 offset:0
    v_mfma_f32_16x16x32_bf16 v[64:67], a[224:227], v[88:91], v[64:67]
    s_add_u32 m0, s42, 1024
    ds_read_b64_tr_b16 a[242:243], v29 offset:512
    v_mfma_f32_16x16x32_bf16 v[44:47], a[228:231], v[92:95], v[44:47]
    buffer_load_dwordx4 v21, s[12:15], s54 offen lds
    ds_read_b64_tr_b16 a[244:245], v30 offset:0
    v_mfma_f32_16x16x32_bf16 v[48:51], a[228:231], v[96:99], v[48:51]
    s_add_u32 m0, s42, 8192
    ds_read_b64_tr_b16 a[246:247], v30 offset:512
    v_mfma_f32_16x16x32_bf16 v[56:59], a[232:235], v[96:99], v[56:59]
    buffer_load_dwordx4 v22, s[12:15], s54 offen lds
    ds_read_b64_tr_b16 a[248:249], v31 offset:0
    v_mfma_f32_16x16x32_bf16 v[52:55], a[232:235], v[92:95], v[52:55]
    s_add_u32 m0, s42, 9216
    ds_read_b64_tr_b16 a[250:251], v31 offset:512
    v_mfma_f32_16x16x32_bf16 v[60:63], a[236:239], v[92:95], v[60:63]
    buffer_load_dwordx4 v23, s[12:15], s54 offen lds
    ds_read_b64_tr_b16 a[252:253], v29 offset:4096
    v_mfma_f32_16x16x32_bf16 v[64:67], a[236:239], v[96:99], v[64:67]
    s_add_u32 m0, s42, 16384
    ds_read_b64_tr_b16 a[254:255], v29 offset:4608
    v_mfma_f32_16x16x32_bf16 v[100:103], a[216:219], v[32:35], v[100:103]
    buffer_load_dwordx4 v24, s[12:15], s54 offen lds
    ds_read_b64_tr_b16 v[128:129], v30 offset:4096
    v_mfma_f32_16x16x32_bf16 v[104:107], a[220:223], v[32:35], v[104:107]
    s_add_u32 m0, s42, 17408
    ds_read_b64_tr_b16 v[130:131], v30 offset:4608
    v_mfma_f32_16x16x32_bf16 v[108:111], a[224:227], v[32:35], v[108:111]
    buffer_load_dwordx4 v25, s[12:15], s54 offen lds
    ds_read_b64_tr_b16 v[132:133], v31 offset:4096
    v_mfma_f32_16x16x32_bf16 v[100:103], a[228:231], v[32:35], v[100:103]
    s_add_u32 s54, s54, 393216
    ds_read_b64_tr_b16 v[134:135], v31 offset:4608
    v_mfma_f32_16x16x32_bf16 v[104:107], a[232:235], v[32:35], v[104:107]
    v_mfma_f32_16x16x32_bf16 v[108:111], a[236:239], v[32:35], v[108:111]
    v_add_u32 v29, 49152, v26
    v_add_u32 v30, 49152, v27
    v_add_u32 v31, 49152, v28
    s_waitcnt vmcnt(15) lgkmcnt(0)
    s_barrier
    v_mfma_f32_16x16x32_bf16 v[44:47], a[240:243], v[68:71], v[44:47]
    s_add_u32 m0, s43, 153856
    ds_read_b128 v[84:87], v4 offset:45056
    v_mfma_f32_16x16x32_bf16 v[48:51], a[240:243], v[72:75], v[48:51]
    buffer_load_dwordx4 v6, s[8:11], s41 offen offset:1792 sc1 lds
    ds_read_b128 v[88:91], v4 offset:47104
    v_mfma_f32_16x16x32_bf16 v[56:59], a[244:247], v[72:75], v[56:59]
    s_add_u32 m0, s42, 24576
    ds_read_b128 v[92:95], v5 offset:45056
    v_mfma_f32_16x16x32_bf16 v[52:55], a[244:247], v[68:71], v[52:55]
    buffer_load_dwordx4 v20, s[12:15], s54 offen lds
    ds_read_b128 v[96:99], v5 offset:47104
    v_mfma_f32_16x16x32_bf16 v[60:63], a[248:251], v[68:71], v[60:63]
    s_add_u32 m0, s42, 25600
    ds_read_b64_tr_b16 v[136:137], v29 offset:0
    v_mfma_f32_16x16x32_bf16 v[64:67], a[248:251], v[72:75], v[64:67]
    buffer_load_dwordx4 v21, s[12:15], s54 offen lds
    ds_read_b64_tr_b16 v[138:139], v29 offset:512
    v_mfma_f32_16x16x32_bf16 v[44:47], a[252:255], v[76:79], v[44:47]
    s_add_u32 m0, s42, 32768
    ds_read_b64_tr_b16 v[140:141], v30 offset:0
    v_mfma_f32_16x16x32_bf16 v[48:51], a[252:255], v[80:83], v[48:51]
    buffer_load_dwordx4 v22, s[12:15], s54 offen lds
    ds_read_b64_tr_b16 v[142:143], v30 offset:512
    v_mfma_f32_16x16x32_bf16 v[56:59], v[128:131], v[80:83], v[56:59]
    s_add_u32 m0, s42, 33792
    ds_read_b64_tr_b16 v[144:145], v31 offset:0
    v_mfma_f32_16x16x32_bf16 v[52:55], v[128:131], v[76:79], v[52:55]
    buffer_load_dwordx4 v23, s[12:15], s54 offen lds
    ds_read_b64_tr_b16 v[146:147], v31 offset:512
    v_mfma_f32_16x16x32_bf16 v[60:63], v[132:135], v[76:79], v[60:63]
    s_add_u32 m0, s42, 40960
    ds_read_b64_tr_b16 v[148:149], v29 offset:4096
    v_mfma_f32_16x16x32_bf16 v[64:67], v[132:135], v[80:83], v[64:67]
    buffer_load_dwordx4 v24, s[12:15], s54 offen lds
    ds_read_b64_tr_b16 v[150:151], v29 offset:4608
    v_mfma_f32_16x16x32_bf16 v[100:103], a[240:243], v[32:35], v[100:103]
    s_add_u32 m0, s42, 41984
    ds_read_b64_tr_b16 v[152:153], v30 offset:4096
    v_mfma_f32_16x16x32_bf16 v[104:107], a[244:247], v[32:35], v[104:107]
    buffer_load_dwordx4 v25, s[12:15], s54 offen lds
    ds_read_b64_tr_b16 v[154:155], v30 offset:4608
    v_mfma_f32_16x16x32_bf16 v[108:111], a[248:251], v[32:35], v[108:111]
    s_add_u32 s54, s54, 393216
    ds_read_b64_tr_b16 v[156:157], v31 offset:4096
    v_mfma_f32_16x16x32_bf16 v[100:103], a[252:255], v[32:35], v[100:103]
    ds_read_b64_tr_b16 v[158:159], v31 offset:4608
    v_mfma_f32_16x16x32_bf16 v[104:107], v[128:131], v[32:35], v[104:107]
    v_mfma_f32_16x16x32_bf16 v[108:111], v[132:135], v[32:35], v[108:111]
    v_add_u32 v29, 73728, v26
    v_add_u32 v30, 73728, v27
    v_add_u32 v31, 73728, v28
    s_waitcnt vmcnt(15) lgkmcnt(0)
    s_barrier
    v_mfma_f32_16x16x32_bf16 v[44:47], v[136:139], v[84:87], v[44:47]
    s_add_u32 m0, s43, 157824
    ds_read_b128 v[68:71], v4 offset:49152
    v_mfma_f32_16x16x32_bf16 v[48:51], v[136:139], v[88:91], v[48:51]
    buffer_load_dwordx4 v6, s[8:11], s41 offen offset:1920 sc1 lds
    ds_read_b128 v[72:75], v4 offset:51200
    v_mfma_f32_16x16x32_bf16 v[56:59], v[140:143], v[88:91], v[56:59]
    s_add_u32 m0, s42, 49152
    ds_read_b128 v[76:79], v5 offset:49152
    v_mfma_f32_16x16x32_bf16 v[52:55], v[140:143], v[84:87], v[52:55]
    buffer_load_dwordx4 v20, s[12:15], s54 offen lds
    ds_read_b128 v[80:83], v5 offset:51200
    v_mfma_f32_16x16x32_bf16 v[60:63], v[144:147], v[84:87], v[60:63]
    s_add_u32 m0, s42, 50176
    ds_read_b64_tr_b16 v[160:161], v29 offset:0
    v_mfma_f32_16x16x32_bf16 v[64:67], v[144:147], v[88:91], v[64:67]
    buffer_load_dwordx4 v21, s[12:15], s54 offen lds
    ds_read_b64_tr_b16 v[162:163], v29 offset:512
    v_mfma_f32_16x16x32_bf16 v[44:47], v[148:151], v[92:95], v[44:47]
    s_add_u32 m0, s42, 57344
    ds_read_b64_tr_b16 v[164:165], v30 offset:0
    v_mfma_f32_16x16x32_bf16 v[48:51], v[148:151], v[96:99], v[48:51]
    buffer_load_dwordx4 v22, s[12:15], s54 offen lds
    ds_read_b64_tr_b16 v[166:167], v30 offset:512
    v_mfma_f32_16x16x32_bf16 v[56:59], v[152:155], v[96:99], v[56:59]
    s_add_u32 m0, s42, 58368
    ds_read_b64_tr_b16 v[168:169], v31 offset:0
    v_mfma_f32_16x16x32_bf16 v[52:55], v[152:155], v[92:95], v[52:55]
    buffer_load_dwordx4 v23, s[12:15], s54 offen lds
    ds_read_b64_tr_b16 v[170:171], v31 offset:512
    v_mfma_f32_16x16x32_bf16 v[60:63], v[156:159], v[92:95], v[60:63]
    s_add_u32 m0, s42, 65536
    ds_read_b64_tr_b16 v[172:173], v29 offset:4096
    v_mfma_f32_16x16x32_bf16 v[64:67], v[156:159], v[96:99], v[64:67]
    buffer_load_dwordx4 v24, s[12:15], s54 offen lds
    ds_read_b64_tr_b16 v[174:175], v29 offset:4608
    v_mfma_f32_16x16x32_bf16 v[100:103], v[136:139], v[32:35], v[100:103]
    s_add_u32 m0, s42, 66560
    ds_read_b64_tr_b16 v[176:177], v30 offset:4096
    v_mfma_f32_16x16x32_bf16 v[104:107], v[140:143], v[32:35], v[104:107]
    buffer_load_dwordx4 v25, s[12:15], s54 offen lds
    ds_read_b64_tr_b16 v[178:179], v30 offset:4608
    v_mfma_f32_16x16x32_bf16 v[108:111], v[144:147], v[32:35], v[108:111]
    s_add_u32 s54, s54, 393216
    ds_read_b64_tr_b16 v[180:181], v31 offset:4096
    v_mfma_f32_16x16x32_bf16 v[100:103], v[148:151], v[32:35], v[100:103]
    ds_read_b64_tr_b16 v[182:183], v31 offset:4608
    v_mfma_f32_16x16x32_bf16 v[104:107], v[152:155], v[32:35], v[104:107]
    v_mfma_f32_16x16x32_bf16 v[108:111], v[156:159], v[32:35], v[108:111]
    v_add_u32 v29, 0, v26
    v_add_u32 v30, 0, v27
    v_add_u32 v31, 0, v28
    s_waitcnt vmcnt(14) lgkmcnt(0)
    v_cmp_eq_u32 vcc, v36, v37
    s_cbranch_vccnz L_spin1
L_back2:
    s_barrier
    v_mfma_f32_16x16x32_bf16 v[44:47], v[160:163], v[68:71], v[44:47]
    s_add_u32 m0, s52, 92160
    ds_read_b128 v[84:87], v4 offset:53248
    v_mfma_f32_16x16x32_bf16 v[48:51], v[160:163], v[72:75], v[48:51]
    buffer_load_dwordx4 v1, s[16:19], s46 offen sc1 lds
    ds_read_b128 v[88:91], v4 offset:55296
    v_mfma_f32_16x16x32_bf16 v[56:59], v[164:167], v[72:75], v[56:59]
    s_cmp_eq_u32 s36, s97
    s_cselect_b32 s47, 31, -2
    s_cselect_b64 s[8:9], s[88:89], s[8:9]
    s_cselect_b32 s55, 0x543fc00, s55
    ds_read_b128 v[92:95], v5 offset:53248
    v_mfma_f32_16x16x32_bf16 v[52:55], v[164:167], v[68:71], v[52:55]
    s_add_u32 s50, s50, s47
    ds_read_b128 v[96:99], v5 offset:55296
    v_mfma_f32_16x16x32_bf16 v[60:63], v[168:171], v[68:71], v[60:63]
    s_max_i32 s47, s50, 0
    ds_read_b64_tr_b16 v[184:185], v29 offset:0
    v_mfma_f32_16x16x32_bf16 v[64:67], v[168:171], v[72:75], v[64:67]
    s_lshl_b32 s41, s47, 15
    ds_read_b64_tr_b16 v[186:187], v29 offset:512
    v_mfma_f32_16x16x32_bf16 v[44:47], v[172:175], v[76:79], v[44:47]
    s_lshl_b32 s46, s47, 10
    ds_read_b64_tr_b16 v[188:189], v30 offset:0
    v_mfma_f32_16x16x32_bf16 v[48:51], v[172:175], v[80:83], v[48:51]
    s_sub_u32 s46, s55, s46
    ds_read_b64_tr_b16 v[190:191], v30 offset:512
    v_mfma_f32_16x16x32_bf16 v[56:59], v[176:179], v[80:83], v[56:59]
    s_add_u32 m0, s52, 90112
    ds_read_b64_tr_b16 v[192:193], v31 offset:0
    v_mfma_f32_16x16x32_bf16 v[52:55], v[176:179], v[76:79], v[52:55]
    buffer_load_dwordx4 v1, s[16:19], s46 offen sc1 lds
    ds_read_b64_tr_b16 v[194:195], v31 offset:512
    v_mfma_f32_16x16x32_bf16 v[60:63], v[180:183], v[76:79], v[60:63]
    buffer_store_dword v124, v124, s[16:19], s91 offen sc1
    ds_read_b64_tr_b16 v[196:197], v29 offset:4096
    v_mfma_f32_16x16x32_bf16 v[64:67], v[180:183], v[80:83], v[64:67]
    s_add_u32 s91, s91, 131072
    ds_read_b64_tr_b16 v[198:199], v29 offset:4608
    v_mfma_f32_16x16x32_bf16 v[100:103], v[160:163], v[32:35], v[100:103]
    ds_read_b64_tr_b16 v[200:201], v30 offset:4096
    v_mfma_f32_16x16x32_bf16 v[104:107], v[164:167], v[32:35], v[104:107]
    ds_read_b64_tr_b16 v[202:203], v30 offset:4608
    v_mfma_f32_16x16x32_bf16 v[108:111], v[168:171], v[32:35], v[108:111]
    ds_read_b64_tr_b16 v[204:205], v31 offset:4096
    v_mfma_f32_16x16x32_bf16 v[100:103], v[172:175], v[32:35], v[100:103]
    ds_read_b64_tr_b16 v[206:207], v31 offset:4608
    v_mfma_f32_16x16x32_bf16 v[104:107], v[176:179], v[32:35], v[104:107]
    v_mfma_f32_16x16x32_bf16 v[108:111], v[180:183], v[32:35], v[108:111]
    v_add_u32 v29, 24576, v26
    v_add_u32 v30, 24576, v27
    v_add_u32 v31, 24576, v28
    s_waitcnt vmcnt(10) lgkmcnt(0)
    s_barrier
    v_mfma_f32_16x16x32_bf16 v[44:47], v[184:187], v[84:87], v[44:47]
    s_add_u32 m0, s43, 0
    ds_read_b128 v[68:71], v4 offset:57344
    v_mfma_f32_16x16x32_bf16 v[48:51], v[184:187], v[88:91], v[48:51]
    buffer_load_dwordx4 v6, s[8:11], s41 offen offset:0 sc1 lds
    ds_read_b128 v[72:75], v4 offset:59392
    v_mfma_f32_16x16x32_bf16 v[56:59], v[188:191], v[88:91], v[56:59]
    s_add_u32 m0, s43, 3968
    ds_read_b128 v[76:79], v5 offset:57344
    v_mfma_f32_16x16x32_bf16 v[52:55], v[188:191], v[84:87], v[52:55]
    buffer_load_dwordx4 v6, s[8:11], s41 offen offset:128 sc1 lds
    ds_read_b128 v[80:83], v5 offset:59392
    v_mfma_f32_16x16x32_bf16 v[60:63], v[192:195], v[84:87], v[60:63]
    s_add_u32 m0, s43, 7936
    ds_read_b64_tr_b16 v[208:209], v29 offset:0
    v_mfma_f32_16x16x32_bf16 v[64:67], v[192:195], v[88:91], v[64:67]
    buffer_load_dwordx4 v6, s[8:11], s41 offen offset:256 sc1 lds
    ds_read_b64_tr_b16 v[210:211], v29 offset:512
    v_mfma_f32_16x16x32_bf16 v[44:47], v[196:199], v[92:95], v[44:47]
    s_add_u32 m0, s43, 11904
    ds_read_b64_tr_b16 v[212:213], v30 offset:0
    v_mfma_f32_16x16x32_bf16 v[48:51], v[196:199], v[96:99], v[48:51]
    buffer_load_dwordx4 v6, s[8:11], s41 offen offset:384 sc1 lds
    ds_read_b64_tr_b16 v[214:215], v30 offset:512
    v_mfma_f32_16x16x32_bf16 v[56:59], v[200:203], v[96:99], v[56:59]
    s_add_u32 m0, s43, 15872
    ds_read_b64_tr_b16 v[216:217], v31 offset:0
    v_mfma_f32_16x16x32_bf16 v[52:55], v[200:203], v[92:95], v[52:55]
    buffer_load_dwordx4 v6, s[8:11], s41 offen offset:512 sc1 lds
    ds_read_b64_tr_b16 v[218:219], v31 offset:512
    v_mfma_f32_16x16x32_bf16 v[60:63], v[204:207], v[92:95], v[60:63]
    s_add_u32 m0, s43, 19840
    ds_read_b64_tr_b16 v[220:221], v29 offset:4096
    v_mfma_f32_16x16x32_bf16 v[64:67], v[204:207], v[96:99], v[64:67]
    buffer_load_dwordx4 v6, s[8:11], s41 offen offset:640 sc1 lds
    ds_read_b64_tr_b16 v[222:223], v29 offset:4608
    v_mfma_f32_16x16x32_bf16 v[100:103], v[184:187], v[32:35], v[100:103]
    ds_read_b64_tr_b16 v[224:225], v30 offset:4096
    v_mfma_f32_16x16x32_bf16 v[104:107], v[188:191], v[32:35], v[104:107]
    ds_read_b64_tr_b16 v[226:227], v30 offset:4608
    v_mfma_f32_16x16x32_bf16 v[108:111], v[192:195], v[32:35], v[108:111]
    ds_read_b64_tr_b16 v[228:229], v31 offset:4096
    v_mfma_f32_16x16x32_bf16 v[100:103], v[196:199], v[32:35], v[100:103]
    ds_read_b64_tr_b16 v[230:231], v31 offset:4608
    v_mfma_f32_16x16x32_bf16 v[104:107], v[200:203], v[32:35], v[104:107]
    v_mfma_f32_16x16x32_bf16 v[108:111], v[204:207], v[32:35], v[108:111]
    v_add_u32 v29, 49152, v26
    v_add_u32 v30, 49152, v27
    v_add_u32 v31, 49152, v28
    s_waitcnt vmcnt(9) lgkmcnt(0)
    s_barrier
    v_mfma_f32_16x16x32_bf16 v[44:47], v[208:211], v[68:71], v[44:47]
    s_add_u32 m0, s43, 23808
    ds_read_b128 v[84:87], v4 offset:61440
    v_mfma_f32_16x16x32_bf16 v[48:51], v[208:211], v[72:75], v[48:51]
    buffer_load_dwordx4 v6, s[8:11], s41 offen offset:768 sc1 lds
    ds_read_b128 v[88:91], v4 offset:63488
    v_mfma_f32_16x16x32_bf16 v[56:59], v[212:215], v[72:75], v[56:59]
    s_add_u32 m0, s43, 27776
    ds_read_b128 v[92:95], v5 offset:61440
    v_mfma_f32_16x16x32_bf16 v[52:55], v[212:215], v[68:71], v[52:55]
    buffer_load_dwordx4 v6, s[8:11], s41 offen offset:896 sc1 lds
    ds_read_b128 v[96:99], v5 offset:63488
    v_mfma_f32_16x16x32_bf16 v[60:63], v[216:219], v[68:71], v[60:63]
    s_add_u32 m0, s43, 31744
    ds_read_b64_tr_b16 v[232:233], v29 offset:0
    v_mfma_f32_16x16x32_bf16 v[64:67], v[216:219], v[72:75], v[64:67]
    buffer_load_dwordx4 v6, s[8:11], s41 offen offset:1024 sc1 lds
    ds_read_b64_tr_b16 v[234:235], v29 offset:512
    v_mfma_f32_16x16x32_bf16 v[44:47], v[220:223], v[76:79], v[44:47]
    s_add_u32 m0, s43, 35712
    ds_read_b64_tr_b16 v[236:237], v30 offset:0
    v_mfma_f32_16x16x32_bf16 v[48:51], v[220:223], v[80:83], v[48:51]
    buffer_load_dwordx4 v6, s[8:11], s41 offen offset:1152 sc1 lds
    ds_read_b64_tr_b16 v[238:239], v30 offset:512
    v_mfma_f32_16x16x32_bf16 v[56:59], v[224:227], v[80:83], v[56:59]
    s_add_u32 m0, s43, 39680
    ds_read_b64_tr_b16 v[240:241], v31 offset:0
    v_mfma_f32_16x16x32_bf16 v[52:55], v[224:227], v[76:79], v[52:55]
    buffer_load_dwordx4 v6, s[8:11], s41 offen offset:1280 sc1 lds
    ds_read_b64_tr_b16 v[242:243], v31 offset:512
    v_mfma_f32_16x16x32_bf16 v[60:63], v[228:231], v[76:79], v[60:63]
    s_add_u32 m0, s43, 43648
    ds_read_b64_tr_b16 v[244:245], v29 offset:4096
    v_mfma_f32_16x16x32_bf16 v[64:67], v[228:231], v[80:83], v[64:67]
    buffer_load_dwordx4 v6, s[8:11], s41 offen offset:1408 sc1 lds
    ds_read_b64_tr_b16 v[246:247], v29 offset:4608
    v_mfma_f32_16x16x32_bf16 v[100:103], v[208:211], v[32:35], v[100:103]
    ds_read_b64_tr_b16 v[248:249], v30 offset:4096
    v_mfma_f32_16x16x32_bf16 v[104:107], v[212:215], v[32:35], v[104:107]
    ds_read_b64_tr_b16 v[250:251], v30 offset:4608
    v_mfma_f32_16x16x32_bf16 v[108:111], v[216:219], v[32:35], v[108:111]
    ds_read_b64_tr_b16 v[252:253], v31 offset:4096
    v_mfma_f32_16x16x32_bf16 v[100:103], v[220:223], v[32:35], v[100:103]
    ds_read_b64_tr_b16 v[254:255], v31 offset:4608
    v_mfma_f32_16x16x32_bf16 v[104:107], v[224:227], v[32:35], v[104:107]
    v_mfma_f32_16x16x32_bf16 v[108:111], v[228:231], v[32:35], v[108:111]
    s_waitcnt vmcnt(13) lgkmcnt(0)
    s_barrier
    v_mfma_f32_16x16x32_bf16 v[44:47], v[232:235], v[84:87], v[44:47]
    s_add_u32 m0, s43, 47616
    v_mfma_f32_16x16x32_bf16 v[48:51], v[232:235], v[88:91], v[48:51]
    buffer_load_dwordx4 v6, s[8:11], s41 offen offset:1536 sc1 lds
    v_mfma_f32_16x16x32_bf16 v[56:59], v[236:239], v[88:91], v[56:59]
    s_add_u32 m0, s43, 51584
    v_mfma_f32_16x16x32_bf16 v[52:55], v[236:239], v[84:87], v[52:55]
    buffer_load_dwordx4 v6, s[8:11], s41 offen offset:1664 sc1 lds
    v_mfma_f32_16x16x32_bf16 v[60:63], v[240:243], v[84:87], v[60:63]
    s_add_u32 m0, s43, 55552
    v_mfma_f32_16x16x32_bf16 v[64:67], v[240:243], v[88:91], v[64:67]
    buffer_load_dwordx4 v6, s[8:11], s41 offen offset:1792 sc1 lds
    v_mfma_f32_16x16x32_bf16 v[44:47], v[244:247], v[92:95], v[44:47]
    s_add_u32 m0, s43, 59520
    v_mfma_f32_16x16x32_bf16 v[48:51], v[244:247], v[96:99], v[48:51]
    buffer_load_dwordx4 v6, s[8:11], s41 offen offset:1920 sc1 lds
    v_mfma_f32_16x16x32_bf16 v[56:59], v[248:251], v[96:99], v[56:59]
    v_mfma_f32_16x16x32_bf16 v[52:55], v[248:251], v[92:95], v[52:55]
    v_mfma_f32_16x16x32_bf16 v[60:63], v[252:255], v[92:95], v[60:63]
    v_mfma_f32_16x16x32_bf16 v[64:67], v[252:255], v[96:99], v[64:67]
    v_mfma_f32_16x16x32_bf16 v[100:103], v[232:235], v[32:35], v[100:103]
    v_mfma_f32_16x16x32_bf16 v[104:107], v[236:239], v[32:35], v[104:107]
    v_mfma_f32_16x16x32_bf16 v[108:111], v[240:243], v[32:35], v[108:111]
    v_mfma_f32_16x16x32_bf16 v[100:103], v[244:247], v[32:35], v[100:103]
    v_mfma_f32_16x16x32_bf16 v[104:107], v[248:251], v[32:35], v[104:107]
    v_mfma_f32_16x16x32_bf16 v[108:111], v[252:255], v[32:35], v[108:111]
    s_mov_b32 s36, 0
    ds_read_b64 v[20:21], v13 offset:2048
    ds_read_b64 v[22:23], v13 offset:2176
    ds_read_b64 v[24:25], v13 offset:2304
    ds_read_b64 v[26:27], v13 offset:2432
    s_waitcnt lgkmcnt(0)
    v_add_f32 v28, v24, v26
    v_add_f32 v29, v25, v27
    v_add_f32 v20, v20, v22
    v_add_f32 v21, v21, v23
    v_add_f32 v20, v20, v28
    v_add_f32 v21, v21, v29
    v_mov_b32 v28, v20
    v_mov_b32 v29, v21
    s_nop 0
    v_permlane32_swap_b32 v20, v28
    v_permlane32_swap_b32 v21, v29
    v_add_f32 v20, v20, v28
    v_add_f32 v21, v21, v29
    v_mul_f32 v112, 0xba800000, v20
    v_mul_f32 v21, 0x3a800000, v21
    v_fma_f32 v21, -v112, v112, v21
    v_mov_b32 v113, v112
    v_max_f32 v21, 0, v21
    v_add_f32 v21, 0x3727c5ac, v21
    v_rsq_f32 v114, v21
    v_permlane16_swap_b32 v112, v113
    v_mov_b32 v115, v114
    s_nop 1
    v_permlane16_swap_b32 v114, v115
    s_cmp_eq_u32 s36, s97
    s_cselect_b32 s47, 31, -2
    s_cselect_b64 s[8:9], s[88:89], s[8:9]
    s_cselect_b32 s55, 0x543fc00, s55
    s_add_u32 s50, s50, s47
    s_max_i32 s47, s50, 0
    s_lshl_b32 s41, s47, 15
    s_lshl_b32 s46, s47, 10
    s_sub_u32 s46, s55, s46
    s_cmp_eq_u32 s36, 17
    s_cselect_b32 s49, s87, 0x10000
    s_add_u32 s90, s90, s49
    s_and_b32 s49, s90, 0xffffffff
    s_bitcmp1_b64 s[24:25], s36
    s_cselect_b32 s44, s49, 0x5e00000
    s_bitcmp1_b64 s[26:27], s36
    s_cselect_b64 s[62:63], 0, -1
    v_fmac_f32 v44, v112, v100
    v_fmac_f32 v45, v112, v101
    v_fmac_f32 v46, v112, v102
    v_fmac_f32 v47, v112, v103
    v_fmac_f32 v48, v113, v100
    v_fmac_f32 v49, v113, v101
    v_fmac_f32 v50, v113, v102
    v_fmac_f32 v51, v113, v103
    v_fmac_f32 v52, v112, v104
    v_fmac_f32 v53, v112, v105
    v_fmac_f32 v54, v112, v106
    v_fmac_f32 v55, v112, v107
    v_fmac_f32 v56, v113, v104
    v_fmac_f32 v57, v113, v105
    v_fmac_f32 v58, v113, v106
    v_fmac_f32 v59, v113, v107
    v_fmac_f32 v60, v112, v108
    v_fmac_f32 v61, v112, v109
    v_fmac_f32 v62, v112, v110
    v_fmac_f32 v63, v112, v111
    v_fmac_f32 v64, v113, v108
    v_fmac_f32 v65, v113, v109
    v_fmac_f32 v66, v113, v110
    v_fmac_f32 v67, v113, v111
    s_waitcnt vmcnt(0) lgkmcnt(0)
    s_barrier
    ds_read_b128 v[68:71], v2 offset:0
    ds_read_b128 v[72:75], v2 offset:2048
    ds_read_b128 v[76:79], v3 offset:0
    ds_read_b128 v[80:83], v3 offset:2048
    s_mov_b32 s36, 1
    s_waitcnt lgkmcnt(0)
    s_nop 7
L_q_b0:
    s_waitcnt lgkmcnt(2)
    v_mfma_f32_16x16x32_bf16 v[20:23], a[0:3], v[68:71], 0
    ds_read_b128 v[84:87], v2 offset:4096
    v_mul_f32 v44, v44, v114
    v_mfma_f32_16x16x32_bf16 v[24:27], a[0:3], v[72:75], 0
    v_mul_f32 v45, v45, v114
    v_mul_f32 v46, v46, v114
    v_mfma_f32_16x16x32_bf16 v[32:35], a[4:7], v[72:75], 0
    v_mul_f32 v47, v47, v114
    v_cvt_pk_bf16_f32 v44, v44, v45
    v_mfma_f32_16x16x32_bf16 v[28:31], a[4:7], v[68:71], 0
    ds_read_b128 v[88:91], v2 offset:6144
    v_cvt_pk_bf16_f32 v45, v46, v47
    v_mfma_f32_16x16x32_bf16 v[36:39], a[8:11], v[68:71], 0
    ds_write_b64 v7, v[44:45] offset:12288
    v_mfma_f32_16x16x32_bf16 v[40:43], a[8:11], v[72:75], 0
    s_waitcnt lgkmcnt(3)
    v_mul_f32 v48, v48, v115
    v_mul_f32 v49, v49, v115
    v_mfma_f32_16x16x32_bf16 v[20:23], a[12:15], v[76:79], v[20:23]
    ds_read_b128 v[92:95], v3 offset:4096
    v_mul_f32 v50, v50, v115
    v_mfma_f32_16x16x32_bf16 v[24:27], a[12:15], v[80:83], v[24:27]
    v_mul_f32 v51, v51, v115
    v_cvt_pk_bf16_f32 v48, v48, v49
    v_mfma_f32_16x16x32_bf16 v[32:35], a[16:19], v[80:83], v[32:35]
    v_cvt_pk_bf16_f32 v49, v50, v51
    v_mfma_f32_16x16x32_bf16 v[28:31], a[16:19], v[76:79], v[28:31]
    ds_read_b128 v[96:99], v3 offset:6144
    v_mfma_f32_16x16x32_bf16 v[36:39], a[20:23], v[76:79], v[36:39]
    ds_write_b64 v7, v[48:49] offset:18432
    v_mfma_f32_16x16x32_bf16 v[40:43], a[20:23], v[80:83], v[40:43]
    s_waitcnt lgkmcnt(4)
    v_mul_f32 v52, v52, v114
    v_mul_f32 v53, v53, v114
    v_mfma_f32_16x16x32_bf16 v[20:23], a[24:27], v[84:87], v[20:23]
    ds_read_b128 v[68:71], v2 offset:8192
    v_mul_f32 v54, v54, v114
    v_mfma_f32_16x16x32_bf16 v[24:27], a[24:27], v[88:91], v[24:27]
    v_mul_f32 v55, v55, v114
    v_cvt_pk_bf16_f32 v52, v52, v53
    v_mfma_f32_16x16x32_bf16 v[32:35], a[28:31], v[88:91], v[32:35]
    v_cvt_pk_bf16_f32 v53, v54, v55
    v_mfma_f32_16x16x32_bf16 v[28:31], a[28:31], v[84:87], v[28:31]
    ds_read_b128 v[72:75], v2 offset:10240
    v_mfma_f32_16x16x32_bf16 v[36:39], a[32:35], v[84:87], v[36:39]
    ds_write_b64 v7, v[52:53] offset:13312
    v_mfma_f32_16x16x32_bf16 v[40:43], a[32:35], v[88:91], v[40:43]
    s_waitcnt lgkmcnt(4)
    v_mul_f32 v56, v56, v115
    v_mul_f32 v57, v57, v115
    v_mfma_f32_16x16x32_bf16 v[20:23], a[36:39], v[92:95], v[20:23]
    ds_read_b128 v[76:79], v3 offset:8192
    v_mul_f32 v58, v58, v115
    v_mfma_f32_16x16x32_bf16 v[24:27], a[36:39], v[96:99], v[24:27]
    v_mul_f32 v59, v59, v115
    v_cvt_pk_bf16_f32 v56, v56, v57
    v_mfma_f32_16x16x32_bf16 v[32:35], a[40:43], v[96:99], v[32:35]
    v_cvt_pk_bf16_f32 v57, v58, v59
    v_mfma_f32_16x16x32_bf16 v[28:31], a[40:43], v[92:95], v[28:31]
    ds_read_b128 v[80:83], v3 offset:10240
    v_mfma_f32_16x16x32_bf16 v[36:39], a[44:47], v[92:95], v[36:39]
    ds_write_b64 v7, v[56:57] offset:19456
    v_mfma_f32_16x16x32_bf16 v[40:43], a[44:47], v[96:99], v[40:43]
    s_waitcnt lgkmcnt(4)
    v_mul_f32 v60, v60, v114
    v_mul_f32 v61, v61, v114
    v_mfma_f32_16x16x32_bf16 v[20:23], a[48:51], v[68:71], v[20:23]
    s_waitcnt vmcnt(1)
    ds_read_b128 v[84:87], v2 offset:12288
    v_cmp_ne_u32 vcc, 0, v116
    v_mfma_f32_16x16x32_bf16 v[24:27], a[48:51], v[72:75], v[24:27]
    v_mul_f32 v62, v62, v114
    v_mul_f32 v63, v63, v114
    v_mfma_f32_16x16x32_bf16 v[32:35], a[52:55], v[72:75], v[32:35]
    s_cbranch_vccnz L_spin3
L_back4:
    v_cvt_pk_bf16_f32 v60, v60, v61
    v_cvt_pk_bf16_f32 v61, v62, v63
    v_mfma_f32_16x16x32_bf16 v[28:31], a[52:55], v[68:71], v[28:31]
    ds_read_b128 v[88:91], v2 offset:14336
    v_mfma_f32_16x16x32_bf16 v[36:39], a[56:59], v[68:71], v[36:39]
    ds_write_b64 v8, v[60:61] offset:14336
    v_mfma_f32_16x16x32_bf16 v[40:43], a[56:59], v[72:75], v[40:43]
    s_waitcnt lgkmcnt(4)
    v_mul_f32 v64, v64, v115
    v_mul_f32 v65, v65, v115
    v_mfma_f32_16x16x32_bf16 v[20:23], a[60:63], v[76:79], v[20:23]
    ds_read_b128 v[92:95], v3 offset:12288
    v_mul_f32 v66, v66, v115
    v_mfma_f32_16x16x32_bf16 v[24:27], a[60:63], v[80:83], v[24:27]
    v_mul_f32 v67, v67, v115
    v_cvt_pk_bf16_f32 v64, v64, v65
    v_mfma_f32_16x16x32_bf16 v[32:35], a[64:67], v[80:83], v[32:35]
    v_cvt_pk_bf16_f32 v65, v66, v67
    v_mfma_f32_16x16x32_bf16 v[28:31], a[64:67], v[76:79], v[28:31]
    ds_read_b128 v[96:99], v3 offset:14336
    v_mfma_f32_16x16x32_bf16 v[36:39], a[68:71], v[76:79], v[36:39]
    ds_write_b64 v8, v[64:65] offset:20480
    v_mfma_f32_16x16x32_bf16 v[40:43], a[68:71], v[80:83], v[40:43]
    s_waitcnt lgkmcnt(4)
    s_waitcnt lgkmcnt(0)
    s_barrier
    v_mfma_f32_16x16x32_bf16 v[20:23], a[72:75], v[84:87], v[20:23]
    ds_read_b128 v[68:71], v2 offset:16384
    v_mfma_f32_16x16x32_bf16 v[24:27], a[72:75], v[88:91], v[24:27]
    ds_read_b128 v[44:47], v9 offset:6144
    v_mfma_f32_16x16x32_bf16 v[32:35], a[76:79], v[88:91], v[32:35]
    ds_read_b128 v[48:51], v9 offset:13312
    v_mfma_f32_16x16x32_bf16 v[28:31], a[76:79], v[84:87], v[28:31]
    ds_read_b128 v[72:75], v2 offset:18432
    v_mfma_f32_16x16x32_bf16 v[36:39], a[80:83], v[84:87], v[36:39]
    ds_read_b128 v[52:55], v9 offset:7168
    s_add_u32 m0, s43, 98304
    v_mfma_f32_16x16x32_bf16 v[40:43], a[80:83], v[88:91], v[40:43]
    s_waitcnt lgkmcnt(6)
    ds_read_b64_tr_b16 v[56:57], v9 offset:14336
    v_mfma_f32_16x16x32_bf16 v[20:23], a[84:87], v[92:95], v[20:23]
    ds_read_b128 v[76:79], v3 offset:16384
    v_mfma_f32_16x16x32_bf16 v[24:27], a[84:87], v[96:99], v[24:27]
    buffer_load_dwordx4 v6, s[8:11], s41 offen offset:0 sc1 lds
    v_mfma_f32_16x16x32_bf16 v[32:35], a[88:91], v[96:99], v[32:35]
    s_add_u32 m0, s43, 102272
    ds_read_b64_tr_b16 v[58:59], v9 offset:8192
    s_waitcnt lgkmcnt(3)
    v_mfma_f32_16x16x32_bf16 v[28:31], a[88:91], v[92:95], v[28:31]
    ds_read_b128 v[80:83], v3 offset:18432
    v_mfma_f32_16x16x32_bf16 v[64:67], v[48:51], v[44:47], 0
    ds_read_b64_tr_b16 v[60:61], v9 offset:14344
    v_mfma_f32_16x16x32_bf16 v[118:121], v[52:55], v[44:47], 0
    ds_read_b64_tr_b16 v[62:63], v9 offset:8200
    v_mfma_f32_16x16x32_bf16 v[36:39], a[92:95], v[92:95], v[36:39]
    v_mfma_f32_16x16x32_bf16 v[40:43], a[92:95], v[96:99], v[40:43]
    s_waitcnt lgkmcnt(7)
    v_cndmask_b32 v64, v64, v65, s[56:57]
    v_cndmask_b32 v66, v66, v67, s[56:57]
    v_mfma_f32_16x16x32_bf16 v[20:23], a[96:99], v[68:71], v[20:23]
    ds_read_b128 v[84:87], v2 offset:20480
    v_cndmask_b32 v118, v118, v119, s[56:57]
    v_mfma_f32_16x16x32_bf16 v[24:27], a[96:99], v[72:75], v[24:27]
    buffer_load_dwordx4 v6, s[8:11], s41 offen offset:128 sc1 lds
    v_mfma_f32_16x16x32_bf16 v[32:35], a[100:103], v[72:75], v[32:35]
    s_add_u32 m0, s43, 106240
    v_cndmask_b32 v120, v120, v121, s[56:57]
    v_cndmask_b32 v64, v18, v64, s[62:63]
    v_mfma_f32_16x16x32_bf16 v[28:31], a[100:103], v[68:71], v[28:31]
    ds_read_b128 v[88:91], v2 offset:22528
    v_cndmask_b32 v66, v18, v66, s[62:63]
    v_mfma_f32_16x16x32_bf16 v[36:39], a[104:107], v[68:71], v[36:39]
    v_cndmask_b32 v46, v64, v118, s[58:59]
    v_cndmask_b32 v47, v66, v120, s[60:61]
    v_mfma_f32_16x16x32_bf16 v[40:43], a[104:107], v[72:75], v[40:43]
    s_waitcnt lgkmcnt(4)
    v_max_f32 v44, v46, v47
    v_mov_b32 v45, v44
    v_mfma_f32_16x16x32_bf16 v[20:23], a[108:111], v[76:79], v[20:23]
    ds_read_b128 v[92:95], v3 offset:20480
    v_mfma_f32_16x16x32_bf16 v[24:27], a[108:111], v[80:83], v[24:27]
    buffer_load_dwordx4 v6, s[8:11], s41 offen offset:256 sc1 lds
    v_mfma_f32_16x16x32_bf16 v[32:35], a[112:115], v[80:83], v[32:35]
    s_add_u32 m0, s43, 110208
    v_permlane16_swap_b32 v44, v45
    v_mfma_f32_16x16x32_bf16 v[28:31], a[112:115], v[76:79], v[28:31]
    ds_read_b128 v[96:99], v3 offset:22528
    v_max_f32 v44, v44, v45
    v_mfma_f32_16x16x32_bf16 v[36:39], a[116:119], v[76:79], v[36:39]
    v_mov_b32 v45, v44
    v_mfma_f32_16x16x32_bf16 v[40:43], a[116:119], v[80:83], v[40:43]
    s_waitcnt lgkmcnt(2)
    v_permlane32_swap_b32 v44, v45
    v_mfma_f32_16x16x32_bf16 v[20:23], a[120:123], v[84:87], v[20:23]
    ds_read_b128 v[68:71], v2 offset:24576
    v_max_f32 v44, v44, v45
    v_mfma_f32_16x16x32_bf16 v[24:27], a[120:123], v[88:91], v[24:27]
    buffer_load_dwordx4 v6, s[8:11], s41 offen offset:384 sc1 lds
    v_mfma_f32_16x16x32_bf16 v[32:35], a[124:127], v[88:91], v[32:35]
    s_add_u32 m0, s43, 114176
    v_mul_f32 v44, s86, v44
    v_fma_f32 v46, v46, s86, -v44
    v_mfma_f32_16x16x32_bf16 v[28:31], a[124:127], v[84:87], v[28:31]
    ds_read_b128 v[72:75], v2 offset:26624
    v_fma_f32 v47, v47, s86, -v44
    v_mfma_f32_16x16x32_bf16 v[36:39], a[128:131], v[84:87], v[36:39]
    v_exp_f32 v46, v46
    v_mfma_f32_16x16x32_bf16 v[40:43], a[128:131], v[88:91], v[40:43]
    s_waitcnt lgkmcnt(2)
    v_exp_f32 v47, v47
    v_mfma_f32_16x16x32_bf16 v[20:23], a[132:135], v[92:95], v[20:23]
    ds_read_b128 v[76:79], v3 offset:24576
    v_cvt_pk_bf16_f32 v52, v46, v47
    v_mfma_f32_16x16x32_bf16 v[24:27], a[132:135], v[96:99], v[24:27]
    buffer_load_dwordx4 v6, s[8:11], s41 offen offset:512 sc1 lds
    v_mfma_f32_16x16x32_bf16 v[32:35], a[136:139], v[96:99], v[32:35]
    s_add_u32 m0, s43, 118144
    v_perm_b32 v48, v52, v52, v14
    v_perm_b32 v49, v52, v52, v15
    v_mfma_f32_16x16x32_bf16 v[28:31], a[136:139], v[92:95], v[28:31]
    ds_read_b128 v[80:83], v3 offset:26624
    v_perm_b32 v50, v52, v52, v16
    v_mfma_f32_16x16x32_bf16 v[36:39], a[140:143], v[92:95], v[36:39]
    v_perm_b32 v51, v52, v52, v17
    v_add_f32 v44, v46, v47
    v_mfma_f32_16x16x32_bf16 v[40:43], a[140:143], v[96:99], v[40:43]
    s_waitcnt lgkmcnt(2)
    v_mov_b32 v45, v44
    s_waitcnt lgkmcnt(8)
    v_mfma_f32_16x16x32_bf16 v[20:23], a[144:147], v[68:71], v[20:23]
    ds_read_b128 v[84:87], v2 offset:28672
    v_mfma_f32_16x16x32_bf16 v[64:67], v[56:59], v[48:51], 0
    v_mfma_f32_16x16x32_bf16 v[118:121], v[60:63], v[48:51], 0
    v_permlane16_swap_b32 v44, v45
    v_mfma_f32_16x16x32_bf16 v[24:27], a[144:147], v[72:75], v[24:27]
    buffer_load_dwordx4 v6, s[8:11], s41 offen offset:640 sc1 lds
    v_mfma_f32_16x16x32_bf16 v[32:35], a[148:151], v[72:75], v[32:35]
    s_add_u32 m0, s43, 122112
    v_add_f32 v44, v44, v45
    v_mov_b32 v45, v44
    v_mfma_f32_16x16x32_bf16 v[28:31], a[148:151], v[68:71], v[28:31]
    ds_read_b128 v[88:91], v2 offset:30720
    v_mfma_f32_16x16x32_bf16 v[36:39], a[152:155], v[68:71], v[36:39]
    v_permlane32_swap_b32 v44, v45
    v_mfma_f32_16x16x32_bf16 v[40:43], a[152:155], v[72:75], v[40:43]
    s_waitcnt lgkmcnt(2)
    v_add_f32 v44, v44, v45
    v_mfma_f32_16x16x32_bf16 v[20:23], a[156:159], v[76:79], v[20:23]
    ds_read_b128 v[92:95], v3 offset:28672
    v_mfma_f32_16x16x32_bf16 v[24:27], a[156:159], v[80:83], v[24:27]
    buffer_load_dwordx4 v6, s[8:11], s41 offen offset:768 sc1 lds
    v_mfma_f32_16x16x32_bf16 v[32:35], a[160:163], v[80:83], v[32:35]
    s_add_u32 m0, s43, 126080
    v_rcp_f32 v44, v44
    v_mfma_f32_16x16x32_bf16 v[28:31], a[160:163], v[76:79], v[28:31]
    ds_read_b128 v[96:99], v3 offset:30720
    v_mul_f32 v64, v64, v44
    v_mfma_f32_16x16x32_bf16 v[36:39], a[164:167], v[76:79], v[36:39]
    v_mul_f32 v65, v65, v44
    v_mul_f32 v66, v66, v44
    v_mfma_f32_16x16x32_bf16 v[40:43], a[164:167], v[80:83], v[40:43]
    s_waitcnt lgkmcnt(2)
    v_mul_f32 v67, v67, v44
    v_cvt_pk_bf16_f32 v52, v64, v65
    v_mfma_f32_16x16x32_bf16 v[20:23], a[168:171], v[84:87], v[20:23]
    ds_read_b128 v[68:71], v2 offset:32768
    v_cvt_pk_bf16_f32 v53, v66, v67
    v_mfma_f32_16x16x32_bf16 v[24:27], a[168:171], v[88:91], v[24:27]
    buffer_load_dwordx4 v6, s[8:11], s41 offen offset:896 sc1 lds
    v_mfma_f32_16x16x32_bf16 v[32:35], a[172:175], v[88:91], v[32:35]
    s_add_u32 m0, s43, 130048
    v_mul_f32 v118, v118, v44
    v_mul_f32 v119, v119, v44
    v_mfma_f32_16x16x32_bf16 v[28:31], a[172:175], v[84:87], v[28:31]
    ds_read_b128 v[72:75], v2 offset:34816
    v_mul_f32 v120, v120, v44
    v_mfma_f32_16x16x32_bf16 v[36:39], a[176:179], v[84:87], v[36:39]
    v_mul_f32 v121, v121, v44
    v_cvt_pk_bf16_f32 v54, v118, v119
    v_mfma_f32_16x16x32_bf16 v[40:43], a[176:179], v[88:91], v[40:43]
    s_waitcnt lgkmcnt(2)
    v_cvt_pk_bf16_f32 v55, v120, v121
    v_mfma_f32_16x16x32_bf16 v[20:23], a[180:183], v[92:95], v[20:23]
    ds_read_b128 v[76:79], v3 offset:32768
    v_mfma_f32_16x16x32_bf16 v[24:27], a[180:183], v[96:99], v[24:27]
    buffer_load_dwordx4 v6, s[8:11], s41 offen offset:1024 sc1 lds
    v_mfma_f32_16x16x32_bf16 v[32:35], a[184:187], v[96:99], v[32:35]
    buffer_store_dwordx4 v[52:55], v1, s[16:19], s44 offen sc1
    v_mfma_f32_16x16x32_bf16 v[28:31], a[184:187], v[92:95], v[28:31]
    s_add_u32 m0, s43, 134016
    ds_read_b128 v[80:83], v3 offset:34816
    s_cmp_eq_u32 s36, 17
    v_mfma_f32_16x16x32_bf16 v[36:39], a[188:191], v[92:95], v[36:39]
    s_cselect_b32 s49, s87, 0x10000
    ds_read_b64 v[56:57], v13 offset:0
    s_add_u32 s90, s90, s49
    v_mfma_f32_16x16x32_bf16 v[40:43], a[188:191], v[96:99], v[40:43]
    s_waitcnt lgkmcnt(3)
    ds_read_b64 v[58:59], v13 offset:128
    s_and_b32 s49, s90, 0xffffffff
    v_mfma_f32_16x16x32_bf16 v[20:23], a[192:195], v[68:71], v[20:23]
    s_bitcmp1_b64 s[24:25], s36
    ds_read_b128 v[84:87], v2 offset:36864
    s_cselect_b32 s44, s49, 0x5e00000
    v_mfma_f32_16x16x32_bf16 v[24:27], a[192:195], v[72:75], v[24:27]
    buffer_load_dwordx4 v6, s[8:11], s41 offen offset:1152 sc1 lds
    v_mfma_f32_16x16x32_bf16 v[32:35], a[196:199], v[72:75], v[32:35]
    s_add_u32 m0, s43, 137984
    ds_read_b64 v[60:61], v13 offset:256
    s_bitcmp1_b64 s[26:27], s36
    v_mfma_f32_16x16x32_bf16 v[28:31], a[196:199], v[68:71], v[28:31]
    s_cselect_b64 s[62:63], 0, -1
    ds_read_b128 v[88:91], v2 offset:38912
    v_mfma_f32_16x16x32_bf16 v[36:39], a[200:203], v[68:71], v[36:39]
    ds_read_b64 v[62:63], v13 offset:384
    v_mfma_f32_16x16x32_bf16 v[40:43], a[200:203], v[72:75], v[40:43]
    s_waitcnt lgkmcnt(6)
    v_mfma_f32_16x16x32_bf16 v[20:23], a[204:207], v[76:79], v[20:23]
    ds_read_b128 v[92:95], v3 offset:36864
    v_mfma_f32_16x16x32_bf16 v[24:27], a[204:207], v[80:83], v[24:27]
    buffer_load_dwordx4 v6, s[8:11], s41 offen offset:1280 sc1 lds
    v_mfma_f32_16x16x32_bf16 v[32:35], a[208:211], v[80:83], v[32:35]
    s_add_u32 m0, s43, 141952
    v_mfma_f32_16x16x32_bf16 v[28:31], a[208:211], v[76:79], v[28:31]
    s_waitcnt lgkmcnt(1)
    ds_read_b128 v[96:99], v3 offset:38912
    v_add_f32 v64, v60, v62
    v_mfma_f32_16x16x32_bf16 v[36:39], a[212:215], v[76:79], v[36:39]
    v_add_f32 v65, v61, v63
    v_add_f32 v56, v56, v58
    v_mfma_f32_16x16x32_bf16 v[40:43], a[212:215], v[80:83], v[40:43]
    s_waitcnt lgkmcnt(3)
    v_add_f32 v57, v57, v59
    v_add_f32 v56, v56, v64
    v_mfma_f32_16x16x32_bf16 v[20:23], a[216:219], v[84:87], v[20:23]
    ds_read_b128 v[68:71], v2 offset:40960
    v_add_f32 v57, v57, v65
    v_mfma_f32_16x16x32_bf16 v[24:27], a[216:219], v[88:91], v[24:27]
    buffer_load_dwordx4 v6, s[8:11], s41 offen offset:1408 sc1 lds
    v_mfma_f32_16x16x32_bf16 v[32:35], a[220:223], v[88:91], v[32:35]
    s_add_u32 m0, s43, 145920
    v_mov_b32 v64, v56
    v_mov_b32 v65, v57
    v_mfma_f32_16x16x32_bf16 v[28:31], a[220:223], v[84:87], v[28:31]
    ds_read_b128 v[72:75], v2 offset:43008
    v_mfma_f32_16x16x32_bf16 v[36:39], a[224:227], v[84:87], v[36:39]
    v_permlane32_swap_b32 v56, v64
    v_mfma_f32_16x16x32_bf16 v[40:43], a[224:227], v[88:91], v[40:43]
    s_waitcnt lgkmcnt(2)
    v_permlane32_swap_b32 v57, v65
    v_mfma_f32_16x16x32_bf16 v[20:23], a[228:231], v[92:95], v[20:23]
    ds_read_b128 v[76:79], v3 offset:40960
    v_add_f32 v56, v56, v64
    v_mfma_f32_16x16x32_bf16 v[24:27], a[228:231], v[96:99], v[24:27]
    buffer_load_dwordx4 v6, s[8:11], s41 offen offset:1536 sc1 lds
    v_mfma_f32_16x16x32_bf16 v[32:35], a[232:235], v[96:99], v[32:35]
    s_add_u32 m0, s43, 149888
    v_add_f32 v57, v57, v65
    v_mul_f32 v112, 0xba800000, v56
    v_mfma_f32_16x16x32_bf16 v[28:31], a[232:235], v[92:95], v[28:31]
    ds_read_b128 v[80:83], v3 offset:43008
    v_mul_f32 v57, 0x3a800000, v57
    v_mfma_f32_16x16x32_bf16 v[36:39], a[236:239], v[92:95], v[36:39]
    v_fma_f32 v57, -v112, v112, v57
    v_mov_b32 v113, v112
    v_mfma_f32_16x16x32_bf16 v[40:43], a[236:239], v[96:99], v[40:43]
    s_waitcnt lgkmcnt(2)
    v_max_f32 v57, 0, v57
    v_add_f32 v57, 0x3727c5ac, v57
    v_mfma_f32_16x16x32_bf16 v[20:23], a[240:243], v[68:71], v[20:23]
    ds_read_b128 v[84:87], v2 offset:45056
    v_mfma_f32_16x16x32_bf16 v[24:27], a[240:243], v[72:75], v[24:27]
    buffer_load_dwordx4 v6, s[8:11], s41 offen offset:1664 sc1 lds
    v_mfma_f32_16x16x32_bf16 v[32:35], a[244:247], v[72:75], v[32:35]
    s_add_u32 m0, s43, 153856
    v_rsq_f32 v114, v57
    v_mfma_f32_16x16x32_bf16 v[28:31], a[244:247], v[68:71], v[28:31]
    ds_read_b128 v[88:91], v2 offset:47104
    v_mfma_f32_16x16x32_bf16 v[36:39], a[248:251], v[68:71], v[36:39]
    v_permlane16_swap_b32 v112, v113
    v_mfma_f32_16x16x32_bf16 v[40:43], a[248:251], v[72:75], v[40:43]
    s_waitcnt lgkmcnt(2)
    v_mov_b32 v115, v114
    v_fmac_f32 v24, v113, v100
    v_mfma_f32_16x16x32_bf16 v[20:23], a[252:255], v[76:79], v[20:23]
    ds_read_b128 v[92:95], v3 offset:45056
    v_fmac_f32 v28, v112, v104
    v_mfma_f32_16x16x32_bf16 v[24:27], a[252:255], v[80:83], v[24:27]
    buffer_load_dwordx4 v6, s[8:11], s41 offen offset:1792 sc1 lds
    v_mfma_f32_16x16x32_bf16 v[32:35], v[128:131], v[80:83], v[32:35]
    s_add_u32 m0, s43, 157824
    v_permlane16_swap_b32 v114, v115
    v_mfma_f32_16x16x32_bf16 v[28:31], v[128:131], v[76:79], v[28:31]
    ds_read_b128 v[96:99], v3 offset:47104
    v_fmac_f32 v20, v112, v100
    v_mfma_f32_16x16x32_bf16 v[36:39], v[132:135], v[76:79], v[36:39]
    v_fmac_f32 v21, v112, v101
    v_fmac_f32 v22, v112, v102
    v_mfma_f32_16x16x32_bf16 v[40:43], v[132:135], v[80:83], v[40:43]
    s_waitcnt lgkmcnt(2)
    v_fmac_f32 v25, v113, v101
    v_fmac_f32 v26, v113, v102
    v_mfma_f32_16x16x32_bf16 v[20:23], v[136:139], v[84:87], v[20:23]
    ds_read_b128 v[68:71], v2 offset:49152
    v_fmac_f32 v29, v112, v105
    v_mfma_f32_16x16x32_bf16 v[24:27], v[136:139], v[88:91], v[24:27]
    buffer_load_dwordx4 v6, s[8:11], s41 offen offset:1920 sc1 lds
    v_mfma_f32_16x16x32_bf16 v[32:35], v[140:143], v[88:91], v[32:35]
    s_add_u32 m0, s52, 92160
    v_fmac_f32 v23, v112, v103
    v_fmac_f32 v36, v112, v108
    v_mfma_f32_16x16x32_bf16 v[28:31], v[140:143], v[84:87], v[28:31]
    ds_read_b128 v[72:75], v2 offset:51200
    v_fmac_f32 v27, v113, v103
    v_mfma_f32_16x16x32_bf16 v[36:39], v[144:147], v[84:87], v[36:39]
    v_fmac_f32 v32, v113, v104
    v_fmac_f32 v33, v113, v105
    v_mfma_f32_16x16x32_bf16 v[40:43], v[144:147], v[88:91], v[40:43]
    s_waitcnt lgkmcnt(2)
    v_fmac_f32 v30, v112, v106
    v_fmac_f32 v31, v112, v107
    v_mfma_f32_16x16x32_bf16 v[20:23], v[148:151], v[92:95], v[20:23]
    ds_read_b128 v[76:79], v3 offset:49152
    v_fmac_f32 v34, v113, v106
    v_mfma_f32_16x16x32_bf16 v[24:27], v[148:151], v[96:99], v[24:27]
    buffer_load_dwordx4 v1, s[16:19], s46 offen sc1 lds
    v_mfma_f32_16x16x32_bf16 v[32:35], v[152:155], v[96:99], v[32:35]
    s_cmp_eq_u32 s36, s97
    v_med3_i32 v117, s45, 0, v12
    v_add_u32 v117, v117, v11
    v_mfma_f32_16x16x32_bf16 v[28:31], v[152:155], v[92:95], v[28:31]
    s_cselect_b32 s47, 31, -2
    ds_read_b128 v[80:83], v3 offset:51200
    v_fmac_f32 v40, v113, v108
    v_mfma_f32_16x16x32_bf16 v[36:39], v[156:159], v[92:95], v[36:39]
    s_cselect_b64 s[8:9], s[88:89], s[8:9]
    v_fmac_f32 v35, v113, v107
    s_cselect_b32 s55, 0x543fc00, s55
    v_mfma_f32_16x16x32_bf16 v[40:43], v[156:159], v[96:99], v[40:43]
    s_waitcnt lgkmcnt(2)
    s_add_u32 s45, s45, 131072
    s_add_u32 s50, s50, s47
    v_mfma_f32_16x16x32_bf16 v[20:23], v[160:163], v[68:71], v[20:23]
    s_max_i32 s47, s50, 0
    ds_read_b128 v[84:87], v2 offset:53248
    v_fmac_f32 v37, v112, v109
    v_mfma_f32_16x16x32_bf16 v[24:27], v[160:163], v[72:75], v[24:27]
    buffer_load_dword v116, v117, s[16:19], 0 offen sc1
    v_mfma_f32_16x16x32_bf16 v[32:35], v[164:167], v[72:75], v[32:35]
    s_lshl_b32 s41, s47, 15
    v_fmac_f32 v38, v112, v110
    v_fmac_f32 v39, v112, v111
    v_mfma_f32_16x16x32_bf16 v[28:31], v[164:167], v[68:71], v[28:31]
    s_lshl_b32 s46, s47, 10
    ds_read_b128 v[88:91], v2 offset:55296
    v_fmac_f32 v41, v113, v109
    v_mfma_f32_16x16x32_bf16 v[36:39], v[168:171], v[68:71], v[36:39]
    s_sub_u32 s46, s55, s46
    v_mfma_f32_16x16x32_bf16 v[40:43], v[168:171], v[72:75], v[40:43]
    s_waitcnt lgkmcnt(2)
    v_mfma_f32_16x16x32_bf16 v[20:23], v[172:175], v[76:79], v[20:23]
    ds_read_b128 v[92:95], v3 offset:53248
    v_mfma_f32_16x16x32_bf16 v[24:27], v[172:175], v[80:83], v[24:27]
    v_mfma_f32_16x16x32_bf16 v[32:35], v[176:179], v[80:83], v[32:35]
    v_fmac_f32 v42, v113, v110
    v_fmac_f32 v43, v113, v111
    v_mfma_f32_16x16x32_bf16 v[28:31], v[176:179], v[76:79], v[28:31]
    ds_read_b128 v[96:99], v3 offset:55296
    v_mfma_f32_16x16x32_bf16 v[36:39], v[180:183], v[76:79], v[36:39]
    v_mfma_f32_16x16x32_bf16 v[40:43], v[180:183], v[80:83], v[40:43]
    s_waitcnt lgkmcnt(2)
    v_mfma_f32_16x16x32_bf16 v[20:23], v[184:187], v[84:87], v[20:23]
    ds_read_b128 v[68:71], v2 offset:57344
    v_mfma_f32_16x16x32_bf16 v[24:27], v[184:187], v[88:91], v[24:27]
    v_mfma_f32_16x16x32_bf16 v[32:35], v[188:191], v[88:91], v[32:35]
    v_mfma_f32_16x16x32_bf16 v[28:31], v[188:191], v[84:87], v[28:31]
    ds_read_b128 v[72:75], v2 offset:59392
    v_mfma_f32_16x16x32_bf16 v[36:39], v[192:195], v[84:87], v[36:39]
    v_mfma_f32_16x16x32_bf16 v[40:43], v[192:195], v[88:91], v[40:43]
    s_waitcnt lgkmcnt(2)
    v_mfma_f32_16x16x32_bf16 v[20:23], v[196:199], v[92:95], v[20:23]
    ds_read_b128 v[76:79], v3 offset:57344
    v_mfma_f32_16x16x32_bf16 v[24:27], v[196:199], v[96:99], v[24:27]
    v_mfma_f32_16x16x32_bf16 v[32:35], v[200:203], v[96:99], v[32:35]
    v_mfma_f32_16x16x32_bf16 v[28:31], v[200:203], v[92:95], v[28:31]
    ds_read_b128 v[80:83], v3 offset:59392
    v_mfma_f32_16x16x32_bf16 v[36:39], v[204:207], v[92:95], v[36:39]
    s_waitcnt vmcnt(9)
    s_barrier
    v_mfma_f32_16x16x32_bf16 v[40:43], v[204:207], v[96:99], v[40:43]
    s_waitcnt lgkmcnt(2)
    v_mfma_f32_16x16x32_bf16 v[20:23], v[208:211], v[68:71], v[20:23]
    ds_read_b128 v[84:87], v2 offset:61440
    v_mfma_f32_16x16x32_bf16 v[24:27], v[208:211], v[72:75], v[24:27]
    buffer_store_dword v124, v124, s[16:19], s91 offen sc1
    v_mfma_f32_16x16x32_bf16 v[32:35], v[212:215], v[72:75], v[32:35]
    s_add_u32 s91, s91, 131072
    v_mfma_f32_16x16x32_bf16 v[28:31], v[212:215], v[68:71], v[28:31]
    ds_read_b128 v[88:91], v2 offset:63488
    v_mfma_f32_16x16x32_bf16 v[36:39], v[216:219], v[68:71], v[36:39]
    v_mfma_f32_16x16x32_bf16 v[40:43], v[216:219], v[72:75], v[40:43]
    s_waitcnt lgkmcnt(2)
    v_mfma_f32_16x16x32_bf16 v[20:23], v[220:223], v[76:79], v[20:23]
    ds_read_b128 v[92:95], v3 offset:61440
    v_mfma_f32_16x16x32_bf16 v[24:27], v[220:223], v[80:83], v[24:27]
    v_mfma_f32_16x16x32_bf16 v[32:35], v[224:227], v[80:83], v[32:35]
    v_mfma_f32_16x16x32_bf16 v[28:31], v[224:227], v[76:79], v[28:31]
    ds_read_b128 v[96:99], v3 offset:63488
    v_mfma_f32_16x16x32_bf16 v[36:39], v[228:231], v[76:79], v[36:39]
    v_mfma_f32_16x16x32_bf16 v[40:43], v[228:231], v[80:83], v[40:43]
    s_waitcnt lgkmcnt(2)
    v_mfma_f32_16x16x32_bf16 v[20:23], v[232:235], v[84:87], v[20:23]
    ds_read_b128 v[68:71], v4 offset:0
    v_mfma_f32_16x16x32_bf16 v[24:27], v[232:235], v[88:91], v[24:27]
    v_mfma_f32_16x16x32_bf16 v[32:35], v[236:239], v[88:91], v[32:35]
    v_mfma_f32_16x16x32_bf16 v[28:31], v[236:239], v[84:87], v[28:31]
    ds_read_b128 v[72:75], v4 offset:2048
    v_mfma_f32_16x16x32_bf16 v[36:39], v[240:243], v[84:87], v[36:39]
    v_mfma_f32_16x16x32_bf16 v[40:43], v[240:243], v[88:91], v[40:43]
    s_waitcnt lgkmcnt(2)
    v_mfma_f32_16x16x32_bf16 v[20:23], v[244:247], v[92:95], v[20:23]
    ds_read_b128 v[76:79], v5 offset:0
    v_mfma_f32_16x16x32_bf16 v[24:27], v[244:247], v[96:99], v[24:27]
    v_mfma_f32_16x16x32_bf16 v[32:35], v[248:251], v[96:99], v[32:35]
    v_mfma_f32_16x16x32_bf16 v[28:31], v[248:251], v[92:95], v[28:31]
    ds_read_b128 v[80:83], v5 offset:2048
    v_mfma_f32_16x16x32_bf16 v[36:39], v[252:255], v[92:95], v[36:39]
    v_mfma_f32_16x16x32_bf16 v[40:43], v[252:255], v[96:99], v[40:43]
    s_add_u32 s36, s36, 1
L_q_b1:
    s_waitcnt lgkmcnt(2)
    v_mfma_f32_16x16x32_bf16 v[44:47], a[0:3], v[68:71], 0
    ds_read_b128 v[84:87], v4 offset:4096
    v_mul_f32 v20, v20, v114
    v_mfma_f32_16x16x32_bf16 v[48:51], a[0:3], v[72:75], 0
    v_mul_f32 v21, v21, v114
    v_mul_f32 v22, v22, v114
    v_mfma_f32_16x16x32_bf16 v[56:59], a[4:7], v[72:75], 0
    v_mul_f32 v23, v23, v114
    v_cvt_pk_bf16_f32 v20, v20, v21
    v_mfma_f32_16x16x32_bf16 v[52:55], a[4:7], v[68:71], 0
    ds_read_b128 v[88:91], v4 offset:6144
    v_cvt_pk_bf16_f32 v21, v22, v23
    v_mfma_f32_16x16x32_bf16 v[60:63], a[8:11], v[68:71], 0
    ds_write_b64 v7, v[20:21] offset:0
    v_mfma_f32_16x16x32_bf16 v[64:67], a[8:11], v[72:75], 0
    s_waitcnt lgkmcnt(3)
    v_mul_f32 v24, v24, v115
    v_mul_f32 v25, v25, v115
    v_mfma_f32_16x16x32_bf16 v[44:47], a[12:15], v[76:79], v[44:47]
    ds_read_b128 v[92:95], v5 offset:4096
    v_mul_f32 v26, v26, v115
    v_mfma_f32_16x16x32_bf16 v[48:51], a[12:15], v[80:83], v[48:51]
    v_mul_f32 v27, v27, v115
    v_cvt_pk_bf16_f32 v24, v24, v25
    v_mfma_f32_16x16x32_bf16 v[56:59], a[16:19], v[80:83], v[56:59]
    v_cvt_pk_bf16_f32 v25, v26, v27
    v_mfma_f32_16x16x32_bf16 v[52:55], a[16:19], v[76:79], v[52:55]
    ds_read_b128 v[96:99], v5 offset:6144
    v_mfma_f32_16x16x32_bf16 v[60:63], a[20:23], v[76:79], v[60:63]
    ds_write_b64 v7, v[24:25] offset:6144
    v_mfma_f32_16x16x32_bf16 v[64:67], a[20:23], v[80:83], v[64:67]
    s_waitcnt lgkmcnt(4)
    v_mul_f32 v28, v28, v114
    v_mul_f32 v29, v29, v114
    v_mfma_f32_16x16x32_bf16 v[44:47], a[24:27], v[84:87], v[44:47]
    ds_read_b128 v[68:71], v4 offset:8192
    v_mul_f32 v30, v30, v114
    v_mfma_f32_16x16x32_bf16 v[48:51], a[24:27], v[88:91], v[48:51]
    v_mul_f32 v31, v31, v114
    v_cvt_pk_bf16_f32 v28, v28, v29
    v_mfma_f32_16x16x32_bf16 v[56:59], a[28:31], v[88:91], v[56:59]
    v_cvt_pk_bf16_f32 v29, v30, v31
    v_mfma_f32_16x16x32_bf16 v[52:55], a[28:31], v[84:87], v[52:55]
    ds_read_b128 v[72:75], v4 offset:10240
    v_mfma_f32_16x16x32_bf16 v[60:63], a[32:35], v[84:87], v[60:63]
    ds_write_b64 v7, v[28:29] offset:1024
    v_mfma_f32_16x16x32_bf16 v[64:67], a[32:35], v[88:91], v[64:67]
    s_waitcnt lgkmcnt(4)
    v_mul_f32 v32, v32, v115
    v_mul_f32 v33, v33, v115
    v_mfma_f32_16x16x32_bf16 v[44:47], a[36:39], v[92:95], v[44:47]
    ds_read_b128 v[76:79], v5 offset:8192
    v_mul_f32 v34, v34, v115
    v_mfma_f32_16x16x32_bf16 v[48:51], a[36:39], v[96:99], v[48:51]
    v_mul_f32 v35, v35, v115
    v_cvt_pk_bf16_f32 v32, v32, v33
    v_mfma_f32_16x16x32_bf16 v[56:59], a[40:43], v[96:99], v[56:59]
    v_cvt_pk_bf16_f32 v33, v34, v35
    v_mfma_f32_16x16x32_bf16 v[52:55], a[40:43], v[92:95], v[52:55]
    ds_read_b128 v[80:83], v5 offset:10240
    v_mfma_f32_16x16x32_bf16 v[60:63], a[44:47], v[92:95], v[60:63]
    ds_write_b64 v7, v[32:33] offset:7168
    v_mfma_f32_16x16x32_bf16 v[64:67], a[44:47], v[96:99], v[64:67]
    s_waitcnt lgkmcnt(4)
    v_mul_f32 v36, v36, v114
    v_mul_f32 v37, v37, v114
    v_mfma_f32_16x16x32_bf16 v[44:47], a[48:51], v[68:71], v[44:47]
    s_waitcnt vmcnt(1)
    ds_read_b128 v[84:87], v4 offset:12288
    v_cmp_ne_u32 vcc, 0, v116
    v_mfma_f32_16x16x32_bf16 v[48:51], a[48:51], v[72:75], v[48:51]
    v_mul_f32 v38, v38, v114
    v_mul_f32 v39, v39, v114
    v_mfma_f32_16x16x32_bf16 v[56:59], a[52:55], v[72:75], v[56:59]
    s_cbranch_vccnz L_spin5
L_back6:
    v_cvt_pk_bf16_f32 v36, v36, v37
    v_cvt_pk_bf16_f32 v37, v38, v39
    v_mfma_f32_16x16x32_bf16 v[52:55], a[52:55], v[68:71], v[52:55]
    ds_read_b128 v[88:91], v4 offset:14336
    v_mfma_f32_16x16x32_bf16 v[60:63], a[56:59], v[68:71], v[60:63]
    ds_write_b64 v8, v[36:37] offset:2048
    v_mfma_f32_16x16x32_bf16 v[64:67], a[56:59], v[72:75], v[64:67]
    s_waitcnt lgkmcnt(4)
    v_mul_f32 v40, v40, v115
    v_mul_f32 v41, v41, v115
    v_mfma_f32_16x16x32_bf16 v[44:47], a[60:63], v[76:79], v[44:47]
    ds_read_b128 v[92:95], v5 offset:12288
    v_mul_f32 v42, v42, v115
    v_mfma_f32_16x16x32_bf16 v[48:51], a[60:63], v[80:83], v[48:51]
    v_mul_f32 v43, v43, v115
    v_cvt_pk_bf16_f32 v40, v40, v41
    v_mfma_f32_16x16x32_bf16 v[56:59], a[64:67], v[80:83], v[56:59]
    v_cvt_pk_bf16_f32 v41, v42, v43
    v_mfma_f32_16x16x32_bf16 v[52:55], a[64:67], v[76:79], v[52:55]
    ds_read_b128 v[96:99], v5 offset:14336
    v_mfma_f32_16x16x32_bf16 v[60:63], a[68:71], v[76:79], v[60:63]
    ds_write_b64 v8, v[40:41] offset:8192
    v_mfma_f32_16x16x32_bf16 v[64:67], a[68:71], v[80:83], v[64:67]
    s_waitcnt lgkmcnt(4)
    s_waitcnt lgkmcnt(0)
    s_barrier
    v_mfma_f32_16x16x32_bf16 v[44:47], a[72:75], v[84:87], v[44:47]
    ds_read_b128 v[68:71], v4 offset:16384
    v_mfma_f32_16x16x32_bf16 v[48:51], a[72:75], v[88:91], v[48:51]
    ds_read_b128 v[20:23], v10 offset:0
    v_mfma_f32_16x16x32_bf16 v[56:59], a[76:79], v[88:91], v[56:59]
    ds_read_b128 v[24:27], v9 offset:1024
    v_mfma_f32_16x16x32_bf16 v[52:55], a[76:79], v[84:87], v[52:55]
    ds_read_b128 v[72:75], v4 offset:18432
    v_mfma_f32_16x16x32_bf16 v[60:63], a[80:83], v[84:87], v[60:63]
    ds_read_b128 v[28:31], v10 offset:1024
    s_add_u32 m0, s43, 0
    v_mfma_f32_16x16x32_bf16 v[64:67], a[80:83], v[88:91], v[64:67]
    s_waitcnt lgkmcnt(6)
    ds_read_b64_tr_b16 v[32:33], v9 offset:2048
    v_mfma_f32_16x16x32_bf16 v[44:47], a[84:87], v[92:95], v[44:47]
    ds_read_b128 v[76:79], v5 offset:16384
    v_mfma_f32_16x16x32_bf16 v[48:51], a[84:87], v[96:99], v[48:51]
    buffer_load_dwordx4 v6, s[8:11], s41 offen offset:0 sc1 lds
    v_mfma_f32_16x16x32_bf16 v[56:59], a[88:91], v[96:99], v[56:59]
    s_add_u32 m0, s43, 3968
    ds_read_b64_tr_b16 v[34:35], v10 offset:2048
    s_waitcnt lgkmcnt(3)
    v_mfma_f32_16x16x32_bf16 v[52:55], a[88:91], v[92:95], v[52:55]
    ds_read_b128 v[80:83], v5 offset:18432
    v_mfma_f32_16x16x32_bf16 v[40:43], v[24:27], v[20:23], 0
    ds_read_b64_tr_b16 v[36:37], v9 offset:2056
    v_mfma_f32_16x16x32_bf16 v[118:121], v[28:31], v[20:23], 0
    ds_read_b64_tr_b16 v[38:39], v10 offset:2056
    v_mfma_f32_16x16x32_bf16 v[60:63], a[92:95], v[92:95], v[60:63]
    v_mfma_f32_16x16x32_bf16 v[64:67], a[92:95], v[96:99], v[64:67]
    s_waitcnt lgkmcnt(7)
    v_cndmask_b32 v40, v40, v41, s[56:57]
    v_cndmask_b32 v42, v42, v43, s[56:57]
    v_mfma_f32_16x16x32_bf16 v[44:47], a[96:99], v[68:71], v[44:47]
    ds_read_b128 v[84:87], v4 offset:20480
    v_cndmask_b32 v118, v118, v119, s[56:57]
    v_mfma_f32_16x16x32_bf16 v[48:51], a[96:99], v[72:75], v[48:51]
    buffer_load_dwordx4 v6, s[8:11], s41 offen offset:128 sc1 lds
    v_mfma_f32_16x16x32_bf16 v[56:59], a[100:103], v[72:75], v[56:59]
    s_add_u32 m0, s43, 7936
    v_cndmask_b32 v120, v120, v121, s[56:57]
    v_cndmask_b32 v40, v18, v40, s[62:63]
    v_mfma_f32_16x16x32_bf16 v[52:55], a[100:103], v[68:71], v[52:55]
    ds_read_b128 v[88:91], v4 offset:22528
    v_cndmask_b32 v42, v18, v42, s[62:63]
    v_mfma_f32_16x16x32_bf16 v[60:63], a[104:107], v[68:71], v[60:63]
    v_cndmask_b32 v22, v40, v118, s[58:59]
    v_cndmask_b32 v23, v42, v120, s[60:61]
    v_mfma_f32_16x16x32_bf16 v[64:67], a[104:107], v[72:75], v[64:67]
    s_waitcnt lgkmcnt(4)
    v_max_f32 v20, v22, v23
    v_mov_b32 v21, v20
    v_mfma_f32_16x16x32_bf16 v[44:47], a[108:111], v[76:79], v[44:47]
    ds_read_b128 v[92:95], v5 offset:20480
    v_mfma_f32_16x16x32_bf16 v[48:51], a[108:111], v[80:83], v[48:51]
    buffer_load_dwordx4 v6, s[8:11], s41 offen offset:256 sc1 lds
    v_mfma_f32_16x16x32_bf16 v[56:59], a[112:115], v[80:83], v[56:59]
    s_add_u32 m0, s43, 11904
    v_permlane16_swap_b32 v20, v21
    v_mfma_f32_16x16x32_bf16 v[52:55], a[112:115], v[76:79], v[52:55]
    ds_read_b128 v[96:99], v5 offset:22528
    v_max_f32 v20, v20, v21
    v_mfma_f32_16x16x32_bf16 v[60:63], a[116:119], v[76:79], v[60:63]
    v_mov_b32 v21, v20
    v_mfma_f32_16x16x32_bf16 v[64:67], a[116:119], v[80:83], v[64:67]
    s_waitcnt lgkmcnt(2)
    v_permlane32_swap_b32 v20, v21
    v_mfma_f32_16x16x32_bf16 v[44:47], a[120:123], v[84:87], v[44:47]
    ds_read_b128 v[68:71], v4 offset:24576
    v_max_f32 v20, v20, v21
    v_mfma_f32_16x16x32_bf16 v[48:51], a[120:123], v[88:91], v[48:51]
    buffer_load_dwordx4 v6, s[8:11], s41 offen offset:384 sc1 lds
    v_mfma_f32_16x16x32_bf16 v[56:59], a[124:127], v[88:91], v[56:59]
    s_add_u32 m0, s43, 15872
    v_mul_f32 v20, s86, v20
    v_fma_f32 v22, v22, s86, -v20
    v_mfma_f32_16x16x32_bf16 v[52:55], a[124:127], v[84:87], v[52:55]
    ds_read_b128 v[72:75], v4 offset:26624
    v_fma_f32 v23, v23, s86, -v20
    v_mfma_f32_16x16x32_bf16 v[60:63], a[128:131], v[84:87], v[60:63]
    v_exp_f32 v22, v22
    v_mfma_f32_16x16x32_bf16 v[64:67], a[128:131], v[88:91], v[64:67]
    s_waitcnt lgkmcnt(2)
    v_exp_f32 v23, v23
    v_mfma_f32_16x16x32_bf16 v[44:47], a[132:135], v[92:95], v[44:47]
    ds_read_b128 v[76:79], v5 offset:24576
    v_cvt_pk_bf16_f32 v28, v22, v23
    v_mfma_f32_16x16x32_bf16 v[48:51], a[132:135], v[96:99], v[48:51]
    buffer_load_dwordx4 v6, s[8:11], s41 offen offset:512 sc1 lds
    v_mfma_f32_16x16x32_bf16 v[56:59], a[136:139], v[96:99], v[56:59]
    s_add_u32 m0, s43, 19840
    v_perm_b32 v24, v28, v28, v14
    v_perm_b32 v25, v28, v28, v15
    v_mfma_f32_16x16x32_bf16 v[52:55], a[136:139], v[92:95], v[52:55]
    ds_read_b128 v[80:83], v5 offset:26624
    v_perm_b32 v26, v28, v28, v16
    v_mfma_f32_16x16x32_bf16 v[60:63], a[140:143], v[92:95], v[60:63]
    v_perm_b32 v27, v28, v28, v17
    v_add_f32 v20, v22, v23
    v_mfma_f32_16x16x32_bf16 v[64:67], a[140:143], v[96:99], v[64:67]
    s_waitcnt lgkmcnt(2)
    v_mov_b32 v21, v20
    s_waitcnt lgkmcnt(8)
    v_mfma_f32_16x16x32_bf16 v[44:47], a[144:147], v[68:71], v[44:47]
    ds_read_b128 v[84:87], v4 offset:28672
    v_mfma_f32_16x16x32_bf16 v[40:43], v[32:35], v[24:27], 0
    v_mfma_f32_16x16x32_bf16 v[118:121], v[36:39], v[24:27], 0
    v_permlane16_swap_b32 v20, v21
    v_mfma_f32_16x16x32_bf16 v[48:51], a[144:147], v[72:75], v[48:51]
    buffer_load_dwordx4 v6, s[8:11], s41 offen offset:640 sc1 lds
    v_mfma_f32_16x16x32_bf16 v[56:59], a[148:151], v[72:75], v[56:59]
    s_add_u32 m0, s43, 23808
    v_add_f32 v20, v20, v21
    v_mov_b32 v21, v20
    v_mfma_f32_16x16x32_bf16 v[52:55], a[148:151], v[68:71], v[52:55]
    ds_read_b128 v[88:91], v4 offset:30720
    v_mfma_f32_16x16x32_bf16 v[60:63], a[152:155], v[68:71], v[60:63]
    v_permlane32_swap_b32 v20, v21
    v_mfma_f32_16x16x32_bf16 v[64:67], a[152:155], v[72:75], v[64:67]
    s_waitcnt lgkmcnt(2)
    v_add_f32 v20, v20, v21
    v_mfma_f32_16x16x32_bf16 v[44:47], a[156:159], v[76:79], v[44:47]
    ds_read_b128 v[92:95], v5 offset:28672
    v_mfma_f32_16x16x32_bf16 v[48:51], a[156:159], v[80:83], v[48:51]
    buffer_load_dwordx4 v6, s[8:11], s41 offen offset:768 sc1 lds
    v_mfma_f32_16x16x32_bf16 v[56:59], a[160:163], v[80:83], v[56:59]
    s_add_u32 m0, s43, 27776
    v_rcp_f32 v20, v20
    v_mfma_f32_16x16x32_bf16 v[52:55], a[160:163], v[76:79], v[52:55]
    ds_read_b128 v[96:99], v5 offset:30720
    v_mul_f32 v40, v40, v20
    v_mfma_f32_16x16x32_bf16 v[60:63], a[164:167], v[76:79], v[60:63]
    v_mul_f32 v41, v41, v20
    v_mul_f32 v42, v42, v20
    v_mfma_f32_16x16x32_bf16 v[64:67], a[164:167], v[80:83], v[64:67]
    s_waitcnt lgkmcnt(2)
    v_mul_f32 v43, v43, v20
    v_cvt_pk_bf16_f32 v28, v40, v41
    v_mfma_f32_16x16x32_bf16 v[44:47], a[168:171], v[84:87], v[44:47]
    ds_read_b128 v[68:71], v4 offset:32768
    v_cvt_pk_bf16_f32 v29, v42, v43
    v_mfma_f32_16x16x32_bf16 v[48:51], a[168:171], v[88:91], v[48:51]
    buffer_load_dwordx4 v6, s[8:11], s41 offen offset:896 sc1 lds
    v_mfma_f32_16x16x32_bf16 v[56:59], a[172:175], v[88:91], v[56:59]
    s_add_u32 m0, s43, 31744
    v_mul_f32 v118, v118, v20
    v_mul_f32 v119, v119, v20
    v_mfma_f32_16x16x32_bf16 v[52:55], a[172:175], v[84:87], v[52:55]
    ds_read_b128 v[72:75], v4 offset:34816
    v_mul_f32 v120, v120, v20
    v_mfma_f32_16x16x32_bf16 v[60:63], a[176:179], v[84:87], v[60:63]
    v_mul_f32 v121, v121, v20
    v_cvt_pk_bf16_f32 v30, v118, v119
    v_mfma_f32_16x16x32_bf16 v[64:67], a[176:179], v[88:91], v[64:67]
    s_waitcnt lgkmcnt(2)
    v_cvt_pk_bf16_f32 v31, v120, v121
    v_mfma_f32_16x16x32_bf16 v[44:47], a[180:183], v[92:95], v[44:47]
    ds_read_b128 v[76:79], v5 offset:32768
    v_mfma_f32_16x16x32_bf16 v[48:51], a[180:183], v[96:99], v[48:51]
    buffer_load_dwordx4 v6, s[8:11], s41 offen offset:1024 sc1 lds
    v_mfma_f32_16x16x32_bf16 v[56:59], a[184:187], v[96:99], v[56:59]
    buffer_store_dwordx4 v[28:31], v1, s[16:19], s44 offen sc1
    v_mfma_f32_16x16x32_bf16 v[52:55], a[184:187], v[92:95], v[52:55]
    s_add_u32 m0, s43, 35712
    ds_read_b128 v[80:83], v5 offset:34816
    s_cmp_eq_u32 s36, 17
    v_mfma_f32_16x16x32_bf16 v[60:63], a[188:191], v[92:95], v[60:63]
    s_cselect_b32 s49, s87, 0x10000
    ds_read_b64 v[32:33], v13 offset:2048
    s_add_u32 s90, s90, s49
    v_mfma_f32_16x16x32_bf16 v[64:67], a[188:191], v[96:99], v[64:67]
    s_waitcnt lgkmcnt(3)
    ds_read_b64 v[34:35], v13 offset:2176
    s_and_b32 s49, s90, 0xffffffff
    v_mfma_f32_16x16x32_bf16 v[44:47], a[192:195], v[68:71], v[44:47]
    s_bitcmp1_b64 s[24:25], s36
    ds_read_b128 v[84:87], v4 offset:36864
    s_cselect_b32 s44, s49, 0x5e00000
    v_mfma_f32_16x16x32_bf16 v[48:51], a[192:195], v[72:75], v[48:51]
    buffer_load_dwordx4 v6, s[8:11], s41 offen offset:1152 sc1 lds
    v_mfma_f32_16x16x32_bf16 v[56:59], a[196:199], v[72:75], v[56:59]
    s_add_u32 m0, s43, 39680
    ds_read_b64 v[36:37], v13 offset:2304
    s_bitcmp1_b64 s[26:27], s36
    v_mfma_f32_16x16x32_bf16 v[52:55], a[196:199], v[68:71], v[52:55]
    s_cselect_b64 s[62:63], 0, -1
    ds_read_b128 v[88:91], v4 offset:38912
    v_mfma_f32_16x16x32_bf16 v[60:63], a[200:203], v[68:71], v[60:63]
    ds_read_b64 v[38:39], v13 offset:2432
    v_mfma_f32_16x16x32_bf16 v[64:67], a[200:203], v[72:75], v[64:67]
    s_waitcnt lgkmcnt(6)
    v_mfma_f32_16x16x32_bf16 v[44:47], a[204:207], v[76:79], v[44:47]
    ds_read_b128 v[92:95], v5 offset:36864
    v_mfma_f32_16x16x32_bf16 v[48:51], a[204:207], v[80:83], v[48:51]
    buffer_load_dwordx4 v6, s[8:11], s41 offen offset:1280 sc1 lds
    v_mfma_f32_16x16x32_bf16 v[56:59], a[208:211], v[80:83], v[56:59]
    s_add_u32 m0, s43, 43648
    v_mfma_f32_16x16x32_bf16 v[52:55], a[208:211], v[76:79], v[52:55]
    s_waitcnt lgkmcnt(1)
    ds_read_b128 v[96:99], v5 offset:38912
    v_add_f32 v40, v36, v38
    v_mfma_f32_16x16x32_bf16 v[60:63], a[212:215], v[76:79], v[60:63]
    v_add_f32 v41, v37, v39
    v_add_f32 v32, v32, v34
    v_mfma_f32_16x16x32_bf16 v[64:67], a[212:215], v[80:83], v[64:67]
    s_waitcnt lgkmcnt(3)
    v_add_f32 v33, v33, v35
    v_add_f32 v32, v32, v40
    v_mfma_f32_16x16x32_bf16 v[44:47], a[216:219], v[84:87], v[44:47]
    ds_read_b128 v[68:71], v4 offset:40960
    v_add_f32 v33, v33, v41
    v_mfma_f32_16x16x32_bf16 v[48:51], a[216:219], v[88:91], v[48:51]
    buffer_load_dwordx4 v6, s[8:11], s41 offen offset:1408 sc1 lds
    v_mfma_f32_16x16x32_bf16 v[56:59], a[220:223], v[88:91], v[56:59]
    s_add_u32 m0, s43, 47616
    v_mov_b32 v40, v32
    v_mov_b32 v41, v33
    v_mfma_f32_16x16x32_bf16 v[52:55], a[220:223], v[84:87], v[52:55]
    ds_read_b128 v[72:75], v4 offset:43008
    v_mfma_f32_16x16x32_bf16 v[60:63], a[224:227], v[84:87], v[60:63]
    v_permlane32_swap_b32 v32, v40
    v_mfma_f32_16x16x32_bf16 v[64:67], a[224:227], v[88:91], v[64:67]
    s_waitcnt lgkmcnt(2)
    v_permlane32_swap_b32 v33, v41
    v_mfma_f32_16x16x32_bf16 v[44:47], a[228:231], v[92:95], v[44:47]
    ds_read_b128 v[76:79], v5 offset:40960
    v_add_f32 v32, v32, v40
    v_mfma_f32_16x16x32_bf16 v[48:51], a[228:231], v[96:99], v[48:51]
    buffer_load_dwordx4 v6, s[8:11], s41 offen offset:1536 sc1 lds
    v_mfma_f32_16x16x32_bf16 v[56:59], a[232:235], v[96:99], v[56:59]
    s_add_u32 m0, s43, 51584
    v_add_f32 v33, v33, v41
    v_mul_f32 v112, 0xba800000, v32
    v_mfma_f32_16x16x32_bf16 v[52:55], a[232:235], v[92:95], v[52:55]
    ds_read_b128 v[80:83], v5 offset:43008
    v_mul_f32 v33, 0x3a800000, v33
    v_mfma_f32_16x16x32_bf16 v[60:63], a[236:239], v[92:95], v[60:63]
    v_fma_f32 v33, -v112, v112, v33
    v_mov_b32 v113, v112
    v_mfma_f32_16x16x32_bf16 v[64:67], a[236:239], v[96:99], v[64:67]
    s_waitcnt lgkmcnt(2)
    v_max_f32 v33, 0, v33
    v_add_f32 v33, 0x3727c5ac, v33
    v_mfma_f32_16x16x32_bf16 v[44:47], a[240:243], v[68:71], v[44:47]
    ds_read_b128 v[84:87], v4 offset:45056
    v_mfma_f32_16x16x32_bf16 v[48:51], a[240:243], v[72:75], v[48:51]
    buffer_load_dwordx4 v6, s[8:11], s41 offen offset:1664 sc1 lds
    v_mfma_f32_16x16x32_bf16 v[56:59], a[244:247], v[72:75], v[56:59]
    s_add_u32 m0, s43, 55552
    v_rsq_f32 v114, v33
    v_mfma_f32_16x16x32_bf16 v[52:55], a[244:247], v[68:71], v[52:55]
    ds_read_b128 v[88:91], v4 offset:47104
    v_mfma_f32_16x16x32_bf16 v[60:63], a[248:251], v[68:71], v[60:63]
    v_permlane16_swap_b32 v112, v113
    v_mfma_f32_16x16x32_bf16 v[64:67], a[248:251], v[72:75], v[64:67]
    s_waitcnt lgkmcnt(2)
    v_mov_b32 v115, v114
    v_fmac_f32 v48, v113, v100
    v_mfma_f32_16x16x32_bf16 v[44:47], a[252:255], v[76:79], v[44:47]
    ds_read_b128 v[92:95], v5 offset:45056
    v_fmac_f32 v52, v112, v104
    v_mfma_f32_16x16x32_bf16 v[48:51], a[252:255], v[80:83], v[48:51]
    buffer_load_dwordx4 v6, s[8:11], s41 offen offset:1792 sc1 lds
    v_mfma_f32_16x16x32_bf16 v[56:59], v[128:131], v[80:83], v[56:59]
    s_add_u32 m0, s43, 59520
    v_permlane16_swap_b32 v114, v115
    v_mfma_f32_16x16x32_bf16 v[52:55], v[128:131], v[76:79], v[52:55]
    ds_read_b128 v[96:99], v5 offset:47104
    v_fmac_f32 v44, v112, v100
    v_mfma_f32_16x16x32_bf16 v[60:63], v[132:135], v[76:79], v[60:63]
    v_fmac_f32 v45, v112, v101
    v_fmac_f32 v46, v112, v102
    v_mfma_f32_16x16x32_bf16 v[64:67], v[132:135], v[80:83], v[64:67]
    s_waitcnt lgkmcnt(2)
    v_fmac_f32 v49, v113, v101
    v_fmac_f32 v50, v113, v102
    v_mfma_f32_16x16x32_bf16 v[44:47], v[136:139], v[84:87], v[44:47]
    ds_read_b128 v[68:71], v4 offset:49152
    v_fmac_f32 v53, v112, v105
    v_mfma_f32_16x16x32_bf16 v[48:51], v[136:139], v[88:91], v[48:51]
    buffer_load_dwordx4 v6, s[8:11], s41 offen offset:1920 sc1 lds
    v_mfma_f32_16x16x32_bf16 v[56:59], v[140:143], v[88:91], v[56:59]
    s_add_u32 m0, s52, 90112
    v_fmac_f32 v47, v112, v103
    v_fmac_f32 v60, v112, v108
    v_mfma_f32_16x16x32_bf16 v[52:55], v[140:143], v[84:87], v[52:55]
    ds_read_b128 v[72:75], v4 offset:51200
    v_fmac_f32 v51, v113, v103
    v_mfma_f32_16x16x32_bf16 v[60:63], v[144:147], v[84:87], v[60:63]
    v_fmac_f32 v56, v113, v104
    v_fmac_f32 v57, v113, v105
    v_mfma_f32_16x16x32_bf16 v[64:67], v[144:147], v[88:91], v[64:67]
    s_waitcnt lgkmcnt(2)
    v_fmac_f32 v54, v112, v106
    v_fmac_f32 v55, v112, v107
    v_mfma_f32_16x16x32_bf16 v[44:47], v[148:151], v[92:95], v[44:47]
    ds_read_b128 v[76:79], v5 offset:49152
    v_fmac_f32 v58, v113, v106
    v_mfma_f32_16x16x32_bf16 v[48:51], v[148:151], v[96:99], v[48:51]
    buffer_load_dwordx4 v1, s[16:19], s46 offen sc1 lds
    v_mfma_f32_16x16x32_bf16 v[56:59], v[152:155], v[96:99], v[56:59]
    s_cmp_eq_u32 s36, s97
    v_med3_i32 v117, s45, 0, v12
    v_add_u32 v117, v117, v11
    v_mfma_f32_16x16x32_bf16 v[52:55], v[152:155], v[92:95], v[52:55]
    s_cselect_b32 s47, 31, -2
    ds_read_b128 v[80:83], v5 offset:51200
    v_fmac_f32 v64, v113, v108
    v_mfma_f32_16x16x32_bf16 v[60:63], v[156:159], v[92:95], v[60:63]
    s_cselect_b64 s[8:9], s[88:89], s[8:9]
    v_fmac_f32 v59, v113, v107
    s_cselect_b32 s55, 0x543fc00, s55
    v_mfma_f32_16x16x32_bf16 v[64:67], v[156:159], v[96:99], v[64:67]
    s_waitcnt lgkmcnt(2)
    s_add_u32 s45, s45, 131072
    s_add_u32 s50, s50, s47
    v_mfma_f32_16x16x32_bf16 v[44:47], v[160:163], v[68:71], v[44:47]
    s_max_i32 s47, s50, 0
    ds_read_b128 v[84:87], v4 offset:53248
    v_fmac_f32 v61, v112, v109
    v_mfma_f32_16x16x32_bf16 v[48:51], v[160:163], v[72:75], v[48:51]
    buffer_load_dword v116, v117, s[16:19], 0 offen sc1
    v_mfma_f32_16x16x32_bf16 v[56:59], v[164:167], v[72:75], v[56:59]
    s_lshl_b32 s41, s47, 15
    v_fmac_f32 v62, v112, v110
    v_fmac_f32 v63, v112, v111
    v_mfma_f32_16x16x32_bf16 v[52:55], v[164:167], v[68:71], v[52:55]
    s_lshl_b32 s46, s47, 10
    ds_read_b128 v[88:91], v4 offset:55296
    v_fmac_f32 v65, v113, v109
    v_mfma_f32_16x16x32_bf16 v[60:63], v[168:171], v[68:71], v[60:63]
    s_sub_u32 s46, s55, s46
    v_mfma_f32_16x16x32_bf16 v[64:67], v[168:171], v[72:75], v[64:67]
    s_waitcnt lgkmcnt(2)
    v_mfma_f32_16x16x32_bf16 v[44:47], v[172:175], v[76:79], v[44:47]
    ds_read_b128 v[92:95], v5 offset:53248
    v_mfma_f32_16x16x32_bf16 v[48:51], v[172:175], v[80:83], v[48:51]
    v_mfma_f32_16x16x32_bf16 v[56:59], v[176:179], v[80:83], v[56:59]
    v_fmac_f32 v66, v113, v110
    v_fmac_f32 v67, v113, v111
    v_mfma_f32_16x16x32_bf16 v[52:55], v[176:179], v[76:79], v[52:55]
    ds_read_b128 v[96:99], v5 offset:55296
    v_mfma_f32_16x16x32_bf16 v[60:63], v[180:183], v[76:79], v[60:63]
    v_mfma_f32_16x16x32_bf16 v[64:67], v[180:183], v[80:83], v[64:67]
    s_waitcnt lgkmcnt(2)
    v_mfma_f32_16x16x32_bf16 v[44:47], v[184:187], v[84:87], v[44:47]
    ds_read_b128 v[68:71], v4 offset:57344
    v_mfma_f32_16x16x32_bf16 v[48:51], v[184:187], v[88:91], v[48:51]
    v_mfma_f32_16x16x32_bf16 v[56:59], v[188:191], v[88:91], v[56:59]
    v_mfma_f32_16x16x32_bf16 v[52:55], v[188:191], v[84:87], v[52:55]
    ds_read_b128 v[72:75], v4 offset:59392
    v_mfma_f32_16x16x32_bf16 v[60:63], v[192:195], v[84:87], v[60:63]
    v_mfma_f32_16x16x32_bf16 v[64:67], v[192:195], v[88:91], v[64:67]
    s_waitcnt lgkmcnt(2)
    v_mfma_f32_16x16x32_bf16 v[44:47], v[196:199], v[92:95], v[44:47]
    ds_read_b128 v[76:79], v5 offset:57344
    v_mfma_f32_16x16x32_bf16 v[48:51], v[196:199], v[96:99], v[48:51]
    v_mfma_f32_16x16x32_bf16 v[56:59], v[200:203], v[96:99], v[56:59]
    v_mfma_f32_16x16x32_bf16 v[52:55], v[200:203], v[92:95], v[52:55]
    ds_read_b128 v[80:83], v5 offset:59392
    v_mfma_f32_16x16x32_bf16 v[60:63], v[204:207], v[92:95], v[60:63]
    s_waitcnt vmcnt(9)
    s_barrier
    v_mfma_f32_16x16x32_bf16 v[64:67], v[204:207], v[96:99], v[64:67]
    s_waitcnt lgkmcnt(2)
    v_mfma_f32_16x16x32_bf16 v[44:47], v[208:211], v[68:71], v[44:47]
    ds_read_b128 v[84:87], v4 offset:61440
    v_mfma_f32_16x16x32_bf16 v[48:51], v[208:211], v[72:75], v[48:51]
    buffer_store_dword v124, v124, s[16:19], s91 offen sc1
    v_mfma_f32_16x16x32_bf16 v[56:59], v[212:215], v[72:75], v[56:59]
    s_add_u32 s91, s91, 131072
    v_mfma_f32_16x16x32_bf16 v[52:55], v[212:215], v[68:71], v[52:55]
    ds_read_b128 v[88:91], v4 offset:63488
    v_mfma_f32_16x16x32_bf16 v[60:63], v[216:219], v[68:71], v[60:63]
    v_mfma_f32_16x16x32_bf16 v[64:67], v[216:219], v[72:75], v[64:67]
    s_waitcnt lgkmcnt(2)
    v_mfma_f32_16x16x32_bf16 v[44:47], v[220:223], v[76:79], v[44:47]
    ds_read_b128 v[92:95], v5 offset:61440
    v_mfma_f32_16x16x32_bf16 v[48:51], v[220:223], v[80:83], v[48:51]
    v_mfma_f32_16x16x32_bf16 v[56:59], v[224:227], v[80:83], v[56:59]
    v_mfma_f32_16x16x32_bf16 v[52:55], v[224:227], v[76:79], v[52:55]
    ds_read_b128 v[96:99], v5 offset:63488
    v_mfma_f32_16x16x32_bf16 v[60:63], v[228:231], v[76:79], v[60:63]
    v_mfma_f32_16x16x32_bf16 v[64:67], v[228:231], v[80:83], v[64:67]
    s_waitcnt lgkmcnt(2)
    v_mfma_f32_16x16x32_bf16 v[44:47], v[232:235], v[84:87], v[44:47]
    ds_read_b128 v[68:71], v2 offset:0
    v_mfma_f32_16x16x32_bf16 v[48:51], v[232:235], v[88:91], v[48:51]
    v_mfma_f32_16x16x32_bf16 v[56:59], v[236:239], v[88:91], v[56:59]
    v_mfma_f32_16x16x32_bf16 v[52:55], v[236:239], v[84:87], v[52:55]
    ds_read_b128 v[72:75], v2 offset:2048
    v_mfma_f32_16x16x32_bf16 v[60:63], v[240:243], v[84:87], v[60:63]
    v_mfma_f32_16x16x32_bf16 v[64:67], v[240:243], v[88:91], v[64:67]
    s_waitcnt lgkmcnt(2)
    v_mfma_f32_16x16x32_bf16 v[44:47], v[244:247], v[92:95], v[44:47]
    ds_read_b128 v[76:79], v3 offset:0
    v_mfma_f32_16x16x32_bf16 v[48:51], v[244:247], v[96:99], v[48:51]
    v_mfma_f32_16x16x32_bf16 v[56:59], v[248:251], v[96:99], v[56:59]
    v_mfma_f32_16x16x32_bf16 v[52:55], v[248:251], v[92:95], v[52:55]
    ds_read_b128 v[80:83], v3 offset:2048
    v_mfma_f32_16x16x32_bf16 v[60:63], v[252:255], v[92:95], v[60:63]
    v_mfma_f32_16x16x32_bf16 v[64:67], v[252:255], v[96:99], v[64:67]
    s_add_u32 s36, s36, 1
    s_cmp_lt_u32 s36, 33
    s_cbranch_scc1 L_q_b0
    s_nop 7
    v_mul_f32 v44, v44, v114
    v_mul_f32 v45, v45, v114
    v_mul_f32 v46, v46, v114
    v_mul_f32 v47, v47, v114
    v_cvt_pk_bf16_f32 v44, v44, v45
    v_cvt_pk_bf16_f32 v45, v46, v47
    ds_write_b64 v7, v[44:45] offset:12288
    v_mul_f32 v48, v48, v115
    v_mul_f32 v49, v49, v115
    v_mul_f32 v50, v50, v115
    v_mul_f32 v51, v51, v115
    v_cvt_pk_bf16_f32 v48, v48, v49
    v_cvt_pk_bf16_f32 v49, v50, v51
    ds_write_b64 v7, v[48:49] offset:18432
    v_mul_f32 v52, v52, v114
    v_mul_f32 v53, v53, v114
    v_mul_f32 v54, v54, v114
    v_mul_f32 v55, v55, v114
    v_cvt_pk_bf16_f32 v52, v52, v53
    v_cvt_pk_bf16_f32 v53, v54, v55
    ds_write_b64 v7, v[52:53] offset:13312
    v_mul_f32 v56, v56, v115
    v_mul_f32 v57, v57, v115
    v_mul_f32 v58, v58, v115
    v_mul_f32 v59, v59, v115
    v_cvt_pk_bf16_f32 v56, v56, v57
    v_cvt_pk_bf16_f32 v57, v58, v59
    ds_write_b64 v7, v[56:57] offset:19456
    v_mul_f32 v60, v60, v114
    v_mul_f32 v61, v61, v114
    v_mul_f32 v62, v62, v114
    v_mul_f32 v63, v63, v114
    v_cvt_pk_bf16_f32 v60, v60, v61
    v_cvt_pk_bf16_f32 v61, v62, v63
    ds_write_b64 v8, v[60:61] offset:14336
    v_mul_f32 v64, v64, v115
    v_mul_f32 v65, v65, v115
    v_mul_f32 v66, v66, v115
    v_mul_f32 v67, v67, v115
    v_cvt_pk_bf16_f32 v64, v64, v65
    v_cvt_pk_bf16_f32 v65, v66, v67
    ds_write_b64 v8, v[64:65] offset:20480
    s_waitcnt lgkmcnt(0)
    s_barrier
    ds_read_b128 v[44:47], v9 offset:6144
    ds_read_b128 v[48:51], v9 offset:13312
    ds_read_b128 v[52:55], v9 offset:7168
    ds_read_b64_tr_b16 v[56:57], v9 offset:14336
    ds_read_b64_tr_b16 v[58:59], v9 offset:8192
    ds_read_b64_tr_b16 v[60:61], v9 offset:14344
    ds_read_b64_tr_b16 v[62:63], v9 offset:8200
    s_waitcnt lgkmcnt(4)
    v_mfma_f32_16x16x32_bf16 v[64:67], v[48:51], v[44:47], 0
    v_mfma_f32_16x16x32_bf16 v[118:121], v[52:55], v[44:47], 0
    s_nop 5
    v_cndmask_b32 v64, v64, v65, s[56:57]
    v_cndmask_b32 v66, v66, v67, s[56:57]
    v_cndmask_b32 v118, v118, v119, s[56:57]
    v_cndmask_b32 v120, v120, v121, s[56:57]
    v_cndmask_b32 v64, v18, v64, s[62:63]
    v_cndmask_b32 v66, v18, v66, s[62:63]
    v_cndmask_b32 v46, v64, v118, s[58:59]
    v_cndmask_b32 v47, v66, v120, s[60:61]
    v_max_f32 v44, v46, v47
    v_mov_b32 v45, v44
    s_nop 1
    v_permlane16_swap_b32 v44, v45
    v_max_f32 v44, v44, v45
    v_mov_b32 v45, v44
    s_nop 1
    v_permlane32_swap_b32 v44, v45
    v_max_f32 v44, v44, v45
    v_mul_f32 v44, s86, v44
    v_fma_f32 v46, v46, s86, -v44
    v_fma_f32 v47, v47, s86, -v44
    v_exp_f32 v46, v46
    v_exp_f32 v47, v47
    s_nop 0
    v_cvt_pk_bf16_f32 v52, v46, v47
    v_perm_b32 v48, v52, v52, v14
    v_perm_b32 v49, v52, v52, v15
    v_perm_b32 v50, v52, v52, v16
    v_perm_b32 v51, v52, v52, v17
    s_waitcnt lgkmcnt(0)
    v_add_f32 v44, v46, v47
    v_mfma_f32_16x16x32_bf16 v[64:67], v[56:59], v[48:51], 0
    v_mfma_f32_16x16x32_bf16 v[118:121], v[60:63], v[48:51], 0
    v_mov_b32 v45, v44
    s_nop 1
    v_permlane16_swap_b32 v44, v45
    v_add_f32 v44, v44, v45
    v_mov_b32 v45, v44
    s_nop 1
    v_permlane32_swap_b32 v44, v45
    v_add_f32 v44, v44, v45
    v_rcp_f32 v44, v44
    s_nop 0
    v_mul_f32 v64, v64, v44
    v_mul_f32 v65, v65, v44
    v_mul_f32 v66, v66, v44
    v_mul_f32 v67, v67, v44
    v_cvt_pk_bf16_f32 v52, v64, v65
    v_cvt_pk_bf16_f32 v53, v66, v67
    v_mul_f32 v118, v118, v44
    v_mul_f32 v119, v119, v44
    v_mul_f32 v120, v120, v44
    v_mul_f32 v121, v121, v44
    v_cvt_pk_bf16_f32 v54, v118, v119
    v_cvt_pk_bf16_f32 v55, v120, v121
    buffer_store_dwordx4 v[52:55], v1, s[16:19], s44 offen sc1
    s_waitcnt vmcnt(0)
    s_barrier
    buffer_store_dword v124, v124, s[16:19], s91 offen sc1
    s_add_u32 s91, s91, 131072
    s_waitcnt vmcnt(0)
    s_endpgm
L_spin1:
    s_mov_b32 s40, 0x20000
L_spin1_l:
    buffer_load_dword v37, v36, s[20:23], 0 offen sc1
    s_sub_u32 s40, s40, 1
    s_waitcnt vmcnt(0)
    v_cmp_eq_u32 vcc, v36, v37
    s_cbranch_scc1 L_back2
    s_cbranch_vccz L_back2
    s_sleep 8
    s_branch L_spin1_l
L_spin3:
    s_mov_b32 s40, 0x20000
L_spin3_l:
    buffer_load_dword v116, v117, s[16:19], 0 offen sc1
    s_sub_u32 s40, s40, 1
    s_waitcnt vmcnt(0)
    v_cmp_ne_u32 vcc, 0, v116
    s_cbranch_scc1 L_back4
    s_cbranch_vccz L_back4
    s_sleep 2
    s_branch L_spin3_l
L_spin5:
    s_mov_b32 s40, 0x20000
L_spin5_l:
    buffer_load_dword v116, v117, s[16:19], 0 offen sc1
    s_sub_u32 s40, s40, 1
    s_waitcnt vmcnt(0)
    v_cmp_ne_u32 vcc, 0, v116
    s_cbranch_scc1 L_back6
    s_cbranch_vccz L_back6
    s_sleep 2
    s_branch L_spin5_l
L_other:
    s_lshr_b32 s37, s38, 3
    s_lshl_b32 s37, s37, 1
    s_sub_u32 s38, s38, s37
    s_sub_u32 s38, s38, 2
    s_lshl_b32 s38, s38, 1
    s_add_u32 s38, s38, s49
    s_lshl_b32 s53, s38, 3
    s_and_b32 s37, s2, 7
    s_add_u32 s53, s53, s37
    s_cmp_lt_u32 s38, 4
    s_cselect_b32 s51, 20, -4
    s_add_u32 s51, s51, s38
    s_lshl_b32 s51, s51, 2
    s_add_u32 s51, s51, s32
    v_lshrrev_b32 v6, 2, v0
    v_and_b32 v7, 3, v0
    v_lshlrev_b32 v7, 7, v7
    v_lshl_add_u32 v6, v6, 11, v7
    s_lshl_b32 s44, s51, 16
    s_lshl_b32 s90, s48, 9
    s_add_u32 s44, s44, s90
    s_sub_u32 s37, s53, 32
    s_cmp_lt_u32 s37, 96
    s_waitcnt lgkmcnt(0)
    s_cbranch_scc0 L_job
    s_mov_b32 s12, s66
    s_mov_b32 s13, s67
    s_mov_b32 s14, 0x600000
    s_mov_b32 s15, 0x00020000
    s_add_u32 s39, s44, 0
    buffer_load_dword v248, v6, s[12:15], s39 offen
    s_add_u32 s39, s44, 32768
    buffer_load_dword v249, v6, s[12:15], s39 offen
    s_mov_b32 s12, s68
    s_mov_b32 s13, s69
    s_mov_b32 s14, 0x200000
    s_mov_b32 s15, 0x00020000
    s_sub_u32 s44, 95, s51
    s_lshl_b32 s44, s44, 15
    s_add_u32 s44, s44, s90
    s_add_u32 s39, s44, 0
    buffer_load_dword v253, v6, s[12:15], s39 offen
    s_mov_b32 s12, s72
    s_mov_b32 s13, s73
    s_mov_b32 s14, 0x700000
    s_mov_b32 s15, 0x00020000
    s_mul_i32 s37, s48, 1920
    s_add_u32 s39, s37, s12
    s_sub_u32 s39, 0x180, s39
    s_and_b32 s39, s39, 0x380
    s_add_u32 s37, s37, s39
    s_mul_i32 s39, s51, 78848
    s_add_u32 s37, s37, s39
    v_lshrrev_b32 v7, 1, v0
    v_min_u32 v7, 10, v7
    v_mul_u32_u24 v7, 7168, v7
    v_and_b32 v5, 1, v0
    v_lshl_add_u32 v7, v5, 10, v7
    buffer_load_dword v255, v7, s[12:15], s37 offen
    s_mov_b32 s16, s84
    s_mov_b32 s17, s85
    s_mov_b32 s18, 0x5e00000
    s_mov_b32 s19, 0x00020000
    v_min_u32 v124, 1, v0
    v_lshlrev_b32 v124, 30, v124
    s_branch L_job_done
L_job:
    s_mov_b32 s16, s84
    s_mov_b32 s17, s85
    s_mov_b32 s18, 0x5e00000
    s_mov_b32 s19, 0x00020000
    v_min_u32 v124, 1, v0
    v_lshlrev_b32 v124, 30, v124
    s_cmp_ge_u32 s53, 128
    s_cbranch_scc1 L_reset
    s_lshr_b32 s50, s53, 3
    s_mul_i32 s50, s50, 40
    s_sub_u32 s50, s50, s53
    s_add_u32 s50, s50, 31
    s_lshl_b32 s46, s50, 15
    s_lshl_b32 s37, s32, 9
    s_add_u32 s46, s46, s37
    v_lshrrev_b32 v48, 3, v0
    v_and_b32 v49, 0x70, v1
    v_lshl_add_u32 v48, v48, 11, v49
    v_add_u32 v49, 16384, v48
    s_mov_b32 s8, s64
    s_mov_b32 s9, s65
    s_mov_b32 s10, 0x400000
    s_mov_b32 s11, 0x00020000
    buffer_load_dwordx4 v[16:19], v48, s[8:11], s46 offen offset:0
    buffer_load_dwordx4 v[20:23], v48, s[8:11], s46 offen offset:128
    buffer_load_dwordx4 v[24:27], v48, s[8:11], s46 offen offset:256
    buffer_load_dwordx4 v[28:31], v48, s[8:11], s46 offen offset:384
    buffer_load_dwordx4 v[32:35], v49, s[8:11], s46 offen offset:0
    buffer_load_dwordx4 v[36:39], v49, s[8:11], s46 offen offset:128
    buffer_load_dwordx4 v[40:43], v49, s[8:11], s46 offen offset:256
    buffer_load_dwordx4 v[44:47], v49, s[8:11], s46 offen offset:384
    s_mov_b32 s86, 0x3f803f80
    v_and_b32 v56, 1, v0
    v_lshlrev_b32 v56, 7, v56
    v_bfe_u32 v57, v0, 1, 1
    v_lshl_add_u32 v56, v57, 6, v56
    v_and_b32 v57, 0x38, v0
    v_add_u32 v56, v57, v56
    s_sub_u32 s46, 127, s50
    s_lshl_b32 s46, s46, 10
    s_lshl_b32 s37, s32, 8
    s_add_u32 s46, s46, s37
    s_add_u32 s46, s46, 0x5400000
    s_waitcnt vmcnt(0)
    v_dot2_f32_bf16 v48, v16, s86, 0
    v_dot2_f32_bf16 v49, v16, v16, 0
    v_dot2_f32_bf16 v50, v24, s86, 0
    v_dot2_f32_bf16 v51, v24, v24, 0
    v_dot2_f32_bf16 v52, v32, s86, 0
    v_dot2_f32_bf16 v53, v32, v32, 0
    v_dot2_f32_bf16 v54, v40, s86, 0
    v_dot2_f32_bf16 v55, v40, v40, 0
    v_dot2_f32_bf16 v48, v17, s86, v48
    v_dot2_f32_bf16 v49, v17, v17, v49
    v_dot2_f32_bf16 v50, v25, s86, v50
    v_dot2_f32_bf16 v51, v25, v25, v51
    v_dot2_f32_bf16 v52, v33, s86, v52
    v_dot2_f32_bf16 v53, v33, v33, v53
    v_dot2_f32_bf16 v54, v41, s86, v54
    v_dot2_f32_bf16 v55, v41, v41, v55
    v_dot2_f32_bf16 v48, v18, s86, v48
    v_dot2_f32_bf16 v49, v18, v18, v49
    v_dot2_f32_bf16 v50, v26, s86, v50
    v_dot2_f32_bf16 v51, v26, v26, v51
    v_dot2_f32_bf16 v52, v34, s86, v52
    v_dot2_f32_bf16 v53, v34, v34, v53
    v_dot2_f32_bf16 v54, v42, s86, v54
    v_dot2_f32_bf16 v55, v42, v42, v55
    v_dot2_f32_bf16 v48, v19, s86, v48
    v_dot2_f32_bf16 v49, v19, v19, v49
    v_dot2_f32_bf16 v50, v27, s86, v50
    v_dot2_f32_bf16 v51, v27, v27, v51
    v_dot2_f32_bf16 v52, v35, s86, v52
    v_dot2_f32_bf16 v53, v35, v35, v53
    v_dot2_f32_bf16 v54, v43, s86, v54
    v_dot2_f32_bf16 v55, v43, v43, v55
    v_dot2_f32_bf16 v48, v20, s86, v48
    v_dot2_f32_bf16 v49, v20, v20, v49
    v_dot2_f32_bf16 v50, v28, s86, v50
    v_dot2_f32_bf16 v51, v28, v28, v51
    v_dot2_f32_bf16 v52, v36, s86, v52
    v_dot2_f32_bf16 v53, v36, v36, v53
    v_dot2_f32_bf16 v54, v44, s86, v54
    v_dot2_f32_bf16 v55, v44, v44, v55
    v_dot2_f32_bf16 v48, v21, s86, v48
    v_dot2_f32_bf16 v49, v21, v21, v49
    v_dot2_f32_bf16 v50, v29, s86, v50
    v_dot2_f32_bf16 v51, v29, v29, v51
    v_dot2_f32_bf16 v52, v37, s86, v52
    v_dot2_f32_bf16 v53, v37, v37, v53
    v_dot2_f32_bf16 v54, v45, s86, v54
    v_dot2_f32_bf16 v55, v45, v45, v55
    v_dot2_f32_bf16 v48, v22, s86, v48
    v_dot2_f32_bf16 v49, v22, v22, v49
    v_dot2_f32_bf16 v50, v30, s86, v50
    v_dot2_f32_bf16 v51, v30, v30, v51
    v_dot2_f32_bf16 v52, v38, s86, v52
    v_dot2_f32_bf16 v53, v38, v38, v53
    v_dot2_f32_bf16 v54, v46, s86, v54
    v_dot2_f32_bf16 v55, v46, v46, v55
    v_dot2_f32_bf16 v48, v23, s86, v48
    v_dot2_f32_bf16 v49, v23, v23, v49
    v_dot2_f32_bf16 v50, v31, s86, v50
    v_dot2_f32_bf16 v51, v31, v31, v51
    v_dot2_f32_bf16 v52, v39, s86, v52
    v_dot2_f32_bf16 v53, v39, v39, v53
    v_dot2_f32_bf16 v54, v47, s86, v54
    v_dot2_f32_bf16 v55, v47, v47, v55
    v_add_f32_dpp v48, v48, v48 quad_perm:[1,0,3,2] row_mask:0xf bank_mask:0xf
    v_add_f32_dpp v49, v49, v49 quad_perm:[1,0,3,2] row_mask:0xf bank_mask:0xf
    v_add_f32_dpp v50, v50, v50 quad_perm:[1,0,3,2] row_mask:0xf bank_mask:0xf
    v_add_f32_dpp v51, v51, v51 quad_perm:[1,0,3,2] row_mask:0xf bank_mask:0xf
    v_add_f32_dpp v52, v52, v52 quad_perm:[1,0,3,2] row_mask:0xf bank_mask:0xf
    v_add_f32_dpp v53, v53, v53 quad_perm:[1,0,3,2] row_mask:0xf bank_mask:0xf
    v_add_f32_dpp v54, v54, v54 quad_perm:[1,0,3,2] row_mask:0xf bank_mask:0xf
    v_add_f32_dpp v55, v55, v55 quad_perm:[1,0,3,2] row_mask:0xf bank_mask:0xf
    v_add_f32_dpp v48, v48, v48 quad_perm:[2,3,0,1] row_mask:0xf bank_mask:0xf
    v_add_f32_dpp v49, v49, v49 quad_perm:[2,3,0,1] row_mask:0xf bank_mask:0xf
    v_add_f32_dpp v50, v50, v50 quad_perm:[2,3,0,1] row_mask:0xf bank_mask:0xf
    v_add_f32_dpp v51, v51, v51 quad_perm:[2,3,0,1] row_mask:0xf bank_mask:0xf
    v_add_f32_dpp v52, v52, v52 quad_perm:[2,3,0,1] row_mask:0xf bank_mask:0xf
    v_add_f32_dpp v53, v53, v53 quad_perm:[2,3,0,1] row_mask:0xf bank_mask:0xf
    v_add_f32_dpp v54, v54, v54 quad_perm:[2,3,0,1] row_mask:0xf bank_mask:0xf
    v_add_f32_dpp v55, v55, v55 quad_perm:[2,3,0,1] row_mask:0xf bank_mask:0xf
    v_add_f32_dpp v48, v48, v48 row_half_mirror row_mask:0xf bank_mask:0xf
    v_add_f32_dpp v49, v49, v49 row_half_mirror row_mask:0xf bank_mask:0xf
    v_add_f32_dpp v50, v50, v50 row_half_mirror row_mask:0xf bank_mask:0xf
    v_add_f32_dpp v51, v51, v51 row_half_mirror row_mask:0xf bank_mask:0xf
    v_add_f32_dpp v52, v52, v52 row_half_mirror row_mask:0xf bank_mask:0xf
    v_add_f32_dpp v53, v53, v53 row_half_mirror row_mask:0xf bank_mask:0xf
    v_add_f32_dpp v54, v54, v54 row_half_mirror row_mask:0xf bank_mask:0xf
    v_add_f32_dpp v55, v55, v55 row_half_mirror row_mask:0xf bank_mask:0xf
    s_mov_b32 exec_lo, 0x2020202
    s_mov_b32 exec_hi, 0x2020202
    v_mov_b32 v48, v50
    v_mov_b32 v49, v51
    s_mov_b32 exec_lo, 0x4040404
    s_mov_b32 exec_hi, 0x4040404
    v_mov_b32 v48, v52
    v_mov_b32 v49, v53
    s_mov_b32 exec_lo, 0x8080808
    s_mov_b32 exec_hi, 0x8080808
    v_mov_b32 v48, v54
    v_mov_b32 v49, v55
    s_mov_b32 exec_lo, 0x0f0f0f0f
    s_mov_b32 exec_hi, 0x0f0f0f0f
    buffer_store_dwordx2 v[48:49], v56, s[16:19], s46 offen sc1
    s_mov_b64 exec, -1
    s_branch L_job_end
L_reset:
    s_lshl_b32 s37, s53, 2
    s_add_u32 s37, s37, s32
    s_sub_u32 s37, s37, 512
    s_and_b32 s36, s37, 63
    s_cmp_lt_u32 s36, 16
    s_cselect_b32 s87, 34, 32
    s_cselect_b32 s39, 2, 3
    v_subrev_u32 v2, s39, v0
    v_cmp_gt_u32 vcc, s87, v2
    v_lshlrev_b32 v3, 17, v0
    s_lshl_b32 s38, s37, 10
    s_add_u32 s38, s38, 0x5440000
    v_cndmask_b32 v2, 0, -1, vcc
    s_lshl_b32 s37, s37, 8
    s_add_u32 s37, s37, 0x5500000
    s_add_u32 s87, s37, 65536
    s_cmp_ge_u32 s36, 44
    s_cselect_b32 s87, s87, 0x5e00000
    v_cmp_lt_u32 vcc, 1, v0
    v_mov_b32 v8, -1
    v_mov_b32 v9, -1
    v_mov_b32 v10, -1
    v_mov_b32 v11, -1
    v_cndmask_b32 v4, 0, -1, vcc
    s_mov_b32 exec_hi, 31
    buffer_load_dword v12, v3, s[16:19], s37 offen sc1
    buffer_load_dword v13, v3, s[16:19], s87 offen sc1
    s_waitcnt vmcnt(0)
    buffer_store_dword v2, v3, s[16:19], s37 offen sc1
    buffer_store_dword v4, v3, s[16:19], s87 offen sc1
    s_mov_b64 exec, -1
    buffer_store_dwordx4 v[8:11], v1, s[16:19], s38 offen sc1
L_job_end:
    s_mov_b32 s8, s82
    s_mov_b32 s9, s83
    s_mov_b32 s10, 0x100
    s_mov_b32 s11, 0x00020000
    v_mov_b32 v123, 1
    s_waitcnt vmcnt(0)
    s_barrier
    s_cmp_lg_u32 s32, 3
    s_cbranch_scc1 L_arr7
    buffer_atomic_add v123, v124, s[8:11], 0 offen sc0
    s_waitcnt vmcnt(0)
    v_readfirstlane_b32 s37, v123
    s_nop 0
    s_cmp_lg_u32 s37, 95
    s_cbranch_scc1 L_arr7
    buffer_store_dword v123, v124, s[8:11], 0 offen offset:128 sc1
L_arr7:
    s_mov_b32 s12, s66
    s_mov_b32 s13, s67
    s_mov_b32 s14, 0x600000
    s_mov_b32 s15, 0x00020000
    s_add_u32 s39, s44, 0
    buffer_load_dword v248, v6, s[12:15], s39 offen
    s_add_u32 s39, s44, 32768
    buffer_load_dword v249, v6, s[12:15], s39 offen
    s_mov_b32 s12, s68
    s_mov_b32 s13, s69
    s_mov_b32 s14, 0x200000
    s_mov_b32 s15, 0x00020000
    s_sub_u32 s44, 95, s51
    s_lshl_b32 s44, s44, 15
    s_add_u32 s44, s44, s90
    s_add_u32 s39, s44, 0
    buffer_load_dword v253, v6, s[12:15], s39 offen
    s_mov_b32 s12, s72
    s_mov_b32 s13, s73
    s_mov_b32 s14, 0x700000
    s_mov_b32 s15, 0x00020000
    s_mul_i32 s37, s48, 1920
    s_add_u32 s39, s37, s12
    s_sub_u32 s39, 0x180, s39
    s_and_b32 s39, s39, 0x380
    s_add_u32 s37, s37, s39
    s_mul_i32 s39, s51, 78848
    s_add_u32 s37, s37, s39
    v_lshrrev_b32 v7, 1, v0
    v_min_u32 v7, 10, v7
    v_mul_u32_u24 v7, 7168, v7
    v_and_b32 v5, 1, v0
    v_lshl_add_u32 v7, v5, 10, v7
    buffer_load_dword v255, v7, s[12:15], s37 offen
L_job_done:
    s_lshr_b32 s38, s47, 2
    s_cmp_eq_u32 s38, 0
    s_mov_b32 s34, 0x18100100
    s_cmp_eq_u32 s38, 1
    s_cselect_b32 s34, 0x2e2d2c19, s34
    s_cmp_eq_u32 s38, 2
    s_cselect_b32 s34, 0x1a110302, s34
    s_cmp_eq_u32 s38, 3
    s_cselect_b32 s34, 0x302f1c1b, s34
    s_cmp_eq_u32 s38, 4
    s_cselect_b32 s34, 0x1d120504, s34
    s_cmp_eq_u32 s38, 5
    s_cselect_b32 s34, 0x3332311e, s34
    s_cmp_eq_u32 s38, 6
    s_cselect_b32 s34, 0x1f130706, s34
    s_cmp_eq_u32 s38, 7
    s_cselect_b32 s34, 0x35342120, s34
    s_cmp_eq_u32 s38, 8
    s_cselect_b32 s34, 0x22140908, s34
    s_cmp_eq_u32 s38, 9
    s_cselect_b32 s34, 0x38373623, s34
    s_cmp_eq_u32 s38, 10
    s_cselect_b32 s34, 0x24150b0a, s34
    s_cmp_eq_u32 s38, 11
    s_cselect_b32 s34, 0x3a392625, s34
    s_cmp_eq_u32 s38, 12
    s_cselect_b32 s34, 0x27160d0c, s34
    s_cmp_eq_u32 s38, 13
    s_cselect_b32 s34, 0x3d3c3b28, s34
    s_cmp_eq_u32 s38, 14
    s_cselect_b32 s34, 0x29170f0e, s34
    s_cmp_eq_u32 s38, 15
    s_cselect_b32 s34, 0x3f3e2b2a, s34
    s_and_b32 s37, s47, 3
    s_lshl_b32 s37, s37, 3
    s_lshr_b32 s34, s34, s37
    s_and_b32 s34, s34, 63
    s_lshl_b32 s91, s33, 6
    s_add_u32 s91, s91, s34
    s_lshl_b32 s91, s91, 8
    s_add_u32 s91, s91, 0x5540000
    s_cmp_eq_u32 s32, 1
    s_cselect_b32 s91, s91, 0x5f00000
    s_cmp_ge_u32 s34, 60
    s_cbranch_scc1 L_role_60
    s_cmp_ge_u32 s34, 44
    s_cbranch_scc1 L_role_44
    s_cmp_ge_u32 s34, 43
    s_cbranch_scc1 L_role_43
    s_cmp_ge_u32 s34, 24
    s_cbranch_scc1 L_role_24
L_role_16:
    s_sub_u32 s35, s34, 16
    s_lshl_b32 s54, s35, 8
    s_mov_b32 s12, s68
    s_mov_b32 s13, s69
    s_mov_b32 s14, 0x200000
    s_mov_b32 s15, 0x00020000
    s_mov_b32 s39, 2048
    v_lshrrev_b32 v52, 3, v0
    v_lshlrev_b32 v53, 2, v0
    v_and_b32 v53, 64, v53
    v_and_b32 v54, 0x70, v1
    v_xor_b32 v53, v53, v54
    v_mad_u32_u24 v44, v52, s39, v53
    v_add_u32 v45, 16384, v44
    v_add_u32 v46, 128, v44
    v_add_u32 v47, 16512, v44
    s_mul_i32 s38, s32, 32768
    s_add_u32 s54, s54, s38
    s_lshl_b32 s42, s32, 11
    s_add_u32 m0, s42, 0
    s_nop 0
    buffer_load_dwordx4 v44, s[12:15], s54 offen lds
    s_add_u32 m0, s42, 1024
    s_nop 0
    buffer_load_dwordx4 v45, s[12:15], s54 offen lds
    s_add_u32 m0, s42, 8192
    s_nop 0
    buffer_load_dwordx4 v46, s[12:15], s54 offen lds
    s_add_u32 m0, s42, 9216
    s_nop 0
    buffer_load_dwordx4 v47, s[12:15], s54 offen lds
    s_add_u32 s54, s54, 131072
    s_add_u32 m0, s42, 16384
    s_nop 0
    buffer_load_dwordx4 v44, s[12:15], s54 offen lds
    s_add_u32 m0, s42, 17408
    s_nop 0
    buffer_load_dwordx4 v45, s[12:15], s54 offen lds
    s_add_u32 m0, s42, 24576
    s_nop 0
    buffer_load_dwordx4 v46, s[12:15], s54 offen lds
    s_add_u32 m0, s42, 25600
    s_nop 0
    buffer_load_dwordx4 v47, s[12:15], s54 offen lds
    s_add_u32 s54, s54, 131072
    s_add_u32 m0, s42, 32768
    s_nop 0
    buffer_load_dwordx4 v44, s[12:15], s54 offen lds
    s_add_u32 m0, s42, 33792
    s_nop 0
    buffer_load_dwordx4 v45, s[12:15], s54 offen lds
    s_add_u32 m0, s42, 40960
    s_nop 0
    buffer_load_dwordx4 v46, s[12:15], s54 offen lds
    s_add_u32 m0, s42, 41984
    s_nop 0
    buffer_load_dwordx4 v47, s[12:15], s54 offen lds
    s_add_u32 s54, s54, 131072
    s_add_u32 m0, s42, 49152
    s_nop 0
    buffer_load_dwordx4 v44, s[12:15], s54 offen lds
    s_add_u32 m0, s42, 50176
    s_nop 0
    buffer_load_dwordx4 v45, s[12:15], s54 offen lds
    s_add_u32 m0, s42, 57344
    s_nop 0
    buffer_load_dwordx4 v46, s[12:15], s54 offen lds
    s_add_u32 m0, s42, 58368
    s_nop 0
    buffer_load_dwordx4 v47, s[12:15], s54 offen lds
    s_add_u32 s54, s54, 131072
    s_add_u32 m0, s42, 65536
    s_nop 0
    buffer_load_dwordx4 v44, s[12:15], s54 offen lds
    s_add_u32 m0, s42, 66560
    s_nop 0
    buffer_load_dwordx4 v45, s[12:15], s54 offen lds
    s_add_u32 m0, s42, 73728
    s_nop 0
    buffer_load_dwordx4 v46, s[12:15], s54 offen lds
    s_add_u32 m0, s42, 74752
    s_nop 0
    buffer_load_dwordx4 v47, s[12:15], s54 offen lds
    s_add_u32 s54, s54, 131072
    v_lshrrev_b32 v52, 4, v0
    v_bfe_u32 v53, v0, 2, 2
    v_lshl_add_u32 v52, v52, 3, v53
    v_lshlrev_b32 v52, 7, v52
    v_lshrrev_b32 v53, 1, v53
    v_lshl_add_u32 v52, v53, 6, v52
    v_and_b32 v53, 3, v0
    v_lshl_add_u32 v52, v53, 4, v52
    s_lshr_b32 s37, s32, 1
    s_lshl_b32 s37, s37, 13
    s_and_b32 s38, s32, 1
    s_lshl_b32 s38, s38, 6
    s_add_u32 s37, s37, s38
    s_add_u32 s37, s37, 0
    v_xor_b32 v48, s37, v52
    s_lshr_b32 s37, s32, 1
    s_lshl_b32 s37, s37, 13
    s_and_b32 s38, s32, 1
    s_lshl_b32 s38, s38, 6
    s_add_u32 s37, s37, s38
    s_add_u32 s37, s37, 8
    v_xor_b32 v49, s37, v52
    v_add_u32 v2, 98304, v1
    v_mov_b32 v108, 0
    v_mov_b32 v109, 0
    v_mov_b32 v110, 0
    v_mov_b32 v111, 0
    v_mov_b32 v112, 0
    v_mov_b32 v113, 0
    v_mov_b32 v114, 0
    v_mov_b32 v115, 0
    v_mov_b32 v13, 0x3f80
    v_and_b32 v12, 1, v0
    v_lshlrev_b32 v12, 4, v12
    v_lshlrev_b32 v12, v12, v13
    s_mov_b32 exec_lo, 0x300003
    s_mov_b32 exec_hi, 0x30000300
    v_mov_b32 v108, v12
    v_mov_b32 v114, v12
    s_mov_b32 exec_lo, 0xc0000c
    s_mov_b32 exec_hi, 0xc0000c00
    v_mov_b32 v109, v12
    v_mov_b32 v115, v12
    s_mov_b64 exec, -1
    s_lshl_b32 s37, s33, 6
    s_add_u32 s37, s37, 0
    s_lshl_b32 s37, s37, 8
    v_lshl_add_u32 v4, v0, 8, s37
    s_cmp_eq_u32 s32, 0
    s_cselect_b32 s37, 16, 0
    v_cmp_le_u32 vcc, s37, v0
    s_nop 1
    v_cndmask_b32 v4, v4, 2.0, vcc
    s_mov_b32 s86, 0x3f803f80
    s_lshl_b32 s43, s32, 12
    s_mul_i32 s41, s33, 2097152
    s_add_u32 s41, s41, 0x0
    s_add_u32 s41, s41, s43
    s_lshl_b32 s38, s35, 2
    s_add_u32 s38, s38, s32
    s_mul_i32 s90, s33, 2097152
    s_add_u32 s90, s90, 0x7f0000
    s_lshl_b32 s37, s38, 11
    s_add_u32 s90, s90, s37
    v_and_b32 v12, 15, v0
    v_and_b32 v13, 0x30, v0
    v_lshl_add_u32 v3, v12, 11, v13
    s_lshl_b32 s37, s38, 6
    v_add_u32 v3, s37, v3
    s_lshl_b32 s50, s33, 20
    s_add_u32 s50, s50, 983040
    s_add_u32 s88, s84, 0x5000000
    s_addc_u32 s89, s85, 0
    s_mov_b32 s8, s64
    s_mov_b32 s9, s65
    s_mov_b32 s10, 0x400000
    s_mov_b32 s11, 0x00020000
    v_bfe_u32 v13, v0, 4, 1
    v_lshl_add_u32 v12, v12, 1, v13
    s_lshl_b32 s37, s32, 2
    s_add_u32 s37, s37, 65536
    v_lshl_add_u32 v6, v12, 4, s37
    v_add_u32 v7, 65536, v1
    v_and_b32 v12, 31, v0
    v_lshrrev_b32 v13, 5, v0
    v_lshlrev_b32 v12, 2, v12
    v_lshl_add_u32 v8, v13, 10, v12
    s_mul_i32 s46, s33, 65536
    s_add_u32 s46, s46, 0x543f800
    s_lshl_b32 s37, s35, 7
    s_add_u32 s46, s46, s37
    s_cmp_eq_u32 s32, 2
    s_cselect_b32 s46, s46, 0x5e00000
    s_mov_b32 s36, -1
    v_add_u32 v50, 0, v48
    v_add_u32 v51, 0, v49
    s_waitcnt vmcnt(16)
    s_barrier
    ds_read_b64_tr_b16 a[0:1], v50 offset:0
    ds_read_b64_tr_b16 a[2:3], v50 offset:512
    ds_read_b64_tr_b16 a[4:5], v51 offset:0
    ds_read_b64_tr_b16 a[6:7], v51 offset:512
    ds_read_b64_tr_b16 a[8:9], v50 offset:4096
    ds_read_b64_tr_b16 a[10:11], v50 offset:4608
    ds_read_b64_tr_b16 a[12:13], v51 offset:4096
    ds_read_b64_tr_b16 a[14:15], v51 offset:4608
    s_add_u32 m0, s42, 81920
    s_nop 0
    buffer_load_dwordx4 v44, s[12:15], s54 offen lds
    s_add_u32 m0, s42, 82944
    s_nop 0
    buffer_load_dwordx4 v45, s[12:15], s54 offen lds
    s_add_u32 m0, s42, 90112
    s_nop 0
    buffer_load_dwordx4 v46, s[12:15], s54 offen lds
    s_add_u32 m0, s42, 91136
    s_nop 0
    buffer_load_dwordx4 v47, s[12:15], s54 offen lds
    s_add_u32 s54, s54, 131072
    s_waitcnt lgkmcnt(0)
    v_add_u32 v50, 16384, v48
    v_add_u32 v51, 16384, v49
    s_waitcnt vmcnt(16)
    s_barrier
    ds_read_b64_tr_b16 a[16:17], v50 offset:0
    ds_read_b64_tr_b16 a[18:19], v50 offset:512
    ds_read_b64_tr_b16 a[20:21], v51 offset:0
    ds_read_b64_tr_b16 a[22:23], v51 offset:512
    ds_read_b64_tr_b16 a[24:25], v50 offset:4096
    ds_read_b64_tr_b16 a[26:27], v50 offset:4608
    ds_read_b64_tr_b16 a[28:29], v51 offset:4096
    ds_read_b64_tr_b16 a[30:31], v51 offset:4608
    s_add_u32 m0, s42, 0
    s_nop 0
    buffer_load_dwordx4 v44, s[12:15], s54 offen lds
    s_add_u32 m0, s42, 1024
    s_nop 0
    buffer_load_dwordx4 v45, s[12:15], s54 offen lds
    s_add_u32 m0, s42, 8192
    s_nop 0
    buffer_load_dwordx4 v46, s[12:15], s54 offen lds
    s_add_u32 m0, s42, 9216
    s_nop 0
    buffer_load_dwordx4 v47, s[12:15], s54 offen lds
    s_add_u32 s54, s54, 131072
    s_waitcnt lgkmcnt(0)
    v_add_u32 v50, 32768, v48
    v_add_u32 v51, 32768, v49
    s_waitcnt vmcnt(16)
    s_barrier
    ds_read_b64_tr_b16 a[32:33], v50 offset:0
    ds_read_b64_tr_b16 a[34:35], v50 offset:512
    ds_read_b64_tr_b16 a[36:37], v51 offset:0
    ds_read_b64_tr_b16 a[38:39], v51 offset:512
    ds_read_b64_tr_b16 a[40:41], v50 offset:4096
    ds_read_b64_tr_b16 a[42:43], v50 offset:4608
    ds_read_b64_tr_b16 a[44:45], v51 offset:4096
    ds_read_b64_tr_b16 a[46:47], v51 offset:4608
    s_add_u32 m0, s42, 16384
    s_nop 0
    buffer_load_dwordx4 v44, s[12:15], s54 offen lds
    s_add_u32 m0, s42, 17408
    s_nop 0
    buffer_load_dwordx4 v45, s[12:15], s54 offen lds
    s_add_u32 m0, s42, 24576
    s_nop 0
    buffer_load_dwordx4 v46, s[12:15], s54 offen lds
    s_add_u32 m0, s42, 25600
    s_nop 0
    buffer_load_dwordx4 v47, s[12:15], s54 offen lds
    s_add_u32 s54, s54, 131072
    s_waitcnt lgkmcnt(0)
    v_add_u32 v50, 49152, v48
    v_add_u32 v51, 49152, v49
    s_waitcnt vmcnt(16)
    s_barrier
    ds_read_b64_tr_b16 a[48:49], v50 offset:0
    ds_read_b64_tr_b16 a[50:51], v50 offset:512
    ds_read_b64_tr_b16 a[52:53], v51 offset:0
    ds_read_b64_tr_b16 a[54:55], v51 offset:512
    ds_read_b64_tr_b16 a[56:57], v50 offset:4096
    ds_read_b64_tr_b16 a[58:59], v50 offset:4608
    ds_read_b64_tr_b16 a[60:61], v51 offset:4096
    ds_read_b64_tr_b16 a[62:63], v51 offset:4608
    s_add_u32 m0, s42, 32768
    s_nop 0
    buffer_load_dwordx4 v44, s[12:15], s54 offen lds
    s_add_u32 m0, s42, 33792
    s_nop 0
    buffer_load_dwordx4 v45, s[12:15], s54 offen lds
    s_add_u32 m0, s42, 40960
    s_nop 0
    buffer_load_dwordx4 v46, s[12:15], s54 offen lds
    s_add_u32 m0, s42, 41984
    s_nop 0
    buffer_load_dwordx4 v47, s[12:15], s54 offen lds
    s_add_u32 s54, s54, 131072
    s_waitcnt lgkmcnt(0)
    v_add_u32 v50, 65536, v48
    v_add_u32 v51, 65536, v49
    s_waitcnt vmcnt(16)
    s_barrier
    ds_read_b64_tr_b16 a[64:65], v50 offset:0
    ds_read_b64_tr_b16 a[66:67], v50 offset:512
    ds_read_b64_tr_b16 a[68:69], v51 offset:0
    ds_read_b64_tr_b16 a[70:71], v51 offset:512
    ds_read_b64_tr_b16 a[72:73], v50 offset:4096
    ds_read_b64_tr_b16 a[74:75], v50 offset:4608
    ds_read_b64_tr_b16 a[76:77], v51 offset:4096
    ds_read_b64_tr_b16 a[78:79], v51 offset:4608
    s_add_u32 m0, s42, 49152
    s_nop 0
    buffer_load_dwordx4 v44, s[12:15], s54 offen lds
    s_add_u32 m0, s42, 50176
    s_nop 0
    buffer_load_dwordx4 v45, s[12:15], s54 offen lds
    s_add_u32 m0, s42, 57344
    s_nop 0
    buffer_load_dwordx4 v46, s[12:15], s54 offen lds
    s_add_u32 m0, s42, 58368
    s_nop 0
    buffer_load_dwordx4 v47, s[12:15], s54 offen lds
    s_add_u32 s54, s54, 131072
    s_waitcnt lgkmcnt(0)
    v_add_u32 v50, 81920, v48
    v_add_u32 v51, 81920, v49
    s_waitcnt vmcnt(16)
    s_barrier
    ds_read_b64_tr_b16 a[80:81], v50 offset:0
    ds_read_b64_tr_b16 a[82:83], v50 offset:512
    ds_read_b64_tr_b16 a[84:85], v51 offset:0
    ds_read_b64_tr_b16 a[86:87], v51 offset:512
    ds_read_b64_tr_b16 a[88:89], v50 offset:4096
    ds_read_b64_tr_b16 a[90:91], v50 offset:4608
    ds_read_b64_tr_b16 a[92:93], v51 offset:4096
    ds_read_b64_tr_b16 a[94:95], v51 offset:4608
    s_add_u32 m0, s42, 65536
    s_nop 0
    buffer_load_dwordx4 v44, s[12:15], s54 offen lds
    s_add_u32 m0, s42, 66560
    s_nop 0
    buffer_load_dwordx4 v45, s[12:15], s54 offen lds
    s_add_u32 m0, s42, 73728
    s_nop 0
    buffer_load_dwordx4 v46, s[12:15], s54 offen lds
    s_add_u32 m0, s42, 74752
    s_nop 0
    buffer_load_dwordx4 v47, s[12:15], s54 offen lds
    s_add_u32 s54, s54, 131072
    s_waitcnt lgkmcnt(0)
    v_add_u32 v50, 0, v48
    v_add_u32 v51, 0, v49
    s_waitcnt vmcnt(16)
    s_barrier
    ds_read_b64_tr_b16 a[96:97], v50 offset:0
    ds_read_b64_tr_b16 a[98:99], v50 offset:512
    ds_read_b64_tr_b16 a[100:101], v51 offset:0
    ds_read_b64_tr_b16 a[102:103], v51 offset:512
    ds_read_b64_tr_b16 a[104:105], v50 offset:4096
    ds_read_b64_tr_b16 a[106:107], v50 offset:4608
    ds_read_b64_tr_b16 a[108:109], v51 offset:4096
    ds_read_b64_tr_b16 a[110:111], v51 offset:4608
    s_add_u32 m0, s42, 81920
    s_nop 0
    buffer_load_dwordx4 v44, s[12:15], s54 offen lds
    s_add_u32 m0, s42, 82944
    s_nop 0
    buffer_load_dwordx4 v45, s[12:15], s54 offen lds
    s_add_u32 m0, s42, 90112
    s_nop 0
    buffer_load_dwordx4 v46, s[12:15], s54 offen lds
    s_add_u32 m0, s42, 91136
    s_nop 0
    buffer_load_dwordx4 v47, s[12:15], s54 offen lds
    s_add_u32 s54, s54, 131072
    s_waitcnt lgkmcnt(0)
    v_add_u32 v50, 16384, v48
    v_add_u32 v51, 16384, v49
    s_waitcnt vmcnt(16)
    s_barrier
    ds_read_b64_tr_b16 a[112:113], v50 offset:0
    ds_read_b64_tr_b16 a[114:115], v50 offset:512
    ds_read_b64_tr_b16 a[116:117], v51 offset:0
    ds_read_b64_tr_b16 a[118:119], v51 offset:512
    ds_read_b64_tr_b16 a[120:121], v50 offset:4096
    ds_read_b64_tr_b16 a[122:123], v50 offset:4608
    ds_read_b64_tr_b16 a[124:125], v51 offset:4096
    ds_read_b64_tr_b16 a[126:127], v51 offset:4608
    s_add_u32 m0, s42, 0
    s_nop 0
    buffer_load_dwordx4 v44, s[12:15], s54 offen lds
    s_add_u32 m0, s42, 1024
    s_nop 0
    buffer_load_dwordx4 v45, s[12:15], s54 offen lds
    s_add_u32 m0, s42, 8192
    s_nop 0
    buffer_load_dwordx4 v46, s[12:15], s54 offen lds
    s_add_u32 m0, s42, 9216
    s_nop 0
    buffer_load_dwordx4 v47, s[12:15], s54 offen lds
    s_add_u32 s54, s54, 131072
    s_waitcnt lgkmcnt(0)
    v_add_u32 v50, 32768, v48
    v_add_u32 v51, 32768, v49
    s_waitcnt vmcnt(16)
    s_barrier
    ds_read_b64_tr_b16 a[128:129], v50 offset:0
    ds_read_b64_tr_b16 a[130:131], v50 offset:512
    ds_read_b64_tr_b16 a[132:133], v51 offset:0
    ds_read_b64_tr_b16 a[134:135], v51 offset:512
    ds_read_b64_tr_b16 a[136:137], v50 offset:4096
    ds_read_b64_tr_b16 a[138:139], v50 offset:4608
    ds_read_b64_tr_b16 a[140:141], v51 offset:4096
    ds_read_b64_tr_b16 a[142:143], v51 offset:4608
    s_add_u32 m0, s42, 16384
    s_nop 0
    buffer_load_dwordx4 v44, s[12:15], s54 offen lds
    s_add_u32 m0, s42, 17408
    s_nop 0
    buffer_load_dwordx4 v45, s[12:15], s54 offen lds
    s_add_u32 m0, s42, 24576
    s_nop 0
    buffer_load_dwordx4 v46, s[12:15], s54 offen lds
    s_add_u32 m0, s42, 25600
    s_nop 0
    buffer_load_dwordx4 v47, s[12:15], s54 offen lds
    s_add_u32 s54, s54, 131072
    s_waitcnt lgkmcnt(0)
    v_add_u32 v50, 49152, v48
    v_add_u32 v51, 49152, v49
    s_waitcnt vmcnt(16)
    s_barrier
    ds_read_b64_tr_b16 a[144:145], v50 offset:0
    ds_read_b64_tr_b16 a[146:147], v50 offset:512
    ds_read_b64_tr_b16 a[148:149], v51 offset:0
    ds_read_b64_tr_b16 a[150:151], v51 offset:512
    ds_read_b64_tr_b16 a[152:153], v50 offset:4096
    ds_read_b64_tr_b16 a[154:155], v50 offset:4608
    ds_read_b64_tr_b16 a[156:157], v51 offset:4096
    ds_read_b64_tr_b16 a[158:159], v51 offset:4608
    s_add_u32 m0, s42, 32768
    s_nop 0
    buffer_load_dwordx4 v44, s[12:15], s54 offen lds
    s_add_u32 m0, s42, 33792
    s_nop 0
    buffer_load_dwordx4 v45, s[12:15], s54 offen lds
    s_add_u32 m0, s42, 40960
    s_nop 0
    buffer_load_dwordx4 v46, s[12:15], s54 offen lds
    s_add_u32 m0, s42, 41984
    s_nop 0
    buffer_load_dwordx4 v47, s[12:15], s54 offen lds
    s_add_u32 s54, s54, 131072
    s_waitcnt lgkmcnt(0)
    v_add_u32 v50, 65536, v48
    v_add_u32 v51, 65536, v49
    s_waitcnt vmcnt(16)
    s_barrier
    ds_read_b64_tr_b16 a[160:161], v50 offset:0
    ds_read_b64_tr_b16 a[162:163], v50 offset:512
    ds_read_b64_tr_b16 a[164:165], v51 offset:0
    ds_read_b64_tr_b16 a[166:167], v51 offset:512
    ds_read_b64_tr_b16 a[168:169], v50 offset:4096
    ds_read_b64_tr_b16 a[170:171], v50 offset:4608
    ds_read_b64_tr_b16 a[172:173], v51 offset:4096
    ds_read_b64_tr_b16 a[174:175], v51 offset:4608
    s_add_u32 m0, s42, 49152
    s_nop 0
    buffer_load_dwordx4 v44, s[12:15], s54 offen lds
    s_add_u32 m0, s42, 50176
    s_nop 0
    buffer_load_dwordx4 v45, s[12:15], s54 offen lds
    s_add_u32 m0, s42, 57344
    s_nop 0
    buffer_load_dwordx4 v46, s[12:15], s54 offen lds
    s_add_u32 m0, s42, 58368
    s_nop 0
    buffer_load_dwordx4 v47, s[12:15], s54 offen lds
    s_add_u32 s54, s54, 131072
    s_waitcnt lgkmcnt(0)
    v_add_u32 v50, 81920, v48
    v_add_u32 v51, 81920, v49
    s_waitcnt vmcnt(16)
    s_barrier
    ds_read_b64_tr_b16 a[176:177], v50 offset:0
    ds_read_b64_tr_b16 a[178:179], v50 offset:512
    ds_read_b64_tr_b16 a[180:181], v51 offset:0
    ds_read_b64_tr_b16 a[182:183], v51 offset:512
    ds_read_b64_tr_b16 a[184:185], v50 offset:4096
    ds_read_b64_tr_b16 a[186:187], v50 offset:4608
    ds_read_b64_tr_b16 a[188:189], v51 offset:4096
    ds_read_b64_tr_b16 a[190:191], v51 offset:4608
    s_waitcnt lgkmcnt(0)
    v_add_u32 v50, 0, v48
    v_add_u32 v51, 0, v49
    s_waitcnt vmcnt(12)
    s_barrier
    ds_read_b64_tr_b16 a[192:193], v50 offset:0
    ds_read_b64_tr_b16 a[194:195], v50 offset:512
    ds_read_b64_tr_b16 a[196:197], v51 offset:0
    ds_read_b64_tr_b16 a[198:199], v51 offset:512
    ds_read_b64_tr_b16 a[200:201], v50 offset:4096
    ds_read_b64_tr_b16 a[202:203], v50 offset:4608
    ds_read_b64_tr_b16 a[204:205], v51 offset:4096
    ds_read_b64_tr_b16 a[206:207], v51 offset:4608
    s_waitcnt lgkmcnt(0)
    v_add_u32 v50, 16384, v48
    v_add_u32 v51, 16384, v49
    s_waitcnt vmcnt(8)
    s_barrier
    ds_read_b64_tr_b16 a[208:209], v50 offset:0
    ds_read_b64_tr_b16 a[210:211], v50 offset:512
    ds_read_b64_tr_b16 a[212:213], v51 offset:0
    ds_read_b64_tr_b16 a[214:215], v51 offset:512
    ds_read_b64_tr_b16 a[216:217], v50 offset:4096
    ds_read_b64_tr_b16 a[218:219], v50 offset:4608
    ds_read_b64_tr_b16 a[220:221], v51 offset:4096
    ds_read_b64_tr_b16 a[222:223], v51 offset:4608
    s_waitcnt lgkmcnt(0)
    v_add_u32 v50, 32768, v48
    v_add_u32 v51, 32768, v49
    s_waitcnt vmcnt(4)
    s_barrier
    ds_read_b64_tr_b16 a[224:225], v50 offset:0
    ds_read_b64_tr_b16 a[226:227], v50 offset:512
    ds_read_b64_tr_b16 a[228:229], v51 offset:0
    ds_read_b64_tr_b16 a[230:231], v51 offset:512
    ds_read_b64_tr_b16 a[232:233], v50 offset:4096
    ds_read_b64_tr_b16 a[234:235], v50 offset:4608
    ds_read_b64_tr_b16 a[236:237], v51 offset:4096
    ds_read_b64_tr_b16 a[238:239], v51 offset:4608
    s_waitcnt lgkmcnt(0)
    v_add_u32 v50, 49152, v48
    v_add_u32 v51, 49152, v49
    s_waitcnt vmcnt(0)
    s_barrier
    ds_read_b64_tr_b16 a[240:241], v50 offset:0
    ds_read_b64_tr_b16 a[242:243], v50 offset:512
    ds_read_b64_tr_b16 a[244:245], v51 offset:0
    ds_read_b64_tr_b16 a[246:247], v51 offset:512
    ds_read_b64_tr_b16 a[248:249], v50 offset:4096
    ds_read_b64_tr_b16 a[250:251], v50 offset:4608
    ds_read_b64_tr_b16 a[252:253], v51 offset:4096
    ds_read_b64_tr_b16 a[254:255], v51 offset:4608
    s_waitcnt lgkmcnt(0)
    s_barrier
    s_cmp_lg_u32 s32, 0
    s_cbranch_scc1 L_arv8
    s_add_u32 s20, s82, 0x80
    s_addc_u32 s21, s83, 0
    s_mov_b32 s22, 0x4
    s_mov_b32 s23, 0x00020000
    buffer_load_dword v12, v124, s[20:23], 0 offen sc1
    s_waitcnt vmcnt(0)
    v_cmp_eq_u32 vcc, v124, v12
    s_cbranch_vccnz L_spin9
L_back10:
L_arv8:
    s_add_u32 s96, s41, 2031616
    s_mov_b32 s98, s41
    s_mov_b32 s45, 0x5580000
    buffer_load_dword v136, v4, s[16:19], s45 offen sc1
    s_waitcnt vmcnt(0)
    v_cmp_ne_u32 vcc, 0, v136
    s_cbranch_vccnz L_spin11
L_back12:
    s_barrier
    s_add_u32 m0, s43, 0
    s_add_u32 s42, s41, 0
    buffer_load_dwordx4 v1, s[16:19], s42 offen offset:0 sc1 lds
    buffer_load_dwordx4 v1, s[16:19], s42 offen offset:1024 sc1 lds
    buffer_load_dwordx4 v1, s[16:19], s42 offen offset:2048 sc1 lds
    buffer_load_dwordx4 v1, s[16:19], s42 offen offset:3072 sc1 lds
    s_add_u32 m0, s43, 16384
    s_add_u32 s42, s41, 16384
    buffer_load_dwordx4 v1, s[16:19], s42 offen offset:0 sc1 lds
    buffer_load_dwordx4 v1, s[16:19], s42 offen offset:1024 sc1 lds
    buffer_load_dwordx4 v1, s[16:19], s42 offen offset:2048 sc1 lds
    buffer_load_dwordx4 v1, s[16:19], s42 offen offset:3072 sc1 lds
    s_add_u32 s45, s45, 131072
    s_add_u32 s47, s36, 1
    s_min_u32 s47, s47, 31
    s_cmp_ge_u32 s47, 16
    s_cselect_b32 s8, s88, s64
    s_cselect_b32 s9, s89, s65
    s_and_b32 s47, s47, 15
    s_lshl_b32 s47, s47, 16
    s_sub_u32 s47, s50, s47
    s_add_u32 s48, s47, 32768
    buffer_load_dwordx4 v[128:131], v3, s[8:11], s48 offen sc1
    buffer_load_dwordx4 v[132:135], v3, s[8:11], s47 offen sc1
    s_waitcnt vmcnt(0) lgkmcnt(0)
    s_barrier
    v_mfma_f32_16x16x32_bf16 v[12:15], v[108:111], v[128:131], 0
    v_mfma_f32_16x16x32_bf16 v[16:19], v[112:115], v[128:131], 0
    v_mfma_f32_16x16x32_bf16 v[20:23], v[108:111], v[132:135], 0
    v_mfma_f32_16x16x32_bf16 v[24:27], v[112:115], v[132:135], 0
    ds_read_b128 v[44:47], v1 offset:0
    ds_read_b128 v[48:51], v1 offset:1024
    ds_read_b128 v[52:55], v1 offset:2048
    ds_read_b128 v[56:59], v1 offset:3072
    s_mov_b32 s36, 0
    s_waitcnt lgkmcnt(0)
    s_nop 7
L_o_b0:
    s_waitcnt lgkmcnt(2)
    v_mfma_f32_16x16x32_bf16 v[12:15], a[0:3], v[44:47], v[12:15]
    s_and_b32 s44, s90, 0xffffffff
    ds_read_b128 v[60:63], v1 offset:4096
    s_cmp_eq_u32 s36, 0
    v_mfma_f32_16x16x32_bf16 v[20:23], a[0:3], v[48:51], v[20:23]
    s_cselect_b32 s44, 0x5e00000, s44
    s_cselect_b32 s49, 0x5e00000, s46
    v_cvt_pk_bf16_f32 v148, v28, v29
    v_mfma_f32_16x16x32_bf16 v[24:27], a[4:7], v[48:51], v[24:27]
    s_add_u32 m0, s43, 32768
    ds_read_b128 v[64:67], v1 offset:5120
    v_cvt_pk_bf16_f32 v149, v30, v31
    v_mfma_f32_16x16x32_bf16 v[16:19], a[4:7], v[44:47], v[16:19]
    s_waitcnt lgkmcnt(2)
    v_cvt_pk_bf16_f32 v150, v32, v33
    v_cvt_pk_bf16_f32 v151, v34, v35
    v_mfma_f32_16x16x32_bf16 v[12:15], a[8:11], v[52:55], v[12:15]
    s_add_u32 s42, s41, 32768
    ds_read_b128 v[68:71], v1 offset:6144
    buffer_store_dwordx4 v[148:151], v1, s[16:19], s44 offen offset:0 sc1
    v_mfma_f32_16x16x32_bf16 v[20:23], a[8:11], v[56:59], v[20:23]
    v_cvt_pk_bf16_f32 v152, v36, v37
    v_cvt_pk_bf16_f32 v153, v38, v39
    v_mfma_f32_16x16x32_bf16 v[24:27], a[12:15], v[56:59], v[24:27]
    ds_read_b128 v[72:75], v1 offset:7168
    v_cvt_pk_bf16_f32 v154, v40, v41
    v_mfma_f32_16x16x32_bf16 v[16:19], a[12:15], v[52:55], v[16:19]
    s_waitcnt lgkmcnt(2)
    v_cvt_pk_bf16_f32 v155, v42, v43
    buffer_store_dwordx4 v[152:155], v1, s[16:19], s44 offen offset:1024 sc1
    v_mfma_f32_16x16x32_bf16 v[12:15], a[16:19], v[60:63], v[12:15]
    ds_read_b128 v[44:47], v1 offset:8192
    buffer_load_dwordx4 v1, s[16:19], s42 offen offset:0 sc1 lds
    v_mfma_f32_16x16x32_bf16 v[20:23], a[16:19], v[64:67], v[20:23]
    v_add_f32 v140, v28, v29
    v_mul_f32 v141, v28, v28
    v_mfma_f32_16x16x32_bf16 v[24:27], a[20:23], v[64:67], v[24:27]
    ds_read_b128 v[48:51], v1 offset:9216
    buffer_load_dwordx4 v1, s[16:19], s42 offen offset:1024 sc1 lds
    v_mfma_f32_16x16x32_bf16 v[16:19], a[20:23], v[60:63], v[16:19]
    s_waitcnt lgkmcnt(2)
    v_fmac_f32 v141, v29, v29
    v_add_f32 v140, v140, v30
    v_mfma_f32_16x16x32_bf16 v[12:15], a[24:27], v[68:71], v[12:15]
    s_add_u32 s47, s36, 1
    ds_read_b128 v[52:55], v1 offset:10240
    buffer_load_dwordx4 v1, s[16:19], s42 offen offset:2048 sc1 lds
    v_mfma_f32_16x16x32_bf16 v[20:23], a[24:27], v[72:75], v[20:23]
    s_min_u32 s47, s47, 31
    v_fmac_f32 v141, v30, v30
    v_add_f32 v140, v140, v31
    v_mfma_f32_16x16x32_bf16 v[24:27], a[28:31], v[72:75], v[24:27]
    s_cmp_ge_u32 s47, 16
    ds_read_b128 v[56:59], v1 offset:11264
    buffer_load_dwordx4 v1, s[16:19], s42 offen offset:3072 sc1 lds
    v_mfma_f32_16x16x32_bf16 v[16:19], a[28:31], v[68:71], v[16:19]
    s_waitcnt lgkmcnt(2)
    v_fmac_f32 v141, v31, v31
    v_add_f32 v140, v140, v32
    v_mfma_f32_16x16x32_bf16 v[12:15], a[32:35], v[44:47], v[12:15]
    s_cselect_b32 s8, s88, s64
    ds_read_b128 v[60:63], v1 offset:12288
    v_fmac_f32 v141, v32, v32
    v_mfma_f32_16x16x32_bf16 v[20:23], a[32:35], v[48:51], v[20:23]
    s_cselect_b32 s9, s89, s65
    v_add_f32 v140, v140, v33
    v_fmac_f32 v141, v33, v33
    v_mfma_f32_16x16x32_bf16 v[24:27], a[36:39], v[48:51], v[24:27]
    s_add_u32 m0, s43, 49152
    ds_read_b128 v[64:67], v1 offset:13312
    v_add_f32 v140, v140, v34
    v_mfma_f32_16x16x32_bf16 v[16:19], a[36:39], v[44:47], v[16:19]
    s_waitcnt lgkmcnt(2)
    v_fmac_f32 v141, v34, v34
    v_add_f32 v140, v140, v35
    v_mfma_f32_16x16x32_bf16 v[12:15], a[40:43], v[52:55], v[12:15]
    s_add_u32 s42, s41, 49152
    ds_read_b128 v[68:71], v1 offset:14336
    buffer_load_dwordx4 v1, s[16:19], s42 offen offset:0 sc1 lds
    v_mfma_f32_16x16x32_bf16 v[20:23], a[40:43], v[56:59], v[20:23]
    s_and_b32 s47, s47, 15
    v_fmac_f32 v141, v35, v35
    s_lshl_b32 s47, s47, 16
    v_mfma_f32_16x16x32_bf16 v[24:27], a[44:47], v[56:59], v[24:27]
    s_sub_u32 s47, s50, s47
    ds_read_b128 v[72:75], v1 offset:15360
    buffer_load_dwordx4 v1, s[16:19], s42 offen offset:1024 sc1 lds
    v_mfma_f32_16x16x32_bf16 v[16:19], a[44:47], v[52:55], v[16:19]
    s_waitcnt vmcnt(8) lgkmcnt(2)
    s_barrier
    v_permlane16_swap_b32 v140, v141
    v_mfma_f32_16x16x32_bf16 v[12:15], a[48:51], v[60:63], v[12:15]
    s_add_u32 s48, s47, 32768
    ds_read_b128 v[44:47], v1 offset:16384
    buffer_load_dwordx4 v1, s[16:19], s42 offen offset:2048 sc1 lds
    v_mfma_f32_16x16x32_bf16 v[20:23], a[48:51], v[64:67], v[20:23]
    v_add_f32 v140, v140, v141
    v_mov_b32 v142, v140
    v_mfma_f32_16x16x32_bf16 v[24:27], a[52:55], v[64:67], v[24:27]
    ds_read_b128 v[48:51], v1 offset:17408
    buffer_load_dwordx4 v1, s[16:19], s42 offen offset:3072 sc1 lds
    v_mfma_f32_16x16x32_bf16 v[16:19], a[52:55], v[60:63], v[16:19]
    s_waitcnt lgkmcnt(2)
    v_permlane32_swap_b32 v140, v142
    v_mfma_f32_16x16x32_bf16 v[12:15], a[56:59], v[68:71], v[12:15]
    s_add_u32 s98, s98, 65536
    ds_read_b128 v[52:55], v1 offset:18432
    v_add_f32 v140, v140, v142
    v_mfma_f32_16x16x32_bf16 v[20:23], a[56:59], v[72:75], v[20:23]
    s_min_u32 s98, s98, s96
    ds_write_b32 v6, v140 offset:1024
    v_mfma_f32_16x16x32_bf16 v[24:27], a[60:63], v[72:75], v[24:27]
    s_and_b32 s41, s98, 0xffffffff
    ds_read_b128 v[56:59], v1 offset:19456
    buffer_load_dword v136, v4, s[16:19], s45 offen sc1
    v_mfma_f32_16x16x32_bf16 v[16:19], a[60:63], v[68:71], v[16:19]
    s_waitcnt lgkmcnt(3)
    v_add_f32 v144, v36, v37
    v_mul_f32 v145, v36, v36
    v_mfma_f32_16x16x32_bf16 v[12:15], a[64:67], v[44:47], v[12:15]
    s_add_u32 m0, s43, 98304
    ds_read_b128 v[60:63], v1 offset:20480
    v_fmac_f32 v145, v37, v37
    v_mfma_f32_16x16x32_bf16 v[20:23], a[64:67], v[48:51], v[20:23]
    s_add_u32 s42, s41, 0
    v_add_f32 v144, v144, v38
    v_fmac_f32 v145, v38, v38
    v_mfma_f32_16x16x32_bf16 v[24:27], a[68:71], v[48:51], v[24:27]
    ds_read_b128 v[64:67], v1 offset:21504
    v_add_f32 v144, v144, v39
    v_mfma_f32_16x16x32_bf16 v[16:19], a[68:71], v[44:47], v[16:19]
    s_waitcnt lgkmcnt(2)
    v_fmac_f32 v145, v39, v39
    v_add_f32 v144, v144, v40
    v_mfma_f32_16x16x32_bf16 v[12:15], a[72:75], v[52:55], v[12:15]
    ds_read_b128 v[68:71], v1 offset:22528
    v_fmac_f32 v145, v40, v40
    v_mfma_f32_16x16x32_bf16 v[20:23], a[72:75], v[56:59], v[20:23]
    v_add_f32 v144, v144, v41
    v_fmac_f32 v145, v41, v41
    v_mfma_f32_16x16x32_bf16 v[24:27], a[76:79], v[56:59], v[24:27]
    ds_read_b128 v[72:75], v1 offset:23552
    v_add_f32 v144, v144, v42
    v_mfma_f32_16x16x32_bf16 v[16:19], a[76:79], v[52:55], v[16:19]
    s_waitcnt lgkmcnt(2)
    v_fmac_f32 v145, v42, v42
    v_add_f32 v144, v144, v43
    v_mfma_f32_16x16x32_bf16 v[12:15], a[80:83], v[60:63], v[12:15]
    ds_read_b128 v[44:47], v1 offset:24576
    v_fmac_f32 v145, v43, v43
    v_mfma_f32_16x16x32_bf16 v[20:23], a[80:83], v[64:67], v[20:23]
    v_permlane16_swap_b32 v144, v145
    v_mfma_f32_16x16x32_bf16 v[24:27], a[84:87], v[64:67], v[24:27]
    ds_read_b128 v[48:51], v1 offset:25600
    v_add_f32 v144, v144, v145
    v_mfma_f32_16x16x32_bf16 v[16:19], a[84:87], v[60:63], v[16:19]
    s_waitcnt lgkmcnt(2)
    v_mov_b32 v146, v144
    buffer_load_dwordx4 v[128:131], v3, s[8:11], s48 offen sc1
    v_mfma_f32_16x16x32_bf16 v[12:15], a[88:91], v[68:71], v[12:15]
    ds_read_b128 v[52:55], v1 offset:26624
    v_permlane32_swap_b32 v144, v146
    v_mfma_f32_16x16x32_bf16 v[20:23], a[88:91], v[72:75], v[20:23]
    v_add_f32 v144, v144, v146
    ds_write_b32 v6, v144 offset:1536
    v_mfma_f32_16x16x32_bf16 v[24:27], a[92:95], v[72:75], v[24:27]
    ds_read_b128 v[56:59], v1 offset:27648
    buffer_load_dwordx4 v[132:135], v3, s[8:11], s47 offen sc1
    v_mfma_f32_16x16x32_bf16 v[16:19], a[92:95], v[68:71], v[16:19]
    s_waitcnt lgkmcnt(3)
    v_mfma_f32_16x16x32_bf16 v[12:15], a[96:99], v[44:47], v[12:15]
    ds_read_b128 v[60:63], v1 offset:28672
    v_mfma_f32_16x16x32_bf16 v[20:23], a[96:99], v[48:51], v[20:23]
    v_mfma_f32_16x16x32_bf16 v[24:27], a[100:103], v[48:51], v[24:27]
    ds_read_b128 v[64:67], v1 offset:29696
    v_mfma_f32_16x16x32_bf16 v[16:19], a[100:103], v[44:47], v[16:19]
    s_waitcnt lgkmcnt(2)
    v_mfma_f32_16x16x32_bf16 v[12:15], a[104:107], v[52:55], v[12:15]
    ds_read_b128 v[68:71], v1 offset:30720
    v_mfma_f32_16x16x32_bf16 v[20:23], a[104:107], v[56:59], v[20:23]
    v_mfma_f32_16x16x32_bf16 v[24:27], a[108:111], v[56:59], v[24:27]
    ds_read_b128 v[72:75], v1 offset:31744
    v_mfma_f32_16x16x32_bf16 v[16:19], a[108:111], v[52:55], v[16:19]
    s_waitcnt vmcnt(7) lgkmcnt(2)
    s_barrier
    v_mfma_f32_16x16x32_bf16 v[12:15], a[112:115], v[60:63], v[12:15]
    ds_read_b128 v[44:47], v1 offset:32768
    ds_read_b128 v[140:143], v7 offset:1024
    v_mfma_f32_16x16x32_bf16 v[20:23], a[112:115], v[64:67], v[20:23]
    v_mfma_f32_16x16x32_bf16 v[24:27], a[116:119], v[64:67], v[24:27]
    ds_read_b128 v[48:51], v1 offset:33792
    v_mfma_f32_16x16x32_bf16 v[16:19], a[116:119], v[60:63], v[16:19]
    s_waitcnt lgkmcnt(3)
    v_mfma_f32_16x16x32_bf16 v[12:15], a[120:123], v[68:71], v[12:15]
    s_waitcnt lgkmcnt(1)
    ds_read_b128 v[52:55], v1 offset:34816
    v_add_f32 v140, v140, v141
    v_mfma_f32_16x16x32_bf16 v[20:23], a[120:123], v[72:75], v[20:23]
    v_add_f32 v142, v142, v143
    v_add_f32 v140, v140, v142
    v_mfma_f32_16x16x32_bf16 v[24:27], a[124:127], v[72:75], v[24:27]
    ds_read_b128 v[56:59], v1 offset:35840
    v_min_u32 v140, -2, v140
    v_mfma_f32_16x16x32_bf16 v[16:19], a[124:127], v[68:71], v[16:19]
    s_waitcnt lgkmcnt(2)
    buffer_store_dword v140, v8, s[16:19], s49 offen sc1
    v_mfma_f32_16x16x32_bf16 v[12:15], a[128:131], v[44:47], v[12:15]
    s_add_u32 s90, s90, 65536
    ds_read_b128 v[60:63], v1 offset:36864
    s_add_u32 s46, s46, 2048
    v_mfma_f32_16x16x32_bf16 v[20:23], a[128:131], v[48:51], v[20:23]
    v_mfma_f32_16x16x32_bf16 v[24:27], a[132:135], v[48:51], v[24:27]
    ds_read_b128 v[64:67], v1 offset:37888
    v_mfma_f32_16x16x32_bf16 v[16:19], a[132:135], v[44:47], v[16:19]
    s_waitcnt lgkmcnt(2)
    v_mfma_f32_16x16x32_bf16 v[12:15], a[136:139], v[52:55], v[12:15]
    ds_read_b128 v[68:71], v1 offset:38912
    v_mfma_f32_16x16x32_bf16 v[20:23], a[136:139], v[56:59], v[20:23]
    v_mfma_f32_16x16x32_bf16 v[24:27], a[140:143], v[56:59], v[24:27]
    ds_read_b128 v[72:75], v1 offset:39936
    v_mfma_f32_16x16x32_bf16 v[16:19], a[140:143], v[52:55], v[16:19]
    s_waitcnt lgkmcnt(2)
    v_mfma_f32_16x16x32_bf16 v[12:15], a[144:147], v[60:63], v[12:15]
    ds_read_b128 v[44:47], v1 offset:40960
    v_mfma_f32_16x16x32_bf16 v[20:23], a[144:147], v[64:67], v[20:23]
    v_mfma_f32_16x16x32_bf16 v[24:27], a[148:151], v[64:67], v[24:27]
    s_waitcnt vmcnt(3)
    ds_read_b128 v[48:51], v1 offset:41984
    s_barrier
    v_mfma_f32_16x16x32_bf16 v[16:19], a[148:151], v[60:63], v[16:19]
    s_waitcnt lgkmcnt(2)
    buffer_store_dword v124, v124, s[16:19], s91 offen sc1
    v_mfma_f32_16x16x32_bf16 v[12:15], a[152:155], v[68:71], v[12:15]
    s_add_u32 s91, s91, 131072
    ds_read_b128 v[52:55], v1 offset:43008
    v_cmp_ne_u32 vcc, 0, v136
    v_mfma_f32_16x16x32_bf16 v[20:23], a[152:155], v[72:75], v[20:23]
    v_mfma_f32_16x16x32_bf16 v[24:27], a[156:159], v[72:75], v[24:27]
    s_cbranch_vccnz L_spin13
L_back14:
    ds_read_b128 v[56:59], v1 offset:44032
    s_barrier
    v_mfma_f32_16x16x32_bf16 v[16:19], a[156:159], v[68:71], v[16:19]
    s_waitcnt lgkmcnt(2)
    buffer_load_dwordx4 v1, s[16:19], s42 offen offset:0 sc1 lds
    v_mfma_f32_16x16x32_bf16 v[12:15], a[160:163], v[44:47], v[12:15]
    ds_read_b128 v[60:63], v1 offset:45056
    buffer_load_dwordx4 v1, s[16:19], s42 offen offset:1024 sc1 lds
    v_mfma_f32_16x16x32_bf16 v[20:23], a[160:163], v[48:51], v[20:23]
    buffer_load_dwordx4 v1, s[16:19], s42 offen offset:2048 sc1 lds
    v_mfma_f32_16x16x32_bf16 v[24:27], a[164:167], v[48:51], v[24:27]
    ds_read_b128 v[64:67], v1 offset:46080
    buffer_load_dwordx4 v1, s[16:19], s42 offen offset:3072 sc1 lds
    v_mfma_f32_16x16x32_bf16 v[16:19], a[164:167], v[44:47], v[16:19]
    s_waitcnt lgkmcnt(2)
    s_add_u32 m0, s43, 114688
    s_add_u32 s42, s41, 16384
    v_mfma_f32_16x16x32_bf16 v[12:15], a[168:171], v[52:55], v[12:15]
    ds_read_b128 v[68:71], v1 offset:47104
    v_mfma_f32_16x16x32_bf16 v[20:23], a[168:171], v[56:59], v[20:23]
    v_mfma_f32_16x16x32_bf16 v[24:27], a[172:175], v[56:59], v[24:27]
    ds_read_b128 v[72:75], v1 offset:48128
    buffer_load_dwordx4 v1, s[16:19], s42 offen offset:0 sc1 lds
    v_mfma_f32_16x16x32_bf16 v[16:19], a[172:175], v[52:55], v[16:19]
    s_waitcnt lgkmcnt(2)
    v_mfma_f32_16x16x32_bf16 v[12:15], a[176:179], v[60:63], v[12:15]
    ds_read_b128 v[44:47], v1 offset:49152
    v_mfma_f32_16x16x32_bf16 v[20:23], a[176:179], v[64:67], v[20:23]
    v_mfma_f32_16x16x32_bf16 v[24:27], a[180:183], v[64:67], v[24:27]
    ds_read_b128 v[48:51], v1 offset:50176
    buffer_load_dwordx4 v1, s[16:19], s42 offen offset:1024 sc1 lds
    v_mfma_f32_16x16x32_bf16 v[16:19], a[180:183], v[60:63], v[16:19]
    s_waitcnt lgkmcnt(2)
    v_mfma_f32_16x16x32_bf16 v[12:15], a[184:187], v[68:71], v[12:15]
    ds_read_b128 v[52:55], v1 offset:51200
    v_mfma_f32_16x16x32_bf16 v[20:23], a[184:187], v[72:75], v[20:23]
    v_mfma_f32_16x16x32_bf16 v[24:27], a[188:191], v[72:75], v[24:27]
    ds_read_b128 v[56:59], v1 offset:52224
    buffer_load_dwordx4 v1, s[16:19], s42 offen offset:2048 sc1 lds
    v_mfma_f32_16x16x32_bf16 v[16:19], a[188:191], v[68:71], v[16:19]
    s_waitcnt lgkmcnt(2)
    v_mfma_f32_16x16x32_bf16 v[12:15], a[192:195], v[44:47], v[12:15]
    ds_read_b128 v[60:63], v1 offset:53248
    v_mfma_f32_16x16x32_bf16 v[20:23], a[192:195], v[48:51], v[20:23]
    v_mfma_f32_16x16x32_bf16 v[24:27], a[196:199], v[48:51], v[24:27]
    ds_read_b128 v[64:67], v1 offset:54272
    buffer_load_dwordx4 v1, s[16:19], s42 offen offset:3072 sc1 lds
    v_mfma_f32_16x16x32_bf16 v[16:19], a[196:199], v[44:47], v[16:19]
    s_waitcnt lgkmcnt(2)
    s_add_u32 s45, s45, 131072
    v_mfma_f32_16x16x32_bf16 v[12:15], a[200:203], v[52:55], v[12:15]
    ds_read_b128 v[68:71], v1 offset:55296
    v_mfma_f32_16x16x32_bf16 v[20:23], a[200:203], v[56:59], v[20:23]
    v_mfma_f32_16x16x32_bf16 v[24:27], a[204:207], v[56:59], v[24:27]
    ds_read_b128 v[72:75], v1 offset:56320
    v_mfma_f32_16x16x32_bf16 v[16:19], a[204:207], v[52:55], v[16:19]
    s_waitcnt lgkmcnt(2)
    v_mfma_f32_16x16x32_bf16 v[12:15], a[208:211], v[60:63], v[12:15]
    ds_read_b128 v[44:47], v1 offset:57344
    v_mfma_f32_16x16x32_bf16 v[20:23], a[208:211], v[64:67], v[20:23]
    v_mfma_f32_16x16x32_bf16 v[24:27], a[212:215], v[64:67], v[24:27]
    ds_read_b128 v[48:51], v1 offset:58368
    v_mfma_f32_16x16x32_bf16 v[16:19], a[212:215], v[60:63], v[16:19]
    s_waitcnt lgkmcnt(2)
    v_mfma_f32_16x16x32_bf16 v[12:15], a[216:219], v[68:71], v[12:15]
    ds_read_b128 v[52:55], v1 offset:59392
    v_mfma_f32_16x16x32_bf16 v[20:23], a[216:219], v[72:75], v[20:23]
    v_mfma_f32_16x16x32_bf16 v[24:27], a[220:223], v[72:75], v[24:27]
    s_waitcnt vmcnt(10)
    ds_read_b128 v[56:59], v1 offset:60416
    v_mfma_f32_16x16x32_bf16 v[28:31], v[108:111], v[128:131], 0
    v_mfma_f32_16x16x32_bf16 v[32:35], v[112:115], v[128:131], 0
    v_mfma_f32_16x16x32_bf16 v[36:39], v[108:111], v[132:135], 0
    v_mfma_f32_16x16x32_bf16 v[40:43], v[112:115], v[132:135], 0
    v_mfma_f32_16x16x32_bf16 v[16:19], a[220:223], v[68:71], v[16:19]
    s_waitcnt lgkmcnt(2)
    v_mfma_f32_16x16x32_bf16 v[12:15], a[224:227], v[44:47], v[12:15]
    ds_read_b128 v[60:63], v1 offset:61440
    v_mfma_f32_16x16x32_bf16 v[20:23], a[224:227], v[48:51], v[20:23]
    v_mfma_f32_16x16x32_bf16 v[24:27], a[228:231], v[48:51], v[24:27]
    ds_read_b128 v[64:67], v1 offset:62464
    v_mfma_f32_16x16x32_bf16 v[16:19], a[228:231], v[44:47], v[16:19]
    s_waitcnt lgkmcnt(2)
    v_mfma_f32_16x16x32_bf16 v[12:15], a[232:235], v[52:55], v[12:15]
    ds_read_b128 v[68:71], v1 offset:63488
    v_mfma_f32_16x16x32_bf16 v[20:23], a[232:235], v[56:59], v[20:23]
    v_mfma_f32_16x16x32_bf16 v[24:27], a[236:239], v[56:59], v[24:27]
    ds_read_b128 v[72:75], v1 offset:64512
    v_mfma_f32_16x16x32_bf16 v[16:19], a[236:239], v[52:55], v[16:19]
    s_waitcnt vmcnt(4) lgkmcnt(2)
    s_barrier
    v_mfma_f32_16x16x32_bf16 v[12:15], a[240:243], v[60:63], v[12:15]
    ds_read_b128 v[44:47], v2 offset:0
    v_mfma_f32_16x16x32_bf16 v[20:23], a[240:243], v[64:67], v[20:23]
    v_mfma_f32_16x16x32_bf16 v[24:27], a[244:247], v[64:67], v[24:27]
    ds_read_b128 v[48:51], v2 offset:1024
    v_mfma_f32_16x16x32_bf16 v[16:19], a[244:247], v[60:63], v[16:19]
    s_waitcnt lgkmcnt(2)
    v_mfma_f32_16x16x32_bf16 v[12:15], a[248:251], v[68:71], v[12:15]
    ds_read_b128 v[52:55], v2 offset:2048
    v_mfma_f32_16x16x32_bf16 v[20:23], a[248:251], v[72:75], v[20:23]
    v_mfma_f32_16x16x32_bf16 v[24:27], a[252:255], v[72:75], v[24:27]
    ds_read_b128 v[56:59], v2 offset:3072
    v_mfma_f32_16x16x32_bf16 v[16:19], a[252:255], v[68:71], v[16:19]
    s_add_u32 s36, s36, 1
L_o_b1:
    s_waitcnt lgkmcnt(2)
    v_mfma_f32_16x16x32_bf16 v[28:31], a[0:3], v[44:47], v[28:31]
    s_and_b32 s44, s90, 0xffffffff
    ds_read_b128 v[60:63], v2 offset:4096
    s_cmp_eq_u32 s36, 0
    v_mfma_f32_16x16x32_bf16 v[36:39], a[0:3], v[48:51], v[36:39]
    s_cselect_b32 s44, 0x5e00000, s44
    s_cselect_b32 s49, 0x5e00000, s46
    v_cvt_pk_bf16_f32 v148, v12, v13
    v_mfma_f32_16x16x32_bf16 v[40:43], a[4:7], v[48:51], v[40:43]
    s_add_u32 m0, s43, 131072
    ds_read_b128 v[64:67], v2 offset:5120
    v_cvt_pk_bf16_f32 v149, v14, v15
    v_mfma_f32_16x16x32_bf16 v[32:35], a[4:7], v[44:47], v[32:35]
    s_waitcnt lgkmcnt(2)
    v_cvt_pk_bf16_f32 v150, v16, v17
    v_cvt_pk_bf16_f32 v151, v18, v19
    v_mfma_f32_16x16x32_bf16 v[28:31], a[8:11], v[52:55], v[28:31]
    s_add_u32 s42, s41, 32768
    ds_read_b128 v[68:71], v2 offset:6144
    buffer_store_dwordx4 v[148:151], v1, s[16:19], s44 offen offset:0 sc1
    v_mfma_f32_16x16x32_bf16 v[36:39], a[8:11], v[56:59], v[36:39]
    v_cvt_pk_bf16_f32 v152, v20, v21
    v_cvt_pk_bf16_f32 v153, v22, v23
    v_mfma_f32_16x16x32_bf16 v[40:43], a[12:15], v[56:59], v[40:43]
    ds_read_b128 v[72:75], v2 offset:7168
    v_cvt_pk_bf16_f32 v154, v24, v25
    v_mfma_f32_16x16x32_bf16 v[32:35], a[12:15], v[52:55], v[32:35]
    s_waitcnt lgkmcnt(2)
    v_cvt_pk_bf16_f32 v155, v26, v27
    buffer_store_dwordx4 v[152:155], v1, s[16:19], s44 offen offset:1024 sc1
    v_mfma_f32_16x16x32_bf16 v[28:31], a[16:19], v[60:63], v[28:31]
    ds_read_b128 v[44:47], v2 offset:8192
    buffer_load_dwordx4 v1, s[16:19], s42 offen offset:0 sc1 lds
    v_mfma_f32_16x16x32_bf16 v[36:39], a[16:19], v[64:67], v[36:39]
    v_add_f32 v140, v12, v13
    v_mul_f32 v141, v12, v12
    v_mfma_f32_16x16x32_bf16 v[40:43], a[20:23], v[64:67], v[40:43]
    ds_read_b128 v[48:51], v2 offset:9216
    buffer_load_dwordx4 v1, s[16:19], s42 offen offset:1024 sc1 lds
    v_mfma_f32_16x16x32_bf16 v[32:35], a[20:23], v[60:63], v[32:35]
    s_waitcnt lgkmcnt(2)
    v_fmac_f32 v141, v13, v13
    v_add_f32 v140, v140, v14
    v_mfma_f32_16x16x32_bf16 v[28:31], a[24:27], v[68:71], v[28:31]
    s_add_u32 s47, s36, 1
    ds_read_b128 v[52:55], v2 offset:10240
    buffer_load_dwordx4 v1, s[16:19], s42 offen offset:2048 sc1 lds
    v_mfma_f32_16x16x32_bf16 v[36:39], a[24:27], v[72:75], v[36:39]
    s_min_u32 s47, s47, 31
    v_fmac_f32 v141, v14, v14
    v_add_f32 v140, v140, v15
    v_mfma_f32_16x16x32_bf16 v[40:43], a[28:31], v[72:75], v[40:43]
    s_cmp_ge_u32 s47, 16
    ds_read_b128 v[56:59], v2 offset:11264
    buffer_load_dwordx4 v1, s[16:19], s42 offen offset:3072 sc1 lds
    v_mfma_f32_16x16x32_bf16 v[32:35], a[28:31], v[68:71], v[32:35]
    s_waitcnt lgkmcnt(2)
    v_fmac_f32 v141, v15, v15
    v_add_f32 v140, v140, v16
    v_mfma_f32_16x16x32_bf16 v[28:31], a[32:35], v[44:47], v[28:31]
    s_cselect_b32 s8, s88, s64
    ds_read_b128 v[60:63], v2 offset:12288
    v_fmac_f32 v141, v16, v16
    v_mfma_f32_16x16x32_bf16 v[36:39], a[32:35], v[48:51], v[36:39]
    s_cselect_b32 s9, s89, s65
    v_add_f32 v140, v140, v17
    v_fmac_f32 v141, v17, v17
    v_mfma_f32_16x16x32_bf16 v[40:43], a[36:39], v[48:51], v[40:43]
    s_add_u32 m0, s43, 147456
    ds_read_b128 v[64:67], v2 offset:13312
    v_add_f32 v140, v140, v18
    v_mfma_f32_16x16x32_bf16 v[32:35], a[36:39], v[44:47], v[32:35]
    s_waitcnt lgkmcnt(2)
    v_fmac_f32 v141, v18, v18
    v_add_f32 v140, v140, v19
    v_mfma_f32_16x16x32_bf16 v[28:31], a[40:43], v[52:55], v[28:31]
    s_add_u32 s42, s41, 49152
    ds_read_b128 v[68:71], v2 offset:14336
    buffer_load_dwordx4 v1, s[16:19], s42 offen offset:0 sc1 lds
    v_mfma_f32_16x16x32_bf16 v[36:39], a[40:43], v[56:59], v[36:39]
    s_and_b32 s47, s47, 15
    v_fmac_f32 v141, v19, v19
    s_lshl_b32 s47, s47, 16
    v_mfma_f32_16x16x32_bf16 v[40:43], a[44:47], v[56:59], v[40:43]
    s_sub_u32 s47, s50, s47
    ds_read_b128 v[72:75], v2 offset:15360
    buffer_load_dwordx4 v1, s[16:19], s42 offen offset:1024 sc1 lds
    v_mfma_f32_16x16x32_bf16 v[32:35], a[44:47], v[52:55], v[32:35]
    s_waitcnt vmcnt(8) lgkmcnt(2)
    s_barrier
    v_permlane16_swap_b32 v140, v141
    v_mfma_f32_16x16x32_bf16 v[28:31], a[48:51], v[60:63], v[28:31]
    s_add_u32 s48, s47, 32768
    ds_read_b128 v[44:47], v2 offset:16384
    buffer_load_dwordx4 v1, s[16:19], s42 offen offset:2048 sc1 lds
    v_mfma_f32_16x16x32_bf16 v[36:39], a[48:51], v[64:67], v[36:39]
    v_add_f32 v140, v140, v141
    v_mov_b32 v142, v140
    v_mfma_f32_16x16x32_bf16 v[40:43], a[52:55], v[64:67], v[40:43]
    ds_read_b128 v[48:51], v2 offset:17408
    buffer_load_dwordx4 v1, s[16:19], s42 offen offset:3072 sc1 lds
    v_mfma_f32_16x16x32_bf16 v[32:35], a[52:55], v[60:63], v[32:35]
    s_waitcnt lgkmcnt(2)
    v_permlane32_swap_b32 v140, v142
    v_mfma_f32_16x16x32_bf16 v[28:31], a[56:59], v[68:71], v[28:31]
    s_add_u32 s98, s98, 65536
    ds_read_b128 v[52:55], v2 offset:18432
    v_add_f32 v140, v140, v142
    v_mfma_f32_16x16x32_bf16 v[36:39], a[56:59], v[72:75], v[36:39]
    s_min_u32 s98, s98, s96
    ds_write_b32 v6, v140 offset:0
    v_mfma_f32_16x16x32_bf16 v[40:43], a[60:63], v[72:75], v[40:43]
    s_and_b32 s41, s98, 0xffffffff
    ds_read_b128 v[56:59], v2 offset:19456
    buffer_load_dword v136, v4, s[16:19], s45 offen sc1
    v_mfma_f32_16x16x32_bf16 v[32:35], a[60:63], v[68:71], v[32:35]
    s_waitcnt lgkmcnt(3)
    v_add_f32 v144, v20, v21
    v_mul_f32 v145, v20, v20
    v_mfma_f32_16x16x32_bf16 v[28:31], a[64:67], v[44:47], v[28:31]
    s_add_u32 m0, s43, 0
    ds_read_b128 v[60:63], v2 offset:20480
    v_fmac_f32 v145, v21, v21
    v_mfma_f32_16x16x32_bf16 v[36:39], a[64:67], v[48:51], v[36:39]
    s_add_u32 s42, s41, 0
    v_add_f32 v144, v144, v22
    v_fmac_f32 v145, v22, v22
    v_mfma_f32_16x16x32_bf16 v[40:43], a[68:71], v[48:51], v[40:43]
    ds_read_b128 v[64:67], v2 offset:21504
    v_add_f32 v144, v144, v23
    v_mfma_f32_16x16x32_bf16 v[32:35], a[68:71], v[44:47], v[32:35]
    s_waitcnt lgkmcnt(2)
    v_fmac_f32 v145, v23, v23
    v_add_f32 v144, v144, v24
    v_mfma_f32_16x16x32_bf16 v[28:31], a[72:75], v[52:55], v[28:31]
    ds_read_b128 v[68:71], v2 offset:22528
    v_fmac_f32 v145, v24, v24
    v_mfma_f32_16x16x32_bf16 v[36:39], a[72:75], v[56:59], v[36:39]
    v_add_f32 v144, v144, v25
    v_fmac_f32 v145, v25, v25
    v_mfma_f32_16x16x32_bf16 v[40:43], a[76:79], v[56:59], v[40:43]
    ds_read_b128 v[72:75], v2 offset:23552
    v_add_f32 v144, v144, v26
    v_mfma_f32_16x16x32_bf16 v[32:35], a[76:79], v[52:55], v[32:35]
    s_waitcnt lgkmcnt(2)
    v_fmac_f32 v145, v26, v26
    v_add_f32 v144, v144, v27
    v_mfma_f32_16x16x32_bf16 v[28:31], a[80:83], v[60:63], v[28:31]
    ds_read_b128 v[44:47], v2 offset:24576
    v_fmac_f32 v145, v27, v27
    v_mfma_f32_16x16x32_bf16 v[36:39], a[80:83], v[64:67], v[36:39]
    v_permlane16_swap_b32 v144, v145
    v_mfma_f32_16x16x32_bf16 v[40:43], a[84:87], v[64:67], v[40:43]
    ds_read_b128 v[48:51], v2 offset:25600
    v_add_f32 v144, v144, v145
    v_mfma_f32_16x16x32_bf16 v[32:35], a[84:87], v[60:63], v[32:35]
    s_waitcnt lgkmcnt(2)
    v_mov_b32 v146, v144
    buffer_load_dwordx4 v[128:131], v3, s[8:11], s48 offen sc1
    v_mfma_f32_16x16x32_bf16 v[28:31], a[88:91], v[68:71], v[28:31]
    ds_read_b128 v[52:55], v2 offset:26624
    v_permlane32_swap_b32 v144, v146
    v_mfma_f32_16x16x32_bf16 v[36:39], a[88:91], v[72:75], v[36:39]
    v_add_f32 v144, v144, v146
    ds_write_b32 v6, v144 offset:512
    v_mfma_f32_16x16x32_bf16 v[40:43], a[92:95], v[72:75], v[40:43]
    ds_read_b128 v[56:59], v2 offset:27648
    buffer_load_dwordx4 v[132:135], v3, s[8:11], s47 offen sc1
    v_mfma_f32_16x16x32_bf16 v[32:35], a[92:95], v[68:71], v[32:35]
    s_waitcnt lgkmcnt(3)
    v_mfma_f32_16x16x32_bf16 v[28:31], a[96:99], v[44:47], v[28:31]
    ds_read_b128 v[60:63], v2 offset:28672
    v_mfma_f32_16x16x32_bf16 v[36:39], a[96:99], v[48:51], v[36:39]
    v_mfma_f32_16x16x32_bf16 v[40:43], a[100:103], v[48:51], v[40:43]
    ds_read_b128 v[64:67], v2 offset:29696
    v_mfma_f32_16x16x32_bf16 v[32:35], a[100:103], v[44:47], v[32:35]
    s_waitcnt lgkmcnt(2)
    v_mfma_f32_16x16x32_bf16 v[28:31], a[104:107], v[52:55], v[28:31]
    ds_read_b128 v[68:71], v2 offset:30720
    v_mfma_f32_16x16x32_bf16 v[36:39], a[104:107], v[56:59], v[36:39]
    v_mfma_f32_16x16x32_bf16 v[40:43], a[108:111], v[56:59], v[40:43]
    ds_read_b128 v[72:75], v2 offset:31744
    v_mfma_f32_16x16x32_bf16 v[32:35], a[108:111], v[52:55], v[32:35]
    s_waitcnt vmcnt(7) lgkmcnt(2)
    s_barrier
    v_mfma_f32_16x16x32_bf16 v[28:31], a[112:115], v[60:63], v[28:31]
    ds_read_b128 v[44:47], v2 offset:32768
    ds_read_b128 v[140:143], v7 offset:0
    v_mfma_f32_16x16x32_bf16 v[36:39], a[112:115], v[64:67], v[36:39]
    v_mfma_f32_16x16x32_bf16 v[40:43], a[116:119], v[64:67], v[40:43]
    ds_read_b128 v[48:51], v2 offset:33792
    v_mfma_f32_16x16x32_bf16 v[32:35], a[116:119], v[60:63], v[32:35]
    s_waitcnt lgkmcnt(3)
    v_mfma_f32_16x16x32_bf16 v[28:31], a[120:123], v[68:71], v[28:31]
    s_waitcnt lgkmcnt(1)
    ds_read_b128 v[52:55], v2 offset:34816
    v_add_f32 v140, v140, v141
    v_mfma_f32_16x16x32_bf16 v[36:39], a[120:123], v[72:75], v[36:39]
    v_add_f32 v142, v142, v143
    v_add_f32 v140, v140, v142
    v_mfma_f32_16x16x32_bf16 v[40:43], a[124:127], v[72:75], v[40:43]
    ds_read_b128 v[56:59], v2 offset:35840
    v_min_u32 v140, -2, v140
    v_mfma_f32_16x16x32_bf16 v[32:35], a[124:127], v[68:71], v[32:35]
    s_waitcnt lgkmcnt(2)
    buffer_store_dword v140, v8, s[16:19], s49 offen sc1
    v_mfma_f32_16x16x32_bf16 v[28:31], a[128:131], v[44:47], v[28:31]
    s_add_u32 s90, s90, 65536
    ds_read_b128 v[60:63], v2 offset:36864
    s_add_u32 s46, s46, 2048
    v_mfma_f32_16x16x32_bf16 v[36:39], a[128:131], v[48:51], v[36:39]
    v_mfma_f32_16x16x32_bf16 v[40:43], a[132:135], v[48:51], v[40:43]
    ds_read_b128 v[64:67], v2 offset:37888
    v_mfma_f32_16x16x32_bf16 v[32:35], a[132:135], v[44:47], v[32:35]
    s_waitcnt lgkmcnt(2)
    v_mfma_f32_16x16x32_bf16 v[28:31], a[136:139], v[52:55], v[28:31]
    ds_read_b128 v[68:71], v2 offset:38912
    v_mfma_f32_16x16x32_bf16 v[36:39], a[136:139], v[56:59], v[36:39]
    v_mfma_f32_16x16x32_bf16 v[40:43], a[140:143], v[56:59], v[40:43]
    ds_read_b128 v[72:75], v2 offset:39936
    v_mfma_f32_16x16x32_bf16 v[32:35], a[140:143], v[52:55], v[32:35]
    s_waitcnt lgkmcnt(2)
    v_mfma_f32_16x16x32_bf16 v[28:31], a[144:147], v[60:63], v[28:31]
    ds_read_b128 v[44:47], v2 offset:40960
    v_mfma_f32_16x16x32_bf16 v[36:39], a[144:147], v[64:67], v[36:39]
    v_mfma_f32_16x16x32_bf16 v[40:43], a[148:151], v[64:67], v[40:43]
    s_waitcnt vmcnt(3)
    ds_read_b128 v[48:51], v2 offset:41984
    s_barrier
    v_mfma_f32_16x16x32_bf16 v[32:35], a[148:151], v[60:63], v[32:35]
    s_waitcnt lgkmcnt(2)
    buffer_store_dword v124, v124, s[16:19], s91 offen sc1
    v_mfma_f32_16x16x32_bf16 v[28:31], a[152:155], v[68:71], v[28:31]
    s_add_u32 s91, s91, 131072
    ds_read_b128 v[52:55], v2 offset:43008
    v_cmp_ne_u32 vcc, 0, v136
    v_mfma_f32_16x16x32_bf16 v[36:39], a[152:155], v[72:75], v[36:39]
    v_mfma_f32_16x16x32_bf16 v[40:43], a[156:159], v[72:75], v[40:43]
    s_cbranch_vccnz L_spin15
L_back16:
    ds_read_b128 v[56:59], v2 offset:44032
    s_barrier
    v_mfma_f32_16x16x32_bf16 v[32:35], a[156:159], v[68:71], v[32:35]
    s_waitcnt lgkmcnt(2)
    buffer_load_dwordx4 v1, s[16:19], s42 offen offset:0 sc1 lds
    v_mfma_f32_16x16x32_bf16 v[28:31], a[160:163], v[44:47], v[28:31]
    ds_read_b128 v[60:63], v2 offset:45056
    buffer_load_dwordx4 v1, s[16:19], s42 offen offset:1024 sc1 lds
    v_mfma_f32_16x16x32_bf16 v[36:39], a[160:163], v[48:51], v[36:39]
    buffer_load_dwordx4 v1, s[16:19], s42 offen offset:2048 sc1 lds
    v_mfma_f32_16x16x32_bf16 v[40:43], a[164:167], v[48:51], v[40:43]
    ds_read_b128 v[64:67], v2 offset:46080
    buffer_load_dwordx4 v1, s[16:19], s42 offen offset:3072 sc1 lds
    v_mfma_f32_16x16x32_bf16 v[32:35], a[164:167], v[44:47], v[32:35]
    s_waitcnt lgkmcnt(2)
    s_add_u32 m0, s43, 16384
    s_add_u32 s42, s41, 16384
    v_mfma_f32_16x16x32_bf16 v[28:31], a[168:171], v[52:55], v[28:31]
    ds_read_b128 v[68:71], v2 offset:47104
    v_mfma_f32_16x16x32_bf16 v[36:39], a[168:171], v[56:59], v[36:39]
    v_mfma_f32_16x16x32_bf16 v[40:43], a[172:175], v[56:59], v[40:43]
    ds_read_b128 v[72:75], v2 offset:48128
    buffer_load_dwordx4 v1, s[16:19], s42 offen offset:0 sc1 lds
    v_mfma_f32_16x16x32_bf16 v[32:35], a[172:175], v[52:55], v[32:35]
    s_waitcnt lgkmcnt(2)
    v_mfma_f32_16x16x32_bf16 v[28:31], a[176:179], v[60:63], v[28:31]
    ds_read_b128 v[44:47], v2 offset:49152
    v_mfma_f32_16x16x32_bf16 v[36:39], a[176:179], v[64:67], v[36:39]
    v_mfma_f32_16x16x32_bf16 v[40:43], a[180:183], v[64:67], v[40:43]
    ds_read_b128 v[48:51], v2 offset:50176
    buffer_load_dwordx4 v1, s[16:19], s42 offen offset:1024 sc1 lds
    v_mfma_f32_16x16x32_bf16 v[32:35], a[180:183], v[60:63], v[32:35]
    s_waitcnt lgkmcnt(2)
    v_mfma_f32_16x16x32_bf16 v[28:31], a[184:187], v[68:71], v[28:31]
    ds_read_b128 v[52:55], v2 offset:51200
    v_mfma_f32_16x16x32_bf16 v[36:39], a[184:187], v[72:75], v[36:39]
    v_mfma_f32_16x16x32_bf16 v[40:43], a[188:191], v[72:75], v[40:43]
    ds_read_b128 v[56:59], v2 offset:52224
    buffer_load_dwordx4 v1, s[16:19], s42 offen offset:2048 sc1 lds
    v_mfma_f32_16x16x32_bf16 v[32:35], a[188:191], v[68:71], v[32:35]
    s_waitcnt lgkmcnt(2)
    v_mfma_f32_16x16x32_bf16 v[28:31], a[192:195], v[44:47], v[28:31]
    ds_read_b128 v[60:63], v2 offset:53248
    v_mfma_f32_16x16x32_bf16 v[36:39], a[192:195], v[48:51], v[36:39]
    v_mfma_f32_16x16x32_bf16 v[40:43], a[196:199], v[48:51], v[40:43]
    ds_read_b128 v[64:67], v2 offset:54272
    buffer_load_dwordx4 v1, s[16:19], s42 offen offset:3072 sc1 lds
    v_mfma_f32_16x16x32_bf16 v[32:35], a[196:199], v[44:47], v[32:35]
    s_waitcnt lgkmcnt(2)
    s_add_u32 s45, s45, 131072
    v_mfma_f32_16x16x32_bf16 v[28:31], a[200:203], v[52:55], v[28:31]
    ds_read_b128 v[68:71], v2 offset:55296
    v_mfma_f32_16x16x32_bf16 v[36:39], a[200:203], v[56:59], v[36:39]
    v_mfma_f32_16x16x32_bf16 v[40:43], a[204:207], v[56:59], v[40:43]
    ds_read_b128 v[72:75], v2 offset:56320
    v_mfma_f32_16x16x32_bf16 v[32:35], a[204:207], v[52:55], v[32:35]
    s_waitcnt lgkmcnt(2)
    v_mfma_f32_16x16x32_bf16 v[28:31], a[208:211], v[60:63], v[28:31]
    ds_read_b128 v[44:47], v2 offset:57344
    v_mfma_f32_16x16x32_bf16 v[36:39], a[208:211], v[64:67], v[36:39]
    v_mfma_f32_16x16x32_bf16 v[40:43], a[212:215], v[64:67], v[40:43]
    ds_read_b128 v[48:51], v2 offset:58368
    v_mfma_f32_16x16x32_bf16 v[32:35], a[212:215], v[60:63], v[32:35]
    s_waitcnt lgkmcnt(2)
    v_mfma_f32_16x16x32_bf16 v[28:31], a[216:219], v[68:71], v[28:31]
    ds_read_b128 v[52:55], v2 offset:59392
    v_mfma_f32_16x16x32_bf16 v[36:39], a[216:219], v[72:75], v[36:39]
    v_mfma_f32_16x16x32_bf16 v[40:43], a[220:223], v[72:75], v[40:43]
    s_waitcnt vmcnt(10)
    ds_read_b128 v[56:59], v2 offset:60416
    v_mfma_f32_16x16x32_bf16 v[12:15], v[108:111], v[128:131], 0
    v_mfma_f32_16x16x32_bf16 v[16:19], v[112:115], v[128:131], 0
    v_mfma_f32_16x16x32_bf16 v[20:23], v[108:111], v[132:135], 0
    v_mfma_f32_16x16x32_bf16 v[24:27], v[112:115], v[132:135], 0
    v_mfma_f32_16x16x32_bf16 v[32:35], a[220:223], v[68:71], v[32:35]
    s_waitcnt lgkmcnt(2)
    v_mfma_f32_16x16x32_bf16 v[28:31], a[224:227], v[44:47], v[28:31]
    ds_read_b128 v[60:63], v2 offset:61440
    v_mfma_f32_16x16x32_bf16 v[36:39], a[224:227], v[48:51], v[36:39]
    v_mfma_f32_16x16x32_bf16 v[40:43], a[228:231], v[48:51], v[40:43]
    ds_read_b128 v[64:67], v2 offset:62464
    v_mfma_f32_16x16x32_bf16 v[32:35], a[228:231], v[44:47], v[32:35]
    s_waitcnt lgkmcnt(2)
    v_mfma_f32_16x16x32_bf16 v[28:31], a[232:235], v[52:55], v[28:31]
    ds_read_b128 v[68:71], v2 offset:63488
    v_mfma_f32_16x16x32_bf16 v[36:39], a[232:235], v[56:59], v[36:39]
    v_mfma_f32_16x16x32_bf16 v[40:43], a[236:239], v[56:59], v[40:43]
    ds_read_b128 v[72:75], v2 offset:64512
    v_mfma_f32_16x16x32_bf16 v[32:35], a[236:239], v[52:55], v[32:35]
    s_waitcnt vmcnt(4) lgkmcnt(2)
    s_barrier
    v_mfma_f32_16x16x32_bf16 v[28:31], a[240:243], v[60:63], v[28:31]
    ds_read_b128 v[44:47], v1 offset:0
    v_mfma_f32_16x16x32_bf16 v[36:39], a[240:243], v[64:67], v[36:39]
    v_mfma_f32_16x16x32_bf16 v[40:43], a[244:247], v[64:67], v[40:43]
    ds_read_b128 v[48:51], v1 offset:1024
    v_mfma_f32_16x16x32_bf16 v[32:35], a[244:247], v[60:63], v[32:35]
    s_waitcnt lgkmcnt(2)
    v_mfma_f32_16x16x32_bf16 v[28:31], a[248:251], v[68:71], v[28:31]
    ds_read_b128 v[52:55], v1 offset:2048
    v_mfma_f32_16x16x32_bf16 v[36:39], a[248:251], v[72:75], v[36:39]
    v_mfma_f32_16x16x32_bf16 v[40:43], a[252:255], v[72:75], v[40:43]
    ds_read_b128 v[56:59], v1 offset:3072
    v_mfma_f32_16x16x32_bf16 v[32:35], a[252:255], v[68:71], v[32:35]
    s_add_u32 s36, s36, 1
    s_cmp_lt_u32 s36, 32
    s_cbranch_scc1 L_o_b0
    s_nop 7
    s_and_b32 s44, s90, 0xffffffff
    s_cmp_eq_u32 s36, 0
    s_cselect_b32 s44, 0x5e00000, s44
    s_cselect_b32 s49, 0x5e00000, s46
    v_cvt_pk_bf16_f32 v148, v28, v29
    v_cvt_pk_bf16_f32 v149, v30, v31
    v_cvt_pk_bf16_f32 v150, v32, v33
    v_cvt_pk_bf16_f32 v151, v34, v35
    buffer_store_dwordx4 v[148:151], v1, s[16:19], s44 offen offset:0 sc1
    v_cvt_pk_bf16_f32 v152, v36, v37
    v_cvt_pk_bf16_f32 v153, v38, v39
    v_cvt_pk_bf16_f32 v154, v40, v41
    v_cvt_pk_bf16_f32 v155, v42, v43
    buffer_store_dwordx4 v[152:155], v1, s[16:19], s44 offen offset:1024 sc1
    v_add_f32 v140, v28, v29
    v_mul_f32 v141, v28, v28
    v_fmac_f32 v141, v29, v29
    v_add_f32 v140, v140, v30
    v_fmac_f32 v141, v30, v30
    v_add_f32 v140, v140, v31
    v_fmac_f32 v141, v31, v31
    v_add_f32 v140, v140, v32
    v_fmac_f32 v141, v32, v32
    v_add_f32 v140, v140, v33
    v_fmac_f32 v141, v33, v33
    v_add_f32 v140, v140, v34
    v_fmac_f32 v141, v34, v34
    v_add_f32 v140, v140, v35
    v_fmac_f32 v141, v35, v35
    s_nop 1
    v_permlane16_swap_b32 v140, v141
    v_add_f32 v140, v140, v141
    v_mov_b32 v142, v140
    s_nop 1
    v_permlane32_swap_b32 v140, v142
    v_add_f32 v140, v140, v142
    ds_write_b32 v6, v140 offset:1024
    v_add_f32 v144, v36, v37
    v_mul_f32 v145, v36, v36
    v_fmac_f32 v145, v37, v37
    v_add_f32 v144, v144, v38
    v_fmac_f32 v145, v38, v38
    v_add_f32 v144, v144, v39
    v_fmac_f32 v145, v39, v39
    v_add_f32 v144, v144, v40
    v_fmac_f32 v145, v40, v40
    v_add_f32 v144, v144, v41
    v_fmac_f32 v145, v41, v41
    v_add_f32 v144, v144, v42
    v_fmac_f32 v145, v42, v42
    v_add_f32 v144, v144, v43
    v_fmac_f32 v145, v43, v43
    s_nop 1
    v_permlane16_swap_b32 v144, v145
    v_add_f32 v144, v144, v145
    v_mov_b32 v146, v144
    s_nop 1
    v_permlane32_swap_b32 v144, v146
    v_add_f32 v144, v144, v146
    ds_write_b32 v6, v144 offset:1536
    s_waitcnt lgkmcnt(0)
    s_barrier
    ds_read_b128 v[140:143], v7 offset:1024
    s_waitcnt lgkmcnt(0)
    v_add_f32 v140, v140, v141
    v_add_f32 v142, v142, v143
    v_add_f32 v140, v140, v142
    v_min_u32 v140, -2, v140
    buffer_store_dword v140, v8, s[16:19], s49 offen sc1
    s_add_u32 s90, s90, 65536
    s_add_u32 s46, s46, 2048
    s_waitcnt vmcnt(1)
    s_barrier
    buffer_store_dword v124, v124, s[16:19], s91 offen sc1
    s_add_u32 s91, s91, 131072
    s_waitcnt vmcnt(0)
    s_endpgm
L_spin9:
    s_mov_b32 s40, 0x20000
L_spin9_l:
    buffer_load_dword v12, v124, s[20:23], 0 offen sc1
    s_sub_u32 s40, s40, 1
    s_waitcnt vmcnt(0)
    v_cmp_eq_u32 vcc, v124, v12
    s_cbranch_scc1 L_back10
    s_cbranch_vccz L_back10
    s_sleep 8
    s_branch L_spin9_l
L_spin11:
    s_mov_b32 s40, 0x20000
L_spin11_l:
    buffer_load_dword v136, v4, s[16:19], s45 offen sc1
    s_sub_u32 s40, s40, 1
    s_waitcnt vmcnt(0)
    v_cmp_ne_u32 vcc, 0, v136
    s_cbranch_scc1 L_back12
    s_cbranch_vccz L_back12
    s_sleep 2
    s_branch L_spin11_l
L_spin13:
    s_mov_b32 s40, 0x20000
L_spin13_l:
    buffer_load_dword v136, v4, s[16:19], s45 offen sc1
    s_sub_u32 s40, s40, 1
    s_waitcnt vmcnt(0)
    v_cmp_ne_u32 vcc, 0, v136
    s_cbranch_scc1 L_back14
    s_cbranch_vccz L_back14
    s_sleep 2
    s_branch L_spin13_l
L_spin15:
    s_mov_b32 s40, 0x20000
L_spin15_l:
    buffer_load_dword v136, v4, s[16:19], s45 offen sc1
    s_sub_u32 s40, s40, 1
    s_waitcnt vmcnt(0)
    v_cmp_ne_u32 vcc, 0, v136
    s_cbranch_scc1 L_back16
    s_cbranch_vccz L_back16
    s_sleep 2
    s_branch L_spin15_l
L_role_24:
    s_sub_u32 s35, s34, 24
    s_mul_i32 s51, s35, 6
    s_min_u32 s51, s51, 106
    s_lshl_b32 s54, s51, 6
    s_mov_b32 s12, s72
    s_mov_b32 s13, s73
    s_mov_b32 s14, 0x700000
    s_mov_b32 s15, 0x00020000
    s_mov_b32 s39, 7168
    v_lshrrev_b32 v68, 3, v0
    v_lshlrev_b32 v69, 2, v0
    v_and_b32 v69, 64, v69
    v_and_b32 v70, 0x70, v1
    v_xor_b32 v69, v69, v70
    v_mad_u32_u24 v56, v68, s39, v69
    v_add_u32 v57, 57344, v56
    v_add_u32 v58, 128, v56
    v_add_u32 v59, 57472, v56
    v_add_u32 v60, 256, v56
    v_add_u32 v61, 57600, v56
    s_mul_i32 s38, s32, 114688
    s_add_u32 s54, s54, s38
    s_lshl_b32 s42, s32, 11
    s_add_u32 m0, s42, 0
    s_nop 0
    buffer_load_dwordx4 v56, s[12:15], s54 offen lds
    s_add_u32 m0, s42, 1024
    s_nop 0
    buffer_load_dwordx4 v57, s[12:15], s54 offen lds
    s_add_u32 m0, s42, 8192
    s_nop 0
    buffer_load_dwordx4 v58, s[12:15], s54 offen lds
    s_add_u32 m0, s42, 9216
    s_nop 0
    buffer_load_dwordx4 v59, s[12:15], s54 offen lds
    s_add_u32 m0, s42, 16384
    s_nop 0
    buffer_load_dwordx4 v60, s[12:15], s54 offen lds
    s_add_u32 m0, s42, 17408
    s_nop 0
    buffer_load_dwordx4 v61, s[12:15], s54 offen lds
    s_add_u32 s54, s54, 458752
    s_add_u32 m0, s42, 24576
    s_nop 0
    buffer_load_dwordx4 v56, s[12:15], s54 offen lds
    s_add_u32 m0, s42, 25600
    s_nop 0
    buffer_load_dwordx4 v57, s[12:15], s54 offen lds
    s_add_u32 m0, s42, 32768
    s_nop 0
    buffer_load_dwordx4 v58, s[12:15], s54 offen lds
    s_add_u32 m0, s42, 33792
    s_nop 0
    buffer_load_dwordx4 v59, s[12:15], s54 offen lds
    s_add_u32 m0, s42, 40960
    s_nop 0
    buffer_load_dwordx4 v60, s[12:15], s54 offen lds
    s_add_u32 m0, s42, 41984
    s_nop 0
    buffer_load_dwordx4 v61, s[12:15], s54 offen lds
    s_add_u32 s54, s54, 458752
    s_add_u32 m0, s42, 49152
    s_nop 0
    buffer_load_dwordx4 v56, s[12:15], s54 offen lds
    s_add_u32 m0, s42, 50176
    s_nop 0
    buffer_load_dwordx4 v57, s[12:15], s54 offen lds
    s_add_u32 m0, s42, 57344
    s_nop 0
    buffer_load_dwordx4 v58, s[12:15], s54 offen lds
    s_add_u32 m0, s42, 58368
    s_nop 0
    buffer_load_dwordx4 v59, s[12:15], s54 offen lds
    s_add_u32 m0, s42, 65536
    s_nop 0
    buffer_load_dwordx4 v60, s[12:15], s54 offen lds
    s_add_u32 m0, s42, 66560
    s_nop 0
    buffer_load_dwordx4 v61, s[12:15], s54 offen lds
    s_add_u32 s54, s54, 458752
    s_add_u32 m0, s42, 73728
    s_nop 0
    buffer_load_dwordx4 v56, s[12:15], s54 offen lds
    s_add_u32 m0, s42, 74752
    s_nop 0
    buffer_load_dwordx4 v57, s[12:15], s54 offen lds
    s_add_u32 m0, s42, 81920
    s_nop 0
    buffer_load_dwordx4 v58, s[12:15], s54 offen lds
    s_add_u32 m0, s42, 82944
    s_nop 0
    buffer_load_dwordx4 v59, s[12:15], s54 offen lds
    s_add_u32 m0, s42, 90112
    s_nop 0
    buffer_load_dwordx4 v60, s[12:15], s54 offen lds
    s_add_u32 m0, s42, 91136
    s_nop 0
    buffer_load_dwordx4 v61, s[12:15], s54 offen lds
    s_add_u32 s54, s54, 458752
    s_add_u32 m0, s42, 98304
    s_nop 0
    buffer_load_dwordx4 v56, s[12:15], s54 offen lds
    s_add_u32 m0, s42, 99328
    s_nop 0
    buffer_load_dwordx4 v57, s[12:15], s54 offen lds
    s_add_u32 m0, s42, 106496
    s_nop 0
    buffer_load_dwordx4 v58, s[12:15], s54 offen lds
    s_add_u32 m0, s42, 107520
    s_nop 0
    buffer_load_dwordx4 v59, s[12:15], s54 offen lds
    s_add_u32 m0, s42, 114688
    s_nop 0
    buffer_load_dwordx4 v60, s[12:15], s54 offen lds
    s_add_u32 m0, s42, 115712
    s_nop 0
    buffer_load_dwordx4 v61, s[12:15], s54 offen lds
    s_add_u32 s54, s54, 458752
    v_lshrrev_b32 v68, 4, v0
    v_bfe_u32 v69, v0, 2, 2
    v_lshl_add_u32 v68, v68, 3, v69
    v_lshlrev_b32 v68, 7, v68
    v_lshrrev_b32 v69, 1, v69
    v_lshl_add_u32 v68, v69, 6, v68
    v_and_b32 v69, 3, v0
    v_lshl_add_u32 v68, v69, 4, v68
    s_lshr_b32 s37, s32, 1
    s_lshl_b32 s37, s37, 13
    s_and_b32 s38, s32, 1
    s_lshl_b32 s38, s38, 6
    s_add_u32 s37, s37, s38
    s_add_u32 s37, s37, 0
    v_xor_b32 v62, s37, v68
    s_lshr_b32 s37, s32, 1
    s_lshl_b32 s37, s37, 13
    s_and_b32 s38, s32, 1
    s_lshl_b32 s38, s38, 6
    s_add_u32 s37, s37, s38
    s_add_u32 s37, s37, 8
    v_xor_b32 v63, s37, v68
    s_lshr_b32 s37, s32, 1
    s_lshl_b32 s37, s37, 6
    s_and_b32 s38, s32, 1
    s_lshl_b32 s38, s38, 3
    s_add_u32 s37, s37, s38
    s_add_u32 s37, s37, 16384
    v_xor_b32 v64, s37, v68
    v_mov_b32 v68, 0x3f803f80
    v_mov_b32 v69, 0x3f803f80
    v_mov_b32 v70, 0x3f803f80
    v_mov_b32 v71, 0x3f803f80
    v_add_u32 v2, 98304, v1
    s_lshl_b32 s37, s33, 6
    s_add_u32 s37, s37, 16
    s_lshl_b32 s37, s37, 8
    v_lshl_add_u32 v5, v0, 8, s37
    s_cmp_eq_u32 s32, 0
    s_cselect_b32 s37, 8, 0
    v_cmp_le_u32 vcc, s37, v0
    s_nop 1
    v_cndmask_b32 v5, v5, 2.0, vcc
    s_lshl_b32 s43, s32, 12
    s_mul_i32 s41, s33, 2097152
    s_add_u32 s41, s41, 0x800000
    s_add_u32 s41, s41, s43
    s_mul_i32 s90, s33, 8388608
    s_add_u32 s90, s90, 0xfc0000
    s_add_u32 s37, s51, s32
    s_lshl_b32 s37, s37, 11
    s_add_u32 s90, s90, s37
    s_lshl_b32 s37, s32, 10
    s_sub_u32 s87, 8192, s37
    s_lshl_b32 s38, s35, 1
    s_lshr_b32 s39, s32, 1
    s_add_u32 s38, s38, s39
    s_cmp_eq_u32 s38, 36
    s_cselect_b32 s88, 0x5e00000, 0
    s_and_b32 s38, s32, 1
    s_lshl_b32 s38, s38, 3
    s_and_b32 s39, s32, 2
    s_lshl_b32 s39, s39, 10
    s_add_u32 s38, s38, s39
    s_add_u32 s38, s38, 65536
    v_add_u32 v3, s38, v1
    s_add_u32 s37, s37, 65536
    v_add_u32 v4, s37, v1
    v_and_b32 v6, 15, v0
    v_lshlrev_b32 v6, 3, v6
    v_lshrrev_b32 v8, 5, v0
    v_lshl_add_u32 v6, v8, 9, v6
    v_and_b32 v8, 16, v0
    v_lshl_add_u32 v6, v8, 6, v6
    v_add_u32 v118, 73728, v6
    s_mul_i32 s46, s33, 65536
    s_add_u32 s46, s46, 0x5440000
    s_add_u32 s55, s46, 63488
    s_and_b32 s52, s32, 1
    s_lshl_b32 s52, s52, 10
    s_mov_b32 s8, s74
    s_mov_b32 s9, s75
    s_mov_b32 s10, 0x1c00
    s_mov_b32 s11, 0x00020000
    v_and_b32 v8, 0x30, v0
    s_add_u32 s37, s51, s32
    s_lshl_b32 s37, s37, 6
    buffer_load_dwordx4 v[16:19], v8, s[8:11], s37 offen
    s_lshr_b32 s37, s32, 1
    s_add_u32 s37, s37, s51
    s_lshl_b32 s37, s37, 6
    s_and_b32 s38, s32, 1
    s_lshl_b32 s38, s38, 3
    s_add_u32 s37, s37, s38
    buffer_load_dwordx2 v[20:21], v8, s[8:11], s37 offen offset:256
    v_add_u32 v65, 0, v62
    v_add_u32 v66, 0, v63
    v_add_u32 v67, 0, v64
    s_waitcnt vmcnt(26)
    s_barrier
    ds_read_b64_tr_b16 a[0:1], v65 offset:0
    ds_read_b64_tr_b16 a[2:3], v65 offset:512
    ds_read_b64_tr_b16 a[4:5], v66 offset:0
    ds_read_b64_tr_b16 a[6:7], v66 offset:512
    ds_read_b64_tr_b16 a[8:9], v67 offset:0
    ds_read_b64_tr_b16 a[10:11], v67 offset:512
    ds_read_b64_tr_b16 a[12:13], v65 offset:4096
    ds_read_b64_tr_b16 a[14:15], v65 offset:4608
    ds_read_b64_tr_b16 a[16:17], v66 offset:4096
    ds_read_b64_tr_b16 a[18:19], v66 offset:4608
    ds_read_b64_tr_b16 a[20:21], v67 offset:4096
    ds_read_b64_tr_b16 a[22:23], v67 offset:4608
    s_add_u32 m0, s42, 122880
    s_nop 0
    buffer_load_dwordx4 v56, s[12:15], s54 offen lds
    s_add_u32 m0, s42, 123904
    s_nop 0
    buffer_load_dwordx4 v57, s[12:15], s54 offen lds
    s_add_u32 m0, s42, 131072
    s_nop 0
    buffer_load_dwordx4 v58, s[12:15], s54 offen lds
    s_add_u32 m0, s42, 132096
    s_nop 0
    buffer_load_dwordx4 v59, s[12:15], s54 offen lds
    s_add_u32 m0, s42, 139264
    s_nop 0
    buffer_load_dwordx4 v60, s[12:15], s54 offen lds
    s_add_u32 m0, s42, 140288
    s_nop 0
    buffer_load_dwordx4 v61, s[12:15], s54 offen lds
    s_add_u32 s54, s54, 458752
    s_waitcnt lgkmcnt(0)
    v_mfma_f32_16x16x32_bf16 v[88:91], a[0:3], v[68:71], 0
    v_mfma_f32_16x16x32_bf16 v[92:95], a[4:7], v[68:71], 0
    v_mfma_f32_16x16x32_bf16 v[96:99], a[8:11], v[68:71], 0
    v_mfma_f32_16x16x32_bf16 v[88:91], a[12:15], v[68:71], v[88:91]
    v_mfma_f32_16x16x32_bf16 v[92:95], a[16:19], v[68:71], v[92:95]
    v_mfma_f32_16x16x32_bf16 v[96:99], a[20:23], v[68:71], v[96:99]
    v_add_u32 v65, 24576, v62
    v_add_u32 v66, 24576, v63
    v_add_u32 v67, 24576, v64
    s_waitcnt vmcnt(26)
    s_barrier
    ds_read_b64_tr_b16 a[24:25], v65 offset:0
    ds_read_b64_tr_b16 a[26:27], v65 offset:512
    ds_read_b64_tr_b16 a[28:29], v66 offset:0
    ds_read_b64_tr_b16 a[30:31], v66 offset:512
    ds_read_b64_tr_b16 a[32:33], v67 offset:0
    ds_read_b64_tr_b16 a[34:35], v67 offset:512
    ds_read_b64_tr_b16 a[36:37], v65 offset:4096
    ds_read_b64_tr_b16 a[38:39], v65 offset:4608
    ds_read_b64_tr_b16 a[40:41], v66 offset:4096
    ds_read_b64_tr_b16 a[42:43], v66 offset:4608
    ds_read_b64_tr_b16 a[44:45], v67 offset:4096
    ds_read_b64_tr_b16 a[46:47], v67 offset:4608
    s_add_u32 m0, s42, 0
    s_nop 0
    buffer_load_dwordx4 v56, s[12:15], s54 offen lds
    s_add_u32 m0, s42, 1024
    s_nop 0
    buffer_load_dwordx4 v57, s[12:15], s54 offen lds
    s_add_u32 m0, s42, 8192
    s_nop 0
    buffer_load_dwordx4 v58, s[12:15], s54 offen lds
    s_add_u32 m0, s42, 9216
    s_nop 0
    buffer_load_dwordx4 v59, s[12:15], s54 offen lds
    s_add_u32 m0, s42, 16384
    s_nop 0
    buffer_load_dwordx4 v60, s[12:15], s54 offen lds
    s_add_u32 m0, s42, 17408
    s_nop 0
    buffer_load_dwordx4 v61, s[12:15], s54 offen lds
    s_add_u32 s54, s54, 458752
    s_waitcnt lgkmcnt(0)
    v_mfma_f32_16x16x32_bf16 v[88:91], a[24:27], v[68:71], v[88:91]
    v_mfma_f32_16x16x32_bf16 v[92:95], a[28:31], v[68:71], v[92:95]
    v_mfma_f32_16x16x32_bf16 v[96:99], a[32:35], v[68:71], v[96:99]
    v_mfma_f32_16x16x32_bf16 v[88:91], a[36:39], v[68:71], v[88:91]
    v_mfma_f32_16x16x32_bf16 v[92:95], a[40:43], v[68:71], v[92:95]
    v_mfma_f32_16x16x32_bf16 v[96:99], a[44:47], v[68:71], v[96:99]
    v_add_u32 v65, 49152, v62
    v_add_u32 v66, 49152, v63
    v_add_u32 v67, 49152, v64
    s_waitcnt vmcnt(26)
    s_barrier
    ds_read_b64_tr_b16 a[48:49], v65 offset:0
    ds_read_b64_tr_b16 a[50:51], v65 offset:512
    ds_read_b64_tr_b16 a[52:53], v66 offset:0
    ds_read_b64_tr_b16 a[54:55], v66 offset:512
    ds_read_b64_tr_b16 a[56:57], v67 offset:0
    ds_read_b64_tr_b16 a[58:59], v67 offset:512
    ds_read_b64_tr_b16 a[60:61], v65 offset:4096
    ds_read_b64_tr_b16 a[62:63], v65 offset:4608
    ds_read_b64_tr_b16 a[64:65], v66 offset:4096
    ds_read_b64_tr_b16 a[66:67], v66 offset:4608
    ds_read_b64_tr_b16 a[68:69], v67 offset:4096
    ds_read_b64_tr_b16 a[70:71], v67 offset:4608
    s_add_u32 m0, s42, 24576
    s_nop 0
    buffer_load_dwordx4 v56, s[12:15], s54 offen lds
    s_add_u32 m0, s42, 25600
    s_nop 0
    buffer_load_dwordx4 v57, s[12:15], s54 offen lds
    s_add_u32 m0, s42, 32768
    s_nop 0
    buffer_load_dwordx4 v58, s[12:15], s54 offen lds
    s_add_u32 m0, s42, 33792
    s_nop 0
    buffer_load_dwordx4 v59, s[12:15], s54 offen lds
    s_add_u32 m0, s42, 40960
    s_nop 0
    buffer_load_dwordx4 v60, s[12:15], s54 offen lds
    s_add_u32 m0, s42, 41984
    s_nop 0
    buffer_load_dwordx4 v61, s[12:15], s54 offen lds
    s_add_u32 s54, s54, 458752
    s_waitcnt lgkmcnt(0)
    v_mfma_f32_16x16x32_bf16 v[88:91], a[48:51], v[68:71], v[88:91]
    v_mfma_f32_16x16x32_bf16 v[92:95], a[52:55], v[68:71], v[92:95]
    v_mfma_f32_16x16x32_bf16 v[96:99], a[56:59], v[68:71], v[96:99]
    v_mfma_f32_16x16x32_bf16 v[88:91], a[60:63], v[68:71], v[88:91]
    v_mfma_f32_16x16x32_bf16 v[92:95], a[64:67], v[68:71], v[92:95]
    v_mfma_f32_16x16x32_bf16 v[96:99], a[68:71], v[68:71], v[96:99]
    v_add_u32 v65, 73728, v62
    v_add_u32 v66, 73728, v63
    v_add_u32 v67, 73728, v64
    s_waitcnt vmcnt(26)
    s_barrier
    ds_read_b64_tr_b16 a[72:73], v65 offset:0
    ds_read_b64_tr_b16 a[74:75], v65 offset:512
    ds_read_b64_tr_b16 a[76:77], v66 offset:0
    ds_read_b64_tr_b16 a[78:79], v66 offset:512
    ds_read_b64_tr_b16 a[80:81], v67 offset:0
    ds_read_b64_tr_b16 a[82:83], v67 offset:512
    ds_read_b64_tr_b16 a[84:85], v65 offset:4096
    ds_read_b64_tr_b16 a[86:87], v65 offset:4608
    ds_read_b64_tr_b16 a[88:89], v66 offset:4096
    ds_read_b64_tr_b16 a[90:91], v66 offset:4608
    ds_read_b64_tr_b16 a[92:93], v67 offset:4096
    ds_read_b64_tr_b16 a[94:95], v67 offset:4608
    s_add_u32 m0, s42, 49152
    s_nop 0
    buffer_load_dwordx4 v56, s[12:15], s54 offen lds
    s_add_u32 m0, s42, 50176
    s_nop 0
    buffer_load_dwordx4 v57, s[12:15], s54 offen lds
    s_add_u32 m0, s42, 57344
    s_nop 0
    buffer_load_dwordx4 v58, s[12:15], s54 offen lds
    s_add_u32 m0, s42, 58368
    s_nop 0
    buffer_load_dwordx4 v59, s[12:15], s54 offen lds
    s_add_u32 m0, s42, 65536
    s_nop 0
    buffer_load_dwordx4 v60, s[12:15], s54 offen lds
    s_add_u32 m0, s42, 66560
    s_nop 0
    buffer_load_dwordx4 v61, s[12:15], s54 offen lds
    s_add_u32 s54, s54, 458752
    s_waitcnt lgkmcnt(0)
    v_mfma_f32_16x16x32_bf16 v[88:91], a[72:75], v[68:71], v[88:91]
    v_mfma_f32_16x16x32_bf16 v[92:95], a[76:79], v[68:71], v[92:95]
    v_mfma_f32_16x16x32_bf16 v[96:99], a[80:83], v[68:71], v[96:99]
    v_mfma_f32_16x16x32_bf16 v[88:91], a[84:87], v[68:71], v[88:91]
    v_mfma_f32_16x16x32_bf16 v[92:95], a[88:91], v[68:71], v[92:95]
    v_mfma_f32_16x16x32_bf16 v[96:99], a[92:95], v[68:71], v[96:99]
    v_add_u32 v65, 98304, v62
    v_add_u32 v66, 98304, v63
    v_add_u32 v67, 98304, v64
    s_waitcnt vmcnt(26)
    s_barrier
    ds_read_b64_tr_b16 a[96:97], v65 offset:0
    ds_read_b64_tr_b16 a[98:99], v65 offset:512
    ds_read_b64_tr_b16 a[100:101], v66 offset:0
    ds_read_b64_tr_b16 a[102:103], v66 offset:512
    ds_read_b64_tr_b16 a[104:105], v67 offset:0
    ds_read_b64_tr_b16 a[106:107], v67 offset:512
    ds_read_b64_tr_b16 a[108:109], v65 offset:4096
    ds_read_b64_tr_b16 a[110:111], v65 offset:4608
    ds_read_b64_tr_b16 a[112:113], v66 offset:4096
    ds_read_b64_tr_b16 a[114:115], v66 offset:4608
    ds_read_b64_tr_b16 a[116:117], v67 offset:4096
    ds_read_b64_tr_b16 a[118:119], v67 offset:4608
    s_add_u32 m0, s42, 73728
    s_nop 0
    buffer_load_dwordx4 v56, s[12:15], s54 offen lds
    s_add_u32 m0, s42, 74752
    s_nop 0
    buffer_load_dwordx4 v57, s[12:15], s54 offen lds
    s_add_u32 m0, s42, 81920
    s_nop 0
    buffer_load_dwordx4 v58, s[12:15], s54 offen lds
    s_add_u32 m0, s42, 82944
    s_nop 0
    buffer_load_dwordx4 v59, s[12:15], s54 offen lds
    s_add_u32 m0, s42, 90112
    s_nop 0
    buffer_load_dwordx4 v60, s[12:15], s54 offen lds
    s_add_u32 m0, s42, 91136
    s_nop 0
    buffer_load_dwordx4 v61, s[12:15], s54 offen lds
    s_add_u32 s54, s54, 458752
    s_waitcnt lgkmcnt(0)
    v_mfma_f32_16x16x32_bf16 v[88:91], a[96:99], v[68:71], v[88:91]
    v_mfma_f32_16x16x32_bf16 v[92:95], a[100:103], v[68:71], v[92:95]
    v_mfma_f32_16x16x32_bf16 v[96:99], a[104:107], v[68:71], v[96:99]
    v_mfma_f32_16x16x32_bf16 v[88:91], a[108:111], v[68:71], v[88:91]
    v_mfma_f32_16x16x32_bf16 v[92:95], a[112:115], v[68:71], v[92:95]
    v_mfma_f32_16x16x32_bf16 v[96:99], a[116:119], v[68:71], v[96:99]
    v_add_u32 v65, 122880, v62
    v_add_u32 v66, 122880, v63
    v_add_u32 v67, 122880, v64
    s_waitcnt vmcnt(24)
    s_barrier
    ds_read_b64_tr_b16 a[120:121], v65 offset:0
    ds_read_b64_tr_b16 a[122:123], v65 offset:512
    ds_read_b64_tr_b16 a[124:125], v66 offset:0
    ds_read_b64_tr_b16 a[126:127], v66 offset:512
    ds_read_b64_tr_b16 a[128:129], v67 offset:0
    ds_read_b64_tr_b16 a[130:131], v67 offset:512
    ds_read_b64_tr_b16 a[132:133], v65 offset:4096
    ds_read_b64_tr_b16 a[134:135], v65 offset:4608
    ds_read_b64_tr_b16 a[136:137], v66 offset:4096
    ds_read_b64_tr_b16 a[138:139], v66 offset:4608
    ds_read_b64_tr_b16 a[140:141], v67 offset:4096
    ds_read_b64_tr_b16 a[142:143], v67 offset:4608
    s_add_u32 m0, s42, 98304
    s_nop 0
    buffer_load_dwordx4 v56, s[12:15], s54 offen lds
    s_add_u32 m0, s42, 99328
    s_nop 0
    buffer_load_dwordx4 v57, s[12:15], s54 offen lds
    s_add_u32 m0, s42, 106496
    s_nop 0
    buffer_load_dwordx4 v58, s[12:15], s54 offen lds
    s_add_u32 m0, s42, 107520
    s_nop 0
    buffer_load_dwordx4 v59, s[12:15], s54 offen lds
    s_add_u32 m0, s42, 114688
    s_nop 0
    buffer_load_dwordx4 v60, s[12:15], s54 offen lds
    s_add_u32 m0, s42, 115712
    s_nop 0
    buffer_load_dwordx4 v61, s[12:15], s54 offen lds
    s_add_u32 s54, s54, 458752
    s_waitcnt lgkmcnt(0)
    v_mfma_f32_16x16x32_bf16 v[88:91], a[120:123], v[68:71], v[88:91]
    v_mfma_f32_16x16x32_bf16 v[92:95], a[124:127], v[68:71], v[92:95]
    v_mfma_f32_16x16x32_bf16 v[96:99], a[128:131], v[68:71], v[96:99]
    v_mfma_f32_16x16x32_bf16 v[88:91], a[132:135], v[68:71], v[88:91]
    v_mfma_f32_16x16x32_bf16 v[92:95], a[136:139], v[68:71], v[92:95]
    v_mfma_f32_16x16x32_bf16 v[96:99], a[140:143], v[68:71], v[96:99]
    v_add_u32 v65, 0, v62
    v_add_u32 v66, 0, v63
    v_add_u32 v67, 0, v64
    s_waitcnt vmcnt(24)
    s_barrier
    ds_read_b64_tr_b16 a[144:145], v65 offset:0
    ds_read_b64_tr_b16 a[146:147], v65 offset:512
    ds_read_b64_tr_b16 a[148:149], v66 offset:0
    ds_read_b64_tr_b16 a[150:151], v66 offset:512
    ds_read_b64_tr_b16 a[152:153], v67 offset:0
    ds_read_b64_tr_b16 a[154:155], v67 offset:512
    ds_read_b64_tr_b16 a[156:157], v65 offset:4096
    ds_read_b64_tr_b16 a[158:159], v65 offset:4608
    ds_read_b64_tr_b16 a[160:161], v66 offset:4096
    ds_read_b64_tr_b16 a[162:163], v66 offset:4608
    ds_read_b64_tr_b16 a[164:165], v67 offset:4096
    ds_read_b64_tr_b16 a[166:167], v67 offset:4608
    s_add_u32 m0, s42, 122880
    s_nop 0
    buffer_load_dwordx4 v56, s[12:15], s54 offen lds
    s_add_u32 m0, s42, 123904
    s_nop 0
    buffer_load_dwordx4 v57, s[12:15], s54 offen lds
    s_add_u32 m0, s42, 131072
    s_nop 0
    buffer_load_dwordx4 v58, s[12:15], s54 offen lds
    s_add_u32 m0, s42, 132096
    s_nop 0
    buffer_load_dwordx4 v59, s[12:15], s54 offen lds
    s_add_u32 m0, s42, 139264
    s_nop 0
    buffer_load_dwordx4 v60, s[12:15], s54 offen lds
    s_add_u32 m0, s42, 140288
    s_nop 0
    buffer_load_dwordx4 v61, s[12:15], s54 offen lds
    s_add_u32 s54, s54, 458752
    s_waitcnt lgkmcnt(0)
    v_mfma_f32_16x16x32_bf16 v[88:91], a[144:147], v[68:71], v[88:91]
    v_mfma_f32_16x16x32_bf16 v[92:95], a[148:151], v[68:71], v[92:95]
    v_mfma_f32_16x16x32_bf16 v[96:99], a[152:155], v[68:71], v[96:99]
    v_mfma_f32_16x16x32_bf16 v[88:91], a[156:159], v[68:71], v[88:91]
    v_mfma_f32_16x16x32_bf16 v[92:95], a[160:163], v[68:71], v[92:95]
    v_mfma_f32_16x16x32_bf16 v[96:99], a[164:167], v[68:71], v[96:99]
    v_add_u32 v65, 24576, v62
    v_add_u32 v66, 24576, v63
    v_add_u32 v67, 24576, v64
    s_waitcnt vmcnt(24)
    s_barrier
    ds_read_b64_tr_b16 a[168:169], v65 offset:0
    ds_read_b64_tr_b16 a[170:171], v65 offset:512
    ds_read_b64_tr_b16 a[172:173], v66 offset:0
    ds_read_b64_tr_b16 a[174:175], v66 offset:512
    ds_read_b64_tr_b16 a[176:177], v67 offset:0
    ds_read_b64_tr_b16 a[178:179], v67 offset:512
    ds_read_b64_tr_b16 a[180:181], v65 offset:4096
    ds_read_b64_tr_b16 a[182:183], v65 offset:4608
    ds_read_b64_tr_b16 a[184:185], v66 offset:4096
    ds_read_b64_tr_b16 a[186:187], v66 offset:4608
    ds_read_b64_tr_b16 a[188:189], v67 offset:4096
    ds_read_b64_tr_b16 a[190:191], v67 offset:4608
    s_add_u32 m0, s42, 0
    s_nop 0
    buffer_load_dwordx4 v56, s[12:15], s54 offen lds
    s_add_u32 m0, s42, 1024
    s_nop 0
    buffer_load_dwordx4 v57, s[12:15], s54 offen lds
    s_add_u32 m0, s42, 8192
    s_nop 0
    buffer_load_dwordx4 v58, s[12:15], s54 offen lds
    s_add_u32 m0, s42, 9216
    s_nop 0
    buffer_load_dwordx4 v59, s[12:15], s54 offen lds
    s_add_u32 m0, s42, 16384
    s_nop 0
    buffer_load_dwordx4 v60, s[12:15], s54 offen lds
    s_add_u32 m0, s42, 17408
    s_nop 0
    buffer_load_dwordx4 v61, s[12:15], s54 offen lds
    s_add_u32 s54, s54, 458752
    s_waitcnt lgkmcnt(0)
    v_mfma_f32_16x16x32_bf16 v[88:91], a[168:171], v[68:71], v[88:91]
    v_mfma_f32_16x16x32_bf16 v[92:95], a[172:175], v[68:71], v[92:95]
    v_mfma_f32_16x16x32_bf16 v[96:99], a[176:179], v[68:71], v[96:99]
    v_mfma_f32_16x16x32_bf16 v[88:91], a[180:183], v[68:71], v[88:91]
    v_mfma_f32_16x16x32_bf16 v[92:95], a[184:187], v[68:71], v[92:95]
    v_mfma_f32_16x16x32_bf16 v[96:99], a[188:191], v[68:71], v[96:99]
    v_add_u32 v65, 49152, v62
    v_add_u32 v66, 49152, v63
    v_add_u32 v67, 49152, v64
    s_waitcnt vmcnt(24)
    s_barrier
    ds_read_b64_tr_b16 a[192:193], v65 offset:0
    ds_read_b64_tr_b16 a[194:195], v65 offset:512
    ds_read_b64_tr_b16 a[196:197], v66 offset:0
    ds_read_b64_tr_b16 a[198:199], v66 offset:512
    ds_read_b64_tr_b16 a[200:201], v67 offset:0
    ds_read_b64_tr_b16 a[202:203], v67 offset:512
    ds_read_b64_tr_b16 a[204:205], v65 offset:4096
    ds_read_b64_tr_b16 a[206:207], v65 offset:4608
    ds_read_b64_tr_b16 a[208:209], v66 offset:4096
    ds_read_b64_tr_b16 a[210:211], v66 offset:4608
    ds_read_b64_tr_b16 a[212:213], v67 offset:4096
    ds_read_b64_tr_b16 a[214:215], v67 offset:4608
    s_add_u32 m0, s42, 24576
    s_nop 0
    buffer_load_dwordx4 v56, s[12:15], s54 offen lds
    s_add_u32 m0, s42, 25600
    s_nop 0
    buffer_load_dwordx4 v57, s[12:15], s54 offen lds
    s_add_u32 m0, s42, 32768
    s_nop 0
    buffer_load_dwordx4 v58, s[12:15], s54 offen lds
    s_add_u32 m0, s42, 33792
    s_nop 0
    buffer_load_dwordx4 v59, s[12:15], s54 offen lds
    s_add_u32 m0, s42, 40960
    s_nop 0
    buffer_load_dwordx4 v60, s[12:15], s54 offen lds
    s_add_u32 m0, s42, 41984
    s_nop 0
    buffer_load_dwordx4 v61, s[12:15], s54 offen lds
    s_add_u32 s54, s54, 458752
    s_waitcnt lgkmcnt(0)
    v_mfma_f32_16x16x32_bf16 v[88:91], a[192:195], v[68:71], v[88:91]
    v_mfma_f32_16x16x32_bf16 v[92:95], a[196:199], v[68:71], v[92:95]
    v_mfma_f32_16x16x32_bf16 v[96:99], a[200:203], v[68:71], v[96:99]
    v_mfma_f32_16x16x32_bf16 v[88:91], a[204:207], v[68:71], v[88:91]
    v_mfma_f32_16x16x32_bf16 v[92:95], a[208:211], v[68:71], v[92:95]
    v_mfma_f32_16x16x32_bf16 v[96:99], a[212:215], v[68:71], v[96:99]
    v_add_u32 v65, 73728, v62
    v_add_u32 v66, 73728, v63
    v_add_u32 v67, 73728, v64
    s_waitcnt vmcnt(24)
    s_barrier
    ds_read_b64_tr_b16 a[216:217], v65 offset:0
    ds_read_b64_tr_b16 a[218:219], v65 offset:512
    ds_read_b64_tr_b16 a[220:221], v66 offset:0
    ds_read_b64_tr_b16 a[222:223], v66 offset:512
    ds_read_b64_tr_b16 a[224:225], v67 offset:0
    ds_read_b64_tr_b16 a[226:227], v67 offset:512
    ds_read_b64_tr_b16 a[228:229], v65 offset:4096
    ds_read_b64_tr_b16 a[230:231], v65 offset:4608
    ds_read_b64_tr_b16 a[232:233], v66 offset:4096
    ds_read_b64_tr_b16 a[234:235], v66 offset:4608
    ds_read_b64_tr_b16 a[236:237], v67 offset:4096
    ds_read_b64_tr_b16 a[238:239], v67 offset:4608
    s_add_u32 m0, s42, 49152
    s_nop 0
    buffer_load_dwordx4 v56, s[12:15], s54 offen lds
    s_add_u32 m0, s42, 50176
    s_nop 0
    buffer_load_dwordx4 v57, s[12:15], s54 offen lds
    s_add_u32 m0, s42, 57344
    s_nop 0
    buffer_load_dwordx4 v58, s[12:15], s54 offen lds
    s_add_u32 m0, s42, 58368
    s_nop 0
    buffer_load_dwordx4 v59, s[12:15], s54 offen lds
    s_add_u32 m0, s42, 65536
    s_nop 0
    buffer_load_dwordx4 v60, s[12:15], s54 offen lds
    s_add_u32 m0, s42, 66560
    s_nop 0
    buffer_load_dwordx4 v61, s[12:15], s54 offen lds
    s_add_u32 s54, s54, 458752
    s_waitcnt lgkmcnt(0)
    v_mfma_f32_16x16x32_bf16 v[88:91], a[216:219], v[68:71], v[88:91]
    v_mfma_f32_16x16x32_bf16 v[92:95], a[220:223], v[68:71], v[92:95]
    v_mfma_f32_16x16x32_bf16 v[96:99], a[224:227], v[68:71], v[96:99]
    v_mfma_f32_16x16x32_bf16 v[88:91], a[228:231], v[68:71], v[88:91]
    v_mfma_f32_16x16x32_bf16 v[92:95], a[232:235], v[68:71], v[92:95]
    v_mfma_f32_16x16x32_bf16 v[96:99], a[236:239], v[68:71], v[96:99]
    v_add_u32 v65, 98304, v62
    v_add_u32 v66, 98304, v63
    v_add_u32 v67, 98304, v64
    s_waitcnt vmcnt(24)
    s_barrier
    ds_read_b64_tr_b16 a[240:241], v65 offset:0
    ds_read_b64_tr_b16 a[242:243], v65 offset:512
    ds_read_b64_tr_b16 a[244:245], v66 offset:0
    ds_read_b64_tr_b16 a[246:247], v66 offset:512
    ds_read_b64_tr_b16 a[248:249], v67 offset:0
    ds_read_b64_tr_b16 a[250:251], v67 offset:512
    ds_read_b64_tr_b16 a[252:253], v65 offset:4096
    ds_read_b64_tr_b16 a[254:255], v65 offset:4608
    ds_read_b64_tr_b16 v[128:129], v66 offset:4096
    ds_read_b64_tr_b16 v[130:131], v66 offset:4608
    ds_read_b64_tr_b16 v[132:133], v67 offset:4096
    ds_read_b64_tr_b16 v[134:135], v67 offset:4608
    s_add_u32 m0, s42, 73728
    s_nop 0
    buffer_load_dwordx4 v56, s[12:15], s54 offen lds
    s_add_u32 m0, s42, 74752
    s_nop 0
    buffer_load_dwordx4 v57, s[12:15], s54 offen lds
    s_add_u32 m0, s42, 81920
    s_nop 0
    buffer_load_dwordx4 v58, s[12:15], s54 offen lds
    s_add_u32 m0, s42, 82944
    s_nop 0
    buffer_load_dwordx4 v59, s[12:15], s54 offen lds
    s_add_u32 m0, s42, 90112
    s_nop 0
    buffer_load_dwordx4 v60, s[12:15], s54 offen lds
    s_add_u32 m0, s42, 91136
    s_nop 0
    buffer_load_dwordx4 v61, s[12:15], s54 offen lds
    s_add_u32 s54, s54, 458752
    s_waitcnt lgkmcnt(0)
    v_mfma_f32_16x16x32_bf16 v[88:91], a[240:243], v[68:71], v[88:91]
    v_mfma_f32_16x16x32_bf16 v[92:95], a[244:247], v[68:71], v[92:95]
    v_mfma_f32_16x16x32_bf16 v[96:99], a[248:251], v[68:71], v[96:99]
    v_mfma_f32_16x16x32_bf16 v[88:91], a[252:255], v[68:71], v[88:91]
    v_mfma_f32_16x16x32_bf16 v[92:95], v[128:131], v[68:71], v[92:95]
    v_mfma_f32_16x16x32_bf16 v[96:99], v[132:135], v[68:71], v[96:99]
    v_add_u32 v65, 122880, v62
    v_add_u32 v66, 122880, v63
    v_add_u32 v67, 122880, v64
    s_waitcnt vmcnt(24)
    s_barrier
    ds_read_b64_tr_b16 v[136:137], v65 offset:0
    ds_read_b64_tr_b16 v[138:139], v65 offset:512
    ds_read_b64_tr_b16 v[140:141], v66 offset:0
    ds_read_b64_tr_b16 v[142:143], v66 offset:512
    ds_read_b64_tr_b16 v[144:145], v67 offset:0
    ds_read_b64_tr_b16 v[146:147], v67 offset:512
    ds_read_b64_tr_b16 v[148:149], v65 offset:4096
    ds_read_b64_tr_b16 v[150:151], v65 offset:4608
    ds_read_b64_tr_b16 v[152:153], v66 offset:4096
    ds_read_b64_tr_b16 v[154:155], v66 offset:4608
    ds_read_b64_tr_b16 v[156:157], v67 offset:4096
    ds_read_b64_tr_b16 v[158:159], v67 offset:4608
    s_waitcnt lgkmcnt(0)
    v_mfma_f32_16x16x32_bf16 v[88:91], v[136:139], v[68:71], v[88:91]
    v_mfma_f32_16x16x32_bf16 v[92:95], v[140:143], v[68:71], v[92:95]
    v_mfma_f32_16x16x32_bf16 v[96:99], v[144:147], v[68:71], v[96:99]
    v_mfma_f32_16x16x32_bf16 v[88:91], v[148:151], v[68:71], v[88:91]
    v_mfma_f32_16x16x32_bf16 v[92:95], v[152:155], v[68:71], v[92:95]
    v_mfma_f32_16x16x32_bf16 v[96:99], v[156:159], v[68:71], v[96:99]
    v_add_u32 v65, 0, v62
    v_add_u32 v66, 0, v63
    v_add_u32 v67, 0, v64
    s_waitcnt vmcnt(18)
    s_barrier
    ds_read_b64_tr_b16 v[160:161], v65 offset:0
    ds_read_b64_tr_b16 v[162:163], v65 offset:512
    ds_read_b64_tr_b16 v[164:165], v66 offset:0
    ds_read_b64_tr_b16 v[166:167], v66 offset:512
    ds_read_b64_tr_b16 v[168:169], v67 offset:0
    ds_read_b64_tr_b16 v[170:171], v67 offset:512
    ds_read_b64_tr_b16 v[172:173], v65 offset:4096
    ds_read_b64_tr_b16 v[174:175], v65 offset:4608
    ds_read_b64_tr_b16 v[176:177], v66 offset:4096
    ds_read_b64_tr_b16 v[178:179], v66 offset:4608
    ds_read_b64_tr_b16 v[180:181], v67 offset:4096
    ds_read_b64_tr_b16 v[182:183], v67 offset:4608
    s_waitcnt lgkmcnt(0)
    v_mfma_f32_16x16x32_bf16 v[88:91], v[160:163], v[68:71], v[88:91]
    v_mfma_f32_16x16x32_bf16 v[92:95], v[164:167], v[68:71], v[92:95]
    v_mfma_f32_16x16x32_bf16 v[96:99], v[168:171], v[68:71], v[96:99]
    v_mfma_f32_16x16x32_bf16 v[88:91], v[172:175], v[68:71], v[88:91]
    v_mfma_f32_16x16x32_bf16 v[92:95], v[176:179], v[68:71], v[92:95]
    v_mfma_f32_16x16x32_bf16 v[96:99], v[180:183], v[68:71], v[96:99]
    v_add_u32 v65, 24576, v62
    v_add_u32 v66, 24576, v63
    v_add_u32 v67, 24576, v64
    s_waitcnt vmcnt(12)
    s_barrier
    ds_read_b64_tr_b16 v[184:185], v65 offset:0
    ds_read_b64_tr_b16 v[186:187], v65 offset:512
    ds_read_b64_tr_b16 v[188:189], v66 offset:0
    ds_read_b64_tr_b16 v[190:191], v66 offset:512
    ds_read_b64_tr_b16 v[192:193], v67 offset:0
    ds_read_b64_tr_b16 v[194:195], v67 offset:512
    ds_read_b64_tr_b16 v[196:197], v65 offset:4096
    ds_read_b64_tr_b16 v[198:199], v65 offset:4608
    ds_read_b64_tr_b16 v[200:201], v66 offset:4096
    ds_read_b64_tr_b16 v[202:203], v66 offset:4608
    ds_read_b64_tr_b16 v[204:205], v67 offset:4096
    ds_read_b64_tr_b16 v[206:207], v67 offset:4608
    s_waitcnt lgkmcnt(0)
    v_mfma_f32_16x16x32_bf16 v[88:91], v[184:187], v[68:71], v[88:91]
    v_mfma_f32_16x16x32_bf16 v[92:95], v[188:191], v[68:71], v[92:95]
    v_mfma_f32_16x16x32_bf16 v[96:99], v[192:195], v[68:71], v[96:99]
    v_mfma_f32_16x16x32_bf16 v[88:91], v[196:199], v[68:71], v[88:91]
    v_mfma_f32_16x16x32_bf16 v[92:95], v[200:203], v[68:71], v[92:95]
    v_mfma_f32_16x16x32_bf16 v[96:99], v[204:207], v[68:71], v[96:99]
    v_add_u32 v65, 49152, v62
    v_add_u32 v66, 49152, v63
    v_add_u32 v67, 49152, v64
    s_waitcnt vmcnt(6)
    s_barrier
    ds_read_b64_tr_b16 v[208:209], v65 offset:0
    ds_read_b64_tr_b16 v[210:211], v65 offset:512
    ds_read_b64_tr_b16 v[212:213], v66 offset:0
    ds_read_b64_tr_b16 v[214:215], v66 offset:512
    ds_read_b64_tr_b16 v[216:217], v67 offset:0
    ds_read_b64_tr_b16 v[218:219], v67 offset:512
    ds_read_b64_tr_b16 v[220:221], v65 offset:4096
    ds_read_b64_tr_b16 v[222:223], v65 offset:4608
    ds_read_b64_tr_b16 v[224:225], v66 offset:4096
    ds_read_b64_tr_b16 v[226:227], v66 offset:4608
    ds_read_b64_tr_b16 v[228:229], v67 offset:4096
    ds_read_b64_tr_b16 v[230:231], v67 offset:4608
    s_waitcnt lgkmcnt(0)
    v_mfma_f32_16x16x32_bf16 v[88:91], v[208:211], v[68:71], v[88:91]
    v_mfma_f32_16x16x32_bf16 v[92:95], v[212:215], v[68:71], v[92:95]
    v_mfma_f32_16x16x32_bf16 v[96:99], v[216:219], v[68:71], v[96:99]
    v_mfma_f32_16x16x32_bf16 v[88:91], v[220:223], v[68:71], v[88:91]
    v_mfma_f32_16x16x32_bf16 v[92:95], v[224:227], v[68:71], v[92:95]
    v_mfma_f32_16x16x32_bf16 v[96:99], v[228:231], v[68:71], v[96:99]
    v_add_u32 v65, 73728, v62
    v_add_u32 v66, 73728, v63
    v_add_u32 v67, 73728, v64
    s_waitcnt vmcnt(0)
    s_barrier
    ds_read_b64_tr_b16 v[232:233], v65 offset:0
    ds_read_b64_tr_b16 v[234:235], v65 offset:512
    ds_read_b64_tr_b16 v[236:237], v66 offset:0
    ds_read_b64_tr_b16 v[238:239], v66 offset:512
    ds_read_b64_tr_b16 v[240:241], v67 offset:0
    ds_read_b64_tr_b16 v[242:243], v67 offset:512
    ds_read_b64_tr_b16 v[244:245], v65 offset:4096
    ds_read_b64_tr_b16 v[246:247], v65 offset:4608
    ds_read_b64_tr_b16 v[248:249], v66 offset:4096
    ds_read_b64_tr_b16 v[250:251], v66 offset:4608
    ds_read_b64_tr_b16 v[252:253], v67 offset:4096
    ds_read_b64_tr_b16 v[254:255], v67 offset:4608
    s_waitcnt lgkmcnt(0)
    v_mfma_f32_16x16x32_bf16 v[88:91], v[232:235], v[68:71], v[88:91]
    v_mfma_f32_16x16x32_bf16 v[92:95], v[236:239], v[68:71], v[92:95]
    v_mfma_f32_16x16x32_bf16 v[96:99], v[240:243], v[68:71], v[96:99]
    v_mfma_f32_16x16x32_bf16 v[88:91], v[244:247], v[68:71], v[88:91]
    v_mfma_f32_16x16x32_bf16 v[92:95], v[248:251], v[68:71], v[92:95]
    v_mfma_f32_16x16x32_bf16 v[96:99], v[252:255], v[68:71], v[96:99]
    s_barrier
    s_mov_b32 s37, 0xffff0000
    v_lshlrev_b32 v100, 16, v16
    v_and_b32 v101, s37, v16
    v_lshlrev_b32 v102, 16, v17
    v_and_b32 v103, s37, v17
    v_lshlrev_b32 v104, 16, v18
    v_and_b32 v105, s37, v18
    v_lshlrev_b32 v106, 16, v19
    v_and_b32 v107, s37, v19
    v_lshlrev_b32 v108, 16, v20
    v_and_b32 v109, s37, v20
    v_lshlrev_b32 v110, 16, v21
    v_and_b32 v111, s37, v21
    s_cmp_lg_u32 s32, 0
    s_cbranch_scc1 L_arv17
    s_add_u32 s20, s82, 0x80
    s_addc_u32 s21, s83, 0
    s_mov_b32 s22, 0x4
    s_mov_b32 s23, 0x00020000
    buffer_load_dword v56, v124, s[20:23], 0 offen sc1
    s_waitcnt vmcnt(0)
    v_cmp_eq_u32 vcc, v124, v56
    s_cbranch_vccnz L_spin18
L_back19:
L_arv17:
    s_add_u32 s96, s41, 2031616
    s_mov_b32 s98, s41
    s_mov_b32 s45, 0x5560000
    buffer_load_dword v7, v5, s[16:19], s45 offen sc1
    s_waitcnt vmcnt(0)
    v_cmp_ne_u32 vcc, 0, v7
    s_cbranch_vccnz L_spin20
L_back21:
    s_barrier
    s_add_u32 m0, s43, 0
    s_add_u32 s42, s41, 0
    buffer_load_dwordx4 v1, s[16:19], s42 offen offset:0 sc1 lds
    buffer_load_dwordx4 v1, s[16:19], s42 offen offset:1024 sc1 lds
    buffer_load_dwordx4 v1, s[16:19], s42 offen offset:2048 sc1 lds
    buffer_load_dwordx4 v1, s[16:19], s42 offen offset:3072 sc1 lds
    s_add_u32 m0, s43, 16384
    s_add_u32 s42, s41, 16384
    buffer_load_dwordx4 v1, s[16:19], s42 offen offset:0 sc1 lds
    buffer_load_dwordx4 v1, s[16:19], s42 offen offset:1024 sc1 lds
    buffer_load_dwordx4 v1, s[16:19], s42 offen offset:2048 sc1 lds
    buffer_load_dwordx4 v1, s[16:19], s42 offen offset:3072 sc1 lds
    s_add_u32 m0, s43, 32768
    s_add_u32 s42, s41, 32768
    buffer_load_dwordx4 v1, s[16:19], s42 offen offset:0 sc1 lds
    buffer_load_dwordx4 v1, s[16:19], s42 offen offset:1024 sc1 lds
    buffer_load_dwordx4 v1, s[16:19], s42 offen offset:2048 sc1 lds
    buffer_load_dwordx4 v1, s[16:19], s42 offen offset:3072 sc1 lds
    s_add_u32 s45, s45, 131072
    s_add_u32 m0, s52, 73728
    s_add_u32 s42, s46, s52
    buffer_load_dwordx4 v1, s[16:19], s42 offen sc1 lds
    s_waitcnt vmcnt(0) lgkmcnt(0)
    s_barrier
    ds_read_b128 v[56:59], v1 offset:0
    ds_read_b128 v[60:63], v1 offset:1024
    ds_read_b128 v[64:67], v1 offset:2048
    ds_read_b128 v[68:71], v1 offset:3072
    s_mov_b32 s36, 0
    s_waitcnt lgkmcnt(0)
    s_nop 7
L_a_b0:
    s_waitcnt lgkmcnt(2)
    v_mfma_f32_16x16x32_bf16 v[8:11], a[0:3], v[56:59], 0
    s_and_b32 s44, s90, 0xffffffff
    ds_read_b128 v[72:75], v1 offset:4096
    v_mul_f32 v120, v48, v116
    v_mfma_f32_16x16x32_bf16 v[16:19], a[0:3], v[60:63], 0
    s_cmp_eq_u32 s36, 0
    v_mul_f32 v121, v49, v116
    v_mul_f32 v120, v120, abs(v48)
    v_mfma_f32_16x16x32_bf16 v[20:23], a[4:7], v[60:63], 0
    s_cselect_b32 s44, 0x5e00000, s44
    v_mul_f32 v121, v121, abs(v49)
    v_cvt_pk_bf16_f32 v48, v120, v121
    v_mfma_f32_16x16x32_bf16 v[12:15], a[4:7], v[56:59], 0
    s_add_u32 s49, s44, s87
    ds_read_b128 v[76:79], v1 offset:5120
    v_pk_max_i16 v48, v48, 0
    v_mfma_f32_16x16x32_bf16 v[24:27], a[8:11], v[56:59], 0
    s_max_u32 s44, s44, s88
    v_mul_f32 v120, v50, v116
    v_mul_f32 v121, v51, v116
    v_mfma_f32_16x16x32_bf16 v[28:31], a[8:11], v[60:63], 0
    s_waitcnt lgkmcnt(2)
    v_mul_f32 v120, v120, abs(v50)
    v_mul_f32 v121, v121, abs(v51)
    v_mfma_f32_16x16x32_bf16 v[8:11], a[12:15], v[64:67], v[8:11]
    s_add_u32 s90, s90, 262144
    ds_read_b128 v[80:83], v1 offset:6144
    v_cvt_pk_bf16_f32 v49, v120, v121
    v_mfma_f32_16x16x32_bf16 v[16:19], a[12:15], v[68:71], v[16:19]
    s_add_u32 m0, s52, 73728
    v_pk_max_i16 v49, v49, 0
    s_add_u32 s42, s46, s52
    v_mfma_f32_16x16x32_bf16 v[20:23], a[16:19], v[68:71], v[20:23]
    buffer_load_dwordx4 v1, s[16:19], s42 offen sc1 lds
    v_mfma_f32_16x16x32_bf16 v[12:15], a[16:19], v[64:67], v[12:15]
    ds_read_b128 v[84:87], v1 offset:7168
    v_mfma_f32_16x16x32_bf16 v[24:27], a[20:23], v[64:67], v[24:27]
    ds_write_b64 v3, v[48:49] offset:4096
    v_mfma_f32_16x16x32_bf16 v[28:31], a[20:23], v[68:71], v[28:31]
    s_waitcnt lgkmcnt(3)
    v_mul_f32 v120, v52, v117
    v_mul_f32 v121, v53, v117
    v_mfma_f32_16x16x32_bf16 v[8:11], a[24:27], v[72:75], v[8:11]
    ds_read_b128 v[56:59], v1 offset:8192
    v_mul_f32 v120, v120, abs(v52)
    v_mfma_f32_16x16x32_bf16 v[16:19], a[24:27], v[76:79], v[16:19]
    v_mul_f32 v121, v121, abs(v53)
    v_cvt_pk_bf16_f32 v52, v120, v121
    v_mfma_f32_16x16x32_bf16 v[20:23], a[28:31], v[76:79], v[20:23]
    v_pk_max_i16 v52, v52, 0
    v_mul_f32 v120, v54, v117
    v_mfma_f32_16x16x32_bf16 v[12:15], a[28:31], v[72:75], v[12:15]
    ds_read_b128 v[60:63], v1 offset:9216
    v_mul_f32 v121, v55, v117
    v_mfma_f32_16x16x32_bf16 v[24:27], a[32:35], v[72:75], v[24:27]
    v_mul_f32 v120, v120, abs(v54)
    v_mul_f32 v121, v121, abs(v55)
    v_mfma_f32_16x16x32_bf16 v[28:31], a[32:35], v[76:79], v[28:31]
    s_waitcnt lgkmcnt(3)
    v_cvt_pk_bf16_f32 v53, v120, v121
    v_pk_max_i16 v53, v53, 0
    v_mfma_f32_16x16x32_bf16 v[8:11], a[36:39], v[80:83], v[8:11]
    ds_read_b128 v[64:67], v1 offset:10240
    v_mfma_f32_16x16x32_bf16 v[16:19], a[36:39], v[84:87], v[16:19]
    ds_write_b64 v3, v[52:53] offset:5120
    v_mfma_f32_16x16x32_bf16 v[20:23], a[40:43], v[84:87], v[20:23]
    v_mul_f32 v120, v32, v116
    v_mul_f32 v121, v33, v116
    v_mfma_f32_16x16x32_bf16 v[12:15], a[40:43], v[80:83], v[12:15]
    ds_read_b128 v[68:71], v1 offset:11264
    v_mul_f32 v120, v120, abs(v32)
    v_mfma_f32_16x16x32_bf16 v[24:27], a[44:47], v[80:83], v[24:27]
    v_mul_f32 v121, v121, abs(v33)
    v_cvt_pk_bf16_f32 v32, v120, v121
    v_mfma_f32_16x16x32_bf16 v[28:31], a[44:47], v[84:87], v[28:31]
    s_waitcnt lgkmcnt(3)
    v_pk_max_i16 v32, v32, 0
    v_mul_f32 v120, v34, v116
    v_mfma_f32_16x16x32_bf16 v[8:11], a[48:51], v[56:59], v[8:11]
    ds_read_b128 v[72:75], v1 offset:12288
    v_mul_f32 v121, v35, v116
    v_mfma_f32_16x16x32_bf16 v[16:19], a[48:51], v[60:63], v[16:19]
    v_mul_f32 v120, v120, abs(v34)
    v_mul_f32 v121, v121, abs(v35)
    v_mfma_f32_16x16x32_bf16 v[20:23], a[52:55], v[60:63], v[20:23]
    v_cvt_pk_bf16_f32 v33, v120, v121
    v_pk_max_i16 v33, v33, 0
    v_mfma_f32_16x16x32_bf16 v[12:15], a[52:55], v[56:59], v[12:15]
    ds_read_b128 v[76:79], v1 offset:13312
    v_mul_f32 v120, v36, v116
    v_mfma_f32_16x16x32_bf16 v[24:27], a[56:59], v[56:59], v[24:27]
    v_mul_f32 v121, v37, v116
    v_mul_f32 v120, v120, abs(v36)
    v_mfma_f32_16x16x32_bf16 v[28:31], a[56:59], v[60:63], v[28:31]
    s_waitcnt vmcnt(5) lgkmcnt(2)
    s_barrier
    v_mul_f32 v121, v121, abs(v37)
    v_mfma_f32_16x16x32_bf16 v[8:11], a[60:63], v[64:67], v[8:11]
    ds_read_b128 v[80:83], v1 offset:14336
    v_cvt_pk_bf16_f32 v34, v120, v121
    v_mfma_f32_16x16x32_bf16 v[16:19], a[60:63], v[68:71], v[16:19]
    ds_read_b128 v[48:51], v4 offset:4096
    v_pk_max_i16 v34, v34, 0
    v_mfma_f32_16x16x32_bf16 v[20:23], a[64:67], v[68:71], v[20:23]
    v_mul_f32 v120, v38, v116
    v_mul_f32 v121, v39, v116
    v_mfma_f32_16x16x32_bf16 v[12:15], a[64:67], v[64:67], v[12:15]
    ds_read_b128 v[84:87], v1 offset:15360
    v_mul_f32 v120, v120, abs(v38)
    v_mfma_f32_16x16x32_bf16 v[24:27], a[68:71], v[64:67], v[24:27]
    v_mul_f32 v121, v121, abs(v39)
    v_cvt_pk_bf16_f32 v35, v120, v121
    v_mfma_f32_16x16x32_bf16 v[28:31], a[68:71], v[68:71], v[28:31]
    s_waitcnt lgkmcnt(3)
    v_pk_max_i16 v35, v35, 0
    s_waitcnt lgkmcnt(1)
    v_mfma_f32_16x16x32_bf16 v[8:11], a[72:75], v[72:75], v[8:11]
    ds_read_b128 v[56:59], v1 offset:16384
    v_mfma_f32_16x16x32_bf16 v[16:19], a[72:75], v[76:79], v[16:19]
    buffer_store_dwordx4 v[48:51], v1, s[16:19], s49 offen sc1
    v_mfma_f32_16x16x32_bf16 v[20:23], a[76:79], v[76:79], v[20:23]
    buffer_store_dwordx4 v[32:35], v1, s[16:19], s44 offen offset:0 sc1
    v_mfma_f32_16x16x32_bf16 v[12:15], a[76:79], v[72:75], v[12:15]
    ds_read_b128 v[60:63], v1 offset:17408
    v_mul_f32 v120, v40, v117
    v_mfma_f32_16x16x32_bf16 v[24:27], a[80:83], v[72:75], v[24:27]
    v_mul_f32 v121, v41, v117
    v_mul_f32 v120, v120, abs(v40)
    v_mfma_f32_16x16x32_bf16 v[28:31], a[80:83], v[76:79], v[28:31]
    s_waitcnt lgkmcnt(2)
    v_mul_f32 v121, v121, abs(v41)
    v_cvt_pk_bf16_f32 v40, v120, v121
    v_mfma_f32_16x16x32_bf16 v[8:11], a[84:87], v[80:83], v[8:11]
    ds_read_b128 v[64:67], v1 offset:18432
    v_pk_max_i16 v40, v40, 0
    v_mfma_f32_16x16x32_bf16 v[16:19], a[84:87], v[84:87], v[16:19]
    v_mul_f32 v120, v42, v117
    v_mul_f32 v121, v43, v117
    v_mfma_f32_16x16x32_bf16 v[20:23], a[88:91], v[84:87], v[20:23]
    v_mul_f32 v120, v120, abs(v42)
    v_mul_f32 v121, v121, abs(v43)
    v_mfma_f32_16x16x32_bf16 v[12:15], a[88:91], v[80:83], v[12:15]
    ds_read_b128 v[68:71], v1 offset:19456
    v_cvt_pk_bf16_f32 v41, v120, v121
    v_mfma_f32_16x16x32_bf16 v[24:27], a[92:95], v[80:83], v[24:27]
    v_pk_max_i16 v41, v41, 0
    v_mul_f32 v120, v44, v117
    v_mfma_f32_16x16x32_bf16 v[28:31], a[92:95], v[84:87], v[28:31]
    s_waitcnt lgkmcnt(2)
    v_mul_f32 v121, v45, v117
    v_mul_f32 v120, v120, abs(v44)
    v_mfma_f32_16x16x32_bf16 v[8:11], a[96:99], v[56:59], v[8:11]
    ds_read_b128 v[72:75], v1 offset:20480
    v_mul_f32 v121, v121, abs(v45)
    v_mfma_f32_16x16x32_bf16 v[16:19], a[96:99], v[60:63], v[16:19]
    v_cvt_pk_bf16_f32 v42, v120, v121
    v_pk_max_i16 v42, v42, 0
    v_mfma_f32_16x16x32_bf16 v[20:23], a[100:103], v[60:63], v[20:23]
    v_mul_f32 v120, v46, v117
    v_mul_f32 v121, v47, v117
    v_mfma_f32_16x16x32_bf16 v[12:15], a[100:103], v[56:59], v[12:15]
    ds_read_b128 v[76:79], v1 offset:21504
    v_mul_f32 v120, v120, abs(v46)
    v_mfma_f32_16x16x32_bf16 v[24:27], a[104:107], v[56:59], v[24:27]
    v_mul_f32 v121, v121, abs(v47)
    v_cvt_pk_bf16_f32 v43, v120, v121
    v_mfma_f32_16x16x32_bf16 v[28:31], a[104:107], v[60:63], v[28:31]
    s_waitcnt lgkmcnt(2)
    v_pk_max_i16 v43, v43, 0
    v_mfma_f32_16x16x32_bf16 v[8:11], a[108:111], v[64:67], v[8:11]
    ds_read_b128 v[80:83], v1 offset:22528
    v_mfma_f32_16x16x32_bf16 v[16:19], a[108:111], v[68:71], v[16:19]
    buffer_store_dwordx4 v[40:43], v1, s[16:19], s44 offen offset:1024 sc1
    v_mfma_f32_16x16x32_bf16 v[20:23], a[112:115], v[68:71], v[20:23]
    s_add_u32 m0, s43, 49152
    s_add_u32 s42, s41, 49152
    v_mfma_f32_16x16x32_bf16 v[12:15], a[112:115], v[64:67], v[12:15]
    ds_read_b128 v[84:87], v1 offset:23552
    v_mfma_f32_16x16x32_bf16 v[24:27], a[116:119], v[64:67], v[24:27]
    buffer_load_dwordx4 v1, s[16:19], s42 offen offset:0 sc1 lds
    v_mfma_f32_16x16x32_bf16 v[28:31], a[116:119], v[68:71], v[28:31]
    s_waitcnt lgkmcnt(2)
    v_mfma_f32_16x16x32_bf16 v[8:11], a[120:123], v[72:75], v[8:11]
    ds_read_b128 v[56:59], v1 offset:24576
    v_mfma_f32_16x16x32_bf16 v[16:19], a[120:123], v[76:79], v[16:19]
    buffer_load_dwordx4 v1, s[16:19], s42 offen offset:1024 sc1 lds
    v_mfma_f32_16x16x32_bf16 v[20:23], a[124:127], v[76:79], v[20:23]
    v_mfma_f32_16x16x32_bf16 v[12:15], a[124:127], v[72:75], v[12:15]
    ds_read_b128 v[60:63], v1 offset:25600
    v_mfma_f32_16x16x32_bf16 v[24:27], a[128:131], v[72:75], v[24:27]
    buffer_load_dwordx4 v1, s[16:19], s42 offen offset:2048 sc1 lds
    v_mfma_f32_16x16x32_bf16 v[28:31], a[128:131], v[76:79], v[28:31]
    s_waitcnt lgkmcnt(2)
    v_mfma_f32_16x16x32_bf16 v[8:11], a[132:135], v[80:83], v[8:11]
    ds_read_b128 v[64:67], v1 offset:26624
    v_mfma_f32_16x16x32_bf16 v[16:19], a[132:135], v[84:87], v[16:19]
    buffer_load_dwordx4 v1, s[16:19], s42 offen offset:3072 sc1 lds
    v_mfma_f32_16x16x32_bf16 v[20:23], a[136:139], v[84:87], v[20:23]
    s_add_u32 s98, s98, 65536
    s_min_u32 s98, s98, s96
    s_and_b32 s41, s98, 0xffffffff
    v_mfma_f32_16x16x32_bf16 v[12:15], a[136:139], v[80:83], v[12:15]
    ds_read_b128 v[68:71], v1 offset:27648
    v_mfma_f32_16x16x32_bf16 v[24:27], a[140:143], v[80:83], v[24:27]
    v_mfma_f32_16x16x32_bf16 v[28:31], a[140:143], v[84:87], v[28:31]
    s_waitcnt lgkmcnt(2)
    v_mfma_f32_16x16x32_bf16 v[8:11], a[144:147], v[56:59], v[8:11]
    ds_read_b128 v[72:75], v1 offset:28672
    v_mfma_f32_16x16x32_bf16 v[16:19], a[144:147], v[60:63], v[16:19]
    v_mfma_f32_16x16x32_bf16 v[20:23], a[148:151], v[60:63], v[20:23]
    v_mfma_f32_16x16x32_bf16 v[12:15], a[148:151], v[56:59], v[12:15]
    ds_read_b128 v[76:79], v1 offset:29696
    v_mfma_f32_16x16x32_bf16 v[24:27], a[152:155], v[56:59], v[24:27]
    v_mfma_f32_16x16x32_bf16 v[28:31], a[152:155], v[60:63], v[28:31]
    s_waitcnt lgkmcnt(2)
    v_mfma_f32_16x16x32_bf16 v[8:11], a[156:159], v[64:67], v[8:11]
    ds_read_b128 v[80:83], v1 offset:30720
    v_mfma_f32_16x16x32_bf16 v[16:19], a[156:159], v[68:71], v[16:19]
    buffer_load_dword v7, v5, s[16:19], s45 offen sc1
    v_mfma_f32_16x16x32_bf16 v[20:23], a[160:163], v[68:71], v[20:23]
    s_add_u32 m0, s43, 98304
    s_add_u32 s42, s41, 0
    v_mfma_f32_16x16x32_bf16 v[12:15], a[160:163], v[64:67], v[12:15]
    ds_read_b128 v[84:87], v1 offset:31744
    v_mfma_f32_16x16x32_bf16 v[24:27], a[164:167], v[64:67], v[24:27]
    v_mfma_f32_16x16x32_bf16 v[28:31], a[164:167], v[68:71], v[28:31]
    s_waitcnt vmcnt(8) lgkmcnt(2)
    s_barrier
    v_mfma_f32_16x16x32_bf16 v[8:11], a[168:171], v[72:75], v[8:11]
    ds_read_b128 v[56:59], v1 offset:32768
    v_mfma_f32_16x16x32_bf16 v[16:19], a[168:171], v[76:79], v[16:19]
    ds_read_b64 v[36:37], v118 offset:0
    v_mfma_f32_16x16x32_bf16 v[20:23], a[172:175], v[76:79], v[20:23]
    ds_read_b64 v[38:39], v118 offset:128
    v_mfma_f32_16x16x32_bf16 v[12:15], a[172:175], v[72:75], v[12:15]
    ds_read_b128 v[60:63], v1 offset:33792
    v_mfma_f32_16x16x32_bf16 v[24:27], a[176:179], v[72:75], v[24:27]
    ds_read_b64 v[40:41], v118 offset:256
    v_mfma_f32_16x16x32_bf16 v[28:31], a[176:179], v[76:79], v[28:31]
    s_waitcnt lgkmcnt(5)
    ds_read_b64 v[42:43], v118 offset:384
    v_mfma_f32_16x16x32_bf16 v[8:11], a[180:183], v[80:83], v[8:11]
    ds_read_b128 v[64:67], v1 offset:34816
    v_mfma_f32_16x16x32_bf16 v[16:19], a[180:183], v[84:87], v[16:19]
    v_mfma_f32_16x16x32_bf16 v[20:23], a[184:187], v[84:87], v[20:23]
    v_mfma_f32_16x16x32_bf16 v[12:15], a[184:187], v[80:83], v[12:15]
    ds_read_b128 v[68:71], v1 offset:35840
    v_mfma_f32_16x16x32_bf16 v[24:27], a[188:191], v[80:83], v[24:27]
    s_waitcnt lgkmcnt(2)
    v_max3_u32 v44, v36, v37, v38
    v_max3_u32 v45, v39, v40, v41
    v_mfma_f32_16x16x32_bf16 v[28:31], a[188:191], v[84:87], v[28:31]
    s_waitcnt lgkmcnt(4)
    v_max3_u32 v44, v44, v42, v43
    v_max_u32 v44, v44, v45
    v_mfma_f32_16x16x32_bf16 v[8:11], a[192:195], v[56:59], v[8:11]
    ds_read_b128 v[72:75], v1 offset:36864
    v_cmp_eq_u32 vcc, -1, v44
    v_mfma_f32_16x16x32_bf16 v[16:19], a[192:195], v[60:63], v[16:19]
    v_mfma_f32_16x16x32_bf16 v[20:23], a[196:199], v[60:63], v[20:23]
    s_cbranch_vccnz L_sspin24
L_sback25:
    v_add_f32 v44, v40, v42
    v_add_f32 v45, v41, v43
    v_mfma_f32_16x16x32_bf16 v[12:15], a[196:199], v[56:59], v[12:15]
    ds_read_b128 v[76:79], v1 offset:37888
    v_add_f32 v36, v36, v38
    v_mfma_f32_16x16x32_bf16 v[24:27], a[200:203], v[56:59], v[24:27]
    v_add_f32 v37, v37, v39
    v_add_f32 v36, v36, v44
    v_mfma_f32_16x16x32_bf16 v[28:31], a[200:203], v[60:63], v[28:31]
    s_waitcnt lgkmcnt(2)
    v_add_f32 v37, v37, v45
    v_mov_b32 v44, v36
    v_mfma_f32_16x16x32_bf16 v[8:11], a[204:207], v[64:67], v[8:11]
    ds_read_b128 v[80:83], v1 offset:38912
    v_mov_b32 v45, v37
    v_mfma_f32_16x16x32_bf16 v[16:19], a[204:207], v[68:71], v[16:19]
    v_permlane32_swap_b32 v36, v44
    v_mfma_f32_16x16x32_bf16 v[20:23], a[208:211], v[68:71], v[20:23]
    v_permlane32_swap_b32 v37, v45
    v_mfma_f32_16x16x32_bf16 v[12:15], a[208:211], v[64:67], v[12:15]
    ds_read_b128 v[84:87], v1 offset:39936
    v_add_f32 v36, v36, v44
    v_mfma_f32_16x16x32_bf16 v[24:27], a[212:215], v[64:67], v[24:27]
    v_add_f32 v37, v37, v45
    v_mul_f32 v112, 0xba800000, v36
    v_mfma_f32_16x16x32_bf16 v[28:31], a[212:215], v[68:71], v[28:31]
    s_waitcnt lgkmcnt(2)
    v_mul_f32 v37, 0x3a800000, v37
    v_fma_f32 v37, -v112, v112, v37
    v_mfma_f32_16x16x32_bf16 v[8:11], a[216:219], v[72:75], v[8:11]
    ds_read_b128 v[56:59], v1 offset:40960
    v_mov_b32 v113, v112
    v_mfma_f32_16x16x32_bf16 v[16:19], a[216:219], v[76:79], v[16:19]
    v_max_f32 v37, 0, v37
    v_add_f32 v37, 0x3727c5ac, v37
    v_mfma_f32_16x16x32_bf16 v[20:23], a[220:223], v[76:79], v[20:23]
    v_rsq_f32 v116, v37
    v_mfma_f32_16x16x32_bf16 v[12:15], a[220:223], v[72:75], v[12:15]
    ds_read_b128 v[60:63], v1 offset:41984
    v_mfma_f32_16x16x32_bf16 v[24:27], a[224:227], v[72:75], v[24:27]
    v_permlane16_swap_b32 v112, v113
    v_mfma_f32_16x16x32_bf16 v[28:31], a[224:227], v[76:79], v[28:31]
    s_waitcnt lgkmcnt(2)
    v_mul_f32 v114, v37, v116
    v_mul_f32 v116, v116, v116
    v_mfma_f32_16x16x32_bf16 v[8:11], a[228:231], v[80:83], v[8:11]
    ds_read_b128 v[64:67], v1 offset:43008
    v_mov_b32 v115, v114
    v_mfma_f32_16x16x32_bf16 v[16:19], a[228:231], v[84:87], v[16:19]
    v_mov_b32 v117, v116
    v_fmac_f32 v12, v112, v92
    v_mfma_f32_16x16x32_bf16 v[20:23], a[232:235], v[84:87], v[20:23]
    v_permlane16_swap_b32 v114, v115
    v_mfma_f32_16x16x32_bf16 v[12:15], a[232:235], v[80:83], v[12:15]
    ds_read_b128 v[68:71], v1 offset:44032
    v_fmac_f32 v8, v112, v88
    v_mfma_f32_16x16x32_bf16 v[24:27], a[236:239], v[80:83], v[24:27]
    v_permlane16_swap_b32 v116, v117
    v_mfma_f32_16x16x32_bf16 v[28:31], a[236:239], v[84:87], v[28:31]
    s_waitcnt lgkmcnt(2)
    v_fmac_f32 v16, v113, v88
    v_fmac_f32 v17, v113, v89
    v_mfma_f32_16x16x32_bf16 v[8:11], a[240:243], v[56:59], v[8:11]
    s_waitcnt vmcnt(0)
    ds_read_b128 v[72:75], v1 offset:45056
    v_cmp_ne_u32 vcc, 0, v7
    v_mfma_f32_16x16x32_bf16 v[16:19], a[240:243], v[60:63], v[16:19]
    v_fmac_f32 v13, v112, v93
    v_fmac_f32 v14, v112, v94
    v_mfma_f32_16x16x32_bf16 v[20:23], a[244:247], v[60:63], v[20:23]
    s_cbranch_vccnz L_spin22
L_back23:
    v_fmac_f32 v9, v112, v89
    v_fmac_f32 v10, v112, v90
    v_mfma_f32_16x16x32_bf16 v[12:15], a[244:247], v[56:59], v[12:15]
    s_barrier
    ds_read_b128 v[76:79], v1 offset:46080
    v_fmac_f32 v11, v112, v91
    v_mfma_f32_16x16x32_bf16 v[24:27], a[248:251], v[56:59], v[24:27]
    buffer_load_dwordx4 v1, s[16:19], s42 offen offset:0 sc1 lds
    v_mfma_f32_16x16x32_bf16 v[28:31], a[248:251], v[60:63], v[28:31]
    s_waitcnt lgkmcnt(2)
    v_fmac_f32 v18, v113, v90
    v_fmac_f32 v19, v113, v91
    v_mfma_f32_16x16x32_bf16 v[8:11], a[252:255], v[64:67], v[8:11]
    s_add_u32 s46, s46, 2048
    ds_read_b128 v[80:83], v1 offset:47104
    v_fmac_f32 v15, v112, v95
    v_mfma_f32_16x16x32_bf16 v[16:19], a[252:255], v[68:71], v[16:19]
    buffer_load_dwordx4 v1, s[16:19], s42 offen offset:1024 sc1 lds
    v_mfma_f32_16x16x32_bf16 v[20:23], v[128:131], v[68:71], v[20:23]
    s_min_u32 s46, s46, s55
    v_fmac_f32 v8, v114, v100
    v_fmac_f32 v9, v114, v101
    v_mfma_f32_16x16x32_bf16 v[12:15], v[128:131], v[64:67], v[12:15]
    ds_read_b128 v[84:87], v1 offset:48128
    v_fmac_f32 v10, v114, v102
    v_mfma_f32_16x16x32_bf16 v[24:27], v[132:135], v[64:67], v[24:27]
    buffer_load_dwordx4 v1, s[16:19], s42 offen offset:2048 sc1 lds
    v_mfma_f32_16x16x32_bf16 v[28:31], v[132:135], v[68:71], v[28:31]
    s_waitcnt lgkmcnt(2)
    v_fmac_f32 v16, v115, v100
    v_fmac_f32 v17, v115, v101
    v_mfma_f32_16x16x32_bf16 v[8:11], v[136:139], v[72:75], v[8:11]
    ds_read_b128 v[56:59], v1 offset:49152
    v_fmac_f32 v12, v114, v104
    v_mfma_f32_16x16x32_bf16 v[16:19], v[136:139], v[76:79], v[16:19]
    buffer_load_dwordx4 v1, s[16:19], s42 offen offset:3072 sc1 lds
    v_mfma_f32_16x16x32_bf16 v[20:23], v[140:143], v[76:79], v[20:23]
    v_fmac_f32 v24, v112, v96
    v_fmac_f32 v11, v114, v103
    v_mfma_f32_16x16x32_bf16 v[12:15], v[140:143], v[72:75], v[12:15]
    ds_read_b128 v[60:63], v1 offset:50176
    v_fmac_f32 v18, v115, v102
    v_mfma_f32_16x16x32_bf16 v[24:27], v[144:147], v[72:75], v[24:27]
    buffer_store_dword v124, v124, s[16:19], s91 offen sc1
    v_mfma_f32_16x16x32_bf16 v[28:31], v[144:147], v[76:79], v[28:31]
    s_waitcnt lgkmcnt(2)
    v_fmac_f32 v19, v115, v103
    v_fmac_f32 v13, v114, v105
    v_mfma_f32_16x16x32_bf16 v[8:11], v[148:151], v[80:83], v[8:11]
    s_add_u32 s91, s91, 131072
    ds_read_b128 v[64:67], v1 offset:51200
    v_fmac_f32 v14, v114, v106
    v_mfma_f32_16x16x32_bf16 v[16:19], v[148:151], v[84:87], v[16:19]
    s_add_u32 m0, s43, 114688
    v_fmac_f32 v15, v114, v107
    v_fmac_f32 v25, v112, v97
    v_mfma_f32_16x16x32_bf16 v[20:23], v[152:155], v[84:87], v[20:23]
    s_add_u32 s42, s41, 16384
    v_fmac_f32 v26, v112, v98
    v_fmac_f32 v27, v112, v99
    v_mfma_f32_16x16x32_bf16 v[12:15], v[152:155], v[80:83], v[12:15]
    ds_read_b128 v[68:71], v1 offset:52224
    v_fmac_f32 v28, v113, v96
    v_mfma_f32_16x16x32_bf16 v[24:27], v[156:159], v[80:83], v[24:27]
    buffer_load_dwordx4 v1, s[16:19], s42 offen offset:0 sc1 lds
    v_mfma_f32_16x16x32_bf16 v[28:31], v[156:159], v[84:87], v[28:31]
    s_waitcnt lgkmcnt(2)
    v_fmac_f32 v20, v113, v92
    v_fmac_f32 v21, v113, v93
    v_mfma_f32_16x16x32_bf16 v[8:11], v[160:163], v[56:59], v[8:11]
    ds_read_b128 v[72:75], v1 offset:53248
    v_fmac_f32 v22, v113, v94
    v_mfma_f32_16x16x32_bf16 v[16:19], v[160:163], v[60:63], v[16:19]
    v_fmac_f32 v24, v114, v108
    v_fmac_f32 v25, v114, v109
    v_mfma_f32_16x16x32_bf16 v[20:23], v[164:167], v[60:63], v[20:23]
    buffer_load_dwordx4 v1, s[16:19], s42 offen offset:1024 sc1 lds
    v_mfma_f32_16x16x32_bf16 v[12:15], v[164:167], v[56:59], v[12:15]
    ds_read_b128 v[76:79], v1 offset:54272
    v_fmac_f32 v29, v113, v97
    v_mfma_f32_16x16x32_bf16 v[24:27], v[168:171], v[56:59], v[24:27]
    v_mfma_f32_16x16x32_bf16 v[28:31], v[168:171], v[60:63], v[28:31]
    s_waitcnt lgkmcnt(2)
    v_fmac_f32 v23, v113, v95
    v_fmac_f32 v20, v115, v104
    v_mfma_f32_16x16x32_bf16 v[8:11], v[172:175], v[64:67], v[8:11]
    ds_read_b128 v[80:83], v1 offset:55296
    v_fmac_f32 v21, v115, v105
    v_mfma_f32_16x16x32_bf16 v[16:19], v[172:175], v[68:71], v[16:19]
    buffer_load_dwordx4 v1, s[16:19], s42 offen offset:2048 sc1 lds
    v_mfma_f32_16x16x32_bf16 v[20:23], v[176:179], v[68:71], v[20:23]
    v_fmac_f32 v26, v114, v110
    v_fmac_f32 v27, v114, v111
    v_mfma_f32_16x16x32_bf16 v[12:15], v[176:179], v[64:67], v[12:15]
    ds_read_b128 v[84:87], v1 offset:56320
    v_fmac_f32 v30, v113, v98
    v_mfma_f32_16x16x32_bf16 v[24:27], v[180:183], v[64:67], v[24:27]
    v_fmac_f32 v22, v115, v106
    v_fmac_f32 v23, v115, v107
    v_mfma_f32_16x16x32_bf16 v[28:31], v[180:183], v[68:71], v[28:31]
    s_waitcnt lgkmcnt(2)
    v_mfma_f32_16x16x32_bf16 v[8:11], v[184:187], v[72:75], v[8:11]
    ds_read_b128 v[56:59], v1 offset:57344
    v_mfma_f32_16x16x32_bf16 v[16:19], v[184:187], v[76:79], v[16:19]
    buffer_load_dwordx4 v1, s[16:19], s42 offen offset:3072 sc1 lds
    v_mfma_f32_16x16x32_bf16 v[20:23], v[188:191], v[76:79], v[20:23]
    s_add_u32 m0, s43, 131072
    v_fmac_f32 v31, v113, v99
    v_fmac_f32 v28, v115, v108
    v_mfma_f32_16x16x32_bf16 v[12:15], v[188:191], v[72:75], v[12:15]
    s_add_u32 s42, s41, 32768
    ds_read_b128 v[60:63], v1 offset:58368
    v_fmac_f32 v29, v115, v109
    v_mfma_f32_16x16x32_bf16 v[24:27], v[192:195], v[72:75], v[24:27]
    v_mfma_f32_16x16x32_bf16 v[28:31], v[192:195], v[76:79], v[28:31]
    s_waitcnt lgkmcnt(2)
    v_mfma_f32_16x16x32_bf16 v[8:11], v[196:199], v[80:83], v[8:11]
    ds_read_b128 v[64:67], v1 offset:59392
    v_mfma_f32_16x16x32_bf16 v[16:19], v[196:199], v[84:87], v[16:19]
    buffer_load_dwordx4 v1, s[16:19], s42 offen offset:0 sc1 lds
    v_mfma_f32_16x16x32_bf16 v[20:23], v[200:203], v[84:87], v[20:23]
    v_fmac_f32 v30, v115, v110
    v_fmac_f32 v31, v115, v111
    v_mfma_f32_16x16x32_bf16 v[12:15], v[200:203], v[80:83], v[12:15]
    ds_read_b128 v[68:71], v1 offset:60416
    v_mfma_f32_16x16x32_bf16 v[24:27], v[204:207], v[80:83], v[24:27]
    v_mfma_f32_16x16x32_bf16 v[28:31], v[204:207], v[84:87], v[28:31]
    s_waitcnt lgkmcnt(2)
    v_mfma_f32_16x16x32_bf16 v[8:11], v[208:211], v[56:59], v[8:11]
    ds_read_b128 v[72:75], v1 offset:61440
    v_mfma_f32_16x16x32_bf16 v[16:19], v[208:211], v[60:63], v[16:19]
    buffer_load_dwordx4 v1, s[16:19], s42 offen offset:1024 sc1 lds
    v_mfma_f32_16x16x32_bf16 v[20:23], v[212:215], v[60:63], v[20:23]
    v_mfma_f32_16x16x32_bf16 v[12:15], v[212:215], v[56:59], v[12:15]
    ds_read_b128 v[76:79], v1 offset:62464
    v_mfma_f32_16x16x32_bf16 v[24:27], v[216:219], v[56:59], v[24:27]
    v_mfma_f32_16x16x32_bf16 v[28:31], v[216:219], v[60:63], v[28:31]
    s_waitcnt lgkmcnt(2)
    v_mfma_f32_16x16x32_bf16 v[8:11], v[220:223], v[64:67], v[8:11]
    ds_read_b128 v[80:83], v1 offset:63488
    v_mfma_f32_16x16x32_bf16 v[16:19], v[220:223], v[68:71], v[16:19]
    buffer_load_dwordx4 v1, s[16:19], s42 offen offset:2048 sc1 lds
    v_mfma_f32_16x16x32_bf16 v[20:23], v[224:227], v[68:71], v[20:23]
    v_mfma_f32_16x16x32_bf16 v[12:15], v[224:227], v[64:67], v[12:15]
    ds_read_b128 v[84:87], v1 offset:64512
    v_mfma_f32_16x16x32_bf16 v[24:27], v[228:231], v[64:67], v[24:27]
    v_mfma_f32_16x16x32_bf16 v[28:31], v[228:231], v[68:71], v[28:31]
    s_waitcnt vmcnt(8) lgkmcnt(2)
    s_barrier
    v_mfma_f32_16x16x32_bf16 v[8:11], v[232:235], v[72:75], v[8:11]
    ds_read_b128 v[56:59], v2 offset:0
    v_mfma_f32_16x16x32_bf16 v[16:19], v[232:235], v[76:79], v[16:19]
    buffer_load_dwordx4 v1, s[16:19], s42 offen offset:3072 sc1 lds
    v_mfma_f32_16x16x32_bf16 v[20:23], v[236:239], v[76:79], v[20:23]
    s_add_u32 s45, s45, 131072
    v_mfma_f32_16x16x32_bf16 v[12:15], v[236:239], v[72:75], v[12:15]
    ds_read_b128 v[60:63], v2 offset:1024
    v_mfma_f32_16x16x32_bf16 v[24:27], v[240:243], v[72:75], v[24:27]
    v_mfma_f32_16x16x32_bf16 v[28:31], v[240:243], v[76:79], v[28:31]
    s_waitcnt lgkmcnt(2)
    v_mfma_f32_16x16x32_bf16 v[8:11], v[244:247], v[80:83], v[8:11]
    ds_read_b128 v[64:67], v2 offset:2048
    v_mfma_f32_16x16x32_bf16 v[16:19], v[244:247], v[84:87], v[16:19]
    v_mfma_f32_16x16x32_bf16 v[20:23], v[248:251], v[84:87], v[20:23]
    v_mfma_f32_16x16x32_bf16 v[12:15], v[248:251], v[80:83], v[12:15]
    ds_read_b128 v[68:71], v2 offset:3072
    v_mfma_f32_16x16x32_bf16 v[24:27], v[252:255], v[80:83], v[24:27]
    v_mfma_f32_16x16x32_bf16 v[28:31], v[252:255], v[84:87], v[28:31]
    s_add_u32 s36, s36, 1
L_a_b1:
    s_waitcnt lgkmcnt(2)
    v_mfma_f32_16x16x32_bf16 v[32:35], a[0:3], v[56:59], 0
    s_and_b32 s44, s90, 0xffffffff
    ds_read_b128 v[72:75], v2 offset:4096
    v_mul_f32 v120, v24, v116
    v_mfma_f32_16x16x32_bf16 v[40:43], a[0:3], v[60:63], 0
    s_cmp_eq_u32 s36, 0
    v_mul_f32 v121, v25, v116
    v_mul_f32 v120, v120, abs(v24)
    v_mfma_f32_16x16x32_bf16 v[44:47], a[4:7], v[60:63], 0
    s_cselect_b32 s44, 0x5e00000, s44
    v_mul_f32 v121, v121, abs(v25)
    v_cvt_pk_bf16_f32 v24, v120, v121
    v_mfma_f32_16x16x32_bf16 v[36:39], a[4:7], v[56:59], 0
    s_add_u32 s49, s44, s87
    ds_read_b128 v[76:79], v2 offset:5120
    v_pk_max_i16 v24, v24, 0
    v_mfma_f32_16x16x32_bf16 v[48:51], a[8:11], v[56:59], 0
    s_max_u32 s44, s44, s88
    v_mul_f32 v120, v26, v116
    v_mul_f32 v121, v27, v116
    v_mfma_f32_16x16x32_bf16 v[52:55], a[8:11], v[60:63], 0
    s_waitcnt lgkmcnt(2)
    v_mul_f32 v120, v120, abs(v26)
    v_mul_f32 v121, v121, abs(v27)
    v_mfma_f32_16x16x32_bf16 v[32:35], a[12:15], v[64:67], v[32:35]
    s_add_u32 s90, s90, 262144
    ds_read_b128 v[80:83], v2 offset:6144
    v_cvt_pk_bf16_f32 v25, v120, v121
    v_mfma_f32_16x16x32_bf16 v[40:43], a[12:15], v[68:71], v[40:43]
    s_add_u32 m0, s52, 73728
    v_pk_max_i16 v25, v25, 0
    s_add_u32 s42, s46, s52
    v_mfma_f32_16x16x32_bf16 v[44:47], a[16:19], v[68:71], v[44:47]
    buffer_load_dwordx4 v1, s[16:19], s42 offen sc1 lds
    v_mfma_f32_16x16x32_bf16 v[36:39], a[16:19], v[64:67], v[36:39]
    ds_read_b128 v[84:87], v2 offset:7168
    v_mfma_f32_16x16x32_bf16 v[48:51], a[20:23], v[64:67], v[48:51]
    ds_write_b64 v3, v[24:25] offset:0
    v_mfma_f32_16x16x32_bf16 v[52:55], a[20:23], v[68:71], v[52:55]
    s_waitcnt lgkmcnt(3)
    v_mul_f32 v120, v28, v117
    v_mul_f32 v121, v29, v117
    v_mfma_f32_16x16x32_bf16 v[32:35], a[24:27], v[72:75], v[32:35]
    ds_read_b128 v[56:59], v2 offset:8192
    v_mul_f32 v120, v120, abs(v28)
    v_mfma_f32_16x16x32_bf16 v[40:43], a[24:27], v[76:79], v[40:43]
    v_mul_f32 v121, v121, abs(v29)
    v_cvt_pk_bf16_f32 v28, v120, v121
    v_mfma_f32_16x16x32_bf16 v[44:47], a[28:31], v[76:79], v[44:47]
    v_pk_max_i16 v28, v28, 0
    v_mul_f32 v120, v30, v117
    v_mfma_f32_16x16x32_bf16 v[36:39], a[28:31], v[72:75], v[36:39]
    ds_read_b128 v[60:63], v2 offset:9216
    v_mul_f32 v121, v31, v117
    v_mfma_f32_16x16x32_bf16 v[48:51], a[32:35], v[72:75], v[48:51]
    v_mul_f32 v120, v120, abs(v30)
    v_mul_f32 v121, v121, abs(v31)
    v_mfma_f32_16x16x32_bf16 v[52:55], a[32:35], v[76:79], v[52:55]
    s_waitcnt lgkmcnt(3)
    v_cvt_pk_bf16_f32 v29, v120, v121
    v_pk_max_i16 v29, v29, 0
    v_mfma_f32_16x16x32_bf16 v[32:35], a[36:39], v[80:83], v[32:35]
    ds_read_b128 v[64:67], v2 offset:10240
    v_mfma_f32_16x16x32_bf16 v[40:43], a[36:39], v[84:87], v[40:43]
    ds_write_b64 v3, v[28:29] offset:1024
    v_mfma_f32_16x16x32_bf16 v[44:47], a[40:43], v[84:87], v[44:47]
    v_mul_f32 v120, v8, v116
    v_mul_f32 v121, v9, v116
    v_mfma_f32_16x16x32_bf16 v[36:39], a[40:43], v[80:83], v[36:39]
    ds_read_b128 v[68:71], v2 offset:11264
    v_mul_f32 v120, v120, abs(v8)
    v_mfma_f32_16x16x32_bf16 v[48:51], a[44:47], v[80:83], v[48:51]
    v_mul_f32 v121, v121, abs(v9)
    v_cvt_pk_bf16_f32 v8, v120, v121
    v_mfma_f32_16x16x32_bf16 v[52:55], a[44:47], v[84:87], v[52:55]
    s_waitcnt lgkmcnt(3)
    v_pk_max_i16 v8, v8, 0
    v_mul_f32 v120, v10, v116
    v_mfma_f32_16x16x32_bf16 v[32:35], a[48:51], v[56:59], v[32:35]
    ds_read_b128 v[72:75], v2 offset:12288
    v_mul_f32 v121, v11, v116
    v_mfma_f32_16x16x32_bf16 v[40:43], a[48:51], v[60:63], v[40:43]
    v_mul_f32 v120, v120, abs(v10)
    v_mul_f32 v121, v121, abs(v11)
    v_mfma_f32_16x16x32_bf16 v[44:47], a[52:55], v[60:63], v[44:47]
    v_cvt_pk_bf16_f32 v9, v120, v121
    v_pk_max_i16 v9, v9, 0
    v_mfma_f32_16x16x32_bf16 v[36:39], a[52:55], v[56:59], v[36:39]
    ds_read_b128 v[76:79], v2 offset:13312
    v_mul_f32 v120, v12, v116
    v_mfma_f32_16x16x32_bf16 v[48:51], a[56:59], v[56:59], v[48:51]
    v_mul_f32 v121, v13, v116
    v_mul_f32 v120, v120, abs(v12)
    v_mfma_f32_16x16x32_bf16 v[52:55], a[56:59], v[60:63], v[52:55]
    s_waitcnt vmcnt(5) lgkmcnt(2)
    s_barrier
    v_mul_f32 v121, v121, abs(v13)
    v_mfma_f32_16x16x32_bf16 v[32:35], a[60:63], v[64:67], v[32:35]
    ds_read_b128 v[80:83], v2 offset:14336
    v_cvt_pk_bf16_f32 v10, v120, v121
    v_mfma_f32_16x16x32_bf16 v[40:43], a[60:63], v[68:71], v[40:43]
    ds_read_b128 v[24:27], v4 offset:0
    v_pk_max_i16 v10, v10, 0
    v_mfma_f32_16x16x32_bf16 v[44:47], a[64:67], v[68:71], v[44:47]
    v_mul_f32 v120, v14, v116
    v_mul_f32 v121, v15, v116
    v_mfma_f32_16x16x32_bf16 v[36:39], a[64:67], v[64:67], v[36:39]
    ds_read_b128 v[84:87], v2 offset:15360
    v_mul_f32 v120, v120, abs(v14)
    v_mfma_f32_16x16x32_bf16 v[48:51], a[68:71], v[64:67], v[48:51]
    v_mul_f32 v121, v121, abs(v15)
    v_cvt_pk_bf16_f32 v11, v120, v121
    v_mfma_f32_16x16x32_bf16 v[52:55], a[68:71], v[68:71], v[52:55]
    s_waitcnt lgkmcnt(3)
    v_pk_max_i16 v11, v11, 0
    s_waitcnt lgkmcnt(1)
    v_mfma_f32_16x16x32_bf16 v[32:35], a[72:75], v[72:75], v[32:35]
    ds_read_b128 v[56:59], v2 offset:16384
    v_mfma_f32_16x16x32_bf16 v[40:43], a[72:75], v[76:79], v[40:43]
    buffer_store_dwordx4 v[24:27], v1, s[16:19], s49 offen sc1
    v_mfma_f32_16x16x32_bf16 v[44:47], a[76:79], v[76:79], v[44:47]
    buffer_store_dwordx4 v[8:11], v1, s[16:19], s44 offen offset:0 sc1
    v_mfma_f32_16x16x32_bf16 v[36:39], a[76:79], v[72:75], v[36:39]
    ds_read_b128 v[60:63], v2 offset:17408
    v_mul_f32 v120, v16, v117
    v_mfma_f32_16x16x32_bf16 v[48:51], a[80:83], v[72:75], v[48:51]
    v_mul_f32 v121, v17, v117
    v_mul_f32 v120, v120, abs(v16)
    v_mfma_f32_16x16x32_bf16 v[52:55], a[80:83], v[76:79], v[52:55]
    s_waitcnt lgkmcnt(2)
    v_mul_f32 v121, v121, abs(v17)
    v_cvt_pk_bf16_f32 v16, v120, v121
    v_mfma_f32_16x16x32_bf16 v[32:35], a[84:87], v[80:83], v[32:35]
    ds_read_b128 v[64:67], v2 offset:18432
    v_pk_max_i16 v16, v16, 0
    v_mfma_f32_16x16x32_bf16 v[40:43], a[84:87], v[84:87], v[40:43]
    v_mul_f32 v120, v18, v117
    v_mul_f32 v121, v19, v117
    v_mfma_f32_16x16x32_bf16 v[44:47], a[88:91], v[84:87], v[44:47]
    v_mul_f32 v120, v120, abs(v18)
    v_mul_f32 v121, v121, abs(v19)
    v_mfma_f32_16x16x32_bf16 v[36:39], a[88:91], v[80:83], v[36:39]
    ds_read_b128 v[68:71], v2 offset:19456
    v_cvt_pk_bf16_f32 v17, v120, v121
    v_mfma_f32_16x16x32_bf16 v[48:51], a[92:95], v[80:83], v[48:51]
    v_pk_max_i16 v17, v17, 0
    v_mul_f32 v120, v20, v117
    v_mfma_f32_16x16x32_bf16 v[52:55], a[92:95], v[84:87], v[52:55]
    s_waitcnt lgkmcnt(2)
    v_mul_f32 v121, v21, v117
    v_mul_f32 v120, v120, abs(v20)
    v_mfma_f32_16x16x32_bf16 v[32:35], a[96:99], v[56:59], v[32:35]
    ds_read_b128 v[72:75], v2 offset:20480
    v_mul_f32 v121, v121, abs(v21)
    v_mfma_f32_16x16x32_bf16 v[40:43], a[96:99], v[60:63], v[40:43]
    v_cvt_pk_bf16_f32 v18, v120, v121
    v_pk_max_i16 v18, v18, 0
    v_mfma_f32_16x16x32_bf16 v[44:47], a[100:103], v[60:63], v[44:47]
    v_mul_f32 v120, v22, v117
    v_mul_f32 v121, v23, v117
    v_mfma_f32_16x16x32_bf16 v[36:39], a[100:103], v[56:59], v[36:39]
    ds_read_b128 v[76:79], v2 offset:21504
    v_mul_f32 v120, v120, abs(v22)
    v_mfma_f32_16x16x32_bf16 v[48:51], a[104:107], v[56:59], v[48:51]
    v_mul_f32 v121, v121, abs(v23)
    v_cvt_pk_bf16_f32 v19, v120, v121
    v_mfma_f32_16x16x32_bf16 v[52:55], a[104:107], v[60:63], v[52:55]
    s_waitcnt lgkmcnt(2)
    v_pk_max_i16 v19, v19, 0
    v_mfma_f32_16x16x32_bf16 v[32:35], a[108:111], v[64:67], v[32:35]
    ds_read_b128 v[80:83], v2 offset:22528
    v_mfma_f32_16x16x32_bf16 v[40:43], a[108:111], v[68:71], v[40:43]
    buffer_store_dwordx4 v[16:19], v1, s[16:19], s44 offen offset:1024 sc1
    v_mfma_f32_16x16x32_bf16 v[44:47], a[112:115], v[68:71], v[44:47]
    s_add_u32 m0, s43, 147456
    s_add_u32 s42, s41, 49152
    v_mfma_f32_16x16x32_bf16 v[36:39], a[112:115], v[64:67], v[36:39]
    ds_read_b128 v[84:87], v2 offset:23552
    v_mfma_f32_16x16x32_bf16 v[48:51], a[116:119], v[64:67], v[48:51]
    buffer_load_dwordx4 v1, s[16:19], s42 offen offset:0 sc1 lds
    v_mfma_f32_16x16x32_bf16 v[52:55], a[116:119], v[68:71], v[52:55]
    s_waitcnt lgkmcnt(2)
    v_mfma_f32_16x16x32_bf16 v[32:35], a[120:123], v[72:75], v[32:35]
    ds_read_b128 v[56:59], v2 offset:24576
    v_mfma_f32_16x16x32_bf16 v[40:43], a[120:123], v[76:79], v[40:43]
    buffer_load_dwordx4 v1, s[16:19], s42 offen offset:1024 sc1 lds
    v_mfma_f32_16x16x32_bf16 v[44:47], a[124:127], v[76:79], v[44:47]
    v_mfma_f32_16x16x32_bf16 v[36:39], a[124:127], v[72:75], v[36:39]
    ds_read_b128 v[60:63], v2 offset:25600
    v_mfma_f32_16x16x32_bf16 v[48:51], a[128:131], v[72:75], v[48:51]
    buffer_load_dwordx4 v1, s[16:19], s42 offen offset:2048 sc1 lds
    v_mfma_f32_16x16x32_bf16 v[52:55], a[128:131], v[76:79], v[52:55]
    s_waitcnt lgkmcnt(2)
    v_mfma_f32_16x16x32_bf16 v[32:35], a[132:135], v[80:83], v[32:35]
    ds_read_b128 v[64:67], v2 offset:26624
    v_mfma_f32_16x16x32_bf16 v[40:43], a[132:135], v[84:87], v[40:43]
    buffer_load_dwordx4 v1, s[16:19], s42 offen offset:3072 sc1 lds
    v_mfma_f32_16x16x32_bf16 v[44:47], a[136:139], v[84:87], v[44:47]
    s_add_u32 s98, s98, 65536
    s_min_u32 s98, s98, s96
    s_and_b32 s41, s98, 0xffffffff
    v_mfma_f32_16x16x32_bf16 v[36:39], a[136:139], v[80:83], v[36:39]
    ds_read_b128 v[68:71], v2 offset:27648
    v_mfma_f32_16x16x32_bf16 v[48:51], a[140:143], v[80:83], v[48:51]
    v_mfma_f32_16x16x32_bf16 v[52:55], a[140:143], v[84:87], v[52:55]
    s_waitcnt lgkmcnt(2)
    v_mfma_f32_16x16x32_bf16 v[32:35], a[144:147], v[56:59], v[32:35]
    ds_read_b128 v[72:75], v2 offset:28672
    v_mfma_f32_16x16x32_bf16 v[40:43], a[144:147], v[60:63], v[40:43]
    v_mfma_f32_16x16x32_bf16 v[44:47], a[148:151], v[60:63], v[44:47]
    v_mfma_f32_16x16x32_bf16 v[36:39], a[148:151], v[56:59], v[36:39]
    ds_read_b128 v[76:79], v2 offset:29696
    v_mfma_f32_16x16x32_bf16 v[48:51], a[152:155], v[56:59], v[48:51]
    v_mfma_f32_16x16x32_bf16 v[52:55], a[152:155], v[60:63], v[52:55]
    s_waitcnt lgkmcnt(2)
    v_mfma_f32_16x16x32_bf16 v[32:35], a[156:159], v[64:67], v[32:35]
    ds_read_b128 v[80:83], v2 offset:30720
    v_mfma_f32_16x16x32_bf16 v[40:43], a[156:159], v[68:71], v[40:43]
    buffer_load_dword v7, v5, s[16:19], s45 offen sc1
    v_mfma_f32_16x16x32_bf16 v[44:47], a[160:163], v[68:71], v[44:47]
    s_add_u32 m0, s43, 0
    s_add_u32 s42, s41, 0
    v_mfma_f32_16x16x32_bf16 v[36:39], a[160:163], v[64:67], v[36:39]
    ds_read_b128 v[84:87], v2 offset:31744
    v_mfma_f32_16x16x32_bf16 v[48:51], a[164:167], v[64:67], v[48:51]
    v_mfma_f32_16x16x32_bf16 v[52:55], a[164:167], v[68:71], v[52:55]
    s_waitcnt vmcnt(8) lgkmcnt(2)
    s_barrier
    v_mfma_f32_16x16x32_bf16 v[32:35], a[168:171], v[72:75], v[32:35]
    ds_read_b128 v[56:59], v2 offset:32768
    v_mfma_f32_16x16x32_bf16 v[40:43], a[168:171], v[76:79], v[40:43]
    ds_read_b64 v[12:13], v118 offset:0
    v_mfma_f32_16x16x32_bf16 v[44:47], a[172:175], v[76:79], v[44:47]
    ds_read_b64 v[14:15], v118 offset:128
    v_mfma_f32_16x16x32_bf16 v[36:39], a[172:175], v[72:75], v[36:39]
    ds_read_b128 v[60:63], v2 offset:33792
    v_mfma_f32_16x16x32_bf16 v[48:51], a[176:179], v[72:75], v[48:51]
    ds_read_b64 v[16:17], v118 offset:256
    v_mfma_f32_16x16x32_bf16 v[52:55], a[176:179], v[76:79], v[52:55]
    s_waitcnt lgkmcnt(5)
    ds_read_b64 v[18:19], v118 offset:384
    v_mfma_f32_16x16x32_bf16 v[32:35], a[180:183], v[80:83], v[32:35]
    ds_read_b128 v[64:67], v2 offset:34816
    v_mfma_f32_16x16x32_bf16 v[40:43], a[180:183], v[84:87], v[40:43]
    v_mfma_f32_16x16x32_bf16 v[44:47], a[184:187], v[84:87], v[44:47]
    v_mfma_f32_16x16x32_bf16 v[36:39], a[184:187], v[80:83], v[36:39]
    ds_read_b128 v[68:71], v2 offset:35840
    v_mfma_f32_16x16x32_bf16 v[48:51], a[188:191], v[80:83], v[48:51]
    s_waitcnt lgkmcnt(2)
    v_max3_u32 v20, v12, v13, v14
    v_max3_u32 v21, v15, v16, v17
    v_mfma_f32_16x16x32_bf16 v[52:55], a[188:191], v[84:87], v[52:55]
    s_waitcnt lgkmcnt(4)
    v_max3_u32 v20, v20, v18, v19
    v_max_u32 v20, v20, v21
    v_mfma_f32_16x16x32_bf16 v[32:35], a[192:195], v[56:59], v[32:35]
    ds_read_b128 v[72:75], v2 offset:36864
    v_cmp_eq_u32 vcc, -1, v20
    v_mfma_f32_16x16x32_bf16 v[40:43], a[192:195], v[60:63], v[40:43]
    v_mfma_f32_16x16x32_bf16 v[44:47], a[196:199], v[60:63], v[44:47]
    s_cbranch_vccnz L_sspin28
L_sback29:
    v_add_f32 v20, v16, v18
    v_add_f32 v21, v17, v19
    v_mfma_f32_16x16x32_bf16 v[36:39], a[196:199], v[56:59], v[36:39]
    ds_read_b128 v[76:79], v2 offset:37888
    v_add_f32 v12, v12, v14
    v_mfma_f32_16x16x32_bf16 v[48:51], a[200:203], v[56:59], v[48:51]
    v_add_f32 v13, v13, v15
    v_add_f32 v12, v12, v20
    v_mfma_f32_16x16x32_bf16 v[52:55], a[200:203], v[60:63], v[52:55]
    s_waitcnt lgkmcnt(2)
    v_add_f32 v13, v13, v21
    v_mov_b32 v20, v12
    v_mfma_f32_16x16x32_bf16 v[32:35], a[204:207], v[64:67], v[32:35]
    ds_read_b128 v[80:83], v2 offset:38912
    v_mov_b32 v21, v13
    v_mfma_f32_16x16x32_bf16 v[40:43], a[204:207], v[68:71], v[40:43]
    v_permlane32_swap_b32 v12, v20
    v_mfma_f32_16x16x32_bf16 v[44:47], a[208:211], v[68:71], v[44:47]
    v_permlane32_swap_b32 v13, v21
    v_mfma_f32_16x16x32_bf16 v[36:39], a[208:211], v[64:67], v[36:39]
    ds_read_b128 v[84:87], v2 offset:39936
    v_add_f32 v12, v12, v20
    v_mfma_f32_16x16x32_bf16 v[48:51], a[212:215], v[64:67], v[48:51]
    v_add_f32 v13, v13, v21
    v_mul_f32 v112, 0xba800000, v12
    v_mfma_f32_16x16x32_bf16 v[52:55], a[212:215], v[68:71], v[52:55]
    s_waitcnt lgkmcnt(2)
    v_mul_f32 v13, 0x3a800000, v13
    v_fma_f32 v13, -v112, v112, v13
    v_mfma_f32_16x16x32_bf16 v[32:35], a[216:219], v[72:75], v[32:35]
    ds_read_b128 v[56:59], v2 offset:40960
    v_mov_b32 v113, v112
    v_mfma_f32_16x16x32_bf16 v[40:43], a[216:219], v[76:79], v[40:43]
    v_max_f32 v13, 0, v13
    v_add_f32 v13, 0x3727c5ac, v13
    v_mfma_f32_16x16x32_bf16 v[44:47], a[220:223], v[76:79], v[44:47]
    v_rsq_f32 v116, v13
    v_mfma_f32_16x16x32_bf16 v[36:39], a[220:223], v[72:75], v[36:39]
    ds_read_b128 v[60:63], v2 offset:41984
    v_mfma_f32_16x16x32_bf16 v[48:51], a[224:227], v[72:75], v[48:51]
    v_permlane16_swap_b32 v112, v113
    v_mfma_f32_16x16x32_bf16 v[52:55], a[224:227], v[76:79], v[52:55]
    s_waitcnt lgkmcnt(2)
    v_mul_f32 v114, v13, v116
    v_mul_f32 v116, v116, v116
    v_mfma_f32_16x16x32_bf16 v[32:35], a[228:231], v[80:83], v[32:35]
    ds_read_b128 v[64:67], v2 offset:43008
    v_mov_b32 v115, v114
    v_mfma_f32_16x16x32_bf16 v[40:43], a[228:231], v[84:87], v[40:43]
    v_mov_b32 v117, v116
    v_fmac_f32 v36, v112, v92
    v_mfma_f32_16x16x32_bf16 v[44:47], a[232:235], v[84:87], v[44:47]
    v_permlane16_swap_b32 v114, v115
    v_mfma_f32_16x16x32_bf16 v[36:39], a[232:235], v[80:83], v[36:39]
    ds_read_b128 v[68:71], v2 offset:44032
    v_fmac_f32 v32, v112, v88
    v_mfma_f32_16x16x32_bf16 v[48:51], a[236:239], v[80:83], v[48:51]
    v_permlane16_swap_b32 v116, v117
    v_mfma_f32_16x16x32_bf16 v[52:55], a[236:239], v[84:87], v[52:55]
    s_waitcnt lgkmcnt(2)
    v_fmac_f32 v40, v113, v88
    v_fmac_f32 v41, v113, v89
    v_mfma_f32_16x16x32_bf16 v[32:35], a[240:243], v[56:59], v[32:35]
    s_waitcnt vmcnt(0)
    ds_read_b128 v[72:75], v2 offset:45056
    v_cmp_ne_u32 vcc, 0, v7
    v_mfma_f32_16x16x32_bf16 v[40:43], a[240:243], v[60:63], v[40:43]
    v_fmac_f32 v37, v112, v93
    v_fmac_f32 v38, v112, v94
    v_mfma_f32_16x16x32_bf16 v[44:47], a[244:247], v[60:63], v[44:47]
    s_cbranch_vccnz L_spin26
L_back27:
    v_fmac_f32 v33, v112, v89
    v_fmac_f32 v34, v112, v90
    v_mfma_f32_16x16x32_bf16 v[36:39], a[244:247], v[56:59], v[36:39]
    s_barrier
    ds_read_b128 v[76:79], v2 offset:46080
    v_fmac_f32 v35, v112, v91
    v_mfma_f32_16x16x32_bf16 v[48:51], a[248:251], v[56:59], v[48:51]
    buffer_load_dwordx4 v1, s[16:19], s42 offen offset:0 sc1 lds
    v_mfma_f32_16x16x32_bf16 v[52:55], a[248:251], v[60:63], v[52:55]
    s_waitcnt lgkmcnt(2)
    v_fmac_f32 v42, v113, v90
    v_fmac_f32 v43, v113, v91
    v_mfma_f32_16x16x32_bf16 v[32:35], a[252:255], v[64:67], v[32:35]
    s_add_u32 s46, s46, 2048
    ds_read_b128 v[80:83], v2 offset:47104
    v_fmac_f32 v39, v112, v95
    v_mfma_f32_16x16x32_bf16 v[40:43], a[252:255], v[68:71], v[40:43]
    buffer_load_dwordx4 v1, s[16:19], s42 offen offset:1024 sc1 lds
    v_mfma_f32_16x16x32_bf16 v[44:47], v[128:131], v[68:71], v[44:47]
    s_min_u32 s46, s46, s55
    v_fmac_f32 v32, v114, v100
    v_fmac_f32 v33, v114, v101
    v_mfma_f32_16x16x32_bf16 v[36:39], v[128:131], v[64:67], v[36:39]
    ds_read_b128 v[84:87], v2 offset:48128
    v_fmac_f32 v34, v114, v102
    v_mfma_f32_16x16x32_bf16 v[48:51], v[132:135], v[64:67], v[48:51]
    buffer_load_dwordx4 v1, s[16:19], s42 offen offset:2048 sc1 lds
    v_mfma_f32_16x16x32_bf16 v[52:55], v[132:135], v[68:71], v[52:55]
    s_waitcnt lgkmcnt(2)
    v_fmac_f32 v40, v115, v100
    v_fmac_f32 v41, v115, v101
    v_mfma_f32_16x16x32_bf16 v[32:35], v[136:139], v[72:75], v[32:35]
    ds_read_b128 v[56:59], v2 offset:49152
    v_fmac_f32 v36, v114, v104
    v_mfma_f32_16x16x32_bf16 v[40:43], v[136:139], v[76:79], v[40:43]
    buffer_load_dwordx4 v1, s[16:19], s42 offen offset:3072 sc1 lds
    v_mfma_f32_16x16x32_bf16 v[44:47], v[140:143], v[76:79], v[44:47]
    v_fmac_f32 v48, v112, v96
    v_fmac_f32 v35, v114, v103
    v_mfma_f32_16x16x32_bf16 v[36:39], v[140:143], v[72:75], v[36:39]
    ds_read_b128 v[60:63], v2 offset:50176
    v_fmac_f32 v42, v115, v102
    v_mfma_f32_16x16x32_bf16 v[48:51], v[144:147], v[72:75], v[48:51]
    buffer_store_dword v124, v124, s[16:19], s91 offen sc1
    v_mfma_f32_16x16x32_bf16 v[52:55], v[144:147], v[76:79], v[52:55]
    s_waitcnt lgkmcnt(2)
    v_fmac_f32 v43, v115, v103
    v_fmac_f32 v37, v114, v105
    v_mfma_f32_16x16x32_bf16 v[32:35], v[148:151], v[80:83], v[32:35]
    s_add_u32 s91, s91, 131072
    ds_read_b128 v[64:67], v2 offset:51200
    v_fmac_f32 v38, v114, v106
    v_mfma_f32_16x16x32_bf16 v[40:43], v[148:151], v[84:87], v[40:43]
    s_add_u32 m0, s43, 16384
    v_fmac_f32 v39, v114, v107
    v_fmac_f32 v49, v112, v97
    v_mfma_f32_16x16x32_bf16 v[44:47], v[152:155], v[84:87], v[44:47]
    s_add_u32 s42, s41, 16384
    v_fmac_f32 v50, v112, v98
    v_fmac_f32 v51, v112, v99
    v_mfma_f32_16x16x32_bf16 v[36:39], v[152:155], v[80:83], v[36:39]
    ds_read_b128 v[68:71], v2 offset:52224
    v_fmac_f32 v52, v113, v96
    v_mfma_f32_16x16x32_bf16 v[48:51], v[156:159], v[80:83], v[48:51]
    buffer_load_dwordx4 v1, s[16:19], s42 offen offset:0 sc1 lds
    v_mfma_f32_16x16x32_bf16 v[52:55], v[156:159], v[84:87], v[52:55]
    s_waitcnt lgkmcnt(2)
    v_fmac_f32 v44, v113, v92
    v_fmac_f32 v45, v113, v93
    v_mfma_f32_16x16x32_bf16 v[32:35], v[160:163], v[56:59], v[32:35]
    ds_read_b128 v[72:75], v2 offset:53248
    v_fmac_f32 v46, v113, v94
    v_mfma_f32_16x16x32_bf16 v[40:43], v[160:163], v[60:63], v[40:43]
    v_fmac_f32 v48, v114, v108
    v_fmac_f32 v49, v114, v109
    v_mfma_f32_16x16x32_bf16 v[44:47], v[164:167], v[60:63], v[44:47]
    buffer_load_dwordx4 v1, s[16:19], s42 offen offset:1024 sc1 lds
    v_mfma_f32_16x16x32_bf16 v[36:39], v[164:167], v[56:59], v[36:39]
    ds_read_b128 v[76:79], v2 offset:54272
    v_fmac_f32 v53, v113, v97
    v_mfma_f32_16x16x32_bf16 v[48:51], v[168:171], v[56:59], v[48:51]
    v_mfma_f32_16x16x32_bf16 v[52:55], v[168:171], v[60:63], v[52:55]
    s_waitcnt lgkmcnt(2)
    v_fmac_f32 v47, v113, v95
    v_fmac_f32 v44, v115, v104
    v_mfma_f32_16x16x32_bf16 v[32:35], v[172:175], v[64:67], v[32:35]
    ds_read_b128 v[80:83], v2 offset:55296
    v_fmac_f32 v45, v115, v105
    v_mfma_f32_16x16x32_bf16 v[40:43], v[172:175], v[68:71], v[40:43]
    buffer_load_dwordx4 v1, s[16:19], s42 offen offset:2048 sc1 lds
    v_mfma_f32_16x16x32_bf16 v[44:47], v[176:179], v[68:71], v[44:47]
    v_fmac_f32 v50, v114, v110
    v_fmac_f32 v51, v114, v111
    v_mfma_f32_16x16x32_bf16 v[36:39], v[176:179], v[64:67], v[36:39]
    ds_read_b128 v[84:87], v2 offset:56320
    v_fmac_f32 v54, v113, v98
    v_mfma_f32_16x16x32_bf16 v[48:51], v[180:183], v[64:67], v[48:51]
    v_fmac_f32 v46, v115, v106
    v_fmac_f32 v47, v115, v107
    v_mfma_f32_16x16x32_bf16 v[52:55], v[180:183], v[68:71], v[52:55]
    s_waitcnt lgkmcnt(2)
    v_mfma_f32_16x16x32_bf16 v[32:35], v[184:187], v[72:75], v[32:35]
    ds_read_b128 v[56:59], v2 offset:57344
    v_mfma_f32_16x16x32_bf16 v[40:43], v[184:187], v[76:79], v[40:43]
    buffer_load_dwordx4 v1, s[16:19], s42 offen offset:3072 sc1 lds
    v_mfma_f32_16x16x32_bf16 v[44:47], v[188:191], v[76:79], v[44:47]
    s_add_u32 m0, s43, 32768
    v_fmac_f32 v55, v113, v99
    v_fmac_f32 v52, v115, v108
    v_mfma_f32_16x16x32_bf16 v[36:39], v[188:191], v[72:75], v[36:39]
    s_add_u32 s42, s41, 32768
    ds_read_b128 v[60:63], v2 offset:58368
    v_fmac_f32 v53, v115, v109
    v_mfma_f32_16x16x32_bf16 v[48:51], v[192:195], v[72:75], v[48:51]
    v_mfma_f32_16x16x32_bf16 v[52:55], v[192:195], v[76:79], v[52:55]
    s_waitcnt lgkmcnt(2)
    v_mfma_f32_16x16x32_bf16 v[32:35], v[196:199], v[80:83], v[32:35]
    ds_read_b128 v[64:67], v2 offset:59392
    v_mfma_f32_16x16x32_bf16 v[40:43], v[196:199], v[84:87], v[40:43]
    buffer_load_dwordx4 v1, s[16:19], s42 offen offset:0 sc1 lds
    v_mfma_f32_16x16x32_bf16 v[44:47], v[200:203], v[84:87], v[44:47]
    v_fmac_f32 v54, v115, v110
    v_fmac_f32 v55, v115, v111
    v_mfma_f32_16x16x32_bf16 v[36:39], v[200:203], v[80:83], v[36:39]
    ds_read_b128 v[68:71], v2 offset:60416
    v_mfma_f32_16x16x32_bf16 v[48:51], v[204:207], v[80:83], v[48:51]
    v_mfma_f32_16x16x32_bf16 v[52:55], v[204:207], v[84:87], v[52:55]
    s_waitcnt lgkmcnt(2)
    v_mfma_f32_16x16x32_bf16 v[32:35], v[208:211], v[56:59], v[32:35]
    ds_read_b128 v[72:75], v2 offset:61440
    v_mfma_f32_16x16x32_bf16 v[40:43], v[208:211], v[60:63], v[40:43]
    buffer_load_dwordx4 v1, s[16:19], s42 offen offset:1024 sc1 lds
    v_mfma_f32_16x16x32_bf16 v[44:47], v[212:215], v[60:63], v[44:47]
    v_mfma_f32_16x16x32_bf16 v[36:39], v[212:215], v[56:59], v[36:39]
    ds_read_b128 v[76:79], v2 offset:62464
    v_mfma_f32_16x16x32_bf16 v[48:51], v[216:219], v[56:59], v[48:51]
    v_mfma_f32_16x16x32_bf16 v[52:55], v[216:219], v[60:63], v[52:55]
    s_waitcnt lgkmcnt(2)
    v_mfma_f32_16x16x32_bf16 v[32:35], v[220:223], v[64:67], v[32:35]
    ds_read_b128 v[80:83], v2 offset:63488
    v_mfma_f32_16x16x32_bf16 v[40:43], v[220:223], v[68:71], v[40:43]
    buffer_load_dwordx4 v1, s[16:19], s42 offen offset:2048 sc1 lds
    v_mfma_f32_16x16x32_bf16 v[44:47], v[224:227], v[68:71], v[44:47]
    v_mfma_f32_16x16x32_bf16 v[36:39], v[224:227], v[64:67], v[36:39]
    ds_read_b128 v[84:87], v2 offset:64512
    v_mfma_f32_16x16x32_bf16 v[48:51], v[228:231], v[64:67], v[48:51]
    v_mfma_f32_16x16x32_bf16 v[52:55], v[228:231], v[68:71], v[52:55]
    s_waitcnt vmcnt(8) lgkmcnt(2)
    s_barrier
    v_mfma_f32_16x16x32_bf16 v[32:35], v[232:235], v[72:75], v[32:35]
    ds_read_b128 v[56:59], v1 offset:0
    v_mfma_f32_16x16x32_bf16 v[40:43], v[232:235], v[76:79], v[40:43]
    buffer_load_dwordx4 v1, s[16:19], s42 offen offset:3072 sc1 lds
    v_mfma_f32_16x16x32_bf16 v[44:47], v[236:239], v[76:79], v[44:47]
    s_add_u32 s45, s45, 131072
    v_mfma_f32_16x16x32_bf16 v[36:39], v[236:239], v[72:75], v[36:39]
    ds_read_b128 v[60:63], v1 offset:1024
    v_mfma_f32_16x16x32_bf16 v[48:51], v[240:243], v[72:75], v[48:51]
    v_mfma_f32_16x16x32_bf16 v[52:55], v[240:243], v[76:79], v[52:55]
    s_waitcnt lgkmcnt(2)
    v_mfma_f32_16x16x32_bf16 v[32:35], v[244:247], v[80:83], v[32:35]
    ds_read_b128 v[64:67], v1 offset:2048
    v_mfma_f32_16x16x32_bf16 v[40:43], v[244:247], v[84:87], v[40:43]
    v_mfma_f32_16x16x32_bf16 v[44:47], v[248:251], v[84:87], v[44:47]
    v_mfma_f32_16x16x32_bf16 v[36:39], v[248:251], v[80:83], v[36:39]
    ds_read_b128 v[68:71], v1 offset:3072
    v_mfma_f32_16x16x32_bf16 v[48:51], v[252:255], v[80:83], v[48:51]
    v_mfma_f32_16x16x32_bf16 v[52:55], v[252:255], v[84:87], v[52:55]
    s_add_u32 s36, s36, 1
    s_cmp_lt_u32 s36, 32
    s_cbranch_scc1 L_a_b0
    s_nop 7
    s_and_b32 s44, s90, 0xffffffff
    s_cmp_eq_u32 s36, 0
    s_cselect_b32 s44, 0x5e00000, s44
    s_add_u32 s49, s44, s87
    s_max_u32 s44, s44, s88
    s_add_u32 s90, s90, 262144
    v_mul_f32 v120, v48, v116
    v_mul_f32 v121, v49, v116
    v_mul_f32 v120, v120, abs(v48)
    v_mul_f32 v121, v121, abs(v49)
    v_cvt_pk_bf16_f32 v48, v120, v121
    v_pk_max_i16 v48, v48, 0
    v_mul_f32 v120, v50, v116
    v_mul_f32 v121, v51, v116
    v_mul_f32 v120, v120, abs(v50)
    v_mul_f32 v121, v121, abs(v51)
    v_cvt_pk_bf16_f32 v49, v120, v121
    v_pk_max_i16 v49, v49, 0
    ds_write_b64 v3, v[48:49] offset:4096
    v_mul_f32 v120, v52, v117
    v_mul_f32 v121, v53, v117
    v_mul_f32 v120, v120, abs(v52)
    v_mul_f32 v121, v121, abs(v53)
    v_cvt_pk_bf16_f32 v52, v120, v121
    v_pk_max_i16 v52, v52, 0
    v_mul_f32 v120, v54, v117
    v_mul_f32 v121, v55, v117
    v_mul_f32 v120, v120, abs(v54)
    v_mul_f32 v121, v121, abs(v55)
    v_cvt_pk_bf16_f32 v53, v120, v121
    v_pk_max_i16 v53, v53, 0
    ds_write_b64 v3, v[52:53] offset:5120
    v_mul_f32 v120, v32, v116
    v_mul_f32 v121, v33, v116
    v_mul_f32 v120, v120, abs(v32)
    v_mul_f32 v121, v121, abs(v33)
    v_cvt_pk_bf16_f32 v32, v120, v121
    v_pk_max_i16 v32, v32, 0
    v_mul_f32 v120, v34, v116
    v_mul_f32 v121, v35, v116
    v_mul_f32 v120, v120, abs(v34)
    v_mul_f32 v121, v121, abs(v35)
    v_cvt_pk_bf16_f32 v33, v120, v121
    v_pk_max_i16 v33, v33, 0
    v_mul_f32 v120, v36, v116
    v_mul_f32 v121, v37, v116
    v_mul_f32 v120, v120, abs(v36)
    v_mul_f32 v121, v121, abs(v37)
    v_cvt_pk_bf16_f32 v34, v120, v121
    v_pk_max_i16 v34, v34, 0
    v_mul_f32 v120, v38, v116
    v_mul_f32 v121, v39, v116
    v_mul_f32 v120, v120, abs(v38)
    v_mul_f32 v121, v121, abs(v39)
    v_cvt_pk_bf16_f32 v35, v120, v121
    v_pk_max_i16 v35, v35, 0
    buffer_store_dwordx4 v[32:35], v1, s[16:19], s44 offen offset:0 sc1
    v_mul_f32 v120, v40, v117
    v_mul_f32 v121, v41, v117
    v_mul_f32 v120, v120, abs(v40)
    s_waitcnt lgkmcnt(0)
    s_barrier
    ds_read_b128 v[48:51], v4 offset:4096
    v_mul_f32 v121, v121, abs(v41)
    v_cvt_pk_bf16_f32 v40, v120, v121
    v_pk_max_i16 v40, v40, 0
    v_mul_f32 v120, v42, v117
    v_mul_f32 v121, v43, v117
    v_mul_f32 v120, v120, abs(v42)
    v_mul_f32 v121, v121, abs(v43)
    v_cvt_pk_bf16_f32 v41, v120, v121
    v_pk_max_i16 v41, v41, 0
    s_waitcnt lgkmcnt(0)
    buffer_store_dwordx4 v[48:51], v1, s[16:19], s49 offen sc1
    v_mul_f32 v120, v44, v117
    v_mul_f32 v121, v45, v117
    v_mul_f32 v120, v120, abs(v44)
    v_mul_f32 v121, v121, abs(v45)
    v_cvt_pk_bf16_f32 v42, v120, v121
    v_pk_max_i16 v42, v42, 0
    v_mul_f32 v120, v46, v117
    v_mul_f32 v121, v47, v117
    v_mul_f32 v120, v120, abs(v46)
    v_mul_f32 v121, v121, abs(v47)
    v_cvt_pk_bf16_f32 v43, v120, v121
    v_pk_max_i16 v43, v43, 0
    buffer_store_dwordx4 v[40:43], v1, s[16:19], s44 offen offset:1024 sc1
    s_waitcnt vmcnt(0)
    s_barrier
    buffer_store_dword v124, v124, s[16:19], s91 offen sc1
    s_add_u32 s91, s91, 131072
    s_waitcnt vmcnt(0)
    s_endpgm
L_spin18:
    s_mov_b32 s40, 0x20000
L_spin18_l:
    buffer_load_dword v56, v124, s[20:23], 0 offen sc1
    s_sub_u32 s40, s40, 1
    s_waitcnt vmcnt(0)
    v_cmp_eq_u32 vcc, v124, v56
    s_cbranch_scc1 L_back19
    s_cbranch_vccz L_back19
    s_sleep 8
    s_branch L_spin18_l
L_spin20:
    s_mov_b32 s40, 0x20000
L_spin20_l:
    buffer_load_dword v7, v5, s[16:19], s45 offen sc1
    s_sub_u32 s40, s40, 1
    s_waitcnt vmcnt(0)
    v_cmp_ne_u32 vcc, 0, v7
    s_cbranch_scc1 L_back21
    s_cbranch_vccz L_back21
    s_sleep 2
    s_branch L_spin20_l
L_spin22:
    s_mov_b32 s40, 0x20000
L_spin22_l:
    buffer_load_dword v7, v5, s[16:19], s45 offen sc1
    s_sub_u32 s40, s40, 1
    s_waitcnt vmcnt(0)
    v_cmp_ne_u32 vcc, 0, v7
    s_cbranch_scc1 L_back23
    s_cbranch_vccz L_back23
    s_sleep 2
    s_branch L_spin22_l
L_sspin24:
    s_mov_b32 s40, 0x20000
L_sspin24_l:
    buffer_load_dwordx2 v[36:37], v6, s[16:19], s46 offen offset:0 sc1
    buffer_load_dwordx2 v[38:39], v6, s[16:19], s46 offen offset:128 sc1
    buffer_load_dwordx2 v[40:41], v6, s[16:19], s46 offen offset:256 sc1
    buffer_load_dwordx2 v[42:43], v6, s[16:19], s46 offen offset:384 sc1
    s_sub_u32 s40, s40, 1
    s_waitcnt vmcnt(0)
    v_max3_u32 v44, v36, v37, v38
    v_max3_u32 v45, v39, v40, v41
    v_max3_u32 v44, v44, v42, v43
    v_max_u32 v44, v44, v45
    v_cmp_eq_u32 vcc, -1, v44
    s_cbranch_scc1 L_sback25
    s_cbranch_vccz L_sback25
    s_sleep 4
    s_branch L_sspin24_l
L_spin26:
    s_mov_b32 s40, 0x20000
L_spin26_l:
    buffer_load_dword v7, v5, s[16:19], s45 offen sc1
    s_sub_u32 s40, s40, 1
    s_waitcnt vmcnt(0)
    v_cmp_ne_u32 vcc, 0, v7
    s_cbranch_scc1 L_back27
    s_cbranch_vccz L_back27
    s_sleep 2
    s_branch L_spin26_l
L_sspin28:
    s_mov_b32 s40, 0x20000
L_sspin28_l:
    buffer_load_dwordx2 v[12:13], v6, s[16:19], s46 offen offset:0 sc1
    buffer_load_dwordx2 v[14:15], v6, s[16:19], s46 offen offset:128 sc1
    buffer_load_dwordx2 v[16:17], v6, s[16:19], s46 offen offset:256 sc1
    buffer_load_dwordx2 v[18:19], v6, s[16:19], s46 offen offset:384 sc1
    s_sub_u32 s40, s40, 1
    s_waitcnt vmcnt(0)
    v_max3_u32 v20, v12, v13, v14
    v_max3_u32 v21, v15, v16, v17
    v_max3_u32 v20, v20, v18, v19
    v_max_u32 v20, v20, v21
    v_cmp_eq_u32 vcc, -1, v20
    s_cbranch_scc1 L_sback29
    s_cbranch_vccz L_sback29
    s_sleep 4
    s_branch L_sspin28_l
L_role_43:
    s_sub_u32 s35, s34, 43
    s_endpgm
L_role_44:
    s_sub_u32 s35, s34, 44
    s_lshl_b32 s50, s33, 4
    s_add_u32 s50, s50, s35
    s_lshl_b32 s50, s50, 1
    s_lshl_b32 s46, s50, 15
    s_lshl_b32 s37, s32, 9
    s_add_u32 s46, s46, s37
    v_lshrrev_b32 v48, 3, v0
    v_and_b32 v49, 0x70, v1
    v_lshl_add_u32 v48, v48, 11, v49
    v_add_u32 v49, 16384, v48
    s_mov_b32 s8, s64
    s_mov_b32 s9, s65
    s_mov_b32 s10, 0x400000
    s_mov_b32 s11, 0x00020000
    buffer_load_dwordx4 v[16:19], v48, s[8:11], s46 offen offset:0
    buffer_load_dwordx4 v[20:23], v48, s[8:11], s46 offen offset:128
    buffer_load_dwordx4 v[24:27], v48, s[8:11], s46 offen offset:256
    buffer_load_dwordx4 v[28:31], v48, s[8:11], s46 offen offset:384
    buffer_load_dwordx4 v[32:35], v49, s[8:11], s46 offen offset:0
    buffer_load_dwordx4 v[36:39], v49, s[8:11], s46 offen offset:128
    buffer_load_dwordx4 v[40:43], v49, s[8:11], s46 offen offset:256
    buffer_load_dwordx4 v[44:47], v49, s[8:11], s46 offen offset:384
    s_xor_b32 s50, s50, 1
    s_lshl_b32 s46, s50, 15
    s_lshl_b32 s37, s32, 9
    s_add_u32 s46, s46, s37
    v_lshrrev_b32 v96, 3, v0
    v_and_b32 v97, 0x70, v1
    v_lshl_add_u32 v96, v96, 11, v97
    v_add_u32 v97, 16384, v96
    s_mov_b32 s8, s64
    s_mov_b32 s9, s65
    s_mov_b32 s10, 0x400000
    s_mov_b32 s11, 0x00020000
    buffer_load_dwordx4 v[64:67], v96, s[8:11], s46 offen offset:0
    buffer_load_dwordx4 v[68:71], v96, s[8:11], s46 offen offset:128
    buffer_load_dwordx4 v[72:75], v96, s[8:11], s46 offen offset:256
    buffer_load_dwordx4 v[76:79], v96, s[8:11], s46 offen offset:384
    buffer_load_dwordx4 v[80:83], v97, s[8:11], s46 offen offset:0
    buffer_load_dwordx4 v[84:87], v97, s[8:11], s46 offen offset:128
    buffer_load_dwordx4 v[88:91], v97, s[8:11], s46 offen offset:256
    buffer_load_dwordx4 v[92:95], v97, s[8:11], s46 offen offset:384
    s_xor_b32 s50, s50, 1
    s_mov_b32 s86, 0x3f803f80
    v_and_b32 v56, 1, v0
    v_lshlrev_b32 v56, 7, v56
    v_bfe_u32 v57, v0, 1, 1
    v_lshl_add_u32 v56, v57, 6, v56
    v_and_b32 v57, 0x38, v0
    v_add_u32 v56, v57, v56
    s_sub_u32 s46, 127, s50
    s_lshl_b32 s46, s46, 10
    s_lshl_b32 s37, s32, 8
    s_add_u32 s46, s46, s37
    s_add_u32 s46, s46, 0x5400000
    s_waitcnt vmcnt(8)
    v_dot2_f32_bf16 v48, v16, s86, 0
    v_dot2_f32_bf16 v49, v16, v16, 0
    v_dot2_f32_bf16 v50, v24, s86, 0
    v_dot2_f32_bf16 v51, v24, v24, 0
    v_dot2_f32_bf16 v52, v32, s86, 0
    v_dot2_f32_bf16 v53, v32, v32, 0
    v_dot2_f32_bf16 v54, v40, s86, 0
    v_dot2_f32_bf16 v55, v40, v40, 0
    v_dot2_f32_bf16 v48, v17, s86, v48
    v_dot2_f32_bf16 v49, v17, v17, v49
    v_dot2_f32_bf16 v50, v25, s86, v50
    v_dot2_f32_bf16 v51, v25, v25, v51
    v_dot2_f32_bf16 v52, v33, s86, v52
    v_dot2_f32_bf16 v53, v33, v33, v53
    v_dot2_f32_bf16 v54, v41, s86, v54
    v_dot2_f32_bf16 v55, v41, v41, v55
    v_dot2_f32_bf16 v48, v18, s86, v48
    v_dot2_f32_bf16 v49, v18, v18, v49
    v_dot2_f32_bf16 v50, v26, s86, v50
    v_dot2_f32_bf16 v51, v26, v26, v51
    v_dot2_f32_bf16 v52, v34, s86, v52
    v_dot2_f32_bf16 v53, v34, v34, v53
    v_dot2_f32_bf16 v54, v42, s86, v54
    v_dot2_f32_bf16 v55, v42, v42, v55
    v_dot2_f32_bf16 v48, v19, s86, v48
    v_dot2_f32_bf16 v49, v19, v19, v49
    v_dot2_f32_bf16 v50, v27, s86, v50
    v_dot2_f32_bf16 v51, v27, v27, v51
    v_dot2_f32_bf16 v52, v35, s86, v52
    v_dot2_f32_bf16 v53, v35, v35, v53
    v_dot2_f32_bf16 v54, v43, s86, v54
    v_dot2_f32_bf16 v55, v43, v43, v55
    v_dot2_f32_bf16 v48, v20, s86, v48
    v_dot2_f32_bf16 v49, v20, v20, v49
    v_dot2_f32_bf16 v50, v28, s86, v50
    v_dot2_f32_bf16 v51, v28, v28, v51
    v_dot2_f32_bf16 v52, v36, s86, v52
    v_dot2_f32_bf16 v53, v36, v36, v53
    v_dot2_f32_bf16 v54, v44, s86, v54
    v_dot2_f32_bf16 v55, v44, v44, v55
    v_dot2_f32_bf16 v48, v21, s86, v48
    v_dot2_f32_bf16 v49, v21, v21, v49
    v_dot2_f32_bf16 v50, v29, s86, v50
    v_dot2_f32_bf16 v51, v29, v29, v51
    v_dot2_f32_bf16 v52, v37, s86, v52
    v_dot2_f32_bf16 v53, v37, v37, v53
    v_dot2_f32_bf16 v54, v45, s86, v54
    v_dot2_f32_bf16 v55, v45, v45, v55
    v_dot2_f32_bf16 v48, v22, s86, v48
    v_dot2_f32_bf16 v49, v22, v22, v49
    v_dot2_f32_bf16 v50, v30, s86, v50
    v_dot2_f32_bf16 v51, v30, v30, v51
    v_dot2_f32_bf16 v52, v38, s86, v52
    v_dot2_f32_bf16 v53, v38, v38, v53
    v_dot2_f32_bf16 v54, v46, s86, v54
    v_dot2_f32_bf16 v55, v46, v46, v55
    v_dot2_f32_bf16 v48, v23, s86, v48
    v_dot2_f32_bf16 v49, v23, v23, v49
    v_dot2_f32_bf16 v50, v31, s86, v50
    v_dot2_f32_bf16 v51, v31, v31, v51
    v_dot2_f32_bf16 v52, v39, s86, v52
    v_dot2_f32_bf16 v53, v39, v39, v53
    v_dot2_f32_bf16 v54, v47, s86, v54
    v_dot2_f32_bf16 v55, v47, v47, v55
    v_add_f32_dpp v48, v48, v48 quad_perm:[1,0,3,2] row_mask:0xf bank_mask:0xf
    v_add_f32_dpp v49, v49, v49 quad_perm:[1,0,3,2] row_mask:0xf bank_mask:0xf
    v_add_f32_dpp v50, v50, v50 quad_perm:[1,0,3,2] row_mask:0xf bank_mask:0xf
    v_add_f32_dpp v51, v51, v51 quad_perm:[1,0,3,2] row_mask:0xf bank_mask:0xf
    v_add_f32_dpp v52, v52, v52 quad_perm:[1,0,3,2] row_mask:0xf bank_mask:0xf
    v_add_f32_dpp v53, v53, v53 quad_perm:[1,0,3,2] row_mask:0xf bank_mask:0xf
    v_add_f32_dpp v54, v54, v54 quad_perm:[1,0,3,2] row_mask:0xf bank_mask:0xf
    v_add_f32_dpp v55, v55, v55 quad_perm:[1,0,3,2] row_mask:0xf bank_mask:0xf
    v_add_f32_dpp v48, v48, v48 quad_perm:[2,3,0,1] row_mask:0xf bank_mask:0xf
    v_add_f32_dpp v49, v49, v49 quad_perm:[2,3,0,1] row_mask:0xf bank_mask:0xf
    v_add_f32_dpp v50, v50, v50 quad_perm:[2,3,0,1] row_mask:0xf bank_mask:0xf
    v_add_f32_dpp v51, v51, v51 quad_perm:[2,3,0,1] row_mask:0xf bank_mask:0xf
    v_add_f32_dpp v52, v52, v52 quad_perm:[2,3,0,1] row_mask:0xf bank_mask:0xf
    v_add_f32_dpp v53, v53, v53 quad_perm:[2,3,0,1] row_mask:0xf bank_mask:0xf
    v_add_f32_dpp v54, v54, v54 quad_perm:[2,3,0,1] row_mask:0xf bank_mask:0xf
    v_add_f32_dpp v55, v55, v55 quad_perm:[2,3,0,1] row_mask:0xf bank_mask:0xf
    v_add_f32_dpp v48, v48, v48 row_half_mirror row_mask:0xf bank_mask:0xf
    v_add_f32_dpp v49, v49, v49 row_half_mirror row_mask:0xf bank_mask:0xf
    v_add_f32_dpp v50, v50, v50 row_half_mirror row_mask:0xf bank_mask:0xf
    v_add_f32_dpp v51, v51, v51 row_half_mirror row_mask:0xf bank_mask:0xf
    v_add_f32_dpp v52, v52, v52 row_half_mirror row_mask:0xf bank_mask:0xf
    v_add_f32_dpp v53, v53, v53 row_half_mirror row_mask:0xf bank_mask:0xf
    v_add_f32_dpp v54, v54, v54 row_half_mirror row_mask:0xf bank_mask:0xf
    v_add_f32_dpp v55, v55, v55 row_half_mirror row_mask:0xf bank_mask:0xf
    s_mov_b32 exec_lo, 0x2020202
    s_mov_b32 exec_hi, 0x2020202
    v_mov_b32 v48, v50
    v_mov_b32 v49, v51
    s_mov_b32 exec_lo, 0x4040404
    s_mov_b32 exec_hi, 0x4040404
    v_mov_b32 v48, v52
    v_mov_b32 v49, v53
    s_mov_b32 exec_lo, 0x8080808
    s_mov_b32 exec_hi, 0x8080808
    v_mov_b32 v48, v54
    v_mov_b32 v49, v55
    s_mov_b32 exec_lo, 0x0f0f0f0f
    s_mov_b32 exec_hi, 0x0f0f0f0f
    buffer_store_dwordx2 v[48:49], v56, s[16:19], s46 offen sc1
    s_mov_b64 exec, -1
    s_xor_b32 s50, s50, 1
    s_mov_b32 s86, 0x3f803f80
    v_and_b32 v104, 1, v0
    v_lshlrev_b32 v104, 7, v104
    v_bfe_u32 v105, v0, 1, 1
    v_lshl_add_u32 v104, v105, 6, v104
    v_and_b32 v105, 0x38, v0
    v_add_u32 v104, v105, v104
    s_sub_u32 s46, 127, s50
    s_lshl_b32 s46, s46, 10
    s_lshl_b32 s37, s32, 8
    s_add_u32 s46, s46, s37
    s_add_u32 s46, s46, 0x5400000
    s_waitcnt vmcnt(1)
    v_dot2_f32_bf16 v96, v64, s86, 0
    v_dot2_f32_bf16 v97, v64, v64, 0
    v_dot2_f32_bf16 v98, v72, s86, 0
    v_dot2_f32_bf16 v99, v72, v72, 0
    v_dot2_f32_bf16 v100, v80, s86, 0
    v_dot2_f32_bf16 v101, v80, v80, 0
    v_dot2_f32_bf16 v102, v88, s86, 0
    v_dot2_f32_bf16 v103, v88, v88, 0
    v_dot2_f32_bf16 v96, v65, s86, v96
    v_dot2_f32_bf16 v97, v65, v65, v97
    v_dot2_f32_bf16 v98, v73, s86, v98
    v_dot2_f32_bf16 v99, v73, v73, v99
    v_dot2_f32_bf16 v100, v81, s86, v100
    v_dot2_f32_bf16 v101, v81, v81, v101
    v_dot2_f32_bf16 v102, v89, s86, v102
    v_dot2_f32_bf16 v103, v89, v89, v103
    v_dot2_f32_bf16 v96, v66, s86, v96
    v_dot2_f32_bf16 v97, v66, v66, v97
    v_dot2_f32_bf16 v98, v74, s86, v98
    v_dot2_f32_bf16 v99, v74, v74, v99
    v_dot2_f32_bf16 v100, v82, s86, v100
    v_dot2_f32_bf16 v101, v82, v82, v101
    v_dot2_f32_bf16 v102, v90, s86, v102
    v_dot2_f32_bf16 v103, v90, v90, v103
    v_dot2_f32_bf16 v96, v67, s86, v96
    v_dot2_f32_bf16 v97, v67, v67, v97
    v_dot2_f32_bf16 v98, v75, s86, v98
    v_dot2_f32_bf16 v99, v75, v75, v99
    v_dot2_f32_bf16 v100, v83, s86, v100
    v_dot2_f32_bf16 v101, v83, v83, v101
    v_dot2_f32_bf16 v102, v91, s86, v102
    v_dot2_f32_bf16 v103, v91, v91, v103
    v_dot2_f32_bf16 v96, v68, s86, v96
    v_dot2_f32_bf16 v97, v68, v68, v97
    v_dot2_f32_bf16 v98, v76, s86, v98
    v_dot2_f32_bf16 v99, v76, v76, v99
    v_dot2_f32_bf16 v100, v84, s86, v100
    v_dot2_f32_bf16 v101, v84, v84, v101
    v_dot2_f32_bf16 v102, v92, s86, v102
    v_dot2_f32_bf16 v103, v92, v92, v103
    v_dot2_f32_bf16 v96, v69, s86, v96
    v_dot2_f32_bf16 v97, v69, v69, v97
    v_dot2_f32_bf16 v98, v77, s86, v98
    v_dot2_f32_bf16 v99, v77, v77, v99
    v_dot2_f32_bf16 v100, v85, s86, v100
    v_dot2_f32_bf16 v101, v85, v85, v101
    v_dot2_f32_bf16 v102, v93, s86, v102
    v_dot2_f32_bf16 v103, v93, v93, v103
    v_dot2_f32_bf16 v96, v70, s86, v96
    v_dot2_f32_bf16 v97, v70, v70, v97
    v_dot2_f32_bf16 v98, v78, s86, v98
    v_dot2_f32_bf16 v99, v78, v78, v99
    v_dot2_f32_bf16 v100, v86, s86, v100
    v_dot2_f32_bf16 v101, v86, v86, v101
    v_dot2_f32_bf16 v102, v94, s86, v102
    v_dot2_f32_bf16 v103, v94, v94, v103
    v_dot2_f32_bf16 v96, v71, s86, v96
    v_dot2_f32_bf16 v97, v71, v71, v97
    v_dot2_f32_bf16 v98, v79, s86, v98
    v_dot2_f32_bf16 v99, v79, v79, v99
    v_dot2_f32_bf16 v100, v87, s86, v100
    v_dot2_f32_bf16 v101, v87, v87, v101
    v_dot2_f32_bf16 v102, v95, s86, v102
    v_dot2_f32_bf16 v103, v95, v95, v103
    v_add_f32_dpp v96, v96, v96 quad_perm:[1,0,3,2] row_mask:0xf bank_mask:0xf
    v_add_f32_dpp v97, v97, v97 quad_perm:[1,0,3,2] row_mask:0xf bank_mask:0xf
    v_add_f32_dpp v98, v98, v98 quad_perm:[1,0,3,2] row_mask:0xf bank_mask:0xf
    v_add_f32_dpp v99, v99, v99 quad_perm:[1,0,3,2] row_mask:0xf bank_mask:0xf
    v_add_f32_dpp v100, v100, v100 quad_perm:[1,0,3,2] row_mask:0xf bank_mask:0xf
    v_add_f32_dpp v101, v101, v101 quad_perm:[1,0,3,2] row_mask:0xf bank_mask:0xf
    v_add_f32_dpp v102, v102, v102 quad_perm:[1,0,3,2] row_mask:0xf bank_mask:0xf
    v_add_f32_dpp v103, v103, v103 quad_perm:[1,0,3,2] row_mask:0xf bank_mask:0xf
    v_add_f32_dpp v96, v96, v96 quad_perm:[2,3,0,1] row_mask:0xf bank_mask:0xf
    v_add_f32_dpp v97, v97, v97 quad_perm:[2,3,0,1] row_mask:0xf bank_mask:0xf
    v_add_f32_dpp v98, v98, v98 quad_perm:[2,3,0,1] row_mask:0xf bank_mask:0xf
    v_add_f32_dpp v99, v99, v99 quad_perm:[2,3,0,1] row_mask:0xf bank_mask:0xf
    v_add_f32_dpp v100, v100, v100 quad_perm:[2,3,0,1] row_mask:0xf bank_mask:0xf
    v_add_f32_dpp v101, v101, v101 quad_perm:[2,3,0,1] row_mask:0xf bank_mask:0xf
    v_add_f32_dpp v102, v102, v102 quad_perm:[2,3,0,1] row_mask:0xf bank_mask:0xf
    v_add_f32_dpp v103, v103, v103 quad_perm:[2,3,0,1] row_mask:0xf bank_mask:0xf
    v_add_f32_dpp v96, v96, v96 row_half_mirror row_mask:0xf bank_mask:0xf
    v_add_f32_dpp v97, v97, v97 row_half_mirror row_mask:0xf bank_mask:0xf
    v_add_f32_dpp v98, v98, v98 row_half_mirror row_mask:0xf bank_mask:0xf
    v_add_f32_dpp v99, v99, v99 row_half_mirror row_mask:0xf bank_mask:0xf
    v_add_f32_dpp v100, v100, v100 row_half_mirror row_mask:0xf bank_mask:0xf
    v_add_f32_dpp v101, v101, v101 row_half_mirror row_mask:0xf bank_mask:0xf
    v_add_f32_dpp v102, v102, v102 row_half_mirror row_mask:0xf bank_mask:0xf
    v_add_f32_dpp v103, v103, v103 row_half_mirror row_mask:0xf bank_mask:0xf
    s_mov_b32 exec_lo, 0x2020202
    s_mov_b32 exec_hi, 0x2020202
    v_mov_b32 v96, v98
    v_mov_b32 v97, v99
    s_mov_b32 exec_lo, 0x4040404
    s_mov_b32 exec_hi, 0x4040404
    v_mov_b32 v96, v100
    v_mov_b32 v97, v101
    s_mov_b32 exec_lo, 0x8080808
    s_mov_b32 exec_hi, 0x8080808
    v_mov_b32 v96, v102
    v_mov_b32 v97, v103
    s_mov_b32 exec_lo, 0x0f0f0f0f
    s_mov_b32 exec_hi, 0x0f0f0f0f
    buffer_store_dwordx2 v[96:97], v104, s[16:19], s46 offen sc1
    s_mov_b64 exec, -1
    s_xor_b32 s50, s50, 1
    s_cmp_lg_u32 s32, 0
    s_cbranch_scc1 L_arv30
    s_add_u32 s20, s82, 0x80
    s_addc_u32 s21, s83, 0
    s_mov_b32 s22, 0x4
    s_mov_b32 s23, 0x00020000
    buffer_load_dword v8, v124, s[20:23], 0 offen sc1
    s_waitcnt vmcnt(0)
    v_cmp_eq_u32 vcc, v124, v8
    s_cbranch_vccnz L_spin31
L_back32:
L_arv30:
    s_waitcnt vmcnt(0)
    s_barrier
    s_add_u32 s39, s91, 65536
    buffer_store_dword v124, v124, s[16:19], s39 offen sc1
    s_lshr_b32 s51, s35, 2
    s_and_b32 s87, s35, 3
    s_mul_i32 s54, s51, 1441792
    s_lshl_b32 s37, s87, 9
    s_add_u32 s54, s54, s37
    s_mov_b32 s12, s76
    s_mov_b32 s13, s77
    s_mov_b32 s14, 0x700000
    s_mov_b32 s15, 0x00020000
    s_mov_b32 s39, 2048
    s_cmp_lg_u32 s32, 0
    s_cbranch_scc1 L_arv33
    s_add_u32 s20, s82, 0x80
    s_addc_u32 s21, s83, 0
    s_mov_b32 s22, 0x4
    s_mov_b32 s23, 0x00020000
    buffer_load_dword v48, v124, s[20:23], 0 offen sc1
    s_waitcnt vmcnt(0)
    v_cmp_eq_u32 vcc, v124, v48
    s_cbranch_vccnz L_spin34
L_back35:
L_arv33:
    s_lshr_b32 s38, s47, 3
    s_lshl_b32 s38, s38, 1
    s_lshl_b32 s37, s33, 6
    s_add_u32 s37, s37, s38
    s_lshl_b32 s37, s37, 8
    v_lshl_add_u32 v48, v0, 8, s37
    s_cmp_eq_u32 s32, 0
    s_cselect_b32 s37, 1, 0
    v_cmp_le_u32 vcc, s37, v0
    s_nop 1
    v_cndmask_b32 v48, v48, 2.0, vcc
    s_mov_b32 s38, 0x5540000
    buffer_load_dword v49, v48, s[16:19], s38 offen sc1
    s_waitcnt vmcnt(0)
    v_cmp_ne_u32 vcc, 0, v49
    s_cbranch_vccnz L_spin36
L_back37:
    s_barrier
    v_lshrrev_b32 v64, 3, v0
    v_lshlrev_b32 v65, 2, v0
    v_and_b32 v65, 64, v65
    v_and_b32 v66, 0x70, v1
    v_xor_b32 v65, v65, v66
    v_mad_u32_u24 v48, v64, s39, v65
    v_add_u32 v49, 16384, v48
    v_add_u32 v50, 128, v48
    v_add_u32 v51, 16512, v48
    v_add_u32 v52, 256, v48
    v_add_u32 v53, 16640, v48
    v_add_u32 v54, 384, v48
    v_add_u32 v55, 16768, v48
    s_mul_i32 s38, s32, 32768
    s_add_u32 s54, s54, s38
    s_lshl_b32 s42, s32, 11
    s_add_u32 m0, s42, 0
    s_nop 0
    buffer_load_dwordx4 v48, s[12:15], s54 offen lds
    s_add_u32 m0, s42, 1024
    s_nop 0
    buffer_load_dwordx4 v49, s[12:15], s54 offen lds
    s_add_u32 m0, s42, 8192
    s_nop 0
    buffer_load_dwordx4 v50, s[12:15], s54 offen lds
    s_add_u32 m0, s42, 9216
    s_nop 0
    buffer_load_dwordx4 v51, s[12:15], s54 offen lds
    s_add_u32 m0, s42, 16384
    s_nop 0
    buffer_load_dwordx4 v52, s[12:15], s54 offen lds
    s_add_u32 m0, s42, 17408
    s_nop 0
    buffer_load_dwordx4 v53, s[12:15], s54 offen lds
    s_add_u32 m0, s42, 24576
    s_nop 0
    buffer_load_dwordx4 v54, s[12:15], s54 offen lds
    s_add_u32 m0, s42, 25600
    s_nop 0
    buffer_load_dwordx4 v55, s[12:15], s54 offen lds
    s_add_u32 s54, s54, 131072
    s_add_u32 m0, s42, 32768
    s_nop 0
    buffer_load_dwordx4 v48, s[12:15], s54 offen lds
    s_add_u32 m0, s42, 33792
    s_nop 0
    buffer_load_dwordx4 v49, s[12:15], s54 offen lds
    s_add_u32 m0, s42, 40960
    s_nop 0
    buffer_load_dwordx4 v50, s[12:15], s54 offen lds
    s_add_u32 m0, s42, 41984
    s_nop 0
    buffer_load_dwordx4 v51, s[12:15], s54 offen lds
    s_add_u32 m0, s42, 49152
    s_nop 0
    buffer_load_dwordx4 v52, s[12:15], s54 offen lds
    s_add_u32 m0, s42, 50176
    s_nop 0
    buffer_load_dwordx4 v53, s[12:15], s54 offen lds
    s_add_u32 m0, s42, 57344
    s_nop 0
    buffer_load_dwordx4 v54, s[12:15], s54 offen lds
    s_add_u32 m0, s42, 58368
    s_nop 0
    buffer_load_dwordx4 v55, s[12:15], s54 offen lds
    s_add_u32 s54, s54, 131072
    s_add_u32 m0, s42, 65536
    s_nop 0
    buffer_load_dwordx4 v48, s[12:15], s54 offen lds
    s_add_u32 m0, s42, 66560
    s_nop 0
    buffer_load_dwordx4 v49, s[12:15], s54 offen lds
    s_add_u32 m0, s42, 73728
    s_nop 0
    buffer_load_dwordx4 v50, s[12:15], s54 offen lds
    s_add_u32 m0, s42, 74752
    s_nop 0
    buffer_load_dwordx4 v51, s[12:15], s54 offen lds
    s_add_u32 m0, s42, 81920
    s_nop 0
    buffer_load_dwordx4 v52, s[12:15], s54 offen lds
    s_add_u32 m0, s42, 82944
    s_nop 0
    buffer_load_dwordx4 v53, s[12:15], s54 offen lds
    s_add_u32 m0, s42, 90112
    s_nop 0
    buffer_load_dwordx4 v54, s[12:15], s54 offen lds
    s_add_u32 m0, s42, 91136
    s_nop 0
    buffer_load_dwordx4 v55, s[12:15], s54 offen lds
    s_add_u32 s54, s54, 131072
    s_add_u32 m0, s42, 98304
    s_nop 0
    buffer_load_dwordx4 v48, s[12:15], s54 offen lds
    s_add_u32 m0, s42, 99328
    s_nop 0
    buffer_load_dwordx4 v49, s[12:15], s54 offen lds
    s_add_u32 m0, s42, 106496
    s_nop 0
    buffer_load_dwordx4 v50, s[12:15], s54 offen lds
    s_add_u32 m0, s42, 107520
    s_nop 0
    buffer_load_dwordx4 v51, s[12:15], s54 offen lds
    s_add_u32 m0, s42, 114688
    s_nop 0
    buffer_load_dwordx4 v52, s[12:15], s54 offen lds
    s_add_u32 m0, s42, 115712
    s_nop 0
    buffer_load_dwordx4 v53, s[12:15], s54 offen lds
    s_add_u32 m0, s42, 122880
    s_nop 0
    buffer_load_dwordx4 v54, s[12:15], s54 offen lds
    s_add_u32 m0, s42, 123904
    s_nop 0
    buffer_load_dwordx4 v55, s[12:15], s54 offen lds
    s_add_u32 s54, s54, 131072
    v_lshrrev_b32 v64, 4, v0
    v_bfe_u32 v65, v0, 2, 2
    v_lshl_add_u32 v64, v64, 3, v65
    v_lshlrev_b32 v64, 7, v64
    v_lshrrev_b32 v65, 1, v65
    v_lshl_add_u32 v64, v65, 6, v64
    v_and_b32 v65, 3, v0
    v_lshl_add_u32 v64, v65, 4, v64
    s_lshl_b32 s37, s32, 13
    s_and_b32 s38, s51, 2
    s_lshl_b32 s38, s38, 5
    s_xor_b32 s38, s38, 0
    s_add_u32 s37, s37, s38
    v_xor_b32 v56, s37, v64
    s_lshl_b32 s37, s32, 13
    s_and_b32 s38, s51, 2
    s_lshl_b32 s38, s38, 5
    s_xor_b32 s38, s38, 8
    s_add_u32 s37, s37, s38
    v_xor_b32 v57, s37, v64
    s_lshl_b32 s37, s32, 13
    s_and_b32 s38, s51, 2
    s_lshl_b32 s38, s38, 5
    s_xor_b32 s38, s38, 64
    s_add_u32 s37, s37, s38
    v_xor_b32 v58, s37, v64
    s_lshl_b32 s37, s32, 13
    s_and_b32 s38, s51, 2
    s_lshl_b32 s38, s38, 5
    s_xor_b32 s38, s38, 72
    s_add_u32 s37, s37, s38
    v_xor_b32 v59, s37, v64
    s_and_b32 s39, s51, 1
    s_lshl_b32 s37, s39, 10
    v_add_u32 v2, s37, v1
    v_xor_b32 v3, 1024, v2
    v_add_u32 v4, 98304, v2
    v_add_u32 v5, 98304, v3
    s_mul_i32 s38, s51, 11*43
    s_lshr_b32 s38, s38, 7
    s_add_u32 s38, s38, 24
    s_lshl_b32 s37, s33, 6
    s_add_u32 s37, s37, s38
    s_lshl_b32 s37, s37, 8
    v_lshl_add_u32 v6, v0, 8, s37
    s_cmp_eq_u32 s32, 0
    s_cselect_b32 s37, 5, 0
    v_cmp_le_u32 vcc, s37, v0
    s_nop 1
    v_cndmask_b32 v6, v6, 2.0, vcc
    s_mul_i32 s43, s32, 3072
    s_lshl_b32 s88, s32, 11
    s_sub_u32 s89, s88, s43
    s_mul_i32 s41, s33, 8388608
    s_add_u32 s41, s41, 0x1000000
    s_mul_i32 s37, s51, 45056
    s_add_u32 s41, s41, s37
    s_add_u32 s41, s41, s43
    s_mul_i32 s90, s33, 8388608
    s_add_u32 s90, s90, 0x2fc0000
    s_lshl_b32 s37, s87, 16
    s_add_u32 s90, s90, s37
    s_lshl_b32 s37, s32, 12
    s_add_u32 s90, s90, s37
    s_and_b32 s37, s51, 3
    s_lshl_b32 s37, s37, 14
    s_add_u32 s90, s90, s37
    v_mov_b32 v104, 0
    v_mov_b32 v105, 0
    v_mov_b32 v106, 0
    v_mov_b32 v107, 0
    v_mov_b32 v108, 0
    v_mov_b32 v109, 0
    v_mov_b32 v110, 0
    v_mov_b32 v111, 0
    v_mov_b32 v17, 0x3f80
    v_and_b32 v16, 1, v0
    v_lshlrev_b32 v16, 4, v16
    v_lshlrev_b32 v16, v16, v17
    s_mov_b32 exec_lo, 0x300003
    s_mov_b32 exec_hi, 0x30000300
    v_mov_b32 v104, v16
    v_mov_b32 v110, v16
    s_mov_b32 exec_lo, 0xc0000c
    s_mov_b32 exec_hi, 0xc0000c00
    v_mov_b32 v105, v16
    v_mov_b32 v111, v16
    s_mov_b64 exec, -1
    s_add_u32 s38, s87, 44
    s_lshl_b32 s37, s33, 6
    s_add_u32 s37, s37, s38
    s_lshl_b32 s37, s37, 8
    v_lshl_add_u32 v8, v0, 10, s37
    s_cmp_eq_u32 s32, 0
    s_cselect_b32 s37, 5, 0
    v_cmp_le_u32 vcc, s37, v0
    s_nop 1
    v_cndmask_b32 v8, v8, 2.0, vcc
    s_lshl_b32 s38, s87, 2
    s_add_u32 s38, s38, s32
    s_lshl_b32 s38, s38, 1
    s_lshr_b32 s37, s51, 1
    s_add_u32 s38, s38, s37
    s_mul_i32 s53, s33, 2097152
    s_add_u32 s53, s53, 0x7f0000
    s_lshl_b32 s37, s38, 11
    s_add_u32 s53, s53, s37
    s_lshl_b32 s37, s39, 10
    s_add_u32 s53, s53, s37
    v_and_b32 v16, 15, v0
    v_and_b32 v17, 0x30, v0
    s_lshl_b32 s38, s38, 6
    s_mov_b32 s8, s78
    s_mov_b32 s9, s79
    s_mov_b32 s10, 0x800
    s_mov_b32 s11, 0x00020000
    buffer_load_dwordx4 v[24:27], v17, s[8:11], s38 offen
    v_lshl_add_u32 v9, v16, 11, v17
    v_add_u32 v9, s38, v9
    s_lshl_b32 s50, s33, 5
    s_add_u32 s50, s50, 31
    s_sub_u32 s50, s50, s39
    v_bfe_u32 v17, v0, 4, 1
    v_lshl_add_u32 v16, v16, 1, v17
    s_lshl_b32 s37, s32, 2
    s_add_u32 s37, s37, 65536
    v_lshl_add_u32 v10, v16, 4, s37
    v_and_b32 v16, 31, v0
    v_lshrrev_b32 v12, 5, v0
    v_lshlrev_b32 v12, 30, v12
    v_lshl_add_u32 v12, v16, 2, v12
    v_lshlrev_b32 v16, 4, v16
    v_add_u32 v11, 65536, v16
    s_lshl_b32 s37, s87, 1
    s_lshr_b32 s38, s51, 1
    s_add_u32 s37, s37, s38
    s_lshl_b32 s37, s37, 7
    s_add_u32 s55, s37, 0x543fc00
    s_cmp_eq_u32 s32, 2
    s_cselect_b32 s55, s55, 0x5f00000
    v_add_u32 v60, 0, v56
    v_add_u32 v61, 0, v57
    v_add_u32 v62, 0, v58
    v_add_u32 v63, 0, v59
    s_waitcnt vmcnt(25)
    s_barrier
    ds_read_b64_tr_b16 a[0:1], v60 offset:0
    ds_read_b64_tr_b16 a[2:3], v60 offset:512
    ds_read_b64_tr_b16 a[4:5], v61 offset:0
    ds_read_b64_tr_b16 a[6:7], v61 offset:512
    ds_read_b64_tr_b16 a[8:9], v62 offset:0
    ds_read_b64_tr_b16 a[10:11], v62 offset:512
    ds_read_b64_tr_b16 a[12:13], v63 offset:0
    ds_read_b64_tr_b16 a[14:15], v63 offset:512
    ds_read_b64_tr_b16 a[16:17], v60 offset:4096
    ds_read_b64_tr_b16 a[18:19], v60 offset:4608
    ds_read_b64_tr_b16 a[20:21], v61 offset:4096
    ds_read_b64_tr_b16 a[22:23], v61 offset:4608
    ds_read_b64_tr_b16 a[24:25], v62 offset:4096
    ds_read_b64_tr_b16 a[26:27], v62 offset:4608
    ds_read_b64_tr_b16 a[28:29], v63 offset:4096
    ds_read_b64_tr_b16 a[30:31], v63 offset:4608
    s_add_u32 m0, s42, 131072
    s_nop 0
    buffer_load_dwordx4 v48, s[12:15], s54 offen lds
    s_add_u32 m0, s42, 132096
    s_nop 0
    buffer_load_dwordx4 v49, s[12:15], s54 offen lds
    s_add_u32 m0, s42, 139264
    s_nop 0
    buffer_load_dwordx4 v50, s[12:15], s54 offen lds
    s_add_u32 m0, s42, 140288
    s_nop 0
    buffer_load_dwordx4 v51, s[12:15], s54 offen lds
    s_add_u32 m0, s42, 147456
    s_nop 0
    buffer_load_dwordx4 v52, s[12:15], s54 offen lds
    s_add_u32 m0, s42, 148480
    s_nop 0
    buffer_load_dwordx4 v53, s[12:15], s54 offen lds
    s_add_u32 m0, s42, 155648
    s_nop 0
    buffer_load_dwordx4 v54, s[12:15], s54 offen lds
    s_add_u32 m0, s42, 156672
    s_nop 0
    buffer_load_dwordx4 v55, s[12:15], s54 offen lds
    s_add_u32 s54, s54, 131072
    s_waitcnt lgkmcnt(0)
    v_add_u32 v60, 32768, v56
    v_add_u32 v61, 32768, v57
    v_add_u32 v62, 32768, v58
    v_add_u32 v63, 32768, v59
    s_waitcnt vmcnt(25)
    s_barrier
    ds_read_b64_tr_b16 a[32:33], v60 offset:0
    ds_read_b64_tr_b16 a[34:35], v60 offset:512
    ds_read_b64_tr_b16 a[36:37], v61 offset:0
    ds_read_b64_tr_b16 a[38:39], v61 offset:512
    ds_read_b64_tr_b16 a[40:41], v62 offset:0
    ds_read_b64_tr_b16 a[42:43], v62 offset:512
    ds_read_b64_tr_b16 a[44:45], v63 offset:0
    ds_read_b64_tr_b16 a[46:47], v63 offset:512
    ds_read_b64_tr_b16 a[48:49], v60 offset:4096
    ds_read_b64_tr_b16 a[50:51], v60 offset:4608
    ds_read_b64_tr_b16 a[52:53], v61 offset:4096
    ds_read_b64_tr_b16 a[54:55], v61 offset:4608
    ds_read_b64_tr_b16 a[56:57], v62 offset:4096
    ds_read_b64_tr_b16 a[58:59], v62 offset:4608
    ds_read_b64_tr_b16 a[60:61], v63 offset:4096
    ds_read_b64_tr_b16 a[62:63], v63 offset:4608
    s_add_u32 m0, s42, 0
    s_nop 0
    buffer_load_dwordx4 v48, s[12:15], s54 offen lds
    s_add_u32 m0, s42, 1024
    s_nop 0
    buffer_load_dwordx4 v49, s[12:15], s54 offen lds
    s_add_u32 m0, s42, 8192
    s_nop 0
    buffer_load_dwordx4 v50, s[12:15], s54 offen lds
    s_add_u32 m0, s42, 9216
    s_nop 0
    buffer_load_dwordx4 v51, s[12:15], s54 offen lds
    s_add_u32 m0, s42, 16384
    s_nop 0
    buffer_load_dwordx4 v52, s[12:15], s54 offen lds
    s_add_u32 m0, s42, 17408
    s_nop 0
    buffer_load_dwordx4 v53, s[12:15], s54 offen lds
    s_add_u32 m0, s42, 24576
    s_nop 0
    buffer_load_dwordx4 v54, s[12:15], s54 offen lds
    s_add_u32 m0, s42, 25600
    s_nop 0
    buffer_load_dwordx4 v55, s[12:15], s54 offen lds
    s_add_u32 s54, s54, 131072
    s_waitcnt lgkmcnt(0)
    v_add_u32 v60, 65536, v56
    v_add_u32 v61, 65536, v57
    v_add_u32 v62, 65536, v58
    v_add_u32 v63, 65536, v59
    s_waitcnt vmcnt(25)
    s_barrier
    ds_read_b64_tr_b16 a[64:65], v60 offset:0
    ds_read_b64_tr_b16 a[66:67], v60 offset:512
    ds_read_b64_tr_b16 a[68:69], v61 offset:0
    ds_read_b64_tr_b16 a[70:71], v61 offset:512
    ds_read_b64_tr_b16 a[72:73], v62 offset:0
    ds_read_b64_tr_b16 a[74:75], v62 offset:512
    ds_read_b64_tr_b16 a[76:77], v63 offset:0
    ds_read_b64_tr_b16 a[78:79], v63 offset:512
    ds_read_b64_tr_b16 a[80:81], v60 offset:4096
    ds_read_b64_tr_b16 a[82:83], v60 offset:4608
    ds_read_b64_tr_b16 a[84:85], v61 offset:4096
    ds_read_b64_tr_b16 a[86:87], v61 offset:4608
    ds_read_b64_tr_b16 a[88:89], v62 offset:4096
    ds_read_b64_tr_b16 a[90:91], v62 offset:4608
    ds_read_b64_tr_b16 a[92:93], v63 offset:4096
    ds_read_b64_tr_b16 a[94:95], v63 offset:4608
    s_add_u32 m0, s42, 32768
    s_nop 0
    buffer_load_dwordx4 v48, s[12:15], s54 offen lds
    s_add_u32 m0, s42, 33792
    s_nop 0
    buffer_load_dwordx4 v49, s[12:15], s54 offen lds
    s_add_u32 m0, s42, 40960
    s_nop 0
    buffer_load_dwordx4 v50, s[12:15], s54 offen lds
    s_add_u32 m0, s42, 41984
    s_nop 0
    buffer_load_dwordx4 v51, s[12:15], s54 offen lds
    s_add_u32 m0, s42, 49152
    s_nop 0
    buffer_load_dwordx4 v52, s[12:15], s54 offen lds
    s_add_u32 m0, s42, 50176
    s_nop 0
    buffer_load_dwordx4 v53, s[12:15], s54 offen lds
    s_add_u32 m0, s42, 57344
    s_nop 0
    buffer_load_dwordx4 v54, s[12:15], s54 offen lds
    s_add_u32 m0, s42, 58368
    s_nop 0
    buffer_load_dwordx4 v55, s[12:15], s54 offen lds
    s_add_u32 s54, s54, 131072
    s_waitcnt lgkmcnt(0)
    v_add_u32 v60, 98304, v56
    v_add_u32 v61, 98304, v57
    v_add_u32 v62, 98304, v58
    v_add_u32 v63, 98304, v59
    s_waitcnt vmcnt(25)
    s_barrier
    ds_read_b64_tr_b16 a[96:97], v60 offset:0
    ds_read_b64_tr_b16 a[98:99], v60 offset:512
    ds_read_b64_tr_b16 a[100:101], v61 offset:0
    ds_read_b64_tr_b16 a[102:103], v61 offset:512
    ds_read_b64_tr_b16 a[104:105], v62 offset:0
    ds_read_b64_tr_b16 a[106:107], v62 offset:512
    ds_read_b64_tr_b16 a[108:109], v63 offset:0
    ds_read_b64_tr_b16 a[110:111], v63 offset:512
    ds_read_b64_tr_b16 a[112:113], v60 offset:4096
    ds_read_b64_tr_b16 a[114:115], v60 offset:4608
    ds_read_b64_tr_b16 a[116:117], v61 offset:4096
    ds_read_b64_tr_b16 a[118:119], v61 offset:4608
    ds_read_b64_tr_b16 a[120:121], v62 offset:4096
    ds_read_b64_tr_b16 a[122:123], v62 offset:4608
    ds_read_b64_tr_b16 a[124:125], v63 offset:4096
    ds_read_b64_tr_b16 a[126:127], v63 offset:4608
    s_add_u32 m0, s42, 65536
    s_nop 0
    buffer_load_dwordx4 v48, s[12:15], s54 offen lds
    s_add_u32 m0, s42, 66560
    s_nop 0
    buffer_load_dwordx4 v49, s[12:15], s54 offen lds
    s_add_u32 m0, s42, 73728
    s_nop 0
    buffer_load_dwordx4 v50, s[12:15], s54 offen lds
    s_add_u32 m0, s42, 74752
    s_nop 0
    buffer_load_dwordx4 v51, s[12:15], s54 offen lds
    s_add_u32 m0, s42, 81920
    s_nop 0
    buffer_load_dwordx4 v52, s[12:15], s54 offen lds
    s_add_u32 m0, s42, 82944
    s_nop 0
    buffer_load_dwordx4 v53, s[12:15], s54 offen lds
    s_add_u32 m0, s42, 90112
    s_nop 0
    buffer_load_dwordx4 v54, s[12:15], s54 offen lds
    s_add_u32 m0, s42, 91136
    s_nop 0
    buffer_load_dwordx4 v55, s[12:15], s54 offen lds
    s_add_u32 s54, s54, 131072
    s_waitcnt lgkmcnt(0)
    v_add_u32 v60, 131072, v56
    v_add_u32 v61, 131072, v57
    v_add_u32 v62, 131072, v58
    v_add_u32 v63, 131072, v59
    s_waitcnt vmcnt(24)
    s_barrier
    ds_read_b64_tr_b16 a[128:129], v60 offset:0
    ds_read_b64_tr_b16 a[130:131], v60 offset:512
    ds_read_b64_tr_b16 a[132:133], v61 offset:0
    ds_read_b64_tr_b16 a[134:135], v61 offset:512
    ds_read_b64_tr_b16 a[136:137], v62 offset:0
    ds_read_b64_tr_b16 a[138:139], v62 offset:512
    ds_read_b64_tr_b16 a[140:141], v63 offset:0
    ds_read_b64_tr_b16 a[142:143], v63 offset:512
    ds_read_b64_tr_b16 a[144:145], v60 offset:4096
    ds_read_b64_tr_b16 a[146:147], v60 offset:4608
    ds_read_b64_tr_b16 a[148:149], v61 offset:4096
    ds_read_b64_tr_b16 a[150:151], v61 offset:4608
    ds_read_b64_tr_b16 a[152:153], v62 offset:4096
    ds_read_b64_tr_b16 a[154:155], v62 offset:4608
    ds_read_b64_tr_b16 a[156:157], v63 offset:4096
    ds_read_b64_tr_b16 a[158:159], v63 offset:4608
    s_add_u32 m0, s42, 98304
    s_nop 0
    buffer_load_dwordx4 v48, s[12:15], s54 offen lds
    s_add_u32 m0, s42, 99328
    s_nop 0
    buffer_load_dwordx4 v49, s[12:15], s54 offen lds
    s_add_u32 m0, s42, 106496
    s_nop 0
    buffer_load_dwordx4 v50, s[12:15], s54 offen lds
    s_add_u32 m0, s42, 107520
    s_nop 0
    buffer_load_dwordx4 v51, s[12:15], s54 offen lds
    s_add_u32 m0, s42, 114688
    s_nop 0
    buffer_load_dwordx4 v52, s[12:15], s54 offen lds
    s_add_u32 m0, s42, 115712
    s_nop 0
    buffer_load_dwordx4 v53, s[12:15], s54 offen lds
    s_add_u32 m0, s42, 122880
    s_nop 0
    buffer_load_dwordx4 v54, s[12:15], s54 offen lds
    s_add_u32 m0, s42, 123904
    s_nop 0
    buffer_load_dwordx4 v55, s[12:15], s54 offen lds
    s_add_u32 s54, s54, 131072
    s_waitcnt lgkmcnt(0)
    v_add_u32 v60, 0, v56
    v_add_u32 v61, 0, v57
    v_add_u32 v62, 0, v58
    v_add_u32 v63, 0, v59
    s_waitcnt vmcnt(24)
    s_barrier
    ds_read_b64_tr_b16 a[160:161], v60 offset:0
    ds_read_b64_tr_b16 a[162:163], v60 offset:512
    ds_read_b64_tr_b16 a[164:165], v61 offset:0
    ds_read_b64_tr_b16 a[166:167], v61 offset:512
    ds_read_b64_tr_b16 a[168:169], v62 offset:0
    ds_read_b64_tr_b16 a[170:171], v62 offset:512
    ds_read_b64_tr_b16 a[172:173], v63 offset:0
    ds_read_b64_tr_b16 a[174:175], v63 offset:512
    ds_read_b64_tr_b16 a[176:177], v60 offset:4096
    ds_read_b64_tr_b16 a[178:179], v60 offset:4608
    ds_read_b64_tr_b16 a[180:181], v61 offset:4096
    ds_read_b64_tr_b16 a[182:183], v61 offset:4608
    ds_read_b64_tr_b16 a[184:185], v62 offset:4096
    ds_read_b64_tr_b16 a[186:187], v62 offset:4608
    ds_read_b64_tr_b16 a[188:189], v63 offset:4096
    ds_read_b64_tr_b16 a[190:191], v63 offset:4608
    s_add_u32 m0, s42, 131072
    s_nop 0
    buffer_load_dwordx4 v48, s[12:15], s54 offen lds
    s_add_u32 m0, s42, 132096
    s_nop 0
    buffer_load_dwordx4 v49, s[12:15], s54 offen lds
    s_add_u32 m0, s42, 139264
    s_nop 0
    buffer_load_dwordx4 v50, s[12:15], s54 offen lds
    s_add_u32 m0, s42, 140288
    s_nop 0
    buffer_load_dwordx4 v51, s[12:15], s54 offen lds
    s_add_u32 m0, s42, 147456
    s_nop 0
    buffer_load_dwordx4 v52, s[12:15], s54 offen lds
    s_add_u32 m0, s42, 148480
    s_nop 0
    buffer_load_dwordx4 v53, s[12:15], s54 offen lds
    s_add_u32 m0, s42, 155648
    s_nop 0
    buffer_load_dwordx4 v54, s[12:15], s54 offen lds
    s_add_u32 m0, s42, 156672
    s_nop 0
    buffer_load_dwordx4 v55, s[12:15], s54 offen lds
    s_add_u32 s54, s54, 131072
    s_waitcnt lgkmcnt(0)
    v_add_u32 v60, 32768, v56
    v_add_u32 v61, 32768, v57
    v_add_u32 v62, 32768, v58
    v_add_u32 v63, 32768, v59
    s_waitcnt vmcnt(24)
    s_barrier
    ds_read_b64_tr_b16 a[192:193], v60 offset:0
    ds_read_b64_tr_b16 a[194:195], v60 offset:512
    ds_read_b64_tr_b16 a[196:197], v61 offset:0
    ds_read_b64_tr_b16 a[198:199], v61 offset:512
    ds_read_b64_tr_b16 a[200:201], v62 offset:0
    ds_read_b64_tr_b16 a[202:203], v62 offset:512
    ds_read_b64_tr_b16 a[204:205], v63 offset:0
    ds_read_b64_tr_b16 a[206:207], v63 offset:512
    ds_read_b64_tr_b16 a[208:209], v60 offset:4096
    ds_read_b64_tr_b16 a[210:211], v60 offset:4608
    ds_read_b64_tr_b16 a[212:213], v61 offset:4096
    ds_read_b64_tr_b16 a[214:215], v61 offset:4608
    ds_read_b64_tr_b16 a[216:217], v62 offset:4096
    ds_read_b64_tr_b16 a[218:219], v62 offset:4608
    ds_read_b64_tr_b16 a[220:221], v63 offset:4096
    ds_read_b64_tr_b16 a[222:223], v63 offset:4608
    s_add_u32 m0, s42, 0
    s_nop 0
    buffer_load_dwordx4 v48, s[12:15], s54 offen lds
    s_add_u32 m0, s42, 1024
    s_nop 0
    buffer_load_dwordx4 v49, s[12:15], s54 offen lds
    s_add_u32 m0, s42, 8192
    s_nop 0
    buffer_load_dwordx4 v50, s[12:15], s54 offen lds
    s_add_u32 m0, s42, 9216
    s_nop 0
    buffer_load_dwordx4 v51, s[12:15], s54 offen lds
    s_add_u32 m0, s42, 16384
    s_nop 0
    buffer_load_dwordx4 v52, s[12:15], s54 offen lds
    s_add_u32 m0, s42, 17408
    s_nop 0
    buffer_load_dwordx4 v53, s[12:15], s54 offen lds
    s_add_u32 m0, s42, 24576
    s_nop 0
    buffer_load_dwordx4 v54, s[12:15], s54 offen lds
    s_add_u32 m0, s42, 25600
    s_nop 0
    buffer_load_dwordx4 v55, s[12:15], s54 offen lds
    s_add_u32 s54, s54, 131072
    s_waitcnt lgkmcnt(0)
    v_add_u32 v60, 65536, v56
    v_add_u32 v61, 65536, v57
    v_add_u32 v62, 65536, v58
    v_add_u32 v63, 65536, v59
    s_waitcnt vmcnt(24)
    s_barrier
    ds_read_b64_tr_b16 a[224:225], v60 offset:0
    ds_read_b64_tr_b16 a[226:227], v60 offset:512
    ds_read_b64_tr_b16 a[228:229], v61 offset:0
    ds_read_b64_tr_b16 a[230:231], v61 offset:512
    ds_read_b64_tr_b16 a[232:233], v62 offset:0
    ds_read_b64_tr_b16 a[234:235], v62 offset:512
    ds_read_b64_tr_b16 a[236:237], v63 offset:0
    ds_read_b64_tr_b16 a[238:239], v63 offset:512
    ds_read_b64_tr_b16 a[240:241], v60 offset:4096
    ds_read_b64_tr_b16 a[242:243], v60 offset:4608
    ds_read_b64_tr_b16 a[244:245], v61 offset:4096
    ds_read_b64_tr_b16 a[246:247], v61 offset:4608
    ds_read_b64_tr_b16 a[248:249], v62 offset:4096
    ds_read_b64_tr_b16 a[250:251], v62 offset:4608
    ds_read_b64_tr_b16 a[252:253], v63 offset:4096
    ds_read_b64_tr_b16 a[254:255], v63 offset:4608
    s_waitcnt lgkmcnt(0)
    v_add_u32 v60, 98304, v56
    v_add_u32 v61, 98304, v57
    v_add_u32 v62, 98304, v58
    v_add_u32 v63, 98304, v59
    s_waitcnt vmcnt(16)
    s_barrier
    ds_read_b64_tr_b16 v[160:161], v60 offset:0
    ds_read_b64_tr_b16 v[162:163], v60 offset:512
    ds_read_b64_tr_b16 v[164:165], v61 offset:0
    ds_read_b64_tr_b16 v[166:167], v61 offset:512
    ds_read_b64_tr_b16 v[168:169], v62 offset:0
    ds_read_b64_tr_b16 v[170:171], v62 offset:512
    ds_read_b64_tr_b16 v[172:173], v63 offset:0
    ds_read_b64_tr_b16 v[174:175], v63 offset:512
    ds_read_b64_tr_b16 v[176:177], v60 offset:4096
    ds_read_b64_tr_b16 v[178:179], v60 offset:4608
    ds_read_b64_tr_b16 v[180:181], v61 offset:4096
    ds_read_b64_tr_b16 v[182:183], v61 offset:4608
    ds_read_b64_tr_b16 v[184:185], v62 offset:4096
    ds_read_b64_tr_b16 v[186:187], v62 offset:4608
    ds_read_b64_tr_b16 v[188:189], v63 offset:4096
    ds_read_b64_tr_b16 v[190:191], v63 offset:4608
    s_waitcnt lgkmcnt(0)
    v_add_u32 v60, 131072, v56
    v_add_u32 v61, 131072, v57
    v_add_u32 v62, 131072, v58
    v_add_u32 v63, 131072, v59
    s_waitcnt vmcnt(8)
    s_barrier
    ds_read_b64_tr_b16 v[192:193], v60 offset:0
    ds_read_b64_tr_b16 v[194:195], v60 offset:512
    ds_read_b64_tr_b16 v[196:197], v61 offset:0
    ds_read_b64_tr_b16 v[198:199], v61 offset:512
    ds_read_b64_tr_b16 v[200:201], v62 offset:0
    ds_read_b64_tr_b16 v[202:203], v62 offset:512
    ds_read_b64_tr_b16 v[204:205], v63 offset:0
    ds_read_b64_tr_b16 v[206:207], v63 offset:512
    ds_read_b64_tr_b16 v[208:209], v60 offset:4096
    ds_read_b64_tr_b16 v[210:211], v60 offset:4608
    ds_read_b64_tr_b16 v[212:213], v61 offset:4096
    ds_read_b64_tr_b16 v[214:215], v61 offset:4608
    ds_read_b64_tr_b16 v[216:217], v62 offset:4096
    ds_read_b64_tr_b16 v[218:219], v62 offset:4608
    ds_read_b64_tr_b16 v[220:221], v63 offset:4096
    ds_read_b64_tr_b16 v[222:223], v63 offset:4608
    s_waitcnt lgkmcnt(0)
    v_add_u32 v60, 0, v56
    v_add_u32 v61, 0, v57
    v_add_u32 v62, 0, v58
    v_add_u32 v63, 0, v59
    s_waitcnt vmcnt(0)
    s_barrier
    ds_read_b64_tr_b16 v[224:225], v60 offset:0
    ds_read_b64_tr_b16 v[226:227], v60 offset:512
    ds_read_b64_tr_b16 v[228:229], v61 offset:0
    ds_read_b64_tr_b16 v[230:231], v61 offset:512
    ds_read_b64_tr_b16 v[232:233], v62 offset:0
    ds_read_b64_tr_b16 v[234:235], v62 offset:512
    ds_read_b64_tr_b16 v[236:237], v63 offset:0
    ds_read_b64_tr_b16 v[238:239], v63 offset:512
    ds_read_b64_tr_b16 v[240:241], v60 offset:4096
    ds_read_b64_tr_b16 v[242:243], v60 offset:4608
    ds_read_b64_tr_b16 v[244:245], v61 offset:4096
    ds_read_b64_tr_b16 v[246:247], v61 offset:4608
    ds_read_b64_tr_b16 v[248:249], v62 offset:4096
    ds_read_b64_tr_b16 v[250:251], v62 offset:4608
    ds_read_b64_tr_b16 v[252:253], v63 offset:4096
    ds_read_b64_tr_b16 v[254:255], v63 offset:4608
    s_waitcnt lgkmcnt(0)
    s_barrier
    s_mov_b32 s37, 0xffff0000
    v_lshlrev_b32 v112, 16, v24
    v_and_b32 v113, s37, v24
    v_lshlrev_b32 v114, 16, v25
    v_and_b32 v115, s37, v25
    v_lshlrev_b32 v116, 16, v26
    v_and_b32 v117, s37, v26
    v_lshlrev_b32 v118, 16, v27
    v_and_b32 v119, s37, v27
    s_cmp_lg_u32 s32, 0
    s_cbranch_scc1 L_arv38
    s_add_u32 s20, s82, 0x80
    s_addc_u32 s21, s83, 0
    s_mov_b32 s22, 0x4
    s_mov_b32 s23, 0x00020000
    buffer_load_dword v80, v124, s[20:23], 0 offen sc1
    s_waitcnt vmcnt(0)
    v_cmp_eq_u32 vcc, v124, v80
    s_cbranch_vccnz L_spin39
L_back40:
L_arv38:
    s_add_u32 s96, s41, 8126464
    s_mov_b32 s98, s41
    s_mov_b32 s45, 0x5560000
    buffer_load_dword v96, v6, s[16:19], s45 offen sc1
    s_waitcnt vmcnt(0)
    v_cmp_ne_u32 vcc, 0, v96
    s_cbranch_vccnz L_spin41
L_back42:
    s_barrier
    s_add_u32 m0, s43, 0
    s_add_u32 s42, s41, 0
    buffer_load_dwordx4 v1, s[16:19], s42 offen offset:0 sc1 lds
    buffer_load_dwordx4 v1, s[16:19], s42 offen offset:1024 sc1 lds
    buffer_load_dwordx4 v1, s[16:19], s42 offen offset:2048 sc1 lds
    s_add_u32 m0, s43, 12288
    s_add_u32 s42, s41, 12288
    buffer_load_dwordx4 v1, s[16:19], s42 offen offset:0 sc1 lds
    buffer_load_dwordx4 v1, s[16:19], s42 offen offset:1024 sc1 lds
    buffer_load_dwordx4 v1, s[16:19], s42 offen offset:2048 sc1 lds
    s_add_u32 m0, s43, 24576
    s_add_u32 s42, s41, 24576
    buffer_load_dwordx4 v1, s[16:19], s42 offen offset:0 sc1 lds
    buffer_load_dwordx4 v1, s[16:19], s42 offen offset:1024 sc1 lds
    buffer_load_dwordx4 v1, s[16:19], s42 offen offset:2048 sc1 lds
    s_add_u32 s45, s45, 131072
    s_waitcnt vmcnt(0) lgkmcnt(0)
    s_barrier
    s_mov_b32 s52, 0x5e00000
    s_mov_b32 s46, 0x5e00000
    s_add_u32 s20, s84, 0x5e00000
    s_addc_u32 s21, s85, 0
    s_mov_b32 s22, 0x400000
    s_mov_b32 s23, 0x00020000
    ds_read_b128 v[80:83], v2 offset:0
    ds_read_b128 v[84:87], v3 offset:0
    s_mov_b32 s36, 0
    s_waitcnt lgkmcnt(0)
    s_nop 7
L_bf_b0:
    s_waitcnt lgkmcnt(0)
    v_mfma_f32_16x16x32_bf16 v[16:19], a[0:3], v[80:83], v[112:115]
    s_sub_u32 s47, s45, 393216
    ds_read_b128 v[88:91], v2 offset:2048
    v_mfma_f32_16x16x32_bf16 v[24:27], a[0:3], v[84:87], 0
    buffer_load_dword v13, v8, s[16:19], s47 offen sc1
    v_mfma_f32_16x16x32_bf16 v[28:31], a[4:7], v[84:87], 0
    s_and_b32 s38, s53, 0xffffffff
    ds_read_b128 v[92:95], v3 offset:2048
    s_cmp_eq_u32 s36, 0
    v_mfma_f32_16x16x32_bf16 v[20:23], a[4:7], v[80:83], v[116:119]
    s_cselect_b32 s38, 0x5e00000, s38
    v_mfma_f32_16x16x32_bf16 v[32:35], a[8:11], v[80:83], 0
    buffer_load_dwordx4 v[136:139], v1, s[16:19], s38 offen sc1
    v_mfma_f32_16x16x32_bf16 v[40:43], a[8:11], v[84:87], 0
    s_add_u32 s53, s53, 65536
    ds_read_b128 v[144:147], v11 offset:0
    s_and_b32 s44, s90, 0xffffffff
    v_mfma_f32_16x16x32_bf16 v[44:47], a[12:15], v[84:87], 0
    s_cmp_eq_u32 s36, 0
    s_cselect_b32 s44, 0x5e00000, s44
    s_xor_b32 s49, s44, 16384
    v_mfma_f32_16x16x32_bf16 v[36:39], a[12:15], v[80:83], 0
    s_waitcnt lgkmcnt(1)
    v_cvt_pk_bf16_f32 v56, v56, v57
    v_cvt_pk_bf16_f32 v57, v58, v59
    v_mfma_f32_16x16x32_bf16 v[16:19], a[16:19], v[88:91], v[16:19]
    ds_read_b128 v[80:83], v2 offset:4096
    v_cvt_pk_bf16_f32 v58, v60, v61
    v_mfma_f32_16x16x32_bf16 v[24:27], a[16:19], v[92:95], v[24:27]
    v_cvt_pk_bf16_f32 v59, v62, v63
    v_mfma_f32_16x16x32_bf16 v[28:31], a[20:23], v[92:95], v[28:31]
    s_waitcnt lgkmcnt(1)
    ds_read_b128 v[84:87], v3 offset:4096
    v_add_f32 v144, v144, v145
    v_mfma_f32_16x16x32_bf16 v[20:23], a[20:23], v[88:91], v[20:23]
    buffer_store_dwordx4 v[56:59], v1, s[16:19], s49 offen offset:0 sc1
    v_mfma_f32_16x16x32_bf16 v[32:35], a[24:27], v[88:91], v[32:35]
    s_xor_b32 s49, s44, 32768
    v_cvt_pk_bf16_f32 v64, v64, v65
    v_cvt_pk_bf16_f32 v65, v66, v67
    v_mfma_f32_16x16x32_bf16 v[40:43], a[24:27], v[92:95], v[40:43]
    v_cvt_pk_bf16_f32 v66, v68, v69
    v_cvt_pk_bf16_f32 v67, v70, v71
    v_mfma_f32_16x16x32_bf16 v[44:47], a[28:31], v[92:95], v[44:47]
    buffer_store_dwordx4 v[64:67], v1, s[16:19], s49 offen offset:1024 sc1
    v_mfma_f32_16x16x32_bf16 v[36:39], a[28:31], v[88:91], v[36:39]
    s_waitcnt lgkmcnt(0)
    v_add_f32 v146, v146, v147
    v_add_f32 v144, v144, v146
    v_mfma_f32_16x16x32_bf16 v[16:19], a[32:35], v[80:83], v[16:19]
    s_xor_b32 s49, s44, 49152
    ds_read_b128 v[88:91], v2 offset:6144
    v_cvt_pk_bf16_f32 v72, v72, v73
    v_mfma_f32_16x16x32_bf16 v[24:27], a[32:35], v[84:87], v[24:27]
    s_add_u32 m0, s88, 36864
    v_cvt_pk_bf16_f32 v73, v74, v75
    v_cvt_pk_bf16_f32 v74, v76, v77
    v_mfma_f32_16x16x32_bf16 v[28:31], a[36:39], v[84:87], v[28:31]
    s_add_u32 s42, s41, 36864
    ds_read_b128 v[92:95], v3 offset:6144
    v_cvt_pk_bf16_f32 v75, v78, v79
    v_mfma_f32_16x16x32_bf16 v[20:23], a[36:39], v[80:83], v[20:23]
    buffer_store_dwordx4 v[72:75], v1, s[16:19], s49 offen offset:2048 sc1
    v_mfma_f32_16x16x32_bf16 v[32:35], a[40:43], v[80:83], v[32:35]
    s_add_u32 s42, s42, s89
    s_add_u32 s90, s90, 262144
    v_mfma_f32_16x16x32_bf16 v[40:43], a[40:43], v[84:87], v[40:43]
    v_mfma_f32_16x16x32_bf16 v[44:47], a[44:47], v[84:87], v[44:47]
    buffer_load_dwordx4 v1, s[16:19], s42 offen offset:0 sc1 lds
    v_mfma_f32_16x16x32_bf16 v[36:39], a[44:47], v[80:83], v[36:39]
    s_waitcnt lgkmcnt(0)
    v_mfma_f32_16x16x32_bf16 v[16:19], a[48:51], v[88:91], v[16:19]
    ds_read_b128 v[80:83], v2 offset:8192
    v_mfma_f32_16x16x32_bf16 v[24:27], a[48:51], v[92:95], v[24:27]
    buffer_store_dword v144, v12, s[16:19], s46 offen sc1
    v_mfma_f32_16x16x32_bf16 v[28:31], a[52:55], v[92:95], v[28:31]
    ds_read_b128 v[84:87], v3 offset:8192
    v_mfma_f32_16x16x32_bf16 v[20:23], a[52:55], v[88:91], v[20:23]
    v_mfma_f32_16x16x32_bf16 v[32:35], a[56:59], v[88:91], v[32:35]
    buffer_load_dwordx4 v1, s[16:19], s42 offen offset:1024 sc1 lds
    v_mfma_f32_16x16x32_bf16 v[40:43], a[56:59], v[92:95], v[40:43]
    s_add_u32 s98, s98, 262144
    s_min_u32 s98, s98, s96
    s_and_b32 s41, s98, 0xffffffff
    v_mfma_f32_16x16x32_bf16 v[44:47], a[60:63], v[92:95], v[44:47]
    v_mfma_f32_16x16x32_bf16 v[36:39], a[60:63], v[88:91], v[36:39]
    s_waitcnt lgkmcnt(0)
    v_mfma_f32_16x16x32_bf16 v[16:19], a[64:67], v[80:83], v[16:19]
    ds_read_b128 v[88:91], v2 offset:10240
    v_mfma_f32_16x16x32_bf16 v[24:27], a[64:67], v[84:87], v[24:27]
    v_mfma_f32_16x16x32_bf16 v[28:31], a[68:71], v[84:87], v[28:31]
    ds_read_b128 v[92:95], v3 offset:10240
    v_mfma_f32_16x16x32_bf16 v[20:23], a[68:71], v[80:83], v[20:23]
    s_waitcnt vmcnt(7)
    v_cmp_ne_u32 vcc, 0, v13
    v_mfma_f32_16x16x32_bf16 v[32:35], a[72:75], v[80:83], v[32:35]
    v_mfma_f32_16x16x32_bf16 v[40:43], a[72:75], v[84:87], v[40:43]
    s_cbranch_vccnz L_spin43
L_back44:
    v_mfma_f32_16x16x32_bf16 v[44:47], a[76:79], v[84:87], v[44:47]
    v_mfma_f32_16x16x32_bf16 v[36:39], a[76:79], v[80:83], v[36:39]
    s_waitcnt vmcnt(8) lgkmcnt(0)
    s_barrier
    v_mfma_f32_16x16x32_bf16 v[16:19], a[80:83], v[88:91], v[16:19]
    s_sub_u32 s48, s90, 524288
    ds_read_b128 v[80:83], v2 offset:12288
    s_and_b32 s48, s48, 0xffffffff
    v_mfma_f32_16x16x32_bf16 v[24:27], a[80:83], v[92:95], v[24:27]
    s_cmp_lt_u32 s36, 2
    s_cselect_b32 s48, s52, s48
    v_mfma_f32_16x16x32_bf16 v[28:31], a[84:87], v[92:95], v[28:31]
    ds_read_b128 v[84:87], v3 offset:12288
    v_mfma_f32_16x16x32_bf16 v[20:23], a[84:87], v[88:91], v[20:23]
    buffer_load_dwordx4 v[140:143], v1, s[16:19], s48 offen offset:0 sc1
    v_mfma_f32_16x16x32_bf16 v[32:35], a[88:91], v[88:91], v[32:35]
    v_mfma_f32_16x16x32_bf16 v[40:43], a[88:91], v[92:95], v[40:43]
    v_mfma_f32_16x16x32_bf16 v[44:47], a[92:95], v[92:95], v[44:47]
    buffer_load_dwordx4 v[144:147], v1, s[16:19], s48 offen offset:1024 sc1
    v_mfma_f32_16x16x32_bf16 v[36:39], a[92:95], v[88:91], v[36:39]
    s_waitcnt lgkmcnt(0)
    v_mfma_f32_16x16x32_bf16 v[16:19], a[96:99], v[80:83], v[16:19]
    ds_read_b128 v[88:91], v2 offset:14336
    v_mfma_f32_16x16x32_bf16 v[24:27], a[96:99], v[84:87], v[24:27]
    buffer_load_dwordx4 v[148:151], v1, s[16:19], s48 offen offset:2048 sc1
    v_mfma_f32_16x16x32_bf16 v[28:31], a[100:103], v[84:87], v[28:31]
    ds_read_b128 v[92:95], v3 offset:14336
    v_mfma_f32_16x16x32_bf16 v[20:23], a[100:103], v[80:83], v[20:23]
    v_mfma_f32_16x16x32_bf16 v[32:35], a[104:107], v[80:83], v[32:35]
    buffer_load_dwordx4 v[152:155], v1, s[16:19], s48 offen offset:3072 sc1
    v_mfma_f32_16x16x32_bf16 v[40:43], a[104:107], v[84:87], v[40:43]
    s_sub_u32 s47, s36, 2
    s_cmp_lt_u32 s47, 16
    s_cselect_b32 s48, 0x5000000, s52
    v_mfma_f32_16x16x32_bf16 v[44:47], a[108:111], v[84:87], v[44:47]
    s_add_u32 s20, s84, s48
    s_addc_u32 s21, s85, 0
    s_cmp_ge_i32 s47, 16
    v_mfma_f32_16x16x32_bf16 v[36:39], a[108:111], v[80:83], v[36:39]
    s_waitcnt lgkmcnt(0)
    s_cselect_b32 s20, s80, s20
    s_cselect_b32 s21, s81, s21
    v_mfma_f32_16x16x32_bf16 v[16:19], a[112:115], v[88:91], v[16:19]
    s_and_b32 s48, s47, 15
    ds_read_b128 v[80:83], v2 offset:16384
    s_lshl_b32 s48, s48, 1
    v_mfma_f32_16x16x32_bf16 v[24:27], a[112:115], v[92:95], v[24:27]
    s_sub_u32 s48, s50, s48
    s_lshl_b32 s46, s48, 10
    s_sub_u32 s46, s55, s46
    v_mfma_f32_16x16x32_bf16 v[28:31], a[116:119], v[92:95], v[28:31]
    s_cmp_lt_u32 s47, 16
    ds_read_b128 v[84:87], v3 offset:16384
    s_cselect_b32 s46, s46, s52
    v_mfma_f32_16x16x32_bf16 v[20:23], a[116:119], v[88:91], v[20:23]
    buffer_load_dword v96, v6, s[16:19], s45 offen sc1
    v_mfma_f32_16x16x32_bf16 v[32:35], a[120:123], v[88:91], v[32:35]
    s_add_u32 m0, s43, 98304
    s_add_u32 s42, s41, 0
    s_lshl_b32 s48, s48, 15
    v_mfma_f32_16x16x32_bf16 v[40:43], a[120:123], v[92:95], v[40:43]
    v_mfma_f32_16x16x32_bf16 v[44:47], a[124:127], v[92:95], v[44:47]
    v_mfma_f32_16x16x32_bf16 v[36:39], a[124:127], v[88:91], v[36:39]
    s_waitcnt lgkmcnt(0)
    v_mfma_f32_16x16x32_bf16 v[16:19], a[128:131], v[80:83], v[16:19]
    ds_read_b128 v[88:91], v2 offset:18432
    v_mfma_f32_16x16x32_bf16 v[24:27], a[128:131], v[84:87], v[24:27]
    v_mfma_f32_16x16x32_bf16 v[28:31], a[132:135], v[84:87], v[28:31]
    ds_read_b128 v[92:95], v3 offset:18432
    v_mfma_f32_16x16x32_bf16 v[20:23], a[132:135], v[80:83], v[20:23]
    v_mfma_f32_16x16x32_bf16 v[32:35], a[136:139], v[80:83], v[32:35]
    v_mfma_f32_16x16x32_bf16 v[40:43], a[136:139], v[84:87], v[40:43]
    v_mfma_f32_16x16x32_bf16 v[44:47], a[140:143], v[84:87], v[44:47]
    v_mfma_f32_16x16x32_bf16 v[36:39], a[140:143], v[80:83], v[36:39]
    s_waitcnt lgkmcnt(0)
    v_mfma_f32_16x16x32_bf16 v[16:19], a[144:147], v[88:91], v[16:19]
    ds_read_b128 v[80:83], v2 offset:20480
    v_mfma_f32_16x16x32_bf16 v[24:27], a[144:147], v[92:95], v[24:27]
    v_mfma_f32_16x16x32_bf16 v[28:31], a[148:151], v[92:95], v[28:31]
    ds_read_b128 v[84:87], v3 offset:20480
    v_mfma_f32_16x16x32_bf16 v[20:23], a[148:151], v[88:91], v[20:23]
    v_mfma_f32_16x16x32_bf16 v[32:35], a[152:155], v[88:91], v[32:35]
    v_mfma_f32_16x16x32_bf16 v[40:43], a[152:155], v[92:95], v[40:43]
    v_mfma_f32_16x16x32_bf16 v[44:47], a[156:159], v[92:95], v[44:47]
    v_mfma_f32_16x16x32_bf16 v[36:39], a[156:159], v[88:91], v[36:39]
    s_waitcnt lgkmcnt(0)
    v_mfma_f32_16x16x32_bf16 v[16:19], a[160:163], v[80:83], v[16:19]
    ds_read_b128 v[88:91], v2 offset:22528
    v_mfma_f32_16x16x32_bf16 v[24:27], a[160:163], v[84:87], v[24:27]
    v_mfma_f32_16x16x32_bf16 v[28:31], a[164:167], v[84:87], v[28:31]
    ds_read_b128 v[92:95], v3 offset:22528
    v_mfma_f32_16x16x32_bf16 v[20:23], a[164:167], v[80:83], v[20:23]
    v_mfma_f32_16x16x32_bf16 v[32:35], a[168:171], v[80:83], v[32:35]
    v_mfma_f32_16x16x32_bf16 v[40:43], a[168:171], v[84:87], v[40:43]
    v_mfma_f32_16x16x32_bf16 v[44:47], a[172:175], v[84:87], v[44:47]
    v_mfma_f32_16x16x32_bf16 v[36:39], a[172:175], v[80:83], v[36:39]
    s_waitcnt lgkmcnt(0)
    v_mfma_f32_16x16x32_bf16 v[16:19], a[176:179], v[88:91], v[16:19]
    ds_read_b128 v[80:83], v2 offset:24576
    v_mfma_f32_16x16x32_bf16 v[24:27], a[176:179], v[92:95], v[24:27]
    v_mfma_f32_16x16x32_bf16 v[28:31], a[180:183], v[92:95], v[28:31]
    ds_read_b128 v[84:87], v3 offset:24576
    v_mfma_f32_16x16x32_bf16 v[20:23], a[180:183], v[88:91], v[20:23]
    v_mfma_f32_16x16x32_bf16 v[32:35], a[184:187], v[88:91], v[32:35]
    v_mfma_f32_16x16x32_bf16 v[40:43], a[184:187], v[92:95], v[40:43]
    v_mfma_f32_16x16x32_bf16 v[44:47], a[188:191], v[92:95], v[44:47]
    v_mfma_f32_16x16x32_bf16 v[36:39], a[188:191], v[88:91], v[36:39]
    s_waitcnt lgkmcnt(0)
    v_mfma_f32_16x16x32_bf16 v[16:19], a[192:195], v[80:83], v[16:19]
    ds_read_b128 v[88:91], v2 offset:26624
    v_mfma_f32_16x16x32_bf16 v[24:27], a[192:195], v[84:87], v[24:27]
    v_mfma_f32_16x16x32_bf16 v[28:31], a[196:199], v[84:87], v[28:31]
    ds_read_b128 v[92:95], v3 offset:26624
    v_mfma_f32_16x16x32_bf16 v[20:23], a[196:199], v[80:83], v[20:23]
    v_mfma_f32_16x16x32_bf16 v[32:35], a[200:203], v[80:83], v[32:35]
    v_mfma_f32_16x16x32_bf16 v[40:43], a[200:203], v[84:87], v[40:43]
    v_mfma_f32_16x16x32_bf16 v[44:47], a[204:207], v[84:87], v[44:47]
    v_mfma_f32_16x16x32_bf16 v[36:39], a[204:207], v[80:83], v[36:39]
    s_waitcnt lgkmcnt(0)
    v_mfma_f32_16x16x32_bf16 v[16:19], a[208:211], v[88:91], v[16:19]
    s_waitcnt vmcnt(0)
    ds_read_b128 v[80:83], v2 offset:28672
    v_cmp_ne_u32 vcc, 0, v96
    v_mfma_f32_16x16x32_bf16 v[24:27], a[208:211], v[92:95], v[24:27]
    v_mfma_f32_16x16x32_bf16 v[28:31], a[212:215], v[92:95], v[28:31]
    s_cbranch_vccnz L_spin45
L_back46:
    ds_read_b128 v[84:87], v3 offset:28672
    s_barrier
    v_mfma_f32_16x16x32_bf16 v[20:23], a[212:215], v[88:91], v[20:23]
    buffer_load_dwordx4 v1, s[16:19], s42 offen offset:0 sc1 lds
    v_mfma_f32_16x16x32_bf16 v[32:35], a[216:219], v[88:91], v[32:35]
    v_mfma_f32_16x16x32_bf16 v[40:43], a[216:219], v[92:95], v[40:43]
    v_mfma_f32_16x16x32_bf16 v[44:47], a[220:223], v[92:95], v[44:47]
    buffer_load_dwordx4 v1, s[16:19], s42 offen offset:1024 sc1 lds
    v_mfma_f32_16x16x32_bf16 v[36:39], a[220:223], v[88:91], v[36:39]
    s_waitcnt lgkmcnt(0)
    v_mfma_f32_16x16x32_bf16 v[16:19], a[224:227], v[80:83], v[16:19]
    ds_read_b128 v[88:91], v2 offset:30720
    v_mfma_f32_16x16x32_bf16 v[24:27], a[224:227], v[84:87], v[24:27]
    buffer_load_dwordx4 v1, s[16:19], s42 offen offset:2048 sc1 lds
    v_mfma_f32_16x16x32_bf16 v[28:31], a[228:231], v[84:87], v[28:31]
    ds_read_b128 v[92:95], v3 offset:30720
    v_mfma_f32_16x16x32_bf16 v[20:23], a[228:231], v[80:83], v[20:23]
    v_mfma_f32_16x16x32_bf16 v[32:35], a[232:235], v[80:83], v[32:35]
    buffer_store_dword v124, v124, s[16:19], s91 offen sc1
    v_mfma_f32_16x16x32_bf16 v[40:43], a[232:235], v[84:87], v[40:43]
    s_add_u32 s91, s91, 131072
    s_add_u32 m0, s43, 110592
    s_add_u32 s42, s41, 12288
    v_mfma_f32_16x16x32_bf16 v[44:47], a[236:239], v[84:87], v[44:47]
    s_add_u32 s39, s91, -327680
    v_mfma_f32_16x16x32_bf16 v[36:39], a[236:239], v[80:83], v[36:39]
    s_waitcnt lgkmcnt(0)
    v_mfma_f32_16x16x32_bf16 v[16:19], a[240:243], v[88:91], v[16:19]
    ds_read_b128 v[80:83], v2 offset:32768
    v_mfma_f32_16x16x32_bf16 v[24:27], a[240:243], v[92:95], v[24:27]
    buffer_store_dword v124, v124, s[16:19], s39 offen sc1
    v_mfma_f32_16x16x32_bf16 v[28:31], a[244:247], v[92:95], v[28:31]
    s_waitcnt vmcnt(6)
    ds_read_b128 v[84:87], v3 offset:32768
    v_mfma_f32_16x16x32_bf16 v[128:131], v[104:107], v[140:143], v[128:131]
    v_mfma_f32_16x16x32_bf16 v[132:135], v[108:111], v[140:143], v[132:135]
    v_mfma_f32_16x16x32_bf16 v[128:131], v[104:107], v[144:147], v[128:131]
    v_mfma_f32_16x16x32_bf16 v[132:135], v[108:111], v[144:147], v[132:135]
    v_mfma_f32_16x16x32_bf16 v[128:131], v[104:107], v[148:151], v[128:131]
    v_mfma_f32_16x16x32_bf16 v[132:135], v[108:111], v[148:151], v[132:135]
    v_mfma_f32_16x16x32_bf16 v[128:131], v[104:107], v[152:155], v[128:131]
    v_mfma_f32_16x16x32_bf16 v[132:135], v[108:111], v[152:155], v[132:135]
    v_mfma_f32_16x16x32_bf16 v[20:23], a[244:247], v[88:91], v[20:23]
    v_mfma_f32_16x16x32_bf16 v[32:35], a[248:251], v[88:91], v[32:35]
    buffer_load_dwordx4 v1, s[16:19], s42 offen offset:0 sc1 lds
    v_mfma_f32_16x16x32_bf16 v[40:43], a[248:251], v[92:95], v[40:43]
    v_cvt_pk_bf16_f32 v140, v128, v129
    v_cvt_pk_bf16_f32 v141, v130, v131
    v_mfma_f32_16x16x32_bf16 v[44:47], a[252:255], v[92:95], v[44:47]
    v_cvt_pk_bf16_f32 v142, v132, v133
    v_cvt_pk_bf16_f32 v143, v134, v135
    v_mfma_f32_16x16x32_bf16 v[36:39], a[252:255], v[88:91], v[36:39]
    s_waitcnt lgkmcnt(0)
    v_mfma_f32_16x16x32_bf16 v[16:19], v[160:163], v[80:83], v[16:19]
    ds_read_b128 v[88:91], v2 offset:34816
    v_mfma_f32_16x16x32_bf16 v[24:27], v[160:163], v[84:87], v[24:27]
    buffer_load_dwordx4 v1, s[16:19], s42 offen offset:1024 sc1 lds
    v_mfma_f32_16x16x32_bf16 v[28:31], v[164:167], v[84:87], v[28:31]
    ds_read_b128 v[92:95], v3 offset:34816
    v_mfma_f32_16x16x32_bf16 v[20:23], v[164:167], v[80:83], v[20:23]
    v_mfma_f32_16x16x32_bf16 v[32:35], v[168:171], v[80:83], v[32:35]
    buffer_store_dwordx4 v[140:143], v9, s[20:23], s48 offen sc1
    v_mfma_f32_16x16x32_bf16 v[40:43], v[168:171], v[84:87], v[40:43]
    v_add_f32 v100, v128, v129
    v_mul_f32 v101, v128, v128
    v_mfma_f32_16x16x32_bf16 v[44:47], v[172:175], v[84:87], v[44:47]
    v_fmac_f32 v101, v129, v129
    v_add_f32 v100, v100, v130
    v_mfma_f32_16x16x32_bf16 v[36:39], v[172:175], v[80:83], v[36:39]
    s_waitcnt lgkmcnt(0)
    v_fmac_f32 v101, v130, v130
    v_add_f32 v100, v100, v131
    v_mfma_f32_16x16x32_bf16 v[16:19], v[176:179], v[88:91], v[16:19]
    ds_read_b128 v[80:83], v2 offset:36864
    v_fmac_f32 v101, v131, v131
    v_mfma_f32_16x16x32_bf16 v[24:27], v[176:179], v[92:95], v[24:27]
    buffer_load_dwordx4 v1, s[16:19], s42 offen offset:2048 sc1 lds
    v_mfma_f32_16x16x32_bf16 v[28:31], v[180:183], v[92:95], v[28:31]
    s_add_u32 m0, s43, 122880
    ds_read_b128 v[84:87], v3 offset:36864
    v_add_f32 v100, v100, v132
    v_mfma_f32_16x16x32_bf16 v[20:23], v[180:183], v[88:91], v[20:23]
    s_add_u32 s42, s41, 24576
    v_fmac_f32 v101, v132, v132
    v_add_f32 v100, v100, v133
    v_mfma_f32_16x16x32_bf16 v[32:35], v[184:187], v[88:91], v[32:35]
    v_fmac_f32 v101, v133, v133
    v_add_f32 v100, v100, v134
    v_mfma_f32_16x16x32_bf16 v[40:43], v[184:187], v[92:95], v[40:43]
    v_fmac_f32 v101, v134, v134
    v_add_f32 v100, v100, v135
    v_mfma_f32_16x16x32_bf16 v[44:47], v[188:191], v[92:95], v[44:47]
    buffer_load_dwordx4 v1, s[16:19], s42 offen offset:0 sc1 lds
    v_mfma_f32_16x16x32_bf16 v[36:39], v[188:191], v[88:91], v[36:39]
    s_waitcnt lgkmcnt(0)
    v_fmac_f32 v101, v135, v135
    v_mfma_f32_16x16x32_bf16 v[16:19], v[192:195], v[80:83], v[16:19]
    ds_read_b128 v[88:91], v2 offset:38912
    v_mfma_f32_16x16x32_bf16 v[24:27], v[192:195], v[84:87], v[24:27]
    v_permlane16_swap_b32 v100, v101
    v_mfma_f32_16x16x32_bf16 v[28:31], v[196:199], v[84:87], v[28:31]
    ds_read_b128 v[92:95], v3 offset:38912
    v_add_f32 v100, v100, v101
    v_mfma_f32_16x16x32_bf16 v[20:23], v[196:199], v[80:83], v[20:23]
    buffer_load_dwordx4 v1, s[16:19], s42 offen offset:1024 sc1 lds
    v_mfma_f32_16x16x32_bf16 v[32:35], v[200:203], v[80:83], v[32:35]
    v_mov_b32 v102, v100
    v_mfma_f32_16x16x32_bf16 v[40:43], v[200:203], v[84:87], v[40:43]
    v_permlane32_swap_b32 v100, v102
    v_mfma_f32_16x16x32_bf16 v[44:47], v[204:207], v[84:87], v[44:47]
    v_add_f32 v100, v100, v102
    v_mfma_f32_16x16x32_bf16 v[36:39], v[204:207], v[80:83], v[36:39]
    s_waitcnt lgkmcnt(0)
    ds_write_b32 v10, v100 offset:512
    v_mfma_f32_16x16x32_bf16 v[16:19], v[208:211], v[88:91], v[16:19]
    s_waitcnt vmcnt(22)
    ds_read_b128 v[80:83], v2 offset:40960
    v_mfma_f32_16x16x32_bf16 v[128:131], v[104:107], v[136:139], v[48:51]
    buffer_load_dwordx4 v1, s[16:19], s42 offen offset:2048 sc1 lds
    v_mfma_f32_16x16x32_bf16 v[24:27], v[208:211], v[92:95], v[24:27]
    v_mfma_f32_16x16x32_bf16 v[132:135], v[108:111], v[136:139], v[52:55]
    s_add_u32 s45, s45, 131072
    v_mfma_f32_16x16x32_bf16 v[28:31], v[212:215], v[92:95], v[28:31]
    ds_read_b128 v[84:87], v3 offset:40960
    v_mfma_f32_16x16x32_bf16 v[20:23], v[212:215], v[88:91], v[20:23]
    v_mfma_f32_16x16x32_bf16 v[32:35], v[216:219], v[88:91], v[32:35]
    v_mfma_f32_16x16x32_bf16 v[40:43], v[216:219], v[92:95], v[40:43]
    v_mfma_f32_16x16x32_bf16 v[44:47], v[220:223], v[92:95], v[44:47]
    v_mfma_f32_16x16x32_bf16 v[36:39], v[220:223], v[88:91], v[36:39]
    s_waitcnt lgkmcnt(0)
    v_mfma_f32_16x16x32_bf16 v[16:19], v[224:227], v[80:83], v[16:19]
    ds_read_b128 v[88:91], v2 offset:43008
    v_mfma_f32_16x16x32_bf16 v[24:27], v[224:227], v[84:87], v[24:27]
    v_mfma_f32_16x16x32_bf16 v[28:31], v[228:231], v[84:87], v[28:31]
    ds_read_b128 v[92:95], v3 offset:43008
    v_mfma_f32_16x16x32_bf16 v[20:23], v[228:231], v[80:83], v[20:23]
    v_mfma_f32_16x16x32_bf16 v[32:35], v[232:235], v[80:83], v[32:35]
    v_mfma_f32_16x16x32_bf16 v[40:43], v[232:235], v[84:87], v[40:43]
    v_mfma_f32_16x16x32_bf16 v[44:47], v[236:239], v[84:87], v[44:47]
    v_mfma_f32_16x16x32_bf16 v[36:39], v[236:239], v[80:83], v[36:39]
    s_waitcnt vmcnt(9) lgkmcnt(0)
    s_barrier
    v_mfma_f32_16x16x32_bf16 v[16:19], v[240:243], v[88:91], v[16:19]
    ds_read_b128 v[80:83], v4 offset:0
    v_mfma_f32_16x16x32_bf16 v[24:27], v[240:243], v[92:95], v[24:27]
    v_mfma_f32_16x16x32_bf16 v[28:31], v[244:247], v[92:95], v[28:31]
    ds_read_b128 v[84:87], v5 offset:0
    v_mfma_f32_16x16x32_bf16 v[20:23], v[244:247], v[88:91], v[20:23]
    v_mfma_f32_16x16x32_bf16 v[32:35], v[248:251], v[88:91], v[32:35]
    v_mfma_f32_16x16x32_bf16 v[40:43], v[248:251], v[92:95], v[40:43]
    v_mfma_f32_16x16x32_bf16 v[44:47], v[252:255], v[92:95], v[44:47]
    v_mfma_f32_16x16x32_bf16 v[36:39], v[252:255], v[88:91], v[36:39]
    s_add_u32 s36, s36, 1
L_bf_b1:
    s_waitcnt lgkmcnt(0)
    v_mfma_f32_16x16x32_bf16 v[48:51], a[0:3], v[80:83], v[112:115]
    s_sub_u32 s47, s45, 393216
    ds_read_b128 v[88:91], v4 offset:2048
    v_mfma_f32_16x16x32_bf16 v[56:59], a[0:3], v[84:87], 0
    buffer_load_dword v13, v8, s[16:19], s47 offen sc1
    v_mfma_f32_16x16x32_bf16 v[60:63], a[4:7], v[84:87], 0
    s_and_b32 s38, s53, 0xffffffff
    ds_read_b128 v[92:95], v5 offset:2048
    s_cmp_eq_u32 s36, 0
    v_mfma_f32_16x16x32_bf16 v[52:55], a[4:7], v[80:83], v[116:119]
    s_cselect_b32 s38, 0x5e00000, s38
    v_mfma_f32_16x16x32_bf16 v[64:67], a[8:11], v[80:83], 0
    buffer_load_dwordx4 v[136:139], v1, s[16:19], s38 offen sc1
    v_mfma_f32_16x16x32_bf16 v[72:75], a[8:11], v[84:87], 0
    s_add_u32 s53, s53, 65536
    ds_read_b128 v[144:147], v11 offset:512
    s_and_b32 s44, s90, 0xffffffff
    v_mfma_f32_16x16x32_bf16 v[76:79], a[12:15], v[84:87], 0
    s_cmp_eq_u32 s36, 0
    s_cselect_b32 s44, 0x5e00000, s44
    s_xor_b32 s49, s44, 16384
    v_mfma_f32_16x16x32_bf16 v[68:71], a[12:15], v[80:83], 0
    s_waitcnt lgkmcnt(1)
    v_cvt_pk_bf16_f32 v24, v24, v25
    v_cvt_pk_bf16_f32 v25, v26, v27
    v_mfma_f32_16x16x32_bf16 v[48:51], a[16:19], v[88:91], v[48:51]
    ds_read_b128 v[80:83], v4 offset:4096
    v_cvt_pk_bf16_f32 v26, v28, v29
    v_mfma_f32_16x16x32_bf16 v[56:59], a[16:19], v[92:95], v[56:59]
    v_cvt_pk_bf16_f32 v27, v30, v31
    v_mfma_f32_16x16x32_bf16 v[60:63], a[20:23], v[92:95], v[60:63]
    s_waitcnt lgkmcnt(1)
    ds_read_b128 v[84:87], v5 offset:4096
    v_add_f32 v144, v144, v145
    v_mfma_f32_16x16x32_bf16 v[52:55], a[20:23], v[88:91], v[52:55]
    buffer_store_dwordx4 v[24:27], v1, s[16:19], s49 offen offset:0 sc1
    v_mfma_f32_16x16x32_bf16 v[64:67], a[24:27], v[88:91], v[64:67]
    s_xor_b32 s49, s44, 32768
    v_cvt_pk_bf16_f32 v32, v32, v33
    v_cvt_pk_bf16_f32 v33, v34, v35
    v_mfma_f32_16x16x32_bf16 v[72:75], a[24:27], v[92:95], v[72:75]
    v_cvt_pk_bf16_f32 v34, v36, v37
    v_cvt_pk_bf16_f32 v35, v38, v39
    v_mfma_f32_16x16x32_bf16 v[76:79], a[28:31], v[92:95], v[76:79]
    buffer_store_dwordx4 v[32:35], v1, s[16:19], s49 offen offset:1024 sc1
    v_mfma_f32_16x16x32_bf16 v[68:71], a[28:31], v[88:91], v[68:71]
    s_waitcnt lgkmcnt(0)
    v_add_f32 v146, v146, v147
    v_add_f32 v144, v144, v146
    v_mfma_f32_16x16x32_bf16 v[48:51], a[32:35], v[80:83], v[48:51]
    s_xor_b32 s49, s44, 49152
    ds_read_b128 v[88:91], v4 offset:6144
    v_cvt_pk_bf16_f32 v40, v40, v41
    v_mfma_f32_16x16x32_bf16 v[56:59], a[32:35], v[84:87], v[56:59]
    s_add_u32 m0, s88, 135168
    v_cvt_pk_bf16_f32 v41, v42, v43
    v_cvt_pk_bf16_f32 v42, v44, v45
    v_mfma_f32_16x16x32_bf16 v[60:63], a[36:39], v[84:87], v[60:63]
    s_add_u32 s42, s41, 36864
    ds_read_b128 v[92:95], v5 offset:6144
    v_cvt_pk_bf16_f32 v43, v46, v47
    v_mfma_f32_16x16x32_bf16 v[52:55], a[36:39], v[80:83], v[52:55]
    buffer_store_dwordx4 v[40:43], v1, s[16:19], s49 offen offset:2048 sc1
    v_mfma_f32_16x16x32_bf16 v[64:67], a[40:43], v[80:83], v[64:67]
    s_add_u32 s42, s42, s89
    s_add_u32 s90, s90, 262144
    v_mfma_f32_16x16x32_bf16 v[72:75], a[40:43], v[84:87], v[72:75]
    v_mfma_f32_16x16x32_bf16 v[76:79], a[44:47], v[84:87], v[76:79]
    buffer_load_dwordx4 v1, s[16:19], s42 offen offset:0 sc1 lds
    v_mfma_f32_16x16x32_bf16 v[68:71], a[44:47], v[80:83], v[68:71]
    s_waitcnt lgkmcnt(0)
    v_mfma_f32_16x16x32_bf16 v[48:51], a[48:51], v[88:91], v[48:51]
    ds_read_b128 v[80:83], v4 offset:8192
    v_mfma_f32_16x16x32_bf16 v[56:59], a[48:51], v[92:95], v[56:59]
    buffer_store_dword v144, v12, s[16:19], s46 offen sc1
    v_mfma_f32_16x16x32_bf16 v[60:63], a[52:55], v[92:95], v[60:63]
    ds_read_b128 v[84:87], v5 offset:8192
    v_mfma_f32_16x16x32_bf16 v[52:55], a[52:55], v[88:91], v[52:55]
    v_mfma_f32_16x16x32_bf16 v[64:67], a[56:59], v[88:91], v[64:67]
    buffer_load_dwordx4 v1, s[16:19], s42 offen offset:1024 sc1 lds
    v_mfma_f32_16x16x32_bf16 v[72:75], a[56:59], v[92:95], v[72:75]
    s_add_u32 s98, s98, 262144
    s_min_u32 s98, s98, s96
    s_and_b32 s41, s98, 0xffffffff
    v_mfma_f32_16x16x32_bf16 v[76:79], a[60:63], v[92:95], v[76:79]
    v_mfma_f32_16x16x32_bf16 v[68:71], a[60:63], v[88:91], v[68:71]
    s_waitcnt lgkmcnt(0)
    v_mfma_f32_16x16x32_bf16 v[48:51], a[64:67], v[80:83], v[48:51]
    ds_read_b128 v[88:91], v4 offset:10240
    v_mfma_f32_16x16x32_bf16 v[56:59], a[64:67], v[84:87], v[56:59]
    v_mfma_f32_16x16x32_bf16 v[60:63], a[68:71], v[84:87], v[60:63]
    ds_read_b128 v[92:95], v5 offset:10240
    v_mfma_f32_16x16x32_bf16 v[52:55], a[68:71], v[80:83], v[52:55]
    s_waitcnt vmcnt(7)
    v_cmp_ne_u32 vcc, 0, v13
    v_mfma_f32_16x16x32_bf16 v[64:67], a[72:75], v[80:83], v[64:67]
    v_mfma_f32_16x16x32_bf16 v[72:75], a[72:75], v[84:87], v[72:75]
    s_cbranch_vccnz L_spin47
L_back48:
    v_mfma_f32_16x16x32_bf16 v[76:79], a[76:79], v[84:87], v[76:79]
    v_mfma_f32_16x16x32_bf16 v[68:71], a[76:79], v[80:83], v[68:71]
    s_waitcnt vmcnt(8) lgkmcnt(0)
    s_barrier
    v_mfma_f32_16x16x32_bf16 v[48:51], a[80:83], v[88:91], v[48:51]
    s_sub_u32 s48, s90, 524288
    ds_read_b128 v[80:83], v4 offset:12288
    s_and_b32 s48, s48, 0xffffffff
    v_mfma_f32_16x16x32_bf16 v[56:59], a[80:83], v[92:95], v[56:59]
    s_cmp_lt_u32 s36, 2
    s_cselect_b32 s48, s52, s48
    v_mfma_f32_16x16x32_bf16 v[60:63], a[84:87], v[92:95], v[60:63]
    ds_read_b128 v[84:87], v5 offset:12288
    v_mfma_f32_16x16x32_bf16 v[52:55], a[84:87], v[88:91], v[52:55]
    buffer_load_dwordx4 v[140:143], v1, s[16:19], s48 offen offset:0 sc1
    v_mfma_f32_16x16x32_bf16 v[64:67], a[88:91], v[88:91], v[64:67]
    v_mfma_f32_16x16x32_bf16 v[72:75], a[88:91], v[92:95], v[72:75]
    v_mfma_f32_16x16x32_bf16 v[76:79], a[92:95], v[92:95], v[76:79]
    buffer_load_dwordx4 v[144:147], v1, s[16:19], s48 offen offset:1024 sc1
    v_mfma_f32_16x16x32_bf16 v[68:71], a[92:95], v[88:91], v[68:71]
    s_waitcnt lgkmcnt(0)
    v_mfma_f32_16x16x32_bf16 v[48:51], a[96:99], v[80:83], v[48:51]
    ds_read_b128 v[88:91], v4 offset:14336
    v_mfma_f32_16x16x32_bf16 v[56:59], a[96:99], v[84:87], v[56:59]
    buffer_load_dwordx4 v[148:151], v1, s[16:19], s48 offen offset:2048 sc1
    v_mfma_f32_16x16x32_bf16 v[60:63], a[100:103], v[84:87], v[60:63]
    ds_read_b128 v[92:95], v5 offset:14336
    v_mfma_f32_16x16x32_bf16 v[52:55], a[100:103], v[80:83], v[52:55]
    v_mfma_f32_16x16x32_bf16 v[64:67], a[104:107], v[80:83], v[64:67]
    buffer_load_dwordx4 v[152:155], v1, s[16:19], s48 offen offset:3072 sc1
    v_mfma_f32_16x16x32_bf16 v[72:75], a[104:107], v[84:87], v[72:75]
    s_sub_u32 s47, s36, 2
    s_cmp_lt_u32 s47, 16
    s_cselect_b32 s48, 0x5000000, s52
    v_mfma_f32_16x16x32_bf16 v[76:79], a[108:111], v[84:87], v[76:79]
    s_add_u32 s20, s84, s48
    s_addc_u32 s21, s85, 0
    s_cmp_ge_i32 s47, 16
    v_mfma_f32_16x16x32_bf16 v[68:71], a[108:111], v[80:83], v[68:71]
    s_waitcnt lgkmcnt(0)
    s_cselect_b32 s20, s80, s20
    s_cselect_b32 s21, s81, s21
    v_mfma_f32_16x16x32_bf16 v[48:51], a[112:115], v[88:91], v[48:51]
    s_and_b32 s48, s47, 15
    ds_read_b128 v[80:83], v4 offset:16384
    s_lshl_b32 s48, s48, 1
    v_mfma_f32_16x16x32_bf16 v[56:59], a[112:115], v[92:95], v[56:59]
    s_sub_u32 s48, s50, s48
    s_lshl_b32 s46, s48, 10
    s_sub_u32 s46, s55, s46
    v_mfma_f32_16x16x32_bf16 v[60:63], a[116:119], v[92:95], v[60:63]
    s_cmp_lt_u32 s47, 16
    ds_read_b128 v[84:87], v5 offset:16384
    s_cselect_b32 s46, s46, s52
    v_mfma_f32_16x16x32_bf16 v[52:55], a[116:119], v[88:91], v[52:55]
    buffer_load_dword v96, v6, s[16:19], s45 offen sc1
    v_mfma_f32_16x16x32_bf16 v[64:67], a[120:123], v[88:91], v[64:67]
    s_add_u32 m0, s43, 0
    s_add_u32 s42, s41, 0
    s_lshl_b32 s48, s48, 15
    v_mfma_f32_16x16x32_bf16 v[72:75], a[120:123], v[92:95], v[72:75]
    v_mfma_f32_16x16x32_bf16 v[76:79], a[124:127], v[92:95], v[76:79]
    v_mfma_f32_16x16x32_bf16 v[68:71], a[124:127], v[88:91], v[68:71]
    s_waitcnt lgkmcnt(0)
    v_mfma_f32_16x16x32_bf16 v[48:51], a[128:131], v[80:83], v[48:51]
    ds_read_b128 v[88:91], v4 offset:18432
    v_mfma_f32_16x16x32_bf16 v[56:59], a[128:131], v[84:87], v[56:59]
    v_mfma_f32_16x16x32_bf16 v[60:63], a[132:135], v[84:87], v[60:63]
    ds_read_b128 v[92:95], v5 offset:18432
    v_mfma_f32_16x16x32_bf16 v[52:55], a[132:135], v[80:83], v[52:55]
    v_mfma_f32_16x16x32_bf16 v[64:67], a[136:139], v[80:83], v[64:67]
    v_mfma_f32_16x16x32_bf16 v[72:75], a[136:139], v[84:87], v[72:75]
    v_mfma_f32_16x16x32_bf16 v[76:79], a[140:143], v[84:87], v[76:79]
    v_mfma_f32_16x16x32_bf16 v[68:71], a[140:143], v[80:83], v[68:71]
    s_waitcnt lgkmcnt(0)
    v_mfma_f32_16x16x32_bf16 v[48:51], a[144:147], v[88:91], v[48:51]
    ds_read_b128 v[80:83], v4 offset:20480
    v_mfma_f32_16x16x32_bf16 v[56:59], a[144:147], v[92:95], v[56:59]
    v_mfma_f32_16x16x32_bf16 v[60:63], a[148:151], v[92:95], v[60:63]
    ds_read_b128 v[84:87], v5 offset:20480
    v_mfma_f32_16x16x32_bf16 v[52:55], a[148:151], v[88:91], v[52:55]
    v_mfma_f32_16x16x32_bf16 v[64:67], a[152:155], v[88:91], v[64:67]
    v_mfma_f32_16x16x32_bf16 v[72:75], a[152:155], v[92:95], v[72:75]
    v_mfma_f32_16x16x32_bf16 v[76:79], a[156:159], v[92:95], v[76:79]
    v_mfma_f32_16x16x32_bf16 v[68:71], a[156:159], v[88:91], v[68:71]
    s_waitcnt lgkmcnt(0)
    v_mfma_f32_16x16x32_bf16 v[48:51], a[160:163], v[80:83], v[48:51]
    ds_read_b128 v[88:91], v4 offset:22528
    v_mfma_f32_16x16x32_bf16 v[56:59], a[160:163], v[84:87], v[56:59]
    v_mfma_f32_16x16x32_bf16 v[60:63], a[164:167], v[84:87], v[60:63]
    ds_read_b128 v[92:95], v5 offset:22528
    v_mfma_f32_16x16x32_bf16 v[52:55], a[164:167], v[80:83], v[52:55]
    v_mfma_f32_16x16x32_bf16 v[64:67], a[168:171], v[80:83], v[64:67]
    v_mfma_f32_16x16x32_bf16 v[72:75], a[168:171], v[84:87], v[72:75]
    v_mfma_f32_16x16x32_bf16 v[76:79], a[172:175], v[84:87], v[76:79]
    v_mfma_f32_16x16x32_bf16 v[68:71], a[172:175], v[80:83], v[68:71]
    s_waitcnt lgkmcnt(0)
    v_mfma_f32_16x16x32_bf16 v[48:51], a[176:179], v[88:91], v[48:51]
    ds_read_b128 v[80:83], v4 offset:24576
    v_mfma_f32_16x16x32_bf16 v[56:59], a[176:179], v[92:95], v[56:59]
    v_mfma_f32_16x16x32_bf16 v[60:63], a[180:183], v[92:95], v[60:63]
    ds_read_b128 v[84:87], v5 offset:24576
    v_mfma_f32_16x16x32_bf16 v[52:55], a[180:183], v[88:91], v[52:55]
    v_mfma_f32_16x16x32_bf16 v[64:67], a[184:187], v[88:91], v[64:67]
    v_mfma_f32_16x16x32_bf16 v[72:75], a[184:187], v[92:95], v[72:75]
    v_mfma_f32_16x16x32_bf16 v[76:79], a[188:191], v[92:95], v[76:79]
    v_mfma_f32_16x16x32_bf16 v[68:71], a[188:191], v[88:91], v[68:71]
    s_waitcnt lgkmcnt(0)
    v_mfma_f32_16x16x32_bf16 v[48:51], a[192:195], v[80:83], v[48:51]
    ds_read_b128 v[88:91], v4 offset:26624
    v_mfma_f32_16x16x32_bf16 v[56:59], a[192:195], v[84:87], v[56:59]
    v_mfma_f32_16x16x32_bf16 v[60:63], a[196:199], v[84:87], v[60:63]
    ds_read_b128 v[92:95], v5 offset:26624
    v_mfma_f32_16x16x32_bf16 v[52:55], a[196:199], v[80:83], v[52:55]
    v_mfma_f32_16x16x32_bf16 v[64:67], a[200:203], v[80:83], v[64:67]
    v_mfma_f32_16x16x32_bf16 v[72:75], a[200:203], v[84:87], v[72:75]
    v_mfma_f32_16x16x32_bf16 v[76:79], a[204:207], v[84:87], v[76:79]
    v_mfma_f32_16x16x32_bf16 v[68:71], a[204:207], v[80:83], v[68:71]
    s_waitcnt lgkmcnt(0)
    v_mfma_f32_16x16x32_bf16 v[48:51], a[208:211], v[88:91], v[48:51]
    s_waitcnt vmcnt(0)
    ds_read_b128 v[80:83], v4 offset:28672
    v_cmp_ne_u32 vcc, 0, v96
    v_mfma_f32_16x16x32_bf16 v[56:59], a[208:211], v[92:95], v[56:59]
    v_mfma_f32_16x16x32_bf16 v[60:63], a[212:215], v[92:95], v[60:63]
    s_cbranch_vccnz L_spin49
L_back50:
    ds_read_b128 v[84:87], v5 offset:28672
    s_barrier
    v_mfma_f32_16x16x32_bf16 v[52:55], a[212:215], v[88:91], v[52:55]
    buffer_load_dwordx4 v1, s[16:19], s42 offen offset:0 sc1 lds
    v_mfma_f32_16x16x32_bf16 v[64:67], a[216:219], v[88:91], v[64:67]
    v_mfma_f32_16x16x32_bf16 v[72:75], a[216:219], v[92:95], v[72:75]
    v_mfma_f32_16x16x32_bf16 v[76:79], a[220:223], v[92:95], v[76:79]
    buffer_load_dwordx4 v1, s[16:19], s42 offen offset:1024 sc1 lds
    v_mfma_f32_16x16x32_bf16 v[68:71], a[220:223], v[88:91], v[68:71]
    s_waitcnt lgkmcnt(0)
    v_mfma_f32_16x16x32_bf16 v[48:51], a[224:227], v[80:83], v[48:51]
    ds_read_b128 v[88:91], v4 offset:30720
    v_mfma_f32_16x16x32_bf16 v[56:59], a[224:227], v[84:87], v[56:59]
    buffer_load_dwordx4 v1, s[16:19], s42 offen offset:2048 sc1 lds
    v_mfma_f32_16x16x32_bf16 v[60:63], a[228:231], v[84:87], v[60:63]
    ds_read_b128 v[92:95], v5 offset:30720
    v_mfma_f32_16x16x32_bf16 v[52:55], a[228:231], v[80:83], v[52:55]
    v_mfma_f32_16x16x32_bf16 v[64:67], a[232:235], v[80:83], v[64:67]
    buffer_store_dword v124, v124, s[16:19], s91 offen sc1
    v_mfma_f32_16x16x32_bf16 v[72:75], a[232:235], v[84:87], v[72:75]
    s_add_u32 s91, s91, 131072
    s_add_u32 m0, s43, 12288
    s_add_u32 s42, s41, 12288
    v_mfma_f32_16x16x32_bf16 v[76:79], a[236:239], v[84:87], v[76:79]
    s_add_u32 s39, s91, -327680
    v_mfma_f32_16x16x32_bf16 v[68:71], a[236:239], v[80:83], v[68:71]
    s_waitcnt lgkmcnt(0)
    v_mfma_f32_16x16x32_bf16 v[48:51], a[240:243], v[88:91], v[48:51]
    ds_read_b128 v[80:83], v4 offset:32768
    v_mfma_f32_16x16x32_bf16 v[56:59], a[240:243], v[92:95], v[56:59]
    buffer_store_dword v124, v124, s[16:19], s39 offen sc1
    v_mfma_f32_16x16x32_bf16 v[60:63], a[244:247], v[92:95], v[60:63]
    s_waitcnt vmcnt(6)
    ds_read_b128 v[84:87], v5 offset:32768
    v_mfma_f32_16x16x32_bf16 v[128:131], v[104:107], v[140:143], v[128:131]
    v_mfma_f32_16x16x32_bf16 v[132:135], v[108:111], v[140:143], v[132:135]
    v_mfma_f32_16x16x32_bf16 v[128:131], v[104:107], v[144:147], v[128:131]
    v_mfma_f32_16x16x32_bf16 v[132:135], v[108:111], v[144:147], v[132:135]
    v_mfma_f32_16x16x32_bf16 v[128:131], v[104:107], v[148:151], v[128:131]
    v_mfma_f32_16x16x32_bf16 v[132:135], v[108:111], v[148:151], v[132:135]
    v_mfma_f32_16x16x32_bf16 v[128:131], v[104:107], v[152:155], v[128:131]
    v_mfma_f32_16x16x32_bf16 v[132:135], v[108:111], v[152:155], v[132:135]
    v_mfma_f32_16x16x32_bf16 v[52:55], a[244:247], v[88:91], v[52:55]
    v_mfma_f32_16x16x32_bf16 v[64:67], a[248:251], v[88:91], v[64:67]
    buffer_load_dwordx4 v1, s[16:19], s42 offen offset:0 sc1 lds
    v_mfma_f32_16x16x32_bf16 v[72:75], a[248:251], v[92:95], v[72:75]
    v_cvt_pk_bf16_f32 v140, v128, v129
    v_cvt_pk_bf16_f32 v141, v130, v131
    v_mfma_f32_16x16x32_bf16 v[76:79], a[252:255], v[92:95], v[76:79]
    v_cvt_pk_bf16_f32 v142, v132, v133
    v_cvt_pk_bf16_f32 v143, v134, v135
    v_mfma_f32_16x16x32_bf16 v[68:71], a[252:255], v[88:91], v[68:71]
    s_waitcnt lgkmcnt(0)
    v_mfma_f32_16x16x32_bf16 v[48:51], v[160:163], v[80:83], v[48:51]
    ds_read_b128 v[88:91], v4 offset:34816
    v_mfma_f32_16x16x32_bf16 v[56:59], v[160:163], v[84:87], v[56:59]
    buffer_load_dwordx4 v1, s[16:19], s42 offen offset:1024 sc1 lds
    v_mfma_f32_16x16x32_bf16 v[60:63], v[164:167], v[84:87], v[60:63]
    ds_read_b128 v[92:95], v5 offset:34816
    v_mfma_f32_16x16x32_bf16 v[52:55], v[164:167], v[80:83], v[52:55]
    v_mfma_f32_16x16x32_bf16 v[64:67], v[168:171], v[80:83], v[64:67]
    buffer_store_dwordx4 v[140:143], v9, s[20:23], s48 offen sc1
    v_mfma_f32_16x16x32_bf16 v[72:75], v[168:171], v[84:87], v[72:75]
    v_add_f32 v100, v128, v129
    v_mul_f32 v101, v128, v128
    v_mfma_f32_16x16x32_bf16 v[76:79], v[172:175], v[84:87], v[76:79]
    v_fmac_f32 v101, v129, v129
    v_add_f32 v100, v100, v130
    v_mfma_f32_16x16x32_bf16 v[68:71], v[172:175], v[80:83], v[68:71]
    s_waitcnt lgkmcnt(0)
    v_fmac_f32 v101, v130, v130
    v_add_f32 v100, v100, v131
    v_mfma_f32_16x16x32_bf16 v[48:51], v[176:179], v[88:91], v[48:51]
    ds_read_b128 v[80:83], v4 offset:36864
    v_fmac_f32 v101, v131, v131
    v_mfma_f32_16x16x32_bf16 v[56:59], v[176:179], v[92:95], v[56:59]
    buffer_load_dwordx4 v1, s[16:19], s42 offen offset:2048 sc1 lds
    v_mfma_f32_16x16x32_bf16 v[60:63], v[180:183], v[92:95], v[60:63]
    s_add_u32 m0, s43, 24576
    ds_read_b128 v[84:87], v5 offset:36864
    v_add_f32 v100, v100, v132
    v_mfma_f32_16x16x32_bf16 v[52:55], v[180:183], v[88:91], v[52:55]
    s_add_u32 s42, s41, 24576
    v_fmac_f32 v101, v132, v132
    v_add_f32 v100, v100, v133
    v_mfma_f32_16x16x32_bf16 v[64:67], v[184:187], v[88:91], v[64:67]
    v_fmac_f32 v101, v133, v133
    v_add_f32 v100, v100, v134
    v_mfma_f32_16x16x32_bf16 v[72:75], v[184:187], v[92:95], v[72:75]
    v_fmac_f32 v101, v134, v134
    v_add_f32 v100, v100, v135
    v_mfma_f32_16x16x32_bf16 v[76:79], v[188:191], v[92:95], v[76:79]
    buffer_load_dwordx4 v1, s[16:19], s42 offen offset:0 sc1 lds
    v_mfma_f32_16x16x32_bf16 v[68:71], v[188:191], v[88:91], v[68:71]
    s_waitcnt lgkmcnt(0)
    v_fmac_f32 v101, v135, v135
    v_mfma_f32_16x16x32_bf16 v[48:51], v[192:195], v[80:83], v[48:51]
    ds_read_b128 v[88:91], v4 offset:38912
    v_mfma_f32_16x16x32_bf16 v[56:59], v[192:195], v[84:87], v[56:59]
    v_permlane16_swap_b32 v100, v101
    v_mfma_f32_16x16x32_bf16 v[60:63], v[196:199], v[84:87], v[60:63]
    ds_read_b128 v[92:95], v5 offset:38912
    v_add_f32 v100, v100, v101
    v_mfma_f32_16x16x32_bf16 v[52:55], v[196:199], v[80:83], v[52:55]
    buffer_load_dwordx4 v1, s[16:19], s42 offen offset:1024 sc1 lds
    v_mfma_f32_16x16x32_bf16 v[64:67], v[200:203], v[80:83], v[64:67]
    v_mov_b32 v102, v100
    v_mfma_f32_16x16x32_bf16 v[72:75], v[200:203], v[84:87], v[72:75]
    v_permlane32_swap_b32 v100, v102
    v_mfma_f32_16x16x32_bf16 v[76:79], v[204:207], v[84:87], v[76:79]
    v_add_f32 v100, v100, v102
    v_mfma_f32_16x16x32_bf16 v[68:71], v[204:207], v[80:83], v[68:71]
    s_waitcnt lgkmcnt(0)
    ds_write_b32 v10, v100 offset:0
    v_mfma_f32_16x16x32_bf16 v[48:51], v[208:211], v[88:91], v[48:51]
    s_waitcnt vmcnt(22)
    ds_read_b128 v[80:83], v4 offset:40960
    v_mfma_f32_16x16x32_bf16 v[128:131], v[104:107], v[136:139], v[16:19]
    buffer_load_dwordx4 v1, s[16:19], s42 offen offset:2048 sc1 lds
    v_mfma_f32_16x16x32_bf16 v[56:59], v[208:211], v[92:95], v[56:59]
    v_mfma_f32_16x16x32_bf16 v[132:135], v[108:111], v[136:139], v[20:23]
    s_add_u32 s45, s45, 131072
    v_mfma_f32_16x16x32_bf16 v[60:63], v[212:215], v[92:95], v[60:63]
    ds_read_b128 v[84:87], v5 offset:40960
    v_mfma_f32_16x16x32_bf16 v[52:55], v[212:215], v[88:91], v[52:55]
    v_mfma_f32_16x16x32_bf16 v[64:67], v[216:219], v[88:91], v[64:67]
    v_mfma_f32_16x16x32_bf16 v[72:75], v[216:219], v[92:95], v[72:75]
    v_mfma_f32_16x16x32_bf16 v[76:79], v[220:223], v[92:95], v[76:79]
    v_mfma_f32_16x16x32_bf16 v[68:71], v[220:223], v[88:91], v[68:71]
    s_waitcnt lgkmcnt(0)
    v_mfma_f32_16x16x32_bf16 v[48:51], v[224:227], v[80:83], v[48:51]
    ds_read_b128 v[88:91], v4 offset:43008
    v_mfma_f32_16x16x32_bf16 v[56:59], v[224:227], v[84:87], v[56:59]
    v_mfma_f32_16x16x32_bf16 v[60:63], v[228:231], v[84:87], v[60:63]
    ds_read_b128 v[92:95], v5 offset:43008
    v_mfma_f32_16x16x32_bf16 v[52:55], v[228:231], v[80:83], v[52:55]
    v_mfma_f32_16x16x32_bf16 v[64:67], v[232:235], v[80:83], v[64:67]
    v_mfma_f32_16x16x32_bf16 v[72:75], v[232:235], v[84:87], v[72:75]
    v_mfma_f32_16x16x32_bf16 v[76:79], v[236:239], v[84:87], v[76:79]
    v_mfma_f32_16x16x32_bf16 v[68:71], v[236:239], v[80:83], v[68:71]
    s_waitcnt vmcnt(9) lgkmcnt(0)
    s_barrier
    v_mfma_f32_16x16x32_bf16 v[48:51], v[240:243], v[88:91], v[48:51]
    ds_read_b128 v[80:83], v2 offset:0
    v_mfma_f32_16x16x32_bf16 v[56:59], v[240:243], v[92:95], v[56:59]
    v_mfma_f32_16x16x32_bf16 v[60:63], v[244:247], v[92:95], v[60:63]
    ds_read_b128 v[84:87], v3 offset:0
    v_mfma_f32_16x16x32_bf16 v[52:55], v[244:247], v[88:91], v[52:55]
    v_mfma_f32_16x16x32_bf16 v[64:67], v[248:251], v[88:91], v[64:67]
    v_mfma_f32_16x16x32_bf16 v[72:75], v[248:251], v[92:95], v[72:75]
    v_mfma_f32_16x16x32_bf16 v[76:79], v[252:255], v[92:95], v[76:79]
    v_mfma_f32_16x16x32_bf16 v[68:71], v[252:255], v[88:91], v[68:71]
    s_add_u32 s36, s36, 1
    s_cmp_lt_u32 s36, 32
    s_cbranch_scc1 L_bf_b0
    s_nop 7
    s_sub_u32 s47, s45, 393216
    buffer_load_dword v13, v8, s[16:19], s47 offen sc1
    s_and_b32 s38, s53, 0xffffffff
    s_cmp_eq_u32 s36, 0
    s_cselect_b32 s38, 0x5e00000, s38
    buffer_load_dwordx4 v[136:139], v1, s[16:19], s38 offen sc1
    s_add_u32 s53, s53, 65536
    s_and_b32 s44, s90, 0xffffffff
    s_cmp_eq_u32 s36, 0
    s_cselect_b32 s44, 0x5e00000, s44
    s_xor_b32 s49, s44, 16384
    v_cvt_pk_bf16_f32 v56, v56, v57
    v_cvt_pk_bf16_f32 v57, v58, v59
    v_cvt_pk_bf16_f32 v58, v60, v61
    v_cvt_pk_bf16_f32 v59, v62, v63
    buffer_store_dwordx4 v[56:59], v1, s[16:19], s49 offen offset:0 sc1
    s_xor_b32 s49, s44, 32768
    v_cvt_pk_bf16_f32 v64, v64, v65
    v_cvt_pk_bf16_f32 v65, v66, v67
    v_cvt_pk_bf16_f32 v66, v68, v69
    v_cvt_pk_bf16_f32 v67, v70, v71
    buffer_store_dwordx4 v[64:67], v1, s[16:19], s49 offen offset:1024 sc1
    s_xor_b32 s49, s44, 49152
    v_cvt_pk_bf16_f32 v72, v72, v73
    v_cvt_pk_bf16_f32 v73, v74, v75
    v_cvt_pk_bf16_f32 v74, v76, v77
    v_cvt_pk_bf16_f32 v75, v78, v79
    buffer_store_dwordx4 v[72:75], v1, s[16:19], s49 offen offset:2048 sc1
    s_add_u32 s90, s90, 262144
    s_waitcnt vmcnt(4)
    v_cmp_ne_u32 vcc, 0, v13
    s_cbranch_vccnz L_spin51
L_back52:
    s_barrier
    s_sub_u32 s48, s90, 524288
    s_and_b32 s48, s48, 0xffffffff
    s_cmp_lt_u32 s36, 2
    s_cselect_b32 s48, s52, s48
    buffer_load_dwordx4 v[140:143], v1, s[16:19], s48 offen offset:0 sc1
    buffer_load_dwordx4 v[144:147], v1, s[16:19], s48 offen offset:1024 sc1
    buffer_load_dwordx4 v[148:151], v1, s[16:19], s48 offen offset:2048 sc1
    buffer_load_dwordx4 v[152:155], v1, s[16:19], s48 offen offset:3072 sc1
    s_sub_u32 s47, s36, 2
    s_cmp_lt_u32 s47, 16
    s_cselect_b32 s48, 0x5000000, s52
    s_add_u32 s20, s84, s48
    s_addc_u32 s21, s85, 0
    s_cmp_ge_i32 s47, 16
    s_cselect_b32 s20, s80, s20
    s_cselect_b32 s21, s81, s21
    s_and_b32 s48, s47, 15
    s_lshl_b32 s48, s48, 1
    s_sub_u32 s48, s50, s48
    s_lshl_b32 s46, s48, 10
    s_sub_u32 s46, s55, s46
    s_cmp_lt_u32 s47, 16
    s_cselect_b32 s46, s46, s52
    s_lshl_b32 s48, s48, 15
    s_waitcnt vmcnt(4)
    s_barrier
    buffer_store_dword v124, v124, s[16:19], s91 offen sc1
    s_add_u32 s91, s91, 131072
    s_waitcnt vmcnt(1)
    v_mfma_f32_16x16x32_bf16 v[128:131], v[104:107], v[140:143], v[128:131]
    v_mfma_f32_16x16x32_bf16 v[132:135], v[108:111], v[140:143], v[132:135]
    v_mfma_f32_16x16x32_bf16 v[128:131], v[104:107], v[144:147], v[128:131]
    v_mfma_f32_16x16x32_bf16 v[132:135], v[108:111], v[144:147], v[132:135]
    v_mfma_f32_16x16x32_bf16 v[128:131], v[104:107], v[148:151], v[128:131]
    v_mfma_f32_16x16x32_bf16 v[132:135], v[108:111], v[148:151], v[132:135]
    v_mfma_f32_16x16x32_bf16 v[128:131], v[104:107], v[152:155], v[128:131]
    v_mfma_f32_16x16x32_bf16 v[132:135], v[108:111], v[152:155], v[132:135]
    s_nop 5
    v_cvt_pk_bf16_f32 v140, v128, v129
    v_cvt_pk_bf16_f32 v141, v130, v131
    v_cvt_pk_bf16_f32 v142, v132, v133
    v_cvt_pk_bf16_f32 v143, v134, v135
    buffer_store_dwordx4 v[140:143], v9, s[20:23], s48 offen sc1
    s_waitcnt vmcnt(9)
    v_mfma_f32_16x16x32_bf16 v[128:131], v[104:107], v[136:139], v[48:51]
    v_mfma_f32_16x16x32_bf16 v[132:135], v[108:111], v[136:139], v[52:55]
    s_sub_u32 s47, s45, 262144
    buffer_load_dword v13, v8, s[16:19], s47 offen sc1
    s_waitcnt vmcnt(0)
    v_cmp_ne_u32 vcc, 0, v13
    s_cbranch_vccnz L_spin53
L_back54:
    s_barrier
    s_sub_u32 s48, s90, 262144
    s_and_b32 s48, s48, 0xffffffff
    s_cmp_lt_u32 s36, 1
    s_cselect_b32 s48, s52, s48
    buffer_load_dwordx4 v[140:143], v1, s[16:19], s48 offen offset:0 sc1
    buffer_load_dwordx4 v[144:147], v1, s[16:19], s48 offen offset:1024 sc1
    buffer_load_dwordx4 v[148:151], v1, s[16:19], s48 offen offset:2048 sc1
    buffer_load_dwordx4 v[152:155], v1, s[16:19], s48 offen offset:3072 sc1
    s_sub_u32 s47, s36, 1
    s_cmp_lt_u32 s47, 16
    s_cselect_b32 s48, 0x5000000, s52
    s_add_u32 s20, s84, s48
    s_addc_u32 s21, s85, 0
    s_cmp_ge_i32 s47, 16
    s_cselect_b32 s20, s80, s20
    s_cselect_b32 s21, s81, s21
    s_and_b32 s48, s47, 15
    s_lshl_b32 s48, s48, 1
    s_sub_u32 s48, s50, s48
    s_lshl_b32 s46, s48, 10
    s_sub_u32 s46, s55, s46
    s_cmp_lt_u32 s47, 16
    s_cselect_b32 s46, s46, s52
    s_lshl_b32 s48, s48, 15
    s_waitcnt vmcnt(0)
    v_mfma_f32_16x16x32_bf16 v[128:131], v[104:107], v[140:143], v[128:131]
    v_mfma_f32_16x16x32_bf16 v[132:135], v[108:111], v[140:143], v[132:135]
    v_mfma_f32_16x16x32_bf16 v[128:131], v[104:107], v[144:147], v[128:131]
    v_mfma_f32_16x16x32_bf16 v[132:135], v[108:111], v[144:147], v[132:135]
    v_mfma_f32_16x16x32_bf16 v[128:131], v[104:107], v[148:151], v[128:131]
    v_mfma_f32_16x16x32_bf16 v[132:135], v[108:111], v[148:151], v[132:135]
    v_mfma_f32_16x16x32_bf16 v[128:131], v[104:107], v[152:155], v[128:131]
    v_mfma_f32_16x16x32_bf16 v[132:135], v[108:111], v[152:155], v[132:135]
    s_nop 5
    v_cvt_pk_bf16_f32 v140, v128, v129
    v_cvt_pk_bf16_f32 v141, v130, v131
    v_cvt_pk_bf16_f32 v142, v132, v133
    v_cvt_pk_bf16_f32 v143, v134, v135
    buffer_store_dwordx4 v[140:143], v9, s[20:23], s48 offen sc1
    s_waitcnt vmcnt(0)
    s_endpgm
L_spin31:
    s_mov_b32 s40, 0x20000
L_spin31_l:
    buffer_load_dword v8, v124, s[20:23], 0 offen sc1
    s_sub_u32 s40, s40, 1
    s_waitcnt vmcnt(0)
    v_cmp_eq_u32 vcc, v124, v8
    s_cbranch_scc1 L_back32
    s_cbranch_vccz L_back32
    s_sleep 8
    s_branch L_spin31_l
L_spin34:
    s_mov_b32 s40, 0x20000
L_spin34_l:
    buffer_load_dword v48, v124, s[20:23], 0 offen sc1
    s_sub_u32 s40, s40, 1
    s_waitcnt vmcnt(0)
    v_cmp_eq_u32 vcc, v124, v48
    s_cbranch_scc1 L_back35
    s_cbranch_vccz L_back35
    s_sleep 8
    s_branch L_spin34_l
L_spin36:
    s_mov_b32 s40, 0x20000
L_spin36_l:
    buffer_load_dword v49, v48, s[16:19], s38 offen sc1
    s_sub_u32 s40, s40, 1
    s_waitcnt vmcnt(0)
    v_cmp_ne_u32 vcc, 0, v49
    s_cbranch_scc1 L_back37
    s_cbranch_vccz L_back37
    s_sleep 8
    s_branch L_spin36_l
L_spin39:
    s_mov_b32 s40, 0x20000
L_spin39_l:
    buffer_load_dword v80, v124, s[20:23], 0 offen sc1
    s_sub_u32 s40, s40, 1
    s_waitcnt vmcnt(0)
    v_cmp_eq_u32 vcc, v124, v80
    s_cbranch_scc1 L_back40
    s_cbranch_vccz L_back40
    s_sleep 8
    s_branch L_spin39_l
L_spin41:
    s_mov_b32 s40, 0x20000
L_spin41_l:
    buffer_load_dword v96, v6, s[16:19], s45 offen sc1
    s_sub_u32 s40, s40, 1
    s_waitcnt vmcnt(0)
    v_cmp_ne_u32 vcc, 0, v96
    s_cbranch_scc1 L_back42
    s_cbranch_vccz L_back42
    s_sleep 2
    s_branch L_spin41_l
L_spin43:
    s_mov_b32 s40, 0x20000
L_spin43_l:
    buffer_load_dword v13, v8, s[16:19], s47 offen sc1
    s_sub_u32 s40, s40, 1
    s_waitcnt vmcnt(0)
    v_cmp_ne_u32 vcc, 0, v13
    s_cbranch_scc1 L_back44
    s_cbranch_vccz L_back44
    s_sleep 2
    s_branch L_spin43_l
L_spin45:
    s_mov_b32 s40, 0x20000
L_spin45_l:
    buffer_load_dword v96, v6, s[16:19], s45 offen sc1
    s_sub_u32 s40, s40, 1
    s_waitcnt vmcnt(0)
    v_cmp_ne_u32 vcc, 0, v96
    s_cbranch_scc1 L_back46
    s_cbranch_vccz L_back46
    s_sleep 2
    s_branch L_spin45_l
L_spin47:
    s_mov_b32 s40, 0x20000
L_spin47_l:
    buffer_load_dword v13, v8, s[16:19], s47 offen sc1
    s_sub_u32 s40, s40, 1
    s_waitcnt vmcnt(0)
    v_cmp_ne_u32 vcc, 0, v13
    s_cbranch_scc1 L_back48
    s_cbranch_vccz L_back48
    s_sleep 2
    s_branch L_spin47_l
L_spin49:
    s_mov_b32 s40, 0x20000
L_spin49_l:
    buffer_load_dword v96, v6, s[16:19], s45 offen sc1
    s_sub_u32 s40, s40, 1
    s_waitcnt vmcnt(0)
    v_cmp_ne_u32 vcc, 0, v96
    s_cbranch_scc1 L_back50
    s_cbranch_vccz L_back50
    s_sleep 2
    s_branch L_spin49_l
L_spin51:
    s_mov_b32 s40, 0x20000
L_spin51_l:
    buffer_load_dword v13, v8, s[16:19], s47 offen sc1
    s_sub_u32 s40, s40, 1
    s_waitcnt vmcnt(0)
    v_cmp_ne_u32 vcc, 0, v13
    s_cbranch_scc1 L_back52
    s_cbranch_vccz L_back52
    s_sleep 2
    s_branch L_spin51_l
L_spin53:
    s_mov_b32 s40, 0x20000
L_spin53_l:
    buffer_load_dword v13, v8, s[16:19], s47 offen sc1
    s_sub_u32 s40, s40, 1
    s_waitcnt vmcnt(0)
    v_cmp_ne_u32 vcc, 0, v13
    s_cbranch_scc1 L_back54
    s_cbranch_vccz L_back54
    s_sleep 2
    s_branch L_spin53_l
L_role_60:
    s_sub_u32 s35, s34, 44
    s_lshr_b32 s51, s35, 2
    s_and_b32 s87, s35, 3
    s_mul_i32 s54, s51, 1441792
    s_lshl_b32 s37, s87, 9
    s_add_u32 s54, s54, s37
    s_mov_b32 s12, s76
    s_mov_b32 s13, s77
    s_mov_b32 s14, 0x700000
    s_mov_b32 s15, 0x00020000
    s_mov_b32 s39, 2048
    s_cmp_lg_u32 s32, 0
    s_cbranch_scc1 L_arv55
    s_add_u32 s20, s82, 0x80
    s_addc_u32 s21, s83, 0
    s_mov_b32 s22, 0x4
    s_mov_b32 s23, 0x00020000
    buffer_load_dword v48, v124, s[20:23], 0 offen sc1
    s_waitcnt vmcnt(0)
    v_cmp_eq_u32 vcc, v124, v48
    s_cbranch_vccnz L_spin56
L_back57:
L_arv55:
    s_lshr_b32 s38, s47, 3
    s_lshl_b32 s38, s38, 1
    s_lshl_b32 s37, s33, 6
    s_add_u32 s37, s37, s38
    s_lshl_b32 s37, s37, 8
    v_lshl_add_u32 v48, v0, 8, s37
    s_cmp_eq_u32 s32, 0
    s_cselect_b32 s37, 1, 0
    v_cmp_le_u32 vcc, s37, v0
    s_nop 1
    v_cndmask_b32 v48, v48, 2.0, vcc
    s_mov_b32 s38, 0x5540000
    buffer_load_dword v49, v48, s[16:19], s38 offen sc1
    s_waitcnt vmcnt(0)
    v_cmp_ne_u32 vcc, 0, v49
    s_cbranch_vccnz L_spin58
L_back59:
    s_barrier
    v_lshrrev_b32 v64, 3, v0
    v_lshlrev_b32 v65, 2, v0
    v_and_b32 v65, 64, v65
    v_and_b32 v66, 0x70, v1
    v_xor_b32 v65, v65, v66
    v_mad_u32_u24 v48, v64, s39, v65
    v_add_u32 v49, 16384, v48
    v_add_u32 v50, 128, v48
    v_add_u32 v51, 16512, v48
    v_add_u32 v52, 256, v48
    v_add_u32 v53, 16640, v48
    v_add_u32 v54, 384, v48
    v_add_u32 v55, 16768, v48
    s_mul_i32 s38, s32, 32768
    s_add_u32 s54, s54, s38
    s_lshl_b32 s42, s32, 11
    s_add_u32 m0, s42, 0
    s_nop 0
    buffer_load_dwordx4 v48, s[12:15], s54 offen lds
    s_add_u32 m0, s42, 1024
    s_nop 0
    buffer_load_dwordx4 v49, s[12:15], s54 offen lds
    s_add_u32 m0, s42, 8192
    s_nop 0
    buffer_load_dwordx4 v50, s[12:15], s54 offen lds
    s_add_u32 m0, s42, 9216
    s_nop 0
    buffer_load_dwordx4 v51, s[12:15], s54 offen lds
    s_add_u32 m0, s42, 16384
    s_nop 0
    buffer_load_dwordx4 v52, s[12:15], s54 offen lds
    s_add_u32 m0, s42, 17408
    s_nop 0
    buffer_load_dwordx4 v53, s[12:15], s54 offen lds
    s_add_u32 m0, s42, 24576
    s_nop 0
    buffer_load_dwordx4 v54, s[12:15], s54 offen lds
    s_add_u32 m0, s42, 25600
    s_nop 0
    buffer_load_dwordx4 v55, s[12:15], s54 offen lds
    s_add_u32 s54, s54, 131072
    s_add_u32 m0, s42, 32768
    s_nop 0
    buffer_load_dwordx4 v48, s[12:15], s54 offen lds
    s_add_u32 m0, s42, 33792
    s_nop 0
    buffer_load_dwordx4 v49, s[12:15], s54 offen lds
    s_add_u32 m0, s42, 40960
    s_nop 0
    buffer_load_dwordx4 v50, s[12:15], s54 offen lds
    s_add_u32 m0, s42, 41984
    s_nop 0
    buffer_load_dwordx4 v51, s[12:15], s54 offen lds
    s_add_u32 m0, s42, 49152
    s_nop 0
    buffer_load_dwordx4 v52, s[12:15], s54 offen lds
    s_add_u32 m0, s42, 50176
    s_nop 0
    buffer_load_dwordx4 v53, s[12:15], s54 offen lds
    s_add_u32 m0, s42, 57344
    s_nop 0
    buffer_load_dwordx4 v54, s[12:15], s54 offen lds
    s_add_u32 m0, s42, 58368
    s_nop 0
    buffer_load_dwordx4 v55, s[12:15], s54 offen lds
    s_add_u32 s54, s54, 131072
    s_add_u32 m0, s42, 65536
    s_nop 0
    buffer_load_dwordx4 v48, s[12:15], s54 offen lds
    s_add_u32 m0, s42, 66560
    s_nop 0
    buffer_load_dwordx4 v49, s[12:15], s54 offen lds
    s_add_u32 m0, s42, 73728
    s_nop 0
    buffer_load_dwordx4 v50, s[12:15], s54 offen lds
    s_add_u32 m0, s42, 74752
    s_nop 0
    buffer_load_dwordx4 v51, s[12:15], s54 offen lds
    s_add_u32 m0, s42, 81920
    s_nop 0
    buffer_load_dwordx4 v52, s[12:15], s54 offen lds
    s_add_u32 m0, s42, 82944
    s_nop 0
    buffer_load_dwordx4 v53, s[12:15], s54 offen lds
    s_add_u32 m0, s42, 90112
    s_nop 0
    buffer_load_dwordx4 v54, s[12:15], s54 offen lds
    s_add_u32 m0, s42, 91136
    s_nop 0
    buffer_load_dwordx4 v55, s[12:15], s54 offen lds
    s_add_u32 s54, s54, 131072
    s_add_u32 m0, s42, 98304
    s_nop 0
    buffer_load_dwordx4 v48, s[12:15], s54 offen lds
    s_add_u32 m0, s42, 99328
    s_nop 0
    buffer_load_dwordx4 v49, s[12:15], s54 offen lds
    s_add_u32 m0, s42, 106496
    s_nop 0
    buffer_load_dwordx4 v50, s[12:15], s54 offen lds
    s_add_u32 m0, s42, 107520
    s_nop 0
    buffer_load_dwordx4 v51, s[12:15], s54 offen lds
    s_add_u32 m0, s42, 114688
    s_nop 0
    buffer_load_dwordx4 v52, s[12:15], s54 offen lds
    s_add_u32 m0, s42, 115712
    s_nop 0
    buffer_load_dwordx4 v53, s[12:15], s54 offen lds
    s_add_u32 m0, s42, 122880
    s_nop 0
    buffer_load_dwordx4 v54, s[12:15], s54 offen lds
    s_add_u32 m0, s42, 123904
    s_nop 0
    buffer_load_dwordx4 v55, s[12:15], s54 offen lds
    s_add_u32 s54, s54, 131072
    v_lshrrev_b32 v64, 4, v0
    v_bfe_u32 v65, v0, 2, 2
    v_lshl_add_u32 v64, v64, 3, v65
    v_lshlrev_b32 v64, 7, v64
    v_lshrrev_b32 v65, 1, v65
    v_lshl_add_u32 v64, v65, 6, v64
    v_and_b32 v65, 3, v0
    v_lshl_add_u32 v64, v65, 4, v64
    s_lshl_b32 s37, s32, 13
    s_and_b32 s38, s51, 2
    s_lshl_b32 s38, s38, 5
    s_xor_b32 s38, s38, 0
    s_add_u32 s37, s37, s38
    v_xor_b32 v56, s37, v64
    s_lshl_b32 s37, s32, 13
    s_and_b32 s38, s51, 2
    s_lshl_b32 s38, s38, 5
    s_xor_b32 s38, s38, 8
    s_add_u32 s37, s37, s38
    v_xor_b32 v57, s37, v64
    s_lshl_b32 s37, s32, 13
    s_and_b32 s38, s51, 2
    s_lshl_b32 s38, s38, 5
    s_xor_b32 s38, s38, 64
    s_add_u32 s37, s37, s38
    v_xor_b32 v58, s37, v64
    s_lshl_b32 s37, s32, 13
    s_and_b32 s38, s51, 2
    s_lshl_b32 s38, s38, 5
    s_xor_b32 s38, s38, 72
    s_add_u32 s37, s37, s38
    v_xor_b32 v59, s37, v64
    s_and_b32 s39, s51, 1
    s_lshl_b32 s37, s39, 10
    v_add_u32 v2, s37, v1
    v_xor_b32 v3, 1024, v2
    v_add_u32 v4, 98304, v2
    v_add_u32 v5, 98304, v3
    s_mul_i32 s38, s51, 11*43
    s_lshr_b32 s38, s38, 7
    s_add_u32 s38, s38, 24
    s_lshl_b32 s37, s33, 6
    s_add_u32 s37, s37, s38
    s_lshl_b32 s37, s37, 8
    v_lshl_add_u32 v6, v0, 8, s37
    s_cmp_eq_u32 s32, 0
    s_cselect_b32 s37, 5, 0
    v_cmp_le_u32 vcc, s37, v0
    s_nop 1
    v_cndmask_b32 v6, v6, 2.0, vcc
    s_mul_i32 s43, s32, 3072
    s_lshl_b32 s88, s32, 11
    s_sub_u32 s89, s88, s43
    s_mul_i32 s41, s33, 8388608
    s_add_u32 s41, s41, 0x1000000
    s_mul_i32 s37, s51, 45056
    s_add_u32 s41, s41, s37
    s_add_u32 s41, s41, s43
    s_mul_i32 s90, s33, 8388608
    s_add_u32 s90, s90, 0x2fc0000
    s_lshl_b32 s37, s87, 16
    s_add_u32 s90, s90, s37
    s_lshl_b32 s37, s32, 12
    s_add_u32 s90, s90, s37
    s_and_b32 s37, s51, 3
    s_lshl_b32 s37, s37, 14
    s_add_u32 s90, s90, s37
    v_add_u32 v60, 0, v56
    v_add_u32 v61, 0, v57
    v_add_u32 v62, 0, v58
    v_add_u32 v63, 0, v59
    s_waitcnt vmcnt(24)
    s_barrier
    ds_read_b64_tr_b16 a[0:1], v60 offset:0
    ds_read_b64_tr_b16 a[2:3], v60 offset:512
    ds_read_b64_tr_b16 a[4:5], v61 offset:0
    ds_read_b64_tr_b16 a[6:7], v61 offset:512
    ds_read_b64_tr_b16 a[8:9], v62 offset:0
    ds_read_b64_tr_b16 a[10:11], v62 offset:512
    ds_read_b64_tr_b16 a[12:13], v63 offset:0
    ds_read_b64_tr_b16 a[14:15], v63 offset:512
    ds_read_b64_tr_b16 a[16:17], v60 offset:4096
    ds_read_b64_tr_b16 a[18:19], v60 offset:4608
    ds_read_b64_tr_b16 a[20:21], v61 offset:4096
    ds_read_b64_tr_b16 a[22:23], v61 offset:4608
    ds_read_b64_tr_b16 a[24:25], v62 offset:4096
    ds_read_b64_tr_b16 a[26:27], v62 offset:4608
    ds_read_b64_tr_b16 a[28:29], v63 offset:4096
    ds_read_b64_tr_b16 a[30:31], v63 offset:4608
    s_add_u32 m0, s42, 131072
    s_nop 0
    buffer_load_dwordx4 v48, s[12:15], s54 offen lds
    s_add_u32 m0, s42, 132096
    s_nop 0
    buffer_load_dwordx4 v49, s[12:15], s54 offen lds
    s_add_u32 m0, s42, 139264
    s_nop 0
    buffer_load_dwordx4 v50, s[12:15], s54 offen lds
    s_add_u32 m0, s42, 140288
    s_nop 0
    buffer_load_dwordx4 v51, s[12:15], s54 offen lds
    s_add_u32 m0, s42, 147456
    s_nop 0
    buffer_load_dwordx4 v52, s[12:15], s54 offen lds
    s_add_u32 m0, s42, 148480
    s_nop 0
    buffer_load_dwordx4 v53, s[12:15], s54 offen lds
    s_add_u32 m0, s42, 155648
    s_nop 0
    buffer_load_dwordx4 v54, s[12:15], s54 offen lds
    s_add_u32 m0, s42, 156672
    s_nop 0
    buffer_load_dwordx4 v55, s[12:15], s54 offen lds
    s_add_u32 s54, s54, 131072
    s_waitcnt lgkmcnt(0)
    v_add_u32 v60, 32768, v56
    v_add_u32 v61, 32768, v57
    v_add_u32 v62, 32768, v58
    v_add_u32 v63, 32768, v59
    s_waitcnt vmcnt(24)
    s_barrier
    ds_read_b64_tr_b16 a[32:33], v60 offset:0
    ds_read_b64_tr_b16 a[34:35], v60 offset:512
    ds_read_b64_tr_b16 a[36:37], v61 offset:0
    ds_read_b64_tr_b16 a[38:39], v61 offset:512
    ds_read_b64_tr_b16 a[40:41], v62 offset:0
    ds_read_b64_tr_b16 a[42:43], v62 offset:512
    ds_read_b64_tr_b16 a[44:45], v63 offset:0
    ds_read_b64_tr_b16 a[46:47], v63 offset:512
    ds_read_b64_tr_b16 a[48:49], v60 offset:4096
    ds_read_b64_tr_b16 a[50:51], v60 offset:4608
    ds_read_b64_tr_b16 a[52:53], v61 offset:4096
    ds_read_b64_tr_b16 a[54:55], v61 offset:4608
    ds_read_b64_tr_b16 a[56:57], v62 offset:4096
    ds_read_b64_tr_b16 a[58:59], v62 offset:4608
    ds_read_b64_tr_b16 a[60:61], v63 offset:4096
    ds_read_b64_tr_b16 a[62:63], v63 offset:4608
    s_add_u32 m0, s42, 0
    s_nop 0
    buffer_load_dwordx4 v48, s[12:15], s54 offen lds
    s_add_u32 m0, s42, 1024
    s_nop 0
    buffer_load_dwordx4 v49, s[12:15], s54 offen lds
    s_add_u32 m0, s42, 8192
    s_nop 0
    buffer_load_dwordx4 v50, s[12:15], s54 offen lds
    s_add_u32 m0, s42, 9216
    s_nop 0
    buffer_load_dwordx4 v51, s[12:15], s54 offen lds
    s_add_u32 m0, s42, 16384
    s_nop 0
    buffer_load_dwordx4 v52, s[12:15], s54 offen lds
    s_add_u32 m0, s42, 17408
    s_nop 0
    buffer_load_dwordx4 v53, s[12:15], s54 offen lds
    s_add_u32 m0, s42, 24576
    s_nop 0
    buffer_load_dwordx4 v54, s[12:15], s54 offen lds
    s_add_u32 m0, s42, 25600
    s_nop 0
    buffer_load_dwordx4 v55, s[12:15], s54 offen lds
    s_add_u32 s54, s54, 131072
    s_waitcnt lgkmcnt(0)
    v_add_u32 v60, 65536, v56
    v_add_u32 v61, 65536, v57
    v_add_u32 v62, 65536, v58
    v_add_u32 v63, 65536, v59
    s_waitcnt vmcnt(24)
    s_barrier
    ds_read_b64_tr_b16 a[64:65], v60 offset:0
    ds_read_b64_tr_b16 a[66:67], v60 offset:512
    ds_read_b64_tr_b16 a[68:69], v61 offset:0
    ds_read_b64_tr_b16 a[70:71], v61 offset:512
    ds_read_b64_tr_b16 a[72:73], v62 offset:0
    ds_read_b64_tr_b16 a[74:75], v62 offset:512
    ds_read_b64_tr_b16 a[76:77], v63 offset:0
    ds_read_b64_tr_b16 a[78:79], v63 offset:512
    ds_read_b64_tr_b16 a[80:81], v60 offset:4096
    ds_read_b64_tr_b16 a[82:83], v60 offset:4608
    ds_read_b64_tr_b16 a[84:85], v61 offset:4096
    ds_read_b64_tr_b16 a[86:87], v61 offset:4608
    ds_read_b64_tr_b16 a[88:89], v62 offset:4096
    ds_read_b64_tr_b16 a[90:91], v62 offset:4608
    ds_read_b64_tr_b16 a[92:93], v63 offset:4096
    ds_read_b64_tr_b16 a[94:95], v63 offset:4608
    s_add_u32 m0, s42, 32768
    s_nop 0
    buffer_load_dwordx4 v48, s[12:15], s54 offen lds
    s_add_u32 m0, s42, 33792
    s_nop 0
    buffer_load_dwordx4 v49, s[12:15], s54 offen lds
    s_add_u32 m0, s42, 40960
    s_nop 0
    buffer_load_dwordx4 v50, s[12:15], s54 offen lds
    s_add_u32 m0, s42, 41984
    s_nop 0
    buffer_load_dwordx4 v51, s[12:15], s54 offen lds
    s_add_u32 m0, s42, 49152
    s_nop 0
    buffer_load_dwordx4 v52, s[12:15], s54 offen lds
    s_add_u32 m0, s42, 50176
    s_nop 0
    buffer_load_dwordx4 v53, s[12:15], s54 offen lds
    s_add_u32 m0, s42, 57344
    s_nop 0
    buffer_load_dwordx4 v54, s[12:15], s54 offen lds
    s_add_u32 m0, s42, 58368
    s_nop 0
    buffer_load_dwordx4 v55, s[12:15], s54 offen lds
    s_add_u32 s54, s54, 131072
    s_waitcnt lgkmcnt(0)
    v_add_u32 v60, 98304, v56
    v_add_u32 v61, 98304, v57
    v_add_u32 v62, 98304, v58
    v_add_u32 v63, 98304, v59
    s_waitcnt vmcnt(24)
    s_barrier
    ds_read_b64_tr_b16 a[96:97], v60 offset:0
    ds_read_b64_tr_b16 a[98:99], v60 offset:512
    ds_read_b64_tr_b16 a[100:101], v61 offset:0
    ds_read_b64_tr_b16 a[102:103], v61 offset:512
    ds_read_b64_tr_b16 a[104:105], v62 offset:0
    ds_read_b64_tr_b16 a[106:107], v62 offset:512
    ds_read_b64_tr_b16 a[108:109], v63 offset:0
    ds_read_b64_tr_b16 a[110:111], v63 offset:512
    ds_read_b64_tr_b16 a[112:113], v60 offset:4096
    ds_read_b64_tr_b16 a[114:115], v60 offset:4608
    ds_read_b64_tr_b16 a[116:117], v61 offset:4096
    ds_read_b64_tr_b16 a[118:119], v61 offset:4608
    ds_read_b64_tr_b16 a[120:121], v62 offset:4096
    ds_read_b64_tr_b16 a[122:123], v62 offset:4608
    ds_read_b64_tr_b16 a[124:125], v63 offset:4096
    ds_read_b64_tr_b16 a[126:127], v63 offset:4608
    s_add_u32 m0, s42, 65536
    s_nop 0
    buffer_load_dwordx4 v48, s[12:15], s54 offen lds
    s_add_u32 m0, s42, 66560
    s_nop 0
    buffer_load_dwordx4 v49, s[12:15], s54 offen lds
    s_add_u32 m0, s42, 73728
    s_nop 0
    buffer_load_dwordx4 v50, s[12:15], s54 offen lds
    s_add_u32 m0, s42, 74752
    s_nop 0
    buffer_load_dwordx4 v51, s[12:15], s54 offen lds
    s_add_u32 m0, s42, 81920
    s_nop 0
    buffer_load_dwordx4 v52, s[12:15], s54 offen lds
    s_add_u32 m0, s42, 82944
    s_nop 0
    buffer_load_dwordx4 v53, s[12:15], s54 offen lds
    s_add_u32 m0, s42, 90112
    s_nop 0
    buffer_load_dwordx4 v54, s[12:15], s54 offen lds
    s_add_u32 m0, s42, 91136
    s_nop 0
    buffer_load_dwordx4 v55, s[12:15], s54 offen lds
    s_add_u32 s54, s54, 131072
    s_waitcnt lgkmcnt(0)
    v_add_u32 v60, 131072, v56
    v_add_u32 v61, 131072, v57
    v_add_u32 v62, 131072, v58
    v_add_u32 v63, 131072, v59
    s_waitcnt vmcnt(24)
    s_barrier
    ds_read_b64_tr_b16 a[128:129], v60 offset:0
    ds_read_b64_tr_b16 a[130:131], v60 offset:512
    ds_read_b64_tr_b16 a[132:133], v61 offset:0
    ds_read_b64_tr_b16 a[134:135], v61 offset:512
    ds_read_b64_tr_b16 a[136:137], v62 offset:0
    ds_read_b64_tr_b16 a[138:139], v62 offset:512
    ds_read_b64_tr_b16 a[140:141], v63 offset:0
    ds_read_b64_tr_b16 a[142:143], v63 offset:512
    ds_read_b64_tr_b16 a[144:145], v60 offset:4096
    ds_read_b64_tr_b16 a[146:147], v60 offset:4608
    ds_read_b64_tr_b16 a[148:149], v61 offset:4096
    ds_read_b64_tr_b16 a[150:151], v61 offset:4608
    ds_read_b64_tr_b16 a[152:153], v62 offset:4096
    ds_read_b64_tr_b16 a[154:155], v62 offset:4608
    ds_read_b64_tr_b16 a[156:157], v63 offset:4096
    ds_read_b64_tr_b16 a[158:159], v63 offset:4608
    s_add_u32 m0, s42, 98304
    s_nop 0
    buffer_load_dwordx4 v48, s[12:15], s54 offen lds
    s_add_u32 m0, s42, 99328
    s_nop 0
    buffer_load_dwordx4 v49, s[12:15], s54 offen lds
    s_add_u32 m0, s42, 106496
    s_nop 0
    buffer_load_dwordx4 v50, s[12:15], s54 offen lds
    s_add_u32 m0, s42, 107520
    s_nop 0
    buffer_load_dwordx4 v51, s[12:15], s54 offen lds
    s_add_u32 m0, s42, 114688
    s_nop 0
    buffer_load_dwordx4 v52, s[12:15], s54 offen lds
    s_add_u32 m0, s42, 115712
    s_nop 0
    buffer_load_dwordx4 v53, s[12:15], s54 offen lds
    s_add_u32 m0, s42, 122880
    s_nop 0
    buffer_load_dwordx4 v54, s[12:15], s54 offen lds
    s_add_u32 m0, s42, 123904
    s_nop 0
    buffer_load_dwordx4 v55, s[12:15], s54 offen lds
    s_add_u32 s54, s54, 131072
    s_waitcnt lgkmcnt(0)
    v_add_u32 v60, 0, v56
    v_add_u32 v61, 0, v57
    v_add_u32 v62, 0, v58
    v_add_u32 v63, 0, v59
    s_waitcnt vmcnt(24)
    s_barrier
    ds_read_b64_tr_b16 a[160:161], v60 offset:0
    ds_read_b64_tr_b16 a[162:163], v60 offset:512
    ds_read_b64_tr_b16 a[164:165], v61 offset:0
    ds_read_b64_tr_b16 a[166:167], v61 offset:512
    ds_read_b64_tr_b16 a[168:169], v62 offset:0
    ds_read_b64_tr_b16 a[170:171], v62 offset:512
    ds_read_b64_tr_b16 a[172:173], v63 offset:0
    ds_read_b64_tr_b16 a[174:175], v63 offset:512
    ds_read_b64_tr_b16 a[176:177], v60 offset:4096
    ds_read_b64_tr_b16 a[178:179], v60 offset:4608
    ds_read_b64_tr_b16 a[180:181], v61 offset:4096
    ds_read_b64_tr_b16 a[182:183], v61 offset:4608
    ds_read_b64_tr_b16 a[184:185], v62 offset:4096
    ds_read_b64_tr_b16 a[186:187], v62 offset:4608
    ds_read_b64_tr_b16 a[188:189], v63 offset:4096
    ds_read_b64_tr_b16 a[190:191], v63 offset:4608
    s_add_u32 m0, s42, 131072
    s_nop 0
    buffer_load_dwordx4 v48, s[12:15], s54 offen lds
    s_add_u32 m0, s42, 132096
    s_nop 0
    buffer_load_dwordx4 v49, s[12:15], s54 offen lds
    s_add_u32 m0, s42, 139264
    s_nop 0
    buffer_load_dwordx4 v50, s[12:15], s54 offen lds
    s_add_u32 m0, s42, 140288
    s_nop 0
    buffer_load_dwordx4 v51, s[12:15], s54 offen lds
    s_add_u32 m0, s42, 147456
    s_nop 0
    buffer_load_dwordx4 v52, s[12:15], s54 offen lds
    s_add_u32 m0, s42, 148480
    s_nop 0
    buffer_load_dwordx4 v53, s[12:15], s54 offen lds
    s_add_u32 m0, s42, 155648
    s_nop 0
    buffer_load_dwordx4 v54, s[12:15], s54 offen lds
    s_add_u32 m0, s42, 156672
    s_nop 0
    buffer_load_dwordx4 v55, s[12:15], s54 offen lds
    s_add_u32 s54, s54, 131072
    s_waitcnt lgkmcnt(0)
    v_add_u32 v60, 32768, v56
    v_add_u32 v61, 32768, v57
    v_add_u32 v62, 32768, v58
    v_add_u32 v63, 32768, v59
    s_waitcnt vmcnt(24)
    s_barrier
    ds_read_b64_tr_b16 a[192:193], v60 offset:0
    ds_read_b64_tr_b16 a[194:195], v60 offset:512
    ds_read_b64_tr_b16 a[196:197], v61 offset:0
    ds_read_b64_tr_b16 a[198:199], v61 offset:512
    ds_read_b64_tr_b16 a[200:201], v62 offset:0
    ds_read_b64_tr_b16 a[202:203], v62 offset:512
    ds_read_b64_tr_b16 a[204:205], v63 offset:0
    ds_read_b64_tr_b16 a[206:207], v63 offset:512
    ds_read_b64_tr_b16 a[208:209], v60 offset:4096
    ds_read_b64_tr_b16 a[210:211], v60 offset:4608
    ds_read_b64_tr_b16 a[212:213], v61 offset:4096
    ds_read_b64_tr_b16 a[214:215], v61 offset:4608
    ds_read_b64_tr_b16 a[216:217], v62 offset:4096
    ds_read_b64_tr_b16 a[218:219], v62 offset:4608
    ds_read_b64_tr_b16 a[220:221], v63 offset:4096
    ds_read_b64_tr_b16 a[222:223], v63 offset:4608
    s_add_u32 m0, s42, 0
    s_nop 0
    buffer_load_dwordx4 v48, s[12:15], s54 offen lds
    s_add_u32 m0, s42, 1024
    s_nop 0
    buffer_load_dwordx4 v49, s[12:15], s54 offen lds
    s_add_u32 m0, s42, 8192
    s_nop 0
    buffer_load_dwordx4 v50, s[12:15], s54 offen lds
    s_add_u32 m0, s42, 9216
    s_nop 0
    buffer_load_dwordx4 v51, s[12:15], s54 offen lds
    s_add_u32 m0, s42, 16384
    s_nop 0
    buffer_load_dwordx4 v52, s[12:15], s54 offen lds
    s_add_u32 m0, s42, 17408
    s_nop 0
    buffer_load_dwordx4 v53, s[12:15], s54 offen lds
    s_add_u32 m0, s42, 24576
    s_nop 0
    buffer_load_dwordx4 v54, s[12:15], s54 offen lds
    s_add_u32 m0, s42, 25600
    s_nop 0
    buffer_load_dwordx4 v55, s[12:15], s54 offen lds
    s_add_u32 s54, s54, 131072
    s_waitcnt lgkmcnt(0)
    v_add_u32 v60, 65536, v56
    v_add_u32 v61, 65536, v57
    v_add_u32 v62, 65536, v58
    v_add_u32 v63, 65536, v59
    s_waitcnt vmcnt(24)
    s_barrier
    ds_read_b64_tr_b16 a[224:225], v60 offset:0
    ds_read_b64_tr_b16 a[226:227], v60 offset:512
    ds_read_b64_tr_b16 a[228:229], v61 offset:0
    ds_read_b64_tr_b16 a[230:231], v61 offset:512
    ds_read_b64_tr_b16 a[232:233], v62 offset:0
    ds_read_b64_tr_b16 a[234:235], v62 offset:512
    ds_read_b64_tr_b16 a[236:237], v63 offset:0
    ds_read_b64_tr_b16 a[238:239], v63 offset:512
    ds_read_b64_tr_b16 a[240:241], v60 offset:4096
    ds_read_b64_tr_b16 a[242:243], v60 offset:4608
    ds_read_b64_tr_b16 a[244:245], v61 offset:4096
    ds_read_b64_tr_b16 a[246:247], v61 offset:4608
    ds_read_b64_tr_b16 a[248:249], v62 offset:4096
    ds_read_b64_tr_b16 a[250:251], v62 offset:4608
    ds_read_b64_tr_b16 a[252:253], v63 offset:4096
    ds_read_b64_tr_b16 a[254:255], v63 offset:4608
    s_add_u32 m0, s42, 32768
    s_nop 0
    buffer_load_dwordx4 v48, s[12:15], s54 offen lds
    s_add_u32 m0, s42, 33792
    s_nop 0
    buffer_load_dwordx4 v49, s[12:15], s54 offen lds
    s_add_u32 m0, s42, 40960
    s_nop 0
    buffer_load_dwordx4 v50, s[12:15], s54 offen lds
    s_add_u32 m0, s42, 41984
    s_nop 0
    buffer_load_dwordx4 v51, s[12:15], s54 offen lds
    s_add_u32 m0, s42, 49152
    s_nop 0
    buffer_load_dwordx4 v52, s[12:15], s54 offen lds
    s_add_u32 m0, s42, 50176
    s_nop 0
    buffer_load_dwordx4 v53, s[12:15], s54 offen lds
    s_add_u32 m0, s42, 57344
    s_nop 0
    buffer_load_dwordx4 v54, s[12:15], s54 offen lds
    s_add_u32 m0, s42, 58368
    s_nop 0
    buffer_load_dwordx4 v55, s[12:15], s54 offen lds
    s_add_u32 s54, s54, 131072
    s_waitcnt lgkmcnt(0)
    v_add_u32 v60, 98304, v56
    v_add_u32 v61, 98304, v57
    v_add_u32 v62, 98304, v58
    v_add_u32 v63, 98304, v59
    s_waitcnt vmcnt(24)
    s_barrier
    ds_read_b64_tr_b16 v[128:129], v60 offset:0
    ds_read_b64_tr_b16 v[130:131], v60 offset:512
    ds_read_b64_tr_b16 v[132:133], v61 offset:0
    ds_read_b64_tr_b16 v[134:135], v61 offset:512
    ds_read_b64_tr_b16 v[136:137], v62 offset:0
    ds_read_b64_tr_b16 v[138:139], v62 offset:512
    ds_read_b64_tr_b16 v[140:141], v63 offset:0
    ds_read_b64_tr_b16 v[142:143], v63 offset:512
    ds_read_b64_tr_b16 v[144:145], v60 offset:4096
    ds_read_b64_tr_b16 v[146:147], v60 offset:4608
    ds_read_b64_tr_b16 v[148:149], v61 offset:4096
    ds_read_b64_tr_b16 v[150:151], v61 offset:4608
    ds_read_b64_tr_b16 v[152:153], v62 offset:4096
    ds_read_b64_tr_b16 v[154:155], v62 offset:4608
    ds_read_b64_tr_b16 v[156:157], v63 offset:4096
    ds_read_b64_tr_b16 v[158:159], v63 offset:4608
    s_waitcnt lgkmcnt(0)
    v_add_u32 v60, 131072, v56
    v_add_u32 v61, 131072, v57
    v_add_u32 v62, 131072, v58
    v_add_u32 v63, 131072, v59
    s_waitcnt vmcnt(16)
    s_barrier
    ds_read_b64_tr_b16 v[160:161], v60 offset:0
    ds_read_b64_tr_b16 v[162:163], v60 offset:512
    ds_read_b64_tr_b16 v[164:165], v61 offset:0
    ds_read_b64_tr_b16 v[166:167], v61 offset:512
    ds_read_b64_tr_b16 v[168:169], v62 offset:0
    ds_read_b64_tr_b16 v[170:171], v62 offset:512
    ds_read_b64_tr_b16 v[172:173], v63 offset:0
    ds_read_b64_tr_b16 v[174:175], v63 offset:512
    ds_read_b64_tr_b16 v[176:177], v60 offset:4096
    ds_read_b64_tr_b16 v[178:179], v60 offset:4608
    ds_read_b64_tr_b16 v[180:181], v61 offset:4096
    ds_read_b64_tr_b16 v[182:183], v61 offset:4608
    ds_read_b64_tr_b16 v[184:185], v62 offset:4096
    ds_read_b64_tr_b16 v[186:187], v62 offset:4608
    ds_read_b64_tr_b16 v[188:189], v63 offset:4096
    ds_read_b64_tr_b16 v[190:191], v63 offset:4608
    s_waitcnt lgkmcnt(0)
    v_add_u32 v60, 0, v56
    v_add_u32 v61, 0, v57
    v_add_u32 v62, 0, v58
    v_add_u32 v63, 0, v59
    s_waitcnt vmcnt(8)
    s_barrier
    ds_read_b64_tr_b16 v[192:193], v60 offset:0
    ds_read_b64_tr_b16 v[194:195], v60 offset:512
    ds_read_b64_tr_b16 v[196:197], v61 offset:0
    ds_read_b64_tr_b16 v[198:199], v61 offset:512
    ds_read_b64_tr_b16 v[200:201], v62 offset:0
    ds_read_b64_tr_b16 v[202:203], v62 offset:512
    ds_read_b64_tr_b16 v[204:205], v63 offset:0
    ds_read_b64_tr_b16 v[206:207], v63 offset:512
    ds_read_b64_tr_b16 v[208:209], v60 offset:4096
    ds_read_b64_tr_b16 v[210:211], v60 offset:4608
    ds_read_b64_tr_b16 v[212:213], v61 offset:4096
    ds_read_b64_tr_b16 v[214:215], v61 offset:4608
    ds_read_b64_tr_b16 v[216:217], v62 offset:4096
    ds_read_b64_tr_b16 v[218:219], v62 offset:4608
    ds_read_b64_tr_b16 v[220:221], v63 offset:4096
    ds_read_b64_tr_b16 v[222:223], v63 offset:4608
    s_waitcnt lgkmcnt(0)
    v_add_u32 v60, 32768, v56
    v_add_u32 v61, 32768, v57
    v_add_u32 v62, 32768, v58
    v_add_u32 v63, 32768, v59
    s_waitcnt vmcnt(0)
    s_barrier
    ds_read_b64_tr_b16 v[224:225], v60 offset:0
    ds_read_b64_tr_b16 v[226:227], v60 offset:512
    ds_read_b64_tr_b16 v[228:229], v61 offset:0
    ds_read_b64_tr_b16 v[230:231], v61 offset:512
    ds_read_b64_tr_b16 v[232:233], v62 offset:0
    ds_read_b64_tr_b16 v[234:235], v62 offset:512
    ds_read_b64_tr_b16 v[236:237], v63 offset:0
    ds_read_b64_tr_b16 v[238:239], v63 offset:512
    ds_read_b64_tr_b16 v[240:241], v60 offset:4096
    ds_read_b64_tr_b16 v[242:243], v60 offset:4608
    ds_read_b64_tr_b16 v[244:245], v61 offset:4096
    ds_read_b64_tr_b16 v[246:247], v61 offset:4608
    ds_read_b64_tr_b16 v[248:249], v62 offset:4096
    ds_read_b64_tr_b16 v[250:251], v62 offset:4608
    ds_read_b64_tr_b16 v[252:253], v63 offset:4096
    ds_read_b64_tr_b16 v[254:255], v63 offset:4608
    s_waitcnt lgkmcnt(0)
    s_barrier
    s_cmp_lg_u32 s32, 0
    s_cbranch_scc1 L_arv60
    s_add_u32 s20, s82, 0x80
    s_addc_u32 s21, s83, 0
    s_mov_b32 s22, 0x4
    s_mov_b32 s23, 0x00020000
    buffer_load_dword v80, v124, s[20:23], 0 offen sc1
    s_waitcnt vmcnt(0)
    v_cmp_eq_u32 vcc, v124, v80
    s_cbranch_vccnz L_spin61
L_back62:
L_arv60:
    s_add_u32 s96, s41, 8126464
    s_mov_b32 s98, s41
    s_mov_b32 s45, 0x5560000
    buffer_load_dword v96, v6, s[16:19], s45 offen sc1
    s_waitcnt vmcnt(0)
    v_cmp_ne_u32 vcc, 0, v96
    s_cbranch_vccnz L_spin63
L_back64:
    s_barrier
    s_add_u32 m0, s43, 0
    s_add_u32 s42, s41, 0
    buffer_load_dwordx4 v1, s[16:19], s42 offen offset:0 sc1 lds
    buffer_load_dwordx4 v1, s[16:19], s42 offen offset:1024 sc1 lds
    buffer_load_dwordx4 v1, s[16:19], s42 offen offset:2048 sc1 lds
    s_add_u32 m0, s43, 12288
    s_add_u32 s42, s41, 12288
    buffer_load_dwordx4 v1, s[16:19], s42 offen offset:0 sc1 lds
    buffer_load_dwordx4 v1, s[16:19], s42 offen offset:1024 sc1 lds
    buffer_load_dwordx4 v1, s[16:19], s42 offen offset:2048 sc1 lds
    s_add_u32 m0, s43, 24576
    s_add_u32 s42, s41, 24576
    buffer_load_dwordx4 v1, s[16:19], s42 offen offset:0 sc1 lds
    buffer_load_dwordx4 v1, s[16:19], s42 offen offset:1024 sc1 lds
    buffer_load_dwordx4 v1, s[16:19], s42 offen offset:2048 sc1 lds
    s_add_u32 s45, s45, 131072
    s_waitcnt vmcnt(0) lgkmcnt(0)
    s_barrier
    s_mov_b32 s52, 0x5e00000
    s_mov_b32 s46, 0x5e00000
    s_add_u32 s20, s84, 0x5e00000
    s_addc_u32 s21, s85, 0
    s_mov_b32 s22, 0x400000
    s_mov_b32 s23, 0x00020000
    ds_read_b128 v[80:83], v2 offset:0
    ds_read_b128 v[84:87], v3 offset:0
    s_mov_b32 s36, 0
    s_waitcnt lgkmcnt(0)
    s_nop 7
L_bs_b0:
    s_waitcnt lgkmcnt(0)
    v_mfma_f32_16x16x32_bf16 v[16:19], a[0:3], v[80:83], 0
    s_and_b32 s44, s90, 0xffffffff
    ds_read_b128 v[88:91], v2 offset:2048
    s_cmp_eq_u32 s36, 0
    v_mfma_f32_16x16x32_bf16 v[24:27], a[0:3], v[84:87], 0
    s_cselect_b32 s44, 0x5e00000, s44
    s_xor_b32 s49, s44, 0
    v_cvt_pk_bf16_f32 v48, v48, v49
    v_mfma_f32_16x16x32_bf16 v[28:31], a[4:7], v[84:87], 0
    ds_read_b128 v[92:95], v3 offset:2048
    v_cvt_pk_bf16_f32 v49, v50, v51
    v_mfma_f32_16x16x32_bf16 v[20:23], a[4:7], v[80:83], 0
    v_cvt_pk_bf16_f32 v50, v52, v53
    v_cvt_pk_bf16_f32 v51, v54, v55
    v_mfma_f32_16x16x32_bf16 v[32:35], a[8:11], v[80:83], 0
    buffer_store_dwordx4 v[48:51], v1, s[16:19], s49 offen offset:3072 sc1
    v_mfma_f32_16x16x32_bf16 v[40:43], a[8:11], v[84:87], 0
    s_xor_b32 s49, s44, 16384
    v_cvt_pk_bf16_f32 v56, v56, v57
    v_cvt_pk_bf16_f32 v57, v58, v59
    v_mfma_f32_16x16x32_bf16 v[44:47], a[12:15], v[84:87], 0
    v_cvt_pk_bf16_f32 v58, v60, v61
    v_cvt_pk_bf16_f32 v59, v62, v63
    v_mfma_f32_16x16x32_bf16 v[36:39], a[12:15], v[80:83], 0
    s_waitcnt lgkmcnt(0)
    v_mfma_f32_16x16x32_bf16 v[16:19], a[16:19], v[88:91], v[16:19]
    ds_read_b128 v[80:83], v2 offset:4096
    v_mfma_f32_16x16x32_bf16 v[24:27], a[16:19], v[92:95], v[24:27]
    buffer_store_dwordx4 v[56:59], v1, s[16:19], s49 offen offset:3072 sc1
    v_mfma_f32_16x16x32_bf16 v[28:31], a[20:23], v[92:95], v[28:31]
    s_xor_b32 s49, s44, 32768
    ds_read_b128 v[84:87], v3 offset:4096
    v_cvt_pk_bf16_f32 v64, v64, v65
    v_mfma_f32_16x16x32_bf16 v[20:23], a[20:23], v[88:91], v[20:23]
    v_cvt_pk_bf16_f32 v65, v66, v67
    v_cvt_pk_bf16_f32 v66, v68, v69
    v_mfma_f32_16x16x32_bf16 v[32:35], a[24:27], v[88:91], v[32:35]
    v_cvt_pk_bf16_f32 v67, v70, v71
    v_mfma_f32_16x16x32_bf16 v[40:43], a[24:27], v[92:95], v[40:43]
    buffer_store_dwordx4 v[64:67], v1, s[16:19], s49 offen offset:3072 sc1
    v_mfma_f32_16x16x32_bf16 v[44:47], a[28:31], v[92:95], v[44:47]
    s_xor_b32 s49, s44, 49152
    v_cvt_pk_bf16_f32 v72, v72, v73
    v_cvt_pk_bf16_f32 v73, v74, v75
    v_mfma_f32_16x16x32_bf16 v[36:39], a[28:31], v[88:91], v[36:39]
    s_waitcnt lgkmcnt(0)
    v_cvt_pk_bf16_f32 v74, v76, v77
    v_cvt_pk_bf16_f32 v75, v78, v79
    v_mfma_f32_16x16x32_bf16 v[16:19], a[32:35], v[80:83], v[16:19]
    s_add_u32 m0, s43, 36864
    ds_read_b128 v[88:91], v2 offset:6144
    s_add_u32 s42, s41, 36864
    v_mfma_f32_16x16x32_bf16 v[24:27], a[32:35], v[84:87], v[24:27]
    buffer_store_dwordx4 v[72:75], v1, s[16:19], s49 offen offset:3072 sc1
    v_mfma_f32_16x16x32_bf16 v[28:31], a[36:39], v[84:87], v[28:31]
    s_add_u32 s90, s90, 262144
    ds_read_b128 v[92:95], v3 offset:6144
    v_mfma_f32_16x16x32_bf16 v[20:23], a[36:39], v[80:83], v[20:23]
    v_mfma_f32_16x16x32_bf16 v[32:35], a[40:43], v[80:83], v[32:35]
    buffer_load_dwordx4 v1, s[16:19], s42 offen offset:0 sc1 lds
    v_mfma_f32_16x16x32_bf16 v[40:43], a[40:43], v[84:87], v[40:43]
    v_mfma_f32_16x16x32_bf16 v[44:47], a[44:47], v[84:87], v[44:47]
    v_mfma_f32_16x16x32_bf16 v[36:39], a[44:47], v[80:83], v[36:39]
    s_waitcnt lgkmcnt(0)
    v_mfma_f32_16x16x32_bf16 v[16:19], a[48:51], v[88:91], v[16:19]
    ds_read_b128 v[80:83], v2 offset:8192
    v_mfma_f32_16x16x32_bf16 v[24:27], a[48:51], v[92:95], v[24:27]
    v_mfma_f32_16x16x32_bf16 v[28:31], a[52:55], v[92:95], v[28:31]
    ds_read_b128 v[84:87], v3 offset:8192
    v_mfma_f32_16x16x32_bf16 v[20:23], a[52:55], v[88:91], v[20:23]
    buffer_load_dwordx4 v1, s[16:19], s42 offen offset:1024 sc1 lds
    v_mfma_f32_16x16x32_bf16 v[32:35], a[56:59], v[88:91], v[32:35]
    v_mfma_f32_16x16x32_bf16 v[40:43], a[56:59], v[92:95], v[40:43]
    v_mfma_f32_16x16x32_bf16 v[44:47], a[60:63], v[92:95], v[44:47]
    v_mfma_f32_16x16x32_bf16 v[36:39], a[60:63], v[88:91], v[36:39]
    s_waitcnt lgkmcnt(0)
    v_mfma_f32_16x16x32_bf16 v[16:19], a[64:67], v[80:83], v[16:19]
    ds_read_b128 v[88:91], v2 offset:10240
    v_mfma_f32_16x16x32_bf16 v[24:27], a[64:67], v[84:87], v[24:27]
    buffer_load_dwordx4 v1, s[16:19], s42 offen offset:2048 sc1 lds
    v_mfma_f32_16x16x32_bf16 v[28:31], a[68:71], v[84:87], v[28:31]
    s_add_u32 s98, s98, 262144
    ds_read_b128 v[92:95], v3 offset:10240
    s_min_u32 s98, s98, s96
    v_mfma_f32_16x16x32_bf16 v[20:23], a[68:71], v[80:83], v[20:23]
    s_and_b32 s41, s98, 0xffffffff
    v_mfma_f32_16x16x32_bf16 v[32:35], a[72:75], v[80:83], v[32:35]
    v_mfma_f32_16x16x32_bf16 v[40:43], a[72:75], v[84:87], v[40:43]
    v_mfma_f32_16x16x32_bf16 v[44:47], a[76:79], v[84:87], v[44:47]
    v_mfma_f32_16x16x32_bf16 v[36:39], a[76:79], v[80:83], v[36:39]
    s_waitcnt vmcnt(7) lgkmcnt(0)
    s_barrier
    v_mfma_f32_16x16x32_bf16 v[16:19], a[80:83], v[88:91], v[16:19]
    ds_read_b128 v[80:83], v2 offset:12288
    v_mfma_f32_16x16x32_bf16 v[24:27], a[80:83], v[92:95], v[24:27]
    v_mfma_f32_16x16x32_bf16 v[28:31], a[84:87], v[92:95], v[28:31]
    ds_read_b128 v[84:87], v3 offset:12288
    v_mfma_f32_16x16x32_bf16 v[20:23], a[84:87], v[88:91], v[20:23]
    v_mfma_f32_16x16x32_bf16 v[32:35], a[88:91], v[88:91], v[32:35]
    v_mfma_f32_16x16x32_bf16 v[40:43], a[88:91], v[92:95], v[40:43]
    v_mfma_f32_16x16x32_bf16 v[44:47], a[92:95], v[92:95], v[44:47]
    v_mfma_f32_16x16x32_bf16 v[36:39], a[92:95], v[88:91], v[36:39]
    s_waitcnt lgkmcnt(0)
    v_mfma_f32_16x16x32_bf16 v[16:19], a[96:99], v[80:83], v[16:19]
    ds_read_b128 v[88:91], v2 offset:14336
    v_mfma_f32_16x16x32_bf16 v[24:27], a[96:99], v[84:87], v[24:27]
    v_mfma_f32_16x16x32_bf16 v[28:31], a[100:103], v[84:87], v[28:31]
    ds_read_b128 v[92:95], v3 offset:14336
    v_mfma_f32_16x16x32_bf16 v[20:23], a[100:103], v[80:83], v[20:23]
    v_mfma_f32_16x16x32_bf16 v[32:35], a[104:107], v[80:83], v[32:35]
    v_mfma_f32_16x16x32_bf16 v[40:43], a[104:107], v[84:87], v[40:43]
    v_mfma_f32_16x16x32_bf16 v[44:47], a[108:111], v[84:87], v[44:47]
    v_mfma_f32_16x16x32_bf16 v[36:39], a[108:111], v[80:83], v[36:39]
    s_waitcnt lgkmcnt(0)
    v_mfma_f32_16x16x32_bf16 v[16:19], a[112:115], v[88:91], v[16:19]
    ds_read_b128 v[80:83], v2 offset:16384
    v_mfma_f32_16x16x32_bf16 v[24:27], a[112:115], v[92:95], v[24:27]
    v_mfma_f32_16x16x32_bf16 v[28:31], a[116:119], v[92:95], v[28:31]
    ds_read_b128 v[84:87], v3 offset:16384
    v_mfma_f32_16x16x32_bf16 v[20:23], a[116:119], v[88:91], v[20:23]
    v_mfma_f32_16x16x32_bf16 v[32:35], a[120:123], v[88:91], v[32:35]
    v_mfma_f32_16x16x32_bf16 v[40:43], a[120:123], v[92:95], v[40:43]
    v_mfma_f32_16x16x32_bf16 v[44:47], a[124:127], v[92:95], v[44:47]
    v_mfma_f32_16x16x32_bf16 v[36:39], a[124:127], v[88:91], v[36:39]
    s_waitcnt lgkmcnt(0)
    v_mfma_f32_16x16x32_bf16 v[16:19], a[128:131], v[80:83], v[16:19]
    ds_read_b128 v[88:91], v2 offset:18432
    v_mfma_f32_16x16x32_bf16 v[24:27], a[128:131], v[84:87], v[24:27]
    v_mfma_f32_16x16x32_bf16 v[28:31], a[132:135], v[84:87], v[28:31]
    ds_read_b128 v[92:95], v3 offset:18432
    v_mfma_f32_16x16x32_bf16 v[20:23], a[132:135], v[80:83], v[20:23]
    v_mfma_f32_16x16x32_bf16 v[32:35], a[136:139], v[80:83], v[32:35]
    v_mfma_f32_16x16x32_bf16 v[40:43], a[136:139], v[84:87], v[40:43]
    v_mfma_f32_16x16x32_bf16 v[44:47], a[140:143], v[84:87], v[44:47]
    v_mfma_f32_16x16x32_bf16 v[36:39], a[140:143], v[80:83], v[36:39]
    s_waitcnt lgkmcnt(0)
    v_mfma_f32_16x16x32_bf16 v[16:19], a[144:147], v[88:91], v[16:19]
    ds_read_b128 v[80:83], v2 offset:20480
    v_mfma_f32_16x16x32_bf16 v[24:27], a[144:147], v[92:95], v[24:27]
    v_mfma_f32_16x16x32_bf16 v[28:31], a[148:151], v[92:95], v[28:31]
    ds_read_b128 v[84:87], v3 offset:20480
    v_mfma_f32_16x16x32_bf16 v[20:23], a[148:151], v[88:91], v[20:23]
    buffer_load_dword v96, v6, s[16:19], s45 offen sc1
    v_mfma_f32_16x16x32_bf16 v[32:35], a[152:155], v[88:91], v[32:35]
    s_add_u32 m0, s43, 98304
    s_add_u32 s42, s41, 0
    v_mfma_f32_16x16x32_bf16 v[40:43], a[152:155], v[92:95], v[40:43]
    v_mfma_f32_16x16x32_bf16 v[44:47], a[156:159], v[92:95], v[44:47]
    v_mfma_f32_16x16x32_bf16 v[36:39], a[156:159], v[88:91], v[36:39]
    s_waitcnt lgkmcnt(0)
    v_mfma_f32_16x16x32_bf16 v[16:19], a[160:163], v[80:83], v[16:19]
    ds_read_b128 v[88:91], v2 offset:22528
    v_mfma_f32_16x16x32_bf16 v[24:27], a[160:163], v[84:87], v[24:27]
    v_mfma_f32_16x16x32_bf16 v[28:31], a[164:167], v[84:87], v[28:31]
    ds_read_b128 v[92:95], v3 offset:22528
    v_mfma_f32_16x16x32_bf16 v[20:23], a[164:167], v[80:83], v[20:23]
    v_mfma_f32_16x16x32_bf16 v[32:35], a[168:171], v[80:83], v[32:35]
    v_mfma_f32_16x16x32_bf16 v[40:43], a[168:171], v[84:87], v[40:43]
    v_mfma_f32_16x16x32_bf16 v[44:47], a[172:175], v[84:87], v[44:47]
    v_mfma_f32_16x16x32_bf16 v[36:39], a[172:175], v[80:83], v[36:39]
    s_waitcnt lgkmcnt(0)
    v_mfma_f32_16x16x32_bf16 v[16:19], a[176:179], v[88:91], v[16:19]
    ds_read_b128 v[80:83], v2 offset:24576
    v_mfma_f32_16x16x32_bf16 v[24:27], a[176:179], v[92:95], v[24:27]
    v_mfma_f32_16x16x32_bf16 v[28:31], a[180:183], v[92:95], v[28:31]
    ds_read_b128 v[84:87], v3 offset:24576
    v_mfma_f32_16x16x32_bf16 v[20:23], a[180:183], v[88:91], v[20:23]
    v_mfma_f32_16x16x32_bf16 v[32:35], a[184:187], v[88:91], v[32:35]
    v_mfma_f32_16x16x32_bf16 v[40:43], a[184:187], v[92:95], v[40:43]
    v_mfma_f32_16x16x32_bf16 v[44:47], a[188:191], v[92:95], v[44:47]
    v_mfma_f32_16x16x32_bf16 v[36:39], a[188:191], v[88:91], v[36:39]
    s_waitcnt lgkmcnt(0)
    v_mfma_f32_16x16x32_bf16 v[16:19], a[192:195], v[80:83], v[16:19]
    ds_read_b128 v[88:91], v2 offset:26624
    v_mfma_f32_16x16x32_bf16 v[24:27], a[192:195], v[84:87], v[24:27]
    v_mfma_f32_16x16x32_bf16 v[28:31], a[196:199], v[84:87], v[28:31]
    ds_read_b128 v[92:95], v3 offset:26624
    v_mfma_f32_16x16x32_bf16 v[20:23], a[196:199], v[80:83], v[20:23]
    v_mfma_f32_16x16x32_bf16 v[32:35], a[200:203], v[80:83], v[32:35]
    v_mfma_f32_16x16x32_bf16 v[40:43], a[200:203], v[84:87], v[40:43]
    v_mfma_f32_16x16x32_bf16 v[44:47], a[204:207], v[84:87], v[44:47]
    v_mfma_f32_16x16x32_bf16 v[36:39], a[204:207], v[80:83], v[36:39]
    s_waitcnt lgkmcnt(0)
    v_mfma_f32_16x16x32_bf16 v[16:19], a[208:211], v[88:91], v[16:19]
    ds_read_b128 v[80:83], v2 offset:28672
    v_mfma_f32_16x16x32_bf16 v[24:27], a[208:211], v[92:95], v[24:27]
    v_mfma_f32_16x16x32_bf16 v[28:31], a[212:215], v[92:95], v[28:31]
    ds_read_b128 v[84:87], v3 offset:28672
    v_mfma_f32_16x16x32_bf16 v[20:23], a[212:215], v[88:91], v[20:23]
    v_mfma_f32_16x16x32_bf16 v[32:35], a[216:219], v[88:91], v[32:35]
    v_mfma_f32_16x16x32_bf16 v[40:43], a[216:219], v[92:95], v[40:43]
    v_mfma_f32_16x16x32_bf16 v[44:47], a[220:223], v[92:95], v[44:47]
    v_mfma_f32_16x16x32_bf16 v[36:39], a[220:223], v[88:91], v[36:39]
    s_waitcnt lgkmcnt(0)
    v_mfma_f32_16x16x32_bf16 v[16:19], a[224:227], v[80:83], v[16:19]
    ds_read_b128 v[88:91], v2 offset:30720
    v_mfma_f32_16x16x32_bf16 v[24:27], a[224:227], v[84:87], v[24:27]
    v_mfma_f32_16x16x32_bf16 v[28:31], a[228:231], v[84:87], v[28:31]
    ds_read_b128 v[92:95], v3 offset:30720
    v_mfma_f32_16x16x32_bf16 v[20:23], a[228:231], v[80:83], v[20:23]
    v_mfma_f32_16x16x32_bf16 v[32:35], a[232:235], v[80:83], v[32:35]
    v_mfma_f32_16x16x32_bf16 v[40:43], a[232:235], v[84:87], v[40:43]
    v_mfma_f32_16x16x32_bf16 v[44:47], a[236:239], v[84:87], v[44:47]
    v_mfma_f32_16x16x32_bf16 v[36:39], a[236:239], v[80:83], v[36:39]
    s_waitcnt lgkmcnt(0)
    v_mfma_f32_16x16x32_bf16 v[16:19], a[240:243], v[88:91], v[16:19]
    s_waitcnt vmcnt(0)
    ds_read_b128 v[80:83], v2 offset:32768
    v_cmp_ne_u32 vcc, 0, v96
    v_mfma_f32_16x16x32_bf16 v[24:27], a[240:243], v[92:95], v[24:27]
    v_mfma_f32_16x16x32_bf16 v[28:31], a[244:247], v[92:95], v[28:31]
    s_cbranch_vccnz L_spin65
L_back66:
    ds_read_b128 v[84:87], v3 offset:32768
    s_barrier
    v_mfma_f32_16x16x32_bf16 v[20:23], a[244:247], v[88:91], v[20:23]
    buffer_load_dwordx4 v1, s[16:19], s42 offen offset:0 sc1 lds
    v_mfma_f32_16x16x32_bf16 v[32:35], a[248:251], v[88:91], v[32:35]
    v_mfma_f32_16x16x32_bf16 v[40:43], a[248:251], v[92:95], v[40:43]
    v_mfma_f32_16x16x32_bf16 v[44:47], a[252:255], v[92:95], v[44:47]
    buffer_load_dwordx4 v1, s[16:19], s42 offen offset:1024 sc1 lds
    v_mfma_f32_16x16x32_bf16 v[36:39], a[252:255], v[88:91], v[36:39]
    s_waitcnt lgkmcnt(0)
    v_mfma_f32_16x16x32_bf16 v[16:19], v[128:131], v[80:83], v[16:19]
    ds_read_b128 v[88:91], v2 offset:34816
    v_mfma_f32_16x16x32_bf16 v[24:27], v[128:131], v[84:87], v[24:27]
    buffer_load_dwordx4 v1, s[16:19], s42 offen offset:2048 sc1 lds
    v_mfma_f32_16x16x32_bf16 v[28:31], v[132:135], v[84:87], v[28:31]
    ds_read_b128 v[92:95], v3 offset:34816
    v_mfma_f32_16x16x32_bf16 v[20:23], v[132:135], v[80:83], v[20:23]
    v_mfma_f32_16x16x32_bf16 v[32:35], v[136:139], v[80:83], v[32:35]
    buffer_store_dword v124, v124, s[16:19], s91 offen sc1
    v_mfma_f32_16x16x32_bf16 v[40:43], v[136:139], v[84:87], v[40:43]
    s_add_u32 s91, s91, 131072
    s_add_u32 m0, s43, 110592
    s_add_u32 s42, s41, 12288
    v_mfma_f32_16x16x32_bf16 v[44:47], v[140:143], v[84:87], v[44:47]
    v_mfma_f32_16x16x32_bf16 v[36:39], v[140:143], v[80:83], v[36:39]
    s_waitcnt lgkmcnt(0)
    v_mfma_f32_16x16x32_bf16 v[16:19], v[144:147], v[88:91], v[16:19]
    ds_read_b128 v[80:83], v2 offset:36864
    v_mfma_f32_16x16x32_bf16 v[24:27], v[144:147], v[92:95], v[24:27]
    v_mfma_f32_16x16x32_bf16 v[28:31], v[148:151], v[92:95], v[28:31]
    ds_read_b128 v[84:87], v3 offset:36864
    v_mfma_f32_16x16x32_bf16 v[20:23], v[148:151], v[88:91], v[20:23]
    buffer_load_dwordx4 v1, s[16:19], s42 offen offset:0 sc1 lds
    v_mfma_f32_16x16x32_bf16 v[32:35], v[152:155], v[88:91], v[32:35]
    v_mfma_f32_16x16x32_bf16 v[40:43], v[152:155], v[92:95], v[40:43]
    v_mfma_f32_16x16x32_bf16 v[44:47], v[156:159], v[92:95], v[44:47]
    v_mfma_f32_16x16x32_bf16 v[36:39], v[156:159], v[88:91], v[36:39]
    s_waitcnt lgkmcnt(0)
    v_mfma_f32_16x16x32_bf16 v[16:19], v[160:163], v[80:83], v[16:19]
    ds_read_b128 v[88:91], v2 offset:38912
    v_mfma_f32_16x16x32_bf16 v[24:27], v[160:163], v[84:87], v[24:27]
    buffer_load_dwordx4 v1, s[16:19], s42 offen offset:1024 sc1 lds
    v_mfma_f32_16x16x32_bf16 v[28:31], v[164:167], v[84:87], v[28:31]
    ds_read_b128 v[92:95], v3 offset:38912
    v_mfma_f32_16x16x32_bf16 v[20:23], v[164:167], v[80:83], v[20:23]
    v_mfma_f32_16x16x32_bf16 v[32:35], v[168:171], v[80:83], v[32:35]
    v_mfma_f32_16x16x32_bf16 v[40:43], v[168:171], v[84:87], v[40:43]
    v_mfma_f32_16x16x32_bf16 v[44:47], v[172:175], v[84:87], v[44:47]
    buffer_load_dwordx4 v1, s[16:19], s42 offen offset:2048 sc1 lds
    v_mfma_f32_16x16x32_bf16 v[36:39], v[172:175], v[80:83], v[36:39]
    s_waitcnt lgkmcnt(0)
    s_add_u32 m0, s43, 122880
    s_add_u32 s42, s41, 24576
    v_mfma_f32_16x16x32_bf16 v[16:19], v[176:179], v[88:91], v[16:19]
    ds_read_b128 v[80:83], v2 offset:40960
    v_mfma_f32_16x16x32_bf16 v[24:27], v[176:179], v[92:95], v[24:27]
    v_mfma_f32_16x16x32_bf16 v[28:31], v[180:183], v[92:95], v[28:31]
    ds_read_b128 v[84:87], v3 offset:40960
    v_mfma_f32_16x16x32_bf16 v[20:23], v[180:183], v[88:91], v[20:23]
    buffer_load_dwordx4 v1, s[16:19], s42 offen offset:0 sc1 lds
    v_mfma_f32_16x16x32_bf16 v[32:35], v[184:187], v[88:91], v[32:35]
    v_mfma_f32_16x16x32_bf16 v[40:43], v[184:187], v[92:95], v[40:43]
    v_mfma_f32_16x16x32_bf16 v[44:47], v[188:191], v[92:95], v[44:47]
    v_mfma_f32_16x16x32_bf16 v[36:39], v[188:191], v[88:91], v[36:39]
    s_waitcnt lgkmcnt(0)
    v_mfma_f32_16x16x32_bf16 v[16:19], v[192:195], v[80:83], v[16:19]
    ds_read_b128 v[88:91], v2 offset:43008
    v_mfma_f32_16x16x32_bf16 v[24:27], v[192:195], v[84:87], v[24:27]
    buffer_load_dwordx4 v1, s[16:19], s42 offen offset:1024 sc1 lds
    v_mfma_f32_16x16x32_bf16 v[28:31], v[196:199], v[84:87], v[28:31]
    ds_read_b128 v[92:95], v3 offset:43008
    v_mfma_f32_16x16x32_bf16 v[20:23], v[196:199], v[80:83], v[20:23]
    v_mfma_f32_16x16x32_bf16 v[32:35], v[200:203], v[80:83], v[32:35]
    v_mfma_f32_16x16x32_bf16 v[40:43], v[200:203], v[84:87], v[40:43]
    v_mfma_f32_16x16x32_bf16 v[44:47], v[204:207], v[84:87], v[44:47]
    buffer_load_dwordx4 v1, s[16:19], s42 offen offset:2048 sc1 lds
    v_mfma_f32_16x16x32_bf16 v[36:39], v[204:207], v[80:83], v[36:39]
    s_waitcnt lgkmcnt(0)
    s_add_u32 s45, s45, 131072
    v_mfma_f32_16x16x32_bf16 v[16:19], v[208:211], v[88:91], v[16:19]
    ds_read_b128 v[80:83], v2 offset:45056
    v_mfma_f32_16x16x32_bf16 v[24:27], v[208:211], v[92:95], v[24:27]
    v_mfma_f32_16x16x32_bf16 v[28:31], v[212:215], v[92:95], v[28:31]
    ds_read_b128 v[84:87], v3 offset:45056
    v_mfma_f32_16x16x32_bf16 v[20:23], v[212:215], v[88:91], v[20:23]
    v_mfma_f32_16x16x32_bf16 v[32:35], v[216:219], v[88:91], v[32:35]
    v_mfma_f32_16x16x32_bf16 v[40:43], v[216:219], v[92:95], v[40:43]
    v_mfma_f32_16x16x32_bf16 v[44:47], v[220:223], v[92:95], v[44:47]
    v_mfma_f32_16x16x32_bf16 v[36:39], v[220:223], v[88:91], v[36:39]
    s_waitcnt lgkmcnt(0)
    v_mfma_f32_16x16x32_bf16 v[16:19], v[224:227], v[80:83], v[16:19]
    ds_read_b128 v[88:91], v2 offset:47104
    v_mfma_f32_16x16x32_bf16 v[24:27], v[224:227], v[84:87], v[24:27]
    v_mfma_f32_16x16x32_bf16 v[28:31], v[228:231], v[84:87], v[28:31]
    ds_read_b128 v[92:95], v3 offset:47104
    v_mfma_f32_16x16x32_bf16 v[20:23], v[228:231], v[80:83], v[20:23]
    v_mfma_f32_16x16x32_bf16 v[32:35], v[232:235], v[80:83], v[32:35]
    v_mfma_f32_16x16x32_bf16 v[40:43], v[232:235], v[84:87], v[40:43]
    v_mfma_f32_16x16x32_bf16 v[44:47], v[236:239], v[84:87], v[44:47]
    v_mfma_f32_16x16x32_bf16 v[36:39], v[236:239], v[80:83], v[36:39]
    s_waitcnt vmcnt(7) lgkmcnt(0)
    s_barrier
    v_mfma_f32_16x16x32_bf16 v[16:19], v[240:243], v[88:91], v[16:19]
    ds_read_b128 v[80:83], v4 offset:0
    v_mfma_f32_16x16x32_bf16 v[24:27], v[240:243], v[92:95], v[24:27]
    v_mfma_f32_16x16x32_bf16 v[28:31], v[244:247], v[92:95], v[28:31]
    ds_read_b128 v[84:87], v5 offset:0
    v_mfma_f32_16x16x32_bf16 v[20:23], v[244:247], v[88:91], v[20:23]
    v_mfma_f32_16x16x32_bf16 v[32:35], v[248:251], v[88:91], v[32:35]
    v_mfma_f32_16x16x32_bf16 v[40:43], v[248:251], v[92:95], v[40:43]
    v_mfma_f32_16x16x32_bf16 v[44:47], v[252:255], v[92:95], v[44:47]
    v_mfma_f32_16x16x32_bf16 v[36:39], v[252:255], v[88:91], v[36:39]
    s_add_u32 s36, s36, 1
L_bs_b1:
    s_waitcnt lgkmcnt(0)
    v_mfma_f32_16x16x32_bf16 v[48:51], a[0:3], v[80:83], 0
    s_and_b32 s44, s90, 0xffffffff
    ds_read_b128 v[88:91], v4 offset:2048
    s_cmp_eq_u32 s36, 0
    v_mfma_f32_16x16x32_bf16 v[56:59], a[0:3], v[84:87], 0
    s_cselect_b32 s44, 0x5e00000, s44
    s_xor_b32 s49, s44, 0
    v_cvt_pk_bf16_f32 v16, v16, v17
    v_mfma_f32_16x16x32_bf16 v[60:63], a[4:7], v[84:87], 0
    ds_read_b128 v[92:95], v5 offset:2048
    v_cvt_pk_bf16_f32 v17, v18, v19
    v_mfma_f32_16x16x32_bf16 v[52:55], a[4:7], v[80:83], 0
    v_cvt_pk_bf16_f32 v18, v20, v21
    v_cvt_pk_bf16_f32 v19, v22, v23
    v_mfma_f32_16x16x32_bf16 v[64:67], a[8:11], v[80:83], 0
    buffer_store_dwordx4 v[16:19], v1, s[16:19], s49 offen offset:3072 sc1
    v_mfma_f32_16x16x32_bf16 v[72:75], a[8:11], v[84:87], 0
    s_xor_b32 s49, s44, 16384
    v_cvt_pk_bf16_f32 v24, v24, v25
    v_cvt_pk_bf16_f32 v25, v26, v27
    v_mfma_f32_16x16x32_bf16 v[76:79], a[12:15], v[84:87], 0
    v_cvt_pk_bf16_f32 v26, v28, v29
    v_cvt_pk_bf16_f32 v27, v30, v31
    v_mfma_f32_16x16x32_bf16 v[68:71], a[12:15], v[80:83], 0
    s_waitcnt lgkmcnt(0)
    v_mfma_f32_16x16x32_bf16 v[48:51], a[16:19], v[88:91], v[48:51]
    ds_read_b128 v[80:83], v4 offset:4096
    v_mfma_f32_16x16x32_bf16 v[56:59], a[16:19], v[92:95], v[56:59]
    buffer_store_dwordx4 v[24:27], v1, s[16:19], s49 offen offset:3072 sc1
    v_mfma_f32_16x16x32_bf16 v[60:63], a[20:23], v[92:95], v[60:63]
    s_xor_b32 s49, s44, 32768
    ds_read_b128 v[84:87], v5 offset:4096
    v_cvt_pk_bf16_f32 v32, v32, v33
    v_mfma_f32_16x16x32_bf16 v[52:55], a[20:23], v[88:91], v[52:55]
    v_cvt_pk_bf16_f32 v33, v34, v35
    v_cvt_pk_bf16_f32 v34, v36, v37
    v_mfma_f32_16x16x32_bf16 v[64:67], a[24:27], v[88:91], v[64:67]
    v_cvt_pk_bf16_f32 v35, v38, v39
    v_mfma_f32_16x16x32_bf16 v[72:75], a[24:27], v[92:95], v[72:75]
    buffer_store_dwordx4 v[32:35], v1, s[16:19], s49 offen offset:3072 sc1
    v_mfma_f32_16x16x32_bf16 v[76:79], a[28:31], v[92:95], v[76:79]
    s_xor_b32 s49, s44, 49152
    v_cvt_pk_bf16_f32 v40, v40, v41
    v_cvt_pk_bf16_f32 v41, v42, v43
    v_mfma_f32_16x16x32_bf16 v[68:71], a[28:31], v[88:91], v[68:71]
    s_waitcnt lgkmcnt(0)
    v_cvt_pk_bf16_f32 v42, v44, v45
    v_cvt_pk_bf16_f32 v43, v46, v47
    v_mfma_f32_16x16x32_bf16 v[48:51], a[32:35], v[80:83], v[48:51]
    s_add_u32 m0, s43, 135168
    ds_read_b128 v[88:91], v4 offset:6144
    s_add_u32 s42, s41, 36864
    v_mfma_f32_16x16x32_bf16 v[56:59], a[32:35], v[84:87], v[56:59]
    buffer_store_dwordx4 v[40:43], v1, s[16:19], s49 offen offset:3072 sc1
    v_mfma_f32_16x16x32_bf16 v[60:63], a[36:39], v[84:87], v[60:63]
    s_add_u32 s90, s90, 262144
    ds_read_b128 v[92:95], v5 offset:6144
    v_mfma_f32_16x16x32_bf16 v[52:55], a[36:39], v[80:83], v[52:55]
    v_mfma_f32_16x16x32_bf16 v[64:67], a[40:43], v[80:83], v[64:67]
    buffer_load_dwordx4 v1, s[16:19], s42 offen offset:0 sc1 lds
    v_mfma_f32_16x16x32_bf16 v[72:75], a[40:43], v[84:87], v[72:75]
    v_mfma_f32_16x16x32_bf16 v[76:79], a[44:47], v[84:87], v[76:79]
    v_mfma_f32_16x16x32_bf16 v[68:71], a[44:47], v[80:83], v[68:71]
    s_waitcnt lgkmcnt(0)
    v_mfma_f32_16x16x32_bf16 v[48:51], a[48:51], v[88:91], v[48:51]
    ds_read_b128 v[80:83], v4 offset:8192
    v_mfma_f32_16x16x32_bf16 v[56:59], a[48:51], v[92:95], v[56:59]
    v_mfma_f32_16x16x32_bf16 v[60:63], a[52:55], v[92:95], v[60:63]
    ds_read_b128 v[84:87], v5 offset:8192
    v_mfma_f32_16x16x32_bf16 v[52:55], a[52:55], v[88:91], v[52:55]
    buffer_load_dwordx4 v1, s[16:19], s42 offen offset:1024 sc1 lds
    v_mfma_f32_16x16x32_bf16 v[64:67], a[56:59], v[88:91], v[64:67]
    v_mfma_f32_16x16x32_bf16 v[72:75], a[56:59], v[92:95], v[72:75]
    v_mfma_f32_16x16x32_bf16 v[76:79], a[60:63], v[92:95], v[76:79]
    v_mfma_f32_16x16x32_bf16 v[68:71], a[60:63], v[88:91], v[68:71]
    s_waitcnt lgkmcnt(0)
    v_mfma_f32_16x16x32_bf16 v[48:51], a[64:67], v[80:83], v[48:51]
    ds_read_b128 v[88:91], v4 offset:10240
    v_mfma_f32_16x16x32_bf16 v[56:59], a[64:67], v[84:87], v[56:59]
    buffer_load_dwordx4 v1, s[16:19], s42 offen offset:2048 sc1 lds
    v_mfma_f32_16x16x32_bf16 v[60:63], a[68:71], v[84:87], v[60:63]
    s_add_u32 s98, s98, 262144
    ds_read_b128 v[92:95], v5 offset:10240
    s_min_u32 s98, s98, s96
    v_mfma_f32_16x16x32_bf16 v[52:55], a[68:71], v[80:83], v[52:55]
    s_and_b32 s41, s98, 0xffffffff
    v_mfma_f32_16x16x32_bf16 v[64:67], a[72:75], v[80:83], v[64:67]
    v_mfma_f32_16x16x32_bf16 v[72:75], a[72:75], v[84:87], v[72:75]
    v_mfma_f32_16x16x32_bf16 v[76:79], a[76:79], v[84:87], v[76:79]
    v_mfma_f32_16x16x32_bf16 v[68:71], a[76:79], v[80:83], v[68:71]
    s_waitcnt vmcnt(7) lgkmcnt(0)
    s_barrier
    v_mfma_f32_16x16x32_bf16 v[48:51], a[80:83], v[88:91], v[48:51]
    ds_read_b128 v[80:83], v4 offset:12288
    v_mfma_f32_16x16x32_bf16 v[56:59], a[80:83], v[92:95], v[56:59]
    v_mfma_f32_16x16x32_bf16 v[60:63], a[84:87], v[92:95], v[60:63]
    ds_read_b128 v[84:87], v5 offset:12288
    v_mfma_f32_16x16x32_bf16 v[52:55], a[84:87], v[88:91], v[52:55]
    v_mfma_f32_16x16x32_bf16 v[64:67], a[88:91], v[88:91], v[64:67]
    v_mfma_f32_16x16x32_bf16 v[72:75], a[88:91], v[92:95], v[72:75]
    v_mfma_f32_16x16x32_bf16 v[76:79], a[92:95], v[92:95], v[76:79]
    v_mfma_f32_16x16x32_bf16 v[68:71], a[92:95], v[88:91], v[68:71]
    s_waitcnt lgkmcnt(0)
    v_mfma_f32_16x16x32_bf16 v[48:51], a[96:99], v[80:83], v[48:51]
    ds_read_b128 v[88:91], v4 offset:14336
    v_mfma_f32_16x16x32_bf16 v[56:59], a[96:99], v[84:87], v[56:59]
    v_mfma_f32_16x16x32_bf16 v[60:63], a[100:103], v[84:87], v[60:63]
    ds_read_b128 v[92:95], v5 offset:14336
    v_mfma_f32_16x16x32_bf16 v[52:55], a[100:103], v[80:83], v[52:55]
    v_mfma_f32_16x16x32_bf16 v[64:67], a[104:107], v[80:83], v[64:67]
    v_mfma_f32_16x16x32_bf16 v[72:75], a[104:107], v[84:87], v[72:75]
    v_mfma_f32_16x16x32_bf16 v[76:79], a[108:111], v[84:87], v[76:79]
    v_mfma_f32_16x16x32_bf16 v[68:71], a[108:111], v[80:83], v[68:71]
    s_waitcnt lgkmcnt(0)
    v_mfma_f32_16x16x32_bf16 v[48:51], a[112:115], v[88:91], v[48:51]
    ds_read_b128 v[80:83], v4 offset:16384
    v_mfma_f32_16x16x32_bf16 v[56:59], a[112:115], v[92:95], v[56:59]
    v_mfma_f32_16x16x32_bf16 v[60:63], a[116:119], v[92:95], v[60:63]
    ds_read_b128 v[84:87], v5 offset:16384
    v_mfma_f32_16x16x32_bf16 v[52:55], a[116:119], v[88:91], v[52:55]
    v_mfma_f32_16x16x32_bf16 v[64:67], a[120:123], v[88:91], v[64:67]
    v_mfma_f32_16x16x32_bf16 v[72:75], a[120:123], v[92:95], v[72:75]
    v_mfma_f32_16x16x32_bf16 v[76:79], a[124:127], v[92:95], v[76:79]
    v_mfma_f32_16x16x32_bf16 v[68:71], a[124:127], v[88:91], v[68:71]
    s_waitcnt lgkmcnt(0)
    v_mfma_f32_16x16x32_bf16 v[48:51], a[128:131], v[80:83], v[48:51]
    ds_read_b128 v[88:91], v4 offset:18432
    v_mfma_f32_16x16x32_bf16 v[56:59], a[128:131], v[84:87], v[56:59]
    v_mfma_f32_16x16x32_bf16 v[60:63], a[132:135], v[84:87], v[60:63]
    ds_read_b128 v[92:95], v5 offset:18432
    v_mfma_f32_16x16x32_bf16 v[52:55], a[132:135], v[80:83], v[52:55]
    v_mfma_f32_16x16x32_bf16 v[64:67], a[136:139], v[80:83], v[64:67]
    v_mfma_f32_16x16x32_bf16 v[72:75], a[136:139], v[84:87], v[72:75]
    v_mfma_f32_16x16x32_bf16 v[76:79], a[140:143], v[84:87], v[76:79]
    v_mfma_f32_16x16x32_bf16 v[68:71], a[140:143], v[80:83], v[68:71]
    s_waitcnt lgkmcnt(0)
    v_mfma_f32_16x16x32_bf16 v[48:51], a[144:147], v[88:91], v[48:51]
    ds_read_b128 v[80:83], v4 offset:20480
    v_mfma_f32_16x16x32_bf16 v[56:59], a[144:147], v[92:95], v[56:59]
    v_mfma_f32_16x16x32_bf16 v[60:63], a[148:151], v[92:95], v[60:63]
    ds_read_b128 v[84:87], v5 offset:20480
    v_mfma_f32_16x16x32_bf16 v[52:55], a[148:151], v[88:91], v[52:55]
    buffer_load_dword v96, v6, s[16:19], s45 offen sc1
    v_mfma_f32_16x16x32_bf16 v[64:67], a[152:155], v[88:91], v[64:67]
    s_add_u32 m0, s43, 0
    s_add_u32 s42, s41, 0
    v_mfma_f32_16x16x32_bf16 v[72:75], a[152:155], v[92:95], v[72:75]
    v_mfma_f32_16x16x32_bf16 v[76:79], a[156:159], v[92:95], v[76:79]
    v_mfma_f32_16x16x32_bf16 v[68:71], a[156:159], v[88:91], v[68:71]
    s_waitcnt lgkmcnt(0)
    v_mfma_f32_16x16x32_bf16 v[48:51], a[160:163], v[80:83], v[48:51]
    ds_read_b128 v[88:91], v4 offset:22528
    v_mfma_f32_16x16x32_bf16 v[56:59], a[160:163], v[84:87], v[56:59]
    v_mfma_f32_16x16x32_bf16 v[60:63], a[164:167], v[84:87], v[60:63]
    ds_read_b128 v[92:95], v5 offset:22528
    v_mfma_f32_16x16x32_bf16 v[52:55], a[164:167], v[80:83], v[52:55]
    v_mfma_f32_16x16x32_bf16 v[64:67], a[168:171], v[80:83], v[64:67]
    v_mfma_f32_16x16x32_bf16 v[72:75], a[168:171], v[84:87], v[72:75]
    v_mfma_f32_16x16x32_bf16 v[76:79], a[172:175], v[84:87], v[76:79]
    v_mfma_f32_16x16x32_bf16 v[68:71], a[172:175], v[80:83], v[68:71]
    s_waitcnt lgkmcnt(0)
    v_mfma_f32_16x16x32_bf16 v[48:51], a[176:179], v[88:91], v[48:51]
    ds_read_b128 v[80:83], v4 offset:24576
    v_mfma_f32_16x16x32_bf16 v[56:59], a[176:179], v[92:95], v[56:59]
    v_mfma_f32_16x16x32_bf16 v[60:63], a[180:183], v[92:95], v[60:63]
    ds_read_b128 v[84:87], v5 offset:24576
    v_mfma_f32_16x16x32_bf16 v[52:55], a[180:183], v[88:91], v[52:55]
    v_mfma_f32_16x16x32_bf16 v[64:67], a[184:187], v[88:91], v[64:67]
    v_mfma_f32_16x16x32_bf16 v[72:75], a[184:187], v[92:95], v[72:75]
    v_mfma_f32_16x16x32_bf16 v[76:79], a[188:191], v[92:95], v[76:79]
    v_mfma_f32_16x16x32_bf16 v[68:71], a[188:191], v[88:91], v[68:71]
    s_waitcnt lgkmcnt(0)
    v_mfma_f32_16x16x32_bf16 v[48:51], a[192:195], v[80:83], v[48:51]
    ds_read_b128 v[88:91], v4 offset:26624
    v_mfma_f32_16x16x32_bf16 v[56:59], a[192:195], v[84:87], v[56:59]
    v_mfma_f32_16x16x32_bf16 v[60:63], a[196:199], v[84:87], v[60:63]
    ds_read_b128 v[92:95], v5 offset:26624
    v_mfma_f32_16x16x32_bf16 v[52:55], a[196:199], v[80:83], v[52:55]
    v_mfma_f32_16x16x32_bf16 v[64:67], a[200:203], v[80:83], v[64:67]
    v_mfma_f32_16x16x32_bf16 v[72:75], a[200:203], v[84:87], v[72:75]
    v_mfma_f32_16x16x32_bf16 v[76:79], a[204:207], v[84:87], v[76:79]
    v_mfma_f32_16x16x32_bf16 v[68:71], a[204:207], v[80:83], v[68:71]
    s_waitcnt lgkmcnt(0)
    v_mfma_f32_16x16x32_bf16 v[48:51], a[208:211], v[88:91], v[48:51]
    ds_read_b128 v[80:83], v4 offset:28672
    v_mfma_f32_16x16x32_bf16 v[56:59], a[208:211], v[92:95], v[56:59]
    v_mfma_f32_16x16x32_bf16 v[60:63], a[212:215], v[92:95], v[60:63]
    ds_read_b128 v[84:87], v5 offset:28672
    v_mfma_f32_16x16x32_bf16 v[52:55], a[212:215], v[88:91], v[52:55]
    v_mfma_f32_16x16x32_bf16 v[64:67], a[216:219], v[88:91], v[64:67]
    v_mfma_f32_16x16x32_bf16 v[72:75], a[216:219], v[92:95], v[72:75]
    v_mfma_f32_16x16x32_bf16 v[76:79], a[220:223], v[92:95], v[76:79]
    v_mfma_f32_16x16x32_bf16 v[68:71], a[220:223], v[88:91], v[68:71]
    s_waitcnt lgkmcnt(0)
    v_mfma_f32_16x16x32_bf16 v[48:51], a[224:227], v[80:83], v[48:51]
    ds_read_b128 v[88:91], v4 offset:30720
    v_mfma_f32_16x16x32_bf16 v[56:59], a[224:227], v[84:87], v[56:59]
    v_mfma_f32_16x16x32_bf16 v[60:63], a[228:231], v[84:87], v[60:63]
    ds_read_b128 v[92:95], v5 offset:30720
    v_mfma_f32_16x16x32_bf16 v[52:55], a[228:231], v[80:83], v[52:55]
    v_mfma_f32_16x16x32_bf16 v[64:67], a[232:235], v[80:83], v[64:67]
    v_mfma_f32_16x16x32_bf16 v[72:75], a[232:235], v[84:87], v[72:75]
    v_mfma_f32_16x16x32_bf16 v[76:79], a[236:239], v[84:87], v[76:79]
    v_mfma_f32_16x16x32_bf16 v[68:71], a[236:239], v[80:83], v[68:71]
    s_waitcnt lgkmcnt(0)
    v_mfma_f32_16x16x32_bf16 v[48:51], a[240:243], v[88:91], v[48:51]
    s_waitcnt vmcnt(0)
    ds_read_b128 v[80:83], v4 offset:32768
    v_cmp_ne_u32 vcc, 0, v96
    v_mfma_f32_16x16x32_bf16 v[56:59], a[240:243], v[92:95], v[56:59]
    v_mfma_f32_16x16x32_bf16 v[60:63], a[244:247], v[92:95], v[60:63]
    s_cbranch_vccnz L_spin67
L_back68:
    ds_read_b128 v[84:87], v5 offset:32768
    s_barrier
    v_mfma_f32_16x16x32_bf16 v[52:55], a[244:247], v[88:91], v[52:55]
    buffer_load_dwordx4 v1, s[16:19], s42 offen offset:0 sc1 lds
    v_mfma_f32_16x16x32_bf16 v[64:67], a[248:251], v[88:91], v[64:67]
    v_mfma_f32_16x16x32_bf16 v[72:75], a[248:251], v[92:95], v[72:75]
    v_mfma_f32_16x16x32_bf16 v[76:79], a[252:255], v[92:95], v[76:79]
    buffer_load_dwordx4 v1, s[16:19], s42 offen offset:1024 sc1 lds
    v_mfma_f32_16x16x32_bf16 v[68:71], a[252:255], v[88:91], v[68:71]
    s_waitcnt lgkmcnt(0)
    v_mfma_f32_16x16x32_bf16 v[48:51], v[128:131], v[80:83], v[48:51]
    ds_read_b128 v[88:91], v4 offset:34816
    v_mfma_f32_16x16x32_bf16 v[56:59], v[128:131], v[84:87], v[56:59]
    buffer_load_dwordx4 v1, s[16:19], s42 offen offset:2048 sc1 lds
    v_mfma_f32_16x16x32_bf16 v[60:63], v[132:135], v[84:87], v[60:63]
    ds_read_b128 v[92:95], v5 offset:34816
    v_mfma_f32_16x16x32_bf16 v[52:55], v[132:135], v[80:83], v[52:55]
    v_mfma_f32_16x16x32_bf16 v[64:67], v[136:139], v[80:83], v[64:67]
    buffer_store_dword v124, v124, s[16:19], s91 offen sc1
    v_mfma_f32_16x16x32_bf16 v[72:75], v[136:139], v[84:87], v[72:75]
    s_add_u32 s91, s91, 131072
    s_add_u32 m0, s43, 12288
    s_add_u32 s42, s41, 12288
    v_mfma_f32_16x16x32_bf16 v[76:79], v[140:143], v[84:87], v[76:79]
    v_mfma_f32_16x16x32_bf16 v[68:71], v[140:143], v[80:83], v[68:71]
    s_waitcnt lgkmcnt(0)
    v_mfma_f32_16x16x32_bf16 v[48:51], v[144:147], v[88:91], v[48:51]
    ds_read_b128 v[80:83], v4 offset:36864
    v_mfma_f32_16x16x32_bf16 v[56:59], v[144:147], v[92:95], v[56:59]
    v_mfma_f32_16x16x32_bf16 v[60:63], v[148:151], v[92:95], v[60:63]
    ds_read_b128 v[84:87], v5 offset:36864
    v_mfma_f32_16x16x32_bf16 v[52:55], v[148:151], v[88:91], v[52:55]
    buffer_load_dwordx4 v1, s[16:19], s42 offen offset:0 sc1 lds
    v_mfma_f32_16x16x32_bf16 v[64:67], v[152:155], v[88:91], v[64:67]
    v_mfma_f32_16x16x32_bf16 v[72:75], v[152:155], v[92:95], v[72:75]
    v_mfma_f32_16x16x32_bf16 v[76:79], v[156:159], v[92:95], v[76:79]
    v_mfma_f32_16x16x32_bf16 v[68:71], v[156:159], v[88:91], v[68:71]
    s_waitcnt lgkmcnt(0)
    v_mfma_f32_16x16x32_bf16 v[48:51], v[160:163], v[80:83], v[48:51]
    ds_read_b128 v[88:91], v4 offset:38912
    v_mfma_f32_16x16x32_bf16 v[56:59], v[160:163], v[84:87], v[56:59]
    buffer_load_dwordx4 v1, s[16:19], s42 offen offset:1024 sc1 lds
    v_mfma_f32_16x16x32_bf16 v[60:63], v[164:167], v[84:87], v[60:63]
    ds_read_b128 v[92:95], v5 offset:38912
    v_mfma_f32_16x16x32_bf16 v[52:55], v[164:167], v[80:83], v[52:55]
    v_mfma_f32_16x16x32_bf16 v[64:67], v[168:171], v[80:83], v[64:67]
    v_mfma_f32_16x16x32_bf16 v[72:75], v[168:171], v[84:87], v[72:75]
    v_mfma_f32_16x16x32_bf16 v[76:79], v[172:175], v[84:87], v[76:79]
    buffer_load_dwordx4 v1, s[16:19], s42 offen offset:2048 sc1 lds
    v_mfma_f32_16x16x32_bf16 v[68:71], v[172:175], v[80:83], v[68:71]
    s_waitcnt lgkmcnt(0)
    s_add_u32 m0, s43, 24576
    s_add_u32 s42, s41, 24576
    v_mfma_f32_16x16x32_bf16 v[48:51], v[176:179], v[88:91], v[48:51]
    ds_read_b128 v[80:83], v4 offset:40960
    v_mfma_f32_16x16x32_bf16 v[56:59], v[176:179], v[92:95], v[56:59]
    v_mfma_f32_16x16x32_bf16 v[60:63], v[180:183], v[92:95], v[60:63]
    ds_read_b128 v[84:87], v5 offset:40960
    v_mfma_f32_16x16x32_bf16 v[52:55], v[180:183], v[88:91], v[52:55]
    buffer_load_dwordx4 v1, s[16:19], s42 offen offset:0 sc1 lds
    v_mfma_f32_16x16x32_bf16 v[64:67], v[184:187], v[88:91], v[64:67]
    v_mfma_f32_16x16x32_bf16 v[72:75], v[184:187], v[92:95], v[72:75]
    v_mfma_f32_16x16x32_bf16 v[76:79], v[188:191], v[92:95], v[76:79]
    v_mfma_f32_16x16x32_bf16 v[68:71], v[188:191], v[88:91], v[68:71]
    s_waitcnt lgkmcnt(0)
    v_mfma_f32_16x16x32_bf16 v[48:51], v[192:195], v[80:83], v[48:51]
    ds_read_b128 v[88:91], v4 offset:43008
    v_mfma_f32_16x16x32_bf16 v[56:59], v[192:195], v[84:87], v[56:59]
    buffer_load_dwordx4 v1, s[16:19], s42 offen offset:1024 sc1 lds
    v_mfma_f32_16x16x32_bf16 v[60:63], v[196:199], v[84:87], v[60:63]
    ds_read_b128 v[92:95], v5 offset:43008
    v_mfma_f32_16x16x32_bf16 v[52:55], v[196:199], v[80:83], v[52:55]
    v_mfma_f32_16x16x32_bf16 v[64:67], v[200:203], v[80:83], v[64:67]
    v_mfma_f32_16x16x32_bf16 v[72:75], v[200:203], v[84:87], v[72:75]
    v_mfma_f32_16x16x32_bf16 v[76:79], v[204:207], v[84:87], v[76:79]
    buffer_load_dwordx4 v1, s[16:19], s42 offen offset:2048 sc1 lds
    v_mfma_f32_16x16x32_bf16 v[68:71], v[204:207], v[80:83], v[68:71]
    s_waitcnt lgkmcnt(0)
    s_add_u32 s45, s45, 131072
    v_mfma_f32_16x16x32_bf16 v[48:51], v[208:211], v[88:91], v[48:51]
    ds_read_b128 v[80:83], v4 offset:45056
    v_mfma_f32_16x16x32_bf16 v[56:59], v[208:211], v[92:95], v[56:59]
    v_mfma_f32_16x16x32_bf16 v[60:63], v[212:215], v[92:95], v[60:63]
    ds_read_b128 v[84:87], v5 offset:45056
    v_mfma_f32_16x16x32_bf16 v[52:55], v[212:215], v[88:91], v[52:55]
    v_mfma_f32_16x16x32_bf16 v[64:67], v[216:219], v[88:91], v[64:67]
    v_mfma_f32_16x16x32_bf16 v[72:75], v[216:219], v[92:95], v[72:75]
    v_mfma_f32_16x16x32_bf16 v[76:79], v[220:223], v[92:95], v[76:79]
    v_mfma_f32_16x16x32_bf16 v[68:71], v[220:223], v[88:91], v[68:71]
    s_waitcnt lgkmcnt(0)
    v_mfma_f32_16x16x32_bf16 v[48:51], v[224:227], v[80:83], v[48:51]
    ds_read_b128 v[88:91], v4 offset:47104
    v_mfma_f32_16x16x32_bf16 v[56:59], v[224:227], v[84:87], v[56:59]
    v_mfma_f32_16x16x32_bf16 v[60:63], v[228:231], v[84:87], v[60:63]
    ds_read_b128 v[92:95], v5 offset:47104
    v_mfma_f32_16x16x32_bf16 v[52:55], v[228:231], v[80:83], v[52:55]
    v_mfma_f32_16x16x32_bf16 v[64:67], v[232:235], v[80:83], v[64:67]
    v_mfma_f32_16x16x32_bf16 v[72:75], v[232:235], v[84:87], v[72:75]
    v_mfma_f32_16x16x32_bf16 v[76:79], v[236:239], v[84:87], v[76:79]
    v_mfma_f32_16x16x32_bf16 v[68:71], v[236:239], v[80:83], v[68:71]
    s_waitcnt vmcnt(7) lgkmcnt(0)
    s_barrier
    v_mfma_f32_16x16x32_bf16 v[48:51], v[240:243], v[88:91], v[48:51]
    ds_read_b128 v[80:83], v2 offset:0
    v_mfma_f32_16x16x32_bf16 v[56:59], v[240:243], v[92:95], v[56:59]
    v_mfma_f32_16x16x32_bf16 v[60:63], v[244:247], v[92:95], v[60:63]
    ds_read_b128 v[84:87], v3 offset:0
    v_mfma_f32_16x16x32_bf16 v[52:55], v[244:247], v[88:91], v[52:55]
    v_mfma_f32_16x16x32_bf16 v[64:67], v[248:251], v[88:91], v[64:67]
    v_mfma_f32_16x16x32_bf16 v[72:75], v[248:251], v[92:95], v[72:75]
    v_mfma_f32_16x16x32_bf16 v[76:79], v[252:255], v[92:95], v[76:79]
    v_mfma_f32_16x16x32_bf16 v[68:71], v[252:255], v[88:91], v[68:71]
    s_add_u32 s36, s36, 1
    s_cmp_lt_u32 s36, 32
    s_cbranch_scc1 L_bs_b0
    s_nop 7
    s_and_b32 s44, s90, 0xffffffff
    s_cmp_eq_u32 s36, 0
    s_cselect_b32 s44, 0x5e00000, s44
    s_xor_b32 s49, s44, 0
    v_cvt_pk_bf16_f32 v48, v48, v49
    v_cvt_pk_bf16_f32 v49, v50, v51
    v_cvt_pk_bf16_f32 v50, v52, v53
    v_cvt_pk_bf16_f32 v51, v54, v55
    buffer_store_dwordx4 v[48:51], v1, s[16:19], s49 offen offset:3072 sc1
    s_xor_b32 s49, s44, 16384
    v_cvt_pk_bf16_f32 v56, v56, v57
    v_cvt_pk_bf16_f32 v57, v58, v59
    v_cvt_pk_bf16_f32 v58, v60, v61
    v_cvt_pk_bf16_f32 v59, v62, v63
    buffer_store_dwordx4 v[56:59], v1, s[16:19], s49 offen offset:3072 sc1
    s_xor_b32 s49, s44, 32768
    v_cvt_pk_bf16_f32 v64, v64, v65
    v_cvt_pk_bf16_f32 v65, v66, v67
    v_cvt_pk_bf16_f32 v66, v68, v69
    v_cvt_pk_bf16_f32 v67, v70, v71
    buffer_store_dwordx4 v[64:67], v1, s[16:19], s49 offen offset:3072 sc1
    s_xor_b32 s49, s44, 49152
    v_cvt_pk_bf16_f32 v72, v72, v73
    v_cvt_pk_bf16_f32 v73, v74, v75
    v_cvt_pk_bf16_f32 v74, v76, v77
    v_cvt_pk_bf16_f32 v75, v78, v79
    buffer_store_dwordx4 v[72:75], v1, s[16:19], s49 offen offset:3072 sc1
    s_add_u32 s90, s90, 262144
    s_waitcnt vmcnt(0)
    s_barrier
    buffer_store_dword v124, v124, s[16:19], s91 offen sc1
    s_add_u32 s91, s91, 131072
    s_waitcnt vmcnt(0)
    s_endpgm
L_spin56:
    s_mov_b32 s40, 0x20000
L_spin56_l:
    buffer_load_dword v48, v124, s[20:23], 0 offen sc1
    s_sub_u32 s40, s40, 1
    s_waitcnt vmcnt(0)
    v_cmp_eq_u32 vcc, v124, v48
    s_cbranch_scc1 L_back57
    s_cbranch_vccz L_back57
    s_sleep 8
    s_branch L_spin56_l
L_spin58:
    s_mov_b32 s40, 0x20000
L_spin58_l:
    buffer_load_dword v49, v48, s[16:19], s38 offen sc1
    s_sub_u32 s40, s40, 1
    s_waitcnt vmcnt(0)
    v_cmp_ne_u32 vcc, 0, v49
    s_cbranch_scc1 L_back59
    s_cbranch_vccz L_back59
    s_sleep 8
    s_branch L_spin58_l
L_spin61:
    s_mov_b32 s40, 0x20000
L_spin61_l:
    buffer_load_dword v80, v124, s[20:23], 0 offen sc1
    s_sub_u32 s40, s40, 1
    s_waitcnt vmcnt(0)
    v_cmp_eq_u32 vcc, v124, v80
    s_cbranch_scc1 L_back62
    s_cbranch_vccz L_back62
    s_sleep 8
    s_branch L_spin61_l
L_spin63:
    s_mov_b32 s40, 0x20000
L_spin63_l:
    buffer_load_dword v96, v6, s[16:19], s45 offen sc1
    s_sub_u32 s40, s40, 1
    s_waitcnt vmcnt(0)
    v_cmp_ne_u32 vcc, 0, v96
    s_cbranch_scc1 L_back64
    s_cbranch_vccz L_back64
    s_sleep 2
    s_branch L_spin63_l
L_spin65:
    s_mov_b32 s40, 0x20000
L_spin65_l:
    buffer_load_dword v96, v6, s[16:19], s45 offen sc1
    s_sub_u32 s40, s40, 1
    s_waitcnt vmcnt(0)
    v_cmp_ne_u32 vcc, 0, v96
    s_cbranch_scc1 L_back66
    s_cbranch_vccz L_back66
    s_sleep 2
    s_branch L_spin65_l
L_spin67:
    s_mov_b32 s40, 0x20000
L_spin67_l:
    buffer_load_dword v96, v6, s[16:19], s45 offen sc1
    s_sub_u32 s40, s40, 1
    s_waitcnt vmcnt(0)
    v_cmp_ne_u32 vcc, 0, v96
    s_cbranch_scc1 L_back68
    s_cbranch_vccz L_back68
    s_sleep 2
    s_branch L_spin67_l
L_code_end:
    s_endpgm
.section .rodata,"a"
.p2align 6
.amdhsa_kernel interleave_layers__sliding_local_dilated__dense_activation_squared_relu__prompt_kernel
  .amdhsa_next_free_vgpr 512
  .amdhsa_next_free_sgpr 102
  .amdhsa_accum_offset 256
  .amdhsa_group_segment_fixed_size 0
  .amdhsa_kernarg_size 88
  .amdhsa_user_sgpr_count 2
  .amdhsa_user_sgpr_kernarg_segment_ptr 1
  .amdhsa_system_sgpr_workgroup_id_x 1
.end_amdhsa_kernel
```

```asm
; @launch grid=(256,1,1) block=(256,1,1) lds=163840
.amdgcn_target "amdgcn-amd-amdhsa--gfx950"
.text
.globl interleave_layers__sliding_local_dilated__dense_activation_squared_relu__prompt_kernel
.p2align 8
.type interleave_layers__sliding_local_dilated__dense_activation_squared_relu__prompt_kernel,@function
interleave_layers__sliding_local_dilated__dense_activation_squared_relu__prompt_kernel:
    s_load_dwordx16 s[64:79], s[0:1], 0x0
    s_load_dwordx4 s[80:83], s[0:1], 0x40
    s_load_dwordx2 s[84:85], s[0:1], 0x50
    v_lshrrev_b32 v1, 6, v0
    s_cmp_ge_u32 s2, 256
    s_cbranch_scc1 L_code_end
    s_getpc_b64 s[20:21]
L_pc:
    s_mov_b32 s22, L_code_end-L_pc
    s_mov_b32 s23, 0x00020000
    v_lshlrev_b32 v7, 12, v0
    s_lshl_b32 s37, s2, 4
    buffer_load_dword v252, v7, s[20:23], s37 offen
    v_readfirstlane_b32 s32, v1
    v_and_b32 v0, 63, v0
    v_lshlrev_b32 v1, 4, v0
    s_bfe_u32 s47, s2, 0x20001
    s_and_b32 s37, s2, 0x81
    s_cmp_lg_u32 s37, 0
    s_cbranch_scc1 L_other
    s_bfe_u32 s33, s2, 0x20003
    s_lshr_b32 s34, s2, 5
    s_lshl2_add_u32 s34, s47, s34
    s_mov_b32 s35, s34
    s_movk_i32 s39, 6144
    s_lshl_b32 s54, s35, 7
    v_lshrrev_b32 v32, 3, v0
    v_lshlrev_b32 v33, 2, v0
    v_and_b32 v33, 64, v33
    v_and_b32 v34, 0x70, v1
    v_xor_b32 v33, v33, v34
    v_mad_u32_u24 v20, v32, s39, v33
    v_add_u32 v21, 49152, v20
    v_add_u32 v22, 2048, v20
    v_add_u32 v23, 51200, v20
    v_add_u32 v24, 4096, v20
    v_add_u32 v25, 53248, v20
    s_mul_i32 s38, s32, 98304
    s_add_u32 s54, s54, s38
    s_lshl_b32 s42, s32, 11
    s_lshr_b32 s51, s32, 1
    s_lshl_b32 s50, s33, 5
    s_add_u32 s50, s50, 31
    s_sub_u32 s50, s50, s51
    s_lshl_b32 s41, s50, 15
    s_lshl_b32 s43, s32, 10
    v_lshlrev_b32 v37, 1, v0
    v_and_b32 v37, 0x60, v37
    v_xor_b32 v37, v37, v34
    s_and_b32 s37, s32, 1
    s_lshl_b32 s37, s37, 14
    v_lshl_add_u32 v6, v32, 11, v37
    v_add_u32 v6, s37, v6
    s_waitcnt lgkmcnt(0)
    s_mov_b32 s12, s66
    s_mov_b32 s13, s67
    s_mov_b32 s14, 0x600000
    s_mov_b32 s15, 0x00020000
    s_mov_b32 s8, s64
    s_mov_b32 s9, s65
    s_mov_b32 s10, 0x400000
    s_mov_b32 s11, 0x00020000
    s_add_u32 m0, s43, 98304
    s_nop 0
    buffer_load_dwordx4 v6, s[8:11], s41 offen offset:0 sc1 lds
    s_add_u32 m0, s42, 73728
    s_nop 0
    buffer_load_dwordx4 v20, s[12:15], s54 offen lds
    s_add_u32 m0, s42, 74752
    s_nop 0
    buffer_load_dwordx4 v21, s[12:15], s54 offen lds
    s_add_u32 m0, s42, 81920
    s_nop 0
    buffer_load_dwordx4 v22, s[12:15], s54 offen lds
    s_add_u32 m0, s42, 82944
    s_nop 0
    buffer_load_dwordx4 v23, s[12:15], s54 offen lds
    s_add_u32 m0, s42, 90112
    s_nop 0
    buffer_load_dwordx4 v24, s[12:15], s54 offen lds
    s_add_u32 m0, s42, 91136
    s_nop 0
    buffer_load_dwordx4 v25, s[12:15], s54 offen lds
    s_add_u32 s54, s54, 393216
    v_lshrrev_b32 v32, 4, v0
    v_bfe_u32 v33, v0, 2, 2
    v_lshl_add_u32 v32, v32, 3, v33
    v_lshlrev_b32 v32, 7, v32
    v_lshrrev_b32 v33, 1, v33
    v_lshl_add_u32 v32, v33, 6, v32
    v_and_b32 v33, 3, v0
    v_lshl_add_u32 v32, v33, 4, v32
    s_lshl_b32 s37, s51, 6
    s_and_b32 s38, s32, 1
    s_lshl_b32 s38, s38, 3
    s_add_u32 s37, s37, s38
    s_add_u32 s37, s37, 0
    v_xor_b32 v26, s37, v32
    s_lshl_b32 s37, s51, 6
    s_and_b32 s38, s32, 1
    s_lshl_b32 s38, s38, 3
    s_add_u32 s37, s37, s38
    s_add_u32 s37, s37, 8192
    v_xor_b32 v27, s37, v32
    s_lshl_b32 s37, s51, 6
    s_and_b32 s38, s32, 1
    s_lshl_b32 s38, s38, 3
    s_add_u32 s37, s37, s38
    s_add_u32 s37, s37, 16384
    v_xor_b32 v28, s37, v32
    v_mov_b32 v32, 0x3f803f80
    v_mov_b32 v33, 0x3f803f80
    v_mov_b32 v34, 0x3f803f80
    v_mov_b32 v35, 0x3f803f80
    v_and_b32 v36, 15, v0
    v_lshrrev_b32 v37, 4, v0
    v_and_b32 v38, 6, v36
    v_xor_b32 v38, v37, v38
    v_lshlrev_b32 v38, 4, v38
    v_lshl_add_u32 v2, v36, 7, v38
    v_xor_b32 v3, 64, v2
    v_add_u32 v4, 98304, v2
    v_add_u32 v5, 98304, v3
    s_add_u32 m0, s43, 102272
    s_nop 0
    buffer_load_dwordx4 v6, s[8:11], s41 offen offset:128 sc1 lds
    s_add_u32 m0, s42, 0
    s_nop 0
    buffer_load_dwordx4 v20, s[12:15], s54 offen lds
    s_add_u32 m0, s42, 1024
    s_nop 0
    buffer_load_dwordx4 v21, s[12:15], s54 offen lds
    s_add_u32 m0, s42, 8192
    s_nop 0
    buffer_load_dwordx4 v22, s[12:15], s54 offen lds
    s_add_u32 m0, s42, 9216
    s_nop 0
    buffer_load_dwordx4 v23, s[12:15], s54 offen lds
    s_add_u32 m0, s42, 16384
    s_nop 0
    buffer_load_dwordx4 v24, s[12:15], s54 offen lds
    s_add_u32 m0, s42, 17408
    s_nop 0
    buffer_load_dwordx4 v25, s[12:15], s54 offen lds
    s_add_u32 s54, s54, 393216
    s_add_u32 m0, s43, 106240
    s_nop 0
    buffer_load_dwordx4 v6, s[8:11], s41 offen offset:256 sc1 lds
    s_add_u32 m0, s42, 24576
    s_nop 0
    buffer_load_dwordx4 v20, s[12:15], s54 offen lds
    s_add_u32 m0, s42, 25600
    s_nop 0
    buffer_load_dwordx4 v21, s[12:15], s54 offen lds
    s_add_u32 m0, s42, 32768
    s_nop 0
    buffer_load_dwordx4 v22, s[12:15], s54 offen lds
    s_add_u32 m0, s42, 33792
    s_nop 0
    buffer_load_dwordx4 v23, s[12:15], s54 offen lds
    s_add_u32 m0, s42, 40960
    s_nop 0
    buffer_load_dwordx4 v24, s[12:15], s54 offen lds
    s_add_u32 m0, s42, 41984
    s_nop 0
    buffer_load_dwordx4 v25, s[12:15], s54 offen lds
    s_add_u32 s54, s54, 393216
    s_mov_b32 s36, -1
    v_add_u32 v29, 73728, v26
    v_add_u32 v30, 73728, v27
    v_add_u32 v31, 73728, v28
    s_waitcnt vmcnt(14) lgkmcnt(0)
    s_barrier
    s_add_u32 m0, s43, 110208
    ds_read_b128 v[68:71], v4 offset:0
    buffer_load_dwordx4 v6, s[8:11], s41 offen offset:384 sc1 lds
    ds_read_b128 v[72:75], v4 offset:2048
    s_add_u32 m0, s42, 49152
    ds_read_b128 v[76:79], v5 offset:0
    buffer_load_dwordx4 v20, s[12:15], s54 offen lds
    ds_read_b128 v[80:83], v5 offset:2048
    s_add_u32 m0, s42, 50176
    ds_read_b64_tr_b16 a[0:1], v29 offset:0
    buffer_load_dwordx4 v21, s[12:15], s54 offen lds
    ds_read_b64_tr_b16 a[2:3], v29 offset:512
    s_add_u32 m0, s42, 57344
    ds_read_b64_tr_b16 a[4:5], v30 offset:0
    buffer_load_dwordx4 v22, s[12:15], s54 offen lds
    ds_read_b64_tr_b16 a[6:7], v30 offset:512
    s_add_u32 m0, s42, 58368
    ds_read_b64_tr_b16 a[8:9], v31 offset:0
    buffer_load_dwordx4 v23, s[12:15], s54 offen lds
    ds_read_b64_tr_b16 a[10:11], v31 offset:512
    s_add_u32 m0, s42, 65536
    ds_read_b64_tr_b16 a[12:13], v29 offset:4096
    buffer_load_dwordx4 v24, s[12:15], s54 offen lds
    ds_read_b64_tr_b16 a[14:15], v29 offset:4608
    s_add_u32 m0, s42, 66560
    ds_read_b64_tr_b16 a[16:17], v30 offset:4096
    buffer_load_dwordx4 v25, s[12:15], s54 offen lds
    ds_read_b64_tr_b16 a[18:19], v30 offset:4608
    s_add_u32 s54, s54, 393216
    ds_read_b64_tr_b16 a[20:21], v31 offset:4096
    ds_read_b64_tr_b16 a[22:23], v31 offset:4608
    s_mov_b32 s16, s84
    s_mov_b32 s17, s85
    s_mov_b32 s18, 0x5e00000
    s_mov_b32 s19, 0x00020000
    v_min_u32 v124, 1, v0
    v_lshlrev_b32 v124, 30, v124
    s_lshl_b32 s91, s33, 6
    s_add_u32 s91, s91, s34
    s_lshl_b32 s91, s91, 8
    s_add_u32 s91, s91, 0x5540000
    s_cmp_eq_u32 s32, 1
    s_cselect_b32 s91, s91, 0x5f00000
    v_add_u32 v29, 0, v26
    v_add_u32 v30, 0, v27
    v_add_u32 v31, 0, v28
    s_waitcnt vmcnt(14) lgkmcnt(0)
    s_barrier
    v_mfma_f32_16x16x32_bf16 v[44:47], a[0:3], v[68:71], 0
    s_add_u32 m0, s43, 114176
    ds_read_b128 v[84:87], v4 offset:4096
    v_mfma_f32_16x16x32_bf16 v[48:51], a[0:3], v[72:75], 0
    buffer_load_dwordx4 v6, s[8:11], s41 offen offset:512 sc1 lds
    ds_read_b128 v[88:91], v4 offset:6144
    v_mfma_f32_16x16x32_bf16 v[56:59], a[4:7], v[72:75], 0
    s_add_u32 m0, s42, 73728
    ds_read_b128 v[92:95], v5 offset:4096
    v_mfma_f32_16x16x32_bf16 v[52:55], a[4:7], v[68:71], 0
    buffer_load_dwordx4 v20, s[12:15], s54 offen lds
    ds_read_b128 v[96:99], v5 offset:6144
    v_mfma_f32_16x16x32_bf16 v[60:63], a[8:11], v[68:71], 0
    s_add_u32 m0, s42, 74752
    ds_read_b64_tr_b16 a[24:25], v29 offset:0
    v_mfma_f32_16x16x32_bf16 v[64:67], a[8:11], v[72:75], 0
    buffer_load_dwordx4 v21, s[12:15], s54 offen lds
    ds_read_b64_tr_b16 a[26:27], v29 offset:512
    v_mfma_f32_16x16x32_bf16 v[44:47], a[12:15], v[76:79], v[44:47]
    s_add_u32 m0, s42, 81920
    ds_read_b64_tr_b16 a[28:29], v30 offset:0
    v_mfma_f32_16x16x32_bf16 v[48:51], a[12:15], v[80:83], v[48:51]
    buffer_load_dwordx4 v22, s[12:15], s54 offen lds
    ds_read_b64_tr_b16 a[30:31], v30 offset:512
    v_mfma_f32_16x16x32_bf16 v[56:59], a[16:19], v[80:83], v[56:59]
    s_add_u32 m0, s42, 82944
    ds_read_b64_tr_b16 a[32:33], v31 offset:0
    v_mfma_f32_16x16x32_bf16 v[52:55], a[16:19], v[76:79], v[52:55]
    buffer_load_dwordx4 v23, s[12:15], s54 offen lds
    ds_read_b64_tr_b16 a[34:35], v31 offset:512
    v_mfma_f32_16x16x32_bf16 v[60:63], a[20:23], v[76:79], v[60:63]
    s_add_u32 m0, s42, 90112
    ds_read_b64_tr_b16 a[36:37], v29 offset:4096
    v_mfma_f32_16x16x32_bf16 v[64:67], a[20:23], v[80:83], v[64:67]
    buffer_load_dwordx4 v24, s[12:15], s54 offen lds
    ds_read_b64_tr_b16 a[38:39], v29 offset:4608
    v_mfma_f32_16x16x32_bf16 v[100:103], a[0:3], v[32:35], 0
    s_add_u32 m0, s42, 91136
    ds_read_b64_tr_b16 a[40:41], v30 offset:4096
    v_mfma_f32_16x16x32_bf16 v[104:107], a[4:7], v[32:35], 0
    buffer_load_dwordx4 v25, s[12:15], s54 offen lds
    ds_read_b64_tr_b16 a[42:43], v30 offset:4608
    v_mfma_f32_16x16x32_bf16 v[108:111], a[8:11], v[32:35], 0
    s_add_u32 s54, s54, 393216
    ds_read_b64_tr_b16 a[44:45], v31 offset:4096
    v_mfma_f32_16x16x32_bf16 v[100:103], a[12:15], v[32:35], v[100:103]
    ds_read_b64_tr_b16 a[46:47], v31 offset:4608
    v_mfma_f32_16x16x32_bf16 v[104:107], a[16:19], v[32:35], v[104:107]
    v_mfma_f32_16x16x32_bf16 v[108:111], a[20:23], v[32:35], v[108:111]
    s_add_u32 s88, s84, 0x5000000
    s_addc_u32 s89, s85, 0
    s_sub_u32 s97, 15, s51
    s_and_b32 s38, s32, 1
    v_lshlrev_b32 v40, 1, v0
    v_and_b32 v40, 0x30, v40
    v_xor_b32 v40, v40, v1
    s_mul_i32 s37, s51, 3072
    s_add_u32 s37, s37, 65536
    s_lshl_b32 s39, s38, 3
    s_add_u32 s39, s39, s37
    v_add_u32 v29, 24576, v26
    v_add_u32 v30, 24576, v27
    v_add_u32 v31, 24576, v28
    s_waitcnt vmcnt(14) lgkmcnt(0)
    s_barrier
    v_mfma_f32_16x16x32_bf16 v[44:47], a[24:27], v[84:87], v[44:47]
    s_add_u32 m0, s43, 118144
    ds_read_b128 v[68:71], v4 offset:8192
    v_mfma_f32_16x16x32_bf16 v[48:51], a[24:27], v[88:91], v[48:51]
    buffer_load_dwordx4 v6, s[8:11], s41 offen offset:640 sc1 lds
    ds_read_b128 v[72:75], v4 offset:10240
    v_mfma_f32_16x16x32_bf16 v[56:59], a[28:31], v[88:91], v[56:59]
    s_add_u32 m0, s42, 0
    ds_read_b128 v[76:79], v5 offset:8192
    v_mfma_f32_16x16x32_bf16 v[52:55], a[28:31], v[84:87], v[52:55]
    buffer_load_dwordx4 v20, s[12:15], s54 offen lds
    ds_read_b128 v[80:83], v5 offset:10240
    v_mfma_f32_16x16x32_bf16 v[60:63], a[32:35], v[84:87], v[60:63]
    s_add_u32 m0, s42, 1024
    ds_read_b64_tr_b16 a[48:49], v29 offset:0
    v_mfma_f32_16x16x32_bf16 v[64:67], a[32:35], v[88:91], v[64:67]
    buffer_load_dwordx4 v21, s[12:15], s54 offen lds
    ds_read_b64_tr_b16 a[50:51], v29 offset:512
    v_mfma_f32_16x16x32_bf16 v[44:47], a[36:39], v[92:95], v[44:47]
    s_add_u32 m0, s42, 8192
    ds_read_b64_tr_b16 a[52:53], v30 offset:0
    v_mfma_f32_16x16x32_bf16 v[48:51], a[36:39], v[96:99], v[48:51]
    buffer_load_dwordx4 v22, s[12:15], s54 offen lds
    ds_read_b64_tr_b16 a[54:55], v30 offset:512
    v_mfma_f32_16x16x32_bf16 v[56:59], a[40:43], v[96:99], v[56:59]
    s_add_u32 m0, s42, 9216
    ds_read_b64_tr_b16 a[56:57], v31 offset:0
    v_mfma_f32_16x16x32_bf16 v[52:55], a[40:43], v[92:95], v[52:55]
    buffer_load_dwordx4 v23, s[12:15], s54 offen lds
    ds_read_b64_tr_b16 a[58:59], v31 offset:512
    v_mfma_f32_16x16x32_bf16 v[60:63], a[44:47], v[92:95], v[60:63]
    s_add_u32 m0, s42, 16384
    ds_read_b64_tr_b16 a[60:61], v29 offset:4096
    v_mfma_f32_16x16x32_bf16 v[64:67], a[44:47], v[96:99], v[64:67]
    buffer_load_dwordx4 v24, s[12:15], s54 offen lds
    ds_read_b64_tr_b16 a[62:63], v29 offset:4608
    v_mfma_f32_16x16x32_bf16 v[100:103], a[24:27], v[32:35], v[100:103]
    s_add_u32 m0, s42, 17408
    ds_read_b64_tr_b16 a[64:65], v30 offset:4096
    v_mfma_f32_16x16x32_bf16 v[104:107], a[28:31], v[32:35], v[104:107]
    buffer_load_dwordx4 v25, s[12:15], s54 offen lds
    ds_read_b64_tr_b16 a[66:67], v30 offset:4608
    v_mfma_f32_16x16x32_bf16 v[108:111], a[32:35], v[32:35], v[108:111]
    s_add_u32 s54, s54, 393216
    ds_read_b64_tr_b16 a[68:69], v31 offset:4096
    v_mfma_f32_16x16x32_bf16 v[100:103], a[36:39], v[32:35], v[100:103]
    ds_read_b64_tr_b16 a[70:71], v31 offset:4608
    v_mfma_f32_16x16x32_bf16 v[104:107], a[40:43], v[32:35], v[104:107]
    v_mfma_f32_16x16x32_bf16 v[108:111], a[44:47], v[32:35], v[108:111]
    v_add_u32 v7, s39, v40
    v_bfe_u32 v38, v0, 1, 2
    v_xor_b32 v38, v38, v37
    v_lshlrev_b32 v38, 4, v38
    v_lshl_add_u32 v38, v36, 6, v38
    v_add_u32 v8, s39, v38
    s_mul_i32 s39, s38, 6144
    s_add_u32 s39, s39, s37
    v_add_u32 v9, s39, v40
    s_cmp_eq_u32 s38, 0
    s_cselect_b32 s39, 18432, 0
    v_add_u32 v29, 49152, v26
    v_add_u32 v30, 49152, v27
    v_add_u32 v31, 49152, v28
    s_waitcnt vmcnt(14) lgkmcnt(0)
    s_barrier
    v_mfma_f32_16x16x32_bf16 v[44:47], a[48:51], v[68:71], v[44:47]
    s_add_u32 m0, s43, 122112
    ds_read_b128 v[84:87], v4 offset:12288
    v_mfma_f32_16x16x32_bf16 v[48:51], a[48:51], v[72:75], v[48:51]
    buffer_load_dwordx4 v6, s[8:11], s41 offen offset:768 sc1 lds
    ds_read_b128 v[88:91], v4 offset:14336
    v_mfma_f32_16x16x32_bf16 v[56:59], a[52:55], v[72:75], v[56:59]
    s_add_u32 m0, s42, 24576
    ds_read_b128 v[92:95], v5 offset:12288
    v_mfma_f32_16x16x32_bf16 v[52:55], a[52:55], v[68:71], v[52:55]
    buffer_load_dwordx4 v20, s[12:15], s54 offen lds
    ds_read_b128 v[96:99], v5 offset:14336
    v_mfma_f32_16x16x32_bf16 v[60:63], a[56:59], v[68:71], v[60:63]
    s_add_u32 m0, s42, 25600
    ds_read_b64_tr_b16 a[72:73], v29 offset:0
    v_mfma_f32_16x16x32_bf16 v[64:67], a[56:59], v[72:75], v[64:67]
    buffer_load_dwordx4 v21, s[12:15], s54 offen lds
    ds_read_b64_tr_b16 a[74:75], v29 offset:512
    v_mfma_f32_16x16x32_bf16 v[44:47], a[60:63], v[76:79], v[44:47]
    s_add_u32 m0, s42, 32768
    ds_read_b64_tr_b16 a[76:77], v30 offset:0
    v_mfma_f32_16x16x32_bf16 v[48:51], a[60:63], v[80:83], v[48:51]
    buffer_load_dwordx4 v22, s[12:15], s54 offen lds
    ds_read_b64_tr_b16 a[78:79], v30 offset:512
    v_mfma_f32_16x16x32_bf16 v[56:59], a[64:67], v[80:83], v[56:59]
    s_add_u32 m0, s42, 33792
    ds_read_b64_tr_b16 a[80:81], v31 offset:0
    v_mfma_f32_16x16x32_bf16 v[52:55], a[64:67], v[76:79], v[52:55]
    buffer_load_dwordx4 v23, s[12:15], s54 offen lds
    ds_read_b64_tr_b16 a[82:83], v31 offset:512
    v_mfma_f32_16x16x32_bf16 v[60:63], a[68:71], v[76:79], v[60:63]
    s_add_u32 m0, s42, 40960
    ds_read_b64_tr_b16 a[84:85], v29 offset:4096
    v_mfma_f32_16x16x32_bf16 v[64:67], a[68:71], v[80:83], v[64:67]
    buffer_load_dwordx4 v24, s[12:15], s54 offen lds
    ds_read_b64_tr_b16 a[86:87], v29 offset:4608
    v_mfma_f32_16x16x32_bf16 v[100:103], a[48:51], v[32:35], v[100:103]
    s_add_u32 m0, s42, 41984
    ds_read_b64_tr_b16 a[88:89], v30 offset:4096
    v_mfma_f32_16x16x32_bf16 v[104:107], a[52:55], v[32:35], v[104:107]
    buffer_load_dwordx4 v25, s[12:15], s54 offen lds
    ds_read_b64_tr_b16 a[90:91], v30 offset:4608
    v_mfma_f32_16x16x32_bf16 v[108:111], a[56:59], v[32:35], v[108:111]
    s_add_u32 s54, s54, 393216
    ds_read_b64_tr_b16 a[92:93], v31 offset:4096
    v_mfma_f32_16x16x32_bf16 v[100:103], a[60:63], v[32:35], v[100:103]
    ds_read_b64_tr_b16 a[94:95], v31 offset:4608
    v_mfma_f32_16x16x32_bf16 v[104:107], a[64:67], v[32:35], v[104:107]
    v_mfma_f32_16x16x32_bf16 v[108:111], a[68:71], v[32:35], v[108:111]
    s_add_u32 s39, s39, s37
    v_add_u32 v10, s39, v40
    s_sub_u32 s39, s33, 1
    s_max_i32 s39, s39, 0
    v_mov_b32 v38, s33
    v_mov_b32 v39, s39
    v_mov_b32 v12, 2097152
    v_mov_b32 v41, 262144
    v_cmp_lt_u32 vcc, 15, v0
    s_nop 1
    v_cndmask_b32 v38, v38, v39, vcc
    v_cndmask_b32 v12, v12, v41, vcc
    v_add_u32 v29, 73728, v26
    v_add_u32 v30, 73728, v27
    v_add_u32 v31, 73728, v28
    s_waitcnt vmcnt(14) lgkmcnt(0)
    s_barrier
    v_mfma_f32_16x16x32_bf16 v[44:47], a[72:75], v[84:87], v[44:47]
    s_add_u32 m0, s43, 126080
    ds_read_b128 v[68:71], v4 offset:16384
    v_mfma_f32_16x16x32_bf16 v[48:51], a[72:75], v[88:91], v[48:51]
    buffer_load_dwordx4 v6, s[8:11], s41 offen offset:896 sc1 lds
    ds_read_b128 v[72:75], v4 offset:18432
    v_mfma_f32_16x16x32_bf16 v[56:59], a[76:79], v[88:91], v[56:59]
    s_add_u32 m0, s42, 49152
    ds_read_b128 v[76:79], v5 offset:16384
    v_mfma_f32_16x16x32_bf16 v[52:55], a[76:79], v[84:87], v[52:55]
    buffer_load_dwordx4 v20, s[12:15], s54 offen lds
    ds_read_b128 v[80:83], v5 offset:18432
    v_mfma_f32_16x16x32_bf16 v[60:63], a[80:83], v[84:87], v[60:63]
    s_add_u32 m0, s42, 50176
    ds_read_b64_tr_b16 a[96:97], v29 offset:0
    v_mfma_f32_16x16x32_bf16 v[64:67], a[80:83], v[88:91], v[64:67]
    buffer_load_dwordx4 v21, s[12:15], s54 offen lds
    ds_read_b64_tr_b16 a[98:99], v29 offset:512
    v_mfma_f32_16x16x32_bf16 v[44:47], a[84:87], v[92:95], v[44:47]
    s_add_u32 m0, s42, 57344
    ds_read_b64_tr_b16 a[100:101], v30 offset:0
    v_mfma_f32_16x16x32_bf16 v[48:51], a[84:87], v[96:99], v[48:51]
    buffer_load_dwordx4 v22, s[12:15], s54 offen lds
    ds_read_b64_tr_b16 a[102:103], v30 offset:512
    v_mfma_f32_16x16x32_bf16 v[56:59], a[88:91], v[96:99], v[56:59]
    s_add_u32 m0, s42, 58368
    ds_read_b64_tr_b16 a[104:105], v31 offset:0
    v_mfma_f32_16x16x32_bf16 v[52:55], a[88:91], v[92:95], v[52:55]
    buffer_load_dwordx4 v23, s[12:15], s54 offen lds
    ds_read_b64_tr_b16 a[106:107], v31 offset:512
    v_mfma_f32_16x16x32_bf16 v[60:63], a[92:95], v[92:95], v[60:63]
    s_add_u32 m0, s42, 65536
    ds_read_b64_tr_b16 a[108:109], v29 offset:4096
    v_mfma_f32_16x16x32_bf16 v[64:67], a[92:95], v[96:99], v[64:67]
    buffer_load_dwordx4 v24, s[12:15], s54 offen lds
    ds_read_b64_tr_b16 a[110:111], v29 offset:4608
    v_mfma_f32_16x16x32_bf16 v[100:103], a[72:75], v[32:35], v[100:103]
    s_add_u32 m0, s42, 66560
    ds_read_b64_tr_b16 a[112:113], v30 offset:4096
    v_mfma_f32_16x16x32_bf16 v[104:107], a[76:79], v[32:35], v[104:107]
    buffer_load_dwordx4 v25, s[12:15], s54 offen lds
    ds_read_b64_tr_b16 a[114:115], v30 offset:4608
    v_mfma_f32_16x16x32_bf16 v[108:111], a[80:83], v[32:35], v[108:111]
    s_add_u32 s54, s54, 393216
    ds_read_b64_tr_b16 a[116:117], v31 offset:4096
    v_mfma_f32_16x16x32_bf16 v[100:103], a[84:87], v[32:35], v[100:103]
    ds_read_b64_tr_b16 a[118:119], v31 offset:4608
    v_mfma_f32_16x16x32_bf16 v[104:107], a[88:91], v[32:35], v[104:107]
    v_mfma_f32_16x16x32_bf16 v[108:111], a[92:95], v[32:35], v[108:111]
    v_lshl_add_u32 v38, v38, 6, v36
    v_add_u32 v38, 349484, v38
    v_lshlrev_b32 v11, 8, v38
    s_cmp_eq_u32 s32, 0
    s_cselect_b32 s37, 32, 0
    v_cmp_le_u32 vcc, s37, v0
    s_nop 1
    v_cndmask_b32 v11, v11, 2.0, vcc
    v_mov_b32 v116, 0
    v_mov_b32 v117, v11
    s_mov_b32 s45, -1572864
    v_and_b32 v13, 15, v0
    v_add_u32 v29, 0, v26
    v_add_u32 v30, 0, v27
    v_add_u32 v31, 0, v28
    s_waitcnt vmcnt(14) lgkmcnt(0)
    s_barrier
    v_mfma_f32_16x16x32_bf16 v[44:47], a[96:99], v[68:71], v[44:47]
    s_add_u32 m0, s43, 130048
    ds_read_b128 v[84:87], v4 offset:20480
    v_mfma_f32_16x16x32_bf16 v[48:51], a[96:99], v[72:75], v[48:51]
    buffer_load_dwordx4 v6, s[8:11], s41 offen offset:1024 sc1 lds
    ds_read_b128 v[88:91], v4 offset:22528
    v_mfma_f32_16x16x32_bf16 v[56:59], a[100:103], v[72:75], v[56:59]
    s_add_u32 m0, s42, 73728
    ds_read_b128 v[92:95], v5 offset:20480
    v_mfma_f32_16x16x32_bf16 v[52:55], a[100:103], v[68:71], v[52:55]
    buffer_load_dwordx4 v20, s[12:15], s54 offen lds
    ds_read_b128 v[96:99], v5 offset:22528
    v_mfma_f32_16x16x32_bf16 v[60:63], a[104:107], v[68:71], v[60:63]
    s_add_u32 m0, s42, 74752
    ds_read_b64_tr_b16 a[120:121], v29 offset:0
    v_mfma_f32_16x16x32_bf16 v[64:67], a[104:107], v[72:75], v[64:67]
    buffer_load_dwordx4 v21, s[12:15], s54 offen lds
    ds_read_b64_tr_b16 a[122:123], v29 offset:512
    v_mfma_f32_16x16x32_bf16 v[44:47], a[108:111], v[76:79], v[44:47]
    s_add_u32 m0, s42, 81920
    ds_read_b64_tr_b16 a[124:125], v30 offset:0
    v_mfma_f32_16x16x32_bf16 v[48:51], a[108:111], v[80:83], v[48:51]
    buffer_load_dwordx4 v22, s[12:15], s54 offen lds
    ds_read_b64_tr_b16 a[126:127], v30 offset:512
    v_mfma_f32_16x16x32_bf16 v[56:59], a[112:115], v[80:83], v[56:59]
    s_add_u32 m0, s42, 82944
    ds_read_b64_tr_b16 a[128:129], v31 offset:0
    v_mfma_f32_16x16x32_bf16 v[52:55], a[112:115], v[76:79], v[52:55]
    buffer_load_dwordx4 v23, s[12:15], s54 offen lds
    ds_read_b64_tr_b16 a[130:131], v31 offset:512
    v_mfma_f32_16x16x32_bf16 v[60:63], a[116:119], v[76:79], v[60:63]
    s_add_u32 m0, s42, 90112
    ds_read_b64_tr_b16 a[132:133], v29 offset:4096
    v_mfma_f32_16x16x32_bf16 v[64:67], a[116:119], v[80:83], v[64:67]
    buffer_load_dwordx4 v24, s[12:15], s54 offen lds
    ds_read_b64_tr_b16 a[134:135], v29 offset:4608
    v_mfma_f32_16x16x32_bf16 v[100:103], a[96:99], v[32:35], v[100:103]
    s_add_u32 m0, s42, 91136
    ds_read_b64_tr_b16 a[136:137], v30 offset:4096
    v_mfma_f32_16x16x32_bf16 v[104:107], a[100:103], v[32:35], v[104:107]
    buffer_load_dwordx4 v25, s[12:15], s54 offen lds
    ds_read_b64_tr_b16 a[138:139], v30 offset:4608
    v_mfma_f32_16x16x32_bf16 v[108:111], a[104:107], v[32:35], v[108:111]
    s_add_u32 s54, s54, 393216
    ds_read_b64_tr_b16 a[140:141], v31 offset:4096
    v_mfma_f32_16x16x32_bf16 v[100:103], a[108:111], v[32:35], v[100:103]
    ds_read_b64_tr_b16 a[142:143], v31 offset:4608
    v_mfma_f32_16x16x32_bf16 v[104:107], a[112:115], v[32:35], v[104:107]
    v_mfma_f32_16x16x32_bf16 v[108:111], a[116:119], v[32:35], v[108:111]
    v_lshlrev_b32 v13, 3, v13
    v_lshrrev_b32 v38, 5, v0
    v_lshl_add_u32 v13, v38, 9, v13
    v_and_b32 v38, 16, v0
    v_lshl_add_u32 v13, v38, 6, v13
    v_add_u32 v13, 90112, v13
    s_lshl_b32 s52, s51, 10
    s_mov_b32 s55, 0x541fc00
    s_lshl_b32 s46, s50, 10
    s_sub_u32 s46, s55, s46
    s_mov_b32 s56, 0xaaaaaaaa
    v_add_u32 v29, 24576, v26
    v_add_u32 v30, 24576, v27
    v_add_u32 v31, 24576, v28
    s_waitcnt vmcnt(14) lgkmcnt(0)
    s_barrier
    v_mfma_f32_16x16x32_bf16 v[44:47], a[120:123], v[84:87], v[44:47]
    s_add_u32 m0, s43, 134016
    ds_read_b128 v[68:71], v4 offset:24576
    v_mfma_f32_16x16x32_bf16 v[48:51], a[120:123], v[88:91], v[48:51]
    buffer_load_dwordx4 v6, s[8:11], s41 offen offset:1152 sc1 lds
    ds_read_b128 v[72:75], v4 offset:26624
    v_mfma_f32_16x16x32_bf16 v[56:59], a[124:127], v[88:91], v[56:59]
    s_add_u32 m0, s42, 0
    ds_read_b128 v[76:79], v5 offset:24576
    v_mfma_f32_16x16x32_bf16 v[52:55], a[124:127], v[84:87], v[52:55]
    buffer_load_dwordx4 v20, s[12:15], s54 offen lds
    ds_read_b128 v[80:83], v5 offset:26624
    v_mfma_f32_16x16x32_bf16 v[60:63], a[128:131], v[84:87], v[60:63]
    s_add_u32 m0, s42, 1024
    ds_read_b64_tr_b16 a[144:145], v29 offset:0
    v_mfma_f32_16x16x32_bf16 v[64:67], a[128:131], v[88:91], v[64:67]
    buffer_load_dwordx4 v21, s[12:15], s54 offen lds
    ds_read_b64_tr_b16 a[146:147], v29 offset:512
    v_mfma_f32_16x16x32_bf16 v[44:47], a[132:135], v[92:95], v[44:47]
    s_add_u32 m0, s42, 8192
    ds_read_b64_tr_b16 a[148:149], v30 offset:0
    v_mfma_f32_16x16x32_bf16 v[48:51], a[132:135], v[96:99], v[48:51]
    buffer_load_dwordx4 v22, s[12:15], s54 offen lds
    ds_read_b64_tr_b16 a[150:151], v30 offset:512
    v_mfma_f32_16x16x32_bf16 v[56:59], a[136:139], v[96:99], v[56:59]
    s_add_u32 m0, s42, 9216
    ds_read_b64_tr_b16 a[152:153], v31 offset:0
    v_mfma_f32_16x16x32_bf16 v[52:55], a[136:139], v[92:95], v[52:55]
    buffer_load_dwordx4 v23, s[12:15], s54 offen lds
    ds_read_b64_tr_b16 a[154:155], v31 offset:512
    v_mfma_f32_16x16x32_bf16 v[60:63], a[140:143], v[92:95], v[60:63]
    s_add_u32 m0, s42, 16384
    ds_read_b64_tr_b16 a[156:157], v29 offset:4096
    v_mfma_f32_16x16x32_bf16 v[64:67], a[140:143], v[96:99], v[64:67]
    buffer_load_dwordx4 v24, s[12:15], s54 offen lds
    ds_read_b64_tr_b16 a[158:159], v29 offset:4608
    v_mfma_f32_16x16x32_bf16 v[100:103], a[120:123], v[32:35], v[100:103]
    s_add_u32 m0, s42, 17408
    ds_read_b64_tr_b16 a[160:161], v30 offset:4096
    v_mfma_f32_16x16x32_bf16 v[104:107], a[124:127], v[32:35], v[104:107]
    buffer_load_dwordx4 v25, s[12:15], s54 offen lds
    ds_read_b64_tr_b16 a[162:163], v30 offset:4608
    v_mfma_f32_16x16x32_bf16 v[108:111], a[128:131], v[32:35], v[108:111]
    s_add_u32 s54, s54, 393216
    ds_read_b64_tr_b16 a[164:165], v31 offset:4096
    v_mfma_f32_16x16x32_bf16 v[100:103], a[132:135], v[32:35], v[100:103]
    ds_read_b64_tr_b16 a[166:167], v31 offset:4608
    v_mfma_f32_16x16x32_bf16 v[104:107], a[136:139], v[32:35], v[104:107]
    v_mfma_f32_16x16x32_bf16 v[108:111], a[140:143], v[32:35], v[108:111]
    s_mov_b32 s57, 0xaaaaaaaa
    s_mov_b32 s58, 0xfff0ffff
    s_mov_b32 s59, 0xf000ff00
    s_mov_b32 s60, 0xffc0fffc
    s_mov_b32 s61, 0xc000fc00
    s_mov_b32 s86, 0x3e8293ee
    v_mov_b32 v38, 0x0c0c0c0c
    v_mov_b32 v36, 0xc0c0100
    v_mov_b32 v37, 0x1000c0c
    v_cndmask_b32 v36, v36, v37, s[56:57]
    v_cndmask_b32 v14, v36, v38, s[58:59]
    v_add_u32 v29, 49152, v26
    v_add_u32 v30, 49152, v27
    v_add_u32 v31, 49152, v28
    s_waitcnt vmcnt(14) lgkmcnt(0)
    s_barrier
    v_mfma_f32_16x16x32_bf16 v[44:47], a[144:147], v[68:71], v[44:47]
    s_add_u32 m0, s43, 137984
    ds_read_b128 v[84:87], v4 offset:28672
    v_mfma_f32_16x16x32_bf16 v[48:51], a[144:147], v[72:75], v[48:51]
    buffer_load_dwordx4 v6, s[8:11], s41 offen offset:1280 sc1 lds
    ds_read_b128 v[88:91], v4 offset:30720
    v_mfma_f32_16x16x32_bf16 v[56:59], a[148:151], v[72:75], v[56:59]
    s_add_u32 m0, s42, 24576
    ds_read_b128 v[92:95], v5 offset:28672
    v_mfma_f32_16x16x32_bf16 v[52:55], a[148:151], v[68:71], v[52:55]
    buffer_load_dwordx4 v20, s[12:15], s54 offen lds
    ds_read_b128 v[96:99], v5 offset:30720
    v_mfma_f32_16x16x32_bf16 v[60:63], a[152:155], v[68:71], v[60:63]
    s_add_u32 m0, s42, 25600
    ds_read_b64_tr_b16 a[168:169], v29 offset:0
    v_mfma_f32_16x16x32_bf16 v[64:67], a[152:155], v[72:75], v[64:67]
    buffer_load_dwordx4 v21, s[12:15], s54 offen lds
    ds_read_b64_tr_b16 a[170:171], v29 offset:512
    v_mfma_f32_16x16x32_bf16 v[44:47], a[156:159], v[76:79], v[44:47]
    s_add_u32 m0, s42, 32768
    ds_read_b64_tr_b16 a[172:173], v30 offset:0
    v_mfma_f32_16x16x32_bf16 v[48:51], a[156:159], v[80:83], v[48:51]
    buffer_load_dwordx4 v22, s[12:15], s54 offen lds
    ds_read_b64_tr_b16 a[174:175], v30 offset:512
    v_mfma_f32_16x16x32_bf16 v[56:59], a[160:163], v[80:83], v[56:59]
    s_add_u32 m0, s42, 33792
    ds_read_b64_tr_b16 a[176:177], v31 offset:0
    v_mfma_f32_16x16x32_bf16 v[52:55], a[160:163], v[76:79], v[52:55]
    buffer_load_dwordx4 v23, s[12:15], s54 offen lds
    ds_read_b64_tr_b16 a[178:179], v31 offset:512
    v_mfma_f32_16x16x32_bf16 v[60:63], a[164:167], v[76:79], v[60:63]
    s_add_u32 m0, s42, 40960
    ds_read_b64_tr_b16 a[180:181], v29 offset:4096
    v_mfma_f32_16x16x32_bf16 v[64:67], a[164:167], v[80:83], v[64:67]
    buffer_load_dwordx4 v24, s[12:15], s54 offen lds
    ds_read_b64_tr_b16 a[182:183], v29 offset:4608
    v_mfma_f32_16x16x32_bf16 v[100:103], a[144:147], v[32:35], v[100:103]
    s_add_u32 m0, s42, 41984
    ds_read_b64_tr_b16 a[184:185], v30 offset:4096
    v_mfma_f32_16x16x32_bf16 v[104:107], a[148:151], v[32:35], v[104:107]
    buffer_load_dwordx4 v25, s[12:15], s54 offen lds
    ds_read_b64_tr_b16 a[186:187], v30 offset:4608
    v_mfma_f32_16x16x32_bf16 v[108:111], a[152:155], v[32:35], v[108:111]
    s_add_u32 s54, s54, 393216
    ds_read_b64_tr_b16 a[188:189], v31 offset:4096
    v_mfma_f32_16x16x32_bf16 v[100:103], a[156:159], v[32:35], v[100:103]
    ds_read_b64_tr_b16 a[190:191], v31 offset:4608
    v_mfma_f32_16x16x32_bf16 v[104:107], a[160:163], v[32:35], v[104:107]
    v_mfma_f32_16x16x32_bf16 v[108:111], a[164:167], v[32:35], v[108:111]
    v_cndmask_b32 v16, v38, v36, s[58:59]
    v_mov_b32 v36, 0xc0c0302
    v_mov_b32 v37, 0x3020c0c
    v_cndmask_b32 v36, v36, v37, s[56:57]
    v_cndmask_b32 v15, v36, v38, s[60:61]
    v_cndmask_b32 v17, v38, v36, s[60:61]
    v_mov_b32 v18, 0xff800000
    s_mul_i32 s90, s33, 2097152
    s_add_u32 s90, s90, 0xfffe0400
    s_lshl_b32 s37, s35, 1
    s_add_u32 s37, s37, s51
    v_add_u32 v29, 73728, v26
    v_add_u32 v30, 73728, v27
    v_add_u32 v31, 73728, v28
    s_waitcnt vmcnt(14) lgkmcnt(0)
    s_barrier
    v_mfma_f32_16x16x32_bf16 v[44:47], a[168:171], v[84:87], v[44:47]
    s_add_u32 m0, s43, 141952
    ds_read_b128 v[68:71], v4 offset:32768
    v_mfma_f32_16x16x32_bf16 v[48:51], a[168:171], v[88:91], v[48:51]
    buffer_load_dwordx4 v6, s[8:11], s41 offen offset:1408 sc1 lds
    ds_read_b128 v[72:75], v4 offset:34816
    v_mfma_f32_16x16x32_bf16 v[56:59], a[172:175], v[88:91], v[56:59]
    s_add_u32 m0, s42, 49152
    ds_read_b128 v[76:79], v5 offset:32768
    v_mfma_f32_16x16x32_bf16 v[52:55], a[172:175], v[84:87], v[52:55]
    buffer_load_dwordx4 v20, s[12:15], s54 offen lds
    ds_read_b128 v[80:83], v5 offset:34816
    v_mfma_f32_16x16x32_bf16 v[60:63], a[176:179], v[84:87], v[60:63]
    s_add_u32 m0, s42, 50176
    ds_read_b64_tr_b16 a[192:193], v29 offset:0
    v_mfma_f32_16x16x32_bf16 v[64:67], a[176:179], v[88:91], v[64:67]
    buffer_load_dwordx4 v21, s[12:15], s54 offen lds
    ds_read_b64_tr_b16 a[194:195], v29 offset:512
    v_mfma_f32_16x16x32_bf16 v[44:47], a[180:183], v[92:95], v[44:47]
    s_add_u32 m0, s42, 57344
    ds_read_b64_tr_b16 a[196:197], v30 offset:0
    v_mfma_f32_16x16x32_bf16 v[48:51], a[180:183], v[96:99], v[48:51]
    buffer_load_dwordx4 v22, s[12:15], s54 offen lds
    ds_read_b64_tr_b16 a[198:199], v30 offset:512
    v_mfma_f32_16x16x32_bf16 v[56:59], a[184:187], v[96:99], v[56:59]
    s_add_u32 m0, s42, 58368
    ds_read_b64_tr_b16 a[200:201], v31 offset:0
    v_mfma_f32_16x16x32_bf16 v[52:55], a[184:187], v[92:95], v[52:55]
    buffer_load_dwordx4 v23, s[12:15], s54 offen lds
    ds_read_b64_tr_b16 a[202:203], v31 offset:512
    v_mfma_f32_16x16x32_bf16 v[60:63], a[188:191], v[92:95], v[60:63]
    s_add_u32 m0, s42, 65536
    ds_read_b64_tr_b16 a[204:205], v29 offset:4096
    v_mfma_f32_16x16x32_bf16 v[64:67], a[188:191], v[96:99], v[64:67]
    buffer_load_dwordx4 v24, s[12:15], s54 offen lds
    ds_read_b64_tr_b16 a[206:207], v29 offset:4608
    v_mfma_f32_16x16x32_bf16 v[100:103], a[168:171], v[32:35], v[100:103]
    s_add_u32 m0, s42, 66560
    ds_read_b64_tr_b16 a[208:209], v30 offset:4096
    v_mfma_f32_16x16x32_bf16 v[104:107], a[172:175], v[32:35], v[104:107]
    buffer_load_dwordx4 v25, s[12:15], s54 offen lds
    ds_read_b64_tr_b16 a[210:211], v30 offset:4608
    v_mfma_f32_16x16x32_bf16 v[108:111], a[176:179], v[32:35], v[108:111]
    s_add_u32 s54, s54, 393216
    ds_read_b64_tr_b16 a[212:213], v31 offset:4096
    v_mfma_f32_16x16x32_bf16 v[100:103], a[180:183], v[32:35], v[100:103]
    ds_read_b64_tr_b16 a[214:215], v31 offset:4608
    v_mfma_f32_16x16x32_bf16 v[104:107], a[184:187], v[32:35], v[104:107]
    v_mfma_f32_16x16x32_bf16 v[108:111], a[188:191], v[32:35], v[108:111]
    s_lshl_b32 s37, s37, 11
    s_add_u32 s90, s90, s37
    s_mul_i32 s37, s38, 64512
    s_add_u32 s90, s90, s37
    s_cmp_eq_u32 s38, 0
    s_cselect_b32 s87, 63488, 0
    s_cselect_b32 s24, -2, 0xfffeffff
    s_cselect_b32 s26, 0x10000, 0
    s_cselect_b32 s27, 0, 1
    s_add_u32 s87, s87, 1024
    s_mov_b32 s25, -1
    s_cmp_eq_u32 s33, 0
    s_cselect_b64 s[26:27], s[26:27], 0
    s_add_u32 s20, s82, 0x80
    s_addc_u32 s21, s83, 0
    s_mov_b32 s22, 0x4
    s_mov_b32 s23, 0x00020000
    v_lshl_add_u32 v36, s32, 4, v124
    v_add_u32 v29, 0, v26
    v_add_u32 v30, 0, v27
    v_add_u32 v31, 0, v28
    s_waitcnt vmcnt(14) lgkmcnt(0)
    s_barrier
    v_mfma_f32_16x16x32_bf16 v[44:47], a[192:195], v[68:71], v[44:47]
    s_add_u32 m0, s43, 145920
    ds_read_b128 v[84:87], v4 offset:36864
    v_mfma_f32_16x16x32_bf16 v[48:51], a[192:195], v[72:75], v[48:51]
    buffer_load_dwordx4 v6, s[8:11], s41 offen offset:1536 sc1 lds
    ds_read_b128 v[88:91], v4 offset:38912
    v_mfma_f32_16x16x32_bf16 v[56:59], a[196:199], v[72:75], v[56:59]
    s_add_u32 m0, s42, 73728
    ds_read_b128 v[92:95], v5 offset:36864
    v_mfma_f32_16x16x32_bf16 v[52:55], a[196:199], v[68:71], v[52:55]
    buffer_load_dwordx4 v20, s[12:15], s54 offen lds
    ds_read_b128 v[96:99], v5 offset:38912
    v_mfma_f32_16x16x32_bf16 v[60:63], a[200:203], v[68:71], v[60:63]
    s_add_u32 m0, s42, 74752
    ds_read_b64_tr_b16 a[216:217], v29 offset:0
    v_mfma_f32_16x16x32_bf16 v[64:67], a[200:203], v[72:75], v[64:67]
    buffer_load_dwordx4 v21, s[12:15], s54 offen lds
    ds_read_b64_tr_b16 a[218:219], v29 offset:512
    v_mfma_f32_16x16x32_bf16 v[44:47], a[204:207], v[76:79], v[44:47]
    s_add_u32 m0, s42, 81920
    ds_read_b64_tr_b16 a[220:221], v30 offset:0
    v_mfma_f32_16x16x32_bf16 v[48:51], a[204:207], v[80:83], v[48:51]
    buffer_load_dwordx4 v22, s[12:15], s54 offen lds
    ds_read_b64_tr_b16 a[222:223], v30 offset:512
    v_mfma_f32_16x16x32_bf16 v[56:59], a[208:211], v[80:83], v[56:59]
    s_add_u32 m0, s42, 82944
    ds_read_b64_tr_b16 a[224:225], v31 offset:0
    v_mfma_f32_16x16x32_bf16 v[52:55], a[208:211], v[76:79], v[52:55]
    buffer_load_dwordx4 v23, s[12:15], s54 offen lds
    ds_read_b64_tr_b16 a[226:227], v31 offset:512
    v_mfma_f32_16x16x32_bf16 v[60:63], a[212:215], v[76:79], v[60:63]
    s_add_u32 m0, s42, 90112
    ds_read_b64_tr_b16 a[228:229], v29 offset:4096
    v_mfma_f32_16x16x32_bf16 v[64:67], a[212:215], v[80:83], v[64:67]
    buffer_load_dwordx4 v24, s[12:15], s54 offen lds
    ds_read_b64_tr_b16 a[230:231], v29 offset:4608
    v_mfma_f32_16x16x32_bf16 v[100:103], a[192:195], v[32:35], v[100:103]
    s_add_u32 m0, s42, 91136
    ds_read_b64_tr_b16 a[232:233], v30 offset:4096
    v_mfma_f32_16x16x32_bf16 v[104:107], a[196:199], v[32:35], v[104:107]
    buffer_load_dwordx4 v25, s[12:15], s54 offen lds
    ds_read_b64_tr_b16 a[234:235], v30 offset:4608
    v_mfma_f32_16x16x32_bf16 v[108:111], a[200:203], v[32:35], v[108:111]
    s_add_u32 s54, s54, 393216
    ds_read_b64_tr_b16 a[236:237], v31 offset:4096
    v_mfma_f32_16x16x32_bf16 v[100:103], a[204:207], v[32:35], v[100:103]
    ds_read_b64_tr_b16 a[238:239], v31 offset:4608
    v_mfma_f32_16x16x32_bf16 v[104:107], a[208:211], v[32:35], v[104:107]
    v_mfma_f32_16x16x32_bf16 v[108:111], a[212:215], v[32:35], v[108:111]
    v_add_u32 v29, 24576, v26
    v_add_u32 v30, 24576, v27
    v_add_u32 v31, 24576, v28
    s_waitcnt vmcnt(14) lgkmcnt(0)
    s_barrier
    v_mfma_f32_16x16x32_bf16 v[44:47], a[216:219], v[84:87], v[44:47]
    buffer_load_dword v37, v36, s[20:23], 0 offen sc1
    ds_read_b128 v[68:71], v4 offset:40960
    v_mfma_f32_16x16x32_bf16 v[48:51], a[216:219], v[88:91], v[48:51]
    s_add_u32 m0, s43, 149888
    ds_read_b128 v[72:75], v4 offset:43008
    v_mfma_f32_16x16x32_bf16 v[56:59], a[220:223], v[88:91], v[56:59]
    buffer_load_dwordx4 v6, s[8:11], s41 offen offset:1664 sc1 lds
    ds_read_b128 v[76:79], v5 offset:40960
    v_mfma_f32_16x16x32_bf16 v[52:55], a[220:223], v[84:87], v[52:55]
    s_add_u32 m0, s42, 0
    ds_read_b128 v[80:83], v5 offset:43008
    v_mfma_f32_16x16x32_bf16 v[60:63], a[224:227], v[84:87], v[60:63]
    buffer_load_dwordx4 v20, s[12:15], s54 offen lds
    ds_read_b64_tr_b16 a[240:241], v29 offset:0
    v_mfma_f32_16x16x32_bf16 v[64:67], a[224:227], v[88:91], v[64:67]
    s_add_u32 m0, s42, 1024
    ds_read_b64_tr_b16 a[242:243], v29 offset:512
    v_mfma_f32_16x16x32_bf16 v[44:47], a[228:231], v[92:95], v[44:47]
    buffer_load_dwordx4 v21, s[12:15], s54 offen lds
    ds_read_b64_tr_b16 a[244:245], v30 offset:0
    v_mfma_f32_16x16x32_bf16 v[48:51], a[228:231], v[96:99], v[48:51]
    s_add_u32 m0, s42, 8192
    ds_read_b64_tr_b16 a[246:247], v30 offset:512
    v_mfma_f32_16x16x32_bf16 v[56:59], a[232:235], v[96:99], v[56:59]
    buffer_load_dwordx4 v22, s[12:15], s54 offen lds
    ds_read_b64_tr_b16 a[248:249], v31 offset:0
    v_mfma_f32_16x16x32_bf16 v[52:55], a[232:235], v[92:95], v[52:55]
    s_add_u32 m0, s42, 9216
    ds_read_b64_tr_b16 a[250:251], v31 offset:512
    v_mfma_f32_16x16x32_bf16 v[60:63], a[236:239], v[92:95], v[60:63]
    buffer_load_dwordx4 v23, s[12:15], s54 offen lds
    ds_read_b64_tr_b16 a[252:253], v29 offset:4096
    v_mfma_f32_16x16x32_bf16 v[64:67], a[236:239], v[96:99], v[64:67]
    s_add_u32 m0, s42, 16384
    ds_read_b64_tr_b16 a[254:255], v29 offset:4608
    v_mfma_f32_16x16x32_bf16 v[100:103], a[216:219], v[32:35], v[100:103]
    buffer_load_dwordx4 v24, s[12:15], s54 offen lds
    ds_read_b64_tr_b16 v[128:129], v30 offset:4096
    v_mfma_f32_16x16x32_bf16 v[104:107], a[220:223], v[32:35], v[104:107]
    s_add_u32 m0, s42, 17408
    ds_read_b64_tr_b16 v[130:131], v30 offset:4608
    v_mfma_f32_16x16x32_bf16 v[108:111], a[224:227], v[32:35], v[108:111]
    buffer_load_dwordx4 v25, s[12:15], s54 offen lds
    ds_read_b64_tr_b16 v[132:133], v31 offset:4096
    v_mfma_f32_16x16x32_bf16 v[100:103], a[228:231], v[32:35], v[100:103]
    s_add_u32 s54, s54, 393216
    ds_read_b64_tr_b16 v[134:135], v31 offset:4608
    v_mfma_f32_16x16x32_bf16 v[104:107], a[232:235], v[32:35], v[104:107]
    v_mfma_f32_16x16x32_bf16 v[108:111], a[236:239], v[32:35], v[108:111]
    v_add_u32 v29, 49152, v26
    v_add_u32 v30, 49152, v27
    v_add_u32 v31, 49152, v28
    s_waitcnt vmcnt(15) lgkmcnt(0)
    s_barrier
    v_mfma_f32_16x16x32_bf16 v[44:47], a[240:243], v[68:71], v[44:47]
    s_add_u32 m0, s43, 153856
    ds_read_b128 v[84:87], v4 offset:45056
    v_mfma_f32_16x16x32_bf16 v[48:51], a[240:243], v[72:75], v[48:51]
    buffer_load_dwordx4 v6, s[8:11], s41 offen offset:1792 sc1 lds
    ds_read_b128 v[88:91], v4 offset:47104
    v_mfma_f32_16x16x32_bf16 v[56:59], a[244:247], v[72:75], v[56:59]
    s_add_u32 m0, s42, 24576
    ds_read_b128 v[92:95], v5 offset:45056
    v_mfma_f32_16x16x32_bf16 v[52:55], a[244:247], v[68:71], v[52:55]
    buffer_load_dwordx4 v20, s[12:15], s54 offen lds
    ds_read_b128 v[96:99], v5 offset:47104
    v_mfma_f32_16x16x32_bf16 v[60:63], a[248:251], v[68:71], v[60:63]
    s_add_u32 m0, s42, 25600
    ds_read_b64_tr_b16 v[136:137], v29 offset:0
    v_mfma_f32_16x16x32_bf16 v[64:67], a[248:251], v[72:75], v[64:67]
    buffer_load_dwordx4 v21, s[12:15], s54 offen lds
    ds_read_b64_tr_b16 v[138:139], v29 offset:512
    v_mfma_f32_16x16x32_bf16 v[44:47], a[252:255], v[76:79], v[44:47]
    s_add_u32 m0, s42, 32768
    ds_read_b64_tr_b16 v[140:141], v30 offset:0
    v_mfma_f32_16x16x32_bf16 v[48:51], a[252:255], v[80:83], v[48:51]
    buffer_load_dwordx4 v22, s[12:15], s54 offen lds
    ds_read_b64_tr_b16 v[142:143], v30 offset:512
    v_mfma_f32_16x16x32_bf16 v[56:59], v[128:131], v[80:83], v[56:59]
    s_add_u32 m0, s42, 33792
    ds_read_b64_tr_b16 v[144:145], v31 offset:0
    v_mfma_f32_16x16x32_bf16 v[52:55], v[128:131], v[76:79], v[52:55]
    buffer_load_dwordx4 v23, s[12:15], s54 offen lds
    ds_read_b64_tr_b16 v[146:147], v31 offset:512
    v_mfma_f32_16x16x32_bf16 v[60:63], v[132:135], v[76:79], v[60:63]
    s_add_u32 m0, s42, 40960
    ds_read_b64_tr_b16 v[148:149], v29 offset:4096
    v_mfma_f32_16x16x32_bf16 v[64:67], v[132:135], v[80:83], v[64:67]
    buffer_load_dwordx4 v24, s[12:15], s54 offen lds
    ds_read_b64_tr_b16 v[150:151], v29 offset:4608
    v_mfma_f32_16x16x32_bf16 v[100:103], a[240:243], v[32:35], v[100:103]
    s_add_u32 m0, s42, 41984
    ds_read_b64_tr_b16 v[152:153], v30 offset:4096
    v_mfma_f32_16x16x32_bf16 v[104:107], a[244:247], v[32:35], v[104:107]
    buffer_load_dwordx4 v25, s[12:15], s54 offen lds
    ds_read_b64_tr_b16 v[154:155], v30 offset:4608
    v_mfma_f32_16x16x32_bf16 v[108:111], a[248:251], v[32:35], v[108:111]
    s_add_u32 s54, s54, 393216
    ds_read_b64_tr_b16 v[156:157], v31 offset:4096
    v_mfma_f32_16x16x32_bf16 v[100:103], a[252:255], v[32:35], v[100:103]
    ds_read_b64_tr_b16 v[158:159], v31 offset:4608
    v_mfma_f32_16x16x32_bf16 v[104:107], v[128:131], v[32:35], v[104:107]
    v_mfma_f32_16x16x32_bf16 v[108:111], v[132:135], v[32:35], v[108:111]
    v_add_u32 v29, 73728, v26
    v_add_u32 v30, 73728, v27
    v_add_u32 v31, 73728, v28
    s_waitcnt vmcnt(15) lgkmcnt(0)
    s_barrier
    v_mfma_f32_16x16x32_bf16 v[44:47], v[136:139], v[84:87], v[44:47]
    s_add_u32 m0, s43, 157824
    ds_read_b128 v[68:71], v4 offset:49152
    v_mfma_f32_16x16x32_bf16 v[48:51], v[136:139], v[88:91], v[48:51]
    buffer_load_dwordx4 v6, s[8:11], s41 offen offset:1920 sc1 lds
    ds_read_b128 v[72:75], v4 offset:51200
    v_mfma_f32_16x16x32_bf16 v[56:59], v[140:143], v[88:91], v[56:59]
    s_add_u32 m0, s42, 49152
    ds_read_b128 v[76:79], v5 offset:49152
    v_mfma_f32_16x16x32_bf16 v[52:55], v[140:143], v[84:87], v[52:55]
    buffer_load_dwordx4 v20, s[12:15], s54 offen lds
    ds_read_b128 v[80:83], v5 offset:51200
    v_mfma_f32_16x16x32_bf16 v[60:63], v[144:147], v[84:87], v[60:63]
    s_add_u32 m0, s42, 50176
    ds_read_b64_tr_b16 v[160:161], v29 offset:0
    v_mfma_f32_16x16x32_bf16 v[64:67], v[144:147], v[88:91], v[64:67]
    buffer_load_dwordx4 v21, s[12:15], s54 offen lds
    ds_read_b64_tr_b16 v[162:163], v29 offset:512
    v_mfma_f32_16x16x32_bf16 v[44:47], v[148:151], v[92:95], v[44:47]
    s_add_u32 m0, s42, 57344
    ds_read_b64_tr_b16 v[164:165], v30 offset:0
    v_mfma_f32_16x16x32_bf16 v[48:51], v[148:151], v[96:99], v[48:51]
    buffer_load_dwordx4 v22, s[12:15], s54 offen lds
    ds_read_b64_tr_b16 v[166:167], v30 offset:512
    v_mfma_f32_16x16x32_bf16 v[56:59], v[152:155], v[96:99], v[56:59]
    s_add_u32 m0, s42, 58368
    ds_read_b64_tr_b16 v[168:169], v31 offset:0
    v_mfma_f32_16x16x32_bf16 v[52:55], v[152:155], v[92:95], v[52:55]
    buffer_load_dwordx4 v23, s[12:15], s54 offen lds
    ds_read_b64_tr_b16 v[170:171], v31 offset:512
    v_mfma_f32_16x16x32_bf16 v[60:63], v[156:159], v[92:95], v[60:63]
    s_add_u32 m0, s42, 65536
    ds_read_b64_tr_b16 v[172:173], v29 offset:4096
    v_mfma_f32_16x16x32_bf16 v[64:67], v[156:159], v[96:99], v[64:67]
    buffer_load_dwordx4 v24, s[12:15], s54 offen lds
    ds_read_b64_tr_b16 v[174:175], v29 offset:4608
    v_mfma_f32_16x16x32_bf16 v[100:103], v[136:139], v[32:35], v[100:103]
    s_add_u32 m0, s42, 66560
    ds_read_b64_tr_b16 v[176:177], v30 offset:4096
    v_mfma_f32_16x16x32_bf16 v[104:107], v[140:143], v[32:35], v[104:107]
    buffer_load_dwordx4 v25, s[12:15], s54 offen lds
    ds_read_b64_tr_b16 v[178:179], v30 offset:4608
    v_mfma_f32_16x16x32_bf16 v[108:111], v[144:147], v[32:35], v[108:111]
    s_add_u32 s54, s54, 393216
    ds_read_b64_tr_b16 v[180:181], v31 offset:4096
    v_mfma_f32_16x16x32_bf16 v[100:103], v[148:151], v[32:35], v[100:103]
    ds_read_b64_tr_b16 v[182:183], v31 offset:4608
    v_mfma_f32_16x16x32_bf16 v[104:107], v[152:155], v[32:35], v[104:107]
    v_mfma_f32_16x16x32_bf16 v[108:111], v[156:159], v[32:35], v[108:111]
    v_add_u32 v29, 0, v26
    v_add_u32 v30, 0, v27
    v_add_u32 v31, 0, v28
    s_waitcnt vmcnt(14) lgkmcnt(0)
    v_cmp_eq_u32 vcc, v36, v37
    s_cbranch_vccnz L_spin1
L_back2:
    s_barrier
    v_mfma_f32_16x16x32_bf16 v[44:47], v[160:163], v[68:71], v[44:47]
    s_add_u32 m0, s52, 92160
    ds_read_b128 v[84:87], v4 offset:53248
    v_mfma_f32_16x16x32_bf16 v[48:51], v[160:163], v[72:75], v[48:51]
    buffer_load_dwordx4 v1, s[16:19], s46 offen sc1 lds
    ds_read_b128 v[88:91], v4 offset:55296
    v_mfma_f32_16x16x32_bf16 v[56:59], v[164:167], v[72:75], v[56:59]
    s_cmp_eq_u32 s36, s97
    s_cselect_b32 s47, 31, -2
    s_cselect_b64 s[8:9], s[88:89], s[8:9]
    s_cselect_b32 s55, 0x543fc00, s55
    ds_read_b128 v[92:95], v5 offset:53248
    v_mfma_f32_16x16x32_bf16 v[52:55], v[164:167], v[68:71], v[52:55]
    s_add_u32 s50, s50, s47
    ds_read_b128 v[96:99], v5 offset:55296
    v_mfma_f32_16x16x32_bf16 v[60:63], v[168:171], v[68:71], v[60:63]
    s_max_i32 s47, s50, 0
    ds_read_b64_tr_b16 v[184:185], v29 offset:0
    v_mfma_f32_16x16x32_bf16 v[64:67], v[168:171], v[72:75], v[64:67]
    s_lshl_b32 s41, s47, 15
    ds_read_b64_tr_b16 v[186:187], v29 offset:512
    v_mfma_f32_16x16x32_bf16 v[44:47], v[172:175], v[76:79], v[44:47]
    s_lshl_b32 s46, s47, 10
    ds_read_b64_tr_b16 v[188:189], v30 offset:0
    v_mfma_f32_16x16x32_bf16 v[48:51], v[172:175], v[80:83], v[48:51]
    s_sub_u32 s46, s55, s46
    ds_read_b64_tr_b16 v[190:191], v30 offset:512
    v_mfma_f32_16x16x32_bf16 v[56:59], v[176:179], v[80:83], v[56:59]
    s_add_u32 m0, s52, 90112
    ds_read_b64_tr_b16 v[192:193], v31 offset:0
    v_mfma_f32_16x16x32_bf16 v[52:55], v[176:179], v[76:79], v[52:55]
    buffer_load_dwordx4 v1, s[16:19], s46 offen sc1 lds
    ds_read_b64_tr_b16 v[194:195], v31 offset:512
    v_mfma_f32_16x16x32_bf16 v[60:63], v[180:183], v[76:79], v[60:63]
    buffer_store_dword v124, v124, s[16:19], s91 offen sc1
    ds_read_b64_tr_b16 v[196:197], v29 offset:4096
    v_mfma_f32_16x16x32_bf16 v[64:67], v[180:183], v[80:83], v[64:67]
    s_add_u32 s91, s91, 131072
    ds_read_b64_tr_b16 v[198:199], v29 offset:4608
    v_mfma_f32_16x16x32_bf16 v[100:103], v[160:163], v[32:35], v[100:103]
    ds_read_b64_tr_b16 v[200:201], v30 offset:4096
    v_mfma_f32_16x16x32_bf16 v[104:107], v[164:167], v[32:35], v[104:107]
    ds_read_b64_tr_b16 v[202:203], v30 offset:4608
    v_mfma_f32_16x16x32_bf16 v[108:111], v[168:171], v[32:35], v[108:111]
    ds_read_b64_tr_b16 v[204:205], v31 offset:4096
    v_mfma_f32_16x16x32_bf16 v[100:103], v[172:175], v[32:35], v[100:103]
    ds_read_b64_tr_b16 v[206:207], v31 offset:4608
    v_mfma_f32_16x16x32_bf16 v[104:107], v[176:179], v[32:35], v[104:107]
    v_mfma_f32_16x16x32_bf16 v[108:111], v[180:183], v[32:35], v[108:111]
    v_add_u32 v29, 24576, v26
    v_add_u32 v30, 24576, v27
    v_add_u32 v31, 24576, v28
    s_waitcnt vmcnt(10) lgkmcnt(0)
    s_barrier
    v_mfma_f32_16x16x32_bf16 v[44:47], v[184:187], v[84:87], v[44:47]
    s_add_u32 m0, s43, 0
    ds_read_b128 v[68:71], v4 offset:57344
    v_mfma_f32_16x16x32_bf16 v[48:51], v[184:187], v[88:91], v[48:51]
    buffer_load_dwordx4 v6, s[8:11], s41 offen offset:0 sc1 lds
    ds_read_b128 v[72:75], v4 offset:59392
    v_mfma_f32_16x16x32_bf16 v[56:59], v[188:191], v[88:91], v[56:59]
    s_add_u32 m0, s43, 3968
    ds_read_b128 v[76:79], v5 offset:57344
    v_mfma_f32_16x16x32_bf16 v[52:55], v[188:191], v[84:87], v[52:55]
    buffer_load_dwordx4 v6, s[8:11], s41 offen offset:128 sc1 lds
    ds_read_b128 v[80:83], v5 offset:59392
    v_mfma_f32_16x16x32_bf16 v[60:63], v[192:195], v[84:87], v[60:63]
    s_add_u32 m0, s43, 7936
    ds_read_b64_tr_b16 v[208:209], v29 offset:0
    v_mfma_f32_16x16x32_bf16 v[64:67], v[192:195], v[88:91], v[64:67]
    buffer_load_dwordx4 v6, s[8:11], s41 offen offset:256 sc1 lds
    ds_read_b64_tr_b16 v[210:211], v29 offset:512
    v_mfma_f32_16x16x32_bf16 v[44:47], v[196:199], v[92:95], v[44:47]
    s_add_u32 m0, s43, 11904
    ds_read_b64_tr_b16 v[212:213], v30 offset:0
    v_mfma_f32_16x16x32_bf16 v[48:51], v[196:199], v[96:99], v[48:51]
    buffer_load_dwordx4 v6, s[8:11], s41 offen offset:384 sc1 lds
    ds_read_b64_tr_b16 v[214:215], v30 offset:512
    v_mfma_f32_16x16x32_bf16 v[56:59], v[200:203], v[96:99], v[56:59]
    s_add_u32 m0, s43, 15872
    ds_read_b64_tr_b16 v[216:217], v31 offset:0
    v_mfma_f32_16x16x32_bf16 v[52:55], v[200:203], v[92:95], v[52:55]
    buffer_load_dwordx4 v6, s[8:11], s41 offen offset:512 sc1 lds
    ds_read_b64_tr_b16 v[218:219], v31 offset:512
    v_mfma_f32_16x16x32_bf16 v[60:63], v[204:207], v[92:95], v[60:63]
    s_add_u32 m0, s43, 19840
    ds_read_b64_tr_b16 v[220:221], v29 offset:4096
    v_mfma_f32_16x16x32_bf16 v[64:67], v[204:207], v[96:99], v[64:67]
    buffer_load_dwordx4 v6, s[8:11], s41 offen offset:640 sc1 lds
    ds_read_b64_tr_b16 v[222:223], v29 offset:4608
    v_mfma_f32_16x16x32_bf16 v[100:103], v[184:187], v[32:35], v[100:103]
    ds_read_b64_tr_b16 v[224:225], v30 offset:4096
    v_mfma_f32_16x16x32_bf16 v[104:107], v[188:191], v[32:35], v[104:107]
    ds_read_b64_tr_b16 v[226:227], v30 offset:4608
    v_mfma_f32_16x16x32_bf16 v[108:111], v[192:195], v[32:35], v[108:111]
    ds_read_b64_tr_b16 v[228:229], v31 offset:4096
    v_mfma_f32_16x16x32_bf16 v[100:103], v[196:199], v[32:35], v[100:103]
    ds_read_b64_tr_b16 v[230:231], v31 offset:4608
    v_mfma_f32_16x16x32_bf16 v[104:107], v[200:203], v[32:35], v[104:107]
    v_mfma_f32_16x16x32_bf16 v[108:111], v[204:207], v[32:35], v[108:111]
    v_add_u32 v29, 49152, v26
    v_add_u32 v30, 49152, v27
    v_add_u32 v31, 49152, v28
    s_waitcnt vmcnt(9) lgkmcnt(0)
    s_barrier
    v_mfma_f32_16x16x32_bf16 v[44:47], v[208:211], v[68:71], v[44:47]
    s_add_u32 m0, s43, 23808
    ds_read_b128 v[84:87], v4 offset:61440
    v_mfma_f32_16x16x32_bf16 v[48:51], v[208:211], v[72:75], v[48:51]
    buffer_load_dwordx4 v6, s[8:11], s41 offen offset:768 sc1 lds
    ds_read_b128 v[88:91], v4 offset:63488
    v_mfma_f32_16x16x32_bf16 v[56:59], v[212:215], v[72:75], v[56:59]
    s_add_u32 m0, s43, 27776
    ds_read_b128 v[92:95], v5 offset:61440
    v_mfma_f32_16x16x32_bf16 v[52:55], v[212:215], v[68:71], v[52:55]
    buffer_load_dwordx4 v6, s[8:11], s41 offen offset:896 sc1 lds
    ds_read_b128 v[96:99], v5 offset:63488
    v_mfma_f32_16x16x32_bf16 v[60:63], v[216:219], v[68:71], v[60:63]
    s_add_u32 m0, s43, 31744
    ds_read_b64_tr_b16 v[232:233], v29 offset:0
    v_mfma_f32_16x16x32_bf16 v[64:67], v[216:219], v[72:75], v[64:67]
    buffer_load_dwordx4 v6, s[8:11], s41 offen offset:1024 sc1 lds
    ds_read_b64_tr_b16 v[234:235], v29 offset:512
    v_mfma_f32_16x16x32_bf16 v[44:47], v[220:223], v[76:79], v[44:47]
    s_add_u32 m0, s43, 35712
    ds_read_b64_tr_b16 v[236:237], v30 offset:0
    v_mfma_f32_16x16x32_bf16 v[48:51], v[220:223], v[80:83], v[48:51]
    buffer_load_dwordx4 v6, s[8:11], s41 offen offset:1152 sc1 lds
    ds_read_b64_tr_b16 v[238:239], v30 offset:512
    v_mfma_f32_16x16x32_bf16 v[56:59], v[224:227], v[80:83], v[56:59]
    s_add_u32 m0, s43, 39680
    ds_read_b64_tr_b16 v[240:241], v31 offset:0
    v_mfma_f32_16x16x32_bf16 v[52:55], v[224:227], v[76:79], v[52:55]
    buffer_load_dwordx4 v6, s[8:11], s41 offen offset:1280 sc1 lds
    ds_read_b64_tr_b16 v[242:243], v31 offset:512
    v_mfma_f32_16x16x32_bf16 v[60:63], v[228:231], v[76:79], v[60:63]
    s_add_u32 m0, s43, 43648
    ds_read_b64_tr_b16 v[244:245], v29 offset:4096
    v_mfma_f32_16x16x32_bf16 v[64:67], v[228:231], v[80:83], v[64:67]
    buffer_load_dwordx4 v6, s[8:11], s41 offen offset:1408 sc1 lds
    ds_read_b64_tr_b16 v[246:247], v29 offset:4608
    v_mfma_f32_16x16x32_bf16 v[100:103], v[208:211], v[32:35], v[100:103]
    ds_read_b64_tr_b16 v[248:249], v30 offset:4096
    v_mfma_f32_16x16x32_bf16 v[104:107], v[212:215], v[32:35], v[104:107]
    ds_read_b64_tr_b16 v[250:251], v30 offset:4608
    v_mfma_f32_16x16x32_bf16 v[108:111], v[216:219], v[32:35], v[108:111]
    ds_read_b64_tr_b16 v[252:253], v31 offset:4096
    v_mfma_f32_16x16x32_bf16 v[100:103], v[220:223], v[32:35], v[100:103]
    ds_read_b64_tr_b16 v[254:255], v31 offset:4608
    v_mfma_f32_16x16x32_bf16 v[104:107], v[224:227], v[32:35], v[104:107]
    v_mfma_f32_16x16x32_bf16 v[108:111], v[228:231], v[32:35], v[108:111]
    s_waitcnt vmcnt(13) lgkmcnt(0)
    s_barrier
    v_mfma_f32_16x16x32_bf16 v[44:47], v[232:235], v[84:87], v[44:47]
    s_add_u32 m0, s43, 47616
    v_mfma_f32_16x16x32_bf16 v[48:51], v[232:235], v[88:91], v[48:51]
    buffer_load_dwordx4 v6, s[8:11], s41 offen offset:1536 sc1 lds
    v_mfma_f32_16x16x32_bf16 v[56:59], v[236:239], v[88:91], v[56:59]
    s_add_u32 m0, s43, 51584
    v_mfma_f32_16x16x32_bf16 v[52:55], v[236:239], v[84:87], v[52:55]
    buffer_load_dwordx4 v6, s[8:11], s41 offen offset:1664 sc1 lds
    v_mfma_f32_16x16x32_bf16 v[60:63], v[240:243], v[84:87], v[60:63]
    s_add_u32 m0, s43, 55552
    v_mfma_f32_16x16x32_bf16 v[64:67], v[240:243], v[88:91], v[64:67]
    buffer_load_dwordx4 v6, s[8:11], s41 offen offset:1792 sc1 lds
    v_mfma_f32_16x16x32_bf16 v[44:47], v[244:247], v[92:95], v[44:47]
    s_add_u32 m0, s43, 59520
    v_mfma_f32_16x16x32_bf16 v[48:51], v[244:247], v[96:99], v[48:51]
    buffer_load_dwordx4 v6, s[8:11], s41 offen offset:1920 sc1 lds
    v_mfma_f32_16x16x32_bf16 v[56:59], v[248:251], v[96:99], v[56:59]
    v_mfma_f32_16x16x32_bf16 v[52:55], v[248:251], v[92:95], v[52:55]
    v_mfma_f32_16x16x32_bf16 v[60:63], v[252:255], v[92:95], v[60:63]
    v_mfma_f32_16x16x32_bf16 v[64:67], v[252:255], v[96:99], v[64:67]
    v_mfma_f32_16x16x32_bf16 v[100:103], v[232:235], v[32:35], v[100:103]
    v_mfma_f32_16x16x32_bf16 v[104:107], v[236:239], v[32:35], v[104:107]
    v_mfma_f32_16x16x32_bf16 v[108:111], v[240:243], v[32:35], v[108:111]
    v_mfma_f32_16x16x32_bf16 v[100:103], v[244:247], v[32:35], v[100:103]
    v_mfma_f32_16x16x32_bf16 v[104:107], v[248:251], v[32:35], v[104:107]
    v_mfma_f32_16x16x32_bf16 v[108:111], v[252:255], v[32:35], v[108:111]
    s_mov_b32 s36, 0
    ds_read_b64 v[20:21], v13 offset:2048
    ds_read_b64 v[22:23], v13 offset:2176
    ds_read_b64 v[24:25], v13 offset:2304
    ds_read_b64 v[26:27], v13 offset:2432
    s_waitcnt lgkmcnt(0)
    v_add_f32 v28, v24, v26
    v_add_f32 v29, v25, v27
    v_add_f32 v20, v20, v22
    v_add_f32 v21, v21, v23
    v_add_f32 v20, v20, v28
    v_add_f32 v21, v21, v29
    v_mov_b32 v28, v20
    v_mov_b32 v29, v21
    s_nop 0
    v_permlane32_swap_b32 v20, v28
    v_permlane32_swap_b32 v21, v29
    v_add_f32 v20, v20, v28
    v_add_f32 v21, v21, v29
    v_mul_f32 v112, 0xba800000, v20
    v_mul_f32 v21, 0x3a800000, v21
    v_fma_f32 v21, -v112, v112, v21
    v_mov_b32 v113, v112
    v_max_f32 v21, 0, v21
    v_add_f32 v21, 0x3727c5ac, v21
    v_rsq_f32 v114, v21
    v_permlane16_swap_b32 v112, v113
    v_mov_b32 v115, v114
    s_nop 1
    v_permlane16_swap_b32 v114, v115
    s_cmp_eq_u32 s36, s97
    s_cselect_b32 s47, 31, -2
    s_cselect_b64 s[8:9], s[88:89], s[8:9]
    s_cselect_b32 s55, 0x543fc00, s55
    s_add_u32 s50, s50, s47
    s_max_i32 s47, s50, 0
    s_lshl_b32 s41, s47, 15
    s_lshl_b32 s46, s47, 10
    s_sub_u32 s46, s55, s46
    s_cmp_eq_u32 s36, 17
    s_cselect_b32 s49, s87, 0x10000
    s_add_u32 s90, s90, s49
    s_and_b32 s49, s90, 0xffffffff
    s_bitcmp1_b64 s[24:25], s36
    s_cselect_b32 s44, s49, 0x5e00000
    s_bitcmp1_b64 s[26:27], s36
    s_cselect_b64 s[62:63], 0, -1
    v_fmac_f32 v44, v112, v100
    v_fmac_f32 v45, v112, v101
    v_fmac_f32 v46, v112, v102
    v_fmac_f32 v47, v112, v103
    v_fmac_f32 v48, v113, v100
    v_fmac_f32 v49, v113, v101
    v_fmac_f32 v50, v113, v102
    v_fmac_f32 v51, v113, v103
    v_fmac_f32 v52, v112, v104
    v_fmac_f32 v53, v112, v105
    v_fmac_f32 v54, v112, v106
    v_fmac_f32 v55, v112, v107
    v_fmac_f32 v56, v113, v104
    v_fmac_f32 v57, v113, v105
    v_fmac_f32 v58, v113, v106
    v_fmac_f32 v59, v113, v107
    v_fmac_f32 v60, v112, v108
    v_fmac_f32 v61, v112, v109
    v_fmac_f32 v62, v112, v110
    v_fmac_f32 v63, v112, v111
    v_fmac_f32 v64, v113, v108
    v_fmac_f32 v65, v113, v109
    v_fmac_f32 v66, v113, v110
    v_fmac_f32 v67, v113, v111
    s_waitcnt vmcnt(0) lgkmcnt(0)
    s_barrier
    ds_read_b128 v[68:71], v2 offset:0
    ds_read_b128 v[72:75], v2 offset:2048
    ds_read_b128 v[76:79], v3 offset:0
    ds_read_b128 v[80:83], v3 offset:2048
    s_mov_b32 s36, 1
    s_waitcnt lgkmcnt(0)
    s_nop 7
L_q_b0:
    s_waitcnt lgkmcnt(2)
    v_mfma_f32_16x16x32_bf16 v[20:23], a[0:3], v[68:71], 0
    ds_read_b128 v[84:87], v2 offset:4096
    v_mul_f32 v44, v44, v114
    v_mfma_f32_16x16x32_bf16 v[24:27], a[0:3], v[72:75], 0
    v_mul_f32 v45, v45, v114
    v_mul_f32 v46, v46, v114
    v_mfma_f32_16x16x32_bf16 v[32:35], a[4:7], v[72:75], 0
    v_mul_f32 v47, v47, v114
    v_cvt_pk_bf16_f32 v44, v44, v45
    v_mfma_f32_16x16x32_bf16 v[28:31], a[4:7], v[68:71], 0
    ds_read_b128 v[88:91], v2 offset:6144
    v_cvt_pk_bf16_f32 v45, v46, v47
    v_mfma_f32_16x16x32_bf16 v[36:39], a[8:11], v[68:71], 0
    ds_write_b64 v7, v[44:45] offset:12288
    v_mfma_f32_16x16x32_bf16 v[40:43], a[8:11], v[72:75], 0
    s_waitcnt lgkmcnt(3)
    v_mul_f32 v48, v48, v115
    v_mul_f32 v49, v49, v115
    v_mfma_f32_16x16x32_bf16 v[20:23], a[12:15], v[76:79], v[20:23]
    ds_read_b128 v[92:95], v3 offset:4096
    v_mul_f32 v50, v50, v115
    v_mfma_f32_16x16x32_bf16 v[24:27], a[12:15], v[80:83], v[24:27]
    v_mul_f32 v51, v51, v115
    v_cvt_pk_bf16_f32 v48, v48, v49
    v_mfma_f32_16x16x32_bf16 v[32:35], a[16:19], v[80:83], v[32:35]
    v_cvt_pk_bf16_f32 v49, v50, v51
    v_mfma_f32_16x16x32_bf16 v[28:31], a[16:19], v[76:79], v[28:31]
    ds_read_b128 v[96:99], v3 offset:6144
    v_mfma_f32_16x16x32_bf16 v[36:39], a[20:23], v[76:79], v[36:39]
    ds_write_b64 v7, v[48:49] offset:18432
    v_mfma_f32_16x16x32_bf16 v[40:43], a[20:23], v[80:83], v[40:43]
    s_waitcnt lgkmcnt(4)
    v_mul_f32 v52, v52, v114
    v_mul_f32 v53, v53, v114
    v_mfma_f32_16x16x32_bf16 v[20:23], a[24:27], v[84:87], v[20:23]
    ds_read_b128 v[68:71], v2 offset:8192
    v_mul_f32 v54, v54, v114
    v_mfma_f32_16x16x32_bf16 v[24:27], a[24:27], v[88:91], v[24:27]
    v_mul_f32 v55, v55, v114
    v_cvt_pk_bf16_f32 v52, v52, v53
    v_mfma_f32_16x16x32_bf16 v[32:35], a[28:31], v[88:91], v[32:35]
    v_cvt_pk_bf16_f32 v53, v54, v55
    v_mfma_f32_16x16x32_bf16 v[28:31], a[28:31], v[84:87], v[28:31]
    ds_read_b128 v[72:75], v2 offset:10240
    v_mfma_f32_16x16x32_bf16 v[36:39], a[32:35], v[84:87], v[36:39]
    ds_write_b64 v7, v[52:53] offset:13312
    v_mfma_f32_16x16x32_bf16 v[40:43], a[32:35], v[88:91], v[40:43]
    s_waitcnt lgkmcnt(4)
    v_mul_f32 v56, v56, v115
    v_mul_f32 v57, v57, v115
    v_mfma_f32_16x16x32_bf16 v[20:23], a[36:39], v[92:95], v[20:23]
    ds_read_b128 v[76:79], v3 offset:8192
    v_mul_f32 v58, v58, v115
    v_mfma_f32_16x16x32_bf16 v[24:27], a[36:39], v[96:99], v[24:27]
    v_mul_f32 v59, v59, v115
    v_cvt_pk_bf16_f32 v56, v56, v57
    v_mfma_f32_16x16x32_bf16 v[32:35], a[40:43], v[96:99], v[32:35]
    v_cvt_pk_bf16_f32 v57, v58, v59
    v_mfma_f32_16x16x32_bf16 v[28:31], a[40:43], v[92:95], v[28:31]
    ds_read_b128 v[80:83], v3 offset:10240
    v_mfma_f32_16x16x32_bf16 v[36:39], a[44:47], v[92:95], v[36:39]
    ds_write_b64 v7, v[56:57] offset:19456
    v_mfma_f32_16x16x32_bf16 v[40:43], a[44:47], v[96:99], v[40:43]
    s_waitcnt lgkmcnt(4)
    v_mul_f32 v60, v60, v114
    v_mul_f32 v61, v61, v114
    v_mfma_f32_16x16x32_bf16 v[20:23], a[48:51], v[68:71], v[20:23]
    s_waitcnt vmcnt(1)
    ds_read_b128 v[84:87], v2 offset:12288
    v_cmp_ne_u32 vcc, 0, v116
    v_mfma_f32_16x16x32_bf16 v[24:27], a[48:51], v[72:75], v[24:27]
    v_mul_f32 v62, v62, v114
    v_mul_f32 v63, v63, v114
    v_mfma_f32_16x16x32_bf16 v[32:35], a[52:55], v[72:75], v[32:35]
    s_cbranch_vccnz L_spin3
L_back4:
    v_cvt_pk_bf16_f32 v60, v60, v61
    v_cvt_pk_bf16_f32 v61, v62, v63
    v_mfma_f32_16x16x32_bf16 v[28:31], a[52:55], v[68:71], v[28:31]
    ds_read_b128 v[88:91], v2 offset:14336
    v_mfma_f32_16x16x32_bf16 v[36:39], a[56:59], v[68:71], v[36:39]
    ds_write_b64 v8, v[60:61] offset:14336
    v_mfma_f32_16x16x32_bf16 v[40:43], a[56:59], v[72:75], v[40:43]
    s_waitcnt lgkmcnt(4)
    v_mul_f32 v64, v64, v115
    v_mul_f32 v65, v65, v115
    v_mfma_f32_16x16x32_bf16 v[20:23], a[60:63], v[76:79], v[20:23]
    ds_read_b128 v[92:95], v3 offset:12288
    v_mul_f32 v66, v66, v115
    v_mfma_f32_16x16x32_bf16 v[24:27], a[60:63], v[80:83], v[24:27]
    v_mul_f32 v67, v67, v115
    v_cvt_pk_bf16_f32 v64, v64, v65
    v_mfma_f32_16x16x32_bf16 v[32:35], a[64:67], v[80:83], v[32:35]
    v_cvt_pk_bf16_f32 v65, v66, v67
    v_mfma_f32_16x16x32_bf16 v[28:31], a[64:67], v[76:79], v[28:31]
    ds_read_b128 v[96:99], v3 offset:14336
    v_mfma_f32_16x16x32_bf16 v[36:39], a[68:71], v[76:79], v[36:39]
    ds_write_b64 v8, v[64:65] offset:20480
    v_mfma_f32_16x16x32_bf16 v[40:43], a[68:71], v[80:83], v[40:43]
    s_waitcnt lgkmcnt(4)
    s_waitcnt lgkmcnt(0)
    s_barrier
    v_mfma_f32_16x16x32_bf16 v[20:23], a[72:75], v[84:87], v[20:23]
    ds_read_b128 v[68:71], v2 offset:16384
    v_mfma_f32_16x16x32_bf16 v[24:27], a[72:75], v[88:91], v[24:27]
    ds_read_b128 v[44:47], v9 offset:6144
    v_mfma_f32_16x16x32_bf16 v[32:35], a[76:79], v[88:91], v[32:35]
    ds_read_b128 v[48:51], v9 offset:13312
    v_mfma_f32_16x16x32_bf16 v[28:31], a[76:79], v[84:87], v[28:31]
    ds_read_b128 v[72:75], v2 offset:18432
    v_mfma_f32_16x16x32_bf16 v[36:39], a[80:83], v[84:87], v[36:39]
    ds_read_b128 v[52:55], v9 offset:7168
    s_add_u32 m0, s43, 98304
    v_mfma_f32_16x16x32_bf16 v[40:43], a[80:83], v[88:91], v[40:43]
    s_waitcnt lgkmcnt(6)
    ds_read_b64_tr_b16 v[56:57], v9 offset:14336
    v_mfma_f32_16x16x32_bf16 v[20:23], a[84:87], v[92:95], v[20:23]
    ds_read_b128 v[76:79], v3 offset:16384
    v_mfma_f32_16x16x32_bf16 v[24:27], a[84:87], v[96:99], v[24:27]
    buffer_load_dwordx4 v6, s[8:11], s41 offen offset:0 sc1 lds
    v_mfma_f32_16x16x32_bf16 v[32:35], a[88:91], v[96:99], v[32:35]
    s_add_u32 m0, s43, 102272
    ds_read_b64_tr_b16 v[58:59], v9 offset:8192
    s_waitcnt lgkmcnt(3)
    v_mfma_f32_16x16x32_bf16 v[28:31], a[88:91], v[92:95], v[28:31]
    ds_read_b128 v[80:83], v3 offset:18432
    v_mfma_f32_16x16x32_bf16 v[64:67], v[48:51], v[44:47], 0
    ds_read_b64_tr_b16 v[60:61], v9 offset:14344
    v_mfma_f32_16x16x32_bf16 v[118:121], v[52:55], v[44:47], 0
    ds_read_b64_tr_b16 v[62:63], v9 offset:8200
    v_mfma_f32_16x16x32_bf16 v[36:39], a[92:95], v[92:95], v[36:39]
    v_mfma_f32_16x16x32_bf16 v[40:43], a[92:95], v[96:99], v[40:43]
    s_waitcnt lgkmcnt(7)
    v_cndmask_b32 v64, v64, v65, s[56:57]
    v_cndmask_b32 v66, v66, v67, s[56:57]
    v_mfma_f32_16x16x32_bf16 v[20:23], a[96:99], v[68:71], v[20:23]
    ds_read_b128 v[84:87], v2 offset:20480
    v_cndmask_b32 v118, v118, v119, s[56:57]
    v_mfma_f32_16x16x32_bf16 v[24:27], a[96:99], v[72:75], v[24:27]
    buffer_load_dwordx4 v6, s[8:11], s41 offen offset:128 sc1 lds
    v_mfma_f32_16x16x32_bf16 v[32:35], a[100:103], v[72:75], v[32:35]
    s_add_u32 m0, s43, 106240
    v_cndmask_b32 v120, v120, v121, s[56:57]
    v_cndmask_b32 v64, v18, v64, s[62:63]
    v_mfma_f32_16x16x32_bf16 v[28:31], a[100:103], v[68:71], v[28:31]
    ds_read_b128 v[88:91], v2 offset:22528
    v_cndmask_b32 v66, v18, v66, s[62:63]
    v_mfma_f32_16x16x32_bf16 v[36:39], a[104:107], v[68:71], v[36:39]
    v_cndmask_b32 v46, v64, v118, s[58:59]
    v_cndmask_b32 v47, v66, v120, s[60:61]
    v_mfma_f32_16x16x32_bf16 v[40:43], a[104:107], v[72:75], v[40:43]
    s_waitcnt lgkmcnt(4)
    v_max_f32 v44, v46, v47
    v_mov_b32 v45, v44
    v_mfma_f32_16x16x32_bf16 v[20:23], a[108:111], v[76:79], v[20:23]
    ds_read_b128 v[92:95], v3 offset:20480
    v_mfma_f32_16x16x32_bf16 v[24:27], a[108:111], v[80:83], v[24:27]
    buffer_load_dwordx4 v6, s[8:11], s41 offen offset:256 sc1 lds
    v_mfma_f32_16x16x32_bf16 v[32:35], a[112:115], v[80:83], v[32:35]
    s_add_u32 m0, s43, 110208
    v_permlane16_swap_b32 v44, v45
    v_mfma_f32_16x16x32_bf16 v[28:31], a[112:115], v[76:79], v[28:31]
    ds_read_b128 v[96:99], v3 offset:22528
    v_max_f32 v44, v44, v45
    v_mfma_f32_16x16x32_bf16 v[36:39], a[116:119], v[76:79], v[36:39]
    v_mov_b32 v45, v44
    v_mfma_f32_16x16x32_bf16 v[40:43], a[116:119], v[80:83], v[40:43]
    s_waitcnt lgkmcnt(2)
    v_permlane32_swap_b32 v44, v45
    v_mfma_f32_16x16x32_bf16 v[20:23], a[120:123], v[84:87], v[20:23]
    ds_read_b128 v[68:71], v2 offset:24576
    v_max_f32 v44, v44, v45
    v_mfma_f32_16x16x32_bf16 v[24:27], a[120:123], v[88:91], v[24:27]
    buffer_load_dwordx4 v6, s[8:11], s41 offen offset:384 sc1 lds
    v_mfma_f32_16x16x32_bf16 v[32:35], a[124:127], v[88:91], v[32:35]
    s_add_u32 m0, s43, 114176
    v_mul_f32 v44, s86, v44
    v_fma_f32 v46, v46, s86, -v44
    v_mfma_f32_16x16x32_bf16 v[28:31], a[124:127], v[84:87], v[28:31]
    ds_read_b128 v[72:75], v2 offset:26624
    v_fma_f32 v47, v47, s86, -v44
    v_mfma_f32_16x16x32_bf16 v[36:39], a[128:131], v[84:87], v[36:39]
    v_exp_f32 v46, v46
    v_mfma_f32_16x16x32_bf16 v[40:43], a[128:131], v[88:91], v[40:43]
    s_waitcnt lgkmcnt(2)
    v_exp_f32 v47, v47
    v_mfma_f32_16x16x32_bf16 v[20:23], a[132:135], v[92:95], v[20:23]
    ds_read_b128 v[76:79], v3 offset:24576
    v_cvt_pk_bf16_f32 v52, v46, v47
    v_mfma_f32_16x16x32_bf16 v[24:27], a[132:135], v[96:99], v[24:27]
    buffer_load_dwordx4 v6, s[8:11], s41 offen offset:512 sc1 lds
    v_mfma_f32_16x16x32_bf16 v[32:35], a[136:139], v[96:99], v[32:35]
    s_add_u32 m0, s43, 118144
    v_perm_b32 v48, v52, v52, v14
    v_perm_b32 v49, v52, v52, v15
    v_mfma_f32_16x16x32_bf16 v[28:31], a[136:139], v[92:95], v[28:31]
    ds_read_b128 v[80:83], v3 offset:26624
    v_perm_b32 v50, v52, v52, v16
    v_mfma_f32_16x16x32_bf16 v[36:39], a[140:143], v[92:95], v[36:39]
    v_perm_b32 v51, v52, v52, v17
    v_add_f32 v44, v46, v47
    v_mfma_f32_16x16x32_bf16 v[40:43], a[140:143], v[96:99], v[40:43]
    s_waitcnt lgkmcnt(2)
    v_mov_b32 v45, v44
    s_waitcnt lgkmcnt(8)
    v_mfma_f32_16x16x32_bf16 v[20:23], a[144:147], v[68:71], v[20:23]
    ds_read_b128 v[84:87], v2 offset:28672
    v_mfma_f32_16x16x32_bf16 v[64:67], v[56:59], v[48:51], 0
    v_mfma_f32_16x16x32_bf16 v[118:121], v[60:63], v[48:51], 0
    v_permlane16_swap_b32 v44, v45
    v_mfma_f32_16x16x32_bf16 v[24:27], a[144:147], v[72:75], v[24:27]
    buffer_load_dwordx4 v6, s[8:11], s41 offen offset:640 sc1 lds
    v_mfma_f32_16x16x32_bf16 v[32:35], a[148:151], v[72:75], v[32:35]
    s_add_u32 m0, s43, 122112
    v_add_f32 v44, v44, v45
    v_mov_b32 v45, v44
    v_mfma_f32_16x16x32_bf16 v[28:31], a[148:151], v[68:71], v[28:31]
    ds_read_b128 v[88:91], v2 offset:30720
    v_mfma_f32_16x16x32_bf16 v[36:39], a[152:155], v[68:71], v[36:39]
    v_permlane32_swap_b32 v44, v45
    v_mfma_f32_16x16x32_bf16 v[40:43], a[152:155], v[72:75], v[40:43]
    s_waitcnt lgkmcnt(2)
    v_add_f32 v44, v44, v45
    v_mfma_f32_16x16x32_bf16 v[20:23], a[156:159], v[76:79], v[20:23]
    ds_read_b128 v[92:95], v3 offset:28672
    v_mfma_f32_16x16x32_bf16 v[24:27], a[156:159], v[80:83], v[24:27]
    buffer_load_dwordx4 v6, s[8:11], s41 offen offset:768 sc1 lds
    v_mfma_f32_16x16x32_bf16 v[32:35], a[160:163], v[80:83], v[32:35]
    s_add_u32 m0, s43, 126080
    v_rcp_f32 v44, v44
    v_mfma_f32_16x16x32_bf16 v[28:31], a[160:163], v[76:79], v[28:31]
    ds_read_b128 v[96:99], v3 offset:30720
    v_mul_f32 v64, v64, v44
    v_mfma_f32_16x16x32_bf16 v[36:39], a[164:167], v[76:79], v[36:39]
    v_mul_f32 v65, v65, v44
    v_mul_f32 v66, v66, v44
    v_mfma_f32_16x16x32_bf16 v[40:43], a[164:167], v[80:83], v[40:43]
    s_waitcnt lgkmcnt(2)
    v_mul_f32 v67, v67, v44
    v_cvt_pk_bf16_f32 v52, v64, v65
    v_mfma_f32_16x16x32_bf16 v[20:23], a[168:171], v[84:87], v[20:23]
    ds_read_b128 v[68:71], v2 offset:32768
    v_cvt_pk_bf16_f32 v53, v66, v67
    v_mfma_f32_16x16x32_bf16 v[24:27], a[168:171], v[88:91], v[24:27]
    buffer_load_dwordx4 v6, s[8:11], s41 offen offset:896 sc1 lds
    v_mfma_f32_16x16x32_bf16 v[32:35], a[172:175], v[88:91], v[32:35]
    s_add_u32 m0, s43, 130048
    v_mul_f32 v118, v118, v44
    v_mul_f32 v119, v119, v44
    v_mfma_f32_16x16x32_bf16 v[28:31], a[172:175], v[84:87], v[28:31]
    ds_read_b128 v[72:75], v2 offset:34816
    v_mul_f32 v120, v120, v44
    v_mfma_f32_16x16x32_bf16 v[36:39], a[176:179], v[84:87], v[36:39]
    v_mul_f32 v121, v121, v44
    v_cvt_pk_bf16_f32 v54, v118, v119
    v_mfma_f32_16x16x32_bf16 v[40:43], a[176:179], v[88:91], v[40:43]
    s_waitcnt lgkmcnt(2)
    v_cvt_pk_bf16_f32 v55, v120, v121
    v_mfma_f32_16x16x32_bf16 v[20:23], a[180:183], v[92:95], v[20:23]
    ds_read_b128 v[76:79], v3 offset:32768
    v_mfma_f32_16x16x32_bf16 v[24:27], a[180:183], v[96:99], v[24:27]
    buffer_load_dwordx4 v6, s[8:11], s41 offen offset:1024 sc1 lds
    v_mfma_f32_16x16x32_bf16 v[32:35], a[184:187], v[96:99], v[32:35]
    buffer_store_dwordx4 v[52:55], v1, s[16:19], s44 offen sc1
    v_mfma_f32_16x16x32_bf16 v[28:31], a[184:187], v[92:95], v[28:31]
    s_add_u32 m0, s43, 134016
    ds_read_b128 v[80:83], v3 offset:34816
    s_cmp_eq_u32 s36, 17
    v_mfma_f32_16x16x32_bf16 v[36:39], a[188:191], v[92:95], v[36:39]
    s_cselect_b32 s49, s87, 0x10000
    ds_read_b64 v[56:57], v13 offset:0
    s_add_u32 s90, s90, s49
    v_mfma_f32_16x16x32_bf16 v[40:43], a[188:191], v[96:99], v[40:43]
    s_waitcnt lgkmcnt(3)
    ds_read_b64 v[58:59], v13 offset:128
    s_and_b32 s49, s90, 0xffffffff
    v_mfma_f32_16x16x32_bf16 v[20:23], a[192:195], v[68:71], v[20:23]
    s_bitcmp1_b64 s[24:25], s36
    ds_read_b128 v[84:87], v2 offset:36864
    s_cselect_b32 s44, s49, 0x5e00000
    v_mfma_f32_16x16x32_bf16 v[24:27], a[192:195], v[72:75], v[24:27]
    buffer_load_dwordx4 v6, s[8:11], s41 offen offset:1152 sc1 lds
    v_mfma_f32_16x16x32_bf16 v[32:35], a[196:199], v[72:75], v[32:35]
    s_add_u32 m0, s43, 137984
    ds_read_b64 v[60:61], v13 offset:256
    s_bitcmp1_b64 s[26:27], s36
    v_mfma_f32_16x16x32_bf16 v[28:31], a[196:199], v[68:71], v[28:31]
    s_cselect_b64 s[62:63], 0, -1
    ds_read_b128 v[88:91], v2 offset:38912
    v_mfma_f32_16x16x32_bf16 v[36:39], a[200:203], v[68:71], v[36:39]
    ds_read_b64 v[62:63], v13 offset:384
    v_mfma_f32_16x16x32_bf16 v[40:43], a[200:203], v[72:75], v[40:43]
    s_waitcnt lgkmcnt(6)
    v_mfma_f32_16x16x32_bf16 v[20:23], a[204:207], v[76:79], v[20:23]
    ds_read_b128 v[92:95], v3 offset:36864
    v_mfma_f32_16x16x32_bf16 v[24:27], a[204:207], v[80:83], v[24:27]
    buffer_load_dwordx4 v6, s[8:11], s41 offen offset:1280 sc1 lds
    v_mfma_f32_16x16x32_bf16 v[32:35], a[208:211], v[80:83], v[32:35]
    s_add_u32 m0, s43, 141952
    v_mfma_f32_16x16x32_bf16 v[28:31], a[208:211], v[76:79], v[28:31]
    s_waitcnt lgkmcnt(1)
    ds_read_b128 v[96:99], v3 offset:38912
    v_add_f32 v64, v60, v62
    v_mfma_f32_16x16x32_bf16 v[36:39], a[212:215], v[76:79], v[36:39]
    v_add_f32 v65, v61, v63
    v_add_f32 v56, v56, v58
    v_mfma_f32_16x16x32_bf16 v[40:43], a[212:215], v[80:83], v[40:43]
    s_waitcnt lgkmcnt(3)
    v_add_f32 v57, v57, v59
    v_add_f32 v56, v56, v64
    v_mfma_f32_16x16x32_bf16 v[20:23], a[216:219], v[84:87], v[20:23]
    ds_read_b128 v[68:71], v2 offset:40960
    v_add_f32 v57, v57, v65
    v_mfma_f32_16x16x32_bf16 v[24:27], a[216:219], v[88:91], v[24:27]
    buffer_load_dwordx4 v6, s[8:11], s41 offen offset:1408 sc1 lds
    v_mfma_f32_16x16x32_bf16 v[32:35], a[220:223], v[88:91], v[32:35]
    s_add_u32 m0, s43, 145920
    v_mov_b32 v64, v56
    v_mov_b32 v65, v57
    v_mfma_f32_16x16x32_bf16 v[28:31], a[220:223], v[84:87], v[28:31]
    ds_read_b128 v[72:75], v2 offset:43008
    v_mfma_f32_16x16x32_bf16 v[36:39], a[224:227], v[84:87], v[36:39]
    v_permlane32_swap_b32 v56, v64
    v_mfma_f32_16x16x32_bf16 v[40:43], a[224:227], v[88:91], v[40:43]
    s_waitcnt lgkmcnt(2)
    v_permlane32_swap_b32 v57, v65
    v_mfma_f32_16x16x32_bf16 v[20:23], a[228:231], v[92:95], v[20:23]
    ds_read_b128 v[76:79], v3 offset:40960
    v_add_f32 v56, v56, v64
    v_mfma_f32_16x16x32_bf16 v[24:27], a[228:231], v[96:99], v[24:27]
    buffer_load_dwordx4 v6, s[8:11], s41 offen offset:1536 sc1 lds
    v_mfma_f32_16x16x32_bf16 v[32:35], a[232:235], v[96:99], v[32:35]
    s_add_u32 m0, s43, 149888
    v_add_f32 v57, v57, v65
    v_mul_f32 v112, 0xba800000, v56
    v_mfma_f32_16x16x32_bf16 v[28:31], a[232:235], v[92:95], v[28:31]
    ds_read_b128 v[80:83], v3 offset:43008
    v_mul_f32 v57, 0x3a800000, v57
    v_mfma_f32_16x16x32_bf16 v[36:39], a[236:239], v[92:95], v[36:39]
    v_fma_f32 v57, -v112, v112, v57
    v_mov_b32 v113, v112
    v_mfma_f32_16x16x32_bf16 v[40:43], a[236:239], v[96:99], v[40:43]
    s_waitcnt lgkmcnt(2)
    v_max_f32 v57, 0, v57
    v_add_f32 v57, 0x3727c5ac, v57
    v_mfma_f32_16x16x32_bf16 v[20:23], a[240:243], v[68:71], v[20:23]
    ds_read_b128 v[84:87], v2 offset:45056
    v_mfma_f32_16x16x32_bf16 v[24:27], a[240:243], v[72:75], v[24:27]
    buffer_load_dwordx4 v6, s[8:11], s41 offen offset:1664 sc1 lds
    v_mfma_f32_16x16x32_bf16 v[32:35], a[244:247], v[72:75], v[32:35]
    s_add_u32 m0, s43, 153856
    v_rsq_f32 v114, v57
    v_mfma_f32_16x16x32_bf16 v[28:31], a[244:247], v[68:71], v[28:31]
    ds_read_b128 v[88:91], v2 offset:47104
    v_mfma_f32_16x16x32_bf16 v[36:39], a[248:251], v[68:71], v[36:39]
    v_permlane16_swap_b32 v112, v113
    v_mfma_f32_16x16x32_bf16 v[40:43], a[248:251], v[72:75], v[40:43]
    s_waitcnt lgkmcnt(2)
    v_mov_b32 v115, v114
    v_fmac_f32 v24, v113, v100
    v_mfma_f32_16x16x32_bf16 v[20:23], a[252:255], v[76:79], v[20:23]
    ds_read_b128 v[92:95], v3 offset:45056
    v_fmac_f32 v28, v112, v104
    v_mfma_f32_16x16x32_bf16 v[24:27], a[252:255], v[80:83], v[24:27]
    buffer_load_dwordx4 v6, s[8:11], s41 offen offset:1792 sc1 lds
    v_mfma_f32_16x16x32_bf16 v[32:35], v[128:131], v[80:83], v[32:35]
    s_add_u32 m0, s43, 157824
    v_permlane16_swap_b32 v114, v115
    v_mfma_f32_16x16x32_bf16 v[28:31], v[128:131], v[76:79], v[28:31]
    ds_read_b128 v[96:99], v3 offset:47104
    v_fmac_f32 v20, v112, v100
    v_mfma_f32_16x16x32_bf16 v[36:39], v[132:135], v[76:79], v[36:39]
    v_fmac_f32 v21, v112, v101
    v_fmac_f32 v22, v112, v102
    v_mfma_f32_16x16x32_bf16 v[40:43], v[132:135], v[80:83], v[40:43]
    s_waitcnt lgkmcnt(2)
    v_fmac_f32 v25, v113, v101
    v_fmac_f32 v26, v113, v102
    v_mfma_f32_16x16x32_bf16 v[20:23], v[136:139], v[84:87], v[20:23]
    ds_read_b128 v[68:71], v2 offset:49152
    v_fmac_f32 v29, v112, v105
    v_mfma_f32_16x16x32_bf16 v[24:27], v[136:139], v[88:91], v[24:27]
    buffer_load_dwordx4 v6, s[8:11], s41 offen offset:1920 sc1 lds
    v_mfma_f32_16x16x32_bf16 v[32:35], v[140:143], v[88:91], v[32:35]
    s_add_u32 m0, s52, 92160
    v_fmac_f32 v23, v112, v103
    v_fmac_f32 v36, v112, v108
    v_mfma_f32_16x16x32_bf16 v[28:31], v[140:143], v[84:87], v[28:31]
    ds_read_b128 v[72:75], v2 offset:51200
    v_fmac_f32 v27, v113, v103
    v_mfma_f32_16x16x32_bf16 v[36:39], v[144:147], v[84:87], v[36:39]
    v_fmac_f32 v32, v113, v104
    v_fmac_f32 v33, v113, v105
    v_mfma_f32_16x16x32_bf16 v[40:43], v[144:147], v[88:91], v[40:43]
    s_waitcnt lgkmcnt(2)
    v_fmac_f32 v30, v112, v106
    v_fmac_f32 v31, v112, v107
    v_mfma_f32_16x16x32_bf16 v[20:23], v[148:151], v[92:95], v[20:23]
    ds_read_b128 v[76:79], v3 offset:49152
    v_fmac_f32 v34, v113, v106
    v_mfma_f32_16x16x32_bf16 v[24:27], v[148:151], v[96:99], v[24:27]
    buffer_load_dwordx4 v1, s[16:19], s46 offen sc1 lds
    v_mfma_f32_16x16x32_bf16 v[32:35], v[152:155], v[96:99], v[32:35]
    s_cmp_eq_u32 s36, s97
    v_med3_i32 v117, s45, 0, v12
    v_add_u32 v117, v117, v11
    v_mfma_f32_16x16x32_bf16 v[28:31], v[152:155], v[92:95], v[28:31]
    s_cselect_b32 s47, 31, -2
    ds_read_b128 v[80:83], v3 offset:51200
    v_fmac_f32 v40, v113, v108
    v_mfma_f32_16x16x32_bf16 v[36:39], v[156:159], v[92:95], v[36:39]
    s_cselect_b64 s[8:9], s[88:89], s[8:9]
    v_fmac_f32 v35, v113, v107
    s_cselect_b32 s55, 0x543fc00, s55
    v_mfma_f32_16x16x32_bf16 v[40:43], v[156:159], v[96:99], v[40:43]
    s_waitcnt lgkmcnt(2)
    s_add_u32 s45, s45, 131072
    s_add_u32 s50, s50, s47
    v_mfma_f32_16x16x32_bf16 v[20:23], v[160:163], v[68:71], v[20:23]
    s_max_i32 s47, s50, 0
    ds_read_b128 v[84:87], v2 offset:53248
    v_fmac_f32 v37, v112, v109
    v_mfma_f32_16x16x32_bf16 v[24:27], v[160:163], v[72:75], v[24:27]
    buffer_load_dword v116, v117, s[16:19], 0 offen sc1
    v_mfma_f32_16x16x32_bf16 v[32:35], v[164:167], v[72:75], v[32:35]
    s_lshl_b32 s41, s47, 15
    v_fmac_f32 v38, v112, v110
    v_fmac_f32 v39, v112, v111
    v_mfma_f32_16x16x32_bf16 v[28:31], v[164:167], v[68:71], v[28:31]
    s_lshl_b32 s46, s47, 10
    ds_read_b128 v[88:91], v2 offset:55296
    v_fmac_f32 v41, v113, v109
    v_mfma_f32_16x16x32_bf16 v[36:39], v[168:171], v[68:71], v[36:39]
    s_sub_u32 s46, s55, s46
    v_mfma_f32_16x16x32_bf16 v[40:43], v[168:171], v[72:75], v[40:43]
    s_waitcnt lgkmcnt(2)
    v_mfma_f32_16x16x32_bf16 v[20:23], v[172:175], v[76:79], v[20:23]
    ds_read_b128 v[92:95], v3 offset:53248
    v_mfma_f32_16x16x32_bf16 v[24:27], v[172:175], v[80:83], v[24:27]
    v_mfma_f32_16x16x32_bf16 v[32:35], v[176:179], v[80:83], v[32:35]
    v_fmac_f32 v42, v113, v110
    v_fmac_f32 v43, v113, v111
    v_mfma_f32_16x16x32_bf16 v[28:31], v[176:179], v[76:79], v[28:31]
    ds_read_b128 v[96:99], v3 offset:55296
    v_mfma_f32_16x16x32_bf16 v[36:39], v[180:183], v[76:79], v[36:39]
    v_mfma_f32_16x16x32_bf16 v[40:43], v[180:183], v[80:83], v[40:43]
    s_waitcnt lgkmcnt(2)
    v_mfma_f32_16x16x32_bf16 v[20:23], v[184:187], v[84:87], v[20:23]
    ds_read_b128 v[68:71], v2 offset:57344
    v_mfma_f32_16x16x32_bf16 v[24:27], v[184:187], v[88:91], v[24:27]
    v_mfma_f32_16x16x32_bf16 v[32:35], v[188:191], v[88:91], v[32:35]
    v_mfma_f32_16x16x32_bf16 v[28:31], v[188:191], v[84:87], v[28:31]
    ds_read_b128 v[72:75], v2 offset:59392
    v_mfma_f32_16x16x32_bf16 v[36:39], v[192:195], v[84:87], v[36:39]
    v_mfma_f32_16x16x32_bf16 v[40:43], v[192:195], v[88:91], v[40:43]
    s_waitcnt lgkmcnt(2)
    v_mfma_f32_16x16x32_bf16 v[20:23], v[196:199], v[92:95], v[20:23]
    ds_read_b128 v[76:79], v3 offset:57344
    v_mfma_f32_16x16x32_bf16 v[24:27], v[196:199], v[96:99], v[24:27]
    v_mfma_f32_16x16x32_bf16 v[32:35], v[200:203], v[96:99], v[32:35]
    v_mfma_f32_16x16x32_bf16 v[28:31], v[200:203], v[92:95], v[28:31]
    ds_read_b128 v[80:83], v3 offset:59392
    v_mfma_f32_16x16x32_bf16 v[36:39], v[204:207], v[92:95], v[36:39]
    s_waitcnt vmcnt(9)
    s_barrier
    v_mfma_f32_16x16x32_bf16 v[40:43], v[204:207], v[96:99], v[40:43]
    s_waitcnt lgkmcnt(2)
    v_mfma_f32_16x16x32_bf16 v[20:23], v[208:211], v[68:71], v[20:23]
    ds_read_b128 v[84:87], v2 offset:61440
    v_mfma_f32_16x16x32_bf16 v[24:27], v[208:211], v[72:75], v[24:27]
    buffer_store_dword v124, v124, s[16:19], s91 offen sc1
    v_mfma_f32_16x16x32_bf16 v[32:35], v[212:215], v[72:75], v[32:35]
    s_add_u32 s91, s91, 131072
    v_mfma_f32_16x16x32_bf16 v[28:31], v[212:215], v[68:71], v[28:31]
    ds_read_b128 v[88:91], v2 offset:63488
    v_mfma_f32_16x16x32_bf16 v[36:39], v[216:219], v[68:71], v[36:39]
    v_mfma_f32_16x16x32_bf16 v[40:43], v[216:219], v[72:75], v[40:43]
    s_waitcnt lgkmcnt(2)
    v_mfma_f32_16x16x32_bf16 v[20:23], v[220:223], v[76:79], v[20:23]
    ds_read_b128 v[92:95], v3 offset:61440
    v_mfma_f32_16x16x32_bf16 v[24:27], v[220:223], v[80:83], v[24:27]
    v_mfma_f32_16x16x32_bf16 v[32:35], v[224:227], v[80:83], v[32:35]
    v_mfma_f32_16x16x32_bf16 v[28:31], v[224:227], v[76:79], v[28:31]
    ds_read_b128 v[96:99], v3 offset:63488
    v_mfma_f32_16x16x32_bf16 v[36:39], v[228:231], v[76:79], v[36:39]
    v_mfma_f32_16x16x32_bf16 v[40:43], v[228:231], v[80:83], v[40:43]
    s_waitcnt lgkmcnt(2)
    v_mfma_f32_16x16x32_bf16 v[20:23], v[232:235], v[84:87], v[20:23]
    ds_read_b128 v[68:71], v4 offset:0
    v_mfma_f32_16x16x32_bf16 v[24:27], v[232:235], v[88:91], v[24:27]
    v_mfma_f32_16x16x32_bf16 v[32:35], v[236:239], v[88:91], v[32:35]
    v_mfma_f32_16x16x32_bf16 v[28:31], v[236:239], v[84:87], v[28:31]
    ds_read_b128 v[72:75], v4 offset:2048
    v_mfma_f32_16x16x32_bf16 v[36:39], v[240:243], v[84:87], v[36:39]
    v_mfma_f32_16x16x32_bf16 v[40:43], v[240:243], v[88:91], v[40:43]
    s_waitcnt lgkmcnt(2)
    v_mfma_f32_16x16x32_bf16 v[20:23], v[244:247], v[92:95], v[20:23]
    ds_read_b128 v[76:79], v5 offset:0
    v_mfma_f32_16x16x32_bf16 v[24:27], v[244:247], v[96:99], v[24:27]
    v_mfma_f32_16x16x32_bf16 v[32:35], v[248:251], v[96:99], v[32:35]
    v_mfma_f32_16x16x32_bf16 v[28:31], v[248:251], v[92:95], v[28:31]
    ds_read_b128 v[80:83], v5 offset:2048
    v_mfma_f32_16x16x32_bf16 v[36:39], v[252:255], v[92:95], v[36:39]
    v_mfma_f32_16x16x32_bf16 v[40:43], v[252:255], v[96:99], v[40:43]
    s_add_u32 s36, s36, 1
L_q_b1:
    s_waitcnt lgkmcnt(2)
    v_mfma_f32_16x16x32_bf16 v[44:47], a[0:3], v[68:71], 0
    ds_read_b128 v[84:87], v4 offset:4096
    v_mul_f32 v20, v20, v114
    v_mfma_f32_16x16x32_bf16 v[48:51], a[0:3], v[72:75], 0
    v_mul_f32 v21, v21, v114
    v_mul_f32 v22, v22, v114
    v_mfma_f32_16x16x32_bf16 v[56:59], a[4:7], v[72:75], 0
    v_mul_f32 v23, v23, v114
    v_cvt_pk_bf16_f32 v20, v20, v21
    v_mfma_f32_16x16x32_bf16 v[52:55], a[4:7], v[68:71], 0
    ds_read_b128 v[88:91], v4 offset:6144
    v_cvt_pk_bf16_f32 v21, v22, v23
    v_mfma_f32_16x16x32_bf16 v[60:63], a[8:11], v[68:71], 0
    ds_write_b64 v7, v[20:21] offset:0
    v_mfma_f32_16x16x32_bf16 v[64:67], a[8:11], v[72:75], 0
    s_waitcnt lgkmcnt(3)
    v_mul_f32 v24, v24, v115
    v_mul_f32 v25, v25, v115
    v_mfma_f32_16x16x32_bf16 v[44:47], a[12:15], v[76:79], v[44:47]
    ds_read_b128 v[92:95], v5 offset:4096
    v_mul_f32 v26, v26, v115
    v_mfma_f32_16x16x32_bf16 v[48:51], a[12:15], v[80:83], v[48:51]
    v_mul_f32 v27, v27, v115
    v_cvt_pk_bf16_f32 v24, v24, v25
    v_mfma_f32_16x16x32_bf16 v[56:59], a[16:19], v[80:83], v[56:59]
    v_cvt_pk_bf16_f32 v25, v26, v27
    v_mfma_f32_16x16x32_bf16 v[52:55], a[16:19], v[76:79], v[52:55]
    ds_read_b128 v[96:99], v5 offset:6144
    v_mfma_f32_16x16x32_bf16 v[60:63], a[20:23], v[76:79], v[60:63]
    ds_write_b64 v7, v[24:25] offset:6144
    v_mfma_f32_16x16x32_bf16 v[64:67], a[20:23], v[80:83], v[64:67]
    s_waitcnt lgkmcnt(4)
    v_mul_f32 v28, v28, v114
    v_mul_f32 v29, v29, v114
    v_mfma_f32_16x16x32_bf16 v[44:47], a[24:27], v[84:87], v[44:47]
    ds_read_b128 v[68:71], v4 offset:8192
    v_mul_f32 v30, v30, v114
    v_mfma_f32_16x16x32_bf16 v[48:51], a[24:27], v[88:91], v[48:51]
    v_mul_f32 v31, v31, v114
    v_cvt_pk_bf16_f32 v28, v28, v29
    v_mfma_f32_16x16x32_bf16 v[56:59], a[28:31], v[88:91], v[56:59]
    v_cvt_pk_bf16_f32 v29, v30, v31
    v_mfma_f32_16x16x32_bf16 v[52:55], a[28:31], v[84:87], v[52:55]
    ds_read_b128 v[72:75], v4 offset:10240
    v_mfma_f32_16x16x32_bf16 v[60:63], a[32:35], v[84:87], v[60:63]
    ds_write_b64 v7, v[28:29] offset:1024
    v_mfma_f32_16x16x32_bf16 v[64:67], a[32:35], v[88:91], v[64:67]
    s_waitcnt lgkmcnt(4)
    v_mul_f32 v32, v32, v115
    v_mul_f32 v33, v33, v115
    v_mfma_f32_16x16x32_bf16 v[44:47], a[36:39], v[92:95], v[44:47]
    ds_read_b128 v[76:79], v5 offset:8192
    v_mul_f32 v34, v34, v115
    v_mfma_f32_16x16x32_bf16 v[48:51], a[36:39], v[96:99], v[48:51]
    v_mul_f32 v35, v35, v115
    v_cvt_pk_bf16_f32 v32, v32, v33
    v_mfma_f32_16x16x32_bf16 v[56:59], a[40:43], v[96:99], v[56:59]
    v_cvt_pk_bf16_f32 v33, v34, v35
    v_mfma_f32_16x16x32_bf16 v[52:55], a[40:43], v[92:95], v[52:55]
    ds_read_b128 v[80:83], v5 offset:10240
    v_mfma_f32_16x16x32_bf16 v[60:63], a[44:47], v[92:95], v[60:63]
    ds_write_b64 v7, v[32:33] offset:7168
    v_mfma_f32_16x16x32_bf16 v[64:67], a[44:47], v[96:99], v[64:67]
    s_waitcnt lgkmcnt(4)
    v_mul_f32 v36, v36, v114
    v_mul_f32 v37, v37, v114
    v_mfma_f32_16x16x32_bf16 v[44:47], a[48:51], v[68:71], v[44:47]
    s_waitcnt vmcnt(1)
    ds_read_b128 v[84:87], v4 offset:12288
    v_cmp_ne_u32 vcc, 0, v116
    v_mfma_f32_16x16x32_bf16 v[48:51], a[48:51], v[72:75], v[48:51]
    v_mul_f32 v38, v38, v114
    v_mul_f32 v39, v39, v114
    v_mfma_f32_16x16x32_bf16 v[56:59], a[52:55], v[72:75], v[56:59]
    s_cbranch_vccnz L_spin5
L_back6:
    v_cvt_pk_bf16_f32 v36, v36, v37
    v_cvt_pk_bf16_f32 v37, v38, v39
    v_mfma_f32_16x16x32_bf16 v[52:55], a[52:55], v[68:71], v[52:55]
    ds_read_b128 v[88:91], v4 offset:14336
    v_mfma_f32_16x16x32_bf16 v[60:63], a[56:59], v[68:71], v[60:63]
    ds_write_b64 v8, v[36:37] offset:2048
    v_mfma_f32_16x16x32_bf16 v[64:67], a[56:59], v[72:75], v[64:67]
    s_waitcnt lgkmcnt(4)
    v_mul_f32 v40, v40, v115
    v_mul_f32 v41, v41, v115
    v_mfma_f32_16x16x32_bf16 v[44:47], a[60:63], v[76:79], v[44:47]
    ds_read_b128 v[92:95], v5 offset:12288
    v_mul_f32 v42, v42, v115
    v_mfma_f32_16x16x32_bf16 v[48:51], a[60:63], v[80:83], v[48:51]
    v_mul_f32 v43, v43, v115
    v_cvt_pk_bf16_f32 v40, v40, v41
    v_mfma_f32_16x16x32_bf16 v[56:59], a[64:67], v[80:83], v[56:59]
    v_cvt_pk_bf16_f32 v41, v42, v43
    v_mfma_f32_16x16x32_bf16 v[52:55], a[64:67], v[76:79], v[52:55]
    ds_read_b128 v[96:99], v5 offset:14336
    v_mfma_f32_16x16x32_bf16 v[60:63], a[68:71], v[76:79], v[60:63]
    ds_write_b64 v8, v[40:41] offset:8192
    v_mfma_f32_16x16x32_bf16 v[64:67], a[68:71], v[80:83], v[64:67]
    s_waitcnt lgkmcnt(4)
    s_waitcnt lgkmcnt(0)
    s_barrier
    v_mfma_f32_16x16x32_bf16 v[44:47], a[72:75], v[84:87], v[44:47]
    ds_read_b128 v[68:71], v4 offset:16384
    v_mfma_f32_16x16x32_bf16 v[48:51], a[72:75], v[88:91], v[48:51]
    ds_read_b128 v[20:23], v10 offset:0
    v_mfma_f32_16x16x32_bf16 v[56:59], a[76:79], v[88:91], v[56:59]
    ds_read_b128 v[24:27], v9 offset:1024
    v_mfma_f32_16x16x32_bf16 v[52:55], a[76:79], v[84:87], v[52:55]
    ds_read_b128 v[72:75], v4 offset:18432
    v_mfma_f32_16x16x32_bf16 v[60:63], a[80:83], v[84:87], v[60:63]
    ds_read_b128 v[28:31], v10 offset:1024
    s_add_u32 m0, s43, 0
    v_mfma_f32_16x16x32_bf16 v[64:67], a[80:83], v[88:91], v[64:67]
    s_waitcnt lgkmcnt(6)
    ds_read_b64_tr_b16 v[32:33], v9 offset:2048
    v_mfma_f32_16x16x32_bf16 v[44:47], a[84:87], v[92:95], v[44:47]
    ds_read_b128 v[76:79], v5 offset:16384
    v_mfma_f32_16x16x32_bf16 v[48:51], a[84:87], v[96:99], v[48:51]
    buffer_load_dwordx4 v6, s[8:11], s41 offen offset:0 sc1 lds
    v_mfma_f32_16x16x32_bf16 v[56:59], a[88:91], v[96:99], v[56:59]
    s_add_u32 m0, s43, 3968
    ds_read_b64_tr_b16 v[34:35], v10 offset:2048
    s_waitcnt lgkmcnt(3)
    v_mfma_f32_16x16x32_bf16 v[52:55], a[88:91], v[92:95], v[52:55]
    ds_read_b128 v[80:83], v5 offset:18432
    v_mfma_f32_16x16x32_bf16 v[40:43], v[24:27], v[20:23], 0
    ds_read_b64_tr_b16 v[36:37], v9 offset:2056
    v_mfma_f32_16x16x32_bf16 v[118:121], v[28:31], v[20:23], 0
    ds_read_b64_tr_b16 v[38:39], v10 offset:2056
    v_mfma_f32_16x16x32_bf16 v[60:63], a[92:95], v[92:95], v[60:63]
    v_mfma_f32_16x16x32_bf16 v[64:67], a[92:95], v[96:99], v[64:67]
    s_waitcnt lgkmcnt(7)
    v_cndmask_b32 v40, v40, v41, s[56:57]
    v_cndmask_b32 v42, v42, v43, s[56:57]
    v_mfma_f32_16x16x32_bf16 v[44:47], a[96:99], v[68:71], v[44:47]
    ds_read_b128 v[84:87], v4 offset:20480
    v_cndmask_b32 v118, v118, v119, s[56:57]
    v_mfma_f32_16x16x32_bf16 v[48:51], a[96:99], v[72:75], v[48:51]
    buffer_load_dwordx4 v6, s[8:11], s41 offen offset:128 sc1 lds
    v_mfma_f32_16x16x32_bf16 v[56:59], a[100:103], v[72:75], v[56:59]
    s_add_u32 m0, s43, 7936
    v_cndmask_b32 v120, v120, v121, s[56:57]
    v_cndmask_b32 v40, v18, v40, s[62:63]
    v_mfma_f32_16x16x32_bf16 v[52:55], a[100:103], v[68:71], v[52:55]
    ds_read_b128 v[88:91], v4 offset:22528
    v_cndmask_b32 v42, v18, v42, s[62:63]
    v_mfma_f32_16x16x32_bf16 v[60:63], a[104:107], v[68:71], v[60:63]
    v_cndmask_b32 v22, v40, v118, s[58:59]
    v_cndmask_b32 v23, v42, v120, s[60:61]
    v_mfma_f32_16x16x32_bf16 v[64:67], a[104:107], v[72:75], v[64:67]
    s_waitcnt lgkmcnt(4)
    v_max_f32 v20, v22, v23
    v_mov_b32 v21, v20
    v_mfma_f32_16x16x32_bf16 v[44:47], a[108:111], v[76:79], v[44:47]
    ds_read_b128 v[92:95], v5 offset:20480
    v_mfma_f32_16x16x32_bf16 v[48:51], a[108:111], v[80:83], v[48:51]
    buffer_load_dwordx4 v6, s[8:11], s41 offen offset:256 sc1 lds
    v_mfma_f32_16x16x32_bf16 v[56:59], a[112:115], v[80:83], v[56:59]
    s_add_u32 m0, s43, 11904
    v_permlane16_swap_b32 v20, v21
    v_mfma_f32_16x16x32_bf16 v[52:55], a[112:115], v[76:79], v[52:55]
    ds_read_b128 v[96:99], v5 offset:22528
    v_max_f32 v20, v20, v21
    v_mfma_f32_16x16x32_bf16 v[60:63], a[116:119], v[76:79], v[60:63]
    v_mov_b32 v21, v20
    v_mfma_f32_16x16x32_bf16 v[64:67], a[116:119], v[80:83], v[64:67]
    s_waitcnt lgkmcnt(2)
    v_permlane32_swap_b32 v20, v21
    v_mfma_f32_16x16x32_bf16 v[44:47], a[120:123], v[84:87], v[44:47]
    ds_read_b128 v[68:71], v4 offset:24576
    v_max_f32 v20, v20, v21
    v_mfma_f32_16x16x32_bf16 v[48:51], a[120:123], v[88:91], v[48:51]
    buffer_load_dwordx4 v6, s[8:11], s41 offen offset:384 sc1 lds
    v_mfma_f32_16x16x32_bf16 v[56:59], a[124:127], v[88:91], v[56:59]
    s_add_u32 m0, s43, 15872
    v_mul_f32 v20, s86, v20
    v_fma_f32 v22, v22, s86, -v20
    v_mfma_f32_16x16x32_bf16 v[52:55], a[124:127], v[84:87], v[52:55]
    ds_read_b128 v[72:75], v4 offset:26624
    v_fma_f32 v23, v23, s86, -v20
    v_mfma_f32_16x16x32_bf16 v[60:63], a[128:131], v[84:87], v[60:63]
    v_exp_f32 v22, v22
    v_mfma_f32_16x16x32_bf16 v[64:67], a[128:131], v[88:91], v[64:67]
    s_waitcnt lgkmcnt(2)
    v_exp_f32 v23, v23
    v_mfma_f32_16x16x32_bf16 v[44:47], a[132:135], v[92:95], v[44:47]
    ds_read_b128 v[76:79], v5 offset:24576
    v_cvt_pk_bf16_f32 v28, v22, v23
    v_mfma_f32_16x16x32_bf16 v[48:51], a[132:135], v[96:99], v[48:51]
    buffer_load_dwordx4 v6, s[8:11], s41 offen offset:512 sc1 lds
    v_mfma_f32_16x16x32_bf16 v[56:59], a[136:139], v[96:99], v[56:59]
    s_add_u32 m0, s43, 19840
    v_perm_b32 v24, v28, v28, v14
    v_perm_b32 v25, v28, v28, v15
    v_mfma_f32_16x16x32_bf16 v[52:55], a[136:139], v[92:95], v[52:55]
    ds_read_b128 v[80:83], v5 offset:26624
    v_perm_b32 v26, v28, v28, v16
    v_mfma_f32_16x16x32_bf16 v[60:63], a[140:143], v[92:95], v[60:63]
    v_perm_b32 v27, v28, v28, v17
    v_add_f32 v20, v22, v23
    v_mfma_f32_16x16x32_bf16 v[64:67], a[140:143], v[96:99], v[64:67]
    s_waitcnt lgkmcnt(2)
    v_mov_b32 v21, v20
    s_waitcnt lgkmcnt(8)
    v_mfma_f32_16x16x32_bf16 v[44:47], a[144:147], v[68:71], v[44:47]
    ds_read_b128 v[84:87], v4 offset:28672
    v_mfma_f32_16x16x32_bf16 v[40:43], v[32:35], v[24:27], 0
    v_mfma_f32_16x16x32_bf16 v[118:121], v[36:39], v[24:27], 0
    v_permlane16_swap_b32 v20, v21
    v_mfma_f32_16x16x32_bf16 v[48:51], a[144:147], v[72:75], v[48:51]
    buffer_load_dwordx4 v6, s[8:11], s41 offen offset:640 sc1 lds
    v_mfma_f32_16x16x32_bf16 v[56:59], a[148:151], v[72:75], v[56:59]
    s_add_u32 m0, s43, 23808
    v_add_f32 v20, v20, v21
    v_mov_b32 v21, v20
    v_mfma_f32_16x16x32_bf16 v[52:55], a[148:151], v[68:71], v[52:55]
    ds_read_b128 v[88:91], v4 offset:30720
    v_mfma_f32_16x16x32_bf16 v[60:63], a[152:155], v[68:71], v[60:63]
    v_permlane32_swap_b32 v20, v21
    v_mfma_f32_16x16x32_bf16 v[64:67], a[152:155], v[72:75], v[64:67]
    s_waitcnt lgkmcnt(2)
    v_add_f32 v20, v20, v21
    v_mfma_f32_16x16x32_bf16 v[44:47], a[156:159], v[76:79], v[44:47]
    ds_read_b128 v[92:95], v5 offset:28672
    v_mfma_f32_16x16x32_bf16 v[48:51], a[156:159], v[80:83], v[48:51]
    buffer_load_dwordx4 v6, s[8:11], s41 offen offset:768 sc1 lds
    v_mfma_f32_16x16x32_bf16 v[56:59], a[160:163], v[80:83], v[56:59]
    s_add_u32 m0, s43, 27776
    v_rcp_f32 v20, v20
    v_mfma_f32_16x16x32_bf16 v[52:55], a[160:163], v[76:79], v[52:55]
    ds_read_b128 v[96:99], v5 offset:30720
    v_mul_f32 v40, v40, v20
    v_mfma_f32_16x16x32_bf16 v[60:63], a[164:167], v[76:79], v[60:63]
    v_mul_f32 v41, v41, v20
    v_mul_f32 v42, v42, v20
    v_mfma_f32_16x16x32_bf16 v[64:67], a[164:167], v[80:83], v[64:67]
    s_waitcnt lgkmcnt(2)
    v_mul_f32 v43, v43, v20
    v_cvt_pk_bf16_f32 v28, v40, v41
    v_mfma_f32_16x16x32_bf16 v[44:47], a[168:171], v[84:87], v[44:47]
    ds_read_b128 v[68:71], v4 offset:32768
    v_cvt_pk_bf16_f32 v29, v42, v43
    v_mfma_f32_16x16x32_bf16 v[48:51], a[168:171], v[88:91], v[48:51]
    buffer_load_dwordx4 v6, s[8:11], s41 offen offset:896 sc1 lds
    v_mfma_f32_16x16x32_bf16 v[56:59], a[172:175], v[88:91], v[56:59]
    s_add_u32 m0, s43, 31744
    v_mul_f32 v118, v118, v20
    v_mul_f32 v119, v119, v20
    v_mfma_f32_16x16x32_bf16 v[52:55], a[172:175], v[84:87], v[52:55]
    ds_read_b128 v[72:75], v4 offset:34816
    v_mul_f32 v120, v120, v20
    v_mfma_f32_16x16x32_bf16 v[60:63], a[176:179], v[84:87], v[60:63]
    v_mul_f32 v121, v121, v20
    v_cvt_pk_bf16_f32 v30, v118, v119
    v_mfma_f32_16x16x32_bf16 v[64:67], a[176:179], v[88:91], v[64:67]
    s_waitcnt lgkmcnt(2)
    v_cvt_pk_bf16_f32 v31, v120, v121
    v_mfma_f32_16x16x32_bf16 v[44:47], a[180:183], v[92:95], v[44:47]
    ds_read_b128 v[76:79], v5 offset:32768
    v_mfma_f32_16x16x32_bf16 v[48:51], a[180:183], v[96:99], v[48:51]
    buffer_load_dwordx4 v6, s[8:11], s41 offen offset:1024 sc1 lds
    v_mfma_f32_16x16x32_bf16 v[56:59], a[184:187], v[96:99], v[56:59]
    buffer_store_dwordx4 v[28:31], v1, s[16:19], s44 offen sc1
    v_mfma_f32_16x16x32_bf16 v[52:55], a[184:187], v[92:95], v[52:55]
    s_add_u32 m0, s43, 35712
    ds_read_b128 v[80:83], v5 offset:34816
    s_cmp_eq_u32 s36, 17
    v_mfma_f32_16x16x32_bf16 v[60:63], a[188:191], v[92:95], v[60:63]
    s_cselect_b32 s49, s87, 0x10000
    ds_read_b64 v[32:33], v13 offset:2048
    s_add_u32 s90, s90, s49
    v_mfma_f32_16x16x32_bf16 v[64:67], a[188:191], v[96:99], v[64:67]
    s_waitcnt lgkmcnt(3)
    ds_read_b64 v[34:35], v13 offset:2176
    s_and_b32 s49, s90, 0xffffffff
    v_mfma_f32_16x16x32_bf16 v[44:47], a[192:195], v[68:71], v[44:47]
    s_bitcmp1_b64 s[24:25], s36
    ds_read_b128 v[84:87], v4 offset:36864
    s_cselect_b32 s44, s49, 0x5e00000
    v_mfma_f32_16x16x32_bf16 v[48:51], a[192:195], v[72:75], v[48:51]
    buffer_load_dwordx4 v6, s[8:11], s41 offen offset:1152 sc1 lds
    v_mfma_f32_16x16x32_bf16 v[56:59], a[196:199], v[72:75], v[56:59]
    s_add_u32 m0, s43, 39680
    ds_read_b64 v[36:37], v13 offset:2304
    s_bitcmp1_b64 s[26:27], s36
    v_mfma_f32_16x16x32_bf16 v[52:55], a[196:199], v[68:71], v[52:55]
    s_cselect_b64 s[62:63], 0, -1
    ds_read_b128 v[88:91], v4 offset:38912
    v_mfma_f32_16x16x32_bf16 v[60:63], a[200:203], v[68:71], v[60:63]
    ds_read_b64 v[38:39], v13 offset:2432
    v_mfma_f32_16x16x32_bf16 v[64:67], a[200:203], v[72:75], v[64:67]
    s_waitcnt lgkmcnt(6)
    v_mfma_f32_16x16x32_bf16 v[44:47], a[204:207], v[76:79], v[44:47]
    ds_read_b128 v[92:95], v5 offset:36864
    v_mfma_f32_16x16x32_bf16 v[48:51], a[204:207], v[80:83], v[48:51]
    buffer_load_dwordx4 v6, s[8:11], s41 offen offset:1280 sc1 lds
    v_mfma_f32_16x16x32_bf16 v[56:59], a[208:211], v[80:83], v[56:59]
    s_add_u32 m0, s43, 43648
    v_mfma_f32_16x16x32_bf16 v[52:55], a[208:211], v[76:79], v[52:55]
    s_waitcnt lgkmcnt(1)
    ds_read_b128 v[96:99], v5 offset:38912
    v_add_f32 v40, v36, v38
    v_mfma_f32_16x16x32_bf16 v[60:63], a[212:215], v[76:79], v[60:63]
    v_add_f32 v41, v37, v39
    v_add_f32 v32, v32, v34
    v_mfma_f32_16x16x32_bf16 v[64:67], a[212:215], v[80:83], v[64:67]
    s_waitcnt lgkmcnt(3)
    v_add_f32 v33, v33, v35
    v_add_f32 v32, v32, v40
    v_mfma_f32_16x16x32_bf16 v[44:47], a[216:219], v[84:87], v[44:47]
    ds_read_b128 v[68:71], v4 offset:40960
    v_add_f32 v33, v33, v41
    v_mfma_f32_16x16x32_bf16 v[48:51], a[216:219], v[88:91], v[48:51]
    buffer_load_dwordx4 v6, s[8:11], s41 offen offset:1408 sc1 lds
    v_mfma_f32_16x16x32_bf16 v[56:59], a[220:223], v[88:91], v[56:59]
    s_add_u32 m0, s43, 47616
    v_mov_b32 v40, v32
    v_mov_b32 v41, v33
    v_mfma_f32_16x16x32_bf16 v[52:55], a[220:223], v[84:87], v[52:55]
    ds_read_b128 v[72:75], v4 offset:43008
    v_mfma_f32_16x16x32_bf16 v[60:63], a[224:227], v[84:87], v[60:63]
    v_permlane32_swap_b32 v32, v40
    v_mfma_f32_16x16x32_bf16 v[64:67], a[224:227], v[88:91], v[64:67]
    s_waitcnt lgkmcnt(2)
    v_permlane32_swap_b32 v33, v41
    v_mfma_f32_16x16x32_bf16 v[44:47], a[228:231], v[92:95], v[44:47]
    ds_read_b128 v[76:79], v5 offset:40960
    v_add_f32 v32, v32, v40
    v_mfma_f32_16x16x32_bf16 v[48:51], a[228:231], v[96:99], v[48:51]
    buffer_load_dwordx4 v6, s[8:11], s41 offen offset:1536 sc1 lds
    v_mfma_f32_16x16x32_bf16 v[56:59], a[232:235], v[96:99], v[56:59]
    s_add_u32 m0, s43, 51584
    v_add_f32 v33, v33, v41
    v_mul_f32 v112, 0xba800000, v32
    v_mfma_f32_16x16x32_bf16 v[52:55], a[232:235], v[92:95], v[52:55]
    ds_read_b128 v[80:83], v5 offset:43008
    v_mul_f32 v33, 0x3a800000, v33
    v_mfma_f32_16x16x32_bf16 v[60:63], a[236:239], v[92:95], v[60:63]
    v_fma_f32 v33, -v112, v112, v33
    v_mov_b32 v113, v112
    v_mfma_f32_16x16x32_bf16 v[64:67], a[236:239], v[96:99], v[64:67]
    s_waitcnt lgkmcnt(2)
    v_max_f32 v33, 0, v33
    v_add_f32 v33, 0x3727c5ac, v33
    v_mfma_f32_16x16x32_bf16 v[44:47], a[240:243], v[68:71], v[44:47]
    ds_read_b128 v[84:87], v4 offset:45056
    v_mfma_f32_16x16x32_bf16 v[48:51], a[240:243], v[72:75], v[48:51]
    buffer_load_dwordx4 v6, s[8:11], s41 offen offset:1664 sc1 lds
    v_mfma_f32_16x16x32_bf16 v[56:59], a[244:247], v[72:75], v[56:59]
    s_add_u32 m0, s43, 55552
    v_rsq_f32 v114, v33
    v_mfma_f32_16x16x32_bf16 v[52:55], a[244:247], v[68:71], v[52:55]
    ds_read_b128 v[88:91], v4 offset:47104
    v_mfma_f32_16x16x32_bf16 v[60:63], a[248:251], v[68:71], v[60:63]
    v_permlane16_swap_b32 v112, v113
    v_mfma_f32_16x16x32_bf16 v[64:67], a[248:251], v[72:75], v[64:67]
    s_waitcnt lgkmcnt(2)
    v_mov_b32 v115, v114
    v_fmac_f32 v48, v113, v100
    v_mfma_f32_16x16x32_bf16 v[44:47], a[252:255], v[76:79], v[44:47]
    ds_read_b128 v[92:95], v5 offset:45056
    v_fmac_f32 v52, v112, v104
    v_mfma_f32_16x16x32_bf16 v[48:51], a[252:255], v[80:83], v[48:51]
    buffer_load_dwordx4 v6, s[8:11], s41 offen offset:1792 sc1 lds
    v_mfma_f32_16x16x32_bf16 v[56:59], v[128:131], v[80:83], v[56:59]
    s_add_u32 m0, s43, 59520
    v_permlane16_swap_b32 v114, v115
    v_mfma_f32_16x16x32_bf16 v[52:55], v[128:131], v[76:79], v[52:55]
    ds_read_b128 v[96:99], v5 offset:47104
    v_fmac_f32 v44, v112, v100
    v_mfma_f32_16x16x32_bf16 v[60:63], v[132:135], v[76:79], v[60:63]
    v_fmac_f32 v45, v112, v101
    v_fmac_f32 v46, v112, v102
    v_mfma_f32_16x16x32_bf16 v[64:67], v[132:135], v[80:83], v[64:67]
    s_waitcnt lgkmcnt(2)
    v_fmac_f32 v49, v113, v101
    v_fmac_f32 v50, v113, v102
    v_mfma_f32_16x16x32_bf16 v[44:47], v[136:139], v[84:87], v[44:47]
    ds_read_b128 v[68:71], v4 offset:49152
    v_fmac_f32 v53, v112, v105
    v_mfma_f32_16x16x32_bf16 v[48:51], v[136:139], v[88:91], v[48:51]
    buffer_load_dwordx4 v6, s[8:11], s41 offen offset:1920 sc1 lds
    v_mfma_f32_16x16x32_bf16 v[56:59], v[140:143], v[88:91], v[56:59]
    s_add_u32 m0, s52, 90112
    v_fmac_f32 v47, v112, v103
    v_fmac_f32 v60, v112, v108
    v_mfma_f32_16x16x32_bf16 v[52:55], v[140:143], v[84:87], v[52:55]
    ds_read_b128 v[72:75], v4 offset:51200
    v_fmac_f32 v51, v113, v103
    v_mfma_f32_16x16x32_bf16 v[60:63], v[144:147], v[84:87], v[60:63]
    v_fmac_f32 v56, v113, v104
    v_fmac_f32 v57, v113, v105
    v_mfma_f32_16x16x32_bf16 v[64:67], v[144:147], v[88:91], v[64:67]
    s_waitcnt lgkmcnt(2)
    v_fmac_f32 v54, v112, v106
    v_fmac_f32 v55, v112, v107
    v_mfma_f32_16x16x32_bf16 v[44:47], v[148:151], v[92:95], v[44:47]
    ds_read_b128 v[76:79], v5 offset:49152
    v_fmac_f32 v58, v113, v106
    v_mfma_f32_16x16x32_bf16 v[48:51], v[148:151], v[96:99], v[48:51]
    buffer_load_dwordx4 v1, s[16:19], s46 offen sc1 lds
    v_mfma_f32_16x16x32_bf16 v[56:59], v[152:155], v[96:99], v[56:59]
    s_cmp_eq_u32 s36, s97
    v_med3_i32 v117, s45, 0, v12
    v_add_u32 v117, v117, v11
    v_mfma_f32_16x16x32_bf16 v[52:55], v[152:155], v[92:95], v[52:55]
    s_cselect_b32 s47, 31, -2
    ds_read_b128 v[80:83], v5 offset:51200
    v_fmac_f32 v64, v113, v108
    v_mfma_f32_16x16x32_bf16 v[60:63], v[156:159], v[92:95], v[60:63]
    s_cselect_b64 s[8:9], s[88:89], s[8:9]
    v_fmac_f32 v59, v113, v107
    s_cselect_b32 s55, 0x543fc00, s55
    v_mfma_f32_16x16x32_bf16 v[64:67], v[156:159], v[96:99], v[64:67]
    s_waitcnt lgkmcnt(2)
    s_add_u32 s45, s45, 131072
    s_add_u32 s50, s50, s47
    v_mfma_f32_16x16x32_bf16 v[44:47], v[160:163], v[68:71], v[44:47]
    s_max_i32 s47, s50, 0
    ds_read_b128 v[84:87], v4 offset:53248
    v_fmac_f32 v61, v112, v109
    v_mfma_f32_16x16x32_bf16 v[48:51], v[160:163], v[72:75], v[48:51]
    buffer_load_dword v116, v117, s[16:19], 0 offen sc1
    v_mfma_f32_16x16x32_bf16 v[56:59], v[164:167], v[72:75], v[56:59]
    s_lshl_b32 s41, s47, 15
    v_fmac_f32 v62, v112, v110
    v_fmac_f32 v63, v112, v111
    v_mfma_f32_16x16x32_bf16 v[52:55], v[164:167], v[68:71], v[52:55]
    s_lshl_b32 s46, s47, 10
    ds_read_b128 v[88:91], v4 offset:55296
    v_fmac_f32 v65, v113, v109
    v_mfma_f32_16x16x32_bf16 v[60:63], v[168:171], v[68:71], v[60:63]
    s_sub_u32 s46, s55, s46
    v_mfma_f32_16x16x32_bf16 v[64:67], v[168:171], v[72:75], v[64:67]
    s_waitcnt lgkmcnt(2)
    v_mfma_f32_16x16x32_bf16 v[44:47], v[172:175], v[76:79], v[44:47]
    ds_read_b128 v[92:95], v5 offset:53248
    v_mfma_f32_16x16x32_bf16 v[48:51], v[172:175], v[80:83], v[48:51]
    v_mfma_f32_16x16x32_bf16 v[56:59], v[176:179], v[80:83], v[56:59]
    v_fmac_f32 v66, v113, v110
    v_fmac_f32 v67, v113, v111
    v_mfma_f32_16x16x32_bf16 v[52:55], v[176:179], v[76:79], v[52:55]
    ds_read_b128 v[96:99], v5 offset:55296
    v_mfma_f32_16x16x32_bf16 v[60:63], v[180:183], v[76:79], v[60:63]
    v_mfma_f32_16x16x32_bf16 v[64:67], v[180:183], v[80:83], v[64:67]
    s_waitcnt lgkmcnt(2)
    v_mfma_f32_16x16x32_bf16 v[44:47], v[184:187], v[84:87], v[44:47]
    ds_read_b128 v[68:71], v4 offset:57344
    v_mfma_f32_16x16x32_bf16 v[48:51], v[184:187], v[88:91], v[48:51]
    v_mfma_f32_16x16x32_bf16 v[56:59], v[188:191], v[88:91], v[56:59]
    v_mfma_f32_16x16x32_bf16 v[52:55], v[188:191], v[84:87], v[52:55]
    ds_read_b128 v[72:75], v4 offset:59392
    v_mfma_f32_16x16x32_bf16 v[60:63], v[192:195], v[84:87], v[60:63]
    v_mfma_f32_16x16x32_bf16 v[64:67], v[192:195], v[88:91], v[64:67]
    s_waitcnt lgkmcnt(2)
    v_mfma_f32_16x16x32_bf16 v[44:47], v[196:199], v[92:95], v[44:47]
    ds_read_b128 v[76:79], v5 offset:57344
    v_mfma_f32_16x16x32_bf16 v[48:51], v[196:199], v[96:99], v[48:51]
    v_mfma_f32_16x16x32_bf16 v[56:59], v[200:203], v[96:99], v[56:59]
    v_mfma_f32_16x16x32_bf16 v[52:55], v[200:203], v[92:95], v[52:55]
    ds_read_b128 v[80:83], v5 offset:59392
    v_mfma_f32_16x16x32_bf16 v[60:63], v[204:207], v[92:95], v[60:63]
    s_waitcnt vmcnt(9)
    s_barrier
    v_mfma_f32_16x16x32_bf16 v[64:67], v[204:207], v[96:99], v[64:67]
    s_waitcnt lgkmcnt(2)
    v_mfma_f32_16x16x32_bf16 v[44:47], v[208:211], v[68:71], v[44:47]
    ds_read_b128 v[84:87], v4 offset:61440
    v_mfma_f32_16x16x32_bf16 v[48:51], v[208:211], v[72:75], v[48:51]
    buffer_store_dword v124, v124, s[16:19], s91 offen sc1
    v_mfma_f32_16x16x32_bf16 v[56:59], v[212:215], v[72:75], v[56:59]
    s_add_u32 s91, s91, 131072
    v_mfma_f32_16x16x32_bf16 v[52:55], v[212:215], v[68:71], v[52:55]
    ds_read_b128 v[88:91], v4 offset:63488
    v_mfma_f32_16x16x32_bf16 v[60:63], v[216:219], v[68:71], v[60:63]
    v_mfma_f32_16x16x32_bf16 v[64:67], v[216:219], v[72:75], v[64:67]
    s_waitcnt lgkmcnt(2)
    v_mfma_f32_16x16x32_bf16 v[44:47], v[220:223], v[76:79], v[44:47]
    ds_read_b128 v[92:95], v5 offset:61440
    v_mfma_f32_16x16x32_bf16 v[48:51], v[220:223], v[80:83], v[48:51]
    v_mfma_f32_16x16x32_bf16 v[56:59], v[224:227], v[80:83], v[56:59]
    v_mfma_f32_16x16x32_bf16 v[52:55], v[224:227], v[76:79], v[52:55]
    ds_read_b128 v[96:99], v5 offset:63488
    v_mfma_f32_16x16x32_bf16 v[60:63], v[228:231], v[76:79], v[60:63]
    v_mfma_f32_16x16x32_bf16 v[64:67], v[228:231], v[80:83], v[64:67]
    s_waitcnt lgkmcnt(2)
    v_mfma_f32_16x16x32_bf16 v[44:47], v[232:235], v[84:87], v[44:47]
    ds_read_b128 v[68:71], v2 offset:0
    v_mfma_f32_16x16x32_bf16 v[48:51], v[232:235], v[88:91], v[48:51]
    v_mfma_f32_16x16x32_bf16 v[56:59], v[236:239], v[88:91], v[56:59]
    v_mfma_f32_16x16x32_bf16 v[52:55], v[236:239], v[84:87], v[52:55]
    ds_read_b128 v[72:75], v2 offset:2048
    v_mfma_f32_16x16x32_bf16 v[60:63], v[240:243], v[84:87], v[60:63]
    v_mfma_f32_16x16x32_bf16 v[64:67], v[240:243], v[88:91], v[64:67]
    s_waitcnt lgkmcnt(2)
    v_mfma_f32_16x16x32_bf16 v[44:47], v[244:247], v[92:95], v[44:47]
    ds_read_b128 v[76:79], v3 offset:0
    v_mfma_f32_16x16x32_bf16 v[48:51], v[244:247], v[96:99], v[48:51]
    v_mfma_f32_16x16x32_bf16 v[56:59], v[248:251], v[96:99], v[56:59]
    v_mfma_f32_16x16x32_bf16 v[52:55], v[248:251], v[92:95], v[52:55]
    ds_read_b128 v[80:83], v3 offset:2048
    v_mfma_f32_16x16x32_bf16 v[60:63], v[252:255], v[92:95], v[60:63]
    v_mfma_f32_16x16x32_bf16 v[64:67], v[252:255], v[96:99], v[64:67]
    s_add_u32 s36, s36, 1
    s_cmp_lt_u32 s36, 33
    s_cbranch_scc1 L_q_b0
    s_nop 7
    v_mul_f32 v44, v44, v114
    v_mul_f32 v45, v45, v114
    v_mul_f32 v46, v46, v114
    v_mul_f32 v47, v47, v114
    v_cvt_pk_bf16_f32 v44, v44, v45
    v_cvt_pk_bf16_f32 v45, v46, v47
    ds_write_b64 v7, v[44:45] offset:12288
    v_mul_f32 v48, v48, v115
    v_mul_f32 v49, v49, v115
    v_mul_f32 v50, v50, v115
    v_mul_f32 v51, v51, v115
    v_cvt_pk_bf16_f32 v48, v48, v49
    v_cvt_pk_bf16_f32 v49, v50, v51
    ds_write_b64 v7, v[48:49] offset:18432
    v_mul_f32 v52, v52, v114
    v_mul_f32 v53, v53, v114
    v_mul_f32 v54, v54, v114
    v_mul_f32 v55, v55, v114
    v_cvt_pk_bf16_f32 v52, v52, v53
    v_cvt_pk_bf16_f32 v53, v54, v55
    ds_write_b64 v7, v[52:53] offset:13312
    v_mul_f32 v56, v56, v115
    v_mul_f32 v57, v57, v115
    v_mul_f32 v58, v58, v115
    v_mul_f32 v59, v59, v115
    v_cvt_pk_bf16_f32 v56, v56, v57
    v_cvt_pk_bf16_f32 v57, v58, v59
    ds_write_b64 v7, v[56:57] offset:19456
    v_mul_f32 v60, v60, v114
    v_mul_f32 v61, v61, v114
    v_mul_f32 v62, v62, v114
    v_mul_f32 v63, v63, v114
    v_cvt_pk_bf16_f32 v60, v60, v61
    v_cvt_pk_bf16_f32 v61, v62, v63
    ds_write_b64 v8, v[60:61] offset:14336
    v_mul_f32 v64, v64, v115
    v_mul_f32 v65, v65, v115
    v_mul_f32 v66, v66, v115
    v_mul_f32 v67, v67, v115
    v_cvt_pk_bf16_f32 v64, v64, v65
    v_cvt_pk_bf16_f32 v65, v66, v67
    ds_write_b64 v8, v[64:65] offset:20480
    s_waitcnt lgkmcnt(0)
    s_barrier
    ds_read_b128 v[44:47], v9 offset:6144
    ds_read_b128 v[48:51], v9 offset:13312
    ds_read_b128 v[52:55], v9 offset:7168
    ds_read_b64_tr_b16 v[56:57], v9 offset:14336
    ds_read_b64_tr_b16 v[58:59], v9 offset:8192
    ds_read_b64_tr_b16 v[60:61], v9 offset:14344
    ds_read_b64_tr_b16 v[62:63], v9 offset:8200
    s_waitcnt lgkmcnt(4)
    v_mfma_f32_16x16x32_bf16 v[64:67], v[48:51], v[44:47], 0
    v_mfma_f32_16x16x32_bf16 v[118:121], v[52:55], v[44:47], 0
    s_nop 5
    v_cndmask_b32 v64, v64, v65, s[56:57]
    v_cndmask_b32 v66, v66, v67, s[56:57]
    v_cndmask_b32 v118, v118, v119, s[56:57]
    v_cndmask_b32 v120, v120, v121, s[56:57]
    v_cndmask_b32 v64, v18, v64, s[62:63]
    v_cndmask_b32 v66, v18, v66, s[62:63]
    v_cndmask_b32 v46, v64, v118, s[58:59]
    v_cndmask_b32 v47, v66, v120, s[60:61]
    v_max_f32 v44, v46, v47
    v_mov_b32 v45, v44
    s_nop 1
    v_permlane16_swap_b32 v44, v45
    v_max_f32 v44, v44, v45
    v_mov_b32 v45, v44
    s_nop 1
    v_permlane32_swap_b32 v44, v45
    v_max_f32 v44, v44, v45
    v_mul_f32 v44, s86, v44
    v_fma_f32 v46, v46, s86, -v44
    v_fma_f32 v47, v47, s86, -v44
    v_exp_f32 v46, v46
    v_exp_f32 v47, v47
    s_nop 0
    v_cvt_pk_bf16_f32 v52, v46, v47
    v_perm_b32 v48, v52, v52, v14
    v_perm_b32 v49, v52, v52, v15
    v_perm_b32 v50, v52, v52, v16
    v_perm_b32 v51, v52, v52, v17
    s_waitcnt lgkmcnt(0)
    v_add_f32 v44, v46, v47
    v_mfma_f32_16x16x32_bf16 v[64:67], v[56:59], v[48:51], 0
    v_mfma_f32_16x16x32_bf16 v[118:121], v[60:63], v[48:51], 0
    v_mov_b32 v45, v44
    s_nop 1
    v_permlane16_swap_b32 v44, v45
    v_add_f32 v44, v44, v45
    v_mov_b32 v45, v44
    s_nop 1
    v_permlane32_swap_b32 v44, v45
    v_add_f32 v44, v44, v45
    v_rcp_f32 v44, v44
    s_nop 0
    v_mul_f32 v64, v64, v44
    v_mul_f32 v65, v65, v44
    v_mul_f32 v66, v66, v44
    v_mul_f32 v67, v67, v44
    v_cvt_pk_bf16_f32 v52, v64, v65
    v_cvt_pk_bf16_f32 v53, v66, v67
    v_mul_f32 v118, v118, v44
    v_mul_f32 v119, v119, v44
    v_mul_f32 v120, v120, v44
    v_mul_f32 v121, v121, v44
    v_cvt_pk_bf16_f32 v54, v118, v119
    v_cvt_pk_bf16_f32 v55, v120, v121
    buffer_store_dwordx4 v[52:55], v1, s[16:19], s44 offen sc1
    s_waitcnt vmcnt(0)
    s_barrier
    buffer_store_dword v124, v124, s[16:19], s91 offen sc1
    s_add_u32 s91, s91, 131072
    s_waitcnt vmcnt(0)
    s_endpgm
L_spin1:
    s_mov_b32 s40, 0x20000
L_spin1_l:
    buffer_load_dword v37, v36, s[20:23], 0 offen sc1
    s_sub_u32 s40, s40, 1
    s_waitcnt vmcnt(0)
    v_cmp_eq_u32 vcc, v36, v37
    s_cbranch_scc1 L_back2
    s_cbranch_vccz L_back2
    s_sleep 8
    s_branch L_spin1_l
L_spin3:
    s_mov_b32 s40, 0x20000
L_spin3_l:
    buffer_load_dword v116, v117, s[16:19], 0 offen sc1
    s_sub_u32 s40, s40, 1
    s_waitcnt vmcnt(0)
    v_cmp_ne_u32 vcc, 0, v116
    s_cbranch_scc1 L_back4
    s_cbranch_vccz L_back4
    s_sleep 2
    s_branch L_spin3_l
L_spin5:
    s_mov_b32 s40, 0x20000
L_spin5_l:
    buffer_load_dword v116, v117, s[16:19], 0 offen sc1
    s_sub_u32 s40, s40, 1
    s_waitcnt vmcnt(0)
    v_cmp_ne_u32 vcc, 0, v116
    s_cbranch_scc1 L_back6
    s_cbranch_vccz L_back6
    s_sleep 2
    s_branch L_spin5_l
L_other:
    s_lshr_b32 s48, s2, 3
    s_bitcmp1_b32 s2, 0
    s_cbranch_scc1 L_odd
    v_lshrrev_b32 v6, 2, v0
    v_and_b32 v7, 3, v0
    v_lshlrev_b32 v7, 7, v7
    v_lshl_add_u32 v6, v6, 11, v7
    s_and_b32 s48, s48, 15
    s_lshl2_add_u32 s39, s48, s32
    s_lshl_b32 s39, s39, 15
    s_lshl_b32 s37, s47, 9
    s_add_u32 s39, s39, s37
    s_waitcnt lgkmcnt(0)
    s_mov_b32 s12, s66
    s_mov_b32 s13, s67
    s_mov_b32 s14, 0x600000
    s_mov_b32 s15, 0x00020000
    buffer_load_dword v248, v6, s[12:15], s39 offen
    s_add_u32 s39, s39, 2097152
    buffer_load_dword v249, v6, s[12:15], s39 offen
    s_add_u32 s39, s39, 2097152
    buffer_load_dword v250, v6, s[12:15], s39 offen
    s_add_u32 s39, s39, 2097152
    s_mov_b32 s16, s84
    s_mov_b32 s17, s85
    s_mov_b32 s18, 0x5e00000
    s_mov_b32 s19, 0x00020000
    v_min_u32 v124, 1, v0
    v_lshlrev_b32 v124, 30, v124
    s_lshr_b32 s33, s47, 1
    s_lshl_b32 s33, s33, 1
    s_and_b32 s37, s48, 1
    s_add_u32 s33, s33, s37
    s_and_b32 s35, s47, 1
    s_lshl_b32 s35, s35, 3
    s_lshr_b32 s37, s48, 1
    s_add_u32 s35, s35, s37
    s_add_u32 s34, s35, 24
    s_lshl_b32 s91, s33, 6
    s_add_u32 s91, s91, s34
    s_lshl_b32 s91, s91, 8
    s_add_u32 s91, s91, 0x5540000
    s_cmp_eq_u32 s32, 1
    s_cselect_b32 s91, s91, 0x5f00000
    s_mul_i32 s51, s35, 6
    s_min_u32 s51, s51, 106
    s_lshl_b32 s54, s51, 6
    s_mov_b32 s12, s72
    s_mov_b32 s13, s73
    s_mov_b32 s14, 0x700000
    s_mov_b32 s15, 0x00020000
    s_mov_b32 s39, 7168
    v_lshrrev_b32 v68, 3, v0
    v_lshlrev_b32 v69, 2, v0
    v_and_b32 v69, 64, v69
    v_and_b32 v70, 0x70, v1
    v_xor_b32 v69, v69, v70
    v_mad_u32_u24 v56, v68, s39, v69
    v_add_u32 v57, 57344, v56
    v_add_u32 v58, 128, v56
    v_add_u32 v59, 57472, v56
    v_add_u32 v60, 256, v56
    v_add_u32 v61, 57600, v56
    s_mul_i32 s38, s32, 114688
    s_add_u32 s54, s54, s38
    s_lshl_b32 s42, s32, 11
    s_add_u32 m0, s42, 0
    s_nop 0
    buffer_load_dwordx4 v56, s[12:15], s54 offen lds
    s_add_u32 m0, s42, 1024
    s_nop 0
    buffer_load_dwordx4 v57, s[12:15], s54 offen lds
    s_add_u32 m0, s42, 8192
    s_nop 0
    buffer_load_dwordx4 v58, s[12:15], s54 offen lds
    s_add_u32 m0, s42, 9216
    s_nop 0
    buffer_load_dwordx4 v59, s[12:15], s54 offen lds
    s_add_u32 m0, s42, 16384
    s_nop 0
    buffer_load_dwordx4 v60, s[12:15], s54 offen lds
    s_add_u32 m0, s42, 17408
    s_nop 0
    buffer_load_dwordx4 v61, s[12:15], s54 offen lds
    s_add_u32 s54, s54, 458752
    s_add_u32 m0, s42, 24576
    s_nop 0
    buffer_load_dwordx4 v56, s[12:15], s54 offen lds
    s_add_u32 m0, s42, 25600
    s_nop 0
    buffer_load_dwordx4 v57, s[12:15], s54 offen lds
    s_add_u32 m0, s42, 32768
    s_nop 0
    buffer_load_dwordx4 v58, s[12:15], s54 offen lds
    s_add_u32 m0, s42, 33792
    s_nop 0
    buffer_load_dwordx4 v59, s[12:15], s54 offen lds
    s_add_u32 m0, s42, 40960
    s_nop 0
    buffer_load_dwordx4 v60, s[12:15], s54 offen lds
    s_add_u32 m0, s42, 41984
    s_nop 0
    buffer_load_dwordx4 v61, s[12:15], s54 offen lds
    s_add_u32 s54, s54, 458752
    s_add_u32 m0, s42, 49152
    s_nop 0
    buffer_load_dwordx4 v56, s[12:15], s54 offen lds
    s_add_u32 m0, s42, 50176
    s_nop 0
    buffer_load_dwordx4 v57, s[12:15], s54 offen lds
    s_add_u32 m0, s42, 57344
    s_nop 0
    buffer_load_dwordx4 v58, s[12:15], s54 offen lds
    s_add_u32 m0, s42, 58368
    s_nop 0
    buffer_load_dwordx4 v59, s[12:15], s54 offen lds
    s_add_u32 m0, s42, 65536
    s_nop 0
    buffer_load_dwordx4 v60, s[12:15], s54 offen lds
    s_add_u32 m0, s42, 66560
    s_nop 0
    buffer_load_dwordx4 v61, s[12:15], s54 offen lds
    s_add_u32 s54, s54, 458752
    s_add_u32 m0, s42, 73728
    s_nop 0
    buffer_load_dwordx4 v56, s[12:15], s54 offen lds
    s_add_u32 m0, s42, 74752
    s_nop 0
    buffer_load_dwordx4 v57, s[12:15], s54 offen lds
    s_add_u32 m0, s42, 81920
    s_nop 0
    buffer_load_dwordx4 v58, s[12:15], s54 offen lds
    s_add_u32 m0, s42, 82944
    s_nop 0
    buffer_load_dwordx4 v59, s[12:15], s54 offen lds
    s_add_u32 m0, s42, 90112
    s_nop 0
    buffer_load_dwordx4 v60, s[12:15], s54 offen lds
    s_add_u32 m0, s42, 91136
    s_nop 0
    buffer_load_dwordx4 v61, s[12:15], s54 offen lds
    s_add_u32 s54, s54, 458752
    s_add_u32 m0, s42, 98304
    s_nop 0
    buffer_load_dwordx4 v56, s[12:15], s54 offen lds
    s_add_u32 m0, s42, 99328
    s_nop 0
    buffer_load_dwordx4 v57, s[12:15], s54 offen lds
    s_add_u32 m0, s42, 106496
    s_nop 0
    buffer_load_dwordx4 v58, s[12:15], s54 offen lds
    s_add_u32 m0, s42, 107520
    s_nop 0
    buffer_load_dwordx4 v59, s[12:15], s54 offen lds
    s_add_u32 m0, s42, 114688
    s_nop 0
    buffer_load_dwordx4 v60, s[12:15], s54 offen lds
    s_add_u32 m0, s42, 115712
    s_nop 0
    buffer_load_dwordx4 v61, s[12:15], s54 offen lds
    s_add_u32 s54, s54, 458752
    v_lshrrev_b32 v68, 4, v0
    v_bfe_u32 v69, v0, 2, 2
    v_lshl_add_u32 v68, v68, 3, v69
    v_lshlrev_b32 v68, 7, v68
    v_lshrrev_b32 v69, 1, v69
    v_lshl_add_u32 v68, v69, 6, v68
    v_and_b32 v69, 3, v0
    v_lshl_add_u32 v68, v69, 4, v68
    s_lshr_b32 s37, s32, 1
    s_lshl_b32 s37, s37, 13
    s_and_b32 s38, s32, 1
    s_lshl_b32 s38, s38, 6
    s_add_u32 s37, s37, s38
    s_add_u32 s37, s37, 0
    v_xor_b32 v62, s37, v68
    s_lshr_b32 s37, s32, 1
    s_lshl_b32 s37, s37, 13
    s_and_b32 s38, s32, 1
    s_lshl_b32 s38, s38, 6
    s_add_u32 s37, s37, s38
    s_add_u32 s37, s37, 8
    v_xor_b32 v63, s37, v68
    s_lshr_b32 s37, s32, 1
    s_lshl_b32 s37, s37, 6
    s_and_b32 s38, s32, 1
    s_lshl_b32 s38, s38, 3
    s_add_u32 s37, s37, s38
    s_add_u32 s37, s37, 16384
    v_xor_b32 v64, s37, v68
    v_mov_b32 v68, 0x3f803f80
    v_mov_b32 v69, 0x3f803f80
    v_mov_b32 v70, 0x3f803f80
    v_mov_b32 v71, 0x3f803f80
    v_add_u32 v2, 98304, v1
    s_lshl_b32 s37, s33, 6
    s_add_u32 s37, s37, 16
    s_lshl_b32 s37, s37, 8
    v_lshl_add_u32 v5, v0, 8, s37
    s_cmp_eq_u32 s32, 0
    s_cselect_b32 s37, 8, 0
    v_cmp_le_u32 vcc, s37, v0
    s_nop 1
    v_cndmask_b32 v5, v5, 2.0, vcc
    s_lshl_b32 s43, s32, 12
    s_mul_i32 s41, s33, 2097152
    s_add_u32 s41, s41, 0x800000
    s_add_u32 s41, s41, s43
    s_mul_i32 s90, s33, 8388608
    s_add_u32 s90, s90, 0xfc0000
    s_add_u32 s37, s51, s32
    s_lshl_b32 s37, s37, 11
    s_add_u32 s90, s90, s37
    s_lshl_b32 s37, s32, 10
    s_sub_u32 s87, 8192, s37
    s_lshl_b32 s38, s35, 1
    s_lshr_b32 s39, s32, 1
    s_add_u32 s38, s38, s39
    s_cmp_eq_u32 s38, 36
    s_cselect_b32 s88, 0x5e00000, 0
    s_and_b32 s38, s32, 1
    s_lshl_b32 s38, s38, 3
    s_and_b32 s39, s32, 2
    s_lshl_b32 s39, s39, 10
    s_add_u32 s38, s38, s39
    s_add_u32 s38, s38, 65536
    v_add_u32 v3, s38, v1
    s_add_u32 s37, s37, 65536
    v_add_u32 v4, s37, v1
    v_and_b32 v6, 15, v0
    v_lshlrev_b32 v6, 3, v6
    v_lshrrev_b32 v8, 5, v0
    v_lshl_add_u32 v6, v8, 9, v6
    v_and_b32 v8, 16, v0
    v_lshl_add_u32 v6, v8, 6, v6
    v_add_u32 v118, 73728, v6
    s_mul_i32 s46, s33, 65536
    s_add_u32 s46, s46, 0x5440000
    s_add_u32 s55, s46, 63488
    s_and_b32 s52, s32, 1
    s_lshl_b32 s52, s52, 10
    s_mov_b32 s8, s74
    s_mov_b32 s9, s75
    s_mov_b32 s10, 0x1c00
    s_mov_b32 s11, 0x00020000
    v_and_b32 v8, 0x30, v0
    s_add_u32 s37, s51, s32
    s_lshl_b32 s37, s37, 6
    buffer_load_dwordx4 v[16:19], v8, s[8:11], s37 offen
    s_lshr_b32 s37, s32, 1
    s_add_u32 s37, s37, s51
    s_lshl_b32 s37, s37, 6
    s_and_b32 s38, s32, 1
    s_lshl_b32 s38, s38, 3
    s_add_u32 s37, s37, s38
    buffer_load_dwordx2 v[20:21], v8, s[8:11], s37 offen offset:256
    v_add_u32 v65, 0, v62
    v_add_u32 v66, 0, v63
    v_add_u32 v67, 0, v64
    s_waitcnt vmcnt(26)
    s_barrier
    ds_read_b64_tr_b16 a[0:1], v65 offset:0
    ds_read_b64_tr_b16 a[2:3], v65 offset:512
    ds_read_b64_tr_b16 a[4:5], v66 offset:0
    ds_read_b64_tr_b16 a[6:7], v66 offset:512
    ds_read_b64_tr_b16 a[8:9], v67 offset:0
    ds_read_b64_tr_b16 a[10:11], v67 offset:512
    ds_read_b64_tr_b16 a[12:13], v65 offset:4096
    ds_read_b64_tr_b16 a[14:15], v65 offset:4608
    ds_read_b64_tr_b16 a[16:17], v66 offset:4096
    ds_read_b64_tr_b16 a[18:19], v66 offset:4608
    ds_read_b64_tr_b16 a[20:21], v67 offset:4096
    ds_read_b64_tr_b16 a[22:23], v67 offset:4608
    s_add_u32 m0, s42, 122880
    s_nop 0
    buffer_load_dwordx4 v56, s[12:15], s54 offen lds
    s_add_u32 m0, s42, 123904
    s_nop 0
    buffer_load_dwordx4 v57, s[12:15], s54 offen lds
    s_add_u32 m0, s42, 131072
    s_nop 0
    buffer_load_dwordx4 v58, s[12:15], s54 offen lds
    s_add_u32 m0, s42, 132096
    s_nop 0
    buffer_load_dwordx4 v59, s[12:15], s54 offen lds
    s_add_u32 m0, s42, 139264
    s_nop 0
    buffer_load_dwordx4 v60, s[12:15], s54 offen lds
    s_add_u32 m0, s42, 140288
    s_nop 0
    buffer_load_dwordx4 v61, s[12:15], s54 offen lds
    s_add_u32 s54, s54, 458752
    s_waitcnt lgkmcnt(0)
    v_mfma_f32_16x16x32_bf16 v[88:91], a[0:3], v[68:71], 0
    v_mfma_f32_16x16x32_bf16 v[92:95], a[4:7], v[68:71], 0
    v_mfma_f32_16x16x32_bf16 v[96:99], a[8:11], v[68:71], 0
    v_mfma_f32_16x16x32_bf16 v[88:91], a[12:15], v[68:71], v[88:91]
    v_mfma_f32_16x16x32_bf16 v[92:95], a[16:19], v[68:71], v[92:95]
    v_mfma_f32_16x16x32_bf16 v[96:99], a[20:23], v[68:71], v[96:99]
    v_add_u32 v65, 24576, v62
    v_add_u32 v66, 24576, v63
    v_add_u32 v67, 24576, v64
    s_waitcnt vmcnt(26)
    s_barrier
    ds_read_b64_tr_b16 a[24:25], v65 offset:0
    ds_read_b64_tr_b16 a[26:27], v65 offset:512
    ds_read_b64_tr_b16 a[28:29], v66 offset:0
    ds_read_b64_tr_b16 a[30:31], v66 offset:512
    ds_read_b64_tr_b16 a[32:33], v67 offset:0
    ds_read_b64_tr_b16 a[34:35], v67 offset:512
    ds_read_b64_tr_b16 a[36:37], v65 offset:4096
    ds_read_b64_tr_b16 a[38:39], v65 offset:4608
    ds_read_b64_tr_b16 a[40:41], v66 offset:4096
    ds_read_b64_tr_b16 a[42:43], v66 offset:4608
    ds_read_b64_tr_b16 a[44:45], v67 offset:4096
    ds_read_b64_tr_b16 a[46:47], v67 offset:4608
    s_add_u32 m0, s42, 0
    s_nop 0
    buffer_load_dwordx4 v56, s[12:15], s54 offen lds
    s_add_u32 m0, s42, 1024
    s_nop 0
    buffer_load_dwordx4 v57, s[12:15], s54 offen lds
    s_add_u32 m0, s42, 8192
    s_nop 0
    buffer_load_dwordx4 v58, s[12:15], s54 offen lds
    s_add_u32 m0, s42, 9216
    s_nop 0
    buffer_load_dwordx4 v59, s[12:15], s54 offen lds
    s_add_u32 m0, s42, 16384
    s_nop 0
    buffer_load_dwordx4 v60, s[12:15], s54 offen lds
    s_add_u32 m0, s42, 17408
    s_nop 0
    buffer_load_dwordx4 v61, s[12:15], s54 offen lds
    s_add_u32 s54, s54, 458752
    s_waitcnt lgkmcnt(0)
    v_mfma_f32_16x16x32_bf16 v[88:91], a[24:27], v[68:71], v[88:91]
    v_mfma_f32_16x16x32_bf16 v[92:95], a[28:31], v[68:71], v[92:95]
    v_mfma_f32_16x16x32_bf16 v[96:99], a[32:35], v[68:71], v[96:99]
    v_mfma_f32_16x16x32_bf16 v[88:91], a[36:39], v[68:71], v[88:91]
    v_mfma_f32_16x16x32_bf16 v[92:95], a[40:43], v[68:71], v[92:95]
    v_mfma_f32_16x16x32_bf16 v[96:99], a[44:47], v[68:71], v[96:99]
    v_add_u32 v65, 49152, v62
    v_add_u32 v66, 49152, v63
    v_add_u32 v67, 49152, v64
    s_waitcnt vmcnt(26)
    s_barrier
    ds_read_b64_tr_b16 a[48:49], v65 offset:0
    ds_read_b64_tr_b16 a[50:51], v65 offset:512
    ds_read_b64_tr_b16 a[52:53], v66 offset:0
    ds_read_b64_tr_b16 a[54:55], v66 offset:512
    ds_read_b64_tr_b16 a[56:57], v67 offset:0
    ds_read_b64_tr_b16 a[58:59], v67 offset:512
    ds_read_b64_tr_b16 a[60:61], v65 offset:4096
    ds_read_b64_tr_b16 a[62:63], v65 offset:4608
    ds_read_b64_tr_b16 a[64:65], v66 offset:4096
    ds_read_b64_tr_b16 a[66:67], v66 offset:4608
    ds_read_b64_tr_b16 a[68:69], v67 offset:4096
    ds_read_b64_tr_b16 a[70:71], v67 offset:4608
    s_add_u32 m0, s42, 24576
    s_nop 0
    buffer_load_dwordx4 v56, s[12:15], s54 offen lds
    s_add_u32 m0, s42, 25600
    s_nop 0
    buffer_load_dwordx4 v57, s[12:15], s54 offen lds
    s_add_u32 m0, s42, 32768
    s_nop 0
    buffer_load_dwordx4 v58, s[12:15], s54 offen lds
    s_add_u32 m0, s42, 33792
    s_nop 0
    buffer_load_dwordx4 v59, s[12:15], s54 offen lds
    s_add_u32 m0, s42, 40960
    s_nop 0
    buffer_load_dwordx4 v60, s[12:15], s54 offen lds
    s_add_u32 m0, s42, 41984
    s_nop 0
    buffer_load_dwordx4 v61, s[12:15], s54 offen lds
    s_add_u32 s54, s54, 458752
    s_waitcnt lgkmcnt(0)
    v_mfma_f32_16x16x32_bf16 v[88:91], a[48:51], v[68:71], v[88:91]
    v_mfma_f32_16x16x32_bf16 v[92:95], a[52:55], v[68:71], v[92:95]
    v_mfma_f32_16x16x32_bf16 v[96:99], a[56:59], v[68:71], v[96:99]
    v_mfma_f32_16x16x32_bf16 v[88:91], a[60:63], v[68:71], v[88:91]
    v_mfma_f32_16x16x32_bf16 v[92:95], a[64:67], v[68:71], v[92:95]
    v_mfma_f32_16x16x32_bf16 v[96:99], a[68:71], v[68:71], v[96:99]
    v_add_u32 v65, 73728, v62
    v_add_u32 v66, 73728, v63
    v_add_u32 v67, 73728, v64
    s_waitcnt vmcnt(26)
    s_barrier
    ds_read_b64_tr_b16 a[72:73], v65 offset:0
    ds_read_b64_tr_b16 a[74:75], v65 offset:512
    ds_read_b64_tr_b16 a[76:77], v66 offset:0
    ds_read_b64_tr_b16 a[78:79], v66 offset:512
    ds_read_b64_tr_b16 a[80:81], v67 offset:0
    ds_read_b64_tr_b16 a[82:83], v67 offset:512
    ds_read_b64_tr_b16 a[84:85], v65 offset:4096
    ds_read_b64_tr_b16 a[86:87], v65 offset:4608
    ds_read_b64_tr_b16 a[88:89], v66 offset:4096
    ds_read_b64_tr_b16 a[90:91], v66 offset:4608
    ds_read_b64_tr_b16 a[92:93], v67 offset:4096
    ds_read_b64_tr_b16 a[94:95], v67 offset:4608
    s_add_u32 m0, s42, 49152
    s_nop 0
    buffer_load_dwordx4 v56, s[12:15], s54 offen lds
    s_add_u32 m0, s42, 50176
    s_nop 0
    buffer_load_dwordx4 v57, s[12:15], s54 offen lds
    s_add_u32 m0, s42, 57344
    s_nop 0
    buffer_load_dwordx4 v58, s[12:15], s54 offen lds
    s_add_u32 m0, s42, 58368
    s_nop 0
    buffer_load_dwordx4 v59, s[12:15], s54 offen lds
    s_add_u32 m0, s42, 65536
    s_nop 0
    buffer_load_dwordx4 v60, s[12:15], s54 offen lds
    s_add_u32 m0, s42, 66560
    s_nop 0
    buffer_load_dwordx4 v61, s[12:15], s54 offen lds
    s_add_u32 s54, s54, 458752
    s_waitcnt lgkmcnt(0)
    v_mfma_f32_16x16x32_bf16 v[88:91], a[72:75], v[68:71], v[88:91]
    v_mfma_f32_16x16x32_bf16 v[92:95], a[76:79], v[68:71], v[92:95]
    v_mfma_f32_16x16x32_bf16 v[96:99], a[80:83], v[68:71], v[96:99]
    v_mfma_f32_16x16x32_bf16 v[88:91], a[84:87], v[68:71], v[88:91]
    v_mfma_f32_16x16x32_bf16 v[92:95], a[88:91], v[68:71], v[92:95]
    v_mfma_f32_16x16x32_bf16 v[96:99], a[92:95], v[68:71], v[96:99]
    v_add_u32 v65, 98304, v62
    v_add_u32 v66, 98304, v63
    v_add_u32 v67, 98304, v64
    s_waitcnt vmcnt(26)
    s_barrier
    ds_read_b64_tr_b16 a[96:97], v65 offset:0
    ds_read_b64_tr_b16 a[98:99], v65 offset:512
    ds_read_b64_tr_b16 a[100:101], v66 offset:0
    ds_read_b64_tr_b16 a[102:103], v66 offset:512
    ds_read_b64_tr_b16 a[104:105], v67 offset:0
    ds_read_b64_tr_b16 a[106:107], v67 offset:512
    ds_read_b64_tr_b16 a[108:109], v65 offset:4096
    ds_read_b64_tr_b16 a[110:111], v65 offset:4608
    ds_read_b64_tr_b16 a[112:113], v66 offset:4096
    ds_read_b64_tr_b16 a[114:115], v66 offset:4608
    ds_read_b64_tr_b16 a[116:117], v67 offset:4096
    ds_read_b64_tr_b16 a[118:119], v67 offset:4608
    s_add_u32 m0, s42, 73728
    s_nop 0
    buffer_load_dwordx4 v56, s[12:15], s54 offen lds
    s_add_u32 m0, s42, 74752
    s_nop 0
    buffer_load_dwordx4 v57, s[12:15], s54 offen lds
    s_add_u32 m0, s42, 81920
    s_nop 0
    buffer_load_dwordx4 v58, s[12:15], s54 offen lds
    s_add_u32 m0, s42, 82944
    s_nop 0
    buffer_load_dwordx4 v59, s[12:15], s54 offen lds
    s_add_u32 m0, s42, 90112
    s_nop 0
    buffer_load_dwordx4 v60, s[12:15], s54 offen lds
    s_add_u32 m0, s42, 91136
    s_nop 0
    buffer_load_dwordx4 v61, s[12:15], s54 offen lds
    s_add_u32 s54, s54, 458752
    s_waitcnt lgkmcnt(0)
    v_mfma_f32_16x16x32_bf16 v[88:91], a[96:99], v[68:71], v[88:91]
    v_mfma_f32_16x16x32_bf16 v[92:95], a[100:103], v[68:71], v[92:95]
    v_mfma_f32_16x16x32_bf16 v[96:99], a[104:107], v[68:71], v[96:99]
    v_mfma_f32_16x16x32_bf16 v[88:91], a[108:111], v[68:71], v[88:91]
    v_mfma_f32_16x16x32_bf16 v[92:95], a[112:115], v[68:71], v[92:95]
    v_mfma_f32_16x16x32_bf16 v[96:99], a[116:119], v[68:71], v[96:99]
    v_add_u32 v65, 122880, v62
    v_add_u32 v66, 122880, v63
    v_add_u32 v67, 122880, v64
    s_waitcnt vmcnt(24)
    s_barrier
    ds_read_b64_tr_b16 a[120:121], v65 offset:0
    ds_read_b64_tr_b16 a[122:123], v65 offset:512
    ds_read_b64_tr_b16 a[124:125], v66 offset:0
    ds_read_b64_tr_b16 a[126:127], v66 offset:512
    ds_read_b64_tr_b16 a[128:129], v67 offset:0
    ds_read_b64_tr_b16 a[130:131], v67 offset:512
    ds_read_b64_tr_b16 a[132:133], v65 offset:4096
    ds_read_b64_tr_b16 a[134:135], v65 offset:4608
    ds_read_b64_tr_b16 a[136:137], v66 offset:4096
    ds_read_b64_tr_b16 a[138:139], v66 offset:4608
    ds_read_b64_tr_b16 a[140:141], v67 offset:4096
    ds_read_b64_tr_b16 a[142:143], v67 offset:4608
    s_add_u32 m0, s42, 98304
    s_nop 0
    buffer_load_dwordx4 v56, s[12:15], s54 offen lds
    s_add_u32 m0, s42, 99328
    s_nop 0
    buffer_load_dwordx4 v57, s[12:15], s54 offen lds
    s_add_u32 m0, s42, 106496
    s_nop 0
    buffer_load_dwordx4 v58, s[12:15], s54 offen lds
    s_add_u32 m0, s42, 107520
    s_nop 0
    buffer_load_dwordx4 v59, s[12:15], s54 offen lds
    s_add_u32 m0, s42, 114688
    s_nop 0
    buffer_load_dwordx4 v60, s[12:15], s54 offen lds
    s_add_u32 m0, s42, 115712
    s_nop 0
    buffer_load_dwordx4 v61, s[12:15], s54 offen lds
    s_add_u32 s54, s54, 458752
    s_waitcnt lgkmcnt(0)
    v_mfma_f32_16x16x32_bf16 v[88:91], a[120:123], v[68:71], v[88:91]
    v_mfma_f32_16x16x32_bf16 v[92:95], a[124:127], v[68:71], v[92:95]
    v_mfma_f32_16x16x32_bf16 v[96:99], a[128:131], v[68:71], v[96:99]
    v_mfma_f32_16x16x32_bf16 v[88:91], a[132:135], v[68:71], v[88:91]
    v_mfma_f32_16x16x32_bf16 v[92:95], a[136:139], v[68:71], v[92:95]
    v_mfma_f32_16x16x32_bf16 v[96:99], a[140:143], v[68:71], v[96:99]
    v_add_u32 v65, 0, v62
    v_add_u32 v66, 0, v63
    v_add_u32 v67, 0, v64
    s_waitcnt vmcnt(24)
    s_barrier
    ds_read_b64_tr_b16 a[144:145], v65 offset:0
    ds_read_b64_tr_b16 a[146:147], v65 offset:512
    ds_read_b64_tr_b16 a[148:149], v66 offset:0
    ds_read_b64_tr_b16 a[150:151], v66 offset:512
    ds_read_b64_tr_b16 a[152:153], v67 offset:0
    ds_read_b64_tr_b16 a[154:155], v67 offset:512
    ds_read_b64_tr_b16 a[156:157], v65 offset:4096
    ds_read_b64_tr_b16 a[158:159], v65 offset:4608
    ds_read_b64_tr_b16 a[160:161], v66 offset:4096
    ds_read_b64_tr_b16 a[162:163], v66 offset:4608
    ds_read_b64_tr_b16 a[164:165], v67 offset:4096
    ds_read_b64_tr_b16 a[166:167], v67 offset:4608
    s_add_u32 m0, s42, 122880
    s_nop 0
    buffer_load_dwordx4 v56, s[12:15], s54 offen lds
    s_add_u32 m0, s42, 123904
    s_nop 0
    buffer_load_dwordx4 v57, s[12:15], s54 offen lds
    s_add_u32 m0, s42, 131072
    s_nop 0
    buffer_load_dwordx4 v58, s[12:15], s54 offen lds
    s_add_u32 m0, s42, 132096
    s_nop 0
    buffer_load_dwordx4 v59, s[12:15], s54 offen lds
    s_add_u32 m0, s42, 139264
    s_nop 0
    buffer_load_dwordx4 v60, s[12:15], s54 offen lds
    s_add_u32 m0, s42, 140288
    s_nop 0
    buffer_load_dwordx4 v61, s[12:15], s54 offen lds
    s_add_u32 s54, s54, 458752
    s_waitcnt lgkmcnt(0)
    v_mfma_f32_16x16x32_bf16 v[88:91], a[144:147], v[68:71], v[88:91]
    v_mfma_f32_16x16x32_bf16 v[92:95], a[148:151], v[68:71], v[92:95]
    v_mfma_f32_16x16x32_bf16 v[96:99], a[152:155], v[68:71], v[96:99]
    v_mfma_f32_16x16x32_bf16 v[88:91], a[156:159], v[68:71], v[88:91]
    v_mfma_f32_16x16x32_bf16 v[92:95], a[160:163], v[68:71], v[92:95]
    v_mfma_f32_16x16x32_bf16 v[96:99], a[164:167], v[68:71], v[96:99]
    v_add_u32 v65, 24576, v62
    v_add_u32 v66, 24576, v63
    v_add_u32 v67, 24576, v64
    s_waitcnt vmcnt(24)
    s_barrier
    ds_read_b64_tr_b16 a[168:169], v65 offset:0
    ds_read_b64_tr_b16 a[170:171], v65 offset:512
    ds_read_b64_tr_b16 a[172:173], v66 offset:0
    ds_read_b64_tr_b16 a[174:175], v66 offset:512
    ds_read_b64_tr_b16 a[176:177], v67 offset:0
    ds_read_b64_tr_b16 a[178:179], v67 offset:512
    ds_read_b64_tr_b16 a[180:181], v65 offset:4096
    ds_read_b64_tr_b16 a[182:183], v65 offset:4608
    ds_read_b64_tr_b16 a[184:185], v66 offset:4096
    ds_read_b64_tr_b16 a[186:187], v66 offset:4608
    ds_read_b64_tr_b16 a[188:189], v67 offset:4096
    ds_read_b64_tr_b16 a[190:191], v67 offset:4608
    s_add_u32 m0, s42, 0
    s_nop 0
    buffer_load_dwordx4 v56, s[12:15], s54 offen lds
    s_add_u32 m0, s42, 1024
    s_nop 0
    buffer_load_dwordx4 v57, s[12:15], s54 offen lds
    s_add_u32 m0, s42, 8192
    s_nop 0
    buffer_load_dwordx4 v58, s[12:15], s54 offen lds
    s_add_u32 m0, s42, 9216
    s_nop 0
    buffer_load_dwordx4 v59, s[12:15], s54 offen lds
    s_add_u32 m0, s42, 16384
    s_nop 0
    buffer_load_dwordx4 v60, s[12:15], s54 offen lds
    s_add_u32 m0, s42, 17408
    s_nop 0
    buffer_load_dwordx4 v61, s[12:15], s54 offen lds
    s_add_u32 s54, s54, 458752
    s_waitcnt lgkmcnt(0)
    v_mfma_f32_16x16x32_bf16 v[88:91], a[168:171], v[68:71], v[88:91]
    v_mfma_f32_16x16x32_bf16 v[92:95], a[172:175], v[68:71], v[92:95]
    v_mfma_f32_16x16x32_bf16 v[96:99], a[176:179], v[68:71], v[96:99]
    v_mfma_f32_16x16x32_bf16 v[88:91], a[180:183], v[68:71], v[88:91]
    v_mfma_f32_16x16x32_bf16 v[92:95], a[184:187], v[68:71], v[92:95]
    v_mfma_f32_16x16x32_bf16 v[96:99], a[188:191], v[68:71], v[96:99]
    v_add_u32 v65, 49152, v62
    v_add_u32 v66, 49152, v63
    v_add_u32 v67, 49152, v64
    s_waitcnt vmcnt(24)
    s_barrier
    ds_read_b64_tr_b16 a[192:193], v65 offset:0
    ds_read_b64_tr_b16 a[194:195], v65 offset:512
    ds_read_b64_tr_b16 a[196:197], v66 offset:0
    ds_read_b64_tr_b16 a[198:199], v66 offset:512
    ds_read_b64_tr_b16 a[200:201], v67 offset:0
    ds_read_b64_tr_b16 a[202:203], v67 offset:512
    ds_read_b64_tr_b16 a[204:205], v65 offset:4096
    ds_read_b64_tr_b16 a[206:207], v65 offset:4608
    ds_read_b64_tr_b16 a[208:209], v66 offset:4096
    ds_read_b64_tr_b16 a[210:211], v66 offset:4608
    ds_read_b64_tr_b16 a[212:213], v67 offset:4096
    ds_read_b64_tr_b16 a[214:215], v67 offset:4608
    s_add_u32 m0, s42, 24576
    s_nop 0
    buffer_load_dwordx4 v56, s[12:15], s54 offen lds
    s_add_u32 m0, s42, 25600
    s_nop 0
    buffer_load_dwordx4 v57, s[12:15], s54 offen lds
    s_add_u32 m0, s42, 32768
    s_nop 0
    buffer_load_dwordx4 v58, s[12:15], s54 offen lds
    s_add_u32 m0, s42, 33792
    s_nop 0
    buffer_load_dwordx4 v59, s[12:15], s54 offen lds
    s_add_u32 m0, s42, 40960
    s_nop 0
    buffer_load_dwordx4 v60, s[12:15], s54 offen lds
    s_add_u32 m0, s42, 41984
    s_nop 0
    buffer_load_dwordx4 v61, s[12:15], s54 offen lds
    s_add_u32 s54, s54, 458752
    s_waitcnt lgkmcnt(0)
    v_mfma_f32_16x16x32_bf16 v[88:91], a[192:195], v[68:71], v[88:91]
    v_mfma_f32_16x16x32_bf16 v[92:95], a[196:199], v[68:71], v[92:95]
    v_mfma_f32_16x16x32_bf16 v[96:99], a[200:203], v[68:71], v[96:99]
    v_mfma_f32_16x16x32_bf16 v[88:91], a[204:207], v[68:71], v[88:91]
    v_mfma_f32_16x16x32_bf16 v[92:95], a[208:211], v[68:71], v[92:95]
    v_mfma_f32_16x16x32_bf16 v[96:99], a[212:215], v[68:71], v[96:99]
    v_add_u32 v65, 73728, v62
    v_add_u32 v66, 73728, v63
    v_add_u32 v67, 73728, v64
    s_waitcnt vmcnt(24)
    s_barrier
    ds_read_b64_tr_b16 a[216:217], v65 offset:0
    ds_read_b64_tr_b16 a[218:219], v65 offset:512
    ds_read_b64_tr_b16 a[220:221], v66 offset:0
    ds_read_b64_tr_b16 a[222:223], v66 offset:512
    ds_read_b64_tr_b16 a[224:225], v67 offset:0
    ds_read_b64_tr_b16 a[226:227], v67 offset:512
    ds_read_b64_tr_b16 a[228:229], v65 offset:4096
    ds_read_b64_tr_b16 a[230:231], v65 offset:4608
    ds_read_b64_tr_b16 a[232:233], v66 offset:4096
    ds_read_b64_tr_b16 a[234:235], v66 offset:4608
    ds_read_b64_tr_b16 a[236:237], v67 offset:4096
    ds_read_b64_tr_b16 a[238:239], v67 offset:4608
    s_add_u32 m0, s42, 49152
    s_nop 0
    buffer_load_dwordx4 v56, s[12:15], s54 offen lds
    s_add_u32 m0, s42, 50176
    s_nop 0
    buffer_load_dwordx4 v57, s[12:15], s54 offen lds
    s_add_u32 m0, s42, 57344
    s_nop 0
    buffer_load_dwordx4 v58, s[12:15], s54 offen lds
    s_add_u32 m0, s42, 58368
    s_nop 0
    buffer_load_dwordx4 v59, s[12:15], s54 offen lds
    s_add_u32 m0, s42, 65536
    s_nop 0
    buffer_load_dwordx4 v60, s[12:15], s54 offen lds
    s_add_u32 m0, s42, 66560
    s_nop 0
    buffer_load_dwordx4 v61, s[12:15], s54 offen lds
    s_add_u32 s54, s54, 458752
    s_waitcnt lgkmcnt(0)
    v_mfma_f32_16x16x32_bf16 v[88:91], a[216:219], v[68:71], v[88:91]
    v_mfma_f32_16x16x32_bf16 v[92:95], a[220:223], v[68:71], v[92:95]
    v_mfma_f32_16x16x32_bf16 v[96:99], a[224:227], v[68:71], v[96:99]
    v_mfma_f32_16x16x32_bf16 v[88:91], a[228:231], v[68:71], v[88:91]
    v_mfma_f32_16x16x32_bf16 v[92:95], a[232:235], v[68:71], v[92:95]
    v_mfma_f32_16x16x32_bf16 v[96:99], a[236:239], v[68:71], v[96:99]
    v_add_u32 v65, 98304, v62
    v_add_u32 v66, 98304, v63
    v_add_u32 v67, 98304, v64
    s_waitcnt vmcnt(24)
    s_barrier
    ds_read_b64_tr_b16 a[240:241], v65 offset:0
    ds_read_b64_tr_b16 a[242:243], v65 offset:512
    ds_read_b64_tr_b16 a[244:245], v66 offset:0
    ds_read_b64_tr_b16 a[246:247], v66 offset:512
    ds_read_b64_tr_b16 a[248:249], v67 offset:0
    ds_read_b64_tr_b16 a[250:251], v67 offset:512
    ds_read_b64_tr_b16 a[252:253], v65 offset:4096
    ds_read_b64_tr_b16 a[254:255], v65 offset:4608
    ds_read_b64_tr_b16 v[128:129], v66 offset:4096
    ds_read_b64_tr_b16 v[130:131], v66 offset:4608
    ds_read_b64_tr_b16 v[132:133], v67 offset:4096
    ds_read_b64_tr_b16 v[134:135], v67 offset:4608
    s_add_u32 m0, s42, 73728
    s_nop 0
    buffer_load_dwordx4 v56, s[12:15], s54 offen lds
    s_add_u32 m0, s42, 74752
    s_nop 0
    buffer_load_dwordx4 v57, s[12:15], s54 offen lds
    s_add_u32 m0, s42, 81920
    s_nop 0
    buffer_load_dwordx4 v58, s[12:15], s54 offen lds
    s_add_u32 m0, s42, 82944
    s_nop 0
    buffer_load_dwordx4 v59, s[12:15], s54 offen lds
    s_add_u32 m0, s42, 90112
    s_nop 0
    buffer_load_dwordx4 v60, s[12:15], s54 offen lds
    s_add_u32 m0, s42, 91136
    s_nop 0
    buffer_load_dwordx4 v61, s[12:15], s54 offen lds
    s_add_u32 s54, s54, 458752
    s_waitcnt lgkmcnt(0)
    v_mfma_f32_16x16x32_bf16 v[88:91], a[240:243], v[68:71], v[88:91]
    v_mfma_f32_16x16x32_bf16 v[92:95], a[244:247], v[68:71], v[92:95]
    v_mfma_f32_16x16x32_bf16 v[96:99], a[248:251], v[68:71], v[96:99]
    v_mfma_f32_16x16x32_bf16 v[88:91], a[252:255], v[68:71], v[88:91]
    v_mfma_f32_16x16x32_bf16 v[92:95], v[128:131], v[68:71], v[92:95]
    v_mfma_f32_16x16x32_bf16 v[96:99], v[132:135], v[68:71], v[96:99]
    v_add_u32 v65, 122880, v62
    v_add_u32 v66, 122880, v63
    v_add_u32 v67, 122880, v64
    s_waitcnt vmcnt(24)
    s_barrier
    ds_read_b64_tr_b16 v[136:137], v65 offset:0
    ds_read_b64_tr_b16 v[138:139], v65 offset:512
    ds_read_b64_tr_b16 v[140:141], v66 offset:0
    ds_read_b64_tr_b16 v[142:143], v66 offset:512
    ds_read_b64_tr_b16 v[144:145], v67 offset:0
    ds_read_b64_tr_b16 v[146:147], v67 offset:512
    ds_read_b64_tr_b16 v[148:149], v65 offset:4096
    ds_read_b64_tr_b16 v[150:151], v65 offset:4608
    ds_read_b64_tr_b16 v[152:153], v66 offset:4096
    ds_read_b64_tr_b16 v[154:155], v66 offset:4608
    ds_read_b64_tr_b16 v[156:157], v67 offset:4096
    ds_read_b64_tr_b16 v[158:159], v67 offset:4608
    s_waitcnt lgkmcnt(0)
    v_mfma_f32_16x16x32_bf16 v[88:91], v[136:139], v[68:71], v[88:91]
    v_mfma_f32_16x16x32_bf16 v[92:95], v[140:143], v[68:71], v[92:95]
    v_mfma_f32_16x16x32_bf16 v[96:99], v[144:147], v[68:71], v[96:99]
    v_mfma_f32_16x16x32_bf16 v[88:91], v[148:151], v[68:71], v[88:91]
    v_mfma_f32_16x16x32_bf16 v[92:95], v[152:155], v[68:71], v[92:95]
    v_mfma_f32_16x16x32_bf16 v[96:99], v[156:159], v[68:71], v[96:99]
    v_add_u32 v65, 0, v62
    v_add_u32 v66, 0, v63
    v_add_u32 v67, 0, v64
    s_waitcnt vmcnt(18)
    s_barrier
    ds_read_b64_tr_b16 v[160:161], v65 offset:0
    ds_read_b64_tr_b16 v[162:163], v65 offset:512
    ds_read_b64_tr_b16 v[164:165], v66 offset:0
    ds_read_b64_tr_b16 v[166:167], v66 offset:512
    ds_read_b64_tr_b16 v[168:169], v67 offset:0
    ds_read_b64_tr_b16 v[170:171], v67 offset:512
    ds_read_b64_tr_b16 v[172:173], v65 offset:4096
    ds_read_b64_tr_b16 v[174:175], v65 offset:4608
    ds_read_b64_tr_b16 v[176:177], v66 offset:4096
    ds_read_b64_tr_b16 v[178:179], v66 offset:4608
    ds_read_b64_tr_b16 v[180:181], v67 offset:4096
    ds_read_b64_tr_b16 v[182:183], v67 offset:4608
    s_waitcnt lgkmcnt(0)
    v_mfma_f32_16x16x32_bf16 v[88:91], v[160:163], v[68:71], v[88:91]
    v_mfma_f32_16x16x32_bf16 v[92:95], v[164:167], v[68:71], v[92:95]
    v_mfma_f32_16x16x32_bf16 v[96:99], v[168:171], v[68:71], v[96:99]
    v_mfma_f32_16x16x32_bf16 v[88:91], v[172:175], v[68:71], v[88:91]
    v_mfma_f32_16x16x32_bf16 v[92:95], v[176:179], v[68:71], v[92:95]
    v_mfma_f32_16x16x32_bf16 v[96:99], v[180:183], v[68:71], v[96:99]
    v_add_u32 v65, 24576, v62
    v_add_u32 v66, 24576, v63
    v_add_u32 v67, 24576, v64
    s_waitcnt vmcnt(12)
    s_barrier
    ds_read_b64_tr_b16 v[184:185], v65 offset:0
    ds_read_b64_tr_b16 v[186:187], v65 offset:512
    ds_read_b64_tr_b16 v[188:189], v66 offset:0
    ds_read_b64_tr_b16 v[190:191], v66 offset:512
    ds_read_b64_tr_b16 v[192:193], v67 offset:0
    ds_read_b64_tr_b16 v[194:195], v67 offset:512
    ds_read_b64_tr_b16 v[196:197], v65 offset:4096
    ds_read_b64_tr_b16 v[198:199], v65 offset:4608
    ds_read_b64_tr_b16 v[200:201], v66 offset:4096
    ds_read_b64_tr_b16 v[202:203], v66 offset:4608
    ds_read_b64_tr_b16 v[204:205], v67 offset:4096
    ds_read_b64_tr_b16 v[206:207], v67 offset:4608
    s_waitcnt lgkmcnt(0)
    v_mfma_f32_16x16x32_bf16 v[88:91], v[184:187], v[68:71], v[88:91]
    v_mfma_f32_16x16x32_bf16 v[92:95], v[188:191], v[68:71], v[92:95]
    v_mfma_f32_16x16x32_bf16 v[96:99], v[192:195], v[68:71], v[96:99]
    v_mfma_f32_16x16x32_bf16 v[88:91], v[196:199], v[68:71], v[88:91]
    v_mfma_f32_16x16x32_bf16 v[92:95], v[200:203], v[68:71], v[92:95]
    v_mfma_f32_16x16x32_bf16 v[96:99], v[204:207], v[68:71], v[96:99]
    v_add_u32 v65, 49152, v62
    v_add_u32 v66, 49152, v63
    v_add_u32 v67, 49152, v64
    s_waitcnt vmcnt(6)
    s_barrier
    ds_read_b64_tr_b16 v[208:209], v65 offset:0
    ds_read_b64_tr_b16 v[210:211], v65 offset:512
    ds_read_b64_tr_b16 v[212:213], v66 offset:0
    ds_read_b64_tr_b16 v[214:215], v66 offset:512
    ds_read_b64_tr_b16 v[216:217], v67 offset:0
    ds_read_b64_tr_b16 v[218:219], v67 offset:512
    ds_read_b64_tr_b16 v[220:221], v65 offset:4096
    ds_read_b64_tr_b16 v[222:223], v65 offset:4608
    ds_read_b64_tr_b16 v[224:225], v66 offset:4096
    ds_read_b64_tr_b16 v[226:227], v66 offset:4608
    ds_read_b64_tr_b16 v[228:229], v67 offset:4096
    ds_read_b64_tr_b16 v[230:231], v67 offset:4608
    s_waitcnt lgkmcnt(0)
    v_mfma_f32_16x16x32_bf16 v[88:91], v[208:211], v[68:71], v[88:91]
    v_mfma_f32_16x16x32_bf16 v[92:95], v[212:215], v[68:71], v[92:95]
    v_mfma_f32_16x16x32_bf16 v[96:99], v[216:219], v[68:71], v[96:99]
    v_mfma_f32_16x16x32_bf16 v[88:91], v[220:223], v[68:71], v[88:91]
    v_mfma_f32_16x16x32_bf16 v[92:95], v[224:227], v[68:71], v[92:95]
    v_mfma_f32_16x16x32_bf16 v[96:99], v[228:231], v[68:71], v[96:99]
    v_add_u32 v65, 73728, v62
    v_add_u32 v66, 73728, v63
    v_add_u32 v67, 73728, v64
    s_waitcnt vmcnt(0)
    s_barrier
    ds_read_b64_tr_b16 v[232:233], v65 offset:0
    ds_read_b64_tr_b16 v[234:235], v65 offset:512
    ds_read_b64_tr_b16 v[236:237], v66 offset:0
    ds_read_b64_tr_b16 v[238:239], v66 offset:512
    ds_read_b64_tr_b16 v[240:241], v67 offset:0
    ds_read_b64_tr_b16 v[242:243], v67 offset:512
    ds_read_b64_tr_b16 v[244:245], v65 offset:4096
    ds_read_b64_tr_b16 v[246:247], v65 offset:4608
    ds_read_b64_tr_b16 v[248:249], v66 offset:4096
    ds_read_b64_tr_b16 v[250:251], v66 offset:4608
    ds_read_b64_tr_b16 v[252:253], v67 offset:4096
    ds_read_b64_tr_b16 v[254:255], v67 offset:4608
    s_waitcnt lgkmcnt(0)
    v_mfma_f32_16x16x32_bf16 v[88:91], v[232:235], v[68:71], v[88:91]
    v_mfma_f32_16x16x32_bf16 v[92:95], v[236:239], v[68:71], v[92:95]
    v_mfma_f32_16x16x32_bf16 v[96:99], v[240:243], v[68:71], v[96:99]
    v_mfma_f32_16x16x32_bf16 v[88:91], v[244:247], v[68:71], v[88:91]
    v_mfma_f32_16x16x32_bf16 v[92:95], v[248:251], v[68:71], v[92:95]
    v_mfma_f32_16x16x32_bf16 v[96:99], v[252:255], v[68:71], v[96:99]
    s_barrier
    s_mov_b32 s37, 0xffff0000
    v_lshlrev_b32 v100, 16, v16
    v_and_b32 v101, s37, v16
    v_lshlrev_b32 v102, 16, v17
    v_and_b32 v103, s37, v17
    v_lshlrev_b32 v104, 16, v18
    v_and_b32 v105, s37, v18
    v_lshlrev_b32 v106, 16, v19
    v_and_b32 v107, s37, v19
    v_lshlrev_b32 v108, 16, v20
    v_and_b32 v109, s37, v20
    v_lshlrev_b32 v110, 16, v21
    v_and_b32 v111, s37, v21
    s_cmp_lg_u32 s32, 0
    s_cbranch_scc1 L_arv7
    s_add_u32 s20, s82, 0x80
    s_addc_u32 s21, s83, 0
    s_mov_b32 s22, 0x4
    s_mov_b32 s23, 0x00020000
    buffer_load_dword v56, v124, s[20:23], 0 offen sc1
    s_waitcnt vmcnt(0)
    v_cmp_eq_u32 vcc, v124, v56
    s_cbranch_vccnz L_spin8
L_back9:
L_arv7:
    s_add_u32 s96, s41, 2031616
    s_mov_b32 s98, s41
    s_mov_b32 s45, 0x5560000
    buffer_load_dword v7, v5, s[16:19], s45 offen sc1
    s_waitcnt vmcnt(0)
    v_cmp_ne_u32 vcc, 0, v7
    s_cbranch_vccnz L_spin10
L_back11:
    s_barrier
    s_add_u32 m0, s43, 0
    s_add_u32 s42, s41, 0
    buffer_load_dwordx4 v1, s[16:19], s42 offen offset:0 sc1 lds
    buffer_load_dwordx4 v1, s[16:19], s42 offen offset:1024 sc1 lds
    buffer_load_dwordx4 v1, s[16:19], s42 offen offset:2048 sc1 lds
    buffer_load_dwordx4 v1, s[16:19], s42 offen offset:3072 sc1 lds
    s_add_u32 m0, s43, 16384
    s_add_u32 s42, s41, 16384
    buffer_load_dwordx4 v1, s[16:19], s42 offen offset:0 sc1 lds
    buffer_load_dwordx4 v1, s[16:19], s42 offen offset:1024 sc1 lds
    buffer_load_dwordx4 v1, s[16:19], s42 offen offset:2048 sc1 lds
    buffer_load_dwordx4 v1, s[16:19], s42 offen offset:3072 sc1 lds
    s_add_u32 m0, s43, 32768
    s_add_u32 s42, s41, 32768
    buffer_load_dwordx4 v1, s[16:19], s42 offen offset:0 sc1 lds
    buffer_load_dwordx4 v1, s[16:19], s42 offen offset:1024 sc1 lds
    buffer_load_dwordx4 v1, s[16:19], s42 offen offset:2048 sc1 lds
    buffer_load_dwordx4 v1, s[16:19], s42 offen offset:3072 sc1 lds
    s_add_u32 s45, s45, 131072
    s_add_u32 m0, s52, 73728
    s_add_u32 s42, s46, s52
    buffer_load_dwordx4 v1, s[16:19], s42 offen sc1 lds
    s_waitcnt vmcnt(0) lgkmcnt(0)
    s_barrier
    ds_read_b128 v[56:59], v1 offset:0
    ds_read_b128 v[60:63], v1 offset:1024
    ds_read_b128 v[64:67], v1 offset:2048
    ds_read_b128 v[68:71], v1 offset:3072
    s_mov_b32 s36, 0
    s_waitcnt lgkmcnt(0)
    s_nop 7
L_a_b0:
    s_waitcnt lgkmcnt(2)
    v_mfma_f32_16x16x32_bf16 v[8:11], a[0:3], v[56:59], 0
    s_and_b32 s44, s90, 0xffffffff
    ds_read_b128 v[72:75], v1 offset:4096
    v_mul_f32 v120, v48, v116
    v_mfma_f32_16x16x32_bf16 v[16:19], a[0:3], v[60:63], 0
    s_cmp_eq_u32 s36, 0
    v_mul_f32 v121, v49, v116
    v_mul_f32 v120, v120, abs(v48)
    v_mfma_f32_16x16x32_bf16 v[20:23], a[4:7], v[60:63], 0
    s_cselect_b32 s44, 0x5e00000, s44
    v_mul_f32 v121, v121, abs(v49)
    v_cvt_pk_bf16_f32 v48, v120, v121
    v_mfma_f32_16x16x32_bf16 v[12:15], a[4:7], v[56:59], 0
    s_add_u32 s49, s44, s87
    ds_read_b128 v[76:79], v1 offset:5120
    v_pk_max_i16 v48, v48, 0
    v_mfma_f32_16x16x32_bf16 v[24:27], a[8:11], v[56:59], 0
    s_max_u32 s44, s44, s88
    v_mul_f32 v120, v50, v116
    v_mul_f32 v121, v51, v116
    v_mfma_f32_16x16x32_bf16 v[28:31], a[8:11], v[60:63], 0
    s_waitcnt lgkmcnt(2)
    v_mul_f32 v120, v120, abs(v50)
    v_mul_f32 v121, v121, abs(v51)
    v_mfma_f32_16x16x32_bf16 v[8:11], a[12:15], v[64:67], v[8:11]
    s_add_u32 s90, s90, 262144
    ds_read_b128 v[80:83], v1 offset:6144
    v_cvt_pk_bf16_f32 v49, v120, v121
    v_mfma_f32_16x16x32_bf16 v[16:19], a[12:15], v[68:71], v[16:19]
    s_add_u32 m0, s52, 73728
    v_pk_max_i16 v49, v49, 0
    s_add_u32 s42, s46, s52
    v_mfma_f32_16x16x32_bf16 v[20:23], a[16:19], v[68:71], v[20:23]
    buffer_load_dwordx4 v1, s[16:19], s42 offen sc1 lds
    v_mfma_f32_16x16x32_bf16 v[12:15], a[16:19], v[64:67], v[12:15]
    ds_read_b128 v[84:87], v1 offset:7168
    v_mfma_f32_16x16x32_bf16 v[24:27], a[20:23], v[64:67], v[24:27]
    ds_write_b64 v3, v[48:49] offset:4096
    v_mfma_f32_16x16x32_bf16 v[28:31], a[20:23], v[68:71], v[28:31]
    s_waitcnt lgkmcnt(3)
    v_mul_f32 v120, v52, v117
    v_mul_f32 v121, v53, v117
    v_mfma_f32_16x16x32_bf16 v[8:11], a[24:27], v[72:75], v[8:11]
    ds_read_b128 v[56:59], v1 offset:8192
    v_mul_f32 v120, v120, abs(v52)
    v_mfma_f32_16x16x32_bf16 v[16:19], a[24:27], v[76:79], v[16:19]
    v_mul_f32 v121, v121, abs(v53)
    v_cvt_pk_bf16_f32 v52, v120, v121
    v_mfma_f32_16x16x32_bf16 v[20:23], a[28:31], v[76:79], v[20:23]
    v_pk_max_i16 v52, v52, 0
    v_mul_f32 v120, v54, v117
    v_mfma_f32_16x16x32_bf16 v[12:15], a[28:31], v[72:75], v[12:15]
    ds_read_b128 v[60:63], v1 offset:9216
    v_mul_f32 v121, v55, v117
    v_mfma_f32_16x16x32_bf16 v[24:27], a[32:35], v[72:75], v[24:27]
    v_mul_f32 v120, v120, abs(v54)
    v_mul_f32 v121, v121, abs(v55)
    v_mfma_f32_16x16x32_bf16 v[28:31], a[32:35], v[76:79], v[28:31]
    s_waitcnt lgkmcnt(3)
    v_cvt_pk_bf16_f32 v53, v120, v121
    v_pk_max_i16 v53, v53, 0
    v_mfma_f32_16x16x32_bf16 v[8:11], a[36:39], v[80:83], v[8:11]
    ds_read_b128 v[64:67], v1 offset:10240
    v_mfma_f32_16x16x32_bf16 v[16:19], a[36:39], v[84:87], v[16:19]
    ds_write_b64 v3, v[52:53] offset:5120
    v_mfma_f32_16x16x32_bf16 v[20:23], a[40:43], v[84:87], v[20:23]
    v_mul_f32 v120, v32, v116
    v_mul_f32 v121, v33, v116
    v_mfma_f32_16x16x32_bf16 v[12:15], a[40:43], v[80:83], v[12:15]
    ds_read_b128 v[68:71], v1 offset:11264
    v_mul_f32 v120, v120, abs(v32)
    v_mfma_f32_16x16x32_bf16 v[24:27], a[44:47], v[80:83], v[24:27]
    v_mul_f32 v121, v121, abs(v33)
    v_cvt_pk_bf16_f32 v32, v120, v121
    v_mfma_f32_16x16x32_bf16 v[28:31], a[44:47], v[84:87], v[28:31]
    s_waitcnt lgkmcnt(3)
    v_pk_max_i16 v32, v32, 0
    v_mul_f32 v120, v34, v116
    v_mfma_f32_16x16x32_bf16 v[8:11], a[48:51], v[56:59], v[8:11]
    ds_read_b128 v[72:75], v1 offset:12288
    v_mul_f32 v121, v35, v116
    v_mfma_f32_16x16x32_bf16 v[16:19], a[48:51], v[60:63], v[16:19]
    v_mul_f32 v120, v120, abs(v34)
    v_mul_f32 v121, v121, abs(v35)
    v_mfma_f32_16x16x32_bf16 v[20:23], a[52:55], v[60:63], v[20:23]
    v_cvt_pk_bf16_f32 v33, v120, v121
    v_pk_max_i16 v33, v33, 0
    v_mfma_f32_16x16x32_bf16 v[12:15], a[52:55], v[56:59], v[12:15]
    ds_read_b128 v[76:79], v1 offset:13312
    v_mul_f32 v120, v36, v116
    v_mfma_f32_16x16x32_bf16 v[24:27], a[56:59], v[56:59], v[24:27]
    v_mul_f32 v121, v37, v116
    v_mul_f32 v120, v120, abs(v36)
    v_mfma_f32_16x16x32_bf16 v[28:31], a[56:59], v[60:63], v[28:31]
    s_waitcnt vmcnt(5) lgkmcnt(2)
    s_barrier
    v_mul_f32 v121, v121, abs(v37)
    v_mfma_f32_16x16x32_bf16 v[8:11], a[60:63], v[64:67], v[8:11]
    ds_read_b128 v[80:83], v1 offset:14336
    v_cvt_pk_bf16_f32 v34, v120, v121
    v_mfma_f32_16x16x32_bf16 v[16:19], a[60:63], v[68:71], v[16:19]
    ds_read_b128 v[48:51], v4 offset:4096
    v_pk_max_i16 v34, v34, 0
    v_mfma_f32_16x16x32_bf16 v[20:23], a[64:67], v[68:71], v[20:23]
    v_mul_f32 v120, v38, v116
    v_mul_f32 v121, v39, v116
    v_mfma_f32_16x16x32_bf16 v[12:15], a[64:67], v[64:67], v[12:15]
    ds_read_b128 v[84:87], v1 offset:15360
    v_mul_f32 v120, v120, abs(v38)
    v_mfma_f32_16x16x32_bf16 v[24:27], a[68:71], v[64:67], v[24:27]
    v_mul_f32 v121, v121, abs(v39)
    v_cvt_pk_bf16_f32 v35, v120, v121
    v_mfma_f32_16x16x32_bf16 v[28:31], a[68:71], v[68:71], v[28:31]
    s_waitcnt lgkmcnt(3)
    v_pk_max_i16 v35, v35, 0
    s_waitcnt lgkmcnt(1)
    v_mfma_f32_16x16x32_bf16 v[8:11], a[72:75], v[72:75], v[8:11]
    ds_read_b128 v[56:59], v1 offset:16384
    v_mfma_f32_16x16x32_bf16 v[16:19], a[72:75], v[76:79], v[16:19]
    buffer_store_dwordx4 v[48:51], v1, s[16:19], s49 offen sc1
    v_mfma_f32_16x16x32_bf16 v[20:23], a[76:79], v[76:79], v[20:23]
    buffer_store_dwordx4 v[32:35], v1, s[16:19], s44 offen offset:0 sc1
    v_mfma_f32_16x16x32_bf16 v[12:15], a[76:79], v[72:75], v[12:15]
    ds_read_b128 v[60:63], v1 offset:17408
    v_mul_f32 v120, v40, v117
    v_mfma_f32_16x16x32_bf16 v[24:27], a[80:83], v[72:75], v[24:27]
    v_mul_f32 v121, v41, v117
    v_mul_f32 v120, v120, abs(v40)
    v_mfma_f32_16x16x32_bf16 v[28:31], a[80:83], v[76:79], v[28:31]
    s_waitcnt lgkmcnt(2)
    v_mul_f32 v121, v121, abs(v41)
    v_cvt_pk_bf16_f32 v40, v120, v121
    v_mfma_f32_16x16x32_bf16 v[8:11], a[84:87], v[80:83], v[8:11]
    ds_read_b128 v[64:67], v1 offset:18432
    v_pk_max_i16 v40, v40, 0
    v_mfma_f32_16x16x32_bf16 v[16:19], a[84:87], v[84:87], v[16:19]
    v_mul_f32 v120, v42, v117
    v_mul_f32 v121, v43, v117
    v_mfma_f32_16x16x32_bf16 v[20:23], a[88:91], v[84:87], v[20:23]
    v_mul_f32 v120, v120, abs(v42)
    v_mul_f32 v121, v121, abs(v43)
    v_mfma_f32_16x16x32_bf16 v[12:15], a[88:91], v[80:83], v[12:15]
    ds_read_b128 v[68:71], v1 offset:19456
    v_cvt_pk_bf16_f32 v41, v120, v121
    v_mfma_f32_16x16x32_bf16 v[24:27], a[92:95], v[80:83], v[24:27]
    v_pk_max_i16 v41, v41, 0
    v_mul_f32 v120, v44, v117
    v_mfma_f32_16x16x32_bf16 v[28:31], a[92:95], v[84:87], v[28:31]
    s_waitcnt lgkmcnt(2)
    v_mul_f32 v121, v45, v117
    v_mul_f32 v120, v120, abs(v44)
    v_mfma_f32_16x16x32_bf16 v[8:11], a[96:99], v[56:59], v[8:11]
    ds_read_b128 v[72:75], v1 offset:20480
    v_mul_f32 v121, v121, abs(v45)
    v_mfma_f32_16x16x32_bf16 v[16:19], a[96:99], v[60:63], v[16:19]
    v_cvt_pk_bf16_f32 v42, v120, v121
    v_pk_max_i16 v42, v42, 0
    v_mfma_f32_16x16x32_bf16 v[20:23], a[100:103], v[60:63], v[20:23]
    v_mul_f32 v120, v46, v117
    v_mul_f32 v121, v47, v117
    v_mfma_f32_16x16x32_bf16 v[12:15], a[100:103], v[56:59], v[12:15]
    ds_read_b128 v[76:79], v1 offset:21504
    v_mul_f32 v120, v120, abs(v46)
    v_mfma_f32_16x16x32_bf16 v[24:27], a[104:107], v[56:59], v[24:27]
    v_mul_f32 v121, v121, abs(v47)
    v_cvt_pk_bf16_f32 v43, v120, v121
    v_mfma_f32_16x16x32_bf16 v[28:31], a[104:107], v[60:63], v[28:31]
    s_waitcnt lgkmcnt(2)
    v_pk_max_i16 v43, v43, 0
    v_mfma_f32_16x16x32_bf16 v[8:11], a[108:111], v[64:67], v[8:11]
    ds_read_b128 v[80:83], v1 offset:22528
    v_mfma_f32_16x16x32_bf16 v[16:19], a[108:111], v[68:71], v[16:19]
    buffer_store_dwordx4 v[40:43], v1, s[16:19], s44 offen offset:1024 sc1
    v_mfma_f32_16x16x32_bf16 v[20:23], a[112:115], v[68:71], v[20:23]
    s_add_u32 m0, s43, 49152
    s_add_u32 s42, s41, 49152
    v_mfma_f32_16x16x32_bf16 v[12:15], a[112:115], v[64:67], v[12:15]
    ds_read_b128 v[84:87], v1 offset:23552
    v_mfma_f32_16x16x32_bf16 v[24:27], a[116:119], v[64:67], v[24:27]
    buffer_load_dwordx4 v1, s[16:19], s42 offen offset:0 sc1 lds
    v_mfma_f32_16x16x32_bf16 v[28:31], a[116:119], v[68:71], v[28:31]
    s_waitcnt lgkmcnt(2)
    v_mfma_f32_16x16x32_bf16 v[8:11], a[120:123], v[72:75], v[8:11]
    ds_read_b128 v[56:59], v1 offset:24576
    v_mfma_f32_16x16x32_bf16 v[16:19], a[120:123], v[76:79], v[16:19]
    buffer_load_dwordx4 v1, s[16:19], s42 offen offset:1024 sc1 lds
    v_mfma_f32_16x16x32_bf16 v[20:23], a[124:127], v[76:79], v[20:23]
    v_mfma_f32_16x16x32_bf16 v[12:15], a[124:127], v[72:75], v[12:15]
    ds_read_b128 v[60:63], v1 offset:25600
    v_mfma_f32_16x16x32_bf16 v[24:27], a[128:131], v[72:75], v[24:27]
    buffer_load_dwordx4 v1, s[16:19], s42 offen offset:2048 sc1 lds
    v_mfma_f32_16x16x32_bf16 v[28:31], a[128:131], v[76:79], v[28:31]
    s_waitcnt lgkmcnt(2)
    v_mfma_f32_16x16x32_bf16 v[8:11], a[132:135], v[80:83], v[8:11]
    ds_read_b128 v[64:67], v1 offset:26624
    v_mfma_f32_16x16x32_bf16 v[16:19], a[132:135], v[84:87], v[16:19]
    buffer_load_dwordx4 v1, s[16:19], s42 offen offset:3072 sc1 lds
    v_mfma_f32_16x16x32_bf16 v[20:23], a[136:139], v[84:87], v[20:23]
    s_add_u32 s98, s98, 65536
    s_min_u32 s98, s98, s96
    s_and_b32 s41, s98, 0xffffffff
    v_mfma_f32_16x16x32_bf16 v[12:15], a[136:139], v[80:83], v[12:15]
    ds_read_b128 v[68:71], v1 offset:27648
    v_mfma_f32_16x16x32_bf16 v[24:27], a[140:143], v[80:83], v[24:27]
    v_mfma_f32_16x16x32_bf16 v[28:31], a[140:143], v[84:87], v[28:31]
    s_waitcnt lgkmcnt(2)
    v_mfma_f32_16x16x32_bf16 v[8:11], a[144:147], v[56:59], v[8:11]
    ds_read_b128 v[72:75], v1 offset:28672
    v_mfma_f32_16x16x32_bf16 v[16:19], a[144:147], v[60:63], v[16:19]
    v_mfma_f32_16x16x32_bf16 v[20:23], a[148:151], v[60:63], v[20:23]
    v_mfma_f32_16x16x32_bf16 v[12:15], a[148:151], v[56:59], v[12:15]
    ds_read_b128 v[76:79], v1 offset:29696
    v_mfma_f32_16x16x32_bf16 v[24:27], a[152:155], v[56:59], v[24:27]
    v_mfma_f32_16x16x32_bf16 v[28:31], a[152:155], v[60:63], v[28:31]
    s_waitcnt lgkmcnt(2)
    v_mfma_f32_16x16x32_bf16 v[8:11], a[156:159], v[64:67], v[8:11]
    ds_read_b128 v[80:83], v1 offset:30720
    v_mfma_f32_16x16x32_bf16 v[16:19], a[156:159], v[68:71], v[16:19]
    buffer_load_dword v7, v5, s[16:19], s45 offen sc1
    v_mfma_f32_16x16x32_bf16 v[20:23], a[160:163], v[68:71], v[20:23]
    s_add_u32 m0, s43, 98304
    s_add_u32 s42, s41, 0
    v_mfma_f32_16x16x32_bf16 v[12:15], a[160:163], v[64:67], v[12:15]
    ds_read_b128 v[84:87], v1 offset:31744
    v_mfma_f32_16x16x32_bf16 v[24:27], a[164:167], v[64:67], v[24:27]
    v_mfma_f32_16x16x32_bf16 v[28:31], a[164:167], v[68:71], v[28:31]
    s_waitcnt vmcnt(8) lgkmcnt(2)
    s_barrier
    v_mfma_f32_16x16x32_bf16 v[8:11], a[168:171], v[72:75], v[8:11]
    ds_read_b128 v[56:59], v1 offset:32768
    v_mfma_f32_16x16x32_bf16 v[16:19], a[168:171], v[76:79], v[16:19]
    ds_read_b64 v[36:37], v118 offset:0
    v_mfma_f32_16x16x32_bf16 v[20:23], a[172:175], v[76:79], v[20:23]
    ds_read_b64 v[38:39], v118 offset:128
    v_mfma_f32_16x16x32_bf16 v[12:15], a[172:175], v[72:75], v[12:15]
    ds_read_b128 v[60:63], v1 offset:33792
    v_mfma_f32_16x16x32_bf16 v[24:27], a[176:179], v[72:75], v[24:27]
    ds_read_b64 v[40:41], v118 offset:256
    v_mfma_f32_16x16x32_bf16 v[28:31], a[176:179], v[76:79], v[28:31]
    s_waitcnt lgkmcnt(5)
    ds_read_b64 v[42:43], v118 offset:384
    v_mfma_f32_16x16x32_bf16 v[8:11], a[180:183], v[80:83], v[8:11]
    ds_read_b128 v[64:67], v1 offset:34816
    v_mfma_f32_16x16x32_bf16 v[16:19], a[180:183], v[84:87], v[16:19]
    v_mfma_f32_16x16x32_bf16 v[20:23], a[184:187], v[84:87], v[20:23]
    v_mfma_f32_16x16x32_bf16 v[12:15], a[184:187], v[80:83], v[12:15]
    ds_read_b128 v[68:71], v1 offset:35840
    v_mfma_f32_16x16x32_bf16 v[24:27], a[188:191], v[80:83], v[24:27]
    s_waitcnt lgkmcnt(2)
    v_max3_u32 v44, v36, v37, v38
    v_max3_u32 v45, v39, v40, v41
    v_mfma_f32_16x16x32_bf16 v[28:31], a[188:191], v[84:87], v[28:31]
    s_waitcnt lgkmcnt(4)
    v_max3_u32 v44, v44, v42, v43
    v_max_u32 v44, v44, v45
    v_mfma_f32_16x16x32_bf16 v[8:11], a[192:195], v[56:59], v[8:11]
    ds_read_b128 v[72:75], v1 offset:36864
    v_cmp_eq_u32 vcc, -1, v44
    v_mfma_f32_16x16x32_bf16 v[16:19], a[192:195], v[60:63], v[16:19]
    v_mfma_f32_16x16x32_bf16 v[20:23], a[196:199], v[60:63], v[20:23]
    s_cbranch_vccnz L_sspin14
L_sback15:
    v_add_f32 v44, v40, v42
    v_add_f32 v45, v41, v43
    v_mfma_f32_16x16x32_bf16 v[12:15], a[196:199], v[56:59], v[12:15]
    ds_read_b128 v[76:79], v1 offset:37888
    v_add_f32 v36, v36, v38
    v_mfma_f32_16x16x32_bf16 v[24:27], a[200:203], v[56:59], v[24:27]
    v_add_f32 v37, v37, v39
    v_add_f32 v36, v36, v44
    v_mfma_f32_16x16x32_bf16 v[28:31], a[200:203], v[60:63], v[28:31]
    s_waitcnt lgkmcnt(2)
    v_add_f32 v37, v37, v45
    v_mov_b32 v44, v36
    v_mfma_f32_16x16x32_bf16 v[8:11], a[204:207], v[64:67], v[8:11]
    ds_read_b128 v[80:83], v1 offset:38912
    v_mov_b32 v45, v37
    v_mfma_f32_16x16x32_bf16 v[16:19], a[204:207], v[68:71], v[16:19]
    v_permlane32_swap_b32 v36, v44
    v_mfma_f32_16x16x32_bf16 v[20:23], a[208:211], v[68:71], v[20:23]
    v_permlane32_swap_b32 v37, v45
    v_mfma_f32_16x16x32_bf16 v[12:15], a[208:211], v[64:67], v[12:15]
    ds_read_b128 v[84:87], v1 offset:39936
    v_add_f32 v36, v36, v44
    v_mfma_f32_16x16x32_bf16 v[24:27], a[212:215], v[64:67], v[24:27]
    v_add_f32 v37, v37, v45
    v_mul_f32 v112, 0xba800000, v36
    v_mfma_f32_16x16x32_bf16 v[28:31], a[212:215], v[68:71], v[28:31]
    s_waitcnt lgkmcnt(2)
    v_mul_f32 v37, 0x3a800000, v37
    v_fma_f32 v37, -v112, v112, v37
    v_mfma_f32_16x16x32_bf16 v[8:11], a[216:219], v[72:75], v[8:11]
    ds_read_b128 v[56:59], v1 offset:40960
    v_mov_b32 v113, v112
    v_mfma_f32_16x16x32_bf16 v[16:19], a[216:219], v[76:79], v[16:19]
    v_max_f32 v37, 0, v37
    v_add_f32 v37, 0x3727c5ac, v37
    v_mfma_f32_16x16x32_bf16 v[20:23], a[220:223], v[76:79], v[20:23]
    v_rsq_f32 v116, v37
    v_mfma_f32_16x16x32_bf16 v[12:15], a[220:223], v[72:75], v[12:15]
    ds_read_b128 v[60:63], v1 offset:41984
    v_mfma_f32_16x16x32_bf16 v[24:27], a[224:227], v[72:75], v[24:27]
    v_permlane16_swap_b32 v112, v113
    v_mfma_f32_16x16x32_bf16 v[28:31], a[224:227], v[76:79], v[28:31]
    s_waitcnt lgkmcnt(2)
    v_mul_f32 v114, v37, v116
    v_mul_f32 v116, v116, v116
    v_mfma_f32_16x16x32_bf16 v[8:11], a[228:231], v[80:83], v[8:11]
    ds_read_b128 v[64:67], v1 offset:43008
    v_mov_b32 v115, v114
    v_mfma_f32_16x16x32_bf16 v[16:19], a[228:231], v[84:87], v[16:19]
    v_mov_b32 v117, v116
    v_fmac_f32 v12, v112, v92
    v_mfma_f32_16x16x32_bf16 v[20:23], a[232:235], v[84:87], v[20:23]
    v_permlane16_swap_b32 v114, v115
    v_mfma_f32_16x16x32_bf16 v[12:15], a[232:235], v[80:83], v[12:15]
    ds_read_b128 v[68:71], v1 offset:44032
    v_fmac_f32 v8, v112, v88
    v_mfma_f32_16x16x32_bf16 v[24:27], a[236:239], v[80:83], v[24:27]
    v_permlane16_swap_b32 v116, v117
    v_mfma_f32_16x16x32_bf16 v[28:31], a[236:239], v[84:87], v[28:31]
    s_waitcnt lgkmcnt(2)
    v_fmac_f32 v16, v113, v88
    v_fmac_f32 v17, v113, v89
    v_mfma_f32_16x16x32_bf16 v[8:11], a[240:243], v[56:59], v[8:11]
    s_waitcnt vmcnt(0)
    ds_read_b128 v[72:75], v1 offset:45056
    v_cmp_ne_u32 vcc, 0, v7
    v_mfma_f32_16x16x32_bf16 v[16:19], a[240:243], v[60:63], v[16:19]
    v_fmac_f32 v13, v112, v93
    v_fmac_f32 v14, v112, v94
    v_mfma_f32_16x16x32_bf16 v[20:23], a[244:247], v[60:63], v[20:23]
    s_cbranch_vccnz L_spin12
L_back13:
    v_fmac_f32 v9, v112, v89
    v_fmac_f32 v10, v112, v90
    v_mfma_f32_16x16x32_bf16 v[12:15], a[244:247], v[56:59], v[12:15]
    s_barrier
    ds_read_b128 v[76:79], v1 offset:46080
    v_fmac_f32 v11, v112, v91
    v_mfma_f32_16x16x32_bf16 v[24:27], a[248:251], v[56:59], v[24:27]
    buffer_load_dwordx4 v1, s[16:19], s42 offen offset:0 sc1 lds
    v_mfma_f32_16x16x32_bf16 v[28:31], a[248:251], v[60:63], v[28:31]
    s_waitcnt lgkmcnt(2)
    v_fmac_f32 v18, v113, v90
    v_fmac_f32 v19, v113, v91
    v_mfma_f32_16x16x32_bf16 v[8:11], a[252:255], v[64:67], v[8:11]
    s_add_u32 s46, s46, 2048
    ds_read_b128 v[80:83], v1 offset:47104
    v_fmac_f32 v15, v112, v95
    v_mfma_f32_16x16x32_bf16 v[16:19], a[252:255], v[68:71], v[16:19]
    buffer_load_dwordx4 v1, s[16:19], s42 offen offset:1024 sc1 lds
    v_mfma_f32_16x16x32_bf16 v[20:23], v[128:131], v[68:71], v[20:23]
    s_min_u32 s46, s46, s55
    v_fmac_f32 v8, v114, v100
    v_fmac_f32 v9, v114, v101
    v_mfma_f32_16x16x32_bf16 v[12:15], v[128:131], v[64:67], v[12:15]
    ds_read_b128 v[84:87], v1 offset:48128
    v_fmac_f32 v10, v114, v102
    v_mfma_f32_16x16x32_bf16 v[24:27], v[132:135], v[64:67], v[24:27]
    buffer_load_dwordx4 v1, s[16:19], s42 offen offset:2048 sc1 lds
    v_mfma_f32_16x16x32_bf16 v[28:31], v[132:135], v[68:71], v[28:31]
    s_waitcnt lgkmcnt(2)
    v_fmac_f32 v16, v115, v100
    v_fmac_f32 v17, v115, v101
    v_mfma_f32_16x16x32_bf16 v[8:11], v[136:139], v[72:75], v[8:11]
    ds_read_b128 v[56:59], v1 offset:49152
    v_fmac_f32 v12, v114, v104
    v_mfma_f32_16x16x32_bf16 v[16:19], v[136:139], v[76:79], v[16:19]
    buffer_load_dwordx4 v1, s[16:19], s42 offen offset:3072 sc1 lds
    v_mfma_f32_16x16x32_bf16 v[20:23], v[140:143], v[76:79], v[20:23]
    v_fmac_f32 v24, v112, v96
    v_fmac_f32 v11, v114, v103
    v_mfma_f32_16x16x32_bf16 v[12:15], v[140:143], v[72:75], v[12:15]
    ds_read_b128 v[60:63], v1 offset:50176
    v_fmac_f32 v18, v115, v102
    v_mfma_f32_16x16x32_bf16 v[24:27], v[144:147], v[72:75], v[24:27]
    buffer_store_dword v124, v124, s[16:19], s91 offen sc1
    v_mfma_f32_16x16x32_bf16 v[28:31], v[144:147], v[76:79], v[28:31]
    s_waitcnt lgkmcnt(2)
    v_fmac_f32 v19, v115, v103
    v_fmac_f32 v13, v114, v105
    v_mfma_f32_16x16x32_bf16 v[8:11], v[148:151], v[80:83], v[8:11]
    s_add_u32 s91, s91, 131072
    ds_read_b128 v[64:67], v1 offset:51200
    v_fmac_f32 v14, v114, v106
    v_mfma_f32_16x16x32_bf16 v[16:19], v[148:151], v[84:87], v[16:19]
    s_add_u32 m0, s43, 114688
    v_fmac_f32 v15, v114, v107
    v_fmac_f32 v25, v112, v97
    v_mfma_f32_16x16x32_bf16 v[20:23], v[152:155], v[84:87], v[20:23]
    s_add_u32 s42, s41, 16384
    v_fmac_f32 v26, v112, v98
    v_fmac_f32 v27, v112, v99
    v_mfma_f32_16x16x32_bf16 v[12:15], v[152:155], v[80:83], v[12:15]
    ds_read_b128 v[68:71], v1 offset:52224
    v_fmac_f32 v28, v113, v96
    v_mfma_f32_16x16x32_bf16 v[24:27], v[156:159], v[80:83], v[24:27]
    buffer_load_dwordx4 v1, s[16:19], s42 offen offset:0 sc1 lds
    v_mfma_f32_16x16x32_bf16 v[28:31], v[156:159], v[84:87], v[28:31]
    s_waitcnt lgkmcnt(2)
    v_fmac_f32 v20, v113, v92
    v_fmac_f32 v21, v113, v93
    v_mfma_f32_16x16x32_bf16 v[8:11], v[160:163], v[56:59], v[8:11]
    ds_read_b128 v[72:75], v1 offset:53248
    v_fmac_f32 v22, v113, v94
    v_mfma_f32_16x16x32_bf16 v[16:19], v[160:163], v[60:63], v[16:19]
    v_fmac_f32 v24, v114, v108
    v_fmac_f32 v25, v114, v109
    v_mfma_f32_16x16x32_bf16 v[20:23], v[164:167], v[60:63], v[20:23]
    buffer_load_dwordx4 v1, s[16:19], s42 offen offset:1024 sc1 lds
    v_mfma_f32_16x16x32_bf16 v[12:15], v[164:167], v[56:59], v[12:15]
    ds_read_b128 v[76:79], v1 offset:54272
    v_fmac_f32 v29, v113, v97
    v_mfma_f32_16x16x32_bf16 v[24:27], v[168:171], v[56:59], v[24:27]
    s_nop 0
    v_fmac_f32 v23, v113, v95
    v_fmac_f32 v20, v115, v104
    v_mfma_f32_16x16x32_bf16 v[28:31], v[168:171], v[60:63], v[28:31]
    s_waitcnt lgkmcnt(2)
    v_fmac_f32 v21, v115, v105
    v_fmac_f32 v22, v115, v106
    v_mfma_f32_16x16x32_bf16 v[8:11], v[172:175], v[64:67], v[8:11]
    ds_read_b128 v[80:83], v1 offset:55296
    v_fmac_f32 v23, v115, v107
    v_mfma_f32_16x16x32_bf16 v[16:19], v[172:175], v[68:71], v[16:19]
    buffer_load_dwordx4 v1, s[16:19], s42 offen offset:2048 sc1 lds
    v_mfma_f32_16x16x32_bf16 v[20:23], v[176:179], v[68:71], v[20:23]
    v_fmac_f32 v26, v114, v110
    v_fmac_f32 v27, v114, v111
    v_mfma_f32_16x16x32_bf16 v[12:15], v[176:179], v[64:67], v[12:15]
    ds_read_b128 v[84:87], v1 offset:56320
    v_fmac_f32 v30, v113, v98
    v_mfma_f32_16x16x32_bf16 v[24:27], v[180:183], v[64:67], v[24:27]
    v_mfma_f32_16x16x32_bf16 v[28:31], v[180:183], v[68:71], v[28:31]
    s_waitcnt lgkmcnt(2)
    v_mfma_f32_16x16x32_bf16 v[8:11], v[184:187], v[72:75], v[8:11]
    ds_read_b128 v[56:59], v1 offset:57344
    v_mfma_f32_16x16x32_bf16 v[16:19], v[184:187], v[76:79], v[16:19]
    buffer_load_dwordx4 v1, s[16:19], s42 offen offset:3072 sc1 lds
    v_mfma_f32_16x16x32_bf16 v[20:23], v[188:191], v[76:79], v[20:23]
    s_add_u32 m0, s43, 131072
    v_fmac_f32 v31, v113, v99
    v_fmac_f32 v28, v115, v108
    v_mfma_f32_16x16x32_bf16 v[12:15], v[188:191], v[72:75], v[12:15]
    s_add_u32 s42, s41, 32768
    ds_read_b128 v[60:63], v1 offset:58368
    v_fmac_f32 v29, v115, v109
    v_mfma_f32_16x16x32_bf16 v[24:27], v[192:195], v[72:75], v[24:27]
    v_mfma_f32_16x16x32_bf16 v[28:31], v[192:195], v[76:79], v[28:31]
    s_waitcnt lgkmcnt(2)
    v_mfma_f32_16x16x32_bf16 v[8:11], v[196:199], v[80:83], v[8:11]
    ds_read_b128 v[64:67], v1 offset:59392
    v_mfma_f32_16x16x32_bf16 v[16:19], v[196:199], v[84:87], v[16:19]
    buffer_load_dwordx4 v1, s[16:19], s42 offen offset:0 sc1 lds
    v_mfma_f32_16x16x32_bf16 v[20:23], v[200:203], v[84:87], v[20:23]
    v_fmac_f32 v30, v115, v110
    v_fmac_f32 v31, v115, v111
    v_mfma_f32_16x16x32_bf16 v[12:15], v[200:203], v[80:83], v[12:15]
    ds_read_b128 v[68:71], v1 offset:60416
    v_mfma_f32_16x16x32_bf16 v[24:27], v[204:207], v[80:83], v[24:27]
    v_mfma_f32_16x16x32_bf16 v[28:31], v[204:207], v[84:87], v[28:31]
    s_waitcnt lgkmcnt(2)
    v_mfma_f32_16x16x32_bf16 v[8:11], v[208:211], v[56:59], v[8:11]
    ds_read_b128 v[72:75], v1 offset:61440
    v_mfma_f32_16x16x32_bf16 v[16:19], v[208:211], v[60:63], v[16:19]
    buffer_load_dwordx4 v1, s[16:19], s42 offen offset:1024 sc1 lds
    v_mfma_f32_16x16x32_bf16 v[20:23], v[212:215], v[60:63], v[20:23]
    v_mfma_f32_16x16x32_bf16 v[12:15], v[212:215], v[56:59], v[12:15]
    ds_read_b128 v[76:79], v1 offset:62464
    v_mfma_f32_16x16x32_bf16 v[24:27], v[216:219], v[56:59], v[24:27]
    v_mfma_f32_16x16x32_bf16 v[28:31], v[216:219], v[60:63], v[28:31]
    s_waitcnt lgkmcnt(2)
    v_mfma_f32_16x16x32_bf16 v[8:11], v[220:223], v[64:67], v[8:11]
    ds_read_b128 v[80:83], v1 offset:63488
    v_mfma_f32_16x16x32_bf16 v[16:19], v[220:223], v[68:71], v[16:19]
    buffer_load_dwordx4 v1, s[16:19], s42 offen offset:2048 sc1 lds
    v_mfma_f32_16x16x32_bf16 v[20:23], v[224:227], v[68:71], v[20:23]
    v_mfma_f32_16x16x32_bf16 v[12:15], v[224:227], v[64:67], v[12:15]
    ds_read_b128 v[84:87], v1 offset:64512
    v_mfma_f32_16x16x32_bf16 v[24:27], v[228:231], v[64:67], v[24:27]
    v_mfma_f32_16x16x32_bf16 v[28:31], v[228:231], v[68:71], v[28:31]
    s_waitcnt vmcnt(8) lgkmcnt(2)
    s_barrier
    v_mfma_f32_16x16x32_bf16 v[8:11], v[232:235], v[72:75], v[8:11]
    ds_read_b128 v[56:59], v2 offset:0
    v_mfma_f32_16x16x32_bf16 v[16:19], v[232:235], v[76:79], v[16:19]
    buffer_load_dwordx4 v1, s[16:19], s42 offen offset:3072 sc1 lds
    v_mfma_f32_16x16x32_bf16 v[20:23], v[236:239], v[76:79], v[20:23]
    s_add_u32 s45, s45, 131072
    v_mfma_f32_16x16x32_bf16 v[12:15], v[236:239], v[72:75], v[12:15]
    ds_read_b128 v[60:63], v2 offset:1024
    v_mfma_f32_16x16x32_bf16 v[24:27], v[240:243], v[72:75], v[24:27]
    v_mfma_f32_16x16x32_bf16 v[28:31], v[240:243], v[76:79], v[28:31]
    s_waitcnt lgkmcnt(2)
    v_mfma_f32_16x16x32_bf16 v[8:11], v[244:247], v[80:83], v[8:11]
    ds_read_b128 v[64:67], v2 offset:2048
    v_mfma_f32_16x16x32_bf16 v[16:19], v[244:247], v[84:87], v[16:19]
    v_mfma_f32_16x16x32_bf16 v[20:23], v[248:251], v[84:87], v[20:23]
    v_mfma_f32_16x16x32_bf16 v[12:15], v[248:251], v[80:83], v[12:15]
    ds_read_b128 v[68:71], v2 offset:3072
    v_mfma_f32_16x16x32_bf16 v[24:27], v[252:255], v[80:83], v[24:27]
    v_mfma_f32_16x16x32_bf16 v[28:31], v[252:255], v[84:87], v[28:31]
    s_add_u32 s36, s36, 1
L_a_b1:
    s_waitcnt lgkmcnt(2)
    v_mfma_f32_16x16x32_bf16 v[32:35], a[0:3], v[56:59], 0
    s_and_b32 s44, s90, 0xffffffff
    ds_read_b128 v[72:75], v2 offset:4096
    v_mul_f32 v120, v24, v116
    v_mfma_f32_16x16x32_bf16 v[40:43], a[0:3], v[60:63], 0
    s_cmp_eq_u32 s36, 0
    v_mul_f32 v121, v25, v116
    v_mul_f32 v120, v120, abs(v24)
    v_mfma_f32_16x16x32_bf16 v[44:47], a[4:7], v[60:63], 0
    s_cselect_b32 s44, 0x5e00000, s44
    v_mul_f32 v121, v121, abs(v25)
    v_cvt_pk_bf16_f32 v24, v120, v121
    v_mfma_f32_16x16x32_bf16 v[36:39], a[4:7], v[56:59], 0
    s_add_u32 s49, s44, s87
    ds_read_b128 v[76:79], v2 offset:5120
    v_pk_max_i16 v24, v24, 0
    v_mfma_f32_16x16x32_bf16 v[48:51], a[8:11], v[56:59], 0
    s_max_u32 s44, s44, s88
    v_mul_f32 v120, v26, v116
    v_mul_f32 v121, v27, v116
    v_mfma_f32_16x16x32_bf16 v[52:55], a[8:11], v[60:63], 0
    s_waitcnt lgkmcnt(2)
    v_mul_f32 v120, v120, abs(v26)
    v_mul_f32 v121, v121, abs(v27)
    v_mfma_f32_16x16x32_bf16 v[32:35], a[12:15], v[64:67], v[32:35]
    s_add_u32 s90, s90, 262144
    ds_read_b128 v[80:83], v2 offset:6144
    v_cvt_pk_bf16_f32 v25, v120, v121
    v_mfma_f32_16x16x32_bf16 v[40:43], a[12:15], v[68:71], v[40:43]
    s_add_u32 m0, s52, 73728
    v_pk_max_i16 v25, v25, 0
    s_add_u32 s42, s46, s52
    v_mfma_f32_16x16x32_bf16 v[44:47], a[16:19], v[68:71], v[44:47]
    buffer_load_dwordx4 v1, s[16:19], s42 offen sc1 lds
    v_mfma_f32_16x16x32_bf16 v[36:39], a[16:19], v[64:67], v[36:39]
    ds_read_b128 v[84:87], v2 offset:7168
    v_mfma_f32_16x16x32_bf16 v[48:51], a[20:23], v[64:67], v[48:51]
    ds_write_b64 v3, v[24:25] offset:0
    v_mfma_f32_16x16x32_bf16 v[52:55], a[20:23], v[68:71], v[52:55]
    s_waitcnt lgkmcnt(3)
    v_mul_f32 v120, v28, v117
    v_mul_f32 v121, v29, v117
    v_mfma_f32_16x16x32_bf16 v[32:35], a[24:27], v[72:75], v[32:35]
    ds_read_b128 v[56:59], v2 offset:8192
    v_mul_f32 v120, v120, abs(v28)
    v_mfma_f32_16x16x32_bf16 v[40:43], a[24:27], v[76:79], v[40:43]
    v_mul_f32 v121, v121, abs(v29)
    v_cvt_pk_bf16_f32 v28, v120, v121
    v_mfma_f32_16x16x32_bf16 v[44:47], a[28:31], v[76:79], v[44:47]
    v_pk_max_i16 v28, v28, 0
    v_mul_f32 v120, v30, v117
    v_mfma_f32_16x16x32_bf16 v[36:39], a[28:31], v[72:75], v[36:39]
    ds_read_b128 v[60:63], v2 offset:9216
    v_mul_f32 v121, v31, v117
    v_mfma_f32_16x16x32_bf16 v[48:51], a[32:35], v[72:75], v[48:51]
    v_mul_f32 v120, v120, abs(v30)
    v_mul_f32 v121, v121, abs(v31)
    v_mfma_f32_16x16x32_bf16 v[52:55], a[32:35], v[76:79], v[52:55]
    s_waitcnt lgkmcnt(3)
    v_cvt_pk_bf16_f32 v29, v120, v121
    v_pk_max_i16 v29, v29, 0
    v_mfma_f32_16x16x32_bf16 v[32:35], a[36:39], v[80:83], v[32:35]
    ds_read_b128 v[64:67], v2 offset:10240
    v_mfma_f32_16x16x32_bf16 v[40:43], a[36:39], v[84:87], v[40:43]
    ds_write_b64 v3, v[28:29] offset:1024
    v_mfma_f32_16x16x32_bf16 v[44:47], a[40:43], v[84:87], v[44:47]
    v_mul_f32 v120, v8, v116
    v_mul_f32 v121, v9, v116
    v_mfma_f32_16x16x32_bf16 v[36:39], a[40:43], v[80:83], v[36:39]
    ds_read_b128 v[68:71], v2 offset:11264
    v_mul_f32 v120, v120, abs(v8)
    v_mfma_f32_16x16x32_bf16 v[48:51], a[44:47], v[80:83], v[48:51]
    v_mul_f32 v121, v121, abs(v9)
    v_cvt_pk_bf16_f32 v8, v120, v121
    v_mfma_f32_16x16x32_bf16 v[52:55], a[44:47], v[84:87], v[52:55]
    s_waitcnt lgkmcnt(3)
    v_pk_max_i16 v8, v8, 0
    v_mul_f32 v120, v10, v116
    v_mfma_f32_16x16x32_bf16 v[32:35], a[48:51], v[56:59], v[32:35]
    ds_read_b128 v[72:75], v2 offset:12288
    v_mul_f32 v121, v11, v116
    v_mfma_f32_16x16x32_bf16 v[40:43], a[48:51], v[60:63], v[40:43]
    v_mul_f32 v120, v120, abs(v10)
    v_mul_f32 v121, v121, abs(v11)
    v_mfma_f32_16x16x32_bf16 v[44:47], a[52:55], v[60:63], v[44:47]
    v_cvt_pk_bf16_f32 v9, v120, v121
    v_pk_max_i16 v9, v9, 0
    v_mfma_f32_16x16x32_bf16 v[36:39], a[52:55], v[56:59], v[36:39]
    ds_read_b128 v[76:79], v2 offset:13312
    v_mul_f32 v120, v12, v116
    v_mfma_f32_16x16x32_bf16 v[48:51], a[56:59], v[56:59], v[48:51]
    v_mul_f32 v121, v13, v116
    v_mul_f32 v120, v120, abs(v12)
    v_mfma_f32_16x16x32_bf16 v[52:55], a[56:59], v[60:63], v[52:55]
    s_waitcnt vmcnt(5) lgkmcnt(2)
    s_barrier
    v_mul_f32 v121, v121, abs(v13)
    v_mfma_f32_16x16x32_bf16 v[32:35], a[60:63], v[64:67], v[32:35]
    ds_read_b128 v[80:83], v2 offset:14336
    v_cvt_pk_bf16_f32 v10, v120, v121
    v_mfma_f32_16x16x32_bf16 v[40:43], a[60:63], v[68:71], v[40:43]
    ds_read_b128 v[24:27], v4 offset:0
    v_pk_max_i16 v10, v10, 0
    v_mfma_f32_16x16x32_bf16 v[44:47], a[64:67], v[68:71], v[44:47]
    v_mul_f32 v120, v14, v116
    v_mul_f32 v121, v15, v116
    v_mfma_f32_16x16x32_bf16 v[36:39], a[64:67], v[64:67], v[36:39]
    ds_read_b128 v[84:87], v2 offset:15360
    v_mul_f32 v120, v120, abs(v14)
    v_mfma_f32_16x16x32_bf16 v[48:51], a[68:71], v[64:67], v[48:51]
    v_mul_f32 v121, v121, abs(v15)
    v_cvt_pk_bf16_f32 v11, v120, v121
    v_mfma_f32_16x16x32_bf16 v[52:55], a[68:71], v[68:71], v[52:55]
    s_waitcnt lgkmcnt(3)
    v_pk_max_i16 v11, v11, 0
    s_waitcnt lgkmcnt(1)
    v_mfma_f32_16x16x32_bf16 v[32:35], a[72:75], v[72:75], v[32:35]
    ds_read_b128 v[56:59], v2 offset:16384
    v_mfma_f32_16x16x32_bf16 v[40:43], a[72:75], v[76:79], v[40:43]
    buffer_store_dwordx4 v[24:27], v1, s[16:19], s49 offen sc1
    v_mfma_f32_16x16x32_bf16 v[44:47], a[76:79], v[76:79], v[44:47]
    buffer_store_dwordx4 v[8:11], v1, s[16:19], s44 offen offset:0 sc1
    v_mfma_f32_16x16x32_bf16 v[36:39], a[76:79], v[72:75], v[36:39]
    ds_read_b128 v[60:63], v2 offset:17408
    v_mul_f32 v120, v16, v117
    v_mfma_f32_16x16x32_bf16 v[48:51], a[80:83], v[72:75], v[48:51]
    v_mul_f32 v121, v17, v117
    v_mul_f32 v120, v120, abs(v16)
    v_mfma_f32_16x16x32_bf16 v[52:55], a[80:83], v[76:79], v[52:55]
    s_waitcnt lgkmcnt(2)
    v_mul_f32 v121, v121, abs(v17)
    v_cvt_pk_bf16_f32 v16, v120, v121
    v_mfma_f32_16x16x32_bf16 v[32:35], a[84:87], v[80:83], v[32:35]
    ds_read_b128 v[64:67], v2 offset:18432
    v_pk_max_i16 v16, v16, 0
    v_mfma_f32_16x16x32_bf16 v[40:43], a[84:87], v[84:87], v[40:43]
    v_mul_f32 v120, v18, v117
    v_mul_f32 v121, v19, v117
    v_mfma_f32_16x16x32_bf16 v[44:47], a[88:91], v[84:87], v[44:47]
    v_mul_f32 v120, v120, abs(v18)
    v_mul_f32 v121, v121, abs(v19)
    v_mfma_f32_16x16x32_bf16 v[36:39], a[88:91], v[80:83], v[36:39]
    ds_read_b128 v[68:71], v2 offset:19456
    v_cvt_pk_bf16_f32 v17, v120, v121
    v_mfma_f32_16x16x32_bf16 v[48:51], a[92:95], v[80:83], v[48:51]
    v_pk_max_i16 v17, v17, 0
    v_mul_f32 v120, v20, v117
    v_mfma_f32_16x16x32_bf16 v[52:55], a[92:95], v[84:87], v[52:55]
    s_waitcnt lgkmcnt(2)
    v_mul_f32 v121, v21, v117
    v_mul_f32 v120, v120, abs(v20)
    v_mfma_f32_16x16x32_bf16 v[32:35], a[96:99], v[56:59], v[32:35]
    ds_read_b128 v[72:75], v2 offset:20480
    v_mul_f32 v121, v121, abs(v21)
    v_mfma_f32_16x16x32_bf16 v[40:43], a[96:99], v[60:63], v[40:43]
    v_cvt_pk_bf16_f32 v18, v120, v121
    v_pk_max_i16 v18, v18, 0
    v_mfma_f32_16x16x32_bf16 v[44:47], a[100:103], v[60:63], v[44:47]
    v_mul_f32 v120, v22, v117
    v_mul_f32 v121, v23, v117
    v_mfma_f32_16x16x32_bf16 v[36:39], a[100:103], v[56:59], v[36:39]
    ds_read_b128 v[76:79], v2 offset:21504
    v_mul_f32 v120, v120, abs(v22)
    v_mfma_f32_16x16x32_bf16 v[48:51], a[104:107], v[56:59], v[48:51]
    v_mul_f32 v121, v121, abs(v23)
    v_cvt_pk_bf16_f32 v19, v120, v121
    v_mfma_f32_16x16x32_bf16 v[52:55], a[104:107], v[60:63], v[52:55]
    s_waitcnt lgkmcnt(2)
    v_pk_max_i16 v19, v19, 0
    v_mfma_f32_16x16x32_bf16 v[32:35], a[108:111], v[64:67], v[32:35]
    ds_read_b128 v[80:83], v2 offset:22528
    v_mfma_f32_16x16x32_bf16 v[40:43], a[108:111], v[68:71], v[40:43]
    buffer_store_dwordx4 v[16:19], v1, s[16:19], s44 offen offset:1024 sc1
    v_mfma_f32_16x16x32_bf16 v[44:47], a[112:115], v[68:71], v[44:47]
    s_add_u32 m0, s43, 147456
    s_add_u32 s42, s41, 49152
    v_mfma_f32_16x16x32_bf16 v[36:39], a[112:115], v[64:67], v[36:39]
    ds_read_b128 v[84:87], v2 offset:23552
    v_mfma_f32_16x16x32_bf16 v[48:51], a[116:119], v[64:67], v[48:51]
    buffer_load_dwordx4 v1, s[16:19], s42 offen offset:0 sc1 lds
    v_mfma_f32_16x16x32_bf16 v[52:55], a[116:119], v[68:71], v[52:55]
    s_waitcnt lgkmcnt(2)
    v_mfma_f32_16x16x32_bf16 v[32:35], a[120:123], v[72:75], v[32:35]
    ds_read_b128 v[56:59], v2 offset:24576
    v_mfma_f32_16x16x32_bf16 v[40:43], a[120:123], v[76:79], v[40:43]
    buffer_load_dwordx4 v1, s[16:19], s42 offen offset:1024 sc1 lds
    v_mfma_f32_16x16x32_bf16 v[44:47], a[124:127], v[76:79], v[44:47]
    v_mfma_f32_16x16x32_bf16 v[36:39], a[124:127], v[72:75], v[36:39]
    ds_read_b128 v[60:63], v2 offset:25600
    v_mfma_f32_16x16x32_bf16 v[48:51], a[128:131], v[72:75], v[48:51]
    buffer_load_dwordx4 v1, s[16:19], s42 offen offset:2048 sc1 lds
    v_mfma_f32_16x16x32_bf16 v[52:55], a[128:131], v[76:79], v[52:55]
    s_waitcnt lgkmcnt(2)
    v_mfma_f32_16x16x32_bf16 v[32:35], a[132:135], v[80:83], v[32:35]
    ds_read_b128 v[64:67], v2 offset:26624
    v_mfma_f32_16x16x32_bf16 v[40:43], a[132:135], v[84:87], v[40:43]
    buffer_load_dwordx4 v1, s[16:19], s42 offen offset:3072 sc1 lds
    v_mfma_f32_16x16x32_bf16 v[44:47], a[136:139], v[84:87], v[44:47]
    s_add_u32 s98, s98, 65536
    s_min_u32 s98, s98, s96
    s_and_b32 s41, s98, 0xffffffff
    v_mfma_f32_16x16x32_bf16 v[36:39], a[136:139], v[80:83], v[36:39]
    ds_read_b128 v[68:71], v2 offset:27648
    v_mfma_f32_16x16x32_bf16 v[48:51], a[140:143], v[80:83], v[48:51]
    v_mfma_f32_16x16x32_bf16 v[52:55], a[140:143], v[84:87], v[52:55]
    s_waitcnt lgkmcnt(2)
    v_mfma_f32_16x16x32_bf16 v[32:35], a[144:147], v[56:59], v[32:35]
    ds_read_b128 v[72:75], v2 offset:28672
    v_mfma_f32_16x16x32_bf16 v[40:43], a[144:147], v[60:63], v[40:43]
    v_mfma_f32_16x16x32_bf16 v[44:47], a[148:151], v[60:63], v[44:47]
    v_mfma_f32_16x16x32_bf16 v[36:39], a[148:151], v[56:59], v[36:39]
    ds_read_b128 v[76:79], v2 offset:29696
    v_mfma_f32_16x16x32_bf16 v[48:51], a[152:155], v[56:59], v[48:51]
    v_mfma_f32_16x16x32_bf16 v[52:55], a[152:155], v[60:63], v[52:55]
    s_waitcnt lgkmcnt(2)
    v_mfma_f32_16x16x32_bf16 v[32:35], a[156:159], v[64:67], v[32:35]
    ds_read_b128 v[80:83], v2 offset:30720
    v_mfma_f32_16x16x32_bf16 v[40:43], a[156:159], v[68:71], v[40:43]
    buffer_load_dword v7, v5, s[16:19], s45 offen sc1
    v_mfma_f32_16x16x32_bf16 v[44:47], a[160:163], v[68:71], v[44:47]
    s_add_u32 m0, s43, 0
    s_add_u32 s42, s41, 0
    v_mfma_f32_16x16x32_bf16 v[36:39], a[160:163], v[64:67], v[36:39]
    ds_read_b128 v[84:87], v2 offset:31744
    v_mfma_f32_16x16x32_bf16 v[48:51], a[164:167], v[64:67], v[48:51]
    v_mfma_f32_16x16x32_bf16 v[52:55], a[164:167], v[68:71], v[52:55]
    s_waitcnt vmcnt(8) lgkmcnt(2)
    s_barrier
    v_mfma_f32_16x16x32_bf16 v[32:35], a[168:171], v[72:75], v[32:35]
    ds_read_b128 v[56:59], v2 offset:32768
    v_mfma_f32_16x16x32_bf16 v[40:43], a[168:171], v[76:79], v[40:43]
    ds_read_b64 v[12:13], v118 offset:0
    v_mfma_f32_16x16x32_bf16 v[44:47], a[172:175], v[76:79], v[44:47]
    ds_read_b64 v[14:15], v118 offset:128
    v_mfma_f32_16x16x32_bf16 v[36:39], a[172:175], v[72:75], v[36:39]
    ds_read_b128 v[60:63], v2 offset:33792
    v_mfma_f32_16x16x32_bf16 v[48:51], a[176:179], v[72:75], v[48:51]
    ds_read_b64 v[16:17], v118 offset:256
    v_mfma_f32_16x16x32_bf16 v[52:55], a[176:179], v[76:79], v[52:55]
    s_waitcnt lgkmcnt(5)
    ds_read_b64 v[18:19], v118 offset:384
    v_mfma_f32_16x16x32_bf16 v[32:35], a[180:183], v[80:83], v[32:35]
    ds_read_b128 v[64:67], v2 offset:34816
    v_mfma_f32_16x16x32_bf16 v[40:43], a[180:183], v[84:87], v[40:43]
    v_mfma_f32_16x16x32_bf16 v[44:47], a[184:187], v[84:87], v[44:47]
    v_mfma_f32_16x16x32_bf16 v[36:39], a[184:187], v[80:83], v[36:39]
    ds_read_b128 v[68:71], v2 offset:35840
    v_mfma_f32_16x16x32_bf16 v[48:51], a[188:191], v[80:83], v[48:51]
    s_waitcnt lgkmcnt(2)
    v_max3_u32 v20, v12, v13, v14
    v_max3_u32 v21, v15, v16, v17
    v_mfma_f32_16x16x32_bf16 v[52:55], a[188:191], v[84:87], v[52:55]
    s_waitcnt lgkmcnt(4)
    v_max3_u32 v20, v20, v18, v19
    v_max_u32 v20, v20, v21
    v_mfma_f32_16x16x32_bf16 v[32:35], a[192:195], v[56:59], v[32:35]
    ds_read_b128 v[72:75], v2 offset:36864
    v_cmp_eq_u32 vcc, -1, v20
    v_mfma_f32_16x16x32_bf16 v[40:43], a[192:195], v[60:63], v[40:43]
    v_mfma_f32_16x16x32_bf16 v[44:47], a[196:199], v[60:63], v[44:47]
    s_cbranch_vccnz L_sspin18
L_sback19:
    v_add_f32 v20, v16, v18
    v_add_f32 v21, v17, v19
    v_mfma_f32_16x16x32_bf16 v[36:39], a[196:199], v[56:59], v[36:39]
    ds_read_b128 v[76:79], v2 offset:37888
    v_add_f32 v12, v12, v14
    v_mfma_f32_16x16x32_bf16 v[48:51], a[200:203], v[56:59], v[48:51]
    v_add_f32 v13, v13, v15
    v_add_f32 v12, v12, v20
    v_mfma_f32_16x16x32_bf16 v[52:55], a[200:203], v[60:63], v[52:55]
    s_waitcnt lgkmcnt(2)
    v_add_f32 v13, v13, v21
    v_mov_b32 v20, v12
    v_mfma_f32_16x16x32_bf16 v[32:35], a[204:207], v[64:67], v[32:35]
    ds_read_b128 v[80:83], v2 offset:38912
    v_mov_b32 v21, v13
    v_mfma_f32_16x16x32_bf16 v[40:43], a[204:207], v[68:71], v[40:43]
    v_permlane32_swap_b32 v12, v20
    v_mfma_f32_16x16x32_bf16 v[44:47], a[208:211], v[68:71], v[44:47]
    v_permlane32_swap_b32 v13, v21
    v_mfma_f32_16x16x32_bf16 v[36:39], a[208:211], v[64:67], v[36:39]
    ds_read_b128 v[84:87], v2 offset:39936
    v_add_f32 v12, v12, v20
    v_mfma_f32_16x16x32_bf16 v[48:51], a[212:215], v[64:67], v[48:51]
    v_add_f32 v13, v13, v21
    v_mul_f32 v112, 0xba800000, v12
    v_mfma_f32_16x16x32_bf16 v[52:55], a[212:215], v[68:71], v[52:55]
    s_waitcnt lgkmcnt(2)
    v_mul_f32 v13, 0x3a800000, v13
    v_fma_f32 v13, -v112, v112, v13
    v_mfma_f32_16x16x32_bf16 v[32:35], a[216:219], v[72:75], v[32:35]
    ds_read_b128 v[56:59], v2 offset:40960
    v_mov_b32 v113, v112
    v_mfma_f32_16x16x32_bf16 v[40:43], a[216:219], v[76:79], v[40:43]
    v_max_f32 v13, 0, v13
    v_add_f32 v13, 0x3727c5ac, v13
    v_mfma_f32_16x16x32_bf16 v[44:47], a[220:223], v[76:79], v[44:47]
    v_rsq_f32 v116, v13
    v_mfma_f32_16x16x32_bf16 v[36:39], a[220:223], v[72:75], v[36:39]
    ds_read_b128 v[60:63], v2 offset:41984
    v_mfma_f32_16x16x32_bf16 v[48:51], a[224:227], v[72:75], v[48:51]
    v_permlane16_swap_b32 v112, v113
    v_mfma_f32_16x16x32_bf16 v[52:55], a[224:227], v[76:79], v[52:55]
    s_waitcnt lgkmcnt(2)
    v_mul_f32 v114, v13, v116
    v_mul_f32 v116, v116, v116
    v_mfma_f32_16x16x32_bf16 v[32:35], a[228:231], v[80:83], v[32:35]
    ds_read_b128 v[64:67], v2 offset:43008
    v_mov_b32 v115, v114
    v_mfma_f32_16x16x32_bf16 v[40:43], a[228:231], v[84:87], v[40:43]
    v_mov_b32 v117, v116
    v_fmac_f32 v36, v112, v92
    v_mfma_f32_16x16x32_bf16 v[44:47], a[232:235], v[84:87], v[44:47]
    v_permlane16_swap_b32 v114, v115
    v_mfma_f32_16x16x32_bf16 v[36:39], a[232:235], v[80:83], v[36:39]
    ds_read_b128 v[68:71], v2 offset:44032
    v_fmac_f32 v32, v112, v88
    v_mfma_f32_16x16x32_bf16 v[48:51], a[236:239], v[80:83], v[48:51]
    v_permlane16_swap_b32 v116, v117
    v_mfma_f32_16x16x32_bf16 v[52:55], a[236:239], v[84:87], v[52:55]
    s_waitcnt lgkmcnt(2)
    v_fmac_f32 v40, v113, v88
    v_fmac_f32 v41, v113, v89
    v_mfma_f32_16x16x32_bf16 v[32:35], a[240:243], v[56:59], v[32:35]
    s_waitcnt vmcnt(0)
    ds_read_b128 v[72:75], v2 offset:45056
    v_cmp_ne_u32 vcc, 0, v7
    v_mfma_f32_16x16x32_bf16 v[40:43], a[240:243], v[60:63], v[40:43]
    v_fmac_f32 v37, v112, v93
    v_fmac_f32 v38, v112, v94
    v_mfma_f32_16x16x32_bf16 v[44:47], a[244:247], v[60:63], v[44:47]
    s_cbranch_vccnz L_spin16
L_back17:
    v_fmac_f32 v33, v112, v89
    v_fmac_f32 v34, v112, v90
    v_mfma_f32_16x16x32_bf16 v[36:39], a[244:247], v[56:59], v[36:39]
    s_barrier
    ds_read_b128 v[76:79], v2 offset:46080
    v_fmac_f32 v35, v112, v91
    v_mfma_f32_16x16x32_bf16 v[48:51], a[248:251], v[56:59], v[48:51]
    buffer_load_dwordx4 v1, s[16:19], s42 offen offset:0 sc1 lds
    v_mfma_f32_16x16x32_bf16 v[52:55], a[248:251], v[60:63], v[52:55]
    s_waitcnt lgkmcnt(2)
    v_fmac_f32 v42, v113, v90
    v_fmac_f32 v43, v113, v91
    v_mfma_f32_16x16x32_bf16 v[32:35], a[252:255], v[64:67], v[32:35]
    s_add_u32 s46, s46, 2048
    ds_read_b128 v[80:83], v2 offset:47104
    v_fmac_f32 v39, v112, v95
    v_mfma_f32_16x16x32_bf16 v[40:43], a[252:255], v[68:71], v[40:43]
    buffer_load_dwordx4 v1, s[16:19], s42 offen offset:1024 sc1 lds
    v_mfma_f32_16x16x32_bf16 v[44:47], v[128:131], v[68:71], v[44:47]
    s_min_u32 s46, s46, s55
    v_fmac_f32 v32, v114, v100
    v_fmac_f32 v33, v114, v101
    v_mfma_f32_16x16x32_bf16 v[36:39], v[128:131], v[64:67], v[36:39]
    ds_read_b128 v[84:87], v2 offset:48128
    v_fmac_f32 v34, v114, v102
    v_mfma_f32_16x16x32_bf16 v[48:51], v[132:135], v[64:67], v[48:51]
    buffer_load_dwordx4 v1, s[16:19], s42 offen offset:2048 sc1 lds
    v_mfma_f32_16x16x32_bf16 v[52:55], v[132:135], v[68:71], v[52:55]
    s_waitcnt lgkmcnt(2)
    v_fmac_f32 v40, v115, v100
    v_fmac_f32 v41, v115, v101
    v_mfma_f32_16x16x32_bf16 v[32:35], v[136:139], v[72:75], v[32:35]
    ds_read_b128 v[56:59], v2 offset:49152
    v_fmac_f32 v36, v114, v104
    v_mfma_f32_16x16x32_bf16 v[40:43], v[136:139], v[76:79], v[40:43]
    buffer_load_dwordx4 v1, s[16:19], s42 offen offset:3072 sc1 lds
    v_mfma_f32_16x16x32_bf16 v[44:47], v[140:143], v[76:79], v[44:47]
    v_fmac_f32 v48, v112, v96
    v_fmac_f32 v35, v114, v103
    v_mfma_f32_16x16x32_bf16 v[36:39], v[140:143], v[72:75], v[36:39]
    ds_read_b128 v[60:63], v2 offset:50176
    v_fmac_f32 v42, v115, v102
    v_mfma_f32_16x16x32_bf16 v[48:51], v[144:147], v[72:75], v[48:51]
    buffer_store_dword v124, v124, s[16:19], s91 offen sc1
    v_mfma_f32_16x16x32_bf16 v[52:55], v[144:147], v[76:79], v[52:55]
    s_waitcnt lgkmcnt(2)
    v_fmac_f32 v43, v115, v103
    v_fmac_f32 v37, v114, v105
    v_mfma_f32_16x16x32_bf16 v[32:35], v[148:151], v[80:83], v[32:35]
    s_add_u32 s91, s91, 131072
    ds_read_b128 v[64:67], v2 offset:51200
    v_fmac_f32 v38, v114, v106
    v_mfma_f32_16x16x32_bf16 v[40:43], v[148:151], v[84:87], v[40:43]
    s_add_u32 m0, s43, 16384
    v_fmac_f32 v39, v114, v107
    v_fmac_f32 v49, v112, v97
    v_mfma_f32_16x16x32_bf16 v[44:47], v[152:155], v[84:87], v[44:47]
    s_add_u32 s42, s41, 16384
    v_fmac_f32 v50, v112, v98
    v_fmac_f32 v51, v112, v99
    v_mfma_f32_16x16x32_bf16 v[36:39], v[152:155], v[80:83], v[36:39]
    ds_read_b128 v[68:71], v2 offset:52224
    v_fmac_f32 v52, v113, v96
    v_mfma_f32_16x16x32_bf16 v[48:51], v[156:159], v[80:83], v[48:51]
    buffer_load_dwordx4 v1, s[16:19], s42 offen offset:0 sc1 lds
    v_mfma_f32_16x16x32_bf16 v[52:55], v[156:159], v[84:87], v[52:55]
    s_waitcnt lgkmcnt(2)
    v_fmac_f32 v44, v113, v92
    v_fmac_f32 v45, v113, v93
    v_mfma_f32_16x16x32_bf16 v[32:35], v[160:163], v[56:59], v[32:35]
    ds_read_b128 v[72:75], v2 offset:53248
    v_fmac_f32 v46, v113, v94
    v_mfma_f32_16x16x32_bf16 v[40:43], v[160:163], v[60:63], v[40:43]
    v_fmac_f32 v48, v114, v108
    v_fmac_f32 v49, v114, v109
    v_mfma_f32_16x16x32_bf16 v[44:47], v[164:167], v[60:63], v[44:47]
    buffer_load_dwordx4 v1, s[16:19], s42 offen offset:1024 sc1 lds
    v_mfma_f32_16x16x32_bf16 v[36:39], v[164:167], v[56:59], v[36:39]
    ds_read_b128 v[76:79], v2 offset:54272
    v_fmac_f32 v53, v113, v97
    v_mfma_f32_16x16x32_bf16 v[48:51], v[168:171], v[56:59], v[48:51]
    s_nop 0
    v_fmac_f32 v47, v113, v95
    v_fmac_f32 v44, v115, v104
    v_mfma_f32_16x16x32_bf16 v[52:55], v[168:171], v[60:63], v[52:55]
    s_waitcnt lgkmcnt(2)
    v_fmac_f32 v45, v115, v105
    v_fmac_f32 v46, v115, v106
    v_mfma_f32_16x16x32_bf16 v[32:35], v[172:175], v[64:67], v[32:35]
    ds_read_b128 v[80:83], v2 offset:55296
    v_fmac_f32 v47, v115, v107
    v_mfma_f32_16x16x32_bf16 v[40:43], v[172:175], v[68:71], v[40:43]
    buffer_load_dwordx4 v1, s[16:19], s42 offen offset:2048 sc1 lds
    v_mfma_f32_16x16x32_bf16 v[44:47], v[176:179], v[68:71], v[44:47]
    v_fmac_f32 v50, v114, v110
    v_fmac_f32 v51, v114, v111
    v_mfma_f32_16x16x32_bf16 v[36:39], v[176:179], v[64:67], v[36:39]
    ds_read_b128 v[84:87], v2 offset:56320
    v_fmac_f32 v54, v113, v98
    v_mfma_f32_16x16x32_bf16 v[48:51], v[180:183], v[64:67], v[48:51]
    v_mfma_f32_16x16x32_bf16 v[52:55], v[180:183], v[68:71], v[52:55]
    s_waitcnt lgkmcnt(2)
    v_mfma_f32_16x16x32_bf16 v[32:35], v[184:187], v[72:75], v[32:35]
    ds_read_b128 v[56:59], v2 offset:57344
    v_mfma_f32_16x16x32_bf16 v[40:43], v[184:187], v[76:79], v[40:43]
    buffer_load_dwordx4 v1, s[16:19], s42 offen offset:3072 sc1 lds
    v_mfma_f32_16x16x32_bf16 v[44:47], v[188:191], v[76:79], v[44:47]
    s_add_u32 m0, s43, 32768
    v_fmac_f32 v55, v113, v99
    v_fmac_f32 v52, v115, v108
    v_mfma_f32_16x16x32_bf16 v[36:39], v[188:191], v[72:75], v[36:39]
    s_add_u32 s42, s41, 32768
    ds_read_b128 v[60:63], v2 offset:58368
    v_fmac_f32 v53, v115, v109
    v_mfma_f32_16x16x32_bf16 v[48:51], v[192:195], v[72:75], v[48:51]
    v_mfma_f32_16x16x32_bf16 v[52:55], v[192:195], v[76:79], v[52:55]
    s_waitcnt lgkmcnt(2)
    v_mfma_f32_16x16x32_bf16 v[32:35], v[196:199], v[80:83], v[32:35]
    ds_read_b128 v[64:67], v2 offset:59392
    v_mfma_f32_16x16x32_bf16 v[40:43], v[196:199], v[84:87], v[40:43]
    buffer_load_dwordx4 v1, s[16:19], s42 offen offset:0 sc1 lds
    v_mfma_f32_16x16x32_bf16 v[44:47], v[200:203], v[84:87], v[44:47]
    v_fmac_f32 v54, v115, v110
    v_fmac_f32 v55, v115, v111
    v_mfma_f32_16x16x32_bf16 v[36:39], v[200:203], v[80:83], v[36:39]
    ds_read_b128 v[68:71], v2 offset:60416
    v_mfma_f32_16x16x32_bf16 v[48:51], v[204:207], v[80:83], v[48:51]
    v_mfma_f32_16x16x32_bf16 v[52:55], v[204:207], v[84:87], v[52:55]
    s_waitcnt lgkmcnt(2)
    v_mfma_f32_16x16x32_bf16 v[32:35], v[208:211], v[56:59], v[32:35]
    ds_read_b128 v[72:75], v2 offset:61440
    v_mfma_f32_16x16x32_bf16 v[40:43], v[208:211], v[60:63], v[40:43]
    buffer_load_dwordx4 v1, s[16:19], s42 offen offset:1024 sc1 lds
    v_mfma_f32_16x16x32_bf16 v[44:47], v[212:215], v[60:63], v[44:47]
    v_mfma_f32_16x16x32_bf16 v[36:39], v[212:215], v[56:59], v[36:39]
    ds_read_b128 v[76:79], v2 offset:62464
    v_mfma_f32_16x16x32_bf16 v[48:51], v[216:219], v[56:59], v[48:51]
    v_mfma_f32_16x16x32_bf16 v[52:55], v[216:219], v[60:63], v[52:55]
    s_waitcnt lgkmcnt(2)
    v_mfma_f32_16x16x32_bf16 v[32:35], v[220:223], v[64:67], v[32:35]
    ds_read_b128 v[80:83], v2 offset:63488
    v_mfma_f32_16x16x32_bf16 v[40:43], v[220:223], v[68:71], v[40:43]
    buffer_load_dwordx4 v1, s[16:19], s42 offen offset:2048 sc1 lds
    v_mfma_f32_16x16x32_bf16 v[44:47], v[224:227], v[68:71], v[44:47]
    v_mfma_f32_16x16x32_bf16 v[36:39], v[224:227], v[64:67], v[36:39]
    ds_read_b128 v[84:87], v2 offset:64512
    v_mfma_f32_16x16x32_bf16 v[48:51], v[228:231], v[64:67], v[48:51]
    v_mfma_f32_16x16x32_bf16 v[52:55], v[228:231], v[68:71], v[52:55]
    s_waitcnt vmcnt(8) lgkmcnt(2)
    s_barrier
    v_mfma_f32_16x16x32_bf16 v[32:35], v[232:235], v[72:75], v[32:35]
    ds_read_b128 v[56:59], v1 offset:0
    v_mfma_f32_16x16x32_bf16 v[40:43], v[232:235], v[76:79], v[40:43]
    buffer_load_dwordx4 v1, s[16:19], s42 offen offset:3072 sc1 lds
    v_mfma_f32_16x16x32_bf16 v[44:47], v[236:239], v[76:79], v[44:47]
    s_add_u32 s45, s45, 131072
    v_mfma_f32_16x16x32_bf16 v[36:39], v[236:239], v[72:75], v[36:39]
    ds_read_b128 v[60:63], v1 offset:1024
    v_mfma_f32_16x16x32_bf16 v[48:51], v[240:243], v[72:75], v[48:51]
    v_mfma_f32_16x16x32_bf16 v[52:55], v[240:243], v[76:79], v[52:55]
    s_waitcnt lgkmcnt(2)
    v_mfma_f32_16x16x32_bf16 v[32:35], v[244:247], v[80:83], v[32:35]
    ds_read_b128 v[64:67], v1 offset:2048
    v_mfma_f32_16x16x32_bf16 v[40:43], v[244:247], v[84:87], v[40:43]
    v_mfma_f32_16x16x32_bf16 v[44:47], v[248:251], v[84:87], v[44:47]
    v_mfma_f32_16x16x32_bf16 v[36:39], v[248:251], v[80:83], v[36:39]
    ds_read_b128 v[68:71], v1 offset:3072
    v_mfma_f32_16x16x32_bf16 v[48:51], v[252:255], v[80:83], v[48:51]
    v_mfma_f32_16x16x32_bf16 v[52:55], v[252:255], v[84:87], v[52:55]
    s_add_u32 s36, s36, 1
    s_cmp_lt_u32 s36, 32
    s_cbranch_scc1 L_a_b0
    s_nop 7
    s_and_b32 s44, s90, 0xffffffff
    s_cmp_eq_u32 s36, 0
    s_cselect_b32 s44, 0x5e00000, s44
    s_add_u32 s49, s44, s87
    s_max_u32 s44, s44, s88
    s_add_u32 s90, s90, 262144
    v_mul_f32 v120, v48, v116
    v_mul_f32 v121, v49, v116
    v_mul_f32 v120, v120, abs(v48)
    v_mul_f32 v121, v121, abs(v49)
    v_cvt_pk_bf16_f32 v48, v120, v121
    v_pk_max_i16 v48, v48, 0
    v_mul_f32 v120, v50, v116
    v_mul_f32 v121, v51, v116
    v_mul_f32 v120, v120, abs(v50)
    v_mul_f32 v121, v121, abs(v51)
    v_cvt_pk_bf16_f32 v49, v120, v121
    v_pk_max_i16 v49, v49, 0
    ds_write_b64 v3, v[48:49] offset:4096
    v_mul_f32 v120, v52, v117
    v_mul_f32 v121, v53, v117
    v_mul_f32 v120, v120, abs(v52)
    v_mul_f32 v121, v121, abs(v53)
    v_cvt_pk_bf16_f32 v52, v120, v121
    v_pk_max_i16 v52, v52, 0
    v_mul_f32 v120, v54, v117
    v_mul_f32 v121, v55, v117
    v_mul_f32 v120, v120, abs(v54)
    v_mul_f32 v121, v121, abs(v55)
    v_cvt_pk_bf16_f32 v53, v120, v121
    v_pk_max_i16 v53, v53, 0
    ds_write_b64 v3, v[52:53] offset:5120
    v_mul_f32 v120, v32, v116
    v_mul_f32 v121, v33, v116
    v_mul_f32 v120, v120, abs(v32)
    v_mul_f32 v121, v121, abs(v33)
    v_cvt_pk_bf16_f32 v32, v120, v121
    v_pk_max_i16 v32, v32, 0
    v_mul_f32 v120, v34, v116
    v_mul_f32 v121, v35, v116
    v_mul_f32 v120, v120, abs(v34)
    v_mul_f32 v121, v121, abs(v35)
    v_cvt_pk_bf16_f32 v33, v120, v121
    v_pk_max_i16 v33, v33, 0
    v_mul_f32 v120, v36, v116
    v_mul_f32 v121, v37, v116
    v_mul_f32 v120, v120, abs(v36)
    v_mul_f32 v121, v121, abs(v37)
    v_cvt_pk_bf16_f32 v34, v120, v121
    v_pk_max_i16 v34, v34, 0
    v_mul_f32 v120, v38, v116
    v_mul_f32 v121, v39, v116
    v_mul_f32 v120, v120, abs(v38)
    v_mul_f32 v121, v121, abs(v39)
    v_cvt_pk_bf16_f32 v35, v120, v121
    v_pk_max_i16 v35, v35, 0
    buffer_store_dwordx4 v[32:35], v1, s[16:19], s44 offen offset:0 sc1
    v_mul_f32 v120, v40, v117
    v_mul_f32 v121, v41, v117
    v_mul_f32 v120, v120, abs(v40)
    s_waitcnt lgkmcnt(0)
    s_barrier
    ds_read_b128 v[48:51], v4 offset:4096
    v_mul_f32 v121, v121, abs(v41)
    v_cvt_pk_bf16_f32 v40, v120, v121
    v_pk_max_i16 v40, v40, 0
    v_mul_f32 v120, v42, v117
    v_mul_f32 v121, v43, v117
    v_mul_f32 v120, v120, abs(v42)
    v_mul_f32 v121, v121, abs(v43)
    v_cvt_pk_bf16_f32 v41, v120, v121
    v_pk_max_i16 v41, v41, 0
    s_waitcnt lgkmcnt(0)
    buffer_store_dwordx4 v[48:51], v1, s[16:19], s49 offen sc1
    v_mul_f32 v120, v44, v117
    v_mul_f32 v121, v45, v117
    v_mul_f32 v120, v120, abs(v44)
    v_mul_f32 v121, v121, abs(v45)
    v_cvt_pk_bf16_f32 v42, v120, v121
    v_pk_max_i16 v42, v42, 0
    v_mul_f32 v120, v46, v117
    v_mul_f32 v121, v47, v117
    v_mul_f32 v120, v120, abs(v46)
    v_mul_f32 v121, v121, abs(v47)
    v_cvt_pk_bf16_f32 v43, v120, v121
    v_pk_max_i16 v43, v43, 0
    buffer_store_dwordx4 v[40:43], v1, s[16:19], s44 offen offset:1024 sc1
    s_waitcnt vmcnt(0)
    s_barrier
    buffer_store_dword v124, v124, s[16:19], s91 offen sc1
    s_add_u32 s91, s91, 131072
    s_waitcnt vmcnt(0)
    s_endpgm
L_spin8:
    s_mov_b32 s40, 0x20000
L_spin8_l:
    buffer_load_dword v56, v124, s[20:23], 0 offen sc1
    s_sub_u32 s40, s40, 1
    s_waitcnt vmcnt(0)
    v_cmp_eq_u32 vcc, v124, v56
    s_cbranch_scc1 L_back9
    s_cbranch_vccz L_back9
    s_sleep 8
    s_branch L_spin8_l
L_spin10:
    s_mov_b32 s40, 0x20000
L_spin10_l:
    buffer_load_dword v7, v5, s[16:19], s45 offen sc1
    s_sub_u32 s40, s40, 1
    s_waitcnt vmcnt(0)
    v_cmp_ne_u32 vcc, 0, v7
    s_cbranch_scc1 L_back11
    s_cbranch_vccz L_back11
    s_sleep 2
    s_branch L_spin10_l
L_spin12:
    s_mov_b32 s40, 0x20000
L_spin12_l:
    buffer_load_dword v7, v5, s[16:19], s45 offen sc1
    s_sub_u32 s40, s40, 1
    s_waitcnt vmcnt(0)
    v_cmp_ne_u32 vcc, 0, v7
    s_cbranch_scc1 L_back13
    s_cbranch_vccz L_back13
    s_sleep 2
    s_branch L_spin12_l
L_sspin14:
    s_mov_b32 s40, 0x20000
L_sspin14_l:
    buffer_load_dwordx2 v[36:37], v6, s[16:19], s46 offen offset:0 sc1
    buffer_load_dwordx2 v[38:39], v6, s[16:19], s46 offen offset:128 sc1
    buffer_load_dwordx2 v[40:41], v6, s[16:19], s46 offen offset:256 sc1
    buffer_load_dwordx2 v[42:43], v6, s[16:19], s46 offen offset:384 sc1
    s_sub_u32 s40, s40, 1
    s_waitcnt vmcnt(0)
    v_max3_u32 v44, v36, v37, v38
    v_max3_u32 v45, v39, v40, v41
    v_max3_u32 v44, v44, v42, v43
    v_max_u32 v44, v44, v45
    v_cmp_eq_u32 vcc, -1, v44
    s_cbranch_scc1 L_sback15
    s_cbranch_vccz L_sback15
    s_sleep 4
    s_branch L_sspin14_l
L_spin16:
    s_mov_b32 s40, 0x20000
L_spin16_l:
    buffer_load_dword v7, v5, s[16:19], s45 offen sc1
    s_sub_u32 s40, s40, 1
    s_waitcnt vmcnt(0)
    v_cmp_ne_u32 vcc, 0, v7
    s_cbranch_scc1 L_back17
    s_cbranch_vccz L_back17
    s_sleep 2
    s_branch L_spin16_l
L_sspin18:
    s_mov_b32 s40, 0x20000
L_sspin18_l:
    buffer_load_dwordx2 v[12:13], v6, s[16:19], s46 offen offset:0 sc1
    buffer_load_dwordx2 v[14:15], v6, s[16:19], s46 offen offset:128 sc1
    buffer_load_dwordx2 v[16:17], v6, s[16:19], s46 offen offset:256 sc1
    buffer_load_dwordx2 v[18:19], v6, s[16:19], s46 offen offset:384 sc1
    s_sub_u32 s40, s40, 1
    s_waitcnt vmcnt(0)
    v_max3_u32 v20, v12, v13, v14
    v_max3_u32 v21, v15, v16, v17
    v_max3_u32 v20, v20, v18, v19
    v_max_u32 v20, v20, v21
    v_cmp_eq_u32 vcc, -1, v20
    s_cbranch_scc1 L_sback19
    s_cbranch_vccz L_sback19
    s_sleep 4
    s_branch L_sspin18_l
L_odd:
    s_mov_b32 s33, s47
    s_lshl2_add_u32 s53, s48, s47
    s_cmp_lt_u32 s48, 8
    s_cselect_b32 s34, 16, 32
    s_add_u32 s34, s34, s48
    s_waitcnt lgkmcnt(0)
    s_mov_b32 s16, s84
    s_mov_b32 s17, s85
    s_mov_b32 s18, 0x5e00000
    s_mov_b32 s19, 0x00020000
    v_min_u32 v124, 1, v0
    v_lshlrev_b32 v124, 30, v124
    s_cmp_lt_u32 s48, 12
    s_cbranch_scc1 L_job_done
    s_cmp_lt_u32 s48, 28
    s_cbranch_scc1 L_reset
    s_lshl_b32 s50, s33, 4
    s_add_u32 s50, s50, s48
    s_sub_u32 s50, s50, 16
    s_lshl_b32 s50, s50, 1
    s_lshl_b32 s46, s50, 15
    s_lshl_b32 s37, s32, 9
    s_add_u32 s46, s46, s37
    v_lshrrev_b32 v48, 3, v0
    v_and_b32 v49, 0x70, v1
    v_lshl_add_u32 v48, v48, 11, v49
    v_add_u32 v49, 16384, v48
    s_mov_b32 s8, s64
    s_mov_b32 s9, s65
    s_mov_b32 s10, 0x400000
    s_mov_b32 s11, 0x00020000
    buffer_load_dwordx4 v[16:19], v48, s[8:11], s46 offen offset:0
    buffer_load_dwordx4 v[20:23], v48, s[8:11], s46 offen offset:128
    buffer_load_dwordx4 v[24:27], v48, s[8:11], s46 offen offset:256
    buffer_load_dwordx4 v[28:31], v48, s[8:11], s46 offen offset:384
    buffer_load_dwordx4 v[32:35], v49, s[8:11], s46 offen offset:0
    buffer_load_dwordx4 v[36:39], v49, s[8:11], s46 offen offset:128
    buffer_load_dwordx4 v[40:43], v49, s[8:11], s46 offen offset:256
    buffer_load_dwordx4 v[44:47], v49, s[8:11], s46 offen offset:384
    s_xor_b32 s50, s50, 1
    s_lshl_b32 s46, s50, 15
    s_lshl_b32 s37, s32, 9
    s_add_u32 s46, s46, s37
    v_lshrrev_b32 v96, 3, v0
    v_and_b32 v97, 0x70, v1
    v_lshl_add_u32 v96, v96, 11, v97
    v_add_u32 v97, 16384, v96
    s_mov_b32 s8, s64
    s_mov_b32 s9, s65
    s_mov_b32 s10, 0x400000
    s_mov_b32 s11, 0x00020000
    buffer_load_dwordx4 v[64:67], v96, s[8:11], s46 offen offset:0
    buffer_load_dwordx4 v[68:71], v96, s[8:11], s46 offen offset:128
    buffer_load_dwordx4 v[72:75], v96, s[8:11], s46 offen offset:256
    buffer_load_dwordx4 v[76:79], v96, s[8:11], s46 offen offset:384
    buffer_load_dwordx4 v[80:83], v97, s[8:11], s46 offen offset:0
    buffer_load_dwordx4 v[84:87], v97, s[8:11], s46 offen offset:128
    buffer_load_dwordx4 v[88:91], v97, s[8:11], s46 offen offset:256
    buffer_load_dwordx4 v[92:95], v97, s[8:11], s46 offen offset:384
    s_xor_b32 s50, s50, 1
    s_mov_b32 s86, 0x3f803f80
    v_and_b32 v56, 1, v0
    v_lshlrev_b32 v56, 7, v56
    v_bfe_u32 v57, v0, 1, 1
    v_lshl_add_u32 v56, v57, 6, v56
    v_and_b32 v57, 0x38, v0
    v_add_u32 v56, v57, v56
    s_sub_u32 s46, 127, s50
    s_lshl_b32 s46, s46, 10
    s_lshl_b32 s37, s32, 8
    s_add_u32 s46, s46, s37
    s_add_u32 s46, s46, 0x5400000
    s_waitcnt vmcnt(8)
    v_dot2_f32_bf16 v48, v16, s86, 0
    v_dot2_f32_bf16 v49, v16, v16, 0
    v_dot2_f32_bf16 v50, v24, s86, 0
    v_dot2_f32_bf16 v51, v24, v24, 0
    v_dot2_f32_bf16 v52, v32, s86, 0
    v_dot2_f32_bf16 v53, v32, v32, 0
    v_dot2_f32_bf16 v54, v40, s86, 0
    v_dot2_f32_bf16 v55, v40, v40, 0
    v_dot2_f32_bf16 v48, v17, s86, v48
    v_dot2_f32_bf16 v49, v17, v17, v49
    v_dot2_f32_bf16 v50, v25, s86, v50
    v_dot2_f32_bf16 v51, v25, v25, v51
    v_dot2_f32_bf16 v52, v33, s86, v52
    v_dot2_f32_bf16 v53, v33, v33, v53
    v_dot2_f32_bf16 v54, v41, s86, v54
    v_dot2_f32_bf16 v55, v41, v41, v55
    v_dot2_f32_bf16 v48, v18, s86, v48
    v_dot2_f32_bf16 v49, v18, v18, v49
    v_dot2_f32_bf16 v50, v26, s86, v50
    v_dot2_f32_bf16 v51, v26, v26, v51
    v_dot2_f32_bf16 v52, v34, s86, v52
    v_dot2_f32_bf16 v53, v34, v34, v53
    v_dot2_f32_bf16 v54, v42, s86, v54
    v_dot2_f32_bf16 v55, v42, v42, v55
    v_dot2_f32_bf16 v48, v19, s86, v48
    v_dot2_f32_bf16 v49, v19, v19, v49
    v_dot2_f32_bf16 v50, v27, s86, v50
    v_dot2_f32_bf16 v51, v27, v27, v51
    v_dot2_f32_bf16 v52, v35, s86, v52
    v_dot2_f32_bf16 v53, v35, v35, v53
    v_dot2_f32_bf16 v54, v43, s86, v54
    v_dot2_f32_bf16 v55, v43, v43, v55
    v_dot2_f32_bf16 v48, v20, s86, v48
    v_dot2_f32_bf16 v49, v20, v20, v49
    v_dot2_f32_bf16 v50, v28, s86, v50
    v_dot2_f32_bf16 v51, v28, v28, v51
    v_dot2_f32_bf16 v52, v36, s86, v52
    v_dot2_f32_bf16 v53, v36, v36, v53
    v_dot2_f32_bf16 v54, v44, s86, v54
    v_dot2_f32_bf16 v55, v44, v44, v55
    v_dot2_f32_bf16 v48, v21, s86, v48
    v_dot2_f32_bf16 v49, v21, v21, v49
    v_dot2_f32_bf16 v50, v29, s86, v50
    v_dot2_f32_bf16 v51, v29, v29, v51
    v_dot2_f32_bf16 v52, v37, s86, v52
    v_dot2_f32_bf16 v53, v37, v37, v53
    v_dot2_f32_bf16 v54, v45, s86, v54
    v_dot2_f32_bf16 v55, v45, v45, v55
    v_dot2_f32_bf16 v48, v22, s86, v48
    v_dot2_f32_bf16 v49, v22, v22, v49
    v_dot2_f32_bf16 v50, v30, s86, v50
    v_dot2_f32_bf16 v51, v30, v30, v51
    v_dot2_f32_bf16 v52, v38, s86, v52
    v_dot2_f32_bf16 v53, v38, v38, v53
    v_dot2_f32_bf16 v54, v46, s86, v54
    v_dot2_f32_bf16 v55, v46, v46, v55
    v_dot2_f32_bf16 v48, v23, s86, v48
    v_dot2_f32_bf16 v49, v23, v23, v49
    v_dot2_f32_bf16 v50, v31, s86, v50
    v_dot2_f32_bf16 v51, v31, v31, v51
    v_dot2_f32_bf16 v52, v39, s86, v52
    v_dot2_f32_bf16 v53, v39, v39, v53
    v_dot2_f32_bf16 v54, v47, s86, v54
    v_dot2_f32_bf16 v55, v47, v47, v55
    v_add_f32_dpp v48, v48, v48 quad_perm:[1,0,3,2] row_mask:0xf bank_mask:0xf
    v_add_f32_dpp v49, v49, v49 quad_perm:[1,0,3,2] row_mask:0xf bank_mask:0xf
    v_add_f32_dpp v50, v50, v50 quad_perm:[1,0,3,2] row_mask:0xf bank_mask:0xf
    v_add_f32_dpp v51, v51, v51 quad_perm:[1,0,3,2] row_mask:0xf bank_mask:0xf
    v_add_f32_dpp v52, v52, v52 quad_perm:[1,0,3,2] row_mask:0xf bank_mask:0xf
    v_add_f32_dpp v53, v53, v53 quad_perm:[1,0,3,2] row_mask:0xf bank_mask:0xf
    v_add_f32_dpp v54, v54, v54 quad_perm:[1,0,3,2] row_mask:0xf bank_mask:0xf
    v_add_f32_dpp v55, v55, v55 quad_perm:[1,0,3,2] row_mask:0xf bank_mask:0xf
    v_add_f32_dpp v48, v48, v48 quad_perm:[2,3,0,1] row_mask:0xf bank_mask:0xf
    v_add_f32_dpp v49, v49, v49 quad_perm:[2,3,0,1] row_mask:0xf bank_mask:0xf
    v_add_f32_dpp v50, v50, v50 quad_perm:[2,3,0,1] row_mask:0xf bank_mask:0xf
    v_add_f32_dpp v51, v51, v51 quad_perm:[2,3,0,1] row_mask:0xf bank_mask:0xf
    v_add_f32_dpp v52, v52, v52 quad_perm:[2,3,0,1] row_mask:0xf bank_mask:0xf
    v_add_f32_dpp v53, v53, v53 quad_perm:[2,3,0,1] row_mask:0xf bank_mask:0xf
    v_add_f32_dpp v54, v54, v54 quad_perm:[2,3,0,1] row_mask:0xf bank_mask:0xf
    v_add_f32_dpp v55, v55, v55 quad_perm:[2,3,0,1] row_mask:0xf bank_mask:0xf
    v_add_f32_dpp v48, v48, v48 row_half_mirror row_mask:0xf bank_mask:0xf
    v_add_f32_dpp v49, v49, v49 row_half_mirror row_mask:0xf bank_mask:0xf
    v_add_f32_dpp v50, v50, v50 row_half_mirror row_mask:0xf bank_mask:0xf
    v_add_f32_dpp v51, v51, v51 row_half_mirror row_mask:0xf bank_mask:0xf
    v_add_f32_dpp v52, v52, v52 row_half_mirror row_mask:0xf bank_mask:0xf
    v_add_f32_dpp v53, v53, v53 row_half_mirror row_mask:0xf bank_mask:0xf
    v_add_f32_dpp v54, v54, v54 row_half_mirror row_mask:0xf bank_mask:0xf
    v_add_f32_dpp v55, v55, v55 row_half_mirror row_mask:0xf bank_mask:0xf
    s_mov_b32 exec_lo, 0x2020202
    s_mov_b32 exec_hi, 0x2020202
    v_mov_b32 v48, v50
    v_mov_b32 v49, v51
    s_mov_b32 exec_lo, 0x4040404
    s_mov_b32 exec_hi, 0x4040404
    v_mov_b32 v48, v52
    v_mov_b32 v49, v53
    s_mov_b32 exec_lo, 0x8080808
    s_mov_b32 exec_hi, 0x8080808
    v_mov_b32 v48, v54
    v_mov_b32 v49, v55
    s_mov_b32 exec_lo, 0x0f0f0f0f
    s_mov_b32 exec_hi, 0x0f0f0f0f
    buffer_store_dwordx2 v[48:49], v56, s[16:19], s46 offen sc1
    s_mov_b64 exec, -1
    s_xor_b32 s50, s50, 1
    s_mov_b32 s86, 0x3f803f80
    v_and_b32 v104, 1, v0
    v_lshlrev_b32 v104, 7, v104
    v_bfe_u32 v105, v0, 1, 1
    v_lshl_add_u32 v104, v105, 6, v104
    v_and_b32 v105, 0x38, v0
    v_add_u32 v104, v105, v104
    s_sub_u32 s46, 127, s50
    s_lshl_b32 s46, s46, 10
    s_lshl_b32 s37, s32, 8
    s_add_u32 s46, s46, s37
    s_add_u32 s46, s46, 0x5400000
    s_waitcnt vmcnt(1)
    v_dot2_f32_bf16 v96, v64, s86, 0
    v_dot2_f32_bf16 v97, v64, v64, 0
    v_dot2_f32_bf16 v98, v72, s86, 0
    v_dot2_f32_bf16 v99, v72, v72, 0
    v_dot2_f32_bf16 v100, v80, s86, 0
    v_dot2_f32_bf16 v101, v80, v80, 0
    v_dot2_f32_bf16 v102, v88, s86, 0
    v_dot2_f32_bf16 v103, v88, v88, 0
    v_dot2_f32_bf16 v96, v65, s86, v96
    v_dot2_f32_bf16 v97, v65, v65, v97
    v_dot2_f32_bf16 v98, v73, s86, v98
    v_dot2_f32_bf16 v99, v73, v73, v99
    v_dot2_f32_bf16 v100, v81, s86, v100
    v_dot2_f32_bf16 v101, v81, v81, v101
    v_dot2_f32_bf16 v102, v89, s86, v102
    v_dot2_f32_bf16 v103, v89, v89, v103
    v_dot2_f32_bf16 v96, v66, s86, v96
    v_dot2_f32_bf16 v97, v66, v66, v97
    v_dot2_f32_bf16 v98, v74, s86, v98
    v_dot2_f32_bf16 v99, v74, v74, v99
    v_dot2_f32_bf16 v100, v82, s86, v100
    v_dot2_f32_bf16 v101, v82, v82, v101
    v_dot2_f32_bf16 v102, v90, s86, v102
    v_dot2_f32_bf16 v103, v90, v90, v103
    v_dot2_f32_bf16 v96, v67, s86, v96
    v_dot2_f32_bf16 v97, v67, v67, v97
    v_dot2_f32_bf16 v98, v75, s86, v98
    v_dot2_f32_bf16 v99, v75, v75, v99
    v_dot2_f32_bf16 v100, v83, s86, v100
    v_dot2_f32_bf16 v101, v83, v83, v101
    v_dot2_f32_bf16 v102, v91, s86, v102
    v_dot2_f32_bf16 v103, v91, v91, v103
    v_dot2_f32_bf16 v96, v68, s86, v96
    v_dot2_f32_bf16 v97, v68, v68, v97
    v_dot2_f32_bf16 v98, v76, s86, v98
    v_dot2_f32_bf16 v99, v76, v76, v99
    v_dot2_f32_bf16 v100, v84, s86, v100
    v_dot2_f32_bf16 v101, v84, v84, v101
    v_dot2_f32_bf16 v102, v92, s86, v102
    v_dot2_f32_bf16 v103, v92, v92, v103
    v_dot2_f32_bf16 v96, v69, s86, v96
    v_dot2_f32_bf16 v97, v69, v69, v97
    v_dot2_f32_bf16 v98, v77, s86, v98
    v_dot2_f32_bf16 v99, v77, v77, v99
    v_dot2_f32_bf16 v100, v85, s86, v100
    v_dot2_f32_bf16 v101, v85, v85, v101
    v_dot2_f32_bf16 v102, v93, s86, v102
    v_dot2_f32_bf16 v103, v93, v93, v103
    v_dot2_f32_bf16 v96, v70, s86, v96
    v_dot2_f32_bf16 v97, v70, v70, v97
    v_dot2_f32_bf16 v98, v78, s86, v98
    v_dot2_f32_bf16 v99, v78, v78, v99
    v_dot2_f32_bf16 v100, v86, s86, v100
    v_dot2_f32_bf16 v101, v86, v86, v101
    v_dot2_f32_bf16 v102, v94, s86, v102
    v_dot2_f32_bf16 v103, v94, v94, v103
    v_dot2_f32_bf16 v96, v71, s86, v96
    v_dot2_f32_bf16 v97, v71, v71, v97
    v_dot2_f32_bf16 v98, v79, s86, v98
    v_dot2_f32_bf16 v99, v79, v79, v99
    v_dot2_f32_bf16 v100, v87, s86, v100
    v_dot2_f32_bf16 v101, v87, v87, v101
    v_dot2_f32_bf16 v102, v95, s86, v102
    v_dot2_f32_bf16 v103, v95, v95, v103
    v_add_f32_dpp v96, v96, v96 quad_perm:[1,0,3,2] row_mask:0xf bank_mask:0xf
    v_add_f32_dpp v97, v97, v97 quad_perm:[1,0,3,2] row_mask:0xf bank_mask:0xf
    v_add_f32_dpp v98, v98, v98 quad_perm:[1,0,3,2] row_mask:0xf bank_mask:0xf
    v_add_f32_dpp v99, v99, v99 quad_perm:[1,0,3,2] row_mask:0xf bank_mask:0xf
    v_add_f32_dpp v100, v100, v100 quad_perm:[1,0,3,2] row_mask:0xf bank_mask:0xf
    v_add_f32_dpp v101, v101, v101 quad_perm:[1,0,3,2] row_mask:0xf bank_mask:0xf
    v_add_f32_dpp v102, v102, v102 quad_perm:[1,0,3,2] row_mask:0xf bank_mask:0xf
    v_add_f32_dpp v103, v103, v103 quad_perm:[1,0,3,2] row_mask:0xf bank_mask:0xf
    v_add_f32_dpp v96, v96, v96 quad_perm:[2,3,0,1] row_mask:0xf bank_mask:0xf
    v_add_f32_dpp v97, v97, v97 quad_perm:[2,3,0,1] row_mask:0xf bank_mask:0xf
    v_add_f32_dpp v98, v98, v98 quad_perm:[2,3,0,1] row_mask:0xf bank_mask:0xf
    v_add_f32_dpp v99, v99, v99 quad_perm:[2,3,0,1] row_mask:0xf bank_mask:0xf
    v_add_f32_dpp v100, v100, v100 quad_perm:[2,3,0,1] row_mask:0xf bank_mask:0xf
    v_add_f32_dpp v101, v101, v101 quad_perm:[2,3,0,1] row_mask:0xf bank_mask:0xf
    v_add_f32_dpp v102, v102, v102 quad_perm:[2,3,0,1] row_mask:0xf bank_mask:0xf
    v_add_f32_dpp v103, v103, v103 quad_perm:[2,3,0,1] row_mask:0xf bank_mask:0xf
    v_add_f32_dpp v96, v96, v96 row_half_mirror row_mask:0xf bank_mask:0xf
    v_add_f32_dpp v97, v97, v97 row_half_mirror row_mask:0xf bank_mask:0xf
    v_add_f32_dpp v98, v98, v98 row_half_mirror row_mask:0xf bank_mask:0xf
    v_add_f32_dpp v99, v99, v99 row_half_mirror row_mask:0xf bank_mask:0xf
    v_add_f32_dpp v100, v100, v100 row_half_mirror row_mask:0xf bank_mask:0xf
    v_add_f32_dpp v101, v101, v101 row_half_mirror row_mask:0xf bank_mask:0xf
    v_add_f32_dpp v102, v102, v102 row_half_mirror row_mask:0xf bank_mask:0xf
    v_add_f32_dpp v103, v103, v103 row_half_mirror row_mask:0xf bank_mask:0xf
    s_mov_b32 exec_lo, 0x2020202
    s_mov_b32 exec_hi, 0x2020202
    v_mov_b32 v96, v98
    v_mov_b32 v97, v99
    s_mov_b32 exec_lo, 0x4040404
    s_mov_b32 exec_hi, 0x4040404
    v_mov_b32 v96, v100
    v_mov_b32 v97, v101
    s_mov_b32 exec_lo, 0x8080808
    s_mov_b32 exec_hi, 0x8080808
    v_mov_b32 v96, v102
    v_mov_b32 v97, v103
    s_mov_b32 exec_lo, 0x0f0f0f0f
    s_mov_b32 exec_hi, 0x0f0f0f0f
    buffer_store_dwordx2 v[96:97], v104, s[16:19], s46 offen sc1
    s_mov_b64 exec, -1
    s_xor_b32 s50, s50, 1
    s_branch L_job_end
L_reset:
    s_add_u32 s53, s53, 80
    s_lshl_b32 s37, s53, 2
    s_add_u32 s37, s37, s32
    s_sub_u32 s37, s37, 512
    s_and_b32 s36, s37, 63
    s_cmp_lt_u32 s36, 16
    s_cselect_b32 s87, 34, 32
    s_cselect_b32 s39, 2, 3
    v_subrev_u32 v2, s39, v0
    v_cmp_gt_u32 vcc, s87, v2
    v_lshlrev_b32 v3, 17, v0
    s_lshl_b32 s38, s37, 10
    s_add_u32 s38, s38, 0x5440000
    v_cndmask_b32 v2, 0, -1, vcc
    s_lshl_b32 s37, s37, 8
    s_add_u32 s37, s37, 0x5500000
    s_add_u32 s87, s37, 65536
    s_cmp_ge_u32 s36, 44
    s_cselect_b32 s87, s87, 0x5e00000
    v_cmp_lt_u32 vcc, 1, v0
    v_mov_b32 v8, -1
    v_mov_b32 v9, -1
    v_mov_b32 v10, -1
    v_mov_b32 v11, -1
    v_cndmask_b32 v4, 0, -1, vcc
    s_mov_b32 exec_hi, 31
    buffer_load_dword v12, v3, s[16:19], s37 offen sc1
    buffer_load_dword v13, v3, s[16:19], s87 offen sc1
    s_waitcnt vmcnt(0)
    buffer_store_dword v2, v3, s[16:19], s37 offen sc1
    buffer_store_dword v4, v3, s[16:19], s87 offen sc1
    s_mov_b64 exec, -1
    buffer_store_dwordx4 v[8:11], v1, s[16:19], s38 offen sc1
L_job_end:
    s_mov_b32 s8, s82
    s_mov_b32 s9, s83
    s_mov_b32 s10, 0x100
    s_mov_b32 s11, 0x00020000
    v_mov_b32 v123, 1
    s_waitcnt vmcnt(0)
    s_barrier
    s_cmp_lg_u32 s32, 3
    s_cbranch_scc1 L_arr20
    buffer_atomic_add v123, v124, s[8:11], 0 offen sc0
    s_waitcnt vmcnt(0)
    v_readfirstlane_b32 s37, v123
    s_nop 0
    s_cmp_lg_u32 s37, 79
    s_cbranch_scc1 L_arr20
    buffer_store_dword v123, v124, s[8:11], 0 offen offset:128 sc1
L_arr20:
L_job_done:
    s_lshl_b32 s91, s33, 6
    s_add_u32 s91, s91, s34
    s_lshl_b32 s91, s91, 8
    s_add_u32 s91, s91, 0x5540000
    s_cmp_eq_u32 s32, 1
    s_cselect_b32 s91, s91, 0x5f00000
    s_cmp_ge_u32 s34, 60
    s_cbranch_scc1 L_role_60
    s_cmp_ge_u32 s34, 44
    s_cbranch_scc1 L_role_44
    s_cmp_ge_u32 s34, 40
    s_cbranch_scc1 L_role_40
L_role_16:
    s_sub_u32 s35, s34, 16
    s_lshl_b32 s54, s35, 8
    s_mov_b32 s12, s68
    s_mov_b32 s13, s69
    s_mov_b32 s14, 0x200000
    s_mov_b32 s15, 0x00020000
    s_mov_b32 s39, 2048
    v_lshrrev_b32 v52, 3, v0
    v_lshlrev_b32 v53, 2, v0
    v_and_b32 v53, 64, v53
    v_and_b32 v54, 0x70, v1
    v_xor_b32 v53, v53, v54
    v_mad_u32_u24 v44, v52, s39, v53
    v_add_u32 v45, 16384, v44
    v_add_u32 v46, 128, v44
    v_add_u32 v47, 16512, v44
    s_mul_i32 s38, s32, 32768
    s_add_u32 s54, s54, s38
    s_lshl_b32 s42, s32, 11
    s_add_u32 m0, s42, 0
    s_nop 0
    buffer_load_dwordx4 v44, s[12:15], s54 offen lds
    s_add_u32 m0, s42, 1024
    s_nop 0
    buffer_load_dwordx4 v45, s[12:15], s54 offen lds
    s_add_u32 m0, s42, 8192
    s_nop 0
    buffer_load_dwordx4 v46, s[12:15], s54 offen lds
    s_add_u32 m0, s42, 9216
    s_nop 0
    buffer_load_dwordx4 v47, s[12:15], s54 offen lds
    s_add_u32 s54, s54, 131072
    s_add_u32 m0, s42, 16384
    s_nop 0
    buffer_load_dwordx4 v44, s[12:15], s54 offen lds
    s_add_u32 m0, s42, 17408
    s_nop 0
    buffer_load_dwordx4 v45, s[12:15], s54 offen lds
    s_add_u32 m0, s42, 24576
    s_nop 0
    buffer_load_dwordx4 v46, s[12:15], s54 offen lds
    s_add_u32 m0, s42, 25600
    s_nop 0
    buffer_load_dwordx4 v47, s[12:15], s54 offen lds
    s_add_u32 s54, s54, 131072
    s_add_u32 m0, s42, 32768
    s_nop 0
    buffer_load_dwordx4 v44, s[12:15], s54 offen lds
    s_add_u32 m0, s42, 33792
    s_nop 0
    buffer_load_dwordx4 v45, s[12:15], s54 offen lds
    s_add_u32 m0, s42, 40960
    s_nop 0
    buffer_load_dwordx4 v46, s[12:15], s54 offen lds
    s_add_u32 m0, s42, 41984
    s_nop 0
    buffer_load_dwordx4 v47, s[12:15], s54 offen lds
    s_add_u32 s54, s54, 131072
    s_add_u32 m0, s42, 49152
    s_nop 0
    buffer_load_dwordx4 v44, s[12:15], s54 offen lds
    s_add_u32 m0, s42, 50176
    s_nop 0
    buffer_load_dwordx4 v45, s[12:15], s54 offen lds
    s_add_u32 m0, s42, 57344
    s_nop 0
    buffer_load_dwordx4 v46, s[12:15], s54 offen lds
    s_add_u32 m0, s42, 58368
    s_nop 0
    buffer_load_dwordx4 v47, s[12:15], s54 offen lds
    s_add_u32 s54, s54, 131072
    s_add_u32 m0, s42, 65536
    s_nop 0
    buffer_load_dwordx4 v44, s[12:15], s54 offen lds
    s_add_u32 m0, s42, 66560
    s_nop 0
    buffer_load_dwordx4 v45, s[12:15], s54 offen lds
    s_add_u32 m0, s42, 73728
    s_nop 0
    buffer_load_dwordx4 v46, s[12:15], s54 offen lds
    s_add_u32 m0, s42, 74752
    s_nop 0
    buffer_load_dwordx4 v47, s[12:15], s54 offen lds
    s_add_u32 s54, s54, 131072
    v_lshrrev_b32 v52, 4, v0
    v_bfe_u32 v53, v0, 2, 2
    v_lshl_add_u32 v52, v52, 3, v53
    v_lshlrev_b32 v52, 7, v52
    v_lshrrev_b32 v53, 1, v53
    v_lshl_add_u32 v52, v53, 6, v52
    v_and_b32 v53, 3, v0
    v_lshl_add_u32 v52, v53, 4, v52
    s_lshr_b32 s37, s32, 1
    s_lshl_b32 s37, s37, 13
    s_and_b32 s38, s32, 1
    s_lshl_b32 s38, s38, 6
    s_add_u32 s37, s37, s38
    s_add_u32 s37, s37, 0
    v_xor_b32 v48, s37, v52
    s_lshr_b32 s37, s32, 1
    s_lshl_b32 s37, s37, 13
    s_and_b32 s38, s32, 1
    s_lshl_b32 s38, s38, 6
    s_add_u32 s37, s37, s38
    s_add_u32 s37, s37, 8
    v_xor_b32 v49, s37, v52
    v_add_u32 v2, 98304, v1
    v_mov_b32 v108, 0
    v_mov_b32 v109, 0
    v_mov_b32 v110, 0
    v_mov_b32 v111, 0
    v_mov_b32 v112, 0
    v_mov_b32 v113, 0
    v_mov_b32 v114, 0
    v_mov_b32 v115, 0
    v_mov_b32 v13, 0x3f80
    v_and_b32 v12, 1, v0
    v_lshlrev_b32 v12, 4, v12
    v_lshlrev_b32 v12, v12, v13
    s_mov_b32 exec_lo, 0x300003
    s_mov_b32 exec_hi, 0x30000300
    v_mov_b32 v108, v12
    v_mov_b32 v114, v12
    s_mov_b32 exec_lo, 0xc0000c
    s_mov_b32 exec_hi, 0xc0000c00
    v_mov_b32 v109, v12
    v_mov_b32 v115, v12
    s_mov_b64 exec, -1
    s_lshl_b32 s37, s33, 6
    s_add_u32 s37, s37, 0
    s_lshl_b32 s37, s37, 8
    v_lshl_add_u32 v4, v0, 8, s37
    s_cmp_eq_u32 s32, 0
    s_cselect_b32 s37, 16, 0
    v_cmp_le_u32 vcc, s37, v0
    s_nop 1
    v_cndmask_b32 v4, v4, 2.0, vcc
    s_mov_b32 s86, 0x3f803f80
    s_lshl_b32 s43, s32, 12
    s_mul_i32 s41, s33, 2097152
    s_add_u32 s41, s41, 0x0
    s_add_u32 s41, s41, s43
    s_lshl_b32 s38, s35, 2
    s_add_u32 s38, s38, s32
    s_mul_i32 s90, s33, 2097152
    s_add_u32 s90, s90, 0x7f0000
    s_lshl_b32 s37, s38, 11
    s_add_u32 s90, s90, s37
    v_and_b32 v12, 15, v0
    v_and_b32 v13, 0x30, v0
    v_lshl_add_u32 v3, v12, 11, v13
    s_lshl_b32 s37, s38, 6
    v_add_u32 v3, s37, v3
    s_lshl_b32 s50, s33, 20
    s_add_u32 s50, s50, 983040
    s_add_u32 s88, s84, 0x5000000
    s_addc_u32 s89, s85, 0
    s_mov_b32 s8, s64
    s_mov_b32 s9, s65
    s_mov_b32 s10, 0x400000
    s_mov_b32 s11, 0x00020000
    v_bfe_u32 v13, v0, 4, 1
    v_lshl_add_u32 v12, v12, 1, v13
    s_lshl_b32 s37, s32, 2
    s_add_u32 s37, s37, 65536
    v_lshl_add_u32 v6, v12, 4, s37
    v_add_u32 v7, 65536, v1
    v_and_b32 v12, 31, v0
    v_lshrrev_b32 v13, 5, v0
    v_lshlrev_b32 v12, 2, v12
    v_lshl_add_u32 v8, v13, 10, v12
    s_mul_i32 s46, s33, 65536
    s_add_u32 s46, s46, 0x543f800
    s_lshl_b32 s37, s35, 7
    s_add_u32 s46, s46, s37
    s_cmp_eq_u32 s32, 2
    s_cselect_b32 s46, s46, 0x5e00000
    s_mov_b32 s36, -1
    v_add_u32 v50, 0, v48
    v_add_u32 v51, 0, v49
    s_waitcnt vmcnt(16)
    s_barrier
    ds_read_b64_tr_b16 a[0:1], v50 offset:0
    ds_read_b64_tr_b16 a[2:3], v50 offset:512
    ds_read_b64_tr_b16 a[4:5], v51 offset:0
    ds_read_b64_tr_b16 a[6:7], v51 offset:512
    ds_read_b64_tr_b16 a[8:9], v50 offset:4096
    ds_read_b64_tr_b16 a[10:11], v50 offset:4608
    ds_read_b64_tr_b16 a[12:13], v51 offset:4096
    ds_read_b64_tr_b16 a[14:15], v51 offset:4608
    s_add_u32 m0, s42, 81920
    s_nop 0
    buffer_load_dwordx4 v44, s[12:15], s54 offen lds
    s_add_u32 m0, s42, 82944
    s_nop 0
    buffer_load_dwordx4 v45, s[12:15], s54 offen lds
    s_add_u32 m0, s42, 90112
    s_nop 0
    buffer_load_dwordx4 v46, s[12:15], s54 offen lds
    s_add_u32 m0, s42, 91136
    s_nop 0
    buffer_load_dwordx4 v47, s[12:15], s54 offen lds
    s_add_u32 s54, s54, 131072
    s_waitcnt lgkmcnt(0)
    v_add_u32 v50, 16384, v48
    v_add_u32 v51, 16384, v49
    s_waitcnt vmcnt(16)
    s_barrier
    ds_read_b64_tr_b16 a[16:17], v50 offset:0
    ds_read_b64_tr_b16 a[18:19], v50 offset:512
    ds_read_b64_tr_b16 a[20:21], v51 offset:0
    ds_read_b64_tr_b16 a[22:23], v51 offset:512
    ds_read_b64_tr_b16 a[24:25], v50 offset:4096
    ds_read_b64_tr_b16 a[26:27], v50 offset:4608
    ds_read_b64_tr_b16 a[28:29], v51 offset:4096
    ds_read_b64_tr_b16 a[30:31], v51 offset:4608
    s_add_u32 m0, s42, 0
    s_nop 0
    buffer_load_dwordx4 v44, s[12:15], s54 offen lds
    s_add_u32 m0, s42, 1024
    s_nop 0
    buffer_load_dwordx4 v45, s[12:15], s54 offen lds
    s_add_u32 m0, s42, 8192
    s_nop 0
    buffer_load_dwordx4 v46, s[12:15], s54 offen lds
    s_add_u32 m0, s42, 9216
    s_nop 0
    buffer_load_dwordx4 v47, s[12:15], s54 offen lds
    s_add_u32 s54, s54, 131072
    s_waitcnt lgkmcnt(0)
    v_add_u32 v50, 32768, v48
    v_add_u32 v51, 32768, v49
    s_waitcnt vmcnt(16)
    s_barrier
    ds_read_b64_tr_b16 a[32:33], v50 offset:0
    ds_read_b64_tr_b16 a[34:35], v50 offset:512
    ds_read_b64_tr_b16 a[36:37], v51 offset:0
    ds_read_b64_tr_b16 a[38:39], v51 offset:512
    ds_read_b64_tr_b16 a[40:41], v50 offset:4096
    ds_read_b64_tr_b16 a[42:43], v50 offset:4608
    ds_read_b64_tr_b16 a[44:45], v51 offset:4096
    ds_read_b64_tr_b16 a[46:47], v51 offset:4608
    s_add_u32 m0, s42, 16384
    s_nop 0
    buffer_load_dwordx4 v44, s[12:15], s54 offen lds
    s_add_u32 m0, s42, 17408
    s_nop 0
    buffer_load_dwordx4 v45, s[12:15], s54 offen lds
    s_add_u32 m0, s42, 24576
    s_nop 0
    buffer_load_dwordx4 v46, s[12:15], s54 offen lds
    s_add_u32 m0, s42, 25600
    s_nop 0
    buffer_load_dwordx4 v47, s[12:15], s54 offen lds
    s_add_u32 s54, s54, 131072
    s_waitcnt lgkmcnt(0)
    v_add_u32 v50, 49152, v48
    v_add_u32 v51, 49152, v49
    s_waitcnt vmcnt(16)
    s_barrier
    ds_read_b64_tr_b16 a[48:49], v50 offset:0
    ds_read_b64_tr_b16 a[50:51], v50 offset:512
    ds_read_b64_tr_b16 a[52:53], v51 offset:0
    ds_read_b64_tr_b16 a[54:55], v51 offset:512
    ds_read_b64_tr_b16 a[56:57], v50 offset:4096
    ds_read_b64_tr_b16 a[58:59], v50 offset:4608
    ds_read_b64_tr_b16 a[60:61], v51 offset:4096
    ds_read_b64_tr_b16 a[62:63], v51 offset:4608
    s_add_u32 m0, s42, 32768
    s_nop 0
    buffer_load_dwordx4 v44, s[12:15], s54 offen lds
    s_add_u32 m0, s42, 33792
    s_nop 0
    buffer_load_dwordx4 v45, s[12:15], s54 offen lds
    s_add_u32 m0, s42, 40960
    s_nop 0
    buffer_load_dwordx4 v46, s[12:15], s54 offen lds
    s_add_u32 m0, s42, 41984
    s_nop 0
    buffer_load_dwordx4 v47, s[12:15], s54 offen lds
    s_add_u32 s54, s54, 131072
    s_waitcnt lgkmcnt(0)
    v_add_u32 v50, 65536, v48
    v_add_u32 v51, 65536, v49
    s_waitcnt vmcnt(16)
    s_barrier
    ds_read_b64_tr_b16 a[64:65], v50 offset:0
    ds_read_b64_tr_b16 a[66:67], v50 offset:512
    ds_read_b64_tr_b16 a[68:69], v51 offset:0
    ds_read_b64_tr_b16 a[70:71], v51 offset:512
    ds_read_b64_tr_b16 a[72:73], v50 offset:4096
    ds_read_b64_tr_b16 a[74:75], v50 offset:4608
    ds_read_b64_tr_b16 a[76:77], v51 offset:4096
    ds_read_b64_tr_b16 a[78:79], v51 offset:4608
    s_add_u32 m0, s42, 49152
    s_nop 0
    buffer_load_dwordx4 v44, s[12:15], s54 offen lds
    s_add_u32 m0, s42, 50176
    s_nop 0
    buffer_load_dwordx4 v45, s[12:15], s54 offen lds
    s_add_u32 m0, s42, 57344
    s_nop 0
    buffer_load_dwordx4 v46, s[12:15], s54 offen lds
    s_add_u32 m0, s42, 58368
    s_nop 0
    buffer_load_dwordx4 v47, s[12:15], s54 offen lds
    s_add_u32 s54, s54, 131072
    s_waitcnt lgkmcnt(0)
    v_add_u32 v50, 81920, v48
    v_add_u32 v51, 81920, v49
    s_waitcnt vmcnt(16)
    s_barrier
    ds_read_b64_tr_b16 a[80:81], v50 offset:0
    ds_read_b64_tr_b16 a[82:83], v50 offset:512
    ds_read_b64_tr_b16 a[84:85], v51 offset:0
    ds_read_b64_tr_b16 a[86:87], v51 offset:512
    ds_read_b64_tr_b16 a[88:89], v50 offset:4096
    ds_read_b64_tr_b16 a[90:91], v50 offset:4608
    ds_read_b64_tr_b16 a[92:93], v51 offset:4096
    ds_read_b64_tr_b16 a[94:95], v51 offset:4608
    s_add_u32 m0, s42, 65536
    s_nop 0
    buffer_load_dwordx4 v44, s[12:15], s54 offen lds
    s_add_u32 m0, s42, 66560
    s_nop 0
    buffer_load_dwordx4 v45, s[12:15], s54 offen lds
    s_add_u32 m0, s42, 73728
    s_nop 0
    buffer_load_dwordx4 v46, s[12:15], s54 offen lds
    s_add_u32 m0, s42, 74752
    s_nop 0
    buffer_load_dwordx4 v47, s[12:15], s54 offen lds
    s_add_u32 s54, s54, 131072
    s_waitcnt lgkmcnt(0)
    v_add_u32 v50, 0, v48
    v_add_u32 v51, 0, v49
    s_waitcnt vmcnt(16)
    s_barrier
    ds_read_b64_tr_b16 a[96:97], v50 offset:0
    ds_read_b64_tr_b16 a[98:99], v50 offset:512
    ds_read_b64_tr_b16 a[100:101], v51 offset:0
    ds_read_b64_tr_b16 a[102:103], v51 offset:512
    ds_read_b64_tr_b16 a[104:105], v50 offset:4096
    ds_read_b64_tr_b16 a[106:107], v50 offset:4608
    ds_read_b64_tr_b16 a[108:109], v51 offset:4096
    ds_read_b64_tr_b16 a[110:111], v51 offset:4608
    s_add_u32 m0, s42, 81920
    s_nop 0
    buffer_load_dwordx4 v44, s[12:15], s54 offen lds
    s_add_u32 m0, s42, 82944
    s_nop 0
    buffer_load_dwordx4 v45, s[12:15], s54 offen lds
    s_add_u32 m0, s42, 90112
    s_nop 0
    buffer_load_dwordx4 v46, s[12:15], s54 offen lds
    s_add_u32 m0, s42, 91136
    s_nop 0
    buffer_load_dwordx4 v47, s[12:15], s54 offen lds
    s_add_u32 s54, s54, 131072
    s_waitcnt lgkmcnt(0)
    v_add_u32 v50, 16384, v48
    v_add_u32 v51, 16384, v49
    s_waitcnt vmcnt(16)
    s_barrier
    ds_read_b64_tr_b16 a[112:113], v50 offset:0
    ds_read_b64_tr_b16 a[114:115], v50 offset:512
    ds_read_b64_tr_b16 a[116:117], v51 offset:0
    ds_read_b64_tr_b16 a[118:119], v51 offset:512
    ds_read_b64_tr_b16 a[120:121], v50 offset:4096
    ds_read_b64_tr_b16 a[122:123], v50 offset:4608
    ds_read_b64_tr_b16 a[124:125], v51 offset:4096
    ds_read_b64_tr_b16 a[126:127], v51 offset:4608
    s_add_u32 m0, s42, 0
    s_nop 0
    buffer_load_dwordx4 v44, s[12:15], s54 offen lds
    s_add_u32 m0, s42, 1024
    s_nop 0
    buffer_load_dwordx4 v45, s[12:15], s54 offen lds
    s_add_u32 m0, s42, 8192
    s_nop 0
    buffer_load_dwordx4 v46, s[12:15], s54 offen lds
    s_add_u32 m0, s42, 9216
    s_nop 0
    buffer_load_dwordx4 v47, s[12:15], s54 offen lds
    s_add_u32 s54, s54, 131072
    s_waitcnt lgkmcnt(0)
    v_add_u32 v50, 32768, v48
    v_add_u32 v51, 32768, v49
    s_waitcnt vmcnt(16)
    s_barrier
    ds_read_b64_tr_b16 a[128:129], v50 offset:0
    ds_read_b64_tr_b16 a[130:131], v50 offset:512
    ds_read_b64_tr_b16 a[132:133], v51 offset:0
    ds_read_b64_tr_b16 a[134:135], v51 offset:512
    ds_read_b64_tr_b16 a[136:137], v50 offset:4096
    ds_read_b64_tr_b16 a[138:139], v50 offset:4608
    ds_read_b64_tr_b16 a[140:141], v51 offset:4096
    ds_read_b64_tr_b16 a[142:143], v51 offset:4608
    s_add_u32 m0, s42, 16384
    s_nop 0
    buffer_load_dwordx4 v44, s[12:15], s54 offen lds
    s_add_u32 m0, s42, 17408
    s_nop 0
    buffer_load_dwordx4 v45, s[12:15], s54 offen lds
    s_add_u32 m0, s42, 24576
    s_nop 0
    buffer_load_dwordx4 v46, s[12:15], s54 offen lds
    s_add_u32 m0, s42, 25600
    s_nop 0
    buffer_load_dwordx4 v47, s[12:15], s54 offen lds
    s_add_u32 s54, s54, 131072
    s_waitcnt lgkmcnt(0)
    v_add_u32 v50, 49152, v48
    v_add_u32 v51, 49152, v49
    s_waitcnt vmcnt(16)
    s_barrier
    ds_read_b64_tr_b16 a[144:145], v50 offset:0
    ds_read_b64_tr_b16 a[146:147], v50 offset:512
    ds_read_b64_tr_b16 a[148:149], v51 offset:0
    ds_read_b64_tr_b16 a[150:151], v51 offset:512
    ds_read_b64_tr_b16 a[152:153], v50 offset:4096
    ds_read_b64_tr_b16 a[154:155], v50 offset:4608
    ds_read_b64_tr_b16 a[156:157], v51 offset:4096
    ds_read_b64_tr_b16 a[158:159], v51 offset:4608
    s_add_u32 m0, s42, 32768
    s_nop 0
    buffer_load_dwordx4 v44, s[12:15], s54 offen lds
    s_add_u32 m0, s42, 33792
    s_nop 0
    buffer_load_dwordx4 v45, s[12:15], s54 offen lds
    s_add_u32 m0, s42, 40960
    s_nop 0
    buffer_load_dwordx4 v46, s[12:15], s54 offen lds
    s_add_u32 m0, s42, 41984
    s_nop 0
    buffer_load_dwordx4 v47, s[12:15], s54 offen lds
    s_add_u32 s54, s54, 131072
    s_waitcnt lgkmcnt(0)
    v_add_u32 v50, 65536, v48
    v_add_u32 v51, 65536, v49
    s_waitcnt vmcnt(16)
    s_barrier
    ds_read_b64_tr_b16 a[160:161], v50 offset:0
    ds_read_b64_tr_b16 a[162:163], v50 offset:512
    ds_read_b64_tr_b16 a[164:165], v51 offset:0
    ds_read_b64_tr_b16 a[166:167], v51 offset:512
    ds_read_b64_tr_b16 a[168:169], v50 offset:4096
    ds_read_b64_tr_b16 a[170:171], v50 offset:4608
    ds_read_b64_tr_b16 a[172:173], v51 offset:4096
    ds_read_b64_tr_b16 a[174:175], v51 offset:4608
    s_add_u32 m0, s42, 49152
    s_nop 0
    buffer_load_dwordx4 v44, s[12:15], s54 offen lds
    s_add_u32 m0, s42, 50176
    s_nop 0
    buffer_load_dwordx4 v45, s[12:15], s54 offen lds
    s_add_u32 m0, s42, 57344
    s_nop 0
    buffer_load_dwordx4 v46, s[12:15], s54 offen lds
    s_add_u32 m0, s42, 58368
    s_nop 0
    buffer_load_dwordx4 v47, s[12:15], s54 offen lds
    s_add_u32 s54, s54, 131072
    s_waitcnt lgkmcnt(0)
    v_add_u32 v50, 81920, v48
    v_add_u32 v51, 81920, v49
    s_waitcnt vmcnt(16)
    s_barrier
    ds_read_b64_tr_b16 a[176:177], v50 offset:0
    ds_read_b64_tr_b16 a[178:179], v50 offset:512
    ds_read_b64_tr_b16 a[180:181], v51 offset:0
    ds_read_b64_tr_b16 a[182:183], v51 offset:512
    ds_read_b64_tr_b16 a[184:185], v50 offset:4096
    ds_read_b64_tr_b16 a[186:187], v50 offset:4608
    ds_read_b64_tr_b16 a[188:189], v51 offset:4096
    ds_read_b64_tr_b16 a[190:191], v51 offset:4608
    s_waitcnt lgkmcnt(0)
    v_add_u32 v50, 0, v48
    v_add_u32 v51, 0, v49
    s_waitcnt vmcnt(12)
    s_barrier
    ds_read_b64_tr_b16 a[192:193], v50 offset:0
    ds_read_b64_tr_b16 a[194:195], v50 offset:512
    ds_read_b64_tr_b16 a[196:197], v51 offset:0
    ds_read_b64_tr_b16 a[198:199], v51 offset:512
    ds_read_b64_tr_b16 a[200:201], v50 offset:4096
    ds_read_b64_tr_b16 a[202:203], v50 offset:4608
    ds_read_b64_tr_b16 a[204:205], v51 offset:4096
    ds_read_b64_tr_b16 a[206:207], v51 offset:4608
    s_waitcnt lgkmcnt(0)
    v_add_u32 v50, 16384, v48
    v_add_u32 v51, 16384, v49
    s_waitcnt vmcnt(8)
    s_barrier
    ds_read_b64_tr_b16 a[208:209], v50 offset:0
    ds_read_b64_tr_b16 a[210:211], v50 offset:512
    ds_read_b64_tr_b16 a[212:213], v51 offset:0
    ds_read_b64_tr_b16 a[214:215], v51 offset:512
    ds_read_b64_tr_b16 a[216:217], v50 offset:4096
    ds_read_b64_tr_b16 a[218:219], v50 offset:4608
    ds_read_b64_tr_b16 a[220:221], v51 offset:4096
    ds_read_b64_tr_b16 a[222:223], v51 offset:4608
    s_waitcnt lgkmcnt(0)
    v_add_u32 v50, 32768, v48
    v_add_u32 v51, 32768, v49
    s_waitcnt vmcnt(4)
    s_barrier
    ds_read_b64_tr_b16 a[224:225], v50 offset:0
    ds_read_b64_tr_b16 a[226:227], v50 offset:512
    ds_read_b64_tr_b16 a[228:229], v51 offset:0
    ds_read_b64_tr_b16 a[230:231], v51 offset:512
    ds_read_b64_tr_b16 a[232:233], v50 offset:4096
    ds_read_b64_tr_b16 a[234:235], v50 offset:4608
    ds_read_b64_tr_b16 a[236:237], v51 offset:4096
    ds_read_b64_tr_b16 a[238:239], v51 offset:4608
    s_waitcnt lgkmcnt(0)
    v_add_u32 v50, 49152, v48
    v_add_u32 v51, 49152, v49
    s_waitcnt vmcnt(0)
    s_barrier
    ds_read_b64_tr_b16 a[240:241], v50 offset:0
    ds_read_b64_tr_b16 a[242:243], v50 offset:512
    ds_read_b64_tr_b16 a[244:245], v51 offset:0
    ds_read_b64_tr_b16 a[246:247], v51 offset:512
    ds_read_b64_tr_b16 a[248:249], v50 offset:4096
    ds_read_b64_tr_b16 a[250:251], v50 offset:4608
    ds_read_b64_tr_b16 a[252:253], v51 offset:4096
    ds_read_b64_tr_b16 a[254:255], v51 offset:4608
    s_waitcnt lgkmcnt(0)
    s_barrier
    s_cmp_lg_u32 s32, 0
    s_cbranch_scc1 L_arv21
    s_add_u32 s20, s82, 0x80
    s_addc_u32 s21, s83, 0
    s_mov_b32 s22, 0x4
    s_mov_b32 s23, 0x00020000
    buffer_load_dword v12, v124, s[20:23], 0 offen sc1
    s_waitcnt vmcnt(0)
    v_cmp_eq_u32 vcc, v124, v12
    s_cbranch_vccnz L_spin22
L_back23:
L_arv21:
    s_add_u32 s96, s41, 2031616
    s_mov_b32 s98, s41
    s_mov_b32 s45, 0x5580000
    buffer_load_dword v136, v4, s[16:19], s45 offen sc1
    s_waitcnt vmcnt(0)
    v_cmp_ne_u32 vcc, 0, v136
    s_cbranch_vccnz L_spin24
L_back25:
    s_barrier
    s_add_u32 m0, s43, 0
    s_add_u32 s42, s41, 0
    buffer_load_dwordx4 v1, s[16:19], s42 offen offset:0 sc1 lds
    buffer_load_dwordx4 v1, s[16:19], s42 offen offset:1024 sc1 lds
    buffer_load_dwordx4 v1, s[16:19], s42 offen offset:2048 sc1 lds
    buffer_load_dwordx4 v1, s[16:19], s42 offen offset:3072 sc1 lds
    s_add_u32 m0, s43, 16384
    s_add_u32 s42, s41, 16384
    buffer_load_dwordx4 v1, s[16:19], s42 offen offset:0 sc1 lds
    buffer_load_dwordx4 v1, s[16:19], s42 offen offset:1024 sc1 lds
    buffer_load_dwordx4 v1, s[16:19], s42 offen offset:2048 sc1 lds
    buffer_load_dwordx4 v1, s[16:19], s42 offen offset:3072 sc1 lds
    s_add_u32 s45, s45, 131072
    s_add_u32 s47, s36, 1
    s_min_u32 s47, s47, 31
    s_cmp_ge_u32 s47, 16
    s_cselect_b32 s8, s88, s64
    s_cselect_b32 s9, s89, s65
    s_and_b32 s47, s47, 15
    s_lshl_b32 s47, s47, 16
    s_sub_u32 s47, s50, s47
    s_add_u32 s48, s47, 32768
    buffer_load_dwordx4 v[128:131], v3, s[8:11], s48 offen sc1
    buffer_load_dwordx4 v[132:135], v3, s[8:11], s47 offen sc1
    s_waitcnt vmcnt(0) lgkmcnt(0)
    s_barrier
    v_mfma_f32_16x16x32_bf16 v[12:15], v[108:111], v[128:131], 0
    v_mfma_f32_16x16x32_bf16 v[16:19], v[112:115], v[128:131], 0
    v_mfma_f32_16x16x32_bf16 v[20:23], v[108:111], v[132:135], 0
    v_mfma_f32_16x16x32_bf16 v[24:27], v[112:115], v[132:135], 0
    ds_read_b128 v[44:47], v1 offset:0
    ds_read_b128 v[48:51], v1 offset:1024
    ds_read_b128 v[52:55], v1 offset:2048
    ds_read_b128 v[56:59], v1 offset:3072
    s_mov_b32 s36, 0
    s_waitcnt lgkmcnt(0)
    s_nop 7
L_o_b0:
    s_waitcnt lgkmcnt(2)
    v_mfma_f32_16x16x32_bf16 v[12:15], a[0:3], v[44:47], v[12:15]
    s_and_b32 s44, s90, 0xffffffff
    ds_read_b128 v[60:63], v1 offset:4096
    s_cmp_eq_u32 s36, 0
    v_mfma_f32_16x16x32_bf16 v[20:23], a[0:3], v[48:51], v[20:23]
    s_cselect_b32 s44, 0x5e00000, s44
    s_cselect_b32 s49, 0x5e00000, s46
    v_cvt_pk_bf16_f32 v148, v28, v29
    v_mfma_f32_16x16x32_bf16 v[24:27], a[4:7], v[48:51], v[24:27]
    s_add_u32 m0, s43, 32768
    ds_read_b128 v[64:67], v1 offset:5120
    v_cvt_pk_bf16_f32 v149, v30, v31
    v_mfma_f32_16x16x32_bf16 v[16:19], a[4:7], v[44:47], v[16:19]
    s_waitcnt lgkmcnt(2)
    v_cvt_pk_bf16_f32 v150, v32, v33
    v_cvt_pk_bf16_f32 v151, v34, v35
    v_mfma_f32_16x16x32_bf16 v[12:15], a[8:11], v[52:55], v[12:15]
    s_add_u32 s42, s41, 32768
    ds_read_b128 v[68:71], v1 offset:6144
    buffer_store_dwordx4 v[148:151], v1, s[16:19], s44 offen offset:0 sc1
    v_mfma_f32_16x16x32_bf16 v[20:23], a[8:11], v[56:59], v[20:23]
    v_cvt_pk_bf16_f32 v152, v36, v37
    v_cvt_pk_bf16_f32 v153, v38, v39
    v_mfma_f32_16x16x32_bf16 v[24:27], a[12:15], v[56:59], v[24:27]
    ds_read_b128 v[72:75], v1 offset:7168
    v_cvt_pk_bf16_f32 v154, v40, v41
    v_mfma_f32_16x16x32_bf16 v[16:19], a[12:15], v[52:55], v[16:19]
    s_waitcnt lgkmcnt(2)
    v_cvt_pk_bf16_f32 v155, v42, v43
    buffer_store_dwordx4 v[152:155], v1, s[16:19], s44 offen offset:1024 sc1
    v_mfma_f32_16x16x32_bf16 v[12:15], a[16:19], v[60:63], v[12:15]
    ds_read_b128 v[44:47], v1 offset:8192
    buffer_load_dwordx4 v1, s[16:19], s42 offen offset:0 sc1 lds
    v_mfma_f32_16x16x32_bf16 v[20:23], a[16:19], v[64:67], v[20:23]
    v_add_f32 v140, v28, v29
    v_mul_f32 v141, v28, v28
    v_mfma_f32_16x16x32_bf16 v[24:27], a[20:23], v[64:67], v[24:27]
    ds_read_b128 v[48:51], v1 offset:9216
    buffer_load_dwordx4 v1, s[16:19], s42 offen offset:1024 sc1 lds
    v_mfma_f32_16x16x32_bf16 v[16:19], a[20:23], v[60:63], v[16:19]
    s_waitcnt lgkmcnt(2)
    v_fmac_f32 v141, v29, v29
    v_add_f32 v140, v140, v30
    v_mfma_f32_16x16x32_bf16 v[12:15], a[24:27], v[68:71], v[12:15]
    s_add_u32 s47, s36, 1
    ds_read_b128 v[52:55], v1 offset:10240
    buffer_load_dwordx4 v1, s[16:19], s42 offen offset:2048 sc1 lds
    v_mfma_f32_16x16x32_bf16 v[20:23], a[24:27], v[72:75], v[20:23]
    s_min_u32 s47, s47, 31
    v_fmac_f32 v141, v30, v30
    v_add_f32 v140, v140, v31
    v_mfma_f32_16x16x32_bf16 v[24:27], a[28:31], v[72:75], v[24:27]
    s_cmp_ge_u32 s47, 16
    ds_read_b128 v[56:59], v1 offset:11264
    buffer_load_dwordx4 v1, s[16:19], s42 offen offset:3072 sc1 lds
    v_mfma_f32_16x16x32_bf16 v[16:19], a[28:31], v[68:71], v[16:19]
    s_waitcnt lgkmcnt(2)
    v_fmac_f32 v141, v31, v31
    v_add_f32 v140, v140, v32
    v_mfma_f32_16x16x32_bf16 v[12:15], a[32:35], v[44:47], v[12:15]
    s_cselect_b32 s8, s88, s64
    ds_read_b128 v[60:63], v1 offset:12288
    v_fmac_f32 v141, v32, v32
    v_mfma_f32_16x16x32_bf16 v[20:23], a[32:35], v[48:51], v[20:23]
    s_cselect_b32 s9, s89, s65
    v_add_f32 v140, v140, v33
    v_fmac_f32 v141, v33, v33
    v_mfma_f32_16x16x32_bf16 v[24:27], a[36:39], v[48:51], v[24:27]
    s_add_u32 m0, s43, 49152
    ds_read_b128 v[64:67], v1 offset:13312
    v_add_f32 v140, v140, v34
    v_mfma_f32_16x16x32_bf16 v[16:19], a[36:39], v[44:47], v[16:19]
    s_waitcnt lgkmcnt(2)
    v_fmac_f32 v141, v34, v34
    v_add_f32 v140, v140, v35
    v_mfma_f32_16x16x32_bf16 v[12:15], a[40:43], v[52:55], v[12:15]
    s_add_u32 s42, s41, 49152
    ds_read_b128 v[68:71], v1 offset:14336
    buffer_load_dwordx4 v1, s[16:19], s42 offen offset:0 sc1 lds
    v_mfma_f32_16x16x32_bf16 v[20:23], a[40:43], v[56:59], v[20:23]
    s_and_b32 s47, s47, 15
    v_fmac_f32 v141, v35, v35
    s_lshl_b32 s47, s47, 16
    v_mfma_f32_16x16x32_bf16 v[24:27], a[44:47], v[56:59], v[24:27]
    s_sub_u32 s47, s50, s47
    ds_read_b128 v[72:75], v1 offset:15360
    buffer_load_dwordx4 v1, s[16:19], s42 offen offset:1024 sc1 lds
    v_mfma_f32_16x16x32_bf16 v[16:19], a[44:47], v[52:55], v[16:19]
    s_waitcnt vmcnt(8) lgkmcnt(2)
    s_barrier
    v_permlane16_swap_b32 v140, v141
    v_mfma_f32_16x16x32_bf16 v[12:15], a[48:51], v[60:63], v[12:15]
    s_add_u32 s48, s47, 32768
    ds_read_b128 v[44:47], v1 offset:16384
    buffer_load_dwordx4 v1, s[16:19], s42 offen offset:2048 sc1 lds
    v_mfma_f32_16x16x32_bf16 v[20:23], a[48:51], v[64:67], v[20:23]
    v_add_f32 v140, v140, v141
    v_mov_b32 v142, v140
    v_mfma_f32_16x16x32_bf16 v[24:27], a[52:55], v[64:67], v[24:27]
    ds_read_b128 v[48:51], v1 offset:17408
    buffer_load_dwordx4 v1, s[16:19], s42 offen offset:3072 sc1 lds
    v_mfma_f32_16x16x32_bf16 v[16:19], a[52:55], v[60:63], v[16:19]
    s_waitcnt lgkmcnt(2)
    v_permlane32_swap_b32 v140, v142
    v_mfma_f32_16x16x32_bf16 v[12:15], a[56:59], v[68:71], v[12:15]
    s_add_u32 s98, s98, 65536
    ds_read_b128 v[52:55], v1 offset:18432
    v_add_f32 v140, v140, v142
    v_mfma_f32_16x16x32_bf16 v[20:23], a[56:59], v[72:75], v[20:23]
    s_min_u32 s98, s98, s96
    ds_write_b32 v6, v140 offset:1024
    v_mfma_f32_16x16x32_bf16 v[24:27], a[60:63], v[72:75], v[24:27]
    s_and_b32 s41, s98, 0xffffffff
    ds_read_b128 v[56:59], v1 offset:19456
    buffer_load_dword v136, v4, s[16:19], s45 offen sc1
    v_mfma_f32_16x16x32_bf16 v[16:19], a[60:63], v[68:71], v[16:19]
    s_waitcnt lgkmcnt(3)
    v_add_f32 v144, v36, v37
    v_mul_f32 v145, v36, v36
    v_mfma_f32_16x16x32_bf16 v[12:15], a[64:67], v[44:47], v[12:15]
    s_add_u32 m0, s43, 98304
    ds_read_b128 v[60:63], v1 offset:20480
    v_fmac_f32 v145, v37, v37
    v_mfma_f32_16x16x32_bf16 v[20:23], a[64:67], v[48:51], v[20:23]
    s_add_u32 s42, s41, 0
    v_add_f32 v144, v144, v38
    v_fmac_f32 v145, v38, v38
    v_mfma_f32_16x16x32_bf16 v[24:27], a[68:71], v[48:51], v[24:27]
    ds_read_b128 v[64:67], v1 offset:21504
    v_add_f32 v144, v144, v39
    v_mfma_f32_16x16x32_bf16 v[16:19], a[68:71], v[44:47], v[16:19]
    s_waitcnt lgkmcnt(2)
    v_fmac_f32 v145, v39, v39
    v_add_f32 v144, v144, v40
    v_mfma_f32_16x16x32_bf16 v[12:15], a[72:75], v[52:55], v[12:15]
    ds_read_b128 v[68:71], v1 offset:22528
    v_fmac_f32 v145, v40, v40
    v_mfma_f32_16x16x32_bf16 v[20:23], a[72:75], v[56:59], v[20:23]
    v_add_f32 v144, v144, v41
    v_fmac_f32 v145, v41, v41
    v_mfma_f32_16x16x32_bf16 v[24:27], a[76:79], v[56:59], v[24:27]
    ds_read_b128 v[72:75], v1 offset:23552
    v_add_f32 v144, v144, v42
    v_mfma_f32_16x16x32_bf16 v[16:19], a[76:79], v[52:55], v[16:19]
    s_waitcnt lgkmcnt(2)
    v_fmac_f32 v145, v42, v42
    v_add_f32 v144, v144, v43
    v_mfma_f32_16x16x32_bf16 v[12:15], a[80:83], v[60:63], v[12:15]
    ds_read_b128 v[44:47], v1 offset:24576
    v_fmac_f32 v145, v43, v43
    v_mfma_f32_16x16x32_bf16 v[20:23], a[80:83], v[64:67], v[20:23]
    v_permlane16_swap_b32 v144, v145
    v_mfma_f32_16x16x32_bf16 v[24:27], a[84:87], v[64:67], v[24:27]
    ds_read_b128 v[48:51], v1 offset:25600
    v_add_f32 v144, v144, v145
    v_mfma_f32_16x16x32_bf16 v[16:19], a[84:87], v[60:63], v[16:19]
    s_waitcnt lgkmcnt(2)
    v_mov_b32 v146, v144
    buffer_load_dwordx4 v[128:131], v3, s[8:11], s48 offen sc1
    v_mfma_f32_16x16x32_bf16 v[12:15], a[88:91], v[68:71], v[12:15]
    ds_read_b128 v[52:55], v1 offset:26624
    v_permlane32_swap_b32 v144, v146
    v_mfma_f32_16x16x32_bf16 v[20:23], a[88:91], v[72:75], v[20:23]
    v_add_f32 v144, v144, v146
    ds_write_b32 v6, v144 offset:1536
    v_mfma_f32_16x16x32_bf16 v[24:27], a[92:95], v[72:75], v[24:27]
    ds_read_b128 v[56:59], v1 offset:27648
    buffer_load_dwordx4 v[132:135], v3, s[8:11], s47 offen sc1
    v_mfma_f32_16x16x32_bf16 v[16:19], a[92:95], v[68:71], v[16:19]
    s_waitcnt lgkmcnt(3)
    v_mfma_f32_16x16x32_bf16 v[12:15], a[96:99], v[44:47], v[12:15]
    ds_read_b128 v[60:63], v1 offset:28672
    v_mfma_f32_16x16x32_bf16 v[20:23], a[96:99], v[48:51], v[20:23]
    v_mfma_f32_16x16x32_bf16 v[24:27], a[100:103], v[48:51], v[24:27]
    ds_read_b128 v[64:67], v1 offset:29696
    v_mfma_f32_16x16x32_bf16 v[16:19], a[100:103], v[44:47], v[16:19]
    s_waitcnt lgkmcnt(2)
    v_mfma_f32_16x16x32_bf16 v[12:15], a[104:107], v[52:55], v[12:15]
    ds_read_b128 v[68:71], v1 offset:30720
    v_mfma_f32_16x16x32_bf16 v[20:23], a[104:107], v[56:59], v[20:23]
    v_mfma_f32_16x16x32_bf16 v[24:27], a[108:111], v[56:59], v[24:27]
    ds_read_b128 v[72:75], v1 offset:31744
    v_mfma_f32_16x16x32_bf16 v[16:19], a[108:111], v[52:55], v[16:19]
    s_waitcnt vmcnt(7) lgkmcnt(2)
    s_barrier
    v_mfma_f32_16x16x32_bf16 v[12:15], a[112:115], v[60:63], v[12:15]
    ds_read_b128 v[44:47], v1 offset:32768
    ds_read_b128 v[140:143], v7 offset:1024
    v_mfma_f32_16x16x32_bf16 v[20:23], a[112:115], v[64:67], v[20:23]
    v_mfma_f32_16x16x32_bf16 v[24:27], a[116:119], v[64:67], v[24:27]
    ds_read_b128 v[48:51], v1 offset:33792
    v_mfma_f32_16x16x32_bf16 v[16:19], a[116:119], v[60:63], v[16:19]
    s_waitcnt lgkmcnt(3)
    v_mfma_f32_16x16x32_bf16 v[12:15], a[120:123], v[68:71], v[12:15]
    s_waitcnt lgkmcnt(1)
    ds_read_b128 v[52:55], v1 offset:34816
    v_add_f32 v140, v140, v141
    v_mfma_f32_16x16x32_bf16 v[20:23], a[120:123], v[72:75], v[20:23]
    v_add_f32 v142, v142, v143
    v_add_f32 v140, v140, v142
    v_mfma_f32_16x16x32_bf16 v[24:27], a[124:127], v[72:75], v[24:27]
    ds_read_b128 v[56:59], v1 offset:35840
    v_min_u32 v140, -2, v140
    v_mfma_f32_16x16x32_bf16 v[16:19], a[124:127], v[68:71], v[16:19]
    s_waitcnt lgkmcnt(2)
    buffer_store_dword v140, v8, s[16:19], s49 offen sc1
    v_mfma_f32_16x16x32_bf16 v[12:15], a[128:131], v[44:47], v[12:15]
    s_add_u32 s90, s90, 65536
    ds_read_b128 v[60:63], v1 offset:36864
    s_add_u32 s46, s46, 2048
    v_mfma_f32_16x16x32_bf16 v[20:23], a[128:131], v[48:51], v[20:23]
    v_mfma_f32_16x16x32_bf16 v[24:27], a[132:135], v[48:51], v[24:27]
    ds_read_b128 v[64:67], v1 offset:37888
    v_mfma_f32_16x16x32_bf16 v[16:19], a[132:135], v[44:47], v[16:19]
    s_waitcnt lgkmcnt(2)
    v_mfma_f32_16x16x32_bf16 v[12:15], a[136:139], v[52:55], v[12:15]
    ds_read_b128 v[68:71], v1 offset:38912
    v_mfma_f32_16x16x32_bf16 v[20:23], a[136:139], v[56:59], v[20:23]
    v_mfma_f32_16x16x32_bf16 v[24:27], a[140:143], v[56:59], v[24:27]
    ds_read_b128 v[72:75], v1 offset:39936
    v_mfma_f32_16x16x32_bf16 v[16:19], a[140:143], v[52:55], v[16:19]
    s_waitcnt lgkmcnt(2)
    v_mfma_f32_16x16x32_bf16 v[12:15], a[144:147], v[60:63], v[12:15]
    ds_read_b128 v[44:47], v1 offset:40960
    v_mfma_f32_16x16x32_bf16 v[20:23], a[144:147], v[64:67], v[20:23]
    v_mfma_f32_16x16x32_bf16 v[24:27], a[148:151], v[64:67], v[24:27]
    s_waitcnt vmcnt(3)
    ds_read_b128 v[48:51], v1 offset:41984
    s_barrier
    v_mfma_f32_16x16x32_bf16 v[16:19], a[148:151], v[60:63], v[16:19]
    s_waitcnt lgkmcnt(2)
    buffer_store_dword v124, v124, s[16:19], s91 offen sc1
    v_mfma_f32_16x16x32_bf16 v[12:15], a[152:155], v[68:71], v[12:15]
    s_add_u32 s91, s91, 131072
    ds_read_b128 v[52:55], v1 offset:43008
    v_cmp_ne_u32 vcc, 0, v136
    v_mfma_f32_16x16x32_bf16 v[20:23], a[152:155], v[72:75], v[20:23]
    v_mfma_f32_16x16x32_bf16 v[24:27], a[156:159], v[72:75], v[24:27]
    s_cbranch_vccnz L_spin26
L_back27:
    ds_read_b128 v[56:59], v1 offset:44032
    s_barrier
    v_mfma_f32_16x16x32_bf16 v[16:19], a[156:159], v[68:71], v[16:19]
    s_waitcnt lgkmcnt(2)
    buffer_load_dwordx4 v1, s[16:19], s42 offen offset:0 sc1 lds
    v_mfma_f32_16x16x32_bf16 v[12:15], a[160:163], v[44:47], v[12:15]
    ds_read_b128 v[60:63], v1 offset:45056
    buffer_load_dwordx4 v1, s[16:19], s42 offen offset:1024 sc1 lds
    v_mfma_f32_16x16x32_bf16 v[20:23], a[160:163], v[48:51], v[20:23]
    buffer_load_dwordx4 v1, s[16:19], s42 offen offset:2048 sc1 lds
    v_mfma_f32_16x16x32_bf16 v[24:27], a[164:167], v[48:51], v[24:27]
    ds_read_b128 v[64:67], v1 offset:46080
    buffer_load_dwordx4 v1, s[16:19], s42 offen offset:3072 sc1 lds
    v_mfma_f32_16x16x32_bf16 v[16:19], a[164:167], v[44:47], v[16:19]
    s_waitcnt lgkmcnt(2)
    s_add_u32 m0, s43, 114688
    s_add_u32 s42, s41, 16384
    v_mfma_f32_16x16x32_bf16 v[12:15], a[168:171], v[52:55], v[12:15]
    ds_read_b128 v[68:71], v1 offset:47104
    v_mfma_f32_16x16x32_bf16 v[20:23], a[168:171], v[56:59], v[20:23]
    v_mfma_f32_16x16x32_bf16 v[24:27], a[172:175], v[56:59], v[24:27]
    ds_read_b128 v[72:75], v1 offset:48128
    buffer_load_dwordx4 v1, s[16:19], s42 offen offset:0 sc1 lds
    v_mfma_f32_16x16x32_bf16 v[16:19], a[172:175], v[52:55], v[16:19]
    s_waitcnt lgkmcnt(2)
    v_mfma_f32_16x16x32_bf16 v[12:15], a[176:179], v[60:63], v[12:15]
    ds_read_b128 v[44:47], v1 offset:49152
    v_mfma_f32_16x16x32_bf16 v[20:23], a[176:179], v[64:67], v[20:23]
    v_mfma_f32_16x16x32_bf16 v[24:27], a[180:183], v[64:67], v[24:27]
    ds_read_b128 v[48:51], v1 offset:50176
    buffer_load_dwordx4 v1, s[16:19], s42 offen offset:1024 sc1 lds
    v_mfma_f32_16x16x32_bf16 v[16:19], a[180:183], v[60:63], v[16:19]
    s_waitcnt lgkmcnt(2)
    v_mfma_f32_16x16x32_bf16 v[12:15], a[184:187], v[68:71], v[12:15]
    ds_read_b128 v[52:55], v1 offset:51200
    v_mfma_f32_16x16x32_bf16 v[20:23], a[184:187], v[72:75], v[20:23]
    v_mfma_f32_16x16x32_bf16 v[24:27], a[188:191], v[72:75], v[24:27]
    ds_read_b128 v[56:59], v1 offset:52224
    buffer_load_dwordx4 v1, s[16:19], s42 offen offset:2048 sc1 lds
    v_mfma_f32_16x16x32_bf16 v[16:19], a[188:191], v[68:71], v[16:19]
    s_waitcnt lgkmcnt(2)
    v_mfma_f32_16x16x32_bf16 v[12:15], a[192:195], v[44:47], v[12:15]
    ds_read_b128 v[60:63], v1 offset:53248
    v_mfma_f32_16x16x32_bf16 v[20:23], a[192:195], v[48:51], v[20:23]
    v_mfma_f32_16x16x32_bf16 v[24:27], a[196:199], v[48:51], v[24:27]
    ds_read_b128 v[64:67], v1 offset:54272
    buffer_load_dwordx4 v1, s[16:19], s42 offen offset:3072 sc1 lds
    v_mfma_f32_16x16x32_bf16 v[16:19], a[196:199], v[44:47], v[16:19]
    s_waitcnt lgkmcnt(2)
    s_add_u32 s45, s45, 131072
    v_mfma_f32_16x16x32_bf16 v[12:15], a[200:203], v[52:55], v[12:15]
    ds_read_b128 v[68:71], v1 offset:55296
    v_mfma_f32_16x16x32_bf16 v[20:23], a[200:203], v[56:59], v[20:23]
    v_mfma_f32_16x16x32_bf16 v[24:27], a[204:207], v[56:59], v[24:27]
    ds_read_b128 v[72:75], v1 offset:56320
    v_mfma_f32_16x16x32_bf16 v[16:19], a[204:207], v[52:55], v[16:19]
    s_waitcnt lgkmcnt(2)
    v_mfma_f32_16x16x32_bf16 v[12:15], a[208:211], v[60:63], v[12:15]
    ds_read_b128 v[44:47], v1 offset:57344
    v_mfma_f32_16x16x32_bf16 v[20:23], a[208:211], v[64:67], v[20:23]
    v_mfma_f32_16x16x32_bf16 v[24:27], a[212:215], v[64:67], v[24:27]
    ds_read_b128 v[48:51], v1 offset:58368
    v_mfma_f32_16x16x32_bf16 v[16:19], a[212:215], v[60:63], v[16:19]
    s_waitcnt lgkmcnt(2)
    v_mfma_f32_16x16x32_bf16 v[12:15], a[216:219], v[68:71], v[12:15]
    ds_read_b128 v[52:55], v1 offset:59392
    v_mfma_f32_16x16x32_bf16 v[20:23], a[216:219], v[72:75], v[20:23]
    v_mfma_f32_16x16x32_bf16 v[24:27], a[220:223], v[72:75], v[24:27]
    s_waitcnt vmcnt(10)
    ds_read_b128 v[56:59], v1 offset:60416
    v_mfma_f32_16x16x32_bf16 v[28:31], v[108:111], v[128:131], 0
    v_mfma_f32_16x16x32_bf16 v[32:35], v[112:115], v[128:131], 0
    v_mfma_f32_16x16x32_bf16 v[36:39], v[108:111], v[132:135], 0
    v_mfma_f32_16x16x32_bf16 v[40:43], v[112:115], v[132:135], 0
    v_mfma_f32_16x16x32_bf16 v[16:19], a[220:223], v[68:71], v[16:19]
    s_waitcnt lgkmcnt(2)
    v_mfma_f32_16x16x32_bf16 v[12:15], a[224:227], v[44:47], v[12:15]
    ds_read_b128 v[60:63], v1 offset:61440
    v_mfma_f32_16x16x32_bf16 v[20:23], a[224:227], v[48:51], v[20:23]
    v_mfma_f32_16x16x32_bf16 v[24:27], a[228:231], v[48:51], v[24:27]
    ds_read_b128 v[64:67], v1 offset:62464
    v_mfma_f32_16x16x32_bf16 v[16:19], a[228:231], v[44:47], v[16:19]
    s_waitcnt lgkmcnt(2)
    v_mfma_f32_16x16x32_bf16 v[12:15], a[232:235], v[52:55], v[12:15]
    ds_read_b128 v[68:71], v1 offset:63488
    v_mfma_f32_16x16x32_bf16 v[20:23], a[232:235], v[56:59], v[20:23]
    v_mfma_f32_16x16x32_bf16 v[24:27], a[236:239], v[56:59], v[24:27]
    ds_read_b128 v[72:75], v1 offset:64512
    v_mfma_f32_16x16x32_bf16 v[16:19], a[236:239], v[52:55], v[16:19]
    s_waitcnt vmcnt(4) lgkmcnt(2)
    s_barrier
    v_mfma_f32_16x16x32_bf16 v[12:15], a[240:243], v[60:63], v[12:15]
    ds_read_b128 v[44:47], v2 offset:0
    v_mfma_f32_16x16x32_bf16 v[20:23], a[240:243], v[64:67], v[20:23]
    v_mfma_f32_16x16x32_bf16 v[24:27], a[244:247], v[64:67], v[24:27]
    ds_read_b128 v[48:51], v2 offset:1024
    v_mfma_f32_16x16x32_bf16 v[16:19], a[244:247], v[60:63], v[16:19]
    s_waitcnt lgkmcnt(2)
    v_mfma_f32_16x16x32_bf16 v[12:15], a[248:251], v[68:71], v[12:15]
    ds_read_b128 v[52:55], v2 offset:2048
    v_mfma_f32_16x16x32_bf16 v[20:23], a[248:251], v[72:75], v[20:23]
    v_mfma_f32_16x16x32_bf16 v[24:27], a[252:255], v[72:75], v[24:27]
    ds_read_b128 v[56:59], v2 offset:3072
    v_mfma_f32_16x16x32_bf16 v[16:19], a[252:255], v[68:71], v[16:19]
    s_add_u32 s36, s36, 1
L_o_b1:
    s_waitcnt lgkmcnt(2)
    v_mfma_f32_16x16x32_bf16 v[28:31], a[0:3], v[44:47], v[28:31]
    s_and_b32 s44, s90, 0xffffffff
    ds_read_b128 v[60:63], v2 offset:4096
    s_cmp_eq_u32 s36, 0
    v_mfma_f32_16x16x32_bf16 v[36:39], a[0:3], v[48:51], v[36:39]
    s_cselect_b32 s44, 0x5e00000, s44
    s_cselect_b32 s49, 0x5e00000, s46
    v_cvt_pk_bf16_f32 v148, v12, v13
    v_mfma_f32_16x16x32_bf16 v[40:43], a[4:7], v[48:51], v[40:43]
    s_add_u32 m0, s43, 131072
    ds_read_b128 v[64:67], v2 offset:5120
    v_cvt_pk_bf16_f32 v149, v14, v15
    v_mfma_f32_16x16x32_bf16 v[32:35], a[4:7], v[44:47], v[32:35]
    s_waitcnt lgkmcnt(2)
    v_cvt_pk_bf16_f32 v150, v16, v17
    v_cvt_pk_bf16_f32 v151, v18, v19
    v_mfma_f32_16x16x32_bf16 v[28:31], a[8:11], v[52:55], v[28:31]
    s_add_u32 s42, s41, 32768
    ds_read_b128 v[68:71], v2 offset:6144
    buffer_store_dwordx4 v[148:151], v1, s[16:19], s44 offen offset:0 sc1
    v_mfma_f32_16x16x32_bf16 v[36:39], a[8:11], v[56:59], v[36:39]
    v_cvt_pk_bf16_f32 v152, v20, v21
    v_cvt_pk_bf16_f32 v153, v22, v23
    v_mfma_f32_16x16x32_bf16 v[40:43], a[12:15], v[56:59], v[40:43]
    ds_read_b128 v[72:75], v2 offset:7168
    v_cvt_pk_bf16_f32 v154, v24, v25
    v_mfma_f32_16x16x32_bf16 v[32:35], a[12:15], v[52:55], v[32:35]
    s_waitcnt lgkmcnt(2)
    v_cvt_pk_bf16_f32 v155, v26, v27
    buffer_store_dwordx4 v[152:155], v1, s[16:19], s44 offen offset:1024 sc1
    v_mfma_f32_16x16x32_bf16 v[28:31], a[16:19], v[60:63], v[28:31]
    ds_read_b128 v[44:47], v2 offset:8192
    buffer_load_dwordx4 v1, s[16:19], s42 offen offset:0 sc1 lds
    v_mfma_f32_16x16x32_bf16 v[36:39], a[16:19], v[64:67], v[36:39]
    v_add_f32 v140, v12, v13
    v_mul_f32 v141, v12, v12
    v_mfma_f32_16x16x32_bf16 v[40:43], a[20:23], v[64:67], v[40:43]
    ds_read_b128 v[48:51], v2 offset:9216
    buffer_load_dwordx4 v1, s[16:19], s42 offen offset:1024 sc1 lds
    v_mfma_f32_16x16x32_bf16 v[32:35], a[20:23], v[60:63], v[32:35]
    s_waitcnt lgkmcnt(2)
    v_fmac_f32 v141, v13, v13
    v_add_f32 v140, v140, v14
    v_mfma_f32_16x16x32_bf16 v[28:31], a[24:27], v[68:71], v[28:31]
    s_add_u32 s47, s36, 1
    ds_read_b128 v[52:55], v2 offset:10240
    buffer_load_dwordx4 v1, s[16:19], s42 offen offset:2048 sc1 lds
    v_mfma_f32_16x16x32_bf16 v[36:39], a[24:27], v[72:75], v[36:39]
    s_min_u32 s47, s47, 31
    v_fmac_f32 v141, v14, v14
    v_add_f32 v140, v140, v15
    v_mfma_f32_16x16x32_bf16 v[40:43], a[28:31], v[72:75], v[40:43]
    s_cmp_ge_u32 s47, 16
    ds_read_b128 v[56:59], v2 offset:11264
    buffer_load_dwordx4 v1, s[16:19], s42 offen offset:3072 sc1 lds
    v_mfma_f32_16x16x32_bf16 v[32:35], a[28:31], v[68:71], v[32:35]
    s_waitcnt lgkmcnt(2)
    v_fmac_f32 v141, v15, v15
    v_add_f32 v140, v140, v16
    v_mfma_f32_16x16x32_bf16 v[28:31], a[32:35], v[44:47], v[28:31]
    s_cselect_b32 s8, s88, s64
    ds_read_b128 v[60:63], v2 offset:12288
    v_fmac_f32 v141, v16, v16
    v_mfma_f32_16x16x32_bf16 v[36:39], a[32:35], v[48:51], v[36:39]
    s_cselect_b32 s9, s89, s65
    v_add_f32 v140, v140, v17
    v_fmac_f32 v141, v17, v17
    v_mfma_f32_16x16x32_bf16 v[40:43], a[36:39], v[48:51], v[40:43]
    s_add_u32 m0, s43, 147456
    ds_read_b128 v[64:67], v2 offset:13312
    v_add_f32 v140, v140, v18
    v_mfma_f32_16x16x32_bf16 v[32:35], a[36:39], v[44:47], v[32:35]
    s_waitcnt lgkmcnt(2)
    v_fmac_f32 v141, v18, v18
    v_add_f32 v140, v140, v19
    v_mfma_f32_16x16x32_bf16 v[28:31], a[40:43], v[52:55], v[28:31]
    s_add_u32 s42, s41, 49152
    ds_read_b128 v[68:71], v2 offset:14336
    buffer_load_dwordx4 v1, s[16:19], s42 offen offset:0 sc1 lds
    v_mfma_f32_16x16x32_bf16 v[36:39], a[40:43], v[56:59], v[36:39]
    s_and_b32 s47, s47, 15
    v_fmac_f32 v141, v19, v19
    s_lshl_b32 s47, s47, 16
    v_mfma_f32_16x16x32_bf16 v[40:43], a[44:47], v[56:59], v[40:43]
    s_sub_u32 s47, s50, s47
    ds_read_b128 v[72:75], v2 offset:15360
    buffer_load_dwordx4 v1, s[16:19], s42 offen offset:1024 sc1 lds
    v_mfma_f32_16x16x32_bf16 v[32:35], a[44:47], v[52:55], v[32:35]
    s_waitcnt vmcnt(8) lgkmcnt(2)
    s_barrier
    v_permlane16_swap_b32 v140, v141
    v_mfma_f32_16x16x32_bf16 v[28:31], a[48:51], v[60:63], v[28:31]
    s_add_u32 s48, s47, 32768
    ds_read_b128 v[44:47], v2 offset:16384
    buffer_load_dwordx4 v1, s[16:19], s42 offen offset:2048 sc1 lds
    v_mfma_f32_16x16x32_bf16 v[36:39], a[48:51], v[64:67], v[36:39]
    v_add_f32 v140, v140, v141
    v_mov_b32 v142, v140
    v_mfma_f32_16x16x32_bf16 v[40:43], a[52:55], v[64:67], v[40:43]
    ds_read_b128 v[48:51], v2 offset:17408
    buffer_load_dwordx4 v1, s[16:19], s42 offen offset:3072 sc1 lds
    v_mfma_f32_16x16x32_bf16 v[32:35], a[52:55], v[60:63], v[32:35]
    s_waitcnt lgkmcnt(2)
    v_permlane32_swap_b32 v140, v142
    v_mfma_f32_16x16x32_bf16 v[28:31], a[56:59], v[68:71], v[28:31]
    s_add_u32 s98, s98, 65536
    ds_read_b128 v[52:55], v2 offset:18432
    v_add_f32 v140, v140, v142
    v_mfma_f32_16x16x32_bf16 v[36:39], a[56:59], v[72:75], v[36:39]
    s_min_u32 s98, s98, s96
    ds_write_b32 v6, v140 offset:0
    v_mfma_f32_16x16x32_bf16 v[40:43], a[60:63], v[72:75], v[40:43]
    s_and_b32 s41, s98, 0xffffffff
    ds_read_b128 v[56:59], v2 offset:19456
    buffer_load_dword v136, v4, s[16:19], s45 offen sc1
    v_mfma_f32_16x16x32_bf16 v[32:35], a[60:63], v[68:71], v[32:35]
    s_waitcnt lgkmcnt(3)
    v_add_f32 v144, v20, v21
    v_mul_f32 v145, v20, v20
    v_mfma_f32_16x16x32_bf16 v[28:31], a[64:67], v[44:47], v[28:31]
    s_add_u32 m0, s43, 0
    ds_read_b128 v[60:63], v2 offset:20480
    v_fmac_f32 v145, v21, v21
    v_mfma_f32_16x16x32_bf16 v[36:39], a[64:67], v[48:51], v[36:39]
    s_add_u32 s42, s41, 0
    v_add_f32 v144, v144, v22
    v_fmac_f32 v145, v22, v22
    v_mfma_f32_16x16x32_bf16 v[40:43], a[68:71], v[48:51], v[40:43]
    ds_read_b128 v[64:67], v2 offset:21504
    v_add_f32 v144, v144, v23
    v_mfma_f32_16x16x32_bf16 v[32:35], a[68:71], v[44:47], v[32:35]
    s_waitcnt lgkmcnt(2)
    v_fmac_f32 v145, v23, v23
    v_add_f32 v144, v144, v24
    v_mfma_f32_16x16x32_bf16 v[28:31], a[72:75], v[52:55], v[28:31]
    ds_read_b128 v[68:71], v2 offset:22528
    v_fmac_f32 v145, v24, v24
    v_mfma_f32_16x16x32_bf16 v[36:39], a[72:75], v[56:59], v[36:39]
    v_add_f32 v144, v144, v25
    v_fmac_f32 v145, v25, v25
    v_mfma_f32_16x16x32_bf16 v[40:43], a[76:79], v[56:59], v[40:43]
    ds_read_b128 v[72:75], v2 offset:23552
    v_add_f32 v144, v144, v26
    v_mfma_f32_16x16x32_bf16 v[32:35], a[76:79], v[52:55], v[32:35]
    s_waitcnt lgkmcnt(2)
    v_fmac_f32 v145, v26, v26
    v_add_f32 v144, v144, v27
    v_mfma_f32_16x16x32_bf16 v[28:31], a[80:83], v[60:63], v[28:31]
    ds_read_b128 v[44:47], v2 offset:24576
    v_fmac_f32 v145, v27, v27
    v_mfma_f32_16x16x32_bf16 v[36:39], a[80:83], v[64:67], v[36:39]
    v_permlane16_swap_b32 v144, v145
    v_mfma_f32_16x16x32_bf16 v[40:43], a[84:87], v[64:67], v[40:43]
    ds_read_b128 v[48:51], v2 offset:25600
    v_add_f32 v144, v144, v145
    v_mfma_f32_16x16x32_bf16 v[32:35], a[84:87], v[60:63], v[32:35]
    s_waitcnt lgkmcnt(2)
    v_mov_b32 v146, v144
    buffer_load_dwordx4 v[128:131], v3, s[8:11], s48 offen sc1
    v_mfma_f32_16x16x32_bf16 v[28:31], a[88:91], v[68:71], v[28:31]
    ds_read_b128 v[52:55], v2 offset:26624
    v_permlane32_swap_b32 v144, v146
    v_mfma_f32_16x16x32_bf16 v[36:39], a[88:91], v[72:75], v[36:39]
    v_add_f32 v144, v144, v146
    ds_write_b32 v6, v144 offset:512
    v_mfma_f32_16x16x32_bf16 v[40:43], a[92:95], v[72:75], v[40:43]
    ds_read_b128 v[56:59], v2 offset:27648
    buffer_load_dwordx4 v[132:135], v3, s[8:11], s47 offen sc1
    v_mfma_f32_16x16x32_bf16 v[32:35], a[92:95], v[68:71], v[32:35]
    s_waitcnt lgkmcnt(3)
    v_mfma_f32_16x16x32_bf16 v[28:31], a[96:99], v[44:47], v[28:31]
    ds_read_b128 v[60:63], v2 offset:28672
    v_mfma_f32_16x16x32_bf16 v[36:39], a[96:99], v[48:51], v[36:39]
    v_mfma_f32_16x16x32_bf16 v[40:43], a[100:103], v[48:51], v[40:43]
    ds_read_b128 v[64:67], v2 offset:29696
    v_mfma_f32_16x16x32_bf16 v[32:35], a[100:103], v[44:47], v[32:35]
    s_waitcnt lgkmcnt(2)
    v_mfma_f32_16x16x32_bf16 v[28:31], a[104:107], v[52:55], v[28:31]
    ds_read_b128 v[68:71], v2 offset:30720
    v_mfma_f32_16x16x32_bf16 v[36:39], a[104:107], v[56:59], v[36:39]
    v_mfma_f32_16x16x32_bf16 v[40:43], a[108:111], v[56:59], v[40:43]
    ds_read_b128 v[72:75], v2 offset:31744
    v_mfma_f32_16x16x32_bf16 v[32:35], a[108:111], v[52:55], v[32:35]
    s_waitcnt vmcnt(7) lgkmcnt(2)
    s_barrier
    v_mfma_f32_16x16x32_bf16 v[28:31], a[112:115], v[60:63], v[28:31]
    ds_read_b128 v[44:47], v2 offset:32768
    ds_read_b128 v[140:143], v7 offset:0
    v_mfma_f32_16x16x32_bf16 v[36:39], a[112:115], v[64:67], v[36:39]
    v_mfma_f32_16x16x32_bf16 v[40:43], a[116:119], v[64:67], v[40:43]
    ds_read_b128 v[48:51], v2 offset:33792
    v_mfma_f32_16x16x32_bf16 v[32:35], a[116:119], v[60:63], v[32:35]
    s_waitcnt lgkmcnt(3)
    v_mfma_f32_16x16x32_bf16 v[28:31], a[120:123], v[68:71], v[28:31]
    s_waitcnt lgkmcnt(1)
    ds_read_b128 v[52:55], v2 offset:34816
    v_add_f32 v140, v140, v141
    v_mfma_f32_16x16x32_bf16 v[36:39], a[120:123], v[72:75], v[36:39]
    v_add_f32 v142, v142, v143
    v_add_f32 v140, v140, v142
    v_mfma_f32_16x16x32_bf16 v[40:43], a[124:127], v[72:75], v[40:43]
    ds_read_b128 v[56:59], v2 offset:35840
    v_min_u32 v140, -2, v140
    v_mfma_f32_16x16x32_bf16 v[32:35], a[124:127], v[68:71], v[32:35]
    s_waitcnt lgkmcnt(2)
    buffer_store_dword v140, v8, s[16:19], s49 offen sc1
    v_mfma_f32_16x16x32_bf16 v[28:31], a[128:131], v[44:47], v[28:31]
    s_add_u32 s90, s90, 65536
    ds_read_b128 v[60:63], v2 offset:36864
    s_add_u32 s46, s46, 2048
    v_mfma_f32_16x16x32_bf16 v[36:39], a[128:131], v[48:51], v[36:39]
    v_mfma_f32_16x16x32_bf16 v[40:43], a[132:135], v[48:51], v[40:43]
    ds_read_b128 v[64:67], v2 offset:37888
    v_mfma_f32_16x16x32_bf16 v[32:35], a[132:135], v[44:47], v[32:35]
    s_waitcnt lgkmcnt(2)
    v_mfma_f32_16x16x32_bf16 v[28:31], a[136:139], v[52:55], v[28:31]
    ds_read_b128 v[68:71], v2 offset:38912
    v_mfma_f32_16x16x32_bf16 v[36:39], a[136:139], v[56:59], v[36:39]
    v_mfma_f32_16x16x32_bf16 v[40:43], a[140:143], v[56:59], v[40:43]
    ds_read_b128 v[72:75], v2 offset:39936
    v_mfma_f32_16x16x32_bf16 v[32:35], a[140:143], v[52:55], v[32:35]
    s_waitcnt lgkmcnt(2)
    v_mfma_f32_16x16x32_bf16 v[28:31], a[144:147], v[60:63], v[28:31]
    ds_read_b128 v[44:47], v2 offset:40960
    v_mfma_f32_16x16x32_bf16 v[36:39], a[144:147], v[64:67], v[36:39]
    v_mfma_f32_16x16x32_bf16 v[40:43], a[148:151], v[64:67], v[40:43]
    s_waitcnt vmcnt(3)
    ds_read_b128 v[48:51], v2 offset:41984
    s_barrier
    v_mfma_f32_16x16x32_bf16 v[32:35], a[148:151], v[60:63], v[32:35]
    s_waitcnt lgkmcnt(2)
    buffer_store_dword v124, v124, s[16:19], s91 offen sc1
    v_mfma_f32_16x16x32_bf16 v[28:31], a[152:155], v[68:71], v[28:31]
    s_add_u32 s91, s91, 131072
    ds_read_b128 v[52:55], v2 offset:43008
    v_cmp_ne_u32 vcc, 0, v136
    v_mfma_f32_16x16x32_bf16 v[36:39], a[152:155], v[72:75], v[36:39]
    v_mfma_f32_16x16x32_bf16 v[40:43], a[156:159], v[72:75], v[40:43]
    s_cbranch_vccnz L_spin28
L_back29:
    ds_read_b128 v[56:59], v2 offset:44032
    s_barrier
    v_mfma_f32_16x16x32_bf16 v[32:35], a[156:159], v[68:71], v[32:35]
    s_waitcnt lgkmcnt(2)
    buffer_load_dwordx4 v1, s[16:19], s42 offen offset:0 sc1 lds
    v_mfma_f32_16x16x32_bf16 v[28:31], a[160:163], v[44:47], v[28:31]
    ds_read_b128 v[60:63], v2 offset:45056
    buffer_load_dwordx4 v1, s[16:19], s42 offen offset:1024 sc1 lds
    v_mfma_f32_16x16x32_bf16 v[36:39], a[160:163], v[48:51], v[36:39]
    buffer_load_dwordx4 v1, s[16:19], s42 offen offset:2048 sc1 lds
    v_mfma_f32_16x16x32_bf16 v[40:43], a[164:167], v[48:51], v[40:43]
    ds_read_b128 v[64:67], v2 offset:46080
    buffer_load_dwordx4 v1, s[16:19], s42 offen offset:3072 sc1 lds
    v_mfma_f32_16x16x32_bf16 v[32:35], a[164:167], v[44:47], v[32:35]
    s_waitcnt lgkmcnt(2)
    s_add_u32 m0, s43, 16384
    s_add_u32 s42, s41, 16384
    v_mfma_f32_16x16x32_bf16 v[28:31], a[168:171], v[52:55], v[28:31]
    ds_read_b128 v[68:71], v2 offset:47104
    v_mfma_f32_16x16x32_bf16 v[36:39], a[168:171], v[56:59], v[36:39]
    v_mfma_f32_16x16x32_bf16 v[40:43], a[172:175], v[56:59], v[40:43]
    ds_read_b128 v[72:75], v2 offset:48128
    buffer_load_dwordx4 v1, s[16:19], s42 offen offset:0 sc1 lds
    v_mfma_f32_16x16x32_bf16 v[32:35], a[172:175], v[52:55], v[32:35]
    s_waitcnt lgkmcnt(2)
    v_mfma_f32_16x16x32_bf16 v[28:31], a[176:179], v[60:63], v[28:31]
    ds_read_b128 v[44:47], v2 offset:49152
    v_mfma_f32_16x16x32_bf16 v[36:39], a[176:179], v[64:67], v[36:39]
    v_mfma_f32_16x16x32_bf16 v[40:43], a[180:183], v[64:67], v[40:43]
    ds_read_b128 v[48:51], v2 offset:50176
    buffer_load_dwordx4 v1, s[16:19], s42 offen offset:1024 sc1 lds
    v_mfma_f32_16x16x32_bf16 v[32:35], a[180:183], v[60:63], v[32:35]
    s_waitcnt lgkmcnt(2)
    v_mfma_f32_16x16x32_bf16 v[28:31], a[184:187], v[68:71], v[28:31]
    ds_read_b128 v[52:55], v2 offset:51200
    v_mfma_f32_16x16x32_bf16 v[36:39], a[184:187], v[72:75], v[36:39]
    v_mfma_f32_16x16x32_bf16 v[40:43], a[188:191], v[72:75], v[40:43]
    ds_read_b128 v[56:59], v2 offset:52224
    buffer_load_dwordx4 v1, s[16:19], s42 offen offset:2048 sc1 lds
    v_mfma_f32_16x16x32_bf16 v[32:35], a[188:191], v[68:71], v[32:35]
    s_waitcnt lgkmcnt(2)
    v_mfma_f32_16x16x32_bf16 v[28:31], a[192:195], v[44:47], v[28:31]
    ds_read_b128 v[60:63], v2 offset:53248
    v_mfma_f32_16x16x32_bf16 v[36:39], a[192:195], v[48:51], v[36:39]
    v_mfma_f32_16x16x32_bf16 v[40:43], a[196:199], v[48:51], v[40:43]
    ds_read_b128 v[64:67], v2 offset:54272
    buffer_load_dwordx4 v1, s[16:19], s42 offen offset:3072 sc1 lds
    v_mfma_f32_16x16x32_bf16 v[32:35], a[196:199], v[44:47], v[32:35]
    s_waitcnt lgkmcnt(2)
    s_add_u32 s45, s45, 131072
    v_mfma_f32_16x16x32_bf16 v[28:31], a[200:203], v[52:55], v[28:31]
    ds_read_b128 v[68:71], v2 offset:55296
    v_mfma_f32_16x16x32_bf16 v[36:39], a[200:203], v[56:59], v[36:39]
    v_mfma_f32_16x16x32_bf16 v[40:43], a[204:207], v[56:59], v[40:43]
    ds_read_b128 v[72:75], v2 offset:56320
    v_mfma_f32_16x16x32_bf16 v[32:35], a[204:207], v[52:55], v[32:35]
    s_waitcnt lgkmcnt(2)
    v_mfma_f32_16x16x32_bf16 v[28:31], a[208:211], v[60:63], v[28:31]
    ds_read_b128 v[44:47], v2 offset:57344
    v_mfma_f32_16x16x32_bf16 v[36:39], a[208:211], v[64:67], v[36:39]
    v_mfma_f32_16x16x32_bf16 v[40:43], a[212:215], v[64:67], v[40:43]
    ds_read_b128 v[48:51], v2 offset:58368
    v_mfma_f32_16x16x32_bf16 v[32:35], a[212:215], v[60:63], v[32:35]
    s_waitcnt lgkmcnt(2)
    v_mfma_f32_16x16x32_bf16 v[28:31], a[216:219], v[68:71], v[28:31]
    ds_read_b128 v[52:55], v2 offset:59392
    v_mfma_f32_16x16x32_bf16 v[36:39], a[216:219], v[72:75], v[36:39]
    v_mfma_f32_16x16x32_bf16 v[40:43], a[220:223], v[72:75], v[40:43]
    s_waitcnt vmcnt(10)
    ds_read_b128 v[56:59], v2 offset:60416
    v_mfma_f32_16x16x32_bf16 v[12:15], v[108:111], v[128:131], 0
    v_mfma_f32_16x16x32_bf16 v[16:19], v[112:115], v[128:131], 0
    v_mfma_f32_16x16x32_bf16 v[20:23], v[108:111], v[132:135], 0
    v_mfma_f32_16x16x32_bf16 v[24:27], v[112:115], v[132:135], 0
    v_mfma_f32_16x16x32_bf16 v[32:35], a[220:223], v[68:71], v[32:35]
    s_waitcnt lgkmcnt(2)
    v_mfma_f32_16x16x32_bf16 v[28:31], a[224:227], v[44:47], v[28:31]
    ds_read_b128 v[60:63], v2 offset:61440
    v_mfma_f32_16x16x32_bf16 v[36:39], a[224:227], v[48:51], v[36:39]
    v_mfma_f32_16x16x32_bf16 v[40:43], a[228:231], v[48:51], v[40:43]
    ds_read_b128 v[64:67], v2 offset:62464
    v_mfma_f32_16x16x32_bf16 v[32:35], a[228:231], v[44:47], v[32:35]
    s_waitcnt lgkmcnt(2)
    v_mfma_f32_16x16x32_bf16 v[28:31], a[232:235], v[52:55], v[28:31]
    ds_read_b128 v[68:71], v2 offset:63488
    v_mfma_f32_16x16x32_bf16 v[36:39], a[232:235], v[56:59], v[36:39]
    v_mfma_f32_16x16x32_bf16 v[40:43], a[236:239], v[56:59], v[40:43]
    ds_read_b128 v[72:75], v2 offset:64512
    v_mfma_f32_16x16x32_bf16 v[32:35], a[236:239], v[52:55], v[32:35]
    s_waitcnt vmcnt(4) lgkmcnt(2)
    s_barrier
    v_mfma_f32_16x16x32_bf16 v[28:31], a[240:243], v[60:63], v[28:31]
    ds_read_b128 v[44:47], v1 offset:0
    v_mfma_f32_16x16x32_bf16 v[36:39], a[240:243], v[64:67], v[36:39]
    v_mfma_f32_16x16x32_bf16 v[40:43], a[244:247], v[64:67], v[40:43]
    ds_read_b128 v[48:51], v1 offset:1024
    v_mfma_f32_16x16x32_bf16 v[32:35], a[244:247], v[60:63], v[32:35]
    s_waitcnt lgkmcnt(2)
    v_mfma_f32_16x16x32_bf16 v[28:31], a[248:251], v[68:71], v[28:31]
    ds_read_b128 v[52:55], v1 offset:2048
    v_mfma_f32_16x16x32_bf16 v[36:39], a[248:251], v[72:75], v[36:39]
    v_mfma_f32_16x16x32_bf16 v[40:43], a[252:255], v[72:75], v[40:43]
    ds_read_b128 v[56:59], v1 offset:3072
    v_mfma_f32_16x16x32_bf16 v[32:35], a[252:255], v[68:71], v[32:35]
    s_add_u32 s36, s36, 1
    s_cmp_lt_u32 s36, 32
    s_cbranch_scc1 L_o_b0
    s_nop 7
    s_and_b32 s44, s90, 0xffffffff
    s_cmp_eq_u32 s36, 0
    s_cselect_b32 s44, 0x5e00000, s44
    s_cselect_b32 s49, 0x5e00000, s46
    v_cvt_pk_bf16_f32 v148, v28, v29
    v_cvt_pk_bf16_f32 v149, v30, v31
    v_cvt_pk_bf16_f32 v150, v32, v33
    v_cvt_pk_bf16_f32 v151, v34, v35
    buffer_store_dwordx4 v[148:151], v1, s[16:19], s44 offen offset:0 sc1
    v_cvt_pk_bf16_f32 v152, v36, v37
    v_cvt_pk_bf16_f32 v153, v38, v39
    v_cvt_pk_bf16_f32 v154, v40, v41
    v_cvt_pk_bf16_f32 v155, v42, v43
    buffer_store_dwordx4 v[152:155], v1, s[16:19], s44 offen offset:1024 sc1
    v_add_f32 v140, v28, v29
    v_mul_f32 v141, v28, v28
    v_fmac_f32 v141, v29, v29
    v_add_f32 v140, v140, v30
    v_fmac_f32 v141, v30, v30
    v_add_f32 v140, v140, v31
    v_fmac_f32 v141, v31, v31
    v_add_f32 v140, v140, v32
    v_fmac_f32 v141, v32, v32
    v_add_f32 v140, v140, v33
    v_fmac_f32 v141, v33, v33
    v_add_f32 v140, v140, v34
    v_fmac_f32 v141, v34, v34
    v_add_f32 v140, v140, v35
    v_fmac_f32 v141, v35, v35
    s_nop 1
    v_permlane16_swap_b32 v140, v141
    v_add_f32 v140, v140, v141
    v_mov_b32 v142, v140
    s_nop 1
    v_permlane32_swap_b32 v140, v142
    v_add_f32 v140, v140, v142
    ds_write_b32 v6, v140 offset:1024
    v_add_f32 v144, v36, v37
    v_mul_f32 v145, v36, v36
    v_fmac_f32 v145, v37, v37
    v_add_f32 v144, v144, v38
    v_fmac_f32 v145, v38, v38
    v_add_f32 v144, v144, v39
    v_fmac_f32 v145, v39, v39
    v_add_f32 v144, v144, v40
    v_fmac_f32 v145, v40, v40
    v_add_f32 v144, v144, v41
    v_fmac_f32 v145, v41, v41
    v_add_f32 v144, v144, v42
    v_fmac_f32 v145, v42, v42
    v_add_f32 v144, v144, v43
    v_fmac_f32 v145, v43, v43
    s_nop 1
    v_permlane16_swap_b32 v144, v145
    v_add_f32 v144, v144, v145
    v_mov_b32 v146, v144
    s_nop 1
    v_permlane32_swap_b32 v144, v146
    v_add_f32 v144, v144, v146
    ds_write_b32 v6, v144 offset:1536
    s_waitcnt lgkmcnt(0)
    s_barrier
    ds_read_b128 v[140:143], v7 offset:1024
    s_waitcnt lgkmcnt(0)
    v_add_f32 v140, v140, v141
    v_add_f32 v142, v142, v143
    v_add_f32 v140, v140, v142
    v_min_u32 v140, -2, v140
    buffer_store_dword v140, v8, s[16:19], s49 offen sc1
    s_add_u32 s90, s90, 65536
    s_add_u32 s46, s46, 2048
    s_waitcnt vmcnt(1)
    s_barrier
    buffer_store_dword v124, v124, s[16:19], s91 offen sc1
    s_add_u32 s91, s91, 131072
    s_waitcnt vmcnt(0)
    s_endpgm
L_spin22:
    s_mov_b32 s40, 0x20000
L_spin22_l:
    buffer_load_dword v12, v124, s[20:23], 0 offen sc1
    s_sub_u32 s40, s40, 1
    s_waitcnt vmcnt(0)
    v_cmp_eq_u32 vcc, v124, v12
    s_cbranch_scc1 L_back23
    s_cbranch_vccz L_back23
    s_sleep 8
    s_branch L_spin22_l
L_spin24:
    s_mov_b32 s40, 0x20000
L_spin24_l:
    buffer_load_dword v136, v4, s[16:19], s45 offen sc1
    s_sub_u32 s40, s40, 1
    s_waitcnt vmcnt(0)
    v_cmp_ne_u32 vcc, 0, v136
    s_cbranch_scc1 L_back25
    s_cbranch_vccz L_back25
    s_sleep 2
    s_branch L_spin24_l
L_spin26:
    s_mov_b32 s40, 0x20000
L_spin26_l:
    buffer_load_dword v136, v4, s[16:19], s45 offen sc1
    s_sub_u32 s40, s40, 1
    s_waitcnt vmcnt(0)
    v_cmp_ne_u32 vcc, 0, v136
    s_cbranch_scc1 L_back27
    s_cbranch_vccz L_back27
    s_sleep 2
    s_branch L_spin26_l
L_spin28:
    s_mov_b32 s40, 0x20000
L_spin28_l:
    buffer_load_dword v136, v4, s[16:19], s45 offen sc1
    s_sub_u32 s40, s40, 1
    s_waitcnt vmcnt(0)
    v_cmp_ne_u32 vcc, 0, v136
    s_cbranch_scc1 L_back29
    s_cbranch_vccz L_back29
    s_sleep 2
    s_branch L_spin28_l
L_role_40:
    s_sub_u32 s35, s34, 40
    s_lshl_b32 s51, s35, 2
    s_add_u32 s51, s51, 96
    s_lshl_b32 s54, s51, 6
    s_mov_b32 s12, s72
    s_mov_b32 s13, s73
    s_mov_b32 s14, 0x700000
    s_mov_b32 s15, 0x00020000
    s_mov_b32 s39, 7168
    v_lshrrev_b32 v64, 3, v0
    v_lshlrev_b32 v65, 2, v0
    v_and_b32 v65, 64, v65
    v_and_b32 v66, 0x70, v1
    v_xor_b32 v65, v65, v66
    v_mad_u32_u24 v56, v64, s39, v65
    v_add_u32 v57, 57344, v56
    v_add_u32 v58, 128, v56
    v_add_u32 v59, 57472, v56
    s_mul_i32 s38, s32, 114688
    s_add_u32 s54, s54, s38
    s_lshl_b32 s42, s32, 11
    s_add_u32 m0, s42, 0
    s_nop 0
    buffer_load_dwordx4 v56, s[12:15], s54 offen lds
    s_add_u32 m0, s42, 1024
    s_nop 0
    buffer_load_dwordx4 v57, s[12:15], s54 offen lds
    s_add_u32 m0, s42, 8192
    s_nop 0
    buffer_load_dwordx4 v58, s[12:15], s54 offen lds
    s_add_u32 m0, s42, 9216
    s_nop 0
    buffer_load_dwordx4 v59, s[12:15], s54 offen lds
    s_add_u32 s54, s54, 458752
    s_add_u32 m0, s42, 16384
    s_nop 0
    buffer_load_dwordx4 v56, s[12:15], s54 offen lds
    s_add_u32 m0, s42, 17408
    s_nop 0
    buffer_load_dwordx4 v57, s[12:15], s54 offen lds
    s_add_u32 m0, s42, 24576
    s_nop 0
    buffer_load_dwordx4 v58, s[12:15], s54 offen lds
    s_add_u32 m0, s42, 25600
    s_nop 0
    buffer_load_dwordx4 v59, s[12:15], s54 offen lds
    s_add_u32 s54, s54, 458752
    s_add_u32 m0, s42, 32768
    s_nop 0
    buffer_load_dwordx4 v56, s[12:15], s54 offen lds
    s_add_u32 m0, s42, 33792
    s_nop 0
    buffer_load_dwordx4 v57, s[12:15], s54 offen lds
    s_add_u32 m0, s42, 40960
    s_nop 0
    buffer_load_dwordx4 v58, s[12:15], s54 offen lds
    s_add_u32 m0, s42, 41984
    s_nop 0
    buffer_load_dwordx4 v59, s[12:15], s54 offen lds
    s_add_u32 s54, s54, 458752
    s_add_u32 m0, s42, 49152
    s_nop 0
    buffer_load_dwordx4 v56, s[12:15], s54 offen lds
    s_add_u32 m0, s42, 50176
    s_nop 0
    buffer_load_dwordx4 v57, s[12:15], s54 offen lds
    s_add_u32 m0, s42, 57344
    s_nop 0
    buffer_load_dwordx4 v58, s[12:15], s54 offen lds
    s_add_u32 m0, s42, 58368
    s_nop 0
    buffer_load_dwordx4 v59, s[12:15], s54 offen lds
    s_add_u32 s54, s54, 458752
    s_add_u32 m0, s42, 65536
    s_nop 0
    buffer_load_dwordx4 v56, s[12:15], s54 offen lds
    s_add_u32 m0, s42, 66560
    s_nop 0
    buffer_load_dwordx4 v57, s[12:15], s54 offen lds
    s_add_u32 m0, s42, 73728
    s_nop 0
    buffer_load_dwordx4 v58, s[12:15], s54 offen lds
    s_add_u32 m0, s42, 74752
    s_nop 0
    buffer_load_dwordx4 v59, s[12:15], s54 offen lds
    s_add_u32 s54, s54, 458752
    v_lshrrev_b32 v64, 4, v0
    v_bfe_u32 v65, v0, 2, 2
    v_lshl_add_u32 v64, v64, 3, v65
    v_lshlrev_b32 v64, 7, v64
    v_lshrrev_b32 v65, 1, v65
    v_lshl_add_u32 v64, v65, 6, v64
    v_and_b32 v65, 3, v0
    v_lshl_add_u32 v64, v65, 4, v64
    s_lshr_b32 s37, s32, 1
    s_lshl_b32 s37, s37, 13
    s_and_b32 s38, s32, 1
    s_lshl_b32 s38, s38, 6
    s_add_u32 s37, s37, s38
    s_add_u32 s37, s37, 0
    v_xor_b32 v60, s37, v64
    s_lshr_b32 s37, s32, 1
    s_lshl_b32 s37, s37, 13
    s_and_b32 s38, s32, 1
    s_lshl_b32 s38, s38, 6
    s_add_u32 s37, s37, s38
    s_add_u32 s37, s37, 8
    v_xor_b32 v61, s37, v64
    v_mov_b32 v64, 0x3f803f80
    v_mov_b32 v65, 0x3f803f80
    v_mov_b32 v66, 0x3f803f80
    v_mov_b32 v67, 0x3f803f80
    v_add_u32 v2, 98304, v1
    s_lshl_b32 s37, s33, 6
    s_add_u32 s37, s37, 16
    s_lshl_b32 s37, s37, 8
    v_lshl_add_u32 v5, v0, 8, s37
    s_cmp_eq_u32 s32, 0
    s_cselect_b32 s37, 8, 0
    v_cmp_le_u32 vcc, s37, v0
    s_nop 1
    v_cndmask_b32 v5, v5, 2.0, vcc
    s_lshl_b32 s43, s32, 12
    s_mul_i32 s41, s33, 2097152
    s_add_u32 s41, s41, 0x800000
    s_add_u32 s41, s41, s43
    s_mul_i32 s90, s33, 8388608
    s_add_u32 s90, s90, 0xfc0000
    s_add_u32 s37, s51, s32
    s_lshl_b32 s37, s37, 11
    s_add_u32 s90, s90, s37
    s_lshl_b32 s37, s32, 10
    s_sub_u32 s87, 8192, s37
    s_lshl_b32 s38, s35, 1
    s_lshr_b32 s39, s32, 1
    s_add_u32 s38, s38, s39
    s_cmp_eq_u32 s38, 36
    s_cselect_b32 s88, 0x5e00000, 0
    s_and_b32 s38, s32, 1
    s_lshl_b32 s38, s38, 3
    s_and_b32 s39, s32, 2
    s_lshl_b32 s39, s39, 10
    s_add_u32 s38, s38, s39
    s_add_u32 s38, s38, 65536
    v_add_u32 v3, s38, v1
    s_add_u32 s37, s37, 65536
    v_add_u32 v4, s37, v1
    v_and_b32 v6, 15, v0
    v_lshlrev_b32 v6, 3, v6
    v_lshrrev_b32 v8, 5, v0
    v_lshl_add_u32 v6, v8, 9, v6
    v_and_b32 v8, 16, v0
    v_lshl_add_u32 v6, v8, 6, v6
    v_add_u32 v118, 73728, v6
    s_mul_i32 s46, s33, 65536
    s_add_u32 s46, s46, 0x5440000
    s_add_u32 s55, s46, 63488
    s_and_b32 s52, s32, 1
    s_lshl_b32 s52, s52, 10
    s_mov_b32 s8, s74
    s_mov_b32 s9, s75
    s_mov_b32 s10, 0x1c00
    s_mov_b32 s11, 0x00020000
    v_and_b32 v8, 0x30, v0
    s_add_u32 s37, s51, s32
    s_lshl_b32 s37, s37, 6
    buffer_load_dwordx4 v[16:19], v8, s[8:11], s37 offen
    s_lshr_b32 s37, s32, 1
    s_add_u32 s37, s37, s51
    s_lshl_b32 s37, s37, 6
    s_and_b32 s38, s32, 1
    s_lshl_b32 s38, s38, 3
    s_add_u32 s37, s37, s38
    buffer_load_dwordx2 v[20:21], v8, s[8:11], s37 offen offset:256
    v_add_u32 v62, 0, v60
    v_add_u32 v63, 0, v61
    s_waitcnt vmcnt(18)
    s_barrier
    ds_read_b64_tr_b16 a[0:1], v62 offset:0
    ds_read_b64_tr_b16 a[2:3], v62 offset:512
    ds_read_b64_tr_b16 a[4:5], v63 offset:0
    ds_read_b64_tr_b16 a[6:7], v63 offset:512
    ds_read_b64_tr_b16 a[8:9], v62 offset:4096
    ds_read_b64_tr_b16 a[10:11], v62 offset:4608
    ds_read_b64_tr_b16 a[12:13], v63 offset:4096
    ds_read_b64_tr_b16 a[14:15], v63 offset:4608
    s_add_u32 m0, s42, 81920
    s_nop 0
    buffer_load_dwordx4 v56, s[12:15], s54 offen lds
    s_add_u32 m0, s42, 82944
    s_nop 0
    buffer_load_dwordx4 v57, s[12:15], s54 offen lds
    s_add_u32 m0, s42, 90112
    s_nop 0
    buffer_load_dwordx4 v58, s[12:15], s54 offen lds
    s_add_u32 m0, s42, 91136
    s_nop 0
    buffer_load_dwordx4 v59, s[12:15], s54 offen lds
    s_add_u32 s54, s54, 458752
    s_waitcnt lgkmcnt(0)
    v_mfma_f32_16x16x32_bf16 v[88:91], a[0:3], v[64:67], 0
    v_mfma_f32_16x16x32_bf16 v[92:95], a[4:7], v[64:67], 0
    v_mfma_f32_16x16x32_bf16 v[88:91], a[8:11], v[64:67], v[88:91]
    v_mfma_f32_16x16x32_bf16 v[92:95], a[12:15], v[64:67], v[92:95]
    v_add_u32 v62, 16384, v60
    v_add_u32 v63, 16384, v61
    s_waitcnt vmcnt(18)
    s_barrier
    ds_read_b64_tr_b16 a[16:17], v62 offset:0
    ds_read_b64_tr_b16 a[18:19], v62 offset:512
    ds_read_b64_tr_b16 a[20:21], v63 offset:0
    ds_read_b64_tr_b16 a[22:23], v63 offset:512
    ds_read_b64_tr_b16 a[24:25], v62 offset:4096
    ds_read_b64_tr_b16 a[26:27], v62 offset:4608
    ds_read_b64_tr_b16 a[28:29], v63 offset:4096
    ds_read_b64_tr_b16 a[30:31], v63 offset:4608
    s_add_u32 m0, s42, 0
    s_nop 0
    buffer_load_dwordx4 v56, s[12:15], s54 offen lds
    s_add_u32 m0, s42, 1024
    s_nop 0
    buffer_load_dwordx4 v57, s[12:15], s54 offen lds
    s_add_u32 m0, s42, 8192
    s_nop 0
    buffer_load_dwordx4 v58, s[12:15], s54 offen lds
    s_add_u32 m0, s42, 9216
    s_nop 0
    buffer_load_dwordx4 v59, s[12:15], s54 offen lds
    s_add_u32 s54, s54, 458752
    s_waitcnt lgkmcnt(0)
    v_mfma_f32_16x16x32_bf16 v[88:91], a[16:19], v[64:67], v[88:91]
    v_mfma_f32_16x16x32_bf16 v[92:95], a[20:23], v[64:67], v[92:95]
    v_mfma_f32_16x16x32_bf16 v[88:91], a[24:27], v[64:67], v[88:91]
    v_mfma_f32_16x16x32_bf16 v[92:95], a[28:31], v[64:67], v[92:95]
    v_add_u32 v62, 32768, v60
    v_add_u32 v63, 32768, v61
    s_waitcnt vmcnt(18)
    s_barrier
    ds_read_b64_tr_b16 a[32:33], v62 offset:0
    ds_read_b64_tr_b16 a[34:35], v62 offset:512
    ds_read_b64_tr_b16 a[36:37], v63 offset:0
    ds_read_b64_tr_b16 a[38:39], v63 offset:512
    ds_read_b64_tr_b16 a[40:41], v62 offset:4096
    ds_read_b64_tr_b16 a[42:43], v62 offset:4608
    ds_read_b64_tr_b16 a[44:45], v63 offset:4096
    ds_read_b64_tr_b16 a[46:47], v63 offset:4608
    s_add_u32 m0, s42, 16384
    s_nop 0
    buffer_load_dwordx4 v56, s[12:15], s54 offen lds
    s_add_u32 m0, s42, 17408
    s_nop 0
    buffer_load_dwordx4 v57, s[12:15], s54 offen lds
    s_add_u32 m0, s42, 24576
    s_nop 0
    buffer_load_dwordx4 v58, s[12:15], s54 offen lds
    s_add_u32 m0, s42, 25600
    s_nop 0
    buffer_load_dwordx4 v59, s[12:15], s54 offen lds
    s_add_u32 s54, s54, 458752
    s_waitcnt lgkmcnt(0)
    v_mfma_f32_16x16x32_bf16 v[88:91], a[32:35], v[64:67], v[88:91]
    v_mfma_f32_16x16x32_bf16 v[92:95], a[36:39], v[64:67], v[92:95]
    v_mfma_f32_16x16x32_bf16 v[88:91], a[40:43], v[64:67], v[88:91]
    v_mfma_f32_16x16x32_bf16 v[92:95], a[44:47], v[64:67], v[92:95]
    v_add_u32 v62, 49152, v60
    v_add_u32 v63, 49152, v61
    s_waitcnt vmcnt(18)
    s_barrier
    ds_read_b64_tr_b16 a[48:49], v62 offset:0
    ds_read_b64_tr_b16 a[50:51], v62 offset:512
    ds_read_b64_tr_b16 a[52:53], v63 offset:0
    ds_read_b64_tr_b16 a[54:55], v63 offset:512
    ds_read_b64_tr_b16 a[56:57], v62 offset:4096
    ds_read_b64_tr_b16 a[58:59], v62 offset:4608
    ds_read_b64_tr_b16 a[60:61], v63 offset:4096
    ds_read_b64_tr_b16 a[62:63], v63 offset:4608
    s_add_u32 m0, s42, 32768
    s_nop 0
    buffer_load_dwordx4 v56, s[12:15], s54 offen lds
    s_add_u32 m0, s42, 33792
    s_nop 0
    buffer_load_dwordx4 v57, s[12:15], s54 offen lds
    s_add_u32 m0, s42, 40960
    s_nop 0
    buffer_load_dwordx4 v58, s[12:15], s54 offen lds
    s_add_u32 m0, s42, 41984
    s_nop 0
    buffer_load_dwordx4 v59, s[12:15], s54 offen lds
    s_add_u32 s54, s54, 458752
    s_waitcnt lgkmcnt(0)
    v_mfma_f32_16x16x32_bf16 v[88:91], a[48:51], v[64:67], v[88:91]
    v_mfma_f32_16x16x32_bf16 v[92:95], a[52:55], v[64:67], v[92:95]
    v_mfma_f32_16x16x32_bf16 v[88:91], a[56:59], v[64:67], v[88:91]
    v_mfma_f32_16x16x32_bf16 v[92:95], a[60:63], v[64:67], v[92:95]
    v_add_u32 v62, 65536, v60
    v_add_u32 v63, 65536, v61
    s_waitcnt vmcnt(18)
    s_barrier
    ds_read_b64_tr_b16 a[64:65], v62 offset:0
    ds_read_b64_tr_b16 a[66:67], v62 offset:512
    ds_read_b64_tr_b16 a[68:69], v63 offset:0
    ds_read_b64_tr_b16 a[70:71], v63 offset:512
    ds_read_b64_tr_b16 a[72:73], v62 offset:4096
    ds_read_b64_tr_b16 a[74:75], v62 offset:4608
    ds_read_b64_tr_b16 a[76:77], v63 offset:4096
    ds_read_b64_tr_b16 a[78:79], v63 offset:4608
    s_add_u32 m0, s42, 49152
    s_nop 0
    buffer_load_dwordx4 v56, s[12:15], s54 offen lds
    s_add_u32 m0, s42, 50176
    s_nop 0
    buffer_load_dwordx4 v57, s[12:15], s54 offen lds
    s_add_u32 m0, s42, 57344
    s_nop 0
    buffer_load_dwordx4 v58, s[12:15], s54 offen lds
    s_add_u32 m0, s42, 58368
    s_nop 0
    buffer_load_dwordx4 v59, s[12:15], s54 offen lds
    s_add_u32 s54, s54, 458752
    s_waitcnt lgkmcnt(0)
    v_mfma_f32_16x16x32_bf16 v[88:91], a[64:67], v[64:67], v[88:91]
    v_mfma_f32_16x16x32_bf16 v[92:95], a[68:71], v[64:67], v[92:95]
    v_mfma_f32_16x16x32_bf16 v[88:91], a[72:75], v[64:67], v[88:91]
    v_mfma_f32_16x16x32_bf16 v[92:95], a[76:79], v[64:67], v[92:95]
    v_add_u32 v62, 81920, v60
    v_add_u32 v63, 81920, v61
    s_waitcnt vmcnt(16)
    s_barrier
    ds_read_b64_tr_b16 a[80:81], v62 offset:0
    ds_read_b64_tr_b16 a[82:83], v62 offset:512
    ds_read_b64_tr_b16 a[84:85], v63 offset:0
    ds_read_b64_tr_b16 a[86:87], v63 offset:512
    ds_read_b64_tr_b16 a[88:89], v62 offset:4096
    ds_read_b64_tr_b16 a[90:91], v62 offset:4608
    ds_read_b64_tr_b16 a[92:93], v63 offset:4096
    ds_read_b64_tr_b16 a[94:95], v63 offset:4608
    s_add_u32 m0, s42, 65536
    s_nop 0
    buffer_load_dwordx4 v56, s[12:15], s54 offen lds
    s_add_u32 m0, s42, 66560
    s_nop 0
    buffer_load_dwordx4 v57, s[12:15], s54 offen lds
    s_add_u32 m0, s42, 73728
    s_nop 0
    buffer_load_dwordx4 v58, s[12:15], s54 offen lds
    s_add_u32 m0, s42, 74752
    s_nop 0
    buffer_load_dwordx4 v59, s[12:15], s54 offen lds
    s_add_u32 s54, s54, 458752
    s_waitcnt lgkmcnt(0)
    v_mfma_f32_16x16x32_bf16 v[88:91], a[80:83], v[64:67], v[88:91]
    v_mfma_f32_16x16x32_bf16 v[92:95], a[84:87], v[64:67], v[92:95]
    v_mfma_f32_16x16x32_bf16 v[88:91], a[88:91], v[64:67], v[88:91]
    v_mfma_f32_16x16x32_bf16 v[92:95], a[92:95], v[64:67], v[92:95]
    v_add_u32 v62, 0, v60
    v_add_u32 v63, 0, v61
    s_waitcnt vmcnt(16)
    s_barrier
    ds_read_b64_tr_b16 a[96:97], v62 offset:0
    ds_read_b64_tr_b16 a[98:99], v62 offset:512
    ds_read_b64_tr_b16 a[100:101], v63 offset:0
    ds_read_b64_tr_b16 a[102:103], v63 offset:512
    ds_read_b64_tr_b16 a[104:105], v62 offset:4096
    ds_read_b64_tr_b16 a[106:107], v62 offset:4608
    ds_read_b64_tr_b16 a[108:109], v63 offset:4096
    ds_read_b64_tr_b16 a[110:111], v63 offset:4608
    s_add_u32 m0, s42, 81920
    s_nop 0
    buffer_load_dwordx4 v56, s[12:15], s54 offen lds
    s_add_u32 m0, s42, 82944
    s_nop 0
    buffer_load_dwordx4 v57, s[12:15], s54 offen lds
    s_add_u32 m0, s42, 90112
    s_nop 0
    buffer_load_dwordx4 v58, s[12:15], s54 offen lds
    s_add_u32 m0, s42, 91136
    s_nop 0
    buffer_load_dwordx4 v59, s[12:15], s54 offen lds
    s_add_u32 s54, s54, 458752
    s_waitcnt lgkmcnt(0)
    v_mfma_f32_16x16x32_bf16 v[88:91], a[96:99], v[64:67], v[88:91]
    v_mfma_f32_16x16x32_bf16 v[92:95], a[100:103], v[64:67], v[92:95]
    v_mfma_f32_16x16x32_bf16 v[88:91], a[104:107], v[64:67], v[88:91]
    v_mfma_f32_16x16x32_bf16 v[92:95], a[108:111], v[64:67], v[92:95]
    v_add_u32 v62, 16384, v60
    v_add_u32 v63, 16384, v61
    s_waitcnt vmcnt(16)
    s_barrier
    ds_read_b64_tr_b16 a[112:113], v62 offset:0
    ds_read_b64_tr_b16 a[114:115], v62 offset:512
    ds_read_b64_tr_b16 a[116:117], v63 offset:0
    ds_read_b64_tr_b16 a[118:119], v63 offset:512
    ds_read_b64_tr_b16 a[120:121], v62 offset:4096
    ds_read_b64_tr_b16 a[122:123], v62 offset:4608
    ds_read_b64_tr_b16 a[124:125], v63 offset:4096
    ds_read_b64_tr_b16 a[126:127], v63 offset:4608
    s_add_u32 m0, s42, 0
    s_nop 0
    buffer_load_dwordx4 v56, s[12:15], s54 offen lds
    s_add_u32 m0, s42, 1024
    s_nop 0
    buffer_load_dwordx4 v57, s[12:15], s54 offen lds
    s_add_u32 m0, s42, 8192
    s_nop 0
    buffer_load_dwordx4 v58, s[12:15], s54 offen lds
    s_add_u32 m0, s42, 9216
    s_nop 0
    buffer_load_dwordx4 v59, s[12:15], s54 offen lds
    s_add_u32 s54, s54, 458752
    s_waitcnt lgkmcnt(0)
    v_mfma_f32_16x16x32_bf16 v[88:91], a[112:115], v[64:67], v[88:91]
    v_mfma_f32_16x16x32_bf16 v[92:95], a[116:119], v[64:67], v[92:95]
    v_mfma_f32_16x16x32_bf16 v[88:91], a[120:123], v[64:67], v[88:91]
    v_mfma_f32_16x16x32_bf16 v[92:95], a[124:127], v[64:67], v[92:95]
    v_add_u32 v62, 32768, v60
    v_add_u32 v63, 32768, v61
    s_waitcnt vmcnt(16)
    s_barrier
    ds_read_b64_tr_b16 a[128:129], v62 offset:0
    ds_read_b64_tr_b16 a[130:131], v62 offset:512
    ds_read_b64_tr_b16 a[132:133], v63 offset:0
    ds_read_b64_tr_b16 a[134:135], v63 offset:512
    ds_read_b64_tr_b16 a[136:137], v62 offset:4096
    ds_read_b64_tr_b16 a[138:139], v62 offset:4608
    ds_read_b64_tr_b16 a[140:141], v63 offset:4096
    ds_read_b64_tr_b16 a[142:143], v63 offset:4608
    s_add_u32 m0, s42, 16384
    s_nop 0
    buffer_load_dwordx4 v56, s[12:15], s54 offen lds
    s_add_u32 m0, s42, 17408
    s_nop 0
    buffer_load_dwordx4 v57, s[12:15], s54 offen lds
    s_add_u32 m0, s42, 24576
    s_nop 0
    buffer_load_dwordx4 v58, s[12:15], s54 offen lds
    s_add_u32 m0, s42, 25600
    s_nop 0
    buffer_load_dwordx4 v59, s[12:15], s54 offen lds
    s_add_u32 s54, s54, 458752
    s_waitcnt lgkmcnt(0)
    v_mfma_f32_16x16x32_bf16 v[88:91], a[128:131], v[64:67], v[88:91]
    v_mfma_f32_16x16x32_bf16 v[92:95], a[132:135], v[64:67], v[92:95]
    v_mfma_f32_16x16x32_bf16 v[88:91], a[136:139], v[64:67], v[88:91]
    v_mfma_f32_16x16x32_bf16 v[92:95], a[140:143], v[64:67], v[92:95]
    v_add_u32 v62, 49152, v60
    v_add_u32 v63, 49152, v61
    s_waitcnt vmcnt(16)
    s_barrier
    ds_read_b64_tr_b16 a[144:145], v62 offset:0
    ds_read_b64_tr_b16 a[146:147], v62 offset:512
    ds_read_b64_tr_b16 a[148:149], v63 offset:0
    ds_read_b64_tr_b16 a[150:151], v63 offset:512
    ds_read_b64_tr_b16 a[152:153], v62 offset:4096
    ds_read_b64_tr_b16 a[154:155], v62 offset:4608
    ds_read_b64_tr_b16 a[156:157], v63 offset:4096
    ds_read_b64_tr_b16 a[158:159], v63 offset:4608
    s_add_u32 m0, s42, 32768
    s_nop 0
    buffer_load_dwordx4 v56, s[12:15], s54 offen lds
    s_add_u32 m0, s42, 33792
    s_nop 0
    buffer_load_dwordx4 v57, s[12:15], s54 offen lds
    s_add_u32 m0, s42, 40960
    s_nop 0
    buffer_load_dwordx4 v58, s[12:15], s54 offen lds
    s_add_u32 m0, s42, 41984
    s_nop 0
    buffer_load_dwordx4 v59, s[12:15], s54 offen lds
    s_add_u32 s54, s54, 458752
    s_waitcnt lgkmcnt(0)
    v_mfma_f32_16x16x32_bf16 v[88:91], a[144:147], v[64:67], v[88:91]
    v_mfma_f32_16x16x32_bf16 v[92:95], a[148:151], v[64:67], v[92:95]
    v_mfma_f32_16x16x32_bf16 v[88:91], a[152:155], v[64:67], v[88:91]
    v_mfma_f32_16x16x32_bf16 v[92:95], a[156:159], v[64:67], v[92:95]
    v_add_u32 v62, 65536, v60
    v_add_u32 v63, 65536, v61
    s_waitcnt vmcnt(16)
    s_barrier
    ds_read_b64_tr_b16 a[160:161], v62 offset:0
    ds_read_b64_tr_b16 a[162:163], v62 offset:512
    ds_read_b64_tr_b16 a[164:165], v63 offset:0
    ds_read_b64_tr_b16 a[166:167], v63 offset:512
    ds_read_b64_tr_b16 a[168:169], v62 offset:4096
    ds_read_b64_tr_b16 a[170:171], v62 offset:4608
    ds_read_b64_tr_b16 a[172:173], v63 offset:4096
    ds_read_b64_tr_b16 a[174:175], v63 offset:4608
    s_add_u32 m0, s42, 49152
    s_nop 0
    buffer_load_dwordx4 v56, s[12:15], s54 offen lds
    s_add_u32 m0, s42, 50176
    s_nop 0
    buffer_load_dwordx4 v57, s[12:15], s54 offen lds
    s_add_u32 m0, s42, 57344
    s_nop 0
    buffer_load_dwordx4 v58, s[12:15], s54 offen lds
    s_add_u32 m0, s42, 58368
    s_nop 0
    buffer_load_dwordx4 v59, s[12:15], s54 offen lds
    s_add_u32 s54, s54, 458752
    s_waitcnt lgkmcnt(0)
    v_mfma_f32_16x16x32_bf16 v[88:91], a[160:163], v[64:67], v[88:91]
    v_mfma_f32_16x16x32_bf16 v[92:95], a[164:167], v[64:67], v[92:95]
    v_mfma_f32_16x16x32_bf16 v[88:91], a[168:171], v[64:67], v[88:91]
    v_mfma_f32_16x16x32_bf16 v[92:95], a[172:175], v[64:67], v[92:95]
    v_add_u32 v62, 81920, v60
    v_add_u32 v63, 81920, v61
    s_waitcnt vmcnt(16)
    s_barrier
    ds_read_b64_tr_b16 a[176:177], v62 offset:0
    ds_read_b64_tr_b16 a[178:179], v62 offset:512
    ds_read_b64_tr_b16 a[180:181], v63 offset:0
    ds_read_b64_tr_b16 a[182:183], v63 offset:512
    ds_read_b64_tr_b16 a[184:185], v62 offset:4096
    ds_read_b64_tr_b16 a[186:187], v62 offset:4608
    ds_read_b64_tr_b16 a[188:189], v63 offset:4096
    ds_read_b64_tr_b16 a[190:191], v63 offset:4608
    s_waitcnt lgkmcnt(0)
    v_mfma_f32_16x16x32_bf16 v[88:91], a[176:179], v[64:67], v[88:91]
    v_mfma_f32_16x16x32_bf16 v[92:95], a[180:183], v[64:67], v[92:95]
    v_mfma_f32_16x16x32_bf16 v[88:91], a[184:187], v[64:67], v[88:91]
    v_mfma_f32_16x16x32_bf16 v[92:95], a[188:191], v[64:67], v[92:95]
    v_add_u32 v62, 0, v60
    v_add_u32 v63, 0, v61
    s_waitcnt vmcnt(12)
    s_barrier
    ds_read_b64_tr_b16 a[192:193], v62 offset:0
    ds_read_b64_tr_b16 a[194:195], v62 offset:512
    ds_read_b64_tr_b16 a[196:197], v63 offset:0
    ds_read_b64_tr_b16 a[198:199], v63 offset:512
    ds_read_b64_tr_b16 a[200:201], v62 offset:4096
    ds_read_b64_tr_b16 a[202:203], v62 offset:4608
    ds_read_b64_tr_b16 a[204:205], v63 offset:4096
    ds_read_b64_tr_b16 a[206:207], v63 offset:4608
    s_waitcnt lgkmcnt(0)
    v_mfma_f32_16x16x32_bf16 v[88:91], a[192:195], v[64:67], v[88:91]
    v_mfma_f32_16x16x32_bf16 v[92:95], a[196:199], v[64:67], v[92:95]
    v_mfma_f32_16x16x32_bf16 v[88:91], a[200:203], v[64:67], v[88:91]
    v_mfma_f32_16x16x32_bf16 v[92:95], a[204:207], v[64:67], v[92:95]
    v_add_u32 v62, 16384, v60
    v_add_u32 v63, 16384, v61
    s_waitcnt vmcnt(8)
    s_barrier
    ds_read_b64_tr_b16 a[208:209], v62 offset:0
    ds_read_b64_tr_b16 a[210:211], v62 offset:512
    ds_read_b64_tr_b16 a[212:213], v63 offset:0
    ds_read_b64_tr_b16 a[214:215], v63 offset:512
    ds_read_b64_tr_b16 a[216:217], v62 offset:4096
    ds_read_b64_tr_b16 a[218:219], v62 offset:4608
    ds_read_b64_tr_b16 a[220:221], v63 offset:4096
    ds_read_b64_tr_b16 a[222:223], v63 offset:4608
    s_waitcnt lgkmcnt(0)
    v_mfma_f32_16x16x32_bf16 v[88:91], a[208:211], v[64:67], v[88:91]
    v_mfma_f32_16x16x32_bf16 v[92:95], a[212:215], v[64:67], v[92:95]
    v_mfma_f32_16x16x32_bf16 v[88:91], a[216:219], v[64:67], v[88:91]
    v_mfma_f32_16x16x32_bf16 v[92:95], a[220:223], v[64:67], v[92:95]
    v_add_u32 v62, 32768, v60
    v_add_u32 v63, 32768, v61
    s_waitcnt vmcnt(4)
    s_barrier
    ds_read_b64_tr_b16 a[224:225], v62 offset:0
    ds_read_b64_tr_b16 a[226:227], v62 offset:512
    ds_read_b64_tr_b16 a[228:229], v63 offset:0
    ds_read_b64_tr_b16 a[230:231], v63 offset:512
    ds_read_b64_tr_b16 a[232:233], v62 offset:4096
    ds_read_b64_tr_b16 a[234:235], v62 offset:4608
    ds_read_b64_tr_b16 a[236:237], v63 offset:4096
    ds_read_b64_tr_b16 a[238:239], v63 offset:4608
    s_waitcnt lgkmcnt(0)
    v_mfma_f32_16x16x32_bf16 v[88:91], a[224:227], v[64:67], v[88:91]
    v_mfma_f32_16x16x32_bf16 v[92:95], a[228:231], v[64:67], v[92:95]
    v_mfma_f32_16x16x32_bf16 v[88:91], a[232:235], v[64:67], v[88:91]
    v_mfma_f32_16x16x32_bf16 v[92:95], a[236:239], v[64:67], v[92:95]
    v_add_u32 v62, 49152, v60
    v_add_u32 v63, 49152, v61
    s_waitcnt vmcnt(0)
    s_barrier
    ds_read_b64_tr_b16 a[240:241], v62 offset:0
    ds_read_b64_tr_b16 a[242:243], v62 offset:512
    ds_read_b64_tr_b16 a[244:245], v63 offset:0
    ds_read_b64_tr_b16 a[246:247], v63 offset:512
    ds_read_b64_tr_b16 a[248:249], v62 offset:4096
    ds_read_b64_tr_b16 a[250:251], v62 offset:4608
    ds_read_b64_tr_b16 a[252:253], v63 offset:4096
    ds_read_b64_tr_b16 a[254:255], v63 offset:4608
    s_waitcnt lgkmcnt(0)
    v_mfma_f32_16x16x32_bf16 v[88:91], a[240:243], v[64:67], v[88:91]
    v_mfma_f32_16x16x32_bf16 v[92:95], a[244:247], v[64:67], v[92:95]
    v_mfma_f32_16x16x32_bf16 v[88:91], a[248:251], v[64:67], v[88:91]
    v_mfma_f32_16x16x32_bf16 v[92:95], a[252:255], v[64:67], v[92:95]
    s_barrier
    s_mov_b32 s37, 0xffff0000
    v_lshlrev_b32 v100, 16, v16
    v_and_b32 v101, s37, v16
    v_lshlrev_b32 v102, 16, v17
    v_and_b32 v103, s37, v17
    v_lshlrev_b32 v104, 16, v18
    v_and_b32 v105, s37, v18
    v_lshlrev_b32 v106, 16, v19
    v_and_b32 v107, s37, v19
    v_lshlrev_b32 v108, 16, v20
    v_and_b32 v109, s37, v20
    v_lshlrev_b32 v110, 16, v21
    v_and_b32 v111, s37, v21
    s_cmp_lg_u32 s32, 0
    s_cbranch_scc1 L_arv30
    s_add_u32 s20, s82, 0x80
    s_addc_u32 s21, s83, 0
    s_mov_b32 s22, 0x4
    s_mov_b32 s23, 0x00020000
    buffer_load_dword v56, v124, s[20:23], 0 offen sc1
    s_waitcnt vmcnt(0)
    v_cmp_eq_u32 vcc, v124, v56
    s_cbranch_vccnz L_spin31
L_back32:
L_arv30:
    s_add_u32 s96, s41, 2031616
    s_mov_b32 s98, s41
    s_mov_b32 s45, 0x5560000
    buffer_load_dword v7, v5, s[16:19], s45 offen sc1
    s_waitcnt vmcnt(0)
    v_cmp_ne_u32 vcc, 0, v7
    s_cbranch_vccnz L_spin33
L_back34:
    s_barrier
    s_add_u32 m0, s43, 0
    s_add_u32 s42, s41, 0
    buffer_load_dwordx4 v1, s[16:19], s42 offen offset:0 sc1 lds
    buffer_load_dwordx4 v1, s[16:19], s42 offen offset:1024 sc1 lds
    buffer_load_dwordx4 v1, s[16:19], s42 offen offset:2048 sc1 lds
    buffer_load_dwordx4 v1, s[16:19], s42 offen offset:3072 sc1 lds
    s_add_u32 m0, s43, 16384
    s_add_u32 s42, s41, 16384
    buffer_load_dwordx4 v1, s[16:19], s42 offen offset:0 sc1 lds
    buffer_load_dwordx4 v1, s[16:19], s42 offen offset:1024 sc1 lds
    buffer_load_dwordx4 v1, s[16:19], s42 offen offset:2048 sc1 lds
    buffer_load_dwordx4 v1, s[16:19], s42 offen offset:3072 sc1 lds
    s_add_u32 s45, s45, 131072
    s_add_u32 m0, s52, 73728
    s_add_u32 s42, s46, s52
    buffer_load_dwordx4 v1, s[16:19], s42 offen sc1 lds
    s_waitcnt vmcnt(0) lgkmcnt(0)
    s_barrier
    ds_read_b128 v[56:59], v1 offset:0
    ds_read_b128 v[60:63], v1 offset:1024
    ds_read_b128 v[64:67], v1 offset:2048
    ds_read_b128 v[68:71], v1 offset:3072
    s_mov_b32 s36, 0
    s_waitcnt lgkmcnt(0)
    s_nop 7
L_l_b0:
    s_waitcnt lgkmcnt(2)
    v_mfma_f32_16x16x32_bf16 v[8:11], a[0:3], v[56:59], 0
    s_add_u32 m0, s52, 73728
    ds_read_b128 v[72:75], v1 offset:4096
    s_add_u32 s42, s46, s52
    v_mfma_f32_16x16x32_bf16 v[16:19], a[0:3], v[60:63], 0
    buffer_load_dwordx4 v1, s[16:19], s42 offen sc1 lds
    v_mfma_f32_16x16x32_bf16 v[20:23], a[4:7], v[60:63], 0
    s_add_u32 m0, s43, 32768
    ds_read_b128 v[76:79], v1 offset:5120
    s_add_u32 s42, s41, 32768
    v_mfma_f32_16x16x32_bf16 v[12:15], a[4:7], v[56:59], 0
    s_waitcnt lgkmcnt(2)
    buffer_load_dwordx4 v1, s[16:19], s42 offen offset:0 sc1 lds
    v_mfma_f32_16x16x32_bf16 v[8:11], a[8:11], v[64:67], v[8:11]
    s_and_b32 s44, s90, 0xffffffff
    ds_read_b128 v[80:83], v1 offset:6144
    s_cmp_eq_u32 s36, 0
    v_mfma_f32_16x16x32_bf16 v[16:19], a[8:11], v[68:71], v[16:19]
    buffer_load_dwordx4 v1, s[16:19], s42 offen offset:1024 sc1 lds
    v_mfma_f32_16x16x32_bf16 v[20:23], a[12:15], v[68:71], v[20:23]
    s_cselect_b32 s44, 0x5e00000, s44
    ds_read_b128 v[84:87], v1 offset:7168
    s_add_u32 s90, s90, 262144
    v_mfma_f32_16x16x32_bf16 v[12:15], a[12:15], v[64:67], v[12:15]
    s_waitcnt lgkmcnt(2)
    buffer_load_dwordx4 v1, s[16:19], s42 offen offset:2048 sc1 lds
    v_mfma_f32_16x16x32_bf16 v[8:11], a[16:19], v[72:75], v[8:11]
    ds_read_b128 v[56:59], v1 offset:8192
    v_add_f32 v32, v32, v128
    v_mfma_f32_16x16x32_bf16 v[16:19], a[16:19], v[76:79], v[16:19]
    buffer_load_dwordx4 v1, s[16:19], s42 offen offset:3072 sc1 lds
    v_mfma_f32_16x16x32_bf16 v[20:23], a[20:23], v[76:79], v[20:23]
    s_add_u32 m0, s43, 49152
    ds_read_b128 v[60:63], v1 offset:9216
    v_add_f32 v33, v33, v129
    v_mfma_f32_16x16x32_bf16 v[12:15], a[20:23], v[72:75], v[12:15]
    s_waitcnt lgkmcnt(2)
    v_mul_f32 v120, v32, v116
    v_mul_f32 v121, v33, v116
    v_mfma_f32_16x16x32_bf16 v[8:11], a[24:27], v[80:83], v[8:11]
    s_add_u32 s42, s41, 49152
    ds_read_b128 v[64:67], v1 offset:10240
    buffer_load_dwordx4 v1, s[16:19], s42 offen offset:0 sc1 lds
    v_mfma_f32_16x16x32_bf16 v[16:19], a[24:27], v[84:87], v[16:19]
    v_mul_f32 v120, v120, abs(v32)
    v_mul_f32 v121, v121, abs(v33)
    v_mfma_f32_16x16x32_bf16 v[20:23], a[28:31], v[84:87], v[20:23]
    ds_read_b128 v[68:71], v1 offset:11264
    buffer_load_dwordx4 v1, s[16:19], s42 offen offset:1024 sc1 lds
    v_mfma_f32_16x16x32_bf16 v[12:15], a[28:31], v[80:83], v[12:15]
    s_waitcnt lgkmcnt(2)
    v_cvt_pk_bf16_f32 v32, v120, v121
    v_pk_max_i16 v32, v32, 0
    v_mfma_f32_16x16x32_bf16 v[8:11], a[32:35], v[56:59], v[8:11]
    ds_read_b128 v[72:75], v1 offset:12288
    buffer_load_dwordx4 v1, s[16:19], s42 offen offset:2048 sc1 lds
    v_mfma_f32_16x16x32_bf16 v[16:19], a[32:35], v[60:63], v[16:19]
    v_add_f32 v34, v34, v130
    v_add_f32 v35, v35, v131
    v_mfma_f32_16x16x32_bf16 v[20:23], a[36:39], v[60:63], v[20:23]
    ds_read_b128 v[76:79], v1 offset:13312
    buffer_load_dwordx4 v1, s[16:19], s42 offen offset:3072 sc1 lds
    v_mfma_f32_16x16x32_bf16 v[12:15], a[36:39], v[56:59], v[12:15]
    s_waitcnt lgkmcnt(2)
    v_mul_f32 v120, v34, v116
    v_mul_f32 v121, v35, v116
    v_mfma_f32_16x16x32_bf16 v[8:11], a[40:43], v[64:67], v[8:11]
    s_add_u32 s98, s98, 65536
    ds_read_b128 v[80:83], v1 offset:14336
    v_mul_f32 v120, v120, abs(v34)
    v_mfma_f32_16x16x32_bf16 v[16:19], a[40:43], v[68:71], v[16:19]
    s_min_u32 s98, s98, s96
    v_mul_f32 v121, v121, abs(v35)
    v_cvt_pk_bf16_f32 v33, v120, v121
    v_mfma_f32_16x16x32_bf16 v[20:23], a[44:47], v[68:71], v[20:23]
    s_and_b32 s41, s98, 0xffffffff
    ds_read_b128 v[84:87], v1 offset:15360
    v_pk_max_i16 v33, v33, 0
    v_mfma_f32_16x16x32_bf16 v[12:15], a[44:47], v[64:67], v[12:15]
    s_waitcnt vmcnt(9) lgkmcnt(2)
    s_barrier
    v_add_f32 v36, v36, v132
    v_mfma_f32_16x16x32_bf16 v[8:11], a[48:51], v[72:75], v[8:11]
    ds_read_b128 v[56:59], v1 offset:16384
    v_add_f32 v37, v37, v133
    v_mfma_f32_16x16x32_bf16 v[16:19], a[48:51], v[76:79], v[16:19]
    v_mul_f32 v120, v36, v116
    v_mul_f32 v121, v37, v116
    v_mfma_f32_16x16x32_bf16 v[20:23], a[52:55], v[76:79], v[20:23]
    ds_read_b128 v[60:63], v1 offset:17408
    v_mul_f32 v120, v120, abs(v36)
    v_mfma_f32_16x16x32_bf16 v[12:15], a[52:55], v[72:75], v[12:15]
    s_waitcnt lgkmcnt(2)
    v_mul_f32 v121, v121, abs(v37)
    v_cvt_pk_bf16_f32 v34, v120, v121
    v_mfma_f32_16x16x32_bf16 v[8:11], a[56:59], v[80:83], v[8:11]
    ds_read_b128 v[64:67], v1 offset:18432
    v_pk_max_i16 v34, v34, 0
    v_mfma_f32_16x16x32_bf16 v[16:19], a[56:59], v[84:87], v[16:19]
    v_add_f32 v38, v38, v134
    v_add_f32 v39, v39, v135
    v_mfma_f32_16x16x32_bf16 v[20:23], a[60:63], v[84:87], v[20:23]
    ds_read_b128 v[68:71], v1 offset:19456
    v_mul_f32 v120, v38, v116
    v_mfma_f32_16x16x32_bf16 v[12:15], a[60:63], v[80:83], v[12:15]
    s_waitcnt lgkmcnt(2)
    v_mul_f32 v121, v39, v116
    v_mul_f32 v120, v120, abs(v38)
    v_mfma_f32_16x16x32_bf16 v[8:11], a[64:67], v[56:59], v[8:11]
    ds_read_b128 v[72:75], v1 offset:20480
    v_mul_f32 v121, v121, abs(v39)
    v_mfma_f32_16x16x32_bf16 v[16:19], a[64:67], v[60:63], v[16:19]
    v_cvt_pk_bf16_f32 v35, v120, v121
    v_pk_max_i16 v35, v35, 0
    v_mfma_f32_16x16x32_bf16 v[20:23], a[68:71], v[60:63], v[20:23]
    ds_read_b128 v[76:79], v1 offset:21504
    buffer_store_dwordx4 v[32:35], v1, s[16:19], s44 offen offset:0 sc1
    v_mfma_f32_16x16x32_bf16 v[12:15], a[68:71], v[56:59], v[12:15]
    s_waitcnt lgkmcnt(2)
    v_add_f32 v40, v40, v136
    v_add_f32 v41, v41, v137
    v_mfma_f32_16x16x32_bf16 v[8:11], a[72:75], v[64:67], v[8:11]
    ds_read_b128 v[80:83], v1 offset:22528
    v_mul_f32 v120, v40, v117
    v_mfma_f32_16x16x32_bf16 v[16:19], a[72:75], v[68:71], v[16:19]
    v_mul_f32 v121, v41, v117
    v_mul_f32 v120, v120, abs(v40)
    v_mfma_f32_16x16x32_bf16 v[20:23], a[76:79], v[68:71], v[20:23]
    ds_read_b128 v[84:87], v1 offset:23552
    v_mul_f32 v121, v121, abs(v41)
    v_mfma_f32_16x16x32_bf16 v[12:15], a[76:79], v[64:67], v[12:15]
    s_waitcnt lgkmcnt(2)
    v_cvt_pk_bf16_f32 v40, v120, v121
    v_pk_max_i16 v40, v40, 0
    v_mfma_f32_16x16x32_bf16 v[8:11], a[80:83], v[72:75], v[8:11]
    ds_read_b128 v[56:59], v1 offset:24576
    v_add_f32 v42, v42, v138
    v_mfma_f32_16x16x32_bf16 v[16:19], a[80:83], v[76:79], v[16:19]
    v_add_f32 v43, v43, v139
    v_mul_f32 v120, v42, v117
    v_mfma_f32_16x16x32_bf16 v[20:23], a[84:87], v[76:79], v[20:23]
    ds_read_b128 v[60:63], v1 offset:25600
    v_mul_f32 v121, v43, v117
    v_mfma_f32_16x16x32_bf16 v[12:15], a[84:87], v[72:75], v[12:15]
    s_waitcnt lgkmcnt(2)
    v_mul_f32 v120, v120, abs(v42)
    v_mul_f32 v121, v121, abs(v43)
    v_mfma_f32_16x16x32_bf16 v[8:11], a[88:91], v[80:83], v[8:11]
    ds_read_b128 v[64:67], v1 offset:26624
    v_cvt_pk_bf16_f32 v41, v120, v121
    v_mfma_f32_16x16x32_bf16 v[16:19], a[88:91], v[84:87], v[16:19]
    v_pk_max_i16 v41, v41, 0
    v_add_f32 v44, v44, v140
    v_mfma_f32_16x16x32_bf16 v[20:23], a[92:95], v[84:87], v[20:23]
    ds_read_b128 v[68:71], v1 offset:27648
    v_add_f32 v45, v45, v141
    v_mfma_f32_16x16x32_bf16 v[12:15], a[92:95], v[80:83], v[12:15]
    s_waitcnt lgkmcnt(2)
    v_mul_f32 v120, v44, v117
    v_mul_f32 v121, v45, v117
    v_mfma_f32_16x16x32_bf16 v[8:11], a[96:99], v[56:59], v[8:11]
    ds_read_b128 v[72:75], v1 offset:28672
    v_mul_f32 v120, v120, abs(v44)
    v_mfma_f32_16x16x32_bf16 v[16:19], a[96:99], v[60:63], v[16:19]
    v_mul_f32 v121, v121, abs(v45)
    v_cvt_pk_bf16_f32 v42, v120, v121
    v_mfma_f32_16x16x32_bf16 v[20:23], a[100:103], v[60:63], v[20:23]
    ds_read_b128 v[76:79], v1 offset:29696
    buffer_load_dword v7, v5, s[16:19], s45 offen sc1
    v_mfma_f32_16x16x32_bf16 v[12:15], a[100:103], v[56:59], v[12:15]
    s_waitcnt lgkmcnt(2)
    v_pk_max_i16 v42, v42, 0
    v_add_f32 v46, v46, v142
    v_mfma_f32_16x16x32_bf16 v[8:11], a[104:107], v[64:67], v[8:11]
    ds_read_b128 v[80:83], v1 offset:30720
    v_add_f32 v47, v47, v143
    v_mfma_f32_16x16x32_bf16 v[16:19], a[104:107], v[68:71], v[16:19]
    v_mul_f32 v120, v46, v117
    v_mul_f32 v121, v47, v117
    v_mfma_f32_16x16x32_bf16 v[20:23], a[108:111], v[68:71], v[20:23]
    ds_read_b128 v[84:87], v1 offset:31744
    v_mul_f32 v120, v120, abs(v46)
    v_mfma_f32_16x16x32_bf16 v[12:15], a[108:111], v[64:67], v[12:15]
    s_waitcnt vmcnt(6) lgkmcnt(2)
    s_barrier
    v_mul_f32 v121, v121, abs(v47)
    v_mfma_f32_16x16x32_bf16 v[8:11], a[112:115], v[72:75], v[8:11]
    ds_read_b128 v[56:59], v1 offset:32768
    v_cvt_pk_bf16_f32 v43, v120, v121
    v_mfma_f32_16x16x32_bf16 v[16:19], a[112:115], v[76:79], v[16:19]
    v_pk_max_i16 v43, v43, 0
    buffer_store_dwordx4 v[40:43], v1, s[16:19], s44 offen offset:1024 sc1
    v_mfma_f32_16x16x32_bf16 v[20:23], a[116:119], v[76:79], v[20:23]
    s_add_u32 m0, s43, 98304
    ds_read_b128 v[60:63], v1 offset:33792
    ds_read_b64 v[144:145], v118 offset:0
    v_mfma_f32_16x16x32_bf16 v[12:15], a[116:119], v[72:75], v[12:15]
    s_waitcnt lgkmcnt(3)
    ds_read_b64 v[146:147], v118 offset:128
    ds_read_b64 v[148:149], v118 offset:256
    v_mfma_f32_16x16x32_bf16 v[8:11], a[120:123], v[80:83], v[8:11]
    s_add_u32 s42, s41, 0
    ds_read_b128 v[64:67], v1 offset:34816
    ds_read_b64 v[150:151], v118 offset:384
    v_mfma_f32_16x16x32_bf16 v[16:19], a[120:123], v[84:87], v[16:19]
    v_mfma_f32_16x16x32_bf16 v[20:23], a[124:127], v[84:87], v[20:23]
    ds_read_b128 v[68:71], v1 offset:35840
    v_mfma_f32_16x16x32_bf16 v[12:15], a[124:127], v[80:83], v[12:15]
    s_waitcnt lgkmcnt(6)
    v_mfma_f32_16x16x32_bf16 v[8:11], a[128:131], v[56:59], v[8:11]
    ds_read_b128 v[72:75], v1 offset:36864
    v_mfma_f32_16x16x32_bf16 v[16:19], a[128:131], v[60:63], v[16:19]
    s_waitcnt lgkmcnt(2)
    v_max3_u32 v152, v144, v145, v146
    v_max3_u32 v153, v147, v148, v149
    v_mfma_f32_16x16x32_bf16 v[20:23], a[132:135], v[60:63], v[20:23]
    ds_read_b128 v[76:79], v1 offset:37888
    v_max3_u32 v152, v152, v150, v151
    v_mfma_f32_16x16x32_bf16 v[12:15], a[132:135], v[56:59], v[12:15]
    s_waitcnt lgkmcnt(2)
    v_max_u32 v152, v152, v153
    v_cmp_eq_u32 vcc, -1, v152
    v_mfma_f32_16x16x32_bf16 v[8:11], a[136:139], v[64:67], v[8:11]
    ds_read_b128 v[80:83], v1 offset:38912
    v_mfma_f32_16x16x32_bf16 v[16:19], a[136:139], v[68:71], v[16:19]
    s_cbranch_vccnz L_sspin37
L_sback38:
    v_add_f32 v152, v148, v150
    v_add_f32 v153, v149, v151
    v_mfma_f32_16x16x32_bf16 v[20:23], a[140:143], v[68:71], v[20:23]
    ds_read_b128 v[84:87], v1 offset:39936
    v_add_f32 v144, v144, v146
    v_mfma_f32_16x16x32_bf16 v[12:15], a[140:143], v[64:67], v[12:15]
    s_waitcnt lgkmcnt(2)
    v_add_f32 v145, v145, v147
    v_add_f32 v144, v144, v152
    v_mfma_f32_16x16x32_bf16 v[8:11], a[144:147], v[72:75], v[8:11]
    ds_read_b128 v[56:59], v1 offset:40960
    v_add_f32 v145, v145, v153
    v_mfma_f32_16x16x32_bf16 v[16:19], a[144:147], v[76:79], v[16:19]
    v_mov_b32 v152, v144
    v_mov_b32 v153, v145
    v_mfma_f32_16x16x32_bf16 v[20:23], a[148:151], v[76:79], v[20:23]
    ds_read_b128 v[60:63], v1 offset:41984
    v_permlane32_swap_b32 v144, v152
    v_mfma_f32_16x16x32_bf16 v[12:15], a[148:151], v[72:75], v[12:15]
    s_waitcnt lgkmcnt(2)
    v_permlane32_swap_b32 v145, v153
    v_mfma_f32_16x16x32_bf16 v[8:11], a[152:155], v[80:83], v[8:11]
    ds_read_b128 v[64:67], v1 offset:43008
    v_add_f32 v144, v144, v152
    v_mfma_f32_16x16x32_bf16 v[16:19], a[152:155], v[84:87], v[16:19]
    v_add_f32 v145, v145, v153
    v_mul_f32 v112, 0xba800000, v144
    v_mfma_f32_16x16x32_bf16 v[20:23], a[156:159], v[84:87], v[20:23]
    ds_read_b128 v[68:71], v1 offset:44032
    v_mul_f32 v145, 0x3a800000, v145
    v_mfma_f32_16x16x32_bf16 v[12:15], a[156:159], v[80:83], v[12:15]
    s_waitcnt lgkmcnt(2)
    v_fma_f32 v145, -v112, v112, v145
    v_mov_b32 v113, v112
    v_mfma_f32_16x16x32_bf16 v[8:11], a[160:163], v[56:59], v[8:11]
    ds_read_b128 v[72:75], v1 offset:45056
    v_max_f32 v145, 0, v145
    v_mfma_f32_16x16x32_bf16 v[16:19], a[160:163], v[60:63], v[16:19]
    v_add_f32 v145, 0x3727c5ac, v145
    v_rsq_f32 v116, v145
    v_mfma_f32_16x16x32_bf16 v[20:23], a[164:167], v[60:63], v[20:23]
    ds_read_b128 v[76:79], v1 offset:46080
    v_permlane16_swap_b32 v112, v113
    v_mfma_f32_16x16x32_bf16 v[12:15], a[164:167], v[56:59], v[12:15]
    s_waitcnt lgkmcnt(2)
    v_mul_f32 v114, v145, v116
    v_mul_f32 v116, v116, v116
    v_mfma_f32_16x16x32_bf16 v[8:11], a[168:171], v[64:67], v[8:11]
    s_waitcnt vmcnt(0)
    ds_read_b128 v[80:83], v1 offset:47104
    v_mov_b32 v115, v114
    v_mfma_f32_16x16x32_bf16 v[16:19], a[168:171], v[68:71], v[16:19]
    s_barrier
    buffer_store_dword v124, v124, s[16:19], s91 offen sc1
    v_mfma_f32_16x16x32_bf16 v[20:23], a[172:175], v[68:71], v[20:23]
    s_add_u32 s91, s91, 131072
    ds_read_b128 v[84:87], v1 offset:48128
    v_cmp_ne_u32 vcc, 0, v7
    v_mfma_f32_16x16x32_bf16 v[12:15], a[172:175], v[64:67], v[12:15]
    s_waitcnt lgkmcnt(2)
    v_mov_b32 v117, v116
    v_permlane16_swap_b32 v114, v115
    v_mfma_f32_16x16x32_bf16 v[8:11], a[176:179], v[72:75], v[8:11]
    s_cbranch_vccnz L_spin35
L_back36:
    ds_read_b128 v[56:59], v1 offset:49152
    v_permlane16_swap_b32 v116, v117
    v_mfma_f32_16x16x32_bf16 v[16:19], a[176:179], v[76:79], v[16:19]
    s_barrier
    buffer_load_dwordx4 v1, s[16:19], s42 offen offset:0 sc1 lds
    v_mfma_f32_16x16x32_bf16 v[20:23], a[180:183], v[76:79], v[20:23]
    s_add_u32 s46, s46, 2048
    ds_read_b128 v[60:63], v1 offset:50176
    buffer_load_dwordx4 v1, s[16:19], s42 offen offset:1024 sc1 lds
    v_mfma_f32_16x16x32_bf16 v[12:15], a[180:183], v[72:75], v[12:15]
    s_waitcnt lgkmcnt(2)
    buffer_load_dwordx4 v1, s[16:19], s42 offen offset:2048 sc1 lds
    v_mfma_f32_16x16x32_bf16 v[8:11], a[184:187], v[80:83], v[8:11]
    ds_read_b128 v[64:67], v1 offset:51200
    buffer_load_dwordx4 v1, s[16:19], s42 offen offset:3072 sc1 lds
    v_mfma_f32_16x16x32_bf16 v[16:19], a[184:187], v[84:87], v[16:19]
    s_add_u32 m0, s43, 114688
    v_mul_f32 v128, v112, v88
    v_fmac_f32 v128, v114, v100
    v_mfma_f32_16x16x32_bf16 v[20:23], a[188:191], v[84:87], v[20:23]
    s_add_u32 s42, s41, 16384
    ds_read_b128 v[68:71], v1 offset:52224
    v_mul_f32 v129, v112, v89
    v_mfma_f32_16x16x32_bf16 v[12:15], a[188:191], v[80:83], v[12:15]
    s_waitcnt lgkmcnt(2)
    v_fmac_f32 v129, v114, v101
    v_mul_f32 v130, v112, v90
    v_mfma_f32_16x16x32_bf16 v[8:11], a[192:195], v[56:59], v[8:11]
    ds_read_b128 v[72:75], v1 offset:53248
    buffer_load_dwordx4 v1, s[16:19], s42 offen offset:0 sc1 lds
    v_mfma_f32_16x16x32_bf16 v[16:19], a[192:195], v[60:63], v[16:19]
    v_fmac_f32 v130, v114, v102
    v_mul_f32 v131, v112, v91
    v_mfma_f32_16x16x32_bf16 v[20:23], a[196:199], v[60:63], v[20:23]
    ds_read_b128 v[76:79], v1 offset:54272
    v_fmac_f32 v131, v114, v103
    v_mfma_f32_16x16x32_bf16 v[12:15], a[196:199], v[56:59], v[12:15]
    s_waitcnt lgkmcnt(2)
    v_mul_f32 v132, v112, v92
    v_fmac_f32 v132, v114, v104
    v_mfma_f32_16x16x32_bf16 v[8:11], a[200:203], v[64:67], v[8:11]
    ds_read_b128 v[80:83], v1 offset:55296
    buffer_load_dwordx4 v1, s[16:19], s42 offen offset:1024 sc1 lds
    v_mfma_f32_16x16x32_bf16 v[16:19], a[200:203], v[68:71], v[16:19]
    v_mul_f32 v133, v112, v93
    v_fmac_f32 v133, v114, v105
    v_mfma_f32_16x16x32_bf16 v[20:23], a[204:207], v[68:71], v[20:23]
    ds_read_b128 v[84:87], v1 offset:56320
    v_mul_f32 v134, v112, v94
    v_mfma_f32_16x16x32_bf16 v[12:15], a[204:207], v[64:67], v[12:15]
    s_waitcnt lgkmcnt(2)
    v_fmac_f32 v134, v114, v106
    v_mul_f32 v135, v112, v95
    v_mfma_f32_16x16x32_bf16 v[8:11], a[208:211], v[72:75], v[8:11]
    ds_read_b128 v[56:59], v1 offset:57344
    buffer_load_dwordx4 v1, s[16:19], s42 offen offset:2048 sc1 lds
    v_mfma_f32_16x16x32_bf16 v[16:19], a[208:211], v[76:79], v[16:19]
    v_fmac_f32 v135, v114, v107
    v_mul_f32 v136, v113, v88
    v_mfma_f32_16x16x32_bf16 v[20:23], a[212:215], v[76:79], v[20:23]
    ds_read_b128 v[60:63], v1 offset:58368
    v_fmac_f32 v136, v115, v100
    v_mfma_f32_16x16x32_bf16 v[12:15], a[212:215], v[72:75], v[12:15]
    s_waitcnt lgkmcnt(2)
    v_mul_f32 v137, v113, v89
    v_fmac_f32 v137, v115, v101
    v_mfma_f32_16x16x32_bf16 v[8:11], a[216:219], v[80:83], v[8:11]
    ds_read_b128 v[64:67], v1 offset:59392
    buffer_load_dwordx4 v1, s[16:19], s42 offen offset:3072 sc1 lds
    v_mfma_f32_16x16x32_bf16 v[16:19], a[216:219], v[84:87], v[16:19]
    s_add_u32 s45, s45, 131072
    v_mul_f32 v138, v113, v90
    v_fmac_f32 v138, v115, v102
    v_mfma_f32_16x16x32_bf16 v[20:23], a[220:223], v[84:87], v[20:23]
    ds_read_b128 v[68:71], v1 offset:60416
    v_mul_f32 v139, v113, v91
    v_mfma_f32_16x16x32_bf16 v[12:15], a[220:223], v[80:83], v[12:15]
    s_waitcnt lgkmcnt(2)
    v_fmac_f32 v139, v115, v103
    v_mul_f32 v140, v113, v92
    v_mfma_f32_16x16x32_bf16 v[8:11], a[224:227], v[56:59], v[8:11]
    ds_read_b128 v[72:75], v1 offset:61440
    v_fmac_f32 v140, v115, v104
    v_mfma_f32_16x16x32_bf16 v[16:19], a[224:227], v[60:63], v[16:19]
    v_mul_f32 v141, v113, v93
    v_fmac_f32 v141, v115, v105
    v_mfma_f32_16x16x32_bf16 v[20:23], a[228:231], v[60:63], v[20:23]
    ds_read_b128 v[76:79], v1 offset:62464
    v_mul_f32 v142, v113, v94
    v_mfma_f32_16x16x32_bf16 v[12:15], a[228:231], v[56:59], v[12:15]
    s_waitcnt lgkmcnt(2)
    v_fmac_f32 v142, v115, v106
    v_mul_f32 v143, v113, v95
    v_mfma_f32_16x16x32_bf16 v[8:11], a[232:235], v[64:67], v[8:11]
    ds_read_b128 v[80:83], v1 offset:63488
    v_fmac_f32 v143, v115, v107
    v_mfma_f32_16x16x32_bf16 v[16:19], a[232:235], v[68:71], v[16:19]
    v_mfma_f32_16x16x32_bf16 v[20:23], a[236:239], v[68:71], v[20:23]
    ds_read_b128 v[84:87], v1 offset:64512
    v_mfma_f32_16x16x32_bf16 v[12:15], a[236:239], v[64:67], v[12:15]
    s_waitcnt vmcnt(4) lgkmcnt(2)
    s_barrier
    v_mfma_f32_16x16x32_bf16 v[8:11], a[240:243], v[72:75], v[8:11]
    ds_read_b128 v[56:59], v2 offset:0
    v_mfma_f32_16x16x32_bf16 v[16:19], a[240:243], v[76:79], v[16:19]
    v_mfma_f32_16x16x32_bf16 v[20:23], a[244:247], v[76:79], v[20:23]
    ds_read_b128 v[60:63], v2 offset:1024
    v_mfma_f32_16x16x32_bf16 v[12:15], a[244:247], v[72:75], v[12:15]
    s_waitcnt lgkmcnt(2)
    v_mfma_f32_16x16x32_bf16 v[8:11], a[248:251], v[80:83], v[8:11]
    ds_read_b128 v[64:67], v2 offset:2048
    v_mfma_f32_16x16x32_bf16 v[16:19], a[248:251], v[84:87], v[16:19]
    v_mfma_f32_16x16x32_bf16 v[20:23], a[252:255], v[84:87], v[20:23]
    ds_read_b128 v[68:71], v2 offset:3072
    v_mfma_f32_16x16x32_bf16 v[12:15], a[252:255], v[80:83], v[12:15]
    s_add_u32 s36, s36, 1
L_l_b1:
    s_waitcnt lgkmcnt(2)
    v_mfma_f32_16x16x32_bf16 v[32:35], a[0:3], v[56:59], 0
    s_add_u32 m0, s52, 73728
    ds_read_b128 v[72:75], v2 offset:4096
    s_add_u32 s42, s46, s52
    v_mfma_f32_16x16x32_bf16 v[40:43], a[0:3], v[60:63], 0
    buffer_load_dwordx4 v1, s[16:19], s42 offen sc1 lds
    v_mfma_f32_16x16x32_bf16 v[44:47], a[4:7], v[60:63], 0
    s_add_u32 m0, s43, 131072
    ds_read_b128 v[76:79], v2 offset:5120
    s_add_u32 s42, s41, 32768
    v_mfma_f32_16x16x32_bf16 v[36:39], a[4:7], v[56:59], 0
    s_waitcnt lgkmcnt(2)
    buffer_load_dwordx4 v1, s[16:19], s42 offen offset:0 sc1 lds
    v_mfma_f32_16x16x32_bf16 v[32:35], a[8:11], v[64:67], v[32:35]
    s_and_b32 s44, s90, 0xffffffff
    ds_read_b128 v[80:83], v2 offset:6144
    s_cmp_eq_u32 s36, 0
    v_mfma_f32_16x16x32_bf16 v[40:43], a[8:11], v[68:71], v[40:43]
    buffer_load_dwordx4 v1, s[16:19], s42 offen offset:1024 sc1 lds
    v_mfma_f32_16x16x32_bf16 v[44:47], a[12:15], v[68:71], v[44:47]
    s_cselect_b32 s44, 0x5e00000, s44
    ds_read_b128 v[84:87], v2 offset:7168
    s_add_u32 s90, s90, 262144
    v_mfma_f32_16x16x32_bf16 v[36:39], a[12:15], v[64:67], v[36:39]
    s_waitcnt lgkmcnt(2)
    buffer_load_dwordx4 v1, s[16:19], s42 offen offset:2048 sc1 lds
    v_mfma_f32_16x16x32_bf16 v[32:35], a[16:19], v[72:75], v[32:35]
    ds_read_b128 v[56:59], v2 offset:8192
    v_add_f32 v8, v8, v128
    v_mfma_f32_16x16x32_bf16 v[40:43], a[16:19], v[76:79], v[40:43]
    buffer_load_dwordx4 v1, s[16:19], s42 offen offset:3072 sc1 lds
    v_mfma_f32_16x16x32_bf16 v[44:47], a[20:23], v[76:79], v[44:47]
    s_add_u32 m0, s43, 147456
    ds_read_b128 v[60:63], v2 offset:9216
    v_add_f32 v9, v9, v129
    v_mfma_f32_16x16x32_bf16 v[36:39], a[20:23], v[72:75], v[36:39]
    s_waitcnt lgkmcnt(2)
    v_mul_f32 v120, v8, v116
    v_mul_f32 v121, v9, v116
    v_mfma_f32_16x16x32_bf16 v[32:35], a[24:27], v[80:83], v[32:35]
    s_add_u32 s42, s41, 49152
    ds_read_b128 v[64:67], v2 offset:10240
    buffer_load_dwordx4 v1, s[16:19], s42 offen offset:0 sc1 lds
    v_mfma_f32_16x16x32_bf16 v[40:43], a[24:27], v[84:87], v[40:43]
    v_mul_f32 v120, v120, abs(v8)
    v_mul_f32 v121, v121, abs(v9)
    v_mfma_f32_16x16x32_bf16 v[44:47], a[28:31], v[84:87], v[44:47]
    ds_read_b128 v[68:71], v2 offset:11264
    buffer_load_dwordx4 v1, s[16:19], s42 offen offset:1024 sc1 lds
    v_mfma_f32_16x16x32_bf16 v[36:39], a[28:31], v[80:83], v[36:39]
    s_waitcnt lgkmcnt(2)
    v_cvt_pk_bf16_f32 v8, v120, v121
    v_pk_max_i16 v8, v8, 0
    v_mfma_f32_16x16x32_bf16 v[32:35], a[32:35], v[56:59], v[32:35]
    ds_read_b128 v[72:75], v2 offset:12288
    buffer_load_dwordx4 v1, s[16:19], s42 offen offset:2048 sc1 lds
    v_mfma_f32_16x16x32_bf16 v[40:43], a[32:35], v[60:63], v[40:43]
    v_add_f32 v10, v10, v130
    v_add_f32 v11, v11, v131
    v_mfma_f32_16x16x32_bf16 v[44:47], a[36:39], v[60:63], v[44:47]
    ds_read_b128 v[76:79], v2 offset:13312
    buffer_load_dwordx4 v1, s[16:19], s42 offen offset:3072 sc1 lds
    v_mfma_f32_16x16x32_bf16 v[36:39], a[36:39], v[56:59], v[36:39]
    s_waitcnt lgkmcnt(2)
    v_mul_f32 v120, v10, v116
    v_mul_f32 v121, v11, v116
    v_mfma_f32_16x16x32_bf16 v[32:35], a[40:43], v[64:67], v[32:35]
    s_add_u32 s98, s98, 65536
    ds_read_b128 v[80:83], v2 offset:14336
    v_mul_f32 v120, v120, abs(v10)
    v_mfma_f32_16x16x32_bf16 v[40:43], a[40:43], v[68:71], v[40:43]
    s_min_u32 s98, s98, s96
    v_mul_f32 v121, v121, abs(v11)
    v_cvt_pk_bf16_f32 v9, v120, v121
    v_mfma_f32_16x16x32_bf16 v[44:47], a[44:47], v[68:71], v[44:47]
    s_and_b32 s41, s98, 0xffffffff
    ds_read_b128 v[84:87], v2 offset:15360
    v_pk_max_i16 v9, v9, 0
    v_mfma_f32_16x16x32_bf16 v[36:39], a[44:47], v[64:67], v[36:39]
    s_waitcnt vmcnt(9) lgkmcnt(2)
    s_barrier
    v_add_f32 v12, v12, v132
    v_mfma_f32_16x16x32_bf16 v[32:35], a[48:51], v[72:75], v[32:35]
    ds_read_b128 v[56:59], v2 offset:16384
    v_add_f32 v13, v13, v133
    v_mfma_f32_16x16x32_bf16 v[40:43], a[48:51], v[76:79], v[40:43]
    v_mul_f32 v120, v12, v116
    v_mul_f32 v121, v13, v116
    v_mfma_f32_16x16x32_bf16 v[44:47], a[52:55], v[76:79], v[44:47]
    ds_read_b128 v[60:63], v2 offset:17408
    v_mul_f32 v120, v120, abs(v12)
    v_mfma_f32_16x16x32_bf16 v[36:39], a[52:55], v[72:75], v[36:39]
    s_waitcnt lgkmcnt(2)
    v_mul_f32 v121, v121, abs(v13)
    v_cvt_pk_bf16_f32 v10, v120, v121
    v_mfma_f32_16x16x32_bf16 v[32:35], a[56:59], v[80:83], v[32:35]
    ds_read_b128 v[64:67], v2 offset:18432
    v_pk_max_i16 v10, v10, 0
    v_mfma_f32_16x16x32_bf16 v[40:43], a[56:59], v[84:87], v[40:43]
    v_add_f32 v14, v14, v134
    v_add_f32 v15, v15, v135
    v_mfma_f32_16x16x32_bf16 v[44:47], a[60:63], v[84:87], v[44:47]
    ds_read_b128 v[68:71], v2 offset:19456
    v_mul_f32 v120, v14, v116
    v_mfma_f32_16x16x32_bf16 v[36:39], a[60:63], v[80:83], v[36:39]
    s_waitcnt lgkmcnt(2)
    v_mul_f32 v121, v15, v116
    v_mul_f32 v120, v120, abs(v14)
    v_mfma_f32_16x16x32_bf16 v[32:35], a[64:67], v[56:59], v[32:35]
    ds_read_b128 v[72:75], v2 offset:20480
    v_mul_f32 v121, v121, abs(v15)
    v_mfma_f32_16x16x32_bf16 v[40:43], a[64:67], v[60:63], v[40:43]
    v_cvt_pk_bf16_f32 v11, v120, v121
    v_pk_max_i16 v11, v11, 0
    v_mfma_f32_16x16x32_bf16 v[44:47], a[68:71], v[60:63], v[44:47]
    ds_read_b128 v[76:79], v2 offset:21504
    buffer_store_dwordx4 v[8:11], v1, s[16:19], s44 offen offset:0 sc1
    v_mfma_f32_16x16x32_bf16 v[36:39], a[68:71], v[56:59], v[36:39]
    s_waitcnt lgkmcnt(2)
    v_add_f32 v16, v16, v136
    v_add_f32 v17, v17, v137
    v_mfma_f32_16x16x32_bf16 v[32:35], a[72:75], v[64:67], v[32:35]
    ds_read_b128 v[80:83], v2 offset:22528
    v_mul_f32 v120, v16, v117
    v_mfma_f32_16x16x32_bf16 v[40:43], a[72:75], v[68:71], v[40:43]
    v_mul_f32 v121, v17, v117
    v_mul_f32 v120, v120, abs(v16)
    v_mfma_f32_16x16x32_bf16 v[44:47], a[76:79], v[68:71], v[44:47]
    ds_read_b128 v[84:87], v2 offset:23552
    v_mul_f32 v121, v121, abs(v17)
    v_mfma_f32_16x16x32_bf16 v[36:39], a[76:79], v[64:67], v[36:39]
    s_waitcnt lgkmcnt(2)
    v_cvt_pk_bf16_f32 v16, v120, v121
    v_pk_max_i16 v16, v16, 0
    v_mfma_f32_16x16x32_bf16 v[32:35], a[80:83], v[72:75], v[32:35]
    ds_read_b128 v[56:59], v2 offset:24576
    v_add_f32 v18, v18, v138
    v_mfma_f32_16x16x32_bf16 v[40:43], a[80:83], v[76:79], v[40:43]
    v_add_f32 v19, v19, v139
    v_mul_f32 v120, v18, v117
    v_mfma_f32_16x16x32_bf16 v[44:47], a[84:87], v[76:79], v[44:47]
    ds_read_b128 v[60:63], v2 offset:25600
    v_mul_f32 v121, v19, v117
    v_mfma_f32_16x16x32_bf16 v[36:39], a[84:87], v[72:75], v[36:39]
    s_waitcnt lgkmcnt(2)
    v_mul_f32 v120, v120, abs(v18)
    v_mul_f32 v121, v121, abs(v19)
    v_mfma_f32_16x16x32_bf16 v[32:35], a[88:91], v[80:83], v[32:35]
    ds_read_b128 v[64:67], v2 offset:26624
    v_cvt_pk_bf16_f32 v17, v120, v121
    v_mfma_f32_16x16x32_bf16 v[40:43], a[88:91], v[84:87], v[40:43]
    v_pk_max_i16 v17, v17, 0
    v_add_f32 v20, v20, v140
    v_mfma_f32_16x16x32_bf16 v[44:47], a[92:95], v[84:87], v[44:47]
    ds_read_b128 v[68:71], v2 offset:27648
    v_add_f32 v21, v21, v141
    v_mfma_f32_16x16x32_bf16 v[36:39], a[92:95], v[80:83], v[36:39]
    s_waitcnt lgkmcnt(2)
    v_mul_f32 v120, v20, v117
    v_mul_f32 v121, v21, v117
    v_mfma_f32_16x16x32_bf16 v[32:35], a[96:99], v[56:59], v[32:35]
    ds_read_b128 v[72:75], v2 offset:28672
    v_mul_f32 v120, v120, abs(v20)
    v_mfma_f32_16x16x32_bf16 v[40:43], a[96:99], v[60:63], v[40:43]
    v_mul_f32 v121, v121, abs(v21)
    v_cvt_pk_bf16_f32 v18, v120, v121
    v_mfma_f32_16x16x32_bf16 v[44:47], a[100:103], v[60:63], v[44:47]
    ds_read_b128 v[76:79], v2 offset:29696
    buffer_load_dword v7, v5, s[16:19], s45 offen sc1
    v_mfma_f32_16x16x32_bf16 v[36:39], a[100:103], v[56:59], v[36:39]
    s_waitcnt lgkmcnt(2)
    v_pk_max_i16 v18, v18, 0
    v_add_f32 v22, v22, v142
    v_mfma_f32_16x16x32_bf16 v[32:35], a[104:107], v[64:67], v[32:35]
    ds_read_b128 v[80:83], v2 offset:30720
    v_add_f32 v23, v23, v143
    v_mfma_f32_16x16x32_bf16 v[40:43], a[104:107], v[68:71], v[40:43]
    v_mul_f32 v120, v22, v117
    v_mul_f32 v121, v23, v117
    v_mfma_f32_16x16x32_bf16 v[44:47], a[108:111], v[68:71], v[44:47]
    ds_read_b128 v[84:87], v2 offset:31744
    v_mul_f32 v120, v120, abs(v22)
    v_mfma_f32_16x16x32_bf16 v[36:39], a[108:111], v[64:67], v[36:39]
    s_waitcnt vmcnt(6) lgkmcnt(2)
    s_barrier
    v_mul_f32 v121, v121, abs(v23)
    v_mfma_f32_16x16x32_bf16 v[32:35], a[112:115], v[72:75], v[32:35]
    ds_read_b128 v[56:59], v2 offset:32768
    v_cvt_pk_bf16_f32 v19, v120, v121
    v_mfma_f32_16x16x32_bf16 v[40:43], a[112:115], v[76:79], v[40:43]
    v_pk_max_i16 v19, v19, 0
    buffer_store_dwordx4 v[16:19], v1, s[16:19], s44 offen offset:1024 sc1
    v_mfma_f32_16x16x32_bf16 v[44:47], a[116:119], v[76:79], v[44:47]
    s_add_u32 m0, s43, 0
    ds_read_b128 v[60:63], v2 offset:33792
    ds_read_b64 v[144:145], v118 offset:0
    v_mfma_f32_16x16x32_bf16 v[36:39], a[116:119], v[72:75], v[36:39]
    s_waitcnt lgkmcnt(3)
    ds_read_b64 v[146:147], v118 offset:128
    ds_read_b64 v[148:149], v118 offset:256
    v_mfma_f32_16x16x32_bf16 v[32:35], a[120:123], v[80:83], v[32:35]
    s_add_u32 s42, s41, 0
    ds_read_b128 v[64:67], v2 offset:34816
    ds_read_b64 v[150:151], v118 offset:384
    v_mfma_f32_16x16x32_bf16 v[40:43], a[120:123], v[84:87], v[40:43]
    v_mfma_f32_16x16x32_bf16 v[44:47], a[124:127], v[84:87], v[44:47]
    ds_read_b128 v[68:71], v2 offset:35840
    v_mfma_f32_16x16x32_bf16 v[36:39], a[124:127], v[80:83], v[36:39]
    s_waitcnt lgkmcnt(6)
    v_mfma_f32_16x16x32_bf16 v[32:35], a[128:131], v[56:59], v[32:35]
    ds_read_b128 v[72:75], v2 offset:36864
    v_mfma_f32_16x16x32_bf16 v[40:43], a[128:131], v[60:63], v[40:43]
    s_waitcnt lgkmcnt(2)
    v_max3_u32 v152, v144, v145, v146
    v_max3_u32 v153, v147, v148, v149
    v_mfma_f32_16x16x32_bf16 v[44:47], a[132:135], v[60:63], v[44:47]
    ds_read_b128 v[76:79], v2 offset:37888
    v_max3_u32 v152, v152, v150, v151
    v_mfma_f32_16x16x32_bf16 v[36:39], a[132:135], v[56:59], v[36:39]
    s_waitcnt lgkmcnt(2)
    v_max_u32 v152, v152, v153
    v_cmp_eq_u32 vcc, -1, v152
    v_mfma_f32_16x16x32_bf16 v[32:35], a[136:139], v[64:67], v[32:35]
    ds_read_b128 v[80:83], v2 offset:38912
    v_mfma_f32_16x16x32_bf16 v[40:43], a[136:139], v[68:71], v[40:43]
    s_cbranch_vccnz L_sspin41
L_sback42:
    v_add_f32 v152, v148, v150
    v_add_f32 v153, v149, v151
    v_mfma_f32_16x16x32_bf16 v[44:47], a[140:143], v[68:71], v[44:47]
    ds_read_b128 v[84:87], v2 offset:39936
    v_add_f32 v144, v144, v146
    v_mfma_f32_16x16x32_bf16 v[36:39], a[140:143], v[64:67], v[36:39]
    s_waitcnt lgkmcnt(2)
    v_add_f32 v145, v145, v147
    v_add_f32 v144, v144, v152
    v_mfma_f32_16x16x32_bf16 v[32:35], a[144:147], v[72:75], v[32:35]
    ds_read_b128 v[56:59], v2 offset:40960
    v_add_f32 v145, v145, v153
    v_mfma_f32_16x16x32_bf16 v[40:43], a[144:147], v[76:79], v[40:43]
    v_mov_b32 v152, v144
    v_mov_b32 v153, v145
    v_mfma_f32_16x16x32_bf16 v[44:47], a[148:151], v[76:79], v[44:47]
    ds_read_b128 v[60:63], v2 offset:41984
    v_permlane32_swap_b32 v144, v152
    v_mfma_f32_16x16x32_bf16 v[36:39], a[148:151], v[72:75], v[36:39]
    s_waitcnt lgkmcnt(2)
    v_permlane32_swap_b32 v145, v153
    v_mfma_f32_16x16x32_bf16 v[32:35], a[152:155], v[80:83], v[32:35]
    ds_read_b128 v[64:67], v2 offset:43008
    v_add_f32 v144, v144, v152
    v_mfma_f32_16x16x32_bf16 v[40:43], a[152:155], v[84:87], v[40:43]
    v_add_f32 v145, v145, v153
    v_mul_f32 v112, 0xba800000, v144
    v_mfma_f32_16x16x32_bf16 v[44:47], a[156:159], v[84:87], v[44:47]
    ds_read_b128 v[68:71], v2 offset:44032
    v_mul_f32 v145, 0x3a800000, v145
    v_mfma_f32_16x16x32_bf16 v[36:39], a[156:159], v[80:83], v[36:39]
    s_waitcnt lgkmcnt(2)
    v_fma_f32 v145, -v112, v112, v145
    v_mov_b32 v113, v112
    v_mfma_f32_16x16x32_bf16 v[32:35], a[160:163], v[56:59], v[32:35]
    ds_read_b128 v[72:75], v2 offset:45056
    v_max_f32 v145, 0, v145
    v_mfma_f32_16x16x32_bf16 v[40:43], a[160:163], v[60:63], v[40:43]
    v_add_f32 v145, 0x3727c5ac, v145
    v_rsq_f32 v116, v145
    v_mfma_f32_16x16x32_bf16 v[44:47], a[164:167], v[60:63], v[44:47]
    ds_read_b128 v[76:79], v2 offset:46080
    v_permlane16_swap_b32 v112, v113
    v_mfma_f32_16x16x32_bf16 v[36:39], a[164:167], v[56:59], v[36:39]
    s_waitcnt lgkmcnt(2)
    v_mul_f32 v114, v145, v116
    v_mul_f32 v116, v116, v116
    v_mfma_f32_16x16x32_bf16 v[32:35], a[168:171], v[64:67], v[32:35]
    s_waitcnt vmcnt(0)
    ds_read_b128 v[80:83], v2 offset:47104
    v_mov_b32 v115, v114
    v_mfma_f32_16x16x32_bf16 v[40:43], a[168:171], v[68:71], v[40:43]
    s_barrier
    buffer_store_dword v124, v124, s[16:19], s91 offen sc1
    v_mfma_f32_16x16x32_bf16 v[44:47], a[172:175], v[68:71], v[44:47]
    s_add_u32 s91, s91, 131072
    ds_read_b128 v[84:87], v2 offset:48128
    v_cmp_ne_u32 vcc, 0, v7
    v_mfma_f32_16x16x32_bf16 v[36:39], a[172:175], v[64:67], v[36:39]
    s_waitcnt lgkmcnt(2)
    v_mov_b32 v117, v116
    v_permlane16_swap_b32 v114, v115
    v_mfma_f32_16x16x32_bf16 v[32:35], a[176:179], v[72:75], v[32:35]
    s_cbranch_vccnz L_spin39
L_back40:
    ds_read_b128 v[56:59], v2 offset:49152
    v_permlane16_swap_b32 v116, v117
    v_mfma_f32_16x16x32_bf16 v[40:43], a[176:179], v[76:79], v[40:43]
    s_barrier
    buffer_load_dwordx4 v1, s[16:19], s42 offen offset:0 sc1 lds
    v_mfma_f32_16x16x32_bf16 v[44:47], a[180:183], v[76:79], v[44:47]
    s_add_u32 s46, s46, 2048
    ds_read_b128 v[60:63], v2 offset:50176
    buffer_load_dwordx4 v1, s[16:19], s42 offen offset:1024 sc1 lds
    v_mfma_f32_16x16x32_bf16 v[36:39], a[180:183], v[72:75], v[36:39]
    s_waitcnt lgkmcnt(2)
    buffer_load_dwordx4 v1, s[16:19], s42 offen offset:2048 sc1 lds
    v_mfma_f32_16x16x32_bf16 v[32:35], a[184:187], v[80:83], v[32:35]
    ds_read_b128 v[64:67], v2 offset:51200
    buffer_load_dwordx4 v1, s[16:19], s42 offen offset:3072 sc1 lds
    v_mfma_f32_16x16x32_bf16 v[40:43], a[184:187], v[84:87], v[40:43]
    s_add_u32 m0, s43, 16384
    v_mul_f32 v128, v112, v88
    v_fmac_f32 v128, v114, v100
    v_mfma_f32_16x16x32_bf16 v[44:47], a[188:191], v[84:87], v[44:47]
    s_add_u32 s42, s41, 16384
    ds_read_b128 v[68:71], v2 offset:52224
    v_mul_f32 v129, v112, v89
    v_mfma_f32_16x16x32_bf16 v[36:39], a[188:191], v[80:83], v[36:39]
    s_waitcnt lgkmcnt(2)
    v_fmac_f32 v129, v114, v101
    v_mul_f32 v130, v112, v90
    v_mfma_f32_16x16x32_bf16 v[32:35], a[192:195], v[56:59], v[32:35]
    ds_read_b128 v[72:75], v2 offset:53248
    buffer_load_dwordx4 v1, s[16:19], s42 offen offset:0 sc1 lds
    v_mfma_f32_16x16x32_bf16 v[40:43], a[192:195], v[60:63], v[40:43]
    v_fmac_f32 v130, v114, v102
    v_mul_f32 v131, v112, v91
    v_mfma_f32_16x16x32_bf16 v[44:47], a[196:199], v[60:63], v[44:47]
    ds_read_b128 v[76:79], v2 offset:54272
    v_fmac_f32 v131, v114, v103
    v_mfma_f32_16x16x32_bf16 v[36:39], a[196:199], v[56:59], v[36:39]
    s_waitcnt lgkmcnt(2)
    v_mul_f32 v132, v112, v92
    v_fmac_f32 v132, v114, v104
    v_mfma_f32_16x16x32_bf16 v[32:35], a[200:203], v[64:67], v[32:35]
    ds_read_b128 v[80:83], v2 offset:55296
    buffer_load_dwordx4 v1, s[16:19], s42 offen offset:1024 sc1 lds
    v_mfma_f32_16x16x32_bf16 v[40:43], a[200:203], v[68:71], v[40:43]
    v_mul_f32 v133, v112, v93
    v_fmac_f32 v133, v114, v105
    v_mfma_f32_16x16x32_bf16 v[44:47], a[204:207], v[68:71], v[44:47]
    ds_read_b128 v[84:87], v2 offset:56320
    v_mul_f32 v134, v112, v94
    v_mfma_f32_16x16x32_bf16 v[36:39], a[204:207], v[64:67], v[36:39]
    s_waitcnt lgkmcnt(2)
    v_fmac_f32 v134, v114, v106
    v_mul_f32 v135, v112, v95
    v_mfma_f32_16x16x32_bf16 v[32:35], a[208:211], v[72:75], v[32:35]
    ds_read_b128 v[56:59], v2 offset:57344
    buffer_load_dwordx4 v1, s[16:19], s42 offen offset:2048 sc1 lds
    v_mfma_f32_16x16x32_bf16 v[40:43], a[208:211], v[76:79], v[40:43]
    v_fmac_f32 v135, v114, v107
    v_mul_f32 v136, v113, v88
    v_mfma_f32_16x16x32_bf16 v[44:47], a[212:215], v[76:79], v[44:47]
    ds_read_b128 v[60:63], v2 offset:58368
    v_fmac_f32 v136, v115, v100
    v_mfma_f32_16x16x32_bf16 v[36:39], a[212:215], v[72:75], v[36:39]
    s_waitcnt lgkmcnt(2)
    v_mul_f32 v137, v113, v89
    v_fmac_f32 v137, v115, v101
    v_mfma_f32_16x16x32_bf16 v[32:35], a[216:219], v[80:83], v[32:35]
    ds_read_b128 v[64:67], v2 offset:59392
    buffer_load_dwordx4 v1, s[16:19], s42 offen offset:3072 sc1 lds
    v_mfma_f32_16x16x32_bf16 v[40:43], a[216:219], v[84:87], v[40:43]
    s_add_u32 s45, s45, 131072
    v_mul_f32 v138, v113, v90
    v_fmac_f32 v138, v115, v102
    v_mfma_f32_16x16x32_bf16 v[44:47], a[220:223], v[84:87], v[44:47]
    ds_read_b128 v[68:71], v2 offset:60416
    v_mul_f32 v139, v113, v91
    v_mfma_f32_16x16x32_bf16 v[36:39], a[220:223], v[80:83], v[36:39]
    s_waitcnt lgkmcnt(2)
    v_fmac_f32 v139, v115, v103
    v_mul_f32 v140, v113, v92
    v_mfma_f32_16x16x32_bf16 v[32:35], a[224:227], v[56:59], v[32:35]
    ds_read_b128 v[72:75], v2 offset:61440
    v_fmac_f32 v140, v115, v104
    v_mfma_f32_16x16x32_bf16 v[40:43], a[224:227], v[60:63], v[40:43]
    v_mul_f32 v141, v113, v93
    v_fmac_f32 v141, v115, v105
    v_mfma_f32_16x16x32_bf16 v[44:47], a[228:231], v[60:63], v[44:47]
    ds_read_b128 v[76:79], v2 offset:62464
    v_mul_f32 v142, v113, v94
    v_mfma_f32_16x16x32_bf16 v[36:39], a[228:231], v[56:59], v[36:39]
    s_waitcnt lgkmcnt(2)
    v_fmac_f32 v142, v115, v106
    v_mul_f32 v143, v113, v95
    v_mfma_f32_16x16x32_bf16 v[32:35], a[232:235], v[64:67], v[32:35]
    ds_read_b128 v[80:83], v2 offset:63488
    v_fmac_f32 v143, v115, v107
    v_mfma_f32_16x16x32_bf16 v[40:43], a[232:235], v[68:71], v[40:43]
    v_mfma_f32_16x16x32_bf16 v[44:47], a[236:239], v[68:71], v[44:47]
    ds_read_b128 v[84:87], v2 offset:64512
    v_mfma_f32_16x16x32_bf16 v[36:39], a[236:239], v[64:67], v[36:39]
    s_waitcnt vmcnt(4) lgkmcnt(2)
    s_barrier
    v_mfma_f32_16x16x32_bf16 v[32:35], a[240:243], v[72:75], v[32:35]
    ds_read_b128 v[56:59], v1 offset:0
    v_mfma_f32_16x16x32_bf16 v[40:43], a[240:243], v[76:79], v[40:43]
    v_mfma_f32_16x16x32_bf16 v[44:47], a[244:247], v[76:79], v[44:47]
    ds_read_b128 v[60:63], v1 offset:1024
    v_mfma_f32_16x16x32_bf16 v[36:39], a[244:247], v[72:75], v[36:39]
    s_waitcnt lgkmcnt(2)
    v_mfma_f32_16x16x32_bf16 v[32:35], a[248:251], v[80:83], v[32:35]
    ds_read_b128 v[64:67], v1 offset:2048
    v_mfma_f32_16x16x32_bf16 v[40:43], a[248:251], v[84:87], v[40:43]
    v_mfma_f32_16x16x32_bf16 v[44:47], a[252:255], v[84:87], v[44:47]
    ds_read_b128 v[68:71], v1 offset:3072
    v_mfma_f32_16x16x32_bf16 v[36:39], a[252:255], v[80:83], v[36:39]
    s_add_u32 s36, s36, 1
    s_cmp_lt_u32 s36, 32
    s_cbranch_scc1 L_l_b0
    s_nop 7
    s_and_b32 s44, s90, 0xffffffff
    s_cmp_eq_u32 s36, 0
    s_cselect_b32 s44, 0x5e00000, s44
    s_add_u32 s90, s90, 262144
    v_add_f32 v32, v32, v128
    v_add_f32 v33, v33, v129
    v_mul_f32 v120, v32, v116
    v_mul_f32 v121, v33, v116
    v_mul_f32 v120, v120, abs(v32)
    v_mul_f32 v121, v121, abs(v33)
    v_cvt_pk_bf16_f32 v32, v120, v121
    v_pk_max_i16 v32, v32, 0
    v_add_f32 v34, v34, v130
    v_add_f32 v35, v35, v131
    v_mul_f32 v120, v34, v116
    v_mul_f32 v121, v35, v116
    v_mul_f32 v120, v120, abs(v34)
    v_mul_f32 v121, v121, abs(v35)
    v_cvt_pk_bf16_f32 v33, v120, v121
    v_pk_max_i16 v33, v33, 0
    v_add_f32 v36, v36, v132
    v_add_f32 v37, v37, v133
    v_mul_f32 v120, v36, v116
    v_mul_f32 v121, v37, v116
    v_mul_f32 v120, v120, abs(v36)
    v_mul_f32 v121, v121, abs(v37)
    v_cvt_pk_bf16_f32 v34, v120, v121
    v_pk_max_i16 v34, v34, 0
    v_add_f32 v38, v38, v134
    v_add_f32 v39, v39, v135
    v_mul_f32 v120, v38, v116
    v_mul_f32 v121, v39, v116
    v_mul_f32 v120, v120, abs(v38)
    v_mul_f32 v121, v121, abs(v39)
    v_cvt_pk_bf16_f32 v35, v120, v121
    v_pk_max_i16 v35, v35, 0
    buffer_store_dwordx4 v[32:35], v1, s[16:19], s44 offen offset:0 sc1
    v_add_f32 v40, v40, v136
    v_add_f32 v41, v41, v137
    v_mul_f32 v120, v40, v117
    v_mul_f32 v121, v41, v117
    v_mul_f32 v120, v120, abs(v40)
    v_mul_f32 v121, v121, abs(v41)
    v_cvt_pk_bf16_f32 v40, v120, v121
    v_pk_max_i16 v40, v40, 0
    v_add_f32 v42, v42, v138
    v_add_f32 v43, v43, v139
    v_mul_f32 v120, v42, v117
    v_mul_f32 v121, v43, v117
    v_mul_f32 v120, v120, abs(v42)
    v_mul_f32 v121, v121, abs(v43)
    v_cvt_pk_bf16_f32 v41, v120, v121
    v_pk_max_i16 v41, v41, 0
    v_add_f32 v44, v44, v140
    v_add_f32 v45, v45, v141
    v_mul_f32 v120, v44, v117
    v_mul_f32 v121, v45, v117
    v_mul_f32 v120, v120, abs(v44)
    v_mul_f32 v121, v121, abs(v45)
    v_cvt_pk_bf16_f32 v42, v120, v121
    v_pk_max_i16 v42, v42, 0
    v_add_f32 v46, v46, v142
    v_add_f32 v47, v47, v143
    v_mul_f32 v120, v46, v117
    v_mul_f32 v121, v47, v117
    v_mul_f32 v120, v120, abs(v46)
    v_mul_f32 v121, v121, abs(v47)
    v_cvt_pk_bf16_f32 v43, v120, v121
    v_pk_max_i16 v43, v43, 0
    buffer_store_dwordx4 v[40:43], v1, s[16:19], s44 offen offset:1024 sc1
    s_waitcnt vmcnt(0)
    s_barrier
    buffer_store_dword v124, v124, s[16:19], s91 offen sc1
    s_add_u32 s91, s91, 131072
    s_waitcnt vmcnt(0)
    s_endpgm
L_spin31:
    s_mov_b32 s40, 0x20000
L_spin31_l:
    buffer_load_dword v56, v124, s[20:23], 0 offen sc1
    s_sub_u32 s40, s40, 1
    s_waitcnt vmcnt(0)
    v_cmp_eq_u32 vcc, v124, v56
    s_cbranch_scc1 L_back32
    s_cbranch_vccz L_back32
    s_sleep 8
    s_branch L_spin31_l
L_spin33:
    s_mov_b32 s40, 0x20000
L_spin33_l:
    buffer_load_dword v7, v5, s[16:19], s45 offen sc1
    s_sub_u32 s40, s40, 1
    s_waitcnt vmcnt(0)
    v_cmp_ne_u32 vcc, 0, v7
    s_cbranch_scc1 L_back34
    s_cbranch_vccz L_back34
    s_sleep 2
    s_branch L_spin33_l
L_spin35:
    s_mov_b32 s40, 0x20000
L_spin35_l:
    buffer_load_dword v7, v5, s[16:19], s45 offen sc1
    s_sub_u32 s40, s40, 1
    s_waitcnt vmcnt(0)
    v_cmp_ne_u32 vcc, 0, v7
    s_cbranch_scc1 L_back36
    s_cbranch_vccz L_back36
    s_sleep 2
    s_branch L_spin35_l
L_sspin37:
    s_mov_b32 s40, 0x20000
L_sspin37_l:
    buffer_load_dwordx2 v[144:145], v6, s[16:19], s46 offen offset:0 sc1
    buffer_load_dwordx2 v[146:147], v6, s[16:19], s46 offen offset:128 sc1
    buffer_load_dwordx2 v[148:149], v6, s[16:19], s46 offen offset:256 sc1
    buffer_load_dwordx2 v[150:151], v6, s[16:19], s46 offen offset:384 sc1
    s_sub_u32 s40, s40, 1
    s_waitcnt vmcnt(0)
    v_max3_u32 v152, v144, v145, v146
    v_max3_u32 v153, v147, v148, v149
    v_max3_u32 v152, v152, v150, v151
    v_max_u32 v152, v152, v153
    v_cmp_eq_u32 vcc, -1, v152
    s_cbranch_scc1 L_sback38
    s_cbranch_vccz L_sback38
    s_sleep 4
    s_branch L_sspin37_l
L_spin39:
    s_mov_b32 s40, 0x20000
L_spin39_l:
    buffer_load_dword v7, v5, s[16:19], s45 offen sc1
    s_sub_u32 s40, s40, 1
    s_waitcnt vmcnt(0)
    v_cmp_ne_u32 vcc, 0, v7
    s_cbranch_scc1 L_back40
    s_cbranch_vccz L_back40
    s_sleep 2
    s_branch L_spin39_l
L_sspin41:
    s_mov_b32 s40, 0x20000
L_sspin41_l:
    buffer_load_dwordx2 v[144:145], v6, s[16:19], s46 offen offset:0 sc1
    buffer_load_dwordx2 v[146:147], v6, s[16:19], s46 offen offset:128 sc1
    buffer_load_dwordx2 v[148:149], v6, s[16:19], s46 offen offset:256 sc1
    buffer_load_dwordx2 v[150:151], v6, s[16:19], s46 offen offset:384 sc1
    s_sub_u32 s40, s40, 1
    s_waitcnt vmcnt(0)
    v_max3_u32 v152, v144, v145, v146
    v_max3_u32 v153, v147, v148, v149
    v_max3_u32 v152, v152, v150, v151
    v_max_u32 v152, v152, v153
    v_cmp_eq_u32 vcc, -1, v152
    s_cbranch_scc1 L_sback42
    s_cbranch_vccz L_sback42
    s_sleep 4
    s_branch L_sspin41_l
L_role_44:
    s_sub_u32 s35, s34, 44
    s_lshl_b32 s50, s33, 4
    s_add_u32 s50, s50, s35
    s_lshl_b32 s50, s50, 1
    s_lshl_b32 s46, s50, 15
    s_lshl_b32 s37, s32, 9
    s_add_u32 s46, s46, s37
    v_lshrrev_b32 v48, 3, v0
    v_and_b32 v49, 0x70, v1
    v_lshl_add_u32 v48, v48, 11, v49
    v_add_u32 v49, 16384, v48
    s_mov_b32 s8, s64
    s_mov_b32 s9, s65
    s_mov_b32 s10, 0x400000
    s_mov_b32 s11, 0x00020000
    buffer_load_dwordx4 v[16:19], v48, s[8:11], s46 offen offset:0
    buffer_load_dwordx4 v[20:23], v48, s[8:11], s46 offen offset:128
    buffer_load_dwordx4 v[24:27], v48, s[8:11], s46 offen offset:256
    buffer_load_dwordx4 v[28:31], v48, s[8:11], s46 offen offset:384
    buffer_load_dwordx4 v[32:35], v49, s[8:11], s46 offen offset:0
    buffer_load_dwordx4 v[36:39], v49, s[8:11], s46 offen offset:128
    buffer_load_dwordx4 v[40:43], v49, s[8:11], s46 offen offset:256
    buffer_load_dwordx4 v[44:47], v49, s[8:11], s46 offen offset:384
    s_xor_b32 s50, s50, 1
    s_lshl_b32 s46, s50, 15
    s_lshl_b32 s37, s32, 9
    s_add_u32 s46, s46, s37
    v_lshrrev_b32 v96, 3, v0
    v_and_b32 v97, 0x70, v1
    v_lshl_add_u32 v96, v96, 11, v97
    v_add_u32 v97, 16384, v96
    s_mov_b32 s8, s64
    s_mov_b32 s9, s65
    s_mov_b32 s10, 0x400000
    s_mov_b32 s11, 0x00020000
    buffer_load_dwordx4 v[64:67], v96, s[8:11], s46 offen offset:0
    buffer_load_dwordx4 v[68:71], v96, s[8:11], s46 offen offset:128
    buffer_load_dwordx4 v[72:75], v96, s[8:11], s46 offen offset:256
    buffer_load_dwordx4 v[76:79], v96, s[8:11], s46 offen offset:384
    buffer_load_dwordx4 v[80:83], v97, s[8:11], s46 offen offset:0
    buffer_load_dwordx4 v[84:87], v97, s[8:11], s46 offen offset:128
    buffer_load_dwordx4 v[88:91], v97, s[8:11], s46 offen offset:256
    buffer_load_dwordx4 v[92:95], v97, s[8:11], s46 offen offset:384
    s_xor_b32 s50, s50, 1
    s_mov_b32 s86, 0x3f803f80
    v_and_b32 v56, 1, v0
    v_lshlrev_b32 v56, 7, v56
    v_bfe_u32 v57, v0, 1, 1
    v_lshl_add_u32 v56, v57, 6, v56
    v_and_b32 v57, 0x38, v0
    v_add_u32 v56, v57, v56
    s_sub_u32 s46, 127, s50
    s_lshl_b32 s46, s46, 10
    s_lshl_b32 s37, s32, 8
    s_add_u32 s46, s46, s37
    s_add_u32 s46, s46, 0x5400000
    s_waitcnt vmcnt(8)
    v_dot2_f32_bf16 v48, v16, s86, 0
    v_dot2_f32_bf16 v49, v16, v16, 0
    v_dot2_f32_bf16 v50, v24, s86, 0
    v_dot2_f32_bf16 v51, v24, v24, 0
    v_dot2_f32_bf16 v52, v32, s86, 0
    v_dot2_f32_bf16 v53, v32, v32, 0
    v_dot2_f32_bf16 v54, v40, s86, 0
    v_dot2_f32_bf16 v55, v40, v40, 0
    v_dot2_f32_bf16 v48, v17, s86, v48
    v_dot2_f32_bf16 v49, v17, v17, v49
    v_dot2_f32_bf16 v50, v25, s86, v50
    v_dot2_f32_bf16 v51, v25, v25, v51
    v_dot2_f32_bf16 v52, v33, s86, v52
    v_dot2_f32_bf16 v53, v33, v33, v53
    v_dot2_f32_bf16 v54, v41, s86, v54
    v_dot2_f32_bf16 v55, v41, v41, v55
    v_dot2_f32_bf16 v48, v18, s86, v48
    v_dot2_f32_bf16 v49, v18, v18, v49
    v_dot2_f32_bf16 v50, v26, s86, v50
    v_dot2_f32_bf16 v51, v26, v26, v51
    v_dot2_f32_bf16 v52, v34, s86, v52
    v_dot2_f32_bf16 v53, v34, v34, v53
    v_dot2_f32_bf16 v54, v42, s86, v54
    v_dot2_f32_bf16 v55, v42, v42, v55
    v_dot2_f32_bf16 v48, v19, s86, v48
    v_dot2_f32_bf16 v49, v19, v19, v49
    v_dot2_f32_bf16 v50, v27, s86, v50
    v_dot2_f32_bf16 v51, v27, v27, v51
    v_dot2_f32_bf16 v52, v35, s86, v52
    v_dot2_f32_bf16 v53, v35, v35, v53
    v_dot2_f32_bf16 v54, v43, s86, v54
    v_dot2_f32_bf16 v55, v43, v43, v55
    v_dot2_f32_bf16 v48, v20, s86, v48
    v_dot2_f32_bf16 v49, v20, v20, v49
    v_dot2_f32_bf16 v50, v28, s86, v50
    v_dot2_f32_bf16 v51, v28, v28, v51
    v_dot2_f32_bf16 v52, v36, s86, v52
    v_dot2_f32_bf16 v53, v36, v36, v53
    v_dot2_f32_bf16 v54, v44, s86, v54
    v_dot2_f32_bf16 v55, v44, v44, v55
    v_dot2_f32_bf16 v48, v21, s86, v48
    v_dot2_f32_bf16 v49, v21, v21, v49
    v_dot2_f32_bf16 v50, v29, s86, v50
    v_dot2_f32_bf16 v51, v29, v29, v51
    v_dot2_f32_bf16 v52, v37, s86, v52
    v_dot2_f32_bf16 v53, v37, v37, v53
    v_dot2_f32_bf16 v54, v45, s86, v54
    v_dot2_f32_bf16 v55, v45, v45, v55
    v_dot2_f32_bf16 v48, v22, s86, v48
    v_dot2_f32_bf16 v49, v22, v22, v49
    v_dot2_f32_bf16 v50, v30, s86, v50
    v_dot2_f32_bf16 v51, v30, v30, v51
    v_dot2_f32_bf16 v52, v38, s86, v52
    v_dot2_f32_bf16 v53, v38, v38, v53
    v_dot2_f32_bf16 v54, v46, s86, v54
    v_dot2_f32_bf16 v55, v46, v46, v55
    v_dot2_f32_bf16 v48, v23, s86, v48
    v_dot2_f32_bf16 v49, v23, v23, v49
    v_dot2_f32_bf16 v50, v31, s86, v50
    v_dot2_f32_bf16 v51, v31, v31, v51
    v_dot2_f32_bf16 v52, v39, s86, v52
    v_dot2_f32_bf16 v53, v39, v39, v53
    v_dot2_f32_bf16 v54, v47, s86, v54
    v_dot2_f32_bf16 v55, v47, v47, v55
    v_add_f32_dpp v48, v48, v48 quad_perm:[1,0,3,2] row_mask:0xf bank_mask:0xf
    v_add_f32_dpp v49, v49, v49 quad_perm:[1,0,3,2] row_mask:0xf bank_mask:0xf
    v_add_f32_dpp v50, v50, v50 quad_perm:[1,0,3,2] row_mask:0xf bank_mask:0xf
    v_add_f32_dpp v51, v51, v51 quad_perm:[1,0,3,2] row_mask:0xf bank_mask:0xf
    v_add_f32_dpp v52, v52, v52 quad_perm:[1,0,3,2] row_mask:0xf bank_mask:0xf
    v_add_f32_dpp v53, v53, v53 quad_perm:[1,0,3,2] row_mask:0xf bank_mask:0xf
    v_add_f32_dpp v54, v54, v54 quad_perm:[1,0,3,2] row_mask:0xf bank_mask:0xf
    v_add_f32_dpp v55, v55, v55 quad_perm:[1,0,3,2] row_mask:0xf bank_mask:0xf
    v_add_f32_dpp v48, v48, v48 quad_perm:[2,3,0,1] row_mask:0xf bank_mask:0xf
    v_add_f32_dpp v49, v49, v49 quad_perm:[2,3,0,1] row_mask:0xf bank_mask:0xf
    v_add_f32_dpp v50, v50, v50 quad_perm:[2,3,0,1] row_mask:0xf bank_mask:0xf
    v_add_f32_dpp v51, v51, v51 quad_perm:[2,3,0,1] row_mask:0xf bank_mask:0xf
    v_add_f32_dpp v52, v52, v52 quad_perm:[2,3,0,1] row_mask:0xf bank_mask:0xf
    v_add_f32_dpp v53, v53, v53 quad_perm:[2,3,0,1] row_mask:0xf bank_mask:0xf
    v_add_f32_dpp v54, v54, v54 quad_perm:[2,3,0,1] row_mask:0xf bank_mask:0xf
    v_add_f32_dpp v55, v55, v55 quad_perm:[2,3,0,1] row_mask:0xf bank_mask:0xf
    v_add_f32_dpp v48, v48, v48 row_half_mirror row_mask:0xf bank_mask:0xf
    v_add_f32_dpp v49, v49, v49 row_half_mirror row_mask:0xf bank_mask:0xf
    v_add_f32_dpp v50, v50, v50 row_half_mirror row_mask:0xf bank_mask:0xf
    v_add_f32_dpp v51, v51, v51 row_half_mirror row_mask:0xf bank_mask:0xf
    v_add_f32_dpp v52, v52, v52 row_half_mirror row_mask:0xf bank_mask:0xf
    v_add_f32_dpp v53, v53, v53 row_half_mirror row_mask:0xf bank_mask:0xf
    v_add_f32_dpp v54, v54, v54 row_half_mirror row_mask:0xf bank_mask:0xf
    v_add_f32_dpp v55, v55, v55 row_half_mirror row_mask:0xf bank_mask:0xf
    s_mov_b32 exec_lo, 0x2020202
    s_mov_b32 exec_hi, 0x2020202
    v_mov_b32 v48, v50
    v_mov_b32 v49, v51
    s_mov_b32 exec_lo, 0x4040404
    s_mov_b32 exec_hi, 0x4040404
    v_mov_b32 v48, v52
    v_mov_b32 v49, v53
    s_mov_b32 exec_lo, 0x8080808
    s_mov_b32 exec_hi, 0x8080808
    v_mov_b32 v48, v54
    v_mov_b32 v49, v55
    s_mov_b32 exec_lo, 0x0f0f0f0f
    s_mov_b32 exec_hi, 0x0f0f0f0f
    buffer_store_dwordx2 v[48:49], v56, s[16:19], s46 offen sc1
    s_mov_b64 exec, -1
    s_xor_b32 s50, s50, 1
    s_mov_b32 s86, 0x3f803f80
    v_and_b32 v104, 1, v0
    v_lshlrev_b32 v104, 7, v104
    v_bfe_u32 v105, v0, 1, 1
    v_lshl_add_u32 v104, v105, 6, v104
    v_and_b32 v105, 0x38, v0
    v_add_u32 v104, v105, v104
    s_sub_u32 s46, 127, s50
    s_lshl_b32 s46, s46, 10
    s_lshl_b32 s37, s32, 8
    s_add_u32 s46, s46, s37
    s_add_u32 s46, s46, 0x5400000
    s_waitcnt vmcnt(1)
    v_dot2_f32_bf16 v96, v64, s86, 0
    v_dot2_f32_bf16 v97, v64, v64, 0
    v_dot2_f32_bf16 v98, v72, s86, 0
    v_dot2_f32_bf16 v99, v72, v72, 0
    v_dot2_f32_bf16 v100, v80, s86, 0
    v_dot2_f32_bf16 v101, v80, v80, 0
    v_dot2_f32_bf16 v102, v88, s86, 0
    v_dot2_f32_bf16 v103, v88, v88, 0
    v_dot2_f32_bf16 v96, v65, s86, v96
    v_dot2_f32_bf16 v97, v65, v65, v97
    v_dot2_f32_bf16 v98, v73, s86, v98
    v_dot2_f32_bf16 v99, v73, v73, v99
    v_dot2_f32_bf16 v100, v81, s86, v100
    v_dot2_f32_bf16 v101, v81, v81, v101
    v_dot2_f32_bf16 v102, v89, s86, v102
    v_dot2_f32_bf16 v103, v89, v89, v103
    v_dot2_f32_bf16 v96, v66, s86, v96
    v_dot2_f32_bf16 v97, v66, v66, v97
    v_dot2_f32_bf16 v98, v74, s86, v98
    v_dot2_f32_bf16 v99, v74, v74, v99
    v_dot2_f32_bf16 v100, v82, s86, v100
    v_dot2_f32_bf16 v101, v82, v82, v101
    v_dot2_f32_bf16 v102, v90, s86, v102
    v_dot2_f32_bf16 v103, v90, v90, v103
    v_dot2_f32_bf16 v96, v67, s86, v96
    v_dot2_f32_bf16 v97, v67, v67, v97
    v_dot2_f32_bf16 v98, v75, s86, v98
    v_dot2_f32_bf16 v99, v75, v75, v99
    v_dot2_f32_bf16 v100, v83, s86, v100
    v_dot2_f32_bf16 v101, v83, v83, v101
    v_dot2_f32_bf16 v102, v91, s86, v102
    v_dot2_f32_bf16 v103, v91, v91, v103
    v_dot2_f32_bf16 v96, v68, s86, v96
    v_dot2_f32_bf16 v97, v68, v68, v97
    v_dot2_f32_bf16 v98, v76, s86, v98
    v_dot2_f32_bf16 v99, v76, v76, v99
    v_dot2_f32_bf16 v100, v84, s86, v100
    v_dot2_f32_bf16 v101, v84, v84, v101
    v_dot2_f32_bf16 v102, v92, s86, v102
    v_dot2_f32_bf16 v103, v92, v92, v103
    v_dot2_f32_bf16 v96, v69, s86, v96
    v_dot2_f32_bf16 v97, v69, v69, v97
    v_dot2_f32_bf16 v98, v77, s86, v98
    v_dot2_f32_bf16 v99, v77, v77, v99
    v_dot2_f32_bf16 v100, v85, s86, v100
    v_dot2_f32_bf16 v101, v85, v85, v101
    v_dot2_f32_bf16 v102, v93, s86, v102
    v_dot2_f32_bf16 v103, v93, v93, v103
    v_dot2_f32_bf16 v96, v70, s86, v96
    v_dot2_f32_bf16 v97, v70, v70, v97
    v_dot2_f32_bf16 v98, v78, s86, v98
    v_dot2_f32_bf16 v99, v78, v78, v99
    v_dot2_f32_bf16 v100, v86, s86, v100
    v_dot2_f32_bf16 v101, v86, v86, v101
    v_dot2_f32_bf16 v102, v94, s86, v102
    v_dot2_f32_bf16 v103, v94, v94, v103
    v_dot2_f32_bf16 v96, v71, s86, v96
    v_dot2_f32_bf16 v97, v71, v71, v97
    v_dot2_f32_bf16 v98, v79, s86, v98
    v_dot2_f32_bf16 v99, v79, v79, v99
    v_dot2_f32_bf16 v100, v87, s86, v100
    v_dot2_f32_bf16 v101, v87, v87, v101
    v_dot2_f32_bf16 v102, v95, s86, v102
    v_dot2_f32_bf16 v103, v95, v95, v103
    v_add_f32_dpp v96, v96, v96 quad_perm:[1,0,3,2] row_mask:0xf bank_mask:0xf
    v_add_f32_dpp v97, v97, v97 quad_perm:[1,0,3,2] row_mask:0xf bank_mask:0xf
    v_add_f32_dpp v98, v98, v98 quad_perm:[1,0,3,2] row_mask:0xf bank_mask:0xf
    v_add_f32_dpp v99, v99, v99 quad_perm:[1,0,3,2] row_mask:0xf bank_mask:0xf
    v_add_f32_dpp v100, v100, v100 quad_perm:[1,0,3,2] row_mask:0xf bank_mask:0xf
    v_add_f32_dpp v101, v101, v101 quad_perm:[1,0,3,2] row_mask:0xf bank_mask:0xf
    v_add_f32_dpp v102, v102, v102 quad_perm:[1,0,3,2] row_mask:0xf bank_mask:0xf
    v_add_f32_dpp v103, v103, v103 quad_perm:[1,0,3,2] row_mask:0xf bank_mask:0xf
    v_add_f32_dpp v96, v96, v96 quad_perm:[2,3,0,1] row_mask:0xf bank_mask:0xf
    v_add_f32_dpp v97, v97, v97 quad_perm:[2,3,0,1] row_mask:0xf bank_mask:0xf
    v_add_f32_dpp v98, v98, v98 quad_perm:[2,3,0,1] row_mask:0xf bank_mask:0xf
    v_add_f32_dpp v99, v99, v99 quad_perm:[2,3,0,1] row_mask:0xf bank_mask:0xf
    v_add_f32_dpp v100, v100, v100 quad_perm:[2,3,0,1] row_mask:0xf bank_mask:0xf
    v_add_f32_dpp v101, v101, v101 quad_perm:[2,3,0,1] row_mask:0xf bank_mask:0xf
    v_add_f32_dpp v102, v102, v102 quad_perm:[2,3,0,1] row_mask:0xf bank_mask:0xf
    v_add_f32_dpp v103, v103, v103 quad_perm:[2,3,0,1] row_mask:0xf bank_mask:0xf
    v_add_f32_dpp v96, v96, v96 row_half_mirror row_mask:0xf bank_mask:0xf
    v_add_f32_dpp v97, v97, v97 row_half_mirror row_mask:0xf bank_mask:0xf
    v_add_f32_dpp v98, v98, v98 row_half_mirror row_mask:0xf bank_mask:0xf
    v_add_f32_dpp v99, v99, v99 row_half_mirror row_mask:0xf bank_mask:0xf
    v_add_f32_dpp v100, v100, v100 row_half_mirror row_mask:0xf bank_mask:0xf
    v_add_f32_dpp v101, v101, v101 row_half_mirror row_mask:0xf bank_mask:0xf
    v_add_f32_dpp v102, v102, v102 row_half_mirror row_mask:0xf bank_mask:0xf
    v_add_f32_dpp v103, v103, v103 row_half_mirror row_mask:0xf bank_mask:0xf
    s_mov_b32 exec_lo, 0x2020202
    s_mov_b32 exec_hi, 0x2020202
    v_mov_b32 v96, v98
    v_mov_b32 v97, v99
    s_mov_b32 exec_lo, 0x4040404
    s_mov_b32 exec_hi, 0x4040404
    v_mov_b32 v96, v100
    v_mov_b32 v97, v101
    s_mov_b32 exec_lo, 0x8080808
    s_mov_b32 exec_hi, 0x8080808
    v_mov_b32 v96, v102
    v_mov_b32 v97, v103
    s_mov_b32 exec_lo, 0x0f0f0f0f
    s_mov_b32 exec_hi, 0x0f0f0f0f
    buffer_store_dwordx2 v[96:97], v104, s[16:19], s46 offen sc1
    s_mov_b64 exec, -1
    s_xor_b32 s50, s50, 1
    s_cmp_lg_u32 s32, 0
    s_cbranch_scc1 L_arv43
    s_add_u32 s20, s82, 0x80
    s_addc_u32 s21, s83, 0
    s_mov_b32 s22, 0x4
    s_mov_b32 s23, 0x00020000
    buffer_load_dword v8, v124, s[20:23], 0 offen sc1
    s_waitcnt vmcnt(0)
    v_cmp_eq_u32 vcc, v124, v8
    s_cbranch_vccnz L_spin44
L_back45:
L_arv43:
    s_waitcnt vmcnt(0)
    s_barrier
    s_add_u32 s39, s91, 65536
    buffer_store_dword v124, v124, s[16:19], s39 offen sc1
    s_lshr_b32 s51, s35, 2
    s_and_b32 s87, s35, 3
    s_mul_i32 s54, s51, 1441792
    s_lshl_b32 s37, s87, 9
    s_add_u32 s54, s54, s37
    s_mov_b32 s12, s76
    s_mov_b32 s13, s77
    s_mov_b32 s14, 0x700000
    s_mov_b32 s15, 0x00020000
    s_mov_b32 s39, 2048
    s_cmp_lg_u32 s32, 0
    s_cbranch_scc1 L_arv46
    s_add_u32 s20, s82, 0x80
    s_addc_u32 s21, s83, 0
    s_mov_b32 s22, 0x4
    s_mov_b32 s23, 0x00020000
    buffer_load_dword v48, v124, s[20:23], 0 offen sc1
    s_waitcnt vmcnt(0)
    v_cmp_eq_u32 vcc, v124, v48
    s_cbranch_vccnz L_spin47
L_back48:
L_arv46:
    s_and_b32 s38, s34, 15
    s_lshl_b32 s37, s33, 6
    s_add_u32 s37, s37, s38
    s_lshl_b32 s37, s37, 8
    v_lshl_add_u32 v48, v0, 8, s37
    s_cmp_eq_u32 s32, 0
    s_cselect_b32 s37, 1, 0
    v_cmp_le_u32 vcc, s37, v0
    s_nop 1
    v_cndmask_b32 v48, v48, 2.0, vcc
    s_mov_b32 s38, 0x5540000
    buffer_load_dword v49, v48, s[16:19], s38 offen sc1
    s_waitcnt vmcnt(0)
    v_cmp_ne_u32 vcc, 0, v49
    s_cbranch_vccnz L_spin49
L_back50:
    s_barrier
    v_lshrrev_b32 v64, 3, v0
    v_lshlrev_b32 v65, 2, v0
    v_and_b32 v65, 64, v65
    v_and_b32 v66, 0x70, v1
    v_xor_b32 v65, v65, v66
    v_mad_u32_u24 v48, v64, s39, v65
    v_add_u32 v49, 16384, v48
    v_add_u32 v50, 128, v48
    v_add_u32 v51, 16512, v48
    v_add_u32 v52, 256, v48
    v_add_u32 v53, 16640, v48
    v_add_u32 v54, 384, v48
    v_add_u32 v55, 16768, v48
    s_mul_i32 s38, s32, 32768
    s_add_u32 s54, s54, s38
    s_lshl_b32 s42, s32, 11
    s_add_u32 m0, s42, 0
    s_nop 0
    buffer_load_dwordx4 v48, s[12:15], s54 offen lds
    s_add_u32 m0, s42, 1024
    s_nop 0
    buffer_load_dwordx4 v49, s[12:15], s54 offen lds
    s_add_u32 m0, s42, 8192
    s_nop 0
    buffer_load_dwordx4 v50, s[12:15], s54 offen lds
    s_add_u32 m0, s42, 9216
    s_nop 0
    buffer_load_dwordx4 v51, s[12:15], s54 offen lds
    s_add_u32 m0, s42, 16384
    s_nop 0
    buffer_load_dwordx4 v52, s[12:15], s54 offen lds
    s_add_u32 m0, s42, 17408
    s_nop 0
    buffer_load_dwordx4 v53, s[12:15], s54 offen lds
    s_add_u32 m0, s42, 24576
    s_nop 0
    buffer_load_dwordx4 v54, s[12:15], s54 offen lds
    s_add_u32 m0, s42, 25600
    s_nop 0
    buffer_load_dwordx4 v55, s[12:15], s54 offen lds
    s_add_u32 s54, s54, 131072
    s_add_u32 m0, s42, 32768
    s_nop 0
    buffer_load_dwordx4 v48, s[12:15], s54 offen lds
    s_add_u32 m0, s42, 33792
    s_nop 0
    buffer_load_dwordx4 v49, s[12:15], s54 offen lds
    s_add_u32 m0, s42, 40960
    s_nop 0
    buffer_load_dwordx4 v50, s[12:15], s54 offen lds
    s_add_u32 m0, s42, 41984
    s_nop 0
    buffer_load_dwordx4 v51, s[12:15], s54 offen lds
    s_add_u32 m0, s42, 49152
    s_nop 0
    buffer_load_dwordx4 v52, s[12:15], s54 offen lds
    s_add_u32 m0, s42, 50176
    s_nop 0
    buffer_load_dwordx4 v53, s[12:15], s54 offen lds
    s_add_u32 m0, s42, 57344
    s_nop 0
    buffer_load_dwordx4 v54, s[12:15], s54 offen lds
    s_add_u32 m0, s42, 58368
    s_nop 0
    buffer_load_dwordx4 v55, s[12:15], s54 offen lds
    s_add_u32 s54, s54, 131072
    s_add_u32 m0, s42, 65536
    s_nop 0
    buffer_load_dwordx4 v48, s[12:15], s54 offen lds
    s_add_u32 m0, s42, 66560
    s_nop 0
    buffer_load_dwordx4 v49, s[12:15], s54 offen lds
    s_add_u32 m0, s42, 73728
    s_nop 0
    buffer_load_dwordx4 v50, s[12:15], s54 offen lds
    s_add_u32 m0, s42, 74752
    s_nop 0
    buffer_load_dwordx4 v51, s[12:15], s54 offen lds
    s_add_u32 m0, s42, 81920
    s_nop 0
    buffer_load_dwordx4 v52, s[12:15], s54 offen lds
    s_add_u32 m0, s42, 82944
    s_nop 0
    buffer_load_dwordx4 v53, s[12:15], s54 offen lds
    s_add_u32 m0, s42, 90112
    s_nop 0
    buffer_load_dwordx4 v54, s[12:15], s54 offen lds
    s_add_u32 m0, s42, 91136
    s_nop 0
    buffer_load_dwordx4 v55, s[12:15], s54 offen lds
    s_add_u32 s54, s54, 131072
    s_add_u32 m0, s42, 98304
    s_nop 0
    buffer_load_dwordx4 v48, s[12:15], s54 offen lds
    s_add_u32 m0, s42, 99328
    s_nop 0
    buffer_load_dwordx4 v49, s[12:15], s54 offen lds
    s_add_u32 m0, s42, 106496
    s_nop 0
    buffer_load_dwordx4 v50, s[12:15], s54 offen lds
    s_add_u32 m0, s42, 107520
    s_nop 0
    buffer_load_dwordx4 v51, s[12:15], s54 offen lds
    s_add_u32 m0, s42, 114688
    s_nop 0
    buffer_load_dwordx4 v52, s[12:15], s54 offen lds
    s_add_u32 m0, s42, 115712
    s_nop 0
    buffer_load_dwordx4 v53, s[12:15], s54 offen lds
    s_add_u32 m0, s42, 122880
    s_nop 0
    buffer_load_dwordx4 v54, s[12:15], s54 offen lds
    s_add_u32 m0, s42, 123904
    s_nop 0
    buffer_load_dwordx4 v55, s[12:15], s54 offen lds
    s_add_u32 s54, s54, 131072
    v_lshrrev_b32 v64, 4, v0
    v_bfe_u32 v65, v0, 2, 2
    v_lshl_add_u32 v64, v64, 3, v65
    v_lshlrev_b32 v64, 7, v64
    v_lshrrev_b32 v65, 1, v65
    v_lshl_add_u32 v64, v65, 6, v64
    v_and_b32 v65, 3, v0
    v_lshl_add_u32 v64, v65, 4, v64
    s_lshl_b32 s37, s32, 13
    s_and_b32 s38, s51, 2
    s_lshl_b32 s38, s38, 5
    s_xor_b32 s38, s38, 0
    s_add_u32 s37, s37, s38
    v_xor_b32 v56, s37, v64
    s_lshl_b32 s37, s32, 13
    s_and_b32 s38, s51, 2
    s_lshl_b32 s38, s38, 5
    s_xor_b32 s38, s38, 8
    s_add_u32 s37, s37, s38
    v_xor_b32 v57, s37, v64
    s_lshl_b32 s37, s32, 13
    s_and_b32 s38, s51, 2
    s_lshl_b32 s38, s38, 5
    s_xor_b32 s38, s38, 64
    s_add_u32 s37, s37, s38
    v_xor_b32 v58, s37, v64
    s_lshl_b32 s37, s32, 13
    s_and_b32 s38, s51, 2
    s_lshl_b32 s38, s38, 5
    s_xor_b32 s38, s38, 72
    s_add_u32 s37, s37, s38
    v_xor_b32 v59, s37, v64
    s_and_b32 s39, s51, 1
    s_lshl_b32 s37, s39, 10
    v_add_u32 v2, s37, v1
    v_xor_b32 v3, 1024, v2
    v_add_u32 v4, 98304, v2
    v_add_u32 v5, 98304, v3
    s_mul_i32 s38, s51, 11*43
    s_lshr_b32 s38, s38, 7
    s_add_u32 s38, s38, 24
    s_lshl_b32 s37, s33, 6
    s_add_u32 s37, s37, s38
    s_lshl_b32 s37, s37, 8
    v_lshl_add_u32 v6, v0, 8, s37
    s_cmp_eq_u32 s32, 0
    s_cselect_b32 s37, 5, 0
    v_cmp_le_u32 vcc, s37, v0
    s_nop 1
    v_cndmask_b32 v6, v6, 2.0, vcc
    s_mul_i32 s43, s32, 3072
    s_lshl_b32 s88, s32, 11
    s_sub_u32 s89, s88, s43
    s_mul_i32 s41, s33, 8388608
    s_add_u32 s41, s41, 0x1000000
    s_mul_i32 s37, s51, 45056
    s_add_u32 s41, s41, s37
    s_add_u32 s41, s41, s43
    s_mul_i32 s90, s33, 8388608
    s_add_u32 s90, s90, 0x2fc0000
    s_lshl_b32 s37, s87, 16
    s_add_u32 s90, s90, s37
    s_lshl_b32 s37, s32, 12
    s_add_u32 s90, s90, s37
    s_and_b32 s37, s51, 3
    s_lshl_b32 s37, s37, 14
    s_add_u32 s90, s90, s37
    v_mov_b32 v104, 0
    v_mov_b32 v105, 0
    v_mov_b32 v106, 0
    v_mov_b32 v107, 0
    v_mov_b32 v108, 0
    v_mov_b32 v109, 0
    v_mov_b32 v110, 0
    v_mov_b32 v111, 0
    v_mov_b32 v17, 0x3f80
    v_and_b32 v16, 1, v0
    v_lshlrev_b32 v16, 4, v16
    v_lshlrev_b32 v16, v16, v17
    s_mov_b32 exec_lo, 0x300003
    s_mov_b32 exec_hi, 0x30000300
    v_mov_b32 v104, v16
    v_mov_b32 v110, v16
    s_mov_b32 exec_lo, 0xc0000c
    s_mov_b32 exec_hi, 0xc0000c00
    v_mov_b32 v105, v16
    v_mov_b32 v111, v16
    s_mov_b64 exec, -1
    s_add_u32 s38, s87, 44
    s_lshl_b32 s37, s33, 6
    s_add_u32 s37, s37, s38
    s_lshl_b32 s37, s37, 8
    v_lshl_add_u32 v8, v0, 10, s37
    s_cmp_eq_u32 s32, 0
    s_cselect_b32 s37, 5, 0
    v_cmp_le_u32 vcc, s37, v0
    s_nop 1
    v_cndmask_b32 v8, v8, 2.0, vcc
    s_lshl_b32 s38, s87, 2
    s_add_u32 s38, s38, s32
    s_lshl_b32 s38, s38, 1
    s_lshr_b32 s37, s51, 1
    s_add_u32 s38, s38, s37
    s_mul_i32 s53, s33, 2097152
    s_add_u32 s53, s53, 0x7f0000
    s_lshl_b32 s37, s38, 11
    s_add_u32 s53, s53, s37
    s_lshl_b32 s37, s39, 10
    s_add_u32 s53, s53, s37
    v_and_b32 v16, 15, v0
    v_and_b32 v17, 0x30, v0
    s_lshl_b32 s38, s38, 6
    s_mov_b32 s8, s78
    s_mov_b32 s9, s79
    s_mov_b32 s10, 0x800
    s_mov_b32 s11, 0x00020000
    buffer_load_dwordx4 v[24:27], v17, s[8:11], s38 offen
    v_lshl_add_u32 v9, v16, 11, v17
    v_add_u32 v9, s38, v9
    s_lshl_b32 s50, s33, 5
    s_add_u32 s50, s50, 31
    s_sub_u32 s50, s50, s39
    v_bfe_u32 v17, v0, 4, 1
    v_lshl_add_u32 v16, v16, 1, v17
    s_lshl_b32 s37, s32, 2
    s_add_u32 s37, s37, 65536
    v_lshl_add_u32 v10, v16, 4, s37
    v_and_b32 v16, 31, v0
    v_lshrrev_b32 v12, 5, v0
    v_lshlrev_b32 v12, 30, v12
    v_lshl_add_u32 v12, v16, 2, v12
    v_lshlrev_b32 v16, 4, v16
    v_add_u32 v11, 65536, v16
    s_lshl_b32 s37, s87, 1
    s_lshr_b32 s38, s51, 1
    s_add_u32 s37, s37, s38
    s_lshl_b32 s37, s37, 7
    s_add_u32 s55, s37, 0x543fc00
    s_cmp_eq_u32 s32, 2
    s_cselect_b32 s55, s55, 0x5f00000
    v_add_u32 v60, 0, v56
    v_add_u32 v61, 0, v57
    v_add_u32 v62, 0, v58
    v_add_u32 v63, 0, v59
    s_waitcnt vmcnt(25)
    s_barrier
    ds_read_b64_tr_b16 a[0:1], v60 offset:0
    ds_read_b64_tr_b16 a[2:3], v60 offset:512
    ds_read_b64_tr_b16 a[4:5], v61 offset:0
    ds_read_b64_tr_b16 a[6:7], v61 offset:512
    ds_read_b64_tr_b16 a[8:9], v62 offset:0
    ds_read_b64_tr_b16 a[10:11], v62 offset:512
    ds_read_b64_tr_b16 a[12:13], v63 offset:0
    ds_read_b64_tr_b16 a[14:15], v63 offset:512
    ds_read_b64_tr_b16 a[16:17], v60 offset:4096
    ds_read_b64_tr_b16 a[18:19], v60 offset:4608
    ds_read_b64_tr_b16 a[20:21], v61 offset:4096
    ds_read_b64_tr_b16 a[22:23], v61 offset:4608
    ds_read_b64_tr_b16 a[24:25], v62 offset:4096
    ds_read_b64_tr_b16 a[26:27], v62 offset:4608
    ds_read_b64_tr_b16 a[28:29], v63 offset:4096
    ds_read_b64_tr_b16 a[30:31], v63 offset:4608
    s_add_u32 m0, s42, 131072
    s_nop 0
    buffer_load_dwordx4 v48, s[12:15], s54 offen lds
    s_add_u32 m0, s42, 132096
    s_nop 0
    buffer_load_dwordx4 v49, s[12:15], s54 offen lds
    s_add_u32 m0, s42, 139264
    s_nop 0
    buffer_load_dwordx4 v50, s[12:15], s54 offen lds
    s_add_u32 m0, s42, 140288
    s_nop 0
    buffer_load_dwordx4 v51, s[12:15], s54 offen lds
    s_add_u32 m0, s42, 147456
    s_nop 0
    buffer_load_dwordx4 v52, s[12:15], s54 offen lds
    s_add_u32 m0, s42, 148480
    s_nop 0
    buffer_load_dwordx4 v53, s[12:15], s54 offen lds
    s_add_u32 m0, s42, 155648
    s_nop 0
    buffer_load_dwordx4 v54, s[12:15], s54 offen lds
    s_add_u32 m0, s42, 156672
    s_nop 0
    buffer_load_dwordx4 v55, s[12:15], s54 offen lds
    s_add_u32 s54, s54, 131072
    s_waitcnt lgkmcnt(0)
    v_add_u32 v60, 32768, v56
    v_add_u32 v61, 32768, v57
    v_add_u32 v62, 32768, v58
    v_add_u32 v63, 32768, v59
    s_waitcnt vmcnt(25)
    s_barrier
    ds_read_b64_tr_b16 a[32:33], v60 offset:0
    ds_read_b64_tr_b16 a[34:35], v60 offset:512
    ds_read_b64_tr_b16 a[36:37], v61 offset:0
    ds_read_b64_tr_b16 a[38:39], v61 offset:512
    ds_read_b64_tr_b16 a[40:41], v62 offset:0
    ds_read_b64_tr_b16 a[42:43], v62 offset:512
    ds_read_b64_tr_b16 a[44:45], v63 offset:0
    ds_read_b64_tr_b16 a[46:47], v63 offset:512
    ds_read_b64_tr_b16 a[48:49], v60 offset:4096
    ds_read_b64_tr_b16 a[50:51], v60 offset:4608
    ds_read_b64_tr_b16 a[52:53], v61 offset:4096
    ds_read_b64_tr_b16 a[54:55], v61 offset:4608
    ds_read_b64_tr_b16 a[56:57], v62 offset:4096
    ds_read_b64_tr_b16 a[58:59], v62 offset:4608
    ds_read_b64_tr_b16 a[60:61], v63 offset:4096
    ds_read_b64_tr_b16 a[62:63], v63 offset:4608
    s_add_u32 m0, s42, 0
    s_nop 0
    buffer_load_dwordx4 v48, s[12:15], s54 offen lds
    s_add_u32 m0, s42, 1024
    s_nop 0
    buffer_load_dwordx4 v49, s[12:15], s54 offen lds
    s_add_u32 m0, s42, 8192
    s_nop 0
    buffer_load_dwordx4 v50, s[12:15], s54 offen lds
    s_add_u32 m0, s42, 9216
    s_nop 0
    buffer_load_dwordx4 v51, s[12:15], s54 offen lds
    s_add_u32 m0, s42, 16384
    s_nop 0
    buffer_load_dwordx4 v52, s[12:15], s54 offen lds
    s_add_u32 m0, s42, 17408
    s_nop 0
    buffer_load_dwordx4 v53, s[12:15], s54 offen lds
    s_add_u32 m0, s42, 24576
    s_nop 0
    buffer_load_dwordx4 v54, s[12:15], s54 offen lds
    s_add_u32 m0, s42, 25600
    s_nop 0
    buffer_load_dwordx4 v55, s[12:15], s54 offen lds
    s_add_u32 s54, s54, 131072
    s_waitcnt lgkmcnt(0)
    v_add_u32 v60, 65536, v56
    v_add_u32 v61, 65536, v57
    v_add_u32 v62, 65536, v58
    v_add_u32 v63, 65536, v59
    s_waitcnt vmcnt(25)
    s_barrier
    ds_read_b64_tr_b16 a[64:65], v60 offset:0
    ds_read_b64_tr_b16 a[66:67], v60 offset:512
    ds_read_b64_tr_b16 a[68:69], v61 offset:0
    ds_read_b64_tr_b16 a[70:71], v61 offset:512
    ds_read_b64_tr_b16 a[72:73], v62 offset:0
    ds_read_b64_tr_b16 a[74:75], v62 offset:512
    ds_read_b64_tr_b16 a[76:77], v63 offset:0
    ds_read_b64_tr_b16 a[78:79], v63 offset:512
    ds_read_b64_tr_b16 a[80:81], v60 offset:4096
    ds_read_b64_tr_b16 a[82:83], v60 offset:4608
    ds_read_b64_tr_b16 a[84:85], v61 offset:4096
    ds_read_b64_tr_b16 a[86:87], v61 offset:4608
    ds_read_b64_tr_b16 a[88:89], v62 offset:4096
    ds_read_b64_tr_b16 a[90:91], v62 offset:4608
    ds_read_b64_tr_b16 a[92:93], v63 offset:4096
    ds_read_b64_tr_b16 a[94:95], v63 offset:4608
    s_add_u32 m0, s42, 32768
    s_nop 0
    buffer_load_dwordx4 v48, s[12:15], s54 offen lds
    s_add_u32 m0, s42, 33792
    s_nop 0
    buffer_load_dwordx4 v49, s[12:15], s54 offen lds
    s_add_u32 m0, s42, 40960
    s_nop 0
    buffer_load_dwordx4 v50, s[12:15], s54 offen lds
    s_add_u32 m0, s42, 41984
    s_nop 0
    buffer_load_dwordx4 v51, s[12:15], s54 offen lds
    s_add_u32 m0, s42, 49152
    s_nop 0
    buffer_load_dwordx4 v52, s[12:15], s54 offen lds
    s_add_u32 m0, s42, 50176
    s_nop 0
    buffer_load_dwordx4 v53, s[12:15], s54 offen lds
    s_add_u32 m0, s42, 57344
    s_nop 0
    buffer_load_dwordx4 v54, s[12:15], s54 offen lds
    s_add_u32 m0, s42, 58368
    s_nop 0
    buffer_load_dwordx4 v55, s[12:15], s54 offen lds
    s_add_u32 s54, s54, 131072
    s_waitcnt lgkmcnt(0)
    v_add_u32 v60, 98304, v56
    v_add_u32 v61, 98304, v57
    v_add_u32 v62, 98304, v58
    v_add_u32 v63, 98304, v59
    s_waitcnt vmcnt(25)
    s_barrier
    ds_read_b64_tr_b16 a[96:97], v60 offset:0
    ds_read_b64_tr_b16 a[98:99], v60 offset:512
    ds_read_b64_tr_b16 a[100:101], v61 offset:0
    ds_read_b64_tr_b16 a[102:103], v61 offset:512
    ds_read_b64_tr_b16 a[104:105], v62 offset:0
    ds_read_b64_tr_b16 a[106:107], v62 offset:512
    ds_read_b64_tr_b16 a[108:109], v63 offset:0
    ds_read_b64_tr_b16 a[110:111], v63 offset:512
    ds_read_b64_tr_b16 a[112:113], v60 offset:4096
    ds_read_b64_tr_b16 a[114:115], v60 offset:4608
    ds_read_b64_tr_b16 a[116:117], v61 offset:4096
    ds_read_b64_tr_b16 a[118:119], v61 offset:4608
    ds_read_b64_tr_b16 a[120:121], v62 offset:4096
    ds_read_b64_tr_b16 a[122:123], v62 offset:4608
    ds_read_b64_tr_b16 a[124:125], v63 offset:4096
    ds_read_b64_tr_b16 a[126:127], v63 offset:4608
    s_add_u32 m0, s42, 65536
    s_nop 0
    buffer_load_dwordx4 v48, s[12:15], s54 offen lds
    s_add_u32 m0, s42, 66560
    s_nop 0
    buffer_load_dwordx4 v49, s[12:15], s54 offen lds
    s_add_u32 m0, s42, 73728
    s_nop 0
    buffer_load_dwordx4 v50, s[12:15], s54 offen lds
    s_add_u32 m0, s42, 74752
    s_nop 0
    buffer_load_dwordx4 v51, s[12:15], s54 offen lds
    s_add_u32 m0, s42, 81920
    s_nop 0
    buffer_load_dwordx4 v52, s[12:15], s54 offen lds
    s_add_u32 m0, s42, 82944
    s_nop 0
    buffer_load_dwordx4 v53, s[12:15], s54 offen lds
    s_add_u32 m0, s42, 90112
    s_nop 0
    buffer_load_dwordx4 v54, s[12:15], s54 offen lds
    s_add_u32 m0, s42, 91136
    s_nop 0
    buffer_load_dwordx4 v55, s[12:15], s54 offen lds
    s_add_u32 s54, s54, 131072
    s_waitcnt lgkmcnt(0)
    v_add_u32 v60, 131072, v56
    v_add_u32 v61, 131072, v57
    v_add_u32 v62, 131072, v58
    v_add_u32 v63, 131072, v59
    s_waitcnt vmcnt(24)
    s_barrier
    ds_read_b64_tr_b16 a[128:129], v60 offset:0
    ds_read_b64_tr_b16 a[130:131], v60 offset:512
    ds_read_b64_tr_b16 a[132:133], v61 offset:0
    ds_read_b64_tr_b16 a[134:135], v61 offset:512
    ds_read_b64_tr_b16 a[136:137], v62 offset:0
    ds_read_b64_tr_b16 a[138:139], v62 offset:512
    ds_read_b64_tr_b16 a[140:141], v63 offset:0
    ds_read_b64_tr_b16 a[142:143], v63 offset:512
    ds_read_b64_tr_b16 a[144:145], v60 offset:4096
    ds_read_b64_tr_b16 a[146:147], v60 offset:4608
    ds_read_b64_tr_b16 a[148:149], v61 offset:4096
    ds_read_b64_tr_b16 a[150:151], v61 offset:4608
    ds_read_b64_tr_b16 a[152:153], v62 offset:4096
    ds_read_b64_tr_b16 a[154:155], v62 offset:4608
    ds_read_b64_tr_b16 a[156:157], v63 offset:4096
    ds_read_b64_tr_b16 a[158:159], v63 offset:4608
    s_add_u32 m0, s42, 98304
    s_nop 0
    buffer_load_dwordx4 v48, s[12:15], s54 offen lds
    s_add_u32 m0, s42, 99328
    s_nop 0
    buffer_load_dwordx4 v49, s[12:15], s54 offen lds
    s_add_u32 m0, s42, 106496
    s_nop 0
    buffer_load_dwordx4 v50, s[12:15], s54 offen lds
    s_add_u32 m0, s42, 107520
    s_nop 0
    buffer_load_dwordx4 v51, s[12:15], s54 offen lds
    s_add_u32 m0, s42, 114688
    s_nop 0
    buffer_load_dwordx4 v52, s[12:15], s54 offen lds
    s_add_u32 m0, s42, 115712
    s_nop 0
    buffer_load_dwordx4 v53, s[12:15], s54 offen lds
    s_add_u32 m0, s42, 122880
    s_nop 0
    buffer_load_dwordx4 v54, s[12:15], s54 offen lds
    s_add_u32 m0, s42, 123904
    s_nop 0
    buffer_load_dwordx4 v55, s[12:15], s54 offen lds
    s_add_u32 s54, s54, 131072
    s_waitcnt lgkmcnt(0)
    v_add_u32 v60, 0, v56
    v_add_u32 v61, 0, v57
    v_add_u32 v62, 0, v58
    v_add_u32 v63, 0, v59
    s_waitcnt vmcnt(24)
    s_barrier
    ds_read_b64_tr_b16 a[160:161], v60 offset:0
    ds_read_b64_tr_b16 a[162:163], v60 offset:512
    ds_read_b64_tr_b16 a[164:165], v61 offset:0
    ds_read_b64_tr_b16 a[166:167], v61 offset:512
    ds_read_b64_tr_b16 a[168:169], v62 offset:0
    ds_read_b64_tr_b16 a[170:171], v62 offset:512
    ds_read_b64_tr_b16 a[172:173], v63 offset:0
    ds_read_b64_tr_b16 a[174:175], v63 offset:512
    ds_read_b64_tr_b16 a[176:177], v60 offset:4096
    ds_read_b64_tr_b16 a[178:179], v60 offset:4608
    ds_read_b64_tr_b16 a[180:181], v61 offset:4096
    ds_read_b64_tr_b16 a[182:183], v61 offset:4608
    ds_read_b64_tr_b16 a[184:185], v62 offset:4096
    ds_read_b64_tr_b16 a[186:187], v62 offset:4608
    ds_read_b64_tr_b16 a[188:189], v63 offset:4096
    ds_read_b64_tr_b16 a[190:191], v63 offset:4608
    s_add_u32 m0, s42, 131072
    s_nop 0
    buffer_load_dwordx4 v48, s[12:15], s54 offen lds
    s_add_u32 m0, s42, 132096
    s_nop 0
    buffer_load_dwordx4 v49, s[12:15], s54 offen lds
    s_add_u32 m0, s42, 139264
    s_nop 0
    buffer_load_dwordx4 v50, s[12:15], s54 offen lds
    s_add_u32 m0, s42, 140288
    s_nop 0
    buffer_load_dwordx4 v51, s[12:15], s54 offen lds
    s_add_u32 m0, s42, 147456
    s_nop 0
    buffer_load_dwordx4 v52, s[12:15], s54 offen lds
    s_add_u32 m0, s42, 148480
    s_nop 0
    buffer_load_dwordx4 v53, s[12:15], s54 offen lds
    s_add_u32 m0, s42, 155648
    s_nop 0
    buffer_load_dwordx4 v54, s[12:15], s54 offen lds
    s_add_u32 m0, s42, 156672
    s_nop 0
    buffer_load_dwordx4 v55, s[12:15], s54 offen lds
    s_add_u32 s54, s54, 131072
    s_waitcnt lgkmcnt(0)
    v_add_u32 v60, 32768, v56
    v_add_u32 v61, 32768, v57
    v_add_u32 v62, 32768, v58
    v_add_u32 v63, 32768, v59
    s_waitcnt vmcnt(24)
    s_barrier
    ds_read_b64_tr_b16 a[192:193], v60 offset:0
    ds_read_b64_tr_b16 a[194:195], v60 offset:512
    ds_read_b64_tr_b16 a[196:197], v61 offset:0
    ds_read_b64_tr_b16 a[198:199], v61 offset:512
    ds_read_b64_tr_b16 a[200:201], v62 offset:0
    ds_read_b64_tr_b16 a[202:203], v62 offset:512
    ds_read_b64_tr_b16 a[204:205], v63 offset:0
    ds_read_b64_tr_b16 a[206:207], v63 offset:512
    ds_read_b64_tr_b16 a[208:209], v60 offset:4096
    ds_read_b64_tr_b16 a[210:211], v60 offset:4608
    ds_read_b64_tr_b16 a[212:213], v61 offset:4096
    ds_read_b64_tr_b16 a[214:215], v61 offset:4608
    ds_read_b64_tr_b16 a[216:217], v62 offset:4096
    ds_read_b64_tr_b16 a[218:219], v62 offset:4608
    ds_read_b64_tr_b16 a[220:221], v63 offset:4096
    ds_read_b64_tr_b16 a[222:223], v63 offset:4608
    s_add_u32 m0, s42, 0
    s_nop 0
    buffer_load_dwordx4 v48, s[12:15], s54 offen lds
    s_add_u32 m0, s42, 1024
    s_nop 0
    buffer_load_dwordx4 v49, s[12:15], s54 offen lds
    s_add_u32 m0, s42, 8192
    s_nop 0
    buffer_load_dwordx4 v50, s[12:15], s54 offen lds
    s_add_u32 m0, s42, 9216
    s_nop 0
    buffer_load_dwordx4 v51, s[12:15], s54 offen lds
    s_add_u32 m0, s42, 16384
    s_nop 0
    buffer_load_dwordx4 v52, s[12:15], s54 offen lds
    s_add_u32 m0, s42, 17408
    s_nop 0
    buffer_load_dwordx4 v53, s[12:15], s54 offen lds
    s_add_u32 m0, s42, 24576
    s_nop 0
    buffer_load_dwordx4 v54, s[12:15], s54 offen lds
    s_add_u32 m0, s42, 25600
    s_nop 0
    buffer_load_dwordx4 v55, s[12:15], s54 offen lds
    s_add_u32 s54, s54, 131072
    s_waitcnt lgkmcnt(0)
    v_add_u32 v60, 65536, v56
    v_add_u32 v61, 65536, v57
    v_add_u32 v62, 65536, v58
    v_add_u32 v63, 65536, v59
    s_waitcnt vmcnt(24)
    s_barrier
    ds_read_b64_tr_b16 a[224:225], v60 offset:0
    ds_read_b64_tr_b16 a[226:227], v60 offset:512
    ds_read_b64_tr_b16 a[228:229], v61 offset:0
    ds_read_b64_tr_b16 a[230:231], v61 offset:512
    ds_read_b64_tr_b16 a[232:233], v62 offset:0
    ds_read_b64_tr_b16 a[234:235], v62 offset:512
    ds_read_b64_tr_b16 a[236:237], v63 offset:0
    ds_read_b64_tr_b16 a[238:239], v63 offset:512
    ds_read_b64_tr_b16 a[240:241], v60 offset:4096
    ds_read_b64_tr_b16 a[242:243], v60 offset:4608
    ds_read_b64_tr_b16 a[244:245], v61 offset:4096
    ds_read_b64_tr_b16 a[246:247], v61 offset:4608
    ds_read_b64_tr_b16 a[248:249], v62 offset:4096
    ds_read_b64_tr_b16 a[250:251], v62 offset:4608
    ds_read_b64_tr_b16 a[252:253], v63 offset:4096
    ds_read_b64_tr_b16 a[254:255], v63 offset:4608
    s_waitcnt lgkmcnt(0)
    v_add_u32 v60, 98304, v56
    v_add_u32 v61, 98304, v57
    v_add_u32 v62, 98304, v58
    v_add_u32 v63, 98304, v59
    s_waitcnt vmcnt(16)
    s_barrier
    ds_read_b64_tr_b16 v[160:161], v60 offset:0
    ds_read_b64_tr_b16 v[162:163], v60 offset:512
    ds_read_b64_tr_b16 v[164:165], v61 offset:0
    ds_read_b64_tr_b16 v[166:167], v61 offset:512
    ds_read_b64_tr_b16 v[168:169], v62 offset:0
    ds_read_b64_tr_b16 v[170:171], v62 offset:512
    ds_read_b64_tr_b16 v[172:173], v63 offset:0
    ds_read_b64_tr_b16 v[174:175], v63 offset:512
    ds_read_b64_tr_b16 v[176:177], v60 offset:4096
    ds_read_b64_tr_b16 v[178:179], v60 offset:4608
    ds_read_b64_tr_b16 v[180:181], v61 offset:4096
    ds_read_b64_tr_b16 v[182:183], v61 offset:4608
    ds_read_b64_tr_b16 v[184:185], v62 offset:4096
    ds_read_b64_tr_b16 v[186:187], v62 offset:4608
    ds_read_b64_tr_b16 v[188:189], v63 offset:4096
    ds_read_b64_tr_b16 v[190:191], v63 offset:4608
    s_waitcnt lgkmcnt(0)
    v_add_u32 v60, 131072, v56
    v_add_u32 v61, 131072, v57
    v_add_u32 v62, 131072, v58
    v_add_u32 v63, 131072, v59
    s_waitcnt vmcnt(8)
    s_barrier
    ds_read_b64_tr_b16 v[192:193], v60 offset:0
    ds_read_b64_tr_b16 v[194:195], v60 offset:512
    ds_read_b64_tr_b16 v[196:197], v61 offset:0
    ds_read_b64_tr_b16 v[198:199], v61 offset:512
    ds_read_b64_tr_b16 v[200:201], v62 offset:0
    ds_read_b64_tr_b16 v[202:203], v62 offset:512
    ds_read_b64_tr_b16 v[204:205], v63 offset:0
    ds_read_b64_tr_b16 v[206:207], v63 offset:512
    ds_read_b64_tr_b16 v[208:209], v60 offset:4096
    ds_read_b64_tr_b16 v[210:211], v60 offset:4608
    ds_read_b64_tr_b16 v[212:213], v61 offset:4096
    ds_read_b64_tr_b16 v[214:215], v61 offset:4608
    ds_read_b64_tr_b16 v[216:217], v62 offset:4096
    ds_read_b64_tr_b16 v[218:219], v62 offset:4608
    ds_read_b64_tr_b16 v[220:221], v63 offset:4096
    ds_read_b64_tr_b16 v[222:223], v63 offset:4608
    s_waitcnt lgkmcnt(0)
    v_add_u32 v60, 0, v56
    v_add_u32 v61, 0, v57
    v_add_u32 v62, 0, v58
    v_add_u32 v63, 0, v59
    s_waitcnt vmcnt(0)
    s_barrier
    ds_read_b64_tr_b16 v[224:225], v60 offset:0
    ds_read_b64_tr_b16 v[226:227], v60 offset:512
    ds_read_b64_tr_b16 v[228:229], v61 offset:0
    ds_read_b64_tr_b16 v[230:231], v61 offset:512
    ds_read_b64_tr_b16 v[232:233], v62 offset:0
    ds_read_b64_tr_b16 v[234:235], v62 offset:512
    ds_read_b64_tr_b16 v[236:237], v63 offset:0
    ds_read_b64_tr_b16 v[238:239], v63 offset:512
    ds_read_b64_tr_b16 v[240:241], v60 offset:4096
    ds_read_b64_tr_b16 v[242:243], v60 offset:4608
    ds_read_b64_tr_b16 v[244:245], v61 offset:4096
    ds_read_b64_tr_b16 v[246:247], v61 offset:4608
    ds_read_b64_tr_b16 v[248:249], v62 offset:4096
    ds_read_b64_tr_b16 v[250:251], v62 offset:4608
    ds_read_b64_tr_b16 v[252:253], v63 offset:4096
    ds_read_b64_tr_b16 v[254:255], v63 offset:4608
    s_waitcnt lgkmcnt(0)
    s_barrier
    s_mov_b32 s37, 0xffff0000
    v_lshlrev_b32 v112, 16, v24
    v_and_b32 v113, s37, v24
    v_lshlrev_b32 v114, 16, v25
    v_and_b32 v115, s37, v25
    v_lshlrev_b32 v116, 16, v26
    v_and_b32 v117, s37, v26
    v_lshlrev_b32 v118, 16, v27
    v_and_b32 v119, s37, v27
    s_cmp_lg_u32 s32, 0
    s_cbranch_scc1 L_arv51
    s_add_u32 s20, s82, 0x80
    s_addc_u32 s21, s83, 0
    s_mov_b32 s22, 0x4
    s_mov_b32 s23, 0x00020000
    buffer_load_dword v80, v124, s[20:23], 0 offen sc1
    s_waitcnt vmcnt(0)
    v_cmp_eq_u32 vcc, v124, v80
    s_cbranch_vccnz L_spin52
L_back53:
L_arv51:
    s_add_u32 s96, s41, 8126464
    s_mov_b32 s98, s41
    s_mov_b32 s45, 0x5560000
    buffer_load_dword v96, v6, s[16:19], s45 offen sc1
    s_waitcnt vmcnt(0)
    v_cmp_ne_u32 vcc, 0, v96
    s_cbranch_vccnz L_spin54
L_back55:
    s_barrier
    s_add_u32 m0, s43, 0
    s_add_u32 s42, s41, 0
    buffer_load_dwordx4 v1, s[16:19], s42 offen offset:0 sc1 lds
    buffer_load_dwordx4 v1, s[16:19], s42 offen offset:1024 sc1 lds
    buffer_load_dwordx4 v1, s[16:19], s42 offen offset:2048 sc1 lds
    s_add_u32 m0, s43, 12288
    s_add_u32 s42, s41, 12288
    buffer_load_dwordx4 v1, s[16:19], s42 offen offset:0 sc1 lds
    buffer_load_dwordx4 v1, s[16:19], s42 offen offset:1024 sc1 lds
    buffer_load_dwordx4 v1, s[16:19], s42 offen offset:2048 sc1 lds
    s_add_u32 m0, s43, 24576
    s_add_u32 s42, s41, 24576
    buffer_load_dwordx4 v1, s[16:19], s42 offen offset:0 sc1 lds
    buffer_load_dwordx4 v1, s[16:19], s42 offen offset:1024 sc1 lds
    buffer_load_dwordx4 v1, s[16:19], s42 offen offset:2048 sc1 lds
    s_add_u32 s45, s45, 131072
    s_waitcnt vmcnt(0) lgkmcnt(0)
    s_barrier
    s_mov_b32 s52, 0x5e00000
    s_mov_b32 s46, 0x5e00000
    s_add_u32 s20, s84, 0x5e00000
    s_addc_u32 s21, s85, 0
    s_mov_b32 s22, 0x400000
    s_mov_b32 s23, 0x00020000
    ds_read_b128 v[80:83], v2 offset:0
    ds_read_b128 v[84:87], v3 offset:0
    s_mov_b32 s36, 0
    s_waitcnt lgkmcnt(0)
    s_nop 7
L_bf_b0:
    s_waitcnt lgkmcnt(0)
    v_mfma_f32_16x16x32_bf16 v[16:19], a[0:3], v[80:83], v[112:115]
    s_sub_u32 s47, s45, 393216
    ds_read_b128 v[88:91], v2 offset:2048
    v_mfma_f32_16x16x32_bf16 v[24:27], a[0:3], v[84:87], 0
    buffer_load_dword v13, v8, s[16:19], s47 offen sc1
    v_mfma_f32_16x16x32_bf16 v[28:31], a[4:7], v[84:87], 0
    s_and_b32 s38, s53, 0xffffffff
    ds_read_b128 v[92:95], v3 offset:2048
    s_cmp_eq_u32 s36, 0
    v_mfma_f32_16x16x32_bf16 v[20:23], a[4:7], v[80:83], v[116:119]
    s_cselect_b32 s38, 0x5e00000, s38
    v_mfma_f32_16x16x32_bf16 v[32:35], a[8:11], v[80:83], 0
    buffer_load_dwordx4 v[136:139], v1, s[16:19], s38 offen sc1
    v_mfma_f32_16x16x32_bf16 v[40:43], a[8:11], v[84:87], 0
    s_add_u32 s53, s53, 65536
    ds_read_b128 v[144:147], v11 offset:0
    s_and_b32 s44, s90, 0xffffffff
    v_mfma_f32_16x16x32_bf16 v[44:47], a[12:15], v[84:87], 0
    s_cmp_eq_u32 s36, 0
    s_cselect_b32 s44, 0x5e00000, s44
    s_xor_b32 s49, s44, 16384
    v_mfma_f32_16x16x32_bf16 v[36:39], a[12:15], v[80:83], 0
    s_waitcnt lgkmcnt(1)
    v_cvt_pk_bf16_f32 v56, v56, v57
    v_cvt_pk_bf16_f32 v57, v58, v59
    v_mfma_f32_16x16x32_bf16 v[16:19], a[16:19], v[88:91], v[16:19]
    ds_read_b128 v[80:83], v2 offset:4096
    v_cvt_pk_bf16_f32 v58, v60, v61
    v_mfma_f32_16x16x32_bf16 v[24:27], a[16:19], v[92:95], v[24:27]
    v_cvt_pk_bf16_f32 v59, v62, v63
    v_mfma_f32_16x16x32_bf16 v[28:31], a[20:23], v[92:95], v[28:31]
    s_waitcnt lgkmcnt(1)
    ds_read_b128 v[84:87], v3 offset:4096
    v_add_f32 v144, v144, v145
    v_mfma_f32_16x16x32_bf16 v[20:23], a[20:23], v[88:91], v[20:23]
    buffer_store_dwordx4 v[56:59], v1, s[16:19], s49 offen offset:0 sc1
    v_mfma_f32_16x16x32_bf16 v[32:35], a[24:27], v[88:91], v[32:35]
    s_xor_b32 s49, s44, 32768
    v_cvt_pk_bf16_f32 v64, v64, v65
    v_cvt_pk_bf16_f32 v65, v66, v67
    v_mfma_f32_16x16x32_bf16 v[40:43], a[24:27], v[92:95], v[40:43]
    v_cvt_pk_bf16_f32 v66, v68, v69
    v_cvt_pk_bf16_f32 v67, v70, v71
    v_mfma_f32_16x16x32_bf16 v[44:47], a[28:31], v[92:95], v[44:47]
    buffer_store_dwordx4 v[64:67], v1, s[16:19], s49 offen offset:1024 sc1
    v_mfma_f32_16x16x32_bf16 v[36:39], a[28:31], v[88:91], v[36:39]
    s_waitcnt lgkmcnt(0)
    v_add_f32 v146, v146, v147
    v_add_f32 v144, v144, v146
    v_mfma_f32_16x16x32_bf16 v[16:19], a[32:35], v[80:83], v[16:19]
    s_xor_b32 s49, s44, 49152
    ds_read_b128 v[88:91], v2 offset:6144
    v_cvt_pk_bf16_f32 v72, v72, v73
    v_mfma_f32_16x16x32_bf16 v[24:27], a[32:35], v[84:87], v[24:27]
    s_add_u32 m0, s88, 36864
    v_cvt_pk_bf16_f32 v73, v74, v75
    v_cvt_pk_bf16_f32 v74, v76, v77
    v_mfma_f32_16x16x32_bf16 v[28:31], a[36:39], v[84:87], v[28:31]
    s_add_u32 s42, s41, 36864
    ds_read_b128 v[92:95], v3 offset:6144
    v_cvt_pk_bf16_f32 v75, v78, v79
    v_mfma_f32_16x16x32_bf16 v[20:23], a[36:39], v[80:83], v[20:23]
    buffer_store_dwordx4 v[72:75], v1, s[16:19], s49 offen offset:2048 sc1
    v_mfma_f32_16x16x32_bf16 v[32:35], a[40:43], v[80:83], v[32:35]
    s_add_u32 s42, s42, s89
    s_add_u32 s90, s90, 262144
    v_mfma_f32_16x16x32_bf16 v[40:43], a[40:43], v[84:87], v[40:43]
    v_mfma_f32_16x16x32_bf16 v[44:47], a[44:47], v[84:87], v[44:47]
    buffer_load_dwordx4 v1, s[16:19], s42 offen offset:0 sc1 lds
    v_mfma_f32_16x16x32_bf16 v[36:39], a[44:47], v[80:83], v[36:39]
    s_waitcnt lgkmcnt(0)
    v_mfma_f32_16x16x32_bf16 v[16:19], a[48:51], v[88:91], v[16:19]
    ds_read_b128 v[80:83], v2 offset:8192
    v_mfma_f32_16x16x32_bf16 v[24:27], a[48:51], v[92:95], v[24:27]
    buffer_store_dword v144, v12, s[16:19], s46 offen sc1
    v_mfma_f32_16x16x32_bf16 v[28:31], a[52:55], v[92:95], v[28:31]
    ds_read_b128 v[84:87], v3 offset:8192
    v_mfma_f32_16x16x32_bf16 v[20:23], a[52:55], v[88:91], v[20:23]
    v_mfma_f32_16x16x32_bf16 v[32:35], a[56:59], v[88:91], v[32:35]
    buffer_load_dwordx4 v1, s[16:19], s42 offen offset:1024 sc1 lds
    v_mfma_f32_16x16x32_bf16 v[40:43], a[56:59], v[92:95], v[40:43]
    s_add_u32 s98, s98, 262144
    s_min_u32 s98, s98, s96
    s_and_b32 s41, s98, 0xffffffff
    v_mfma_f32_16x16x32_bf16 v[44:47], a[60:63], v[92:95], v[44:47]
    v_mfma_f32_16x16x32_bf16 v[36:39], a[60:63], v[88:91], v[36:39]
    s_waitcnt lgkmcnt(0)
    v_mfma_f32_16x16x32_bf16 v[16:19], a[64:67], v[80:83], v[16:19]
    ds_read_b128 v[88:91], v2 offset:10240
    v_mfma_f32_16x16x32_bf16 v[24:27], a[64:67], v[84:87], v[24:27]
    v_mfma_f32_16x16x32_bf16 v[28:31], a[68:71], v[84:87], v[28:31]
    ds_read_b128 v[92:95], v3 offset:10240
    v_mfma_f32_16x16x32_bf16 v[20:23], a[68:71], v[80:83], v[20:23]
    s_waitcnt vmcnt(7)
    v_cmp_ne_u32 vcc, 0, v13
    v_mfma_f32_16x16x32_bf16 v[32:35], a[72:75], v[80:83], v[32:35]
    v_mfma_f32_16x16x32_bf16 v[40:43], a[72:75], v[84:87], v[40:43]
    s_cbranch_vccnz L_spin56
L_back57:
    v_mfma_f32_16x16x32_bf16 v[44:47], a[76:79], v[84:87], v[44:47]
    v_mfma_f32_16x16x32_bf16 v[36:39], a[76:79], v[80:83], v[36:39]
    s_waitcnt vmcnt(8) lgkmcnt(0)
    s_barrier
    v_mfma_f32_16x16x32_bf16 v[16:19], a[80:83], v[88:91], v[16:19]
    s_sub_u32 s48, s90, 524288
    ds_read_b128 v[80:83], v2 offset:12288
    s_and_b32 s48, s48, 0xffffffff
    v_mfma_f32_16x16x32_bf16 v[24:27], a[80:83], v[92:95], v[24:27]
    s_cmp_lt_u32 s36, 2
    s_cselect_b32 s48, s52, s48
    v_mfma_f32_16x16x32_bf16 v[28:31], a[84:87], v[92:95], v[28:31]
    ds_read_b128 v[84:87], v3 offset:12288
    v_mfma_f32_16x16x32_bf16 v[20:23], a[84:87], v[88:91], v[20:23]
    buffer_load_dwordx4 v[140:143], v1, s[16:19], s48 offen offset:0 sc1
    v_mfma_f32_16x16x32_bf16 v[32:35], a[88:91], v[88:91], v[32:35]
    v_mfma_f32_16x16x32_bf16 v[40:43], a[88:91], v[92:95], v[40:43]
    v_mfma_f32_16x16x32_bf16 v[44:47], a[92:95], v[92:95], v[44:47]
    buffer_load_dwordx4 v[144:147], v1, s[16:19], s48 offen offset:1024 sc1
    v_mfma_f32_16x16x32_bf16 v[36:39], a[92:95], v[88:91], v[36:39]
    s_waitcnt lgkmcnt(0)
    v_mfma_f32_16x16x32_bf16 v[16:19], a[96:99], v[80:83], v[16:19]
    ds_read_b128 v[88:91], v2 offset:14336
    v_mfma_f32_16x16x32_bf16 v[24:27], a[96:99], v[84:87], v[24:27]
    buffer_load_dwordx4 v[148:151], v1, s[16:19], s48 offen offset:2048 sc1
    v_mfma_f32_16x16x32_bf16 v[28:31], a[100:103], v[84:87], v[28:31]
    ds_read_b128 v[92:95], v3 offset:14336
    v_mfma_f32_16x16x32_bf16 v[20:23], a[100:103], v[80:83], v[20:23]
    v_mfma_f32_16x16x32_bf16 v[32:35], a[104:107], v[80:83], v[32:35]
    buffer_load_dwordx4 v[152:155], v1, s[16:19], s48 offen offset:3072 sc1
    v_mfma_f32_16x16x32_bf16 v[40:43], a[104:107], v[84:87], v[40:43]
    s_sub_u32 s47, s36, 2
    s_cmp_lt_u32 s47, 16
    s_cselect_b32 s48, 0x5000000, s52
    v_mfma_f32_16x16x32_bf16 v[44:47], a[108:111], v[84:87], v[44:47]
    s_add_u32 s20, s84, s48
    s_addc_u32 s21, s85, 0
    s_cmp_ge_i32 s47, 16
    v_mfma_f32_16x16x32_bf16 v[36:39], a[108:111], v[80:83], v[36:39]
    s_waitcnt lgkmcnt(0)
    s_cselect_b32 s20, s80, s20
    s_cselect_b32 s21, s81, s21
    v_mfma_f32_16x16x32_bf16 v[16:19], a[112:115], v[88:91], v[16:19]
    s_and_b32 s48, s47, 15
    ds_read_b128 v[80:83], v2 offset:16384
    s_lshl_b32 s48, s48, 1
    v_mfma_f32_16x16x32_bf16 v[24:27], a[112:115], v[92:95], v[24:27]
    s_sub_u32 s48, s50, s48
    s_lshl_b32 s46, s48, 10
    s_sub_u32 s46, s55, s46
    v_mfma_f32_16x16x32_bf16 v[28:31], a[116:119], v[92:95], v[28:31]
    s_cmp_lt_u32 s47, 16
    ds_read_b128 v[84:87], v3 offset:16384
    s_cselect_b32 s46, s46, s52
    v_mfma_f32_16x16x32_bf16 v[20:23], a[116:119], v[88:91], v[20:23]
    buffer_load_dword v96, v6, s[16:19], s45 offen sc1
    v_mfma_f32_16x16x32_bf16 v[32:35], a[120:123], v[88:91], v[32:35]
    s_add_u32 m0, s43, 98304
    s_add_u32 s42, s41, 0
    s_lshl_b32 s48, s48, 15
    v_mfma_f32_16x16x32_bf16 v[40:43], a[120:123], v[92:95], v[40:43]
    v_mfma_f32_16x16x32_bf16 v[44:47], a[124:127], v[92:95], v[44:47]
    v_mfma_f32_16x16x32_bf16 v[36:39], a[124:127], v[88:91], v[36:39]
    s_waitcnt lgkmcnt(0)
    v_mfma_f32_16x16x32_bf16 v[16:19], a[128:131], v[80:83], v[16:19]
    ds_read_b128 v[88:91], v2 offset:18432
    v_mfma_f32_16x16x32_bf16 v[24:27], a[128:131], v[84:87], v[24:27]
    v_mfma_f32_16x16x32_bf16 v[28:31], a[132:135], v[84:87], v[28:31]
    ds_read_b128 v[92:95], v3 offset:18432
    v_mfma_f32_16x16x32_bf16 v[20:23], a[132:135], v[80:83], v[20:23]
    v_mfma_f32_16x16x32_bf16 v[32:35], a[136:139], v[80:83], v[32:35]
    v_mfma_f32_16x16x32_bf16 v[40:43], a[136:139], v[84:87], v[40:43]
    v_mfma_f32_16x16x32_bf16 v[44:47], a[140:143], v[84:87], v[44:47]
    v_mfma_f32_16x16x32_bf16 v[36:39], a[140:143], v[80:83], v[36:39]
    s_waitcnt lgkmcnt(0)
    v_mfma_f32_16x16x32_bf16 v[16:19], a[144:147], v[88:91], v[16:19]
    ds_read_b128 v[80:83], v2 offset:20480
    v_mfma_f32_16x16x32_bf16 v[24:27], a[144:147], v[92:95], v[24:27]
    v_mfma_f32_16x16x32_bf16 v[28:31], a[148:151], v[92:95], v[28:31]
    ds_read_b128 v[84:87], v3 offset:20480
    v_mfma_f32_16x16x32_bf16 v[20:23], a[148:151], v[88:91], v[20:23]
    v_mfma_f32_16x16x32_bf16 v[32:35], a[152:155], v[88:91], v[32:35]
    v_mfma_f32_16x16x32_bf16 v[40:43], a[152:155], v[92:95], v[40:43]
    v_mfma_f32_16x16x32_bf16 v[44:47], a[156:159], v[92:95], v[44:47]
    v_mfma_f32_16x16x32_bf16 v[36:39], a[156:159], v[88:91], v[36:39]
    s_waitcnt lgkmcnt(0)
    v_mfma_f32_16x16x32_bf16 v[16:19], a[160:163], v[80:83], v[16:19]
    ds_read_b128 v[88:91], v2 offset:22528
    v_mfma_f32_16x16x32_bf16 v[24:27], a[160:163], v[84:87], v[24:27]
    v_mfma_f32_16x16x32_bf16 v[28:31], a[164:167], v[84:87], v[28:31]
    ds_read_b128 v[92:95], v3 offset:22528
    v_mfma_f32_16x16x32_bf16 v[20:23], a[164:167], v[80:83], v[20:23]
    v_mfma_f32_16x16x32_bf16 v[32:35], a[168:171], v[80:83], v[32:35]
    v_mfma_f32_16x16x32_bf16 v[40:43], a[168:171], v[84:87], v[40:43]
    v_mfma_f32_16x16x32_bf16 v[44:47], a[172:175], v[84:87], v[44:47]
    v_mfma_f32_16x16x32_bf16 v[36:39], a[172:175], v[80:83], v[36:39]
    s_waitcnt lgkmcnt(0)
    v_mfma_f32_16x16x32_bf16 v[16:19], a[176:179], v[88:91], v[16:19]
    ds_read_b128 v[80:83], v2 offset:24576
    v_mfma_f32_16x16x32_bf16 v[24:27], a[176:179], v[92:95], v[24:27]
    v_mfma_f32_16x16x32_bf16 v[28:31], a[180:183], v[92:95], v[28:31]
    ds_read_b128 v[84:87], v3 offset:24576
    v_mfma_f32_16x16x32_bf16 v[20:23], a[180:183], v[88:91], v[20:23]
    v_mfma_f32_16x16x32_bf16 v[32:35], a[184:187], v[88:91], v[32:35]
    v_mfma_f32_16x16x32_bf16 v[40:43], a[184:187], v[92:95], v[40:43]
    v_mfma_f32_16x16x32_bf16 v[44:47], a[188:191], v[92:95], v[44:47]
    v_mfma_f32_16x16x32_bf16 v[36:39], a[188:191], v[88:91], v[36:39]
    s_waitcnt lgkmcnt(0)
    v_mfma_f32_16x16x32_bf16 v[16:19], a[192:195], v[80:83], v[16:19]
    ds_read_b128 v[88:91], v2 offset:26624
    v_mfma_f32_16x16x32_bf16 v[24:27], a[192:195], v[84:87], v[24:27]
    v_mfma_f32_16x16x32_bf16 v[28:31], a[196:199], v[84:87], v[28:31]
    ds_read_b128 v[92:95], v3 offset:26624
    v_mfma_f32_16x16x32_bf16 v[20:23], a[196:199], v[80:83], v[20:23]
    v_mfma_f32_16x16x32_bf16 v[32:35], a[200:203], v[80:83], v[32:35]
    v_mfma_f32_16x16x32_bf16 v[40:43], a[200:203], v[84:87], v[40:43]
    v_mfma_f32_16x16x32_bf16 v[44:47], a[204:207], v[84:87], v[44:47]
    v_mfma_f32_16x16x32_bf16 v[36:39], a[204:207], v[80:83], v[36:39]
    s_waitcnt lgkmcnt(0)
    v_mfma_f32_16x16x32_bf16 v[16:19], a[208:211], v[88:91], v[16:19]
    s_waitcnt vmcnt(0)
    ds_read_b128 v[80:83], v2 offset:28672
    v_cmp_ne_u32 vcc, 0, v96
    v_mfma_f32_16x16x32_bf16 v[24:27], a[208:211], v[92:95], v[24:27]
    v_mfma_f32_16x16x32_bf16 v[28:31], a[212:215], v[92:95], v[28:31]
    s_cbranch_vccnz L_spin58
L_back59:
    ds_read_b128 v[84:87], v3 offset:28672
    s_barrier
    v_mfma_f32_16x16x32_bf16 v[20:23], a[212:215], v[88:91], v[20:23]
    buffer_load_dwordx4 v1, s[16:19], s42 offen offset:0 sc1 lds
    v_mfma_f32_16x16x32_bf16 v[32:35], a[216:219], v[88:91], v[32:35]
    v_mfma_f32_16x16x32_bf16 v[40:43], a[216:219], v[92:95], v[40:43]
    v_mfma_f32_16x16x32_bf16 v[44:47], a[220:223], v[92:95], v[44:47]
    buffer_load_dwordx4 v1, s[16:19], s42 offen offset:1024 sc1 lds
    v_mfma_f32_16x16x32_bf16 v[36:39], a[220:223], v[88:91], v[36:39]
    s_waitcnt lgkmcnt(0)
    v_mfma_f32_16x16x32_bf16 v[16:19], a[224:227], v[80:83], v[16:19]
    ds_read_b128 v[88:91], v2 offset:30720
    v_mfma_f32_16x16x32_bf16 v[24:27], a[224:227], v[84:87], v[24:27]
    buffer_load_dwordx4 v1, s[16:19], s42 offen offset:2048 sc1 lds
    v_mfma_f32_16x16x32_bf16 v[28:31], a[228:231], v[84:87], v[28:31]
    ds_read_b128 v[92:95], v3 offset:30720
    v_mfma_f32_16x16x32_bf16 v[20:23], a[228:231], v[80:83], v[20:23]
    v_mfma_f32_16x16x32_bf16 v[32:35], a[232:235], v[80:83], v[32:35]
    buffer_store_dword v124, v124, s[16:19], s91 offen sc1
    v_mfma_f32_16x16x32_bf16 v[40:43], a[232:235], v[84:87], v[40:43]
    s_add_u32 s91, s91, 131072
    s_add_u32 m0, s43, 110592
    s_add_u32 s42, s41, 12288
    v_mfma_f32_16x16x32_bf16 v[44:47], a[236:239], v[84:87], v[44:47]
    s_add_u32 s39, s91, -327680
    v_mfma_f32_16x16x32_bf16 v[36:39], a[236:239], v[80:83], v[36:39]
    s_waitcnt lgkmcnt(0)
    v_mfma_f32_16x16x32_bf16 v[16:19], a[240:243], v[88:91], v[16:19]
    ds_read_b128 v[80:83], v2 offset:32768
    v_mfma_f32_16x16x32_bf16 v[24:27], a[240:243], v[92:95], v[24:27]
    buffer_store_dword v124, v124, s[16:19], s39 offen sc1
    v_mfma_f32_16x16x32_bf16 v[28:31], a[244:247], v[92:95], v[28:31]
    s_waitcnt vmcnt(6)
    ds_read_b128 v[84:87], v3 offset:32768
    v_mfma_f32_16x16x32_bf16 v[128:131], v[104:107], v[140:143], v[128:131]
    v_mfma_f32_16x16x32_bf16 v[132:135], v[108:111], v[140:143], v[132:135]
    v_mfma_f32_16x16x32_bf16 v[128:131], v[104:107], v[144:147], v[128:131]
    v_mfma_f32_16x16x32_bf16 v[132:135], v[108:111], v[144:147], v[132:135]
    v_mfma_f32_16x16x32_bf16 v[128:131], v[104:107], v[148:151], v[128:131]
    v_mfma_f32_16x16x32_bf16 v[132:135], v[108:111], v[148:151], v[132:135]
    v_mfma_f32_16x16x32_bf16 v[128:131], v[104:107], v[152:155], v[128:131]
    v_mfma_f32_16x16x32_bf16 v[132:135], v[108:111], v[152:155], v[132:135]
    v_mfma_f32_16x16x32_bf16 v[20:23], a[244:247], v[88:91], v[20:23]
    v_mfma_f32_16x16x32_bf16 v[32:35], a[248:251], v[88:91], v[32:35]
    buffer_load_dwordx4 v1, s[16:19], s42 offen offset:0 sc1 lds
    v_mfma_f32_16x16x32_bf16 v[40:43], a[248:251], v[92:95], v[40:43]
    v_cvt_pk_bf16_f32 v140, v128, v129
    v_cvt_pk_bf16_f32 v141, v130, v131
    v_mfma_f32_16x16x32_bf16 v[44:47], a[252:255], v[92:95], v[44:47]
    v_cvt_pk_bf16_f32 v142, v132, v133
    v_cvt_pk_bf16_f32 v143, v134, v135
    v_mfma_f32_16x16x32_bf16 v[36:39], a[252:255], v[88:91], v[36:39]
    s_waitcnt lgkmcnt(0)
    v_mfma_f32_16x16x32_bf16 v[16:19], v[160:163], v[80:83], v[16:19]
    ds_read_b128 v[88:91], v2 offset:34816
    v_mfma_f32_16x16x32_bf16 v[24:27], v[160:163], v[84:87], v[24:27]
    buffer_load_dwordx4 v1, s[16:19], s42 offen offset:1024 sc1 lds
    v_mfma_f32_16x16x32_bf16 v[28:31], v[164:167], v[84:87], v[28:31]
    ds_read_b128 v[92:95], v3 offset:34816
    v_mfma_f32_16x16x32_bf16 v[20:23], v[164:167], v[80:83], v[20:23]
    v_mfma_f32_16x16x32_bf16 v[32:35], v[168:171], v[80:83], v[32:35]
    buffer_store_dwordx4 v[140:143], v9, s[20:23], s48 offen sc1
    v_mfma_f32_16x16x32_bf16 v[40:43], v[168:171], v[84:87], v[40:43]
    v_add_f32 v100, v128, v129
    v_mul_f32 v101, v128, v128
    v_mfma_f32_16x16x32_bf16 v[44:47], v[172:175], v[84:87], v[44:47]
    v_fmac_f32 v101, v129, v129
    v_add_f32 v100, v100, v130
    v_mfma_f32_16x16x32_bf16 v[36:39], v[172:175], v[80:83], v[36:39]
    s_waitcnt lgkmcnt(0)
    v_fmac_f32 v101, v130, v130
    v_add_f32 v100, v100, v131
    v_mfma_f32_16x16x32_bf16 v[16:19], v[176:179], v[88:91], v[16:19]
    ds_read_b128 v[80:83], v2 offset:36864
    v_fmac_f32 v101, v131, v131
    v_mfma_f32_16x16x32_bf16 v[24:27], v[176:179], v[92:95], v[24:27]
    buffer_load_dwordx4 v1, s[16:19], s42 offen offset:2048 sc1 lds
    v_mfma_f32_16x16x32_bf16 v[28:31], v[180:183], v[92:95], v[28:31]
    s_add_u32 m0, s43, 122880
    ds_read_b128 v[84:87], v3 offset:36864
    v_add_f32 v100, v100, v132
    v_mfma_f32_16x16x32_bf16 v[20:23], v[180:183], v[88:91], v[20:23]
    s_add_u32 s42, s41, 24576
    v_fmac_f32 v101, v132, v132
    v_add_f32 v100, v100, v133
    v_mfma_f32_16x16x32_bf16 v[32:35], v[184:187], v[88:91], v[32:35]
    v_fmac_f32 v101, v133, v133
    v_add_f32 v100, v100, v134
    v_mfma_f32_16x16x32_bf16 v[40:43], v[184:187], v[92:95], v[40:43]
    v_fmac_f32 v101, v134, v134
    v_add_f32 v100, v100, v135
    v_mfma_f32_16x16x32_bf16 v[44:47], v[188:191], v[92:95], v[44:47]
    buffer_load_dwordx4 v1, s[16:19], s42 offen offset:0 sc1 lds
    v_mfma_f32_16x16x32_bf16 v[36:39], v[188:191], v[88:91], v[36:39]
    s_waitcnt lgkmcnt(0)
    v_fmac_f32 v101, v135, v135
    v_mfma_f32_16x16x32_bf16 v[16:19], v[192:195], v[80:83], v[16:19]
    ds_read_b128 v[88:91], v2 offset:38912
    v_mfma_f32_16x16x32_bf16 v[24:27], v[192:195], v[84:87], v[24:27]
    v_permlane16_swap_b32 v100, v101
    v_mfma_f32_16x16x32_bf16 v[28:31], v[196:199], v[84:87], v[28:31]
    ds_read_b128 v[92:95], v3 offset:38912
    v_add_f32 v100, v100, v101
    v_mfma_f32_16x16x32_bf16 v[20:23], v[196:199], v[80:83], v[20:23]
    buffer_load_dwordx4 v1, s[16:19], s42 offen offset:1024 sc1 lds
    v_mfma_f32_16x16x32_bf16 v[32:35], v[200:203], v[80:83], v[32:35]
    v_mov_b32 v102, v100
    v_mfma_f32_16x16x32_bf16 v[40:43], v[200:203], v[84:87], v[40:43]
    v_permlane32_swap_b32 v100, v102
    v_mfma_f32_16x16x32_bf16 v[44:47], v[204:207], v[84:87], v[44:47]
    v_add_f32 v100, v100, v102
    v_mfma_f32_16x16x32_bf16 v[36:39], v[204:207], v[80:83], v[36:39]
    s_waitcnt lgkmcnt(0)
    ds_write_b32 v10, v100 offset:512
    v_mfma_f32_16x16x32_bf16 v[16:19], v[208:211], v[88:91], v[16:19]
    s_waitcnt vmcnt(22)
    ds_read_b128 v[80:83], v2 offset:40960
    v_mfma_f32_16x16x32_bf16 v[128:131], v[104:107], v[136:139], v[48:51]
    buffer_load_dwordx4 v1, s[16:19], s42 offen offset:2048 sc1 lds
    v_mfma_f32_16x16x32_bf16 v[24:27], v[208:211], v[92:95], v[24:27]
    v_mfma_f32_16x16x32_bf16 v[132:135], v[108:111], v[136:139], v[52:55]
    s_add_u32 s45, s45, 131072
    v_mfma_f32_16x16x32_bf16 v[28:31], v[212:215], v[92:95], v[28:31]
    ds_read_b128 v[84:87], v3 offset:40960
    v_mfma_f32_16x16x32_bf16 v[20:23], v[212:215], v[88:91], v[20:23]
    v_mfma_f32_16x16x32_bf16 v[32:35], v[216:219], v[88:91], v[32:35]
    v_mfma_f32_16x16x32_bf16 v[40:43], v[216:219], v[92:95], v[40:43]
    v_mfma_f32_16x16x32_bf16 v[44:47], v[220:223], v[92:95], v[44:47]
    v_mfma_f32_16x16x32_bf16 v[36:39], v[220:223], v[88:91], v[36:39]
    s_waitcnt lgkmcnt(0)
    v_mfma_f32_16x16x32_bf16 v[16:19], v[224:227], v[80:83], v[16:19]
    ds_read_b128 v[88:91], v2 offset:43008
    v_mfma_f32_16x16x32_bf16 v[24:27], v[224:227], v[84:87], v[24:27]
    v_mfma_f32_16x16x32_bf16 v[28:31], v[228:231], v[84:87], v[28:31]
    ds_read_b128 v[92:95], v3 offset:43008
    v_mfma_f32_16x16x32_bf16 v[20:23], v[228:231], v[80:83], v[20:23]
    v_mfma_f32_16x16x32_bf16 v[32:35], v[232:235], v[80:83], v[32:35]
    v_mfma_f32_16x16x32_bf16 v[40:43], v[232:235], v[84:87], v[40:43]
    v_mfma_f32_16x16x32_bf16 v[44:47], v[236:239], v[84:87], v[44:47]
    v_mfma_f32_16x16x32_bf16 v[36:39], v[236:239], v[80:83], v[36:39]
    s_waitcnt vmcnt(9) lgkmcnt(0)
    s_barrier
    v_mfma_f32_16x16x32_bf16 v[16:19], v[240:243], v[88:91], v[16:19]
    ds_read_b128 v[80:83], v4 offset:0
    v_mfma_f32_16x16x32_bf16 v[24:27], v[240:243], v[92:95], v[24:27]
    v_mfma_f32_16x16x32_bf16 v[28:31], v[244:247], v[92:95], v[28:31]
    ds_read_b128 v[84:87], v5 offset:0
    v_mfma_f32_16x16x32_bf16 v[20:23], v[244:247], v[88:91], v[20:23]
    v_mfma_f32_16x16x32_bf16 v[32:35], v[248:251], v[88:91], v[32:35]
    v_mfma_f32_16x16x32_bf16 v[40:43], v[248:251], v[92:95], v[40:43]
    v_mfma_f32_16x16x32_bf16 v[44:47], v[252:255], v[92:95], v[44:47]
    v_mfma_f32_16x16x32_bf16 v[36:39], v[252:255], v[88:91], v[36:39]
    s_add_u32 s36, s36, 1
L_bf_b1:
    s_waitcnt lgkmcnt(0)
    v_mfma_f32_16x16x32_bf16 v[48:51], a[0:3], v[80:83], v[112:115]
    s_sub_u32 s47, s45, 393216
    ds_read_b128 v[88:91], v4 offset:2048
    v_mfma_f32_16x16x32_bf16 v[56:59], a[0:3], v[84:87], 0
    buffer_load_dword v13, v8, s[16:19], s47 offen sc1
    v_mfma_f32_16x16x32_bf16 v[60:63], a[4:7], v[84:87], 0
    s_and_b32 s38, s53, 0xffffffff
    ds_read_b128 v[92:95], v5 offset:2048
    s_cmp_eq_u32 s36, 0
    v_mfma_f32_16x16x32_bf16 v[52:55], a[4:7], v[80:83], v[116:119]
    s_cselect_b32 s38, 0x5e00000, s38
    v_mfma_f32_16x16x32_bf16 v[64:67], a[8:11], v[80:83], 0
    buffer_load_dwordx4 v[136:139], v1, s[16:19], s38 offen sc1
    v_mfma_f32_16x16x32_bf16 v[72:75], a[8:11], v[84:87], 0
    s_add_u32 s53, s53, 65536
    ds_read_b128 v[144:147], v11 offset:512
    s_and_b32 s44, s90, 0xffffffff
    v_mfma_f32_16x16x32_bf16 v[76:79], a[12:15], v[84:87], 0
    s_cmp_eq_u32 s36, 0
    s_cselect_b32 s44, 0x5e00000, s44
    s_xor_b32 s49, s44, 16384
    v_mfma_f32_16x16x32_bf16 v[68:71], a[12:15], v[80:83], 0
    s_waitcnt lgkmcnt(1)
    v_cvt_pk_bf16_f32 v24, v24, v25
    v_cvt_pk_bf16_f32 v25, v26, v27
    v_mfma_f32_16x16x32_bf16 v[48:51], a[16:19], v[88:91], v[48:51]
    ds_read_b128 v[80:83], v4 offset:4096
    v_cvt_pk_bf16_f32 v26, v28, v29
    v_mfma_f32_16x16x32_bf16 v[56:59], a[16:19], v[92:95], v[56:59]
    v_cvt_pk_bf16_f32 v27, v30, v31
    v_mfma_f32_16x16x32_bf16 v[60:63], a[20:23], v[92:95], v[60:63]
    s_waitcnt lgkmcnt(1)
    ds_read_b128 v[84:87], v5 offset:4096
    v_add_f32 v144, v144, v145
    v_mfma_f32_16x16x32_bf16 v[52:55], a[20:23], v[88:91], v[52:55]
    buffer_store_dwordx4 v[24:27], v1, s[16:19], s49 offen offset:0 sc1
    v_mfma_f32_16x16x32_bf16 v[64:67], a[24:27], v[88:91], v[64:67]
    s_xor_b32 s49, s44, 32768
    v_cvt_pk_bf16_f32 v32, v32, v33
    v_cvt_pk_bf16_f32 v33, v34, v35
    v_mfma_f32_16x16x32_bf16 v[72:75], a[24:27], v[92:95], v[72:75]
    v_cvt_pk_bf16_f32 v34, v36, v37
    v_cvt_pk_bf16_f32 v35, v38, v39
    v_mfma_f32_16x16x32_bf16 v[76:79], a[28:31], v[92:95], v[76:79]
    buffer_store_dwordx4 v[32:35], v1, s[16:19], s49 offen offset:1024 sc1
    v_mfma_f32_16x16x32_bf16 v[68:71], a[28:31], v[88:91], v[68:71]
    s_waitcnt lgkmcnt(0)
    v_add_f32 v146, v146, v147
    v_add_f32 v144, v144, v146
    v_mfma_f32_16x16x32_bf16 v[48:51], a[32:35], v[80:83], v[48:51]
    s_xor_b32 s49, s44, 49152
    ds_read_b128 v[88:91], v4 offset:6144
    v_cvt_pk_bf16_f32 v40, v40, v41
    v_mfma_f32_16x16x32_bf16 v[56:59], a[32:35], v[84:87], v[56:59]
    s_add_u32 m0, s88, 135168
    v_cvt_pk_bf16_f32 v41, v42, v43
    v_cvt_pk_bf16_f32 v42, v44, v45
    v_mfma_f32_16x16x32_bf16 v[60:63], a[36:39], v[84:87], v[60:63]
    s_add_u32 s42, s41, 36864
    ds_read_b128 v[92:95], v5 offset:6144
    v_cvt_pk_bf16_f32 v43, v46, v47
    v_mfma_f32_16x16x32_bf16 v[52:55], a[36:39], v[80:83], v[52:55]
    buffer_store_dwordx4 v[40:43], v1, s[16:19], s49 offen offset:2048 sc1
    v_mfma_f32_16x16x32_bf16 v[64:67], a[40:43], v[80:83], v[64:67]
    s_add_u32 s42, s42, s89
    s_add_u32 s90, s90, 262144
    v_mfma_f32_16x16x32_bf16 v[72:75], a[40:43], v[84:87], v[72:75]
    v_mfma_f32_16x16x32_bf16 v[76:79], a[44:47], v[84:87], v[76:79]
    buffer_load_dwordx4 v1, s[16:19], s42 offen offset:0 sc1 lds
    v_mfma_f32_16x16x32_bf16 v[68:71], a[44:47], v[80:83], v[68:71]
    s_waitcnt lgkmcnt(0)
    v_mfma_f32_16x16x32_bf16 v[48:51], a[48:51], v[88:91], v[48:51]
    ds_read_b128 v[80:83], v4 offset:8192
    v_mfma_f32_16x16x32_bf16 v[56:59], a[48:51], v[92:95], v[56:59]
    buffer_store_dword v144, v12, s[16:19], s46 offen sc1
    v_mfma_f32_16x16x32_bf16 v[60:63], a[52:55], v[92:95], v[60:63]
    ds_read_b128 v[84:87], v5 offset:8192
    v_mfma_f32_16x16x32_bf16 v[52:55], a[52:55], v[88:91], v[52:55]
    v_mfma_f32_16x16x32_bf16 v[64:67], a[56:59], v[88:91], v[64:67]
    buffer_load_dwordx4 v1, s[16:19], s42 offen offset:1024 sc1 lds
    v_mfma_f32_16x16x32_bf16 v[72:75], a[56:59], v[92:95], v[72:75]
    s_add_u32 s98, s98, 262144
    s_min_u32 s98, s98, s96
    s_and_b32 s41, s98, 0xffffffff
    v_mfma_f32_16x16x32_bf16 v[76:79], a[60:63], v[92:95], v[76:79]
    v_mfma_f32_16x16x32_bf16 v[68:71], a[60:63], v[88:91], v[68:71]
    s_waitcnt lgkmcnt(0)
    v_mfma_f32_16x16x32_bf16 v[48:51], a[64:67], v[80:83], v[48:51]
    ds_read_b128 v[88:91], v4 offset:10240
    v_mfma_f32_16x16x32_bf16 v[56:59], a[64:67], v[84:87], v[56:59]
    v_mfma_f32_16x16x32_bf16 v[60:63], a[68:71], v[84:87], v[60:63]
    ds_read_b128 v[92:95], v5 offset:10240
    v_mfma_f32_16x16x32_bf16 v[52:55], a[68:71], v[80:83], v[52:55]
    s_waitcnt vmcnt(7)
    v_cmp_ne_u32 vcc, 0, v13
    v_mfma_f32_16x16x32_bf16 v[64:67], a[72:75], v[80:83], v[64:67]
    v_mfma_f32_16x16x32_bf16 v[72:75], a[72:75], v[84:87], v[72:75]
    s_cbranch_vccnz L_spin60
L_back61:
    v_mfma_f32_16x16x32_bf16 v[76:79], a[76:79], v[84:87], v[76:79]
    v_mfma_f32_16x16x32_bf16 v[68:71], a[76:79], v[80:83], v[68:71]
    s_waitcnt vmcnt(8) lgkmcnt(0)
    s_barrier
    v_mfma_f32_16x16x32_bf16 v[48:51], a[80:83], v[88:91], v[48:51]
    s_sub_u32 s48, s90, 524288
    ds_read_b128 v[80:83], v4 offset:12288
    s_and_b32 s48, s48, 0xffffffff
    v_mfma_f32_16x16x32_bf16 v[56:59], a[80:83], v[92:95], v[56:59]
    s_cmp_lt_u32 s36, 2
    s_cselect_b32 s48, s52, s48
    v_mfma_f32_16x16x32_bf16 v[60:63], a[84:87], v[92:95], v[60:63]
    ds_read_b128 v[84:87], v5 offset:12288
    v_mfma_f32_16x16x32_bf16 v[52:55], a[84:87], v[88:91], v[52:55]
    buffer_load_dwordx4 v[140:143], v1, s[16:19], s48 offen offset:0 sc1
    v_mfma_f32_16x16x32_bf16 v[64:67], a[88:91], v[88:91], v[64:67]
    v_mfma_f32_16x16x32_bf16 v[72:75], a[88:91], v[92:95], v[72:75]
    v_mfma_f32_16x16x32_bf16 v[76:79], a[92:95], v[92:95], v[76:79]
    buffer_load_dwordx4 v[144:147], v1, s[16:19], s48 offen offset:1024 sc1
    v_mfma_f32_16x16x32_bf16 v[68:71], a[92:95], v[88:91], v[68:71]
    s_waitcnt lgkmcnt(0)
    v_mfma_f32_16x16x32_bf16 v[48:51], a[96:99], v[80:83], v[48:51]
    ds_read_b128 v[88:91], v4 offset:14336
    v_mfma_f32_16x16x32_bf16 v[56:59], a[96:99], v[84:87], v[56:59]
    buffer_load_dwordx4 v[148:151], v1, s[16:19], s48 offen offset:2048 sc1
    v_mfma_f32_16x16x32_bf16 v[60:63], a[100:103], v[84:87], v[60:63]
    ds_read_b128 v[92:95], v5 offset:14336
    v_mfma_f32_16x16x32_bf16 v[52:55], a[100:103], v[80:83], v[52:55]
    v_mfma_f32_16x16x32_bf16 v[64:67], a[104:107], v[80:83], v[64:67]
    buffer_load_dwordx4 v[152:155], v1, s[16:19], s48 offen offset:3072 sc1
    v_mfma_f32_16x16x32_bf16 v[72:75], a[104:107], v[84:87], v[72:75]
    s_sub_u32 s47, s36, 2
    s_cmp_lt_u32 s47, 16
    s_cselect_b32 s48, 0x5000000, s52
    v_mfma_f32_16x16x32_bf16 v[76:79], a[108:111], v[84:87], v[76:79]
    s_add_u32 s20, s84, s48
    s_addc_u32 s21, s85, 0
    s_cmp_ge_i32 s47, 16
    v_mfma_f32_16x16x32_bf16 v[68:71], a[108:111], v[80:83], v[68:71]
    s_waitcnt lgkmcnt(0)
    s_cselect_b32 s20, s80, s20
    s_cselect_b32 s21, s81, s21
    v_mfma_f32_16x16x32_bf16 v[48:51], a[112:115], v[88:91], v[48:51]
    s_and_b32 s48, s47, 15
    ds_read_b128 v[80:83], v4 offset:16384
    s_lshl_b32 s48, s48, 1
    v_mfma_f32_16x16x32_bf16 v[56:59], a[112:115], v[92:95], v[56:59]
    s_sub_u32 s48, s50, s48
    s_lshl_b32 s46, s48, 10
    s_sub_u32 s46, s55, s46
    v_mfma_f32_16x16x32_bf16 v[60:63], a[116:119], v[92:95], v[60:63]
    s_cmp_lt_u32 s47, 16
    ds_read_b128 v[84:87], v5 offset:16384
    s_cselect_b32 s46, s46, s52
    v_mfma_f32_16x16x32_bf16 v[52:55], a[116:119], v[88:91], v[52:55]
    buffer_load_dword v96, v6, s[16:19], s45 offen sc1
    v_mfma_f32_16x16x32_bf16 v[64:67], a[120:123], v[88:91], v[64:67]
    s_add_u32 m0, s43, 0
    s_add_u32 s42, s41, 0
    s_lshl_b32 s48, s48, 15
    v_mfma_f32_16x16x32_bf16 v[72:75], a[120:123], v[92:95], v[72:75]
    v_mfma_f32_16x16x32_bf16 v[76:79], a[124:127], v[92:95], v[76:79]
    v_mfma_f32_16x16x32_bf16 v[68:71], a[124:127], v[88:91], v[68:71]
    s_waitcnt lgkmcnt(0)
    v_mfma_f32_16x16x32_bf16 v[48:51], a[128:131], v[80:83], v[48:51]
    ds_read_b128 v[88:91], v4 offset:18432
    v_mfma_f32_16x16x32_bf16 v[56:59], a[128:131], v[84:87], v[56:59]
    v_mfma_f32_16x16x32_bf16 v[60:63], a[132:135], v[84:87], v[60:63]
    ds_read_b128 v[92:95], v5 offset:18432
    v_mfma_f32_16x16x32_bf16 v[52:55], a[132:135], v[80:83], v[52:55]
    v_mfma_f32_16x16x32_bf16 v[64:67], a[136:139], v[80:83], v[64:67]
    v_mfma_f32_16x16x32_bf16 v[72:75], a[136:139], v[84:87], v[72:75]
    v_mfma_f32_16x16x32_bf16 v[76:79], a[140:143], v[84:87], v[76:79]
    v_mfma_f32_16x16x32_bf16 v[68:71], a[140:143], v[80:83], v[68:71]
    s_waitcnt lgkmcnt(0)
    v_mfma_f32_16x16x32_bf16 v[48:51], a[144:147], v[88:91], v[48:51]
    ds_read_b128 v[80:83], v4 offset:20480
    v_mfma_f32_16x16x32_bf16 v[56:59], a[144:147], v[92:95], v[56:59]
    v_mfma_f32_16x16x32_bf16 v[60:63], a[148:151], v[92:95], v[60:63]
    ds_read_b128 v[84:87], v5 offset:20480
    v_mfma_f32_16x16x32_bf16 v[52:55], a[148:151], v[88:91], v[52:55]
    v_mfma_f32_16x16x32_bf16 v[64:67], a[152:155], v[88:91], v[64:67]
    v_mfma_f32_16x16x32_bf16 v[72:75], a[152:155], v[92:95], v[72:75]
    v_mfma_f32_16x16x32_bf16 v[76:79], a[156:159], v[92:95], v[76:79]
    v_mfma_f32_16x16x32_bf16 v[68:71], a[156:159], v[88:91], v[68:71]
    s_waitcnt lgkmcnt(0)
    v_mfma_f32_16x16x32_bf16 v[48:51], a[160:163], v[80:83], v[48:51]
    ds_read_b128 v[88:91], v4 offset:22528
    v_mfma_f32_16x16x32_bf16 v[56:59], a[160:163], v[84:87], v[56:59]
    v_mfma_f32_16x16x32_bf16 v[60:63], a[164:167], v[84:87], v[60:63]
    ds_read_b128 v[92:95], v5 offset:22528
    v_mfma_f32_16x16x32_bf16 v[52:55], a[164:167], v[80:83], v[52:55]
    v_mfma_f32_16x16x32_bf16 v[64:67], a[168:171], v[80:83], v[64:67]
    v_mfma_f32_16x16x32_bf16 v[72:75], a[168:171], v[84:87], v[72:75]
    v_mfma_f32_16x16x32_bf16 v[76:79], a[172:175], v[84:87], v[76:79]
    v_mfma_f32_16x16x32_bf16 v[68:71], a[172:175], v[80:83], v[68:71]
    s_waitcnt lgkmcnt(0)
    v_mfma_f32_16x16x32_bf16 v[48:51], a[176:179], v[88:91], v[48:51]
    ds_read_b128 v[80:83], v4 offset:24576
    v_mfma_f32_16x16x32_bf16 v[56:59], a[176:179], v[92:95], v[56:59]
    v_mfma_f32_16x16x32_bf16 v[60:63], a[180:183], v[92:95], v[60:63]
    ds_read_b128 v[84:87], v5 offset:24576
    v_mfma_f32_16x16x32_bf16 v[52:55], a[180:183], v[88:91], v[52:55]
    v_mfma_f32_16x16x32_bf16 v[64:67], a[184:187], v[88:91], v[64:67]
    v_mfma_f32_16x16x32_bf16 v[72:75], a[184:187], v[92:95], v[72:75]
    v_mfma_f32_16x16x32_bf16 v[76:79], a[188:191], v[92:95], v[76:79]
    v_mfma_f32_16x16x32_bf16 v[68:71], a[188:191], v[88:91], v[68:71]
    s_waitcnt lgkmcnt(0)
    v_mfma_f32_16x16x32_bf16 v[48:51], a[192:195], v[80:83], v[48:51]
    ds_read_b128 v[88:91], v4 offset:26624
    v_mfma_f32_16x16x32_bf16 v[56:59], a[192:195], v[84:87], v[56:59]
    v_mfma_f32_16x16x32_bf16 v[60:63], a[196:199], v[84:87], v[60:63]
    ds_read_b128 v[92:95], v5 offset:26624
    v_mfma_f32_16x16x32_bf16 v[52:55], a[196:199], v[80:83], v[52:55]
    v_mfma_f32_16x16x32_bf16 v[64:67], a[200:203], v[80:83], v[64:67]
    v_mfma_f32_16x16x32_bf16 v[72:75], a[200:203], v[84:87], v[72:75]
    v_mfma_f32_16x16x32_bf16 v[76:79], a[204:207], v[84:87], v[76:79]
    v_mfma_f32_16x16x32_bf16 v[68:71], a[204:207], v[80:83], v[68:71]
    s_waitcnt lgkmcnt(0)
    v_mfma_f32_16x16x32_bf16 v[48:51], a[208:211], v[88:91], v[48:51]
    s_waitcnt vmcnt(0)
    ds_read_b128 v[80:83], v4 offset:28672
    v_cmp_ne_u32 vcc, 0, v96
    v_mfma_f32_16x16x32_bf16 v[56:59], a[208:211], v[92:95], v[56:59]
    v_mfma_f32_16x16x32_bf16 v[60:63], a[212:215], v[92:95], v[60:63]
    s_cbranch_vccnz L_spin62
L_back63:
    ds_read_b128 v[84:87], v5 offset:28672
    s_barrier
    v_mfma_f32_16x16x32_bf16 v[52:55], a[212:215], v[88:91], v[52:55]
    buffer_load_dwordx4 v1, s[16:19], s42 offen offset:0 sc1 lds
    v_mfma_f32_16x16x32_bf16 v[64:67], a[216:219], v[88:91], v[64:67]
    v_mfma_f32_16x16x32_bf16 v[72:75], a[216:219], v[92:95], v[72:75]
    v_mfma_f32_16x16x32_bf16 v[76:79], a[220:223], v[92:95], v[76:79]
    buffer_load_dwordx4 v1, s[16:19], s42 offen offset:1024 sc1 lds
    v_mfma_f32_16x16x32_bf16 v[68:71], a[220:223], v[88:91], v[68:71]
    s_waitcnt lgkmcnt(0)
    v_mfma_f32_16x16x32_bf16 v[48:51], a[224:227], v[80:83], v[48:51]
    ds_read_b128 v[88:91], v4 offset:30720
    v_mfma_f32_16x16x32_bf16 v[56:59], a[224:227], v[84:87], v[56:59]
    buffer_load_dwordx4 v1, s[16:19], s42 offen offset:2048 sc1 lds
    v_mfma_f32_16x16x32_bf16 v[60:63], a[228:231], v[84:87], v[60:63]
    ds_read_b128 v[92:95], v5 offset:30720
    v_mfma_f32_16x16x32_bf16 v[52:55], a[228:231], v[80:83], v[52:55]
    v_mfma_f32_16x16x32_bf16 v[64:67], a[232:235], v[80:83], v[64:67]
    buffer_store_dword v124, v124, s[16:19], s91 offen sc1
    v_mfma_f32_16x16x32_bf16 v[72:75], a[232:235], v[84:87], v[72:75]
    s_add_u32 s91, s91, 131072
    s_add_u32 m0, s43, 12288
    s_add_u32 s42, s41, 12288
    v_mfma_f32_16x16x32_bf16 v[76:79], a[236:239], v[84:87], v[76:79]
    s_add_u32 s39, s91, -327680
    v_mfma_f32_16x16x32_bf16 v[68:71], a[236:239], v[80:83], v[68:71]
    s_waitcnt lgkmcnt(0)
    v_mfma_f32_16x16x32_bf16 v[48:51], a[240:243], v[88:91], v[48:51]
    ds_read_b128 v[80:83], v4 offset:32768
    v_mfma_f32_16x16x32_bf16 v[56:59], a[240:243], v[92:95], v[56:59]
    buffer_store_dword v124, v124, s[16:19], s39 offen sc1
    v_mfma_f32_16x16x32_bf16 v[60:63], a[244:247], v[92:95], v[60:63]
    s_waitcnt vmcnt(6)
    ds_read_b128 v[84:87], v5 offset:32768
    v_mfma_f32_16x16x32_bf16 v[128:131], v[104:107], v[140:143], v[128:131]
    v_mfma_f32_16x16x32_bf16 v[132:135], v[108:111], v[140:143], v[132:135]
    v_mfma_f32_16x16x32_bf16 v[128:131], v[104:107], v[144:147], v[128:131]
    v_mfma_f32_16x16x32_bf16 v[132:135], v[108:111], v[144:147], v[132:135]
    v_mfma_f32_16x16x32_bf16 v[128:131], v[104:107], v[148:151], v[128:131]
    v_mfma_f32_16x16x32_bf16 v[132:135], v[108:111], v[148:151], v[132:135]
    v_mfma_f32_16x16x32_bf16 v[128:131], v[104:107], v[152:155], v[128:131]
    v_mfma_f32_16x16x32_bf16 v[132:135], v[108:111], v[152:155], v[132:135]
    v_mfma_f32_16x16x32_bf16 v[52:55], a[244:247], v[88:91], v[52:55]
    v_mfma_f32_16x16x32_bf16 v[64:67], a[248:251], v[88:91], v[64:67]
    buffer_load_dwordx4 v1, s[16:19], s42 offen offset:0 sc1 lds
    v_mfma_f32_16x16x32_bf16 v[72:75], a[248:251], v[92:95], v[72:75]
    v_cvt_pk_bf16_f32 v140, v128, v129
    v_cvt_pk_bf16_f32 v141, v130, v131
    v_mfma_f32_16x16x32_bf16 v[76:79], a[252:255], v[92:95], v[76:79]
    v_cvt_pk_bf16_f32 v142, v132, v133
    v_cvt_pk_bf16_f32 v143, v134, v135
    v_mfma_f32_16x16x32_bf16 v[68:71], a[252:255], v[88:91], v[68:71]
    s_waitcnt lgkmcnt(0)
    v_mfma_f32_16x16x32_bf16 v[48:51], v[160:163], v[80:83], v[48:51]
    ds_read_b128 v[88:91], v4 offset:34816
    v_mfma_f32_16x16x32_bf16 v[56:59], v[160:163], v[84:87], v[56:59]
    buffer_load_dwordx4 v1, s[16:19], s42 offen offset:1024 sc1 lds
    v_mfma_f32_16x16x32_bf16 v[60:63], v[164:167], v[84:87], v[60:63]
    ds_read_b128 v[92:95], v5 offset:34816
    v_mfma_f32_16x16x32_bf16 v[52:55], v[164:167], v[80:83], v[52:55]
    v_mfma_f32_16x16x32_bf16 v[64:67], v[168:171], v[80:83], v[64:67]
    buffer_store_dwordx4 v[140:143], v9, s[20:23], s48 offen sc1
    v_mfma_f32_16x16x32_bf16 v[72:75], v[168:171], v[84:87], v[72:75]
    v_add_f32 v100, v128, v129
    v_mul_f32 v101, v128, v128
    v_mfma_f32_16x16x32_bf16 v[76:79], v[172:175], v[84:87], v[76:79]
    v_fmac_f32 v101, v129, v129
    v_add_f32 v100, v100, v130
    v_mfma_f32_16x16x32_bf16 v[68:71], v[172:175], v[80:83], v[68:71]
    s_waitcnt lgkmcnt(0)
    v_fmac_f32 v101, v130, v130
    v_add_f32 v100, v100, v131
    v_mfma_f32_16x16x32_bf16 v[48:51], v[176:179], v[88:91], v[48:51]
    ds_read_b128 v[80:83], v4 offset:36864
    v_fmac_f32 v101, v131, v131
    v_mfma_f32_16x16x32_bf16 v[56:59], v[176:179], v[92:95], v[56:59]
    buffer_load_dwordx4 v1, s[16:19], s42 offen offset:2048 sc1 lds
    v_mfma_f32_16x16x32_bf16 v[60:63], v[180:183], v[92:95], v[60:63]
    s_add_u32 m0, s43, 24576
    ds_read_b128 v[84:87], v5 offset:36864
    v_add_f32 v100, v100, v132
    v_mfma_f32_16x16x32_bf16 v[52:55], v[180:183], v[88:91], v[52:55]
    s_add_u32 s42, s41, 24576
    v_fmac_f32 v101, v132, v132
    v_add_f32 v100, v100, v133
    v_mfma_f32_16x16x32_bf16 v[64:67], v[184:187], v[88:91], v[64:67]
    v_fmac_f32 v101, v133, v133
    v_add_f32 v100, v100, v134
    v_mfma_f32_16x16x32_bf16 v[72:75], v[184:187], v[92:95], v[72:75]
    v_fmac_f32 v101, v134, v134
    v_add_f32 v100, v100, v135
    v_mfma_f32_16x16x32_bf16 v[76:79], v[188:191], v[92:95], v[76:79]
    buffer_load_dwordx4 v1, s[16:19], s42 offen offset:0 sc1 lds
    v_mfma_f32_16x16x32_bf16 v[68:71], v[188:191], v[88:91], v[68:71]
    s_waitcnt lgkmcnt(0)
    v_fmac_f32 v101, v135, v135
    v_mfma_f32_16x16x32_bf16 v[48:51], v[192:195], v[80:83], v[48:51]
    ds_read_b128 v[88:91], v4 offset:38912
    v_mfma_f32_16x16x32_bf16 v[56:59], v[192:195], v[84:87], v[56:59]
    v_permlane16_swap_b32 v100, v101
    v_mfma_f32_16x16x32_bf16 v[60:63], v[196:199], v[84:87], v[60:63]
    ds_read_b128 v[92:95], v5 offset:38912
    v_add_f32 v100, v100, v101
    v_mfma_f32_16x16x32_bf16 v[52:55], v[196:199], v[80:83], v[52:55]
    buffer_load_dwordx4 v1, s[16:19], s42 offen offset:1024 sc1 lds
    v_mfma_f32_16x16x32_bf16 v[64:67], v[200:203], v[80:83], v[64:67]
    v_mov_b32 v102, v100
    v_mfma_f32_16x16x32_bf16 v[72:75], v[200:203], v[84:87], v[72:75]
    v_permlane32_swap_b32 v100, v102
    v_mfma_f32_16x16x32_bf16 v[76:79], v[204:207], v[84:87], v[76:79]
    v_add_f32 v100, v100, v102
    v_mfma_f32_16x16x32_bf16 v[68:71], v[204:207], v[80:83], v[68:71]
    s_waitcnt lgkmcnt(0)
    ds_write_b32 v10, v100 offset:0
    v_mfma_f32_16x16x32_bf16 v[48:51], v[208:211], v[88:91], v[48:51]
    s_waitcnt vmcnt(22)
    ds_read_b128 v[80:83], v4 offset:40960
    v_mfma_f32_16x16x32_bf16 v[128:131], v[104:107], v[136:139], v[16:19]
    buffer_load_dwordx4 v1, s[16:19], s42 offen offset:2048 sc1 lds
    v_mfma_f32_16x16x32_bf16 v[56:59], v[208:211], v[92:95], v[56:59]
    v_mfma_f32_16x16x32_bf16 v[132:135], v[108:111], v[136:139], v[20:23]
    s_add_u32 s45, s45, 131072
    v_mfma_f32_16x16x32_bf16 v[60:63], v[212:215], v[92:95], v[60:63]
    ds_read_b128 v[84:87], v5 offset:40960
    v_mfma_f32_16x16x32_bf16 v[52:55], v[212:215], v[88:91], v[52:55]
    v_mfma_f32_16x16x32_bf16 v[64:67], v[216:219], v[88:91], v[64:67]
    v_mfma_f32_16x16x32_bf16 v[72:75], v[216:219], v[92:95], v[72:75]
    v_mfma_f32_16x16x32_bf16 v[76:79], v[220:223], v[92:95], v[76:79]
    v_mfma_f32_16x16x32_bf16 v[68:71], v[220:223], v[88:91], v[68:71]
    s_waitcnt lgkmcnt(0)
    v_mfma_f32_16x16x32_bf16 v[48:51], v[224:227], v[80:83], v[48:51]
    ds_read_b128 v[88:91], v4 offset:43008
    v_mfma_f32_16x16x32_bf16 v[56:59], v[224:227], v[84:87], v[56:59]
    v_mfma_f32_16x16x32_bf16 v[60:63], v[228:231], v[84:87], v[60:63]
    ds_read_b128 v[92:95], v5 offset:43008
    v_mfma_f32_16x16x32_bf16 v[52:55], v[228:231], v[80:83], v[52:55]
    v_mfma_f32_16x16x32_bf16 v[64:67], v[232:235], v[80:83], v[64:67]
    v_mfma_f32_16x16x32_bf16 v[72:75], v[232:235], v[84:87], v[72:75]
    v_mfma_f32_16x16x32_bf16 v[76:79], v[236:239], v[84:87], v[76:79]
    v_mfma_f32_16x16x32_bf16 v[68:71], v[236:239], v[80:83], v[68:71]
    s_waitcnt vmcnt(9) lgkmcnt(0)
    s_barrier
    v_mfma_f32_16x16x32_bf16 v[48:51], v[240:243], v[88:91], v[48:51]
    ds_read_b128 v[80:83], v2 offset:0
    v_mfma_f32_16x16x32_bf16 v[56:59], v[240:243], v[92:95], v[56:59]
    v_mfma_f32_16x16x32_bf16 v[60:63], v[244:247], v[92:95], v[60:63]
    ds_read_b128 v[84:87], v3 offset:0
    v_mfma_f32_16x16x32_bf16 v[52:55], v[244:247], v[88:91], v[52:55]
    v_mfma_f32_16x16x32_bf16 v[64:67], v[248:251], v[88:91], v[64:67]
    v_mfma_f32_16x16x32_bf16 v[72:75], v[248:251], v[92:95], v[72:75]
    v_mfma_f32_16x16x32_bf16 v[76:79], v[252:255], v[92:95], v[76:79]
    v_mfma_f32_16x16x32_bf16 v[68:71], v[252:255], v[88:91], v[68:71]
    s_add_u32 s36, s36, 1
    s_cmp_lt_u32 s36, 32
    s_cbranch_scc1 L_bf_b0
    s_nop 7
    s_sub_u32 s47, s45, 393216
    buffer_load_dword v13, v8, s[16:19], s47 offen sc1
    s_and_b32 s38, s53, 0xffffffff
    s_cmp_eq_u32 s36, 0
    s_cselect_b32 s38, 0x5e00000, s38
    buffer_load_dwordx4 v[136:139], v1, s[16:19], s38 offen sc1
    s_add_u32 s53, s53, 65536
    s_and_b32 s44, s90, 0xffffffff
    s_cmp_eq_u32 s36, 0
    s_cselect_b32 s44, 0x5e00000, s44
    s_xor_b32 s49, s44, 16384
    v_cvt_pk_bf16_f32 v56, v56, v57
    v_cvt_pk_bf16_f32 v57, v58, v59
    v_cvt_pk_bf16_f32 v58, v60, v61
    v_cvt_pk_bf16_f32 v59, v62, v63
    buffer_store_dwordx4 v[56:59], v1, s[16:19], s49 offen offset:0 sc1
    s_xor_b32 s49, s44, 32768
    v_cvt_pk_bf16_f32 v64, v64, v65
    v_cvt_pk_bf16_f32 v65, v66, v67
    v_cvt_pk_bf16_f32 v66, v68, v69
    v_cvt_pk_bf16_f32 v67, v70, v71
    buffer_store_dwordx4 v[64:67], v1, s[16:19], s49 offen offset:1024 sc1
    s_xor_b32 s49, s44, 49152
    v_cvt_pk_bf16_f32 v72, v72, v73
    v_cvt_pk_bf16_f32 v73, v74, v75
    v_cvt_pk_bf16_f32 v74, v76, v77
    v_cvt_pk_bf16_f32 v75, v78, v79
    buffer_store_dwordx4 v[72:75], v1, s[16:19], s49 offen offset:2048 sc1
    s_add_u32 s90, s90, 262144
    s_waitcnt vmcnt(4)
    v_cmp_ne_u32 vcc, 0, v13
    s_cbranch_vccnz L_spin64
L_back65:
    s_barrier
    s_sub_u32 s48, s90, 524288
    s_and_b32 s48, s48, 0xffffffff
    s_cmp_lt_u32 s36, 2
    s_cselect_b32 s48, s52, s48
    buffer_load_dwordx4 v[140:143], v1, s[16:19], s48 offen offset:0 sc1
    buffer_load_dwordx4 v[144:147], v1, s[16:19], s48 offen offset:1024 sc1
    buffer_load_dwordx4 v[148:151], v1, s[16:19], s48 offen offset:2048 sc1
    buffer_load_dwordx4 v[152:155], v1, s[16:19], s48 offen offset:3072 sc1
    s_sub_u32 s47, s36, 2
    s_cmp_lt_u32 s47, 16
    s_cselect_b32 s48, 0x5000000, s52
    s_add_u32 s20, s84, s48
    s_addc_u32 s21, s85, 0
    s_cmp_ge_i32 s47, 16
    s_cselect_b32 s20, s80, s20
    s_cselect_b32 s21, s81, s21
    s_and_b32 s48, s47, 15
    s_lshl_b32 s48, s48, 1
    s_sub_u32 s48, s50, s48
    s_lshl_b32 s46, s48, 10
    s_sub_u32 s46, s55, s46
    s_cmp_lt_u32 s47, 16
    s_cselect_b32 s46, s46, s52
    s_lshl_b32 s48, s48, 15
    s_waitcnt vmcnt(4)
    s_barrier
    buffer_store_dword v124, v124, s[16:19], s91 offen sc1
    s_add_u32 s91, s91, 131072
    s_waitcnt vmcnt(1)
    v_mfma_f32_16x16x32_bf16 v[128:131], v[104:107], v[140:143], v[128:131]
    v_mfma_f32_16x16x32_bf16 v[132:135], v[108:111], v[140:143], v[132:135]
    v_mfma_f32_16x16x32_bf16 v[128:131], v[104:107], v[144:147], v[128:131]
    v_mfma_f32_16x16x32_bf16 v[132:135], v[108:111], v[144:147], v[132:135]
    v_mfma_f32_16x16x32_bf16 v[128:131], v[104:107], v[148:151], v[128:131]
    v_mfma_f32_16x16x32_bf16 v[132:135], v[108:111], v[148:151], v[132:135]
    v_mfma_f32_16x16x32_bf16 v[128:131], v[104:107], v[152:155], v[128:131]
    v_mfma_f32_16x16x32_bf16 v[132:135], v[108:111], v[152:155], v[132:135]
    s_nop 5
    v_cvt_pk_bf16_f32 v140, v128, v129
    v_cvt_pk_bf16_f32 v141, v130, v131
    v_cvt_pk_bf16_f32 v142, v132, v133
    v_cvt_pk_bf16_f32 v143, v134, v135
    buffer_store_dwordx4 v[140:143], v9, s[20:23], s48 offen sc1
    s_waitcnt vmcnt(9)
    v_mfma_f32_16x16x32_bf16 v[128:131], v[104:107], v[136:139], v[48:51]
    v_mfma_f32_16x16x32_bf16 v[132:135], v[108:111], v[136:139], v[52:55]
    s_sub_u32 s47, s45, 262144
    buffer_load_dword v13, v8, s[16:19], s47 offen sc1
    s_waitcnt vmcnt(0)
    v_cmp_ne_u32 vcc, 0, v13
    s_cbranch_vccnz L_spin66
L_back67:
    s_barrier
    s_sub_u32 s48, s90, 262144
    s_and_b32 s48, s48, 0xffffffff
    s_cmp_lt_u32 s36, 1
    s_cselect_b32 s48, s52, s48
    buffer_load_dwordx4 v[140:143], v1, s[16:19], s48 offen offset:0 sc1
    buffer_load_dwordx4 v[144:147], v1, s[16:19], s48 offen offset:1024 sc1
    buffer_load_dwordx4 v[148:151], v1, s[16:19], s48 offen offset:2048 sc1
    buffer_load_dwordx4 v[152:155], v1, s[16:19], s48 offen offset:3072 sc1
    s_sub_u32 s47, s36, 1
    s_cmp_lt_u32 s47, 16
    s_cselect_b32 s48, 0x5000000, s52
    s_add_u32 s20, s84, s48
    s_addc_u32 s21, s85, 0
    s_cmp_ge_i32 s47, 16
    s_cselect_b32 s20, s80, s20
    s_cselect_b32 s21, s81, s21
    s_and_b32 s48, s47, 15
    s_lshl_b32 s48, s48, 1
    s_sub_u32 s48, s50, s48
    s_lshl_b32 s46, s48, 10
    s_sub_u32 s46, s55, s46
    s_cmp_lt_u32 s47, 16
    s_cselect_b32 s46, s46, s52
    s_lshl_b32 s48, s48, 15
    s_waitcnt vmcnt(0)
    v_mfma_f32_16x16x32_bf16 v[128:131], v[104:107], v[140:143], v[128:131]
    v_mfma_f32_16x16x32_bf16 v[132:135], v[108:111], v[140:143], v[132:135]
    v_mfma_f32_16x16x32_bf16 v[128:131], v[104:107], v[144:147], v[128:131]
    v_mfma_f32_16x16x32_bf16 v[132:135], v[108:111], v[144:147], v[132:135]
    v_mfma_f32_16x16x32_bf16 v[128:131], v[104:107], v[148:151], v[128:131]
    v_mfma_f32_16x16x32_bf16 v[132:135], v[108:111], v[148:151], v[132:135]
    v_mfma_f32_16x16x32_bf16 v[128:131], v[104:107], v[152:155], v[128:131]
    v_mfma_f32_16x16x32_bf16 v[132:135], v[108:111], v[152:155], v[132:135]
    s_nop 5
    v_cvt_pk_bf16_f32 v140, v128, v129
    v_cvt_pk_bf16_f32 v141, v130, v131
    v_cvt_pk_bf16_f32 v142, v132, v133
    v_cvt_pk_bf16_f32 v143, v134, v135
    buffer_store_dwordx4 v[140:143], v9, s[20:23], s48 offen sc1
    s_waitcnt vmcnt(0)
    s_endpgm
L_spin44:
    s_mov_b32 s40, 0x20000
L_spin44_l:
    buffer_load_dword v8, v124, s[20:23], 0 offen sc1
    s_sub_u32 s40, s40, 1
    s_waitcnt vmcnt(0)
    v_cmp_eq_u32 vcc, v124, v8
    s_cbranch_scc1 L_back45
    s_cbranch_vccz L_back45
    s_sleep 8
    s_branch L_spin44_l
L_spin47:
    s_mov_b32 s40, 0x20000
L_spin47_l:
    buffer_load_dword v48, v124, s[20:23], 0 offen sc1
    s_sub_u32 s40, s40, 1
    s_waitcnt vmcnt(0)
    v_cmp_eq_u32 vcc, v124, v48
    s_cbranch_scc1 L_back48
    s_cbranch_vccz L_back48
    s_sleep 8
    s_branch L_spin47_l
L_spin49:
    s_mov_b32 s40, 0x20000
L_spin49_l:
    buffer_load_dword v49, v48, s[16:19], s38 offen sc1
    s_sub_u32 s40, s40, 1
    s_waitcnt vmcnt(0)
    v_cmp_ne_u32 vcc, 0, v49
    s_cbranch_scc1 L_back50
    s_cbranch_vccz L_back50
    s_sleep 8
    s_branch L_spin49_l
L_spin52:
    s_mov_b32 s40, 0x20000
L_spin52_l:
    buffer_load_dword v80, v124, s[20:23], 0 offen sc1
    s_sub_u32 s40, s40, 1
    s_waitcnt vmcnt(0)
    v_cmp_eq_u32 vcc, v124, v80
    s_cbranch_scc1 L_back53
    s_cbranch_vccz L_back53
    s_sleep 8
    s_branch L_spin52_l
L_spin54:
    s_mov_b32 s40, 0x20000
L_spin54_l:
    buffer_load_dword v96, v6, s[16:19], s45 offen sc1
    s_sub_u32 s40, s40, 1
    s_waitcnt vmcnt(0)
    v_cmp_ne_u32 vcc, 0, v96
    s_cbranch_scc1 L_back55
    s_cbranch_vccz L_back55
    s_sleep 2
    s_branch L_spin54_l
L_spin56:
    s_mov_b32 s40, 0x20000
L_spin56_l:
    buffer_load_dword v13, v8, s[16:19], s47 offen sc1
    s_sub_u32 s40, s40, 1
    s_waitcnt vmcnt(0)
    v_cmp_ne_u32 vcc, 0, v13
    s_cbranch_scc1 L_back57
    s_cbranch_vccz L_back57
    s_sleep 2
    s_branch L_spin56_l
L_spin58:
    s_mov_b32 s40, 0x20000
L_spin58_l:
    buffer_load_dword v96, v6, s[16:19], s45 offen sc1
    s_sub_u32 s40, s40, 1
    s_waitcnt vmcnt(0)
    v_cmp_ne_u32 vcc, 0, v96
    s_cbranch_scc1 L_back59
    s_cbranch_vccz L_back59
    s_sleep 2
    s_branch L_spin58_l
L_spin60:
    s_mov_b32 s40, 0x20000
L_spin60_l:
    buffer_load_dword v13, v8, s[16:19], s47 offen sc1
    s_sub_u32 s40, s40, 1
    s_waitcnt vmcnt(0)
    v_cmp_ne_u32 vcc, 0, v13
    s_cbranch_scc1 L_back61
    s_cbranch_vccz L_back61
    s_sleep 2
    s_branch L_spin60_l
L_spin62:
    s_mov_b32 s40, 0x20000
L_spin62_l:
    buffer_load_dword v96, v6, s[16:19], s45 offen sc1
    s_sub_u32 s40, s40, 1
    s_waitcnt vmcnt(0)
    v_cmp_ne_u32 vcc, 0, v96
    s_cbranch_scc1 L_back63
    s_cbranch_vccz L_back63
    s_sleep 2
    s_branch L_spin62_l
L_spin64:
    s_mov_b32 s40, 0x20000
L_spin64_l:
    buffer_load_dword v13, v8, s[16:19], s47 offen sc1
    s_sub_u32 s40, s40, 1
    s_waitcnt vmcnt(0)
    v_cmp_ne_u32 vcc, 0, v13
    s_cbranch_scc1 L_back65
    s_cbranch_vccz L_back65
    s_sleep 2
    s_branch L_spin64_l
L_spin66:
    s_mov_b32 s40, 0x20000
L_spin66_l:
    buffer_load_dword v13, v8, s[16:19], s47 offen sc1
    s_sub_u32 s40, s40, 1
    s_waitcnt vmcnt(0)
    v_cmp_ne_u32 vcc, 0, v13
    s_cbranch_scc1 L_back67
    s_cbranch_vccz L_back67
    s_sleep 2
    s_branch L_spin66_l
L_role_60:
    s_sub_u32 s35, s34, 44
    s_lshr_b32 s51, s35, 2
    s_and_b32 s87, s35, 3
    s_mul_i32 s54, s51, 1441792
    s_lshl_b32 s37, s87, 9
    s_add_u32 s54, s54, s37
    s_mov_b32 s12, s76
    s_mov_b32 s13, s77
    s_mov_b32 s14, 0x700000
    s_mov_b32 s15, 0x00020000
    s_mov_b32 s39, 2048
    s_cmp_lg_u32 s32, 0
    s_cbranch_scc1 L_arv68
    s_add_u32 s20, s82, 0x80
    s_addc_u32 s21, s83, 0
    s_mov_b32 s22, 0x4
    s_mov_b32 s23, 0x00020000
    buffer_load_dword v48, v124, s[20:23], 0 offen sc1
    s_waitcnt vmcnt(0)
    v_cmp_eq_u32 vcc, v124, v48
    s_cbranch_vccnz L_spin69
L_back70:
L_arv68:
    s_and_b32 s38, s34, 15
    s_lshl_b32 s37, s33, 6
    s_add_u32 s37, s37, s38
    s_lshl_b32 s37, s37, 8
    v_lshl_add_u32 v48, v0, 8, s37
    s_cmp_eq_u32 s32, 0
    s_cselect_b32 s37, 1, 0
    v_cmp_le_u32 vcc, s37, v0
    s_nop 1
    v_cndmask_b32 v48, v48, 2.0, vcc
    s_mov_b32 s38, 0x5540000
    buffer_load_dword v49, v48, s[16:19], s38 offen sc1
    s_waitcnt vmcnt(0)
    v_cmp_ne_u32 vcc, 0, v49
    s_cbranch_vccnz L_spin71
L_back72:
    s_barrier
    v_lshrrev_b32 v64, 3, v0
    v_lshlrev_b32 v65, 2, v0
    v_and_b32 v65, 64, v65
    v_and_b32 v66, 0x70, v1
    v_xor_b32 v65, v65, v66
    v_mad_u32_u24 v48, v64, s39, v65
    v_add_u32 v49, 16384, v48
    v_add_u32 v50, 128, v48
    v_add_u32 v51, 16512, v48
    v_add_u32 v52, 256, v48
    v_add_u32 v53, 16640, v48
    v_add_u32 v54, 384, v48
    v_add_u32 v55, 16768, v48
    s_mul_i32 s38, s32, 32768
    s_add_u32 s54, s54, s38
    s_lshl_b32 s42, s32, 11
    s_add_u32 m0, s42, 0
    s_nop 0
    buffer_load_dwordx4 v48, s[12:15], s54 offen lds
    s_add_u32 m0, s42, 1024
    s_nop 0
    buffer_load_dwordx4 v49, s[12:15], s54 offen lds
    s_add_u32 m0, s42, 8192
    s_nop 0
    buffer_load_dwordx4 v50, s[12:15], s54 offen lds
    s_add_u32 m0, s42, 9216
    s_nop 0
    buffer_load_dwordx4 v51, s[12:15], s54 offen lds
    s_add_u32 m0, s42, 16384
    s_nop 0
    buffer_load_dwordx4 v52, s[12:15], s54 offen lds
    s_add_u32 m0, s42, 17408
    s_nop 0
    buffer_load_dwordx4 v53, s[12:15], s54 offen lds
    s_add_u32 m0, s42, 24576
    s_nop 0
    buffer_load_dwordx4 v54, s[12:15], s54 offen lds
    s_add_u32 m0, s42, 25600
    s_nop 0
    buffer_load_dwordx4 v55, s[12:15], s54 offen lds
    s_add_u32 s54, s54, 131072
    s_add_u32 m0, s42, 32768
    s_nop 0
    buffer_load_dwordx4 v48, s[12:15], s54 offen lds
    s_add_u32 m0, s42, 33792
    s_nop 0
    buffer_load_dwordx4 v49, s[12:15], s54 offen lds
    s_add_u32 m0, s42, 40960
    s_nop 0
    buffer_load_dwordx4 v50, s[12:15], s54 offen lds
    s_add_u32 m0, s42, 41984
    s_nop 0
    buffer_load_dwordx4 v51, s[12:15], s54 offen lds
    s_add_u32 m0, s42, 49152
    s_nop 0
    buffer_load_dwordx4 v52, s[12:15], s54 offen lds
    s_add_u32 m0, s42, 50176
    s_nop 0
    buffer_load_dwordx4 v53, s[12:15], s54 offen lds
    s_add_u32 m0, s42, 57344
    s_nop 0
    buffer_load_dwordx4 v54, s[12:15], s54 offen lds
    s_add_u32 m0, s42, 58368
    s_nop 0
    buffer_load_dwordx4 v55, s[12:15], s54 offen lds
    s_add_u32 s54, s54, 131072
    s_add_u32 m0, s42, 65536
    s_nop 0
    buffer_load_dwordx4 v48, s[12:15], s54 offen lds
    s_add_u32 m0, s42, 66560
    s_nop 0
    buffer_load_dwordx4 v49, s[12:15], s54 offen lds
    s_add_u32 m0, s42, 73728
    s_nop 0
    buffer_load_dwordx4 v50, s[12:15], s54 offen lds
    s_add_u32 m0, s42, 74752
    s_nop 0
    buffer_load_dwordx4 v51, s[12:15], s54 offen lds
    s_add_u32 m0, s42, 81920
    s_nop 0
    buffer_load_dwordx4 v52, s[12:15], s54 offen lds
    s_add_u32 m0, s42, 82944
    s_nop 0
    buffer_load_dwordx4 v53, s[12:15], s54 offen lds
    s_add_u32 m0, s42, 90112
    s_nop 0
    buffer_load_dwordx4 v54, s[12:15], s54 offen lds
    s_add_u32 m0, s42, 91136
    s_nop 0
    buffer_load_dwordx4 v55, s[12:15], s54 offen lds
    s_add_u32 s54, s54, 131072
    s_add_u32 m0, s42, 98304
    s_nop 0
    buffer_load_dwordx4 v48, s[12:15], s54 offen lds
    s_add_u32 m0, s42, 99328
    s_nop 0
    buffer_load_dwordx4 v49, s[12:15], s54 offen lds
    s_add_u32 m0, s42, 106496
    s_nop 0
    buffer_load_dwordx4 v50, s[12:15], s54 offen lds
    s_add_u32 m0, s42, 107520
    s_nop 0
    buffer_load_dwordx4 v51, s[12:15], s54 offen lds
    s_add_u32 m0, s42, 114688
    s_nop 0
    buffer_load_dwordx4 v52, s[12:15], s54 offen lds
    s_add_u32 m0, s42, 115712
    s_nop 0
    buffer_load_dwordx4 v53, s[12:15], s54 offen lds
    s_add_u32 m0, s42, 122880
    s_nop 0
    buffer_load_dwordx4 v54, s[12:15], s54 offen lds
    s_add_u32 m0, s42, 123904
    s_nop 0
    buffer_load_dwordx4 v55, s[12:15], s54 offen lds
    s_add_u32 s54, s54, 131072
    v_lshrrev_b32 v64, 4, v0
    v_bfe_u32 v65, v0, 2, 2
    v_lshl_add_u32 v64, v64, 3, v65
    v_lshlrev_b32 v64, 7, v64
    v_lshrrev_b32 v65, 1, v65
    v_lshl_add_u32 v64, v65, 6, v64
    v_and_b32 v65, 3, v0
    v_lshl_add_u32 v64, v65, 4, v64
    s_lshl_b32 s37, s32, 13
    s_and_b32 s38, s51, 2
    s_lshl_b32 s38, s38, 5
    s_xor_b32 s38, s38, 0
    s_add_u32 s37, s37, s38
    v_xor_b32 v56, s37, v64
    s_lshl_b32 s37, s32, 13
    s_and_b32 s38, s51, 2
    s_lshl_b32 s38, s38, 5
    s_xor_b32 s38, s38, 8
    s_add_u32 s37, s37, s38
    v_xor_b32 v57, s37, v64
    s_lshl_b32 s37, s32, 13
    s_and_b32 s38, s51, 2
    s_lshl_b32 s38, s38, 5
    s_xor_b32 s38, s38, 64
    s_add_u32 s37, s37, s38
    v_xor_b32 v58, s37, v64
    s_lshl_b32 s37, s32, 13
    s_and_b32 s38, s51, 2
    s_lshl_b32 s38, s38, 5
    s_xor_b32 s38, s38, 72
    s_add_u32 s37, s37, s38
    v_xor_b32 v59, s37, v64
    s_and_b32 s39, s51, 1
    s_lshl_b32 s37, s39, 10
    v_add_u32 v2, s37, v1
    v_xor_b32 v3, 1024, v2
    v_add_u32 v4, 98304, v2
    v_add_u32 v5, 98304, v3
    s_mul_i32 s38, s51, 11*43
    s_lshr_b32 s38, s38, 7
    s_add_u32 s38, s38, 24
    s_lshl_b32 s37, s33, 6
    s_add_u32 s37, s37, s38
    s_lshl_b32 s37, s37, 8
    v_lshl_add_u32 v6, v0, 8, s37
    s_cmp_eq_u32 s32, 0
    s_cselect_b32 s37, 6, 0
    v_cmp_le_u32 vcc, s37, v0
    s_nop 1
    v_cndmask_b32 v6, v6, 2.0, vcc
    s_mul_i32 s43, s32, 3072
    s_lshl_b32 s88, s32, 11
    s_sub_u32 s89, s88, s43
    s_mul_i32 s41, s33, 8388608
    s_add_u32 s41, s41, 0x1000000
    s_mul_i32 s37, s51, 45056
    s_add_u32 s41, s41, s37
    s_add_u32 s41, s41, s43
    s_mul_i32 s90, s33, 8388608
    s_add_u32 s90, s90, 0x2fc0000
    s_lshl_b32 s37, s87, 16
    s_add_u32 s90, s90, s37
    s_lshl_b32 s37, s32, 12
    s_add_u32 s90, s90, s37
    s_and_b32 s37, s51, 3
    s_lshl_b32 s37, s37, 14
    s_add_u32 s90, s90, s37
    v_add_u32 v60, 0, v56
    v_add_u32 v61, 0, v57
    v_add_u32 v62, 0, v58
    v_add_u32 v63, 0, v59
    s_waitcnt vmcnt(24)
    s_barrier
    ds_read_b64_tr_b16 a[0:1], v60 offset:0
    ds_read_b64_tr_b16 a[2:3], v60 offset:512
    ds_read_b64_tr_b16 a[4:5], v61 offset:0
    ds_read_b64_tr_b16 a[6:7], v61 offset:512
    ds_read_b64_tr_b16 a[8:9], v62 offset:0
    ds_read_b64_tr_b16 a[10:11], v62 offset:512
    ds_read_b64_tr_b16 a[12:13], v63 offset:0
    ds_read_b64_tr_b16 a[14:15], v63 offset:512
    ds_read_b64_tr_b16 a[16:17], v60 offset:4096
    ds_read_b64_tr_b16 a[18:19], v60 offset:4608
    ds_read_b64_tr_b16 a[20:21], v61 offset:4096
    ds_read_b64_tr_b16 a[22:23], v61 offset:4608
    ds_read_b64_tr_b16 a[24:25], v62 offset:4096
    ds_read_b64_tr_b16 a[26:27], v62 offset:4608
    ds_read_b64_tr_b16 a[28:29], v63 offset:4096
    ds_read_b64_tr_b16 a[30:31], v63 offset:4608
    s_add_u32 m0, s42, 131072
    s_nop 0
    buffer_load_dwordx4 v48, s[12:15], s54 offen lds
    s_add_u32 m0, s42, 132096
    s_nop 0
    buffer_load_dwordx4 v49, s[12:15], s54 offen lds
    s_add_u32 m0, s42, 139264
    s_nop 0
    buffer_load_dwordx4 v50, s[12:15], s54 offen lds
    s_add_u32 m0, s42, 140288
    s_nop 0
    buffer_load_dwordx4 v51, s[12:15], s54 offen lds
    s_add_u32 m0, s42, 147456
    s_nop 0
    buffer_load_dwordx4 v52, s[12:15], s54 offen lds
    s_add_u32 m0, s42, 148480
    s_nop 0
    buffer_load_dwordx4 v53, s[12:15], s54 offen lds
    s_add_u32 m0, s42, 155648
    s_nop 0
    buffer_load_dwordx4 v54, s[12:15], s54 offen lds
    s_add_u32 m0, s42, 156672
    s_nop 0
    buffer_load_dwordx4 v55, s[12:15], s54 offen lds
    s_add_u32 s54, s54, 131072
    s_waitcnt lgkmcnt(0)
    v_add_u32 v60, 32768, v56
    v_add_u32 v61, 32768, v57
    v_add_u32 v62, 32768, v58
    v_add_u32 v63, 32768, v59
    s_waitcnt vmcnt(24)
    s_barrier
    ds_read_b64_tr_b16 a[32:33], v60 offset:0
    ds_read_b64_tr_b16 a[34:35], v60 offset:512
    ds_read_b64_tr_b16 a[36:37], v61 offset:0
    ds_read_b64_tr_b16 a[38:39], v61 offset:512
    ds_read_b64_tr_b16 a[40:41], v62 offset:0
    ds_read_b64_tr_b16 a[42:43], v62 offset:512
    ds_read_b64_tr_b16 a[44:45], v63 offset:0
    ds_read_b64_tr_b16 a[46:47], v63 offset:512
    ds_read_b64_tr_b16 a[48:49], v60 offset:4096
    ds_read_b64_tr_b16 a[50:51], v60 offset:4608
    ds_read_b64_tr_b16 a[52:53], v61 offset:4096
    ds_read_b64_tr_b16 a[54:55], v61 offset:4608
    ds_read_b64_tr_b16 a[56:57], v62 offset:4096
    ds_read_b64_tr_b16 a[58:59], v62 offset:4608
    ds_read_b64_tr_b16 a[60:61], v63 offset:4096
    ds_read_b64_tr_b16 a[62:63], v63 offset:4608
    s_add_u32 m0, s42, 0
    s_nop 0
    buffer_load_dwordx4 v48, s[12:15], s54 offen lds
    s_add_u32 m0, s42, 1024
    s_nop 0
    buffer_load_dwordx4 v49, s[12:15], s54 offen lds
    s_add_u32 m0, s42, 8192
    s_nop 0
    buffer_load_dwordx4 v50, s[12:15], s54 offen lds
    s_add_u32 m0, s42, 9216
    s_nop 0
    buffer_load_dwordx4 v51, s[12:15], s54 offen lds
    s_add_u32 m0, s42, 16384
    s_nop 0
    buffer_load_dwordx4 v52, s[12:15], s54 offen lds
    s_add_u32 m0, s42, 17408
    s_nop 0
    buffer_load_dwordx4 v53, s[12:15], s54 offen lds
    s_add_u32 m0, s42, 24576
    s_nop 0
    buffer_load_dwordx4 v54, s[12:15], s54 offen lds
    s_add_u32 m0, s42, 25600
    s_nop 0
    buffer_load_dwordx4 v55, s[12:15], s54 offen lds
    s_add_u32 s54, s54, 131072
    s_waitcnt lgkmcnt(0)
    v_add_u32 v60, 65536, v56
    v_add_u32 v61, 65536, v57
    v_add_u32 v62, 65536, v58
    v_add_u32 v63, 65536, v59
    s_waitcnt vmcnt(24)
    s_barrier
    ds_read_b64_tr_b16 a[64:65], v60 offset:0
    ds_read_b64_tr_b16 a[66:67], v60 offset:512
    ds_read_b64_tr_b16 a[68:69], v61 offset:0
    ds_read_b64_tr_b16 a[70:71], v61 offset:512
    ds_read_b64_tr_b16 a[72:73], v62 offset:0
    ds_read_b64_tr_b16 a[74:75], v62 offset:512
    ds_read_b64_tr_b16 a[76:77], v63 offset:0
    ds_read_b64_tr_b16 a[78:79], v63 offset:512
    ds_read_b64_tr_b16 a[80:81], v60 offset:4096
    ds_read_b64_tr_b16 a[82:83], v60 offset:4608
    ds_read_b64_tr_b16 a[84:85], v61 offset:4096
    ds_read_b64_tr_b16 a[86:87], v61 offset:4608
    ds_read_b64_tr_b16 a[88:89], v62 offset:4096
    ds_read_b64_tr_b16 a[90:91], v62 offset:4608
    ds_read_b64_tr_b16 a[92:93], v63 offset:4096
    ds_read_b64_tr_b16 a[94:95], v63 offset:4608
    s_add_u32 m0, s42, 32768
    s_nop 0
    buffer_load_dwordx4 v48, s[12:15], s54 offen lds
    s_add_u32 m0, s42, 33792
    s_nop 0
    buffer_load_dwordx4 v49, s[12:15], s54 offen lds
    s_add_u32 m0, s42, 40960
    s_nop 0
    buffer_load_dwordx4 v50, s[12:15], s54 offen lds
    s_add_u32 m0, s42, 41984
    s_nop 0
    buffer_load_dwordx4 v51, s[12:15], s54 offen lds
    s_add_u32 m0, s42, 49152
    s_nop 0
    buffer_load_dwordx4 v52, s[12:15], s54 offen lds
    s_add_u32 m0, s42, 50176
    s_nop 0
    buffer_load_dwordx4 v53, s[12:15], s54 offen lds
    s_add_u32 m0, s42, 57344
    s_nop 0
    buffer_load_dwordx4 v54, s[12:15], s54 offen lds
    s_add_u32 m0, s42, 58368
    s_nop 0
    buffer_load_dwordx4 v55, s[12:15], s54 offen lds
    s_add_u32 s54, s54, 131072
    s_waitcnt lgkmcnt(0)
    v_add_u32 v60, 98304, v56
    v_add_u32 v61, 98304, v57
    v_add_u32 v62, 98304, v58
    v_add_u32 v63, 98304, v59
    s_waitcnt vmcnt(24)
    s_barrier
    ds_read_b64_tr_b16 a[96:97], v60 offset:0
    ds_read_b64_tr_b16 a[98:99], v60 offset:512
    ds_read_b64_tr_b16 a[100:101], v61 offset:0
    ds_read_b64_tr_b16 a[102:103], v61 offset:512
    ds_read_b64_tr_b16 a[104:105], v62 offset:0
    ds_read_b64_tr_b16 a[106:107], v62 offset:512
    ds_read_b64_tr_b16 a[108:109], v63 offset:0
    ds_read_b64_tr_b16 a[110:111], v63 offset:512
    ds_read_b64_tr_b16 a[112:113], v60 offset:4096
    ds_read_b64_tr_b16 a[114:115], v60 offset:4608
    ds_read_b64_tr_b16 a[116:117], v61 offset:4096
    ds_read_b64_tr_b16 a[118:119], v61 offset:4608
    ds_read_b64_tr_b16 a[120:121], v62 offset:4096
    ds_read_b64_tr_b16 a[122:123], v62 offset:4608
    ds_read_b64_tr_b16 a[124:125], v63 offset:4096
    ds_read_b64_tr_b16 a[126:127], v63 offset:4608
    s_add_u32 m0, s42, 65536
    s_nop 0
    buffer_load_dwordx4 v48, s[12:15], s54 offen lds
    s_add_u32 m0, s42, 66560
    s_nop 0
    buffer_load_dwordx4 v49, s[12:15], s54 offen lds
    s_add_u32 m0, s42, 73728
    s_nop 0
    buffer_load_dwordx4 v50, s[12:15], s54 offen lds
    s_add_u32 m0, s42, 74752
    s_nop 0
    buffer_load_dwordx4 v51, s[12:15], s54 offen lds
    s_add_u32 m0, s42, 81920
    s_nop 0
    buffer_load_dwordx4 v52, s[12:15], s54 offen lds
    s_add_u32 m0, s42, 82944
    s_nop 0
    buffer_load_dwordx4 v53, s[12:15], s54 offen lds
    s_add_u32 m0, s42, 90112
    s_nop 0
    buffer_load_dwordx4 v54, s[12:15], s54 offen lds
    s_add_u32 m0, s42, 91136
    s_nop 0
    buffer_load_dwordx4 v55, s[12:15], s54 offen lds
    s_add_u32 s54, s54, 131072
    s_waitcnt lgkmcnt(0)
    v_add_u32 v60, 131072, v56
    v_add_u32 v61, 131072, v57
    v_add_u32 v62, 131072, v58
    v_add_u32 v63, 131072, v59
    s_waitcnt vmcnt(24)
    s_barrier
    ds_read_b64_tr_b16 a[128:129], v60 offset:0
    ds_read_b64_tr_b16 a[130:131], v60 offset:512
    ds_read_b64_tr_b16 a[132:133], v61 offset:0
    ds_read_b64_tr_b16 a[134:135], v61 offset:512
    ds_read_b64_tr_b16 a[136:137], v62 offset:0
    ds_read_b64_tr_b16 a[138:139], v62 offset:512
    ds_read_b64_tr_b16 a[140:141], v63 offset:0
    ds_read_b64_tr_b16 a[142:143], v63 offset:512
    ds_read_b64_tr_b16 a[144:145], v60 offset:4096
    ds_read_b64_tr_b16 a[146:147], v60 offset:4608
    ds_read_b64_tr_b16 a[148:149], v61 offset:4096
    ds_read_b64_tr_b16 a[150:151], v61 offset:4608
    ds_read_b64_tr_b16 a[152:153], v62 offset:4096
    ds_read_b64_tr_b16 a[154:155], v62 offset:4608
    ds_read_b64_tr_b16 a[156:157], v63 offset:4096
    ds_read_b64_tr_b16 a[158:159], v63 offset:4608
    s_add_u32 m0, s42, 98304
    s_nop 0
    buffer_load_dwordx4 v48, s[12:15], s54 offen lds
    s_add_u32 m0, s42, 99328
    s_nop 0
    buffer_load_dwordx4 v49, s[12:15], s54 offen lds
    s_add_u32 m0, s42, 106496
    s_nop 0
    buffer_load_dwordx4 v50, s[12:15], s54 offen lds
    s_add_u32 m0, s42, 107520
    s_nop 0
    buffer_load_dwordx4 v51, s[12:15], s54 offen lds
    s_add_u32 m0, s42, 114688
    s_nop 0
    buffer_load_dwordx4 v52, s[12:15], s54 offen lds
    s_add_u32 m0, s42, 115712
    s_nop 0
    buffer_load_dwordx4 v53, s[12:15], s54 offen lds
    s_add_u32 m0, s42, 122880
    s_nop 0
    buffer_load_dwordx4 v54, s[12:15], s54 offen lds
    s_add_u32 m0, s42, 123904
    s_nop 0
    buffer_load_dwordx4 v55, s[12:15], s54 offen lds
    s_add_u32 s54, s54, 131072
    s_waitcnt lgkmcnt(0)
    v_add_u32 v60, 0, v56
    v_add_u32 v61, 0, v57
    v_add_u32 v62, 0, v58
    v_add_u32 v63, 0, v59
    s_waitcnt vmcnt(24)
    s_barrier
    ds_read_b64_tr_b16 a[160:161], v60 offset:0
    ds_read_b64_tr_b16 a[162:163], v60 offset:512
    ds_read_b64_tr_b16 a[164:165], v61 offset:0
    ds_read_b64_tr_b16 a[166:167], v61 offset:512
    ds_read_b64_tr_b16 a[168:169], v62 offset:0
    ds_read_b64_tr_b16 a[170:171], v62 offset:512
    ds_read_b64_tr_b16 a[172:173], v63 offset:0
    ds_read_b64_tr_b16 a[174:175], v63 offset:512
    ds_read_b64_tr_b16 a[176:177], v60 offset:4096
    ds_read_b64_tr_b16 a[178:179], v60 offset:4608
    ds_read_b64_tr_b16 a[180:181], v61 offset:4096
    ds_read_b64_tr_b16 a[182:183], v61 offset:4608
    ds_read_b64_tr_b16 a[184:185], v62 offset:4096
    ds_read_b64_tr_b16 a[186:187], v62 offset:4608
    ds_read_b64_tr_b16 a[188:189], v63 offset:4096
    ds_read_b64_tr_b16 a[190:191], v63 offset:4608
    s_add_u32 m0, s42, 131072
    s_nop 0
    buffer_load_dwordx4 v48, s[12:15], s54 offen lds
    s_add_u32 m0, s42, 132096
    s_nop 0
    buffer_load_dwordx4 v49, s[12:15], s54 offen lds
    s_add_u32 m0, s42, 139264
    s_nop 0
    buffer_load_dwordx4 v50, s[12:15], s54 offen lds
    s_add_u32 m0, s42, 140288
    s_nop 0
    buffer_load_dwordx4 v51, s[12:15], s54 offen lds
    s_add_u32 m0, s42, 147456
    s_nop 0
    buffer_load_dwordx4 v52, s[12:15], s54 offen lds
    s_add_u32 m0, s42, 148480
    s_nop 0
    buffer_load_dwordx4 v53, s[12:15], s54 offen lds
    s_add_u32 m0, s42, 155648
    s_nop 0
    buffer_load_dwordx4 v54, s[12:15], s54 offen lds
    s_add_u32 m0, s42, 156672
    s_nop 0
    buffer_load_dwordx4 v55, s[12:15], s54 offen lds
    s_add_u32 s54, s54, 131072
    s_waitcnt lgkmcnt(0)
    v_add_u32 v60, 32768, v56
    v_add_u32 v61, 32768, v57
    v_add_u32 v62, 32768, v58
    v_add_u32 v63, 32768, v59
    s_waitcnt vmcnt(24)
    s_barrier
    ds_read_b64_tr_b16 a[192:193], v60 offset:0
    ds_read_b64_tr_b16 a[194:195], v60 offset:512
    ds_read_b64_tr_b16 a[196:197], v61 offset:0
    ds_read_b64_tr_b16 a[198:199], v61 offset:512
    ds_read_b64_tr_b16 a[200:201], v62 offset:0
    ds_read_b64_tr_b16 a[202:203], v62 offset:512
    ds_read_b64_tr_b16 a[204:205], v63 offset:0
    ds_read_b64_tr_b16 a[206:207], v63 offset:512
    ds_read_b64_tr_b16 a[208:209], v60 offset:4096
    ds_read_b64_tr_b16 a[210:211], v60 offset:4608
    ds_read_b64_tr_b16 a[212:213], v61 offset:4096
    ds_read_b64_tr_b16 a[214:215], v61 offset:4608
    ds_read_b64_tr_b16 a[216:217], v62 offset:4096
    ds_read_b64_tr_b16 a[218:219], v62 offset:4608
    ds_read_b64_tr_b16 a[220:221], v63 offset:4096
    ds_read_b64_tr_b16 a[222:223], v63 offset:4608
    s_add_u32 m0, s42, 0
    s_nop 0
    buffer_load_dwordx4 v48, s[12:15], s54 offen lds
    s_add_u32 m0, s42, 1024
    s_nop 0
    buffer_load_dwordx4 v49, s[12:15], s54 offen lds
    s_add_u32 m0, s42, 8192
    s_nop 0
    buffer_load_dwordx4 v50, s[12:15], s54 offen lds
    s_add_u32 m0, s42, 9216
    s_nop 0
    buffer_load_dwordx4 v51, s[12:15], s54 offen lds
    s_add_u32 m0, s42, 16384
    s_nop 0
    buffer_load_dwordx4 v52, s[12:15], s54 offen lds
    s_add_u32 m0, s42, 17408
    s_nop 0
    buffer_load_dwordx4 v53, s[12:15], s54 offen lds
    s_add_u32 m0, s42, 24576
    s_nop 0
    buffer_load_dwordx4 v54, s[12:15], s54 offen lds
    s_add_u32 m0, s42, 25600
    s_nop 0
    buffer_load_dwordx4 v55, s[12:15], s54 offen lds
    s_add_u32 s54, s54, 131072
    s_waitcnt lgkmcnt(0)
    v_add_u32 v60, 65536, v56
    v_add_u32 v61, 65536, v57
    v_add_u32 v62, 65536, v58
    v_add_u32 v63, 65536, v59
    s_waitcnt vmcnt(24)
    s_barrier
    ds_read_b64_tr_b16 a[224:225], v60 offset:0
    ds_read_b64_tr_b16 a[226:227], v60 offset:512
    ds_read_b64_tr_b16 a[228:229], v61 offset:0
    ds_read_b64_tr_b16 a[230:231], v61 offset:512
    ds_read_b64_tr_b16 a[232:233], v62 offset:0
    ds_read_b64_tr_b16 a[234:235], v62 offset:512
    ds_read_b64_tr_b16 a[236:237], v63 offset:0
    ds_read_b64_tr_b16 a[238:239], v63 offset:512
    ds_read_b64_tr_b16 a[240:241], v60 offset:4096
    ds_read_b64_tr_b16 a[242:243], v60 offset:4608
    ds_read_b64_tr_b16 a[244:245], v61 offset:4096
    ds_read_b64_tr_b16 a[246:247], v61 offset:4608
    ds_read_b64_tr_b16 a[248:249], v62 offset:4096
    ds_read_b64_tr_b16 a[250:251], v62 offset:4608
    ds_read_b64_tr_b16 a[252:253], v63 offset:4096
    ds_read_b64_tr_b16 a[254:255], v63 offset:4608
    s_add_u32 m0, s42, 32768
    s_nop 0
    buffer_load_dwordx4 v48, s[12:15], s54 offen lds
    s_add_u32 m0, s42, 33792
    s_nop 0
    buffer_load_dwordx4 v49, s[12:15], s54 offen lds
    s_add_u32 m0, s42, 40960
    s_nop 0
    buffer_load_dwordx4 v50, s[12:15], s54 offen lds
    s_add_u32 m0, s42, 41984
    s_nop 0
    buffer_load_dwordx4 v51, s[12:15], s54 offen lds
    s_add_u32 m0, s42, 49152
    s_nop 0
    buffer_load_dwordx4 v52, s[12:15], s54 offen lds
    s_add_u32 m0, s42, 50176
    s_nop 0
    buffer_load_dwordx4 v53, s[12:15], s54 offen lds
    s_add_u32 m0, s42, 57344
    s_nop 0
    buffer_load_dwordx4 v54, s[12:15], s54 offen lds
    s_add_u32 m0, s42, 58368
    s_nop 0
    buffer_load_dwordx4 v55, s[12:15], s54 offen lds
    s_add_u32 s54, s54, 131072
    s_waitcnt lgkmcnt(0)
    v_add_u32 v60, 98304, v56
    v_add_u32 v61, 98304, v57
    v_add_u32 v62, 98304, v58
    v_add_u32 v63, 98304, v59
    s_waitcnt vmcnt(24)
    s_barrier
    ds_read_b64_tr_b16 v[128:129], v60 offset:0
    ds_read_b64_tr_b16 v[130:131], v60 offset:512
    ds_read_b64_tr_b16 v[132:133], v61 offset:0
    ds_read_b64_tr_b16 v[134:135], v61 offset:512
    ds_read_b64_tr_b16 v[136:137], v62 offset:0
    ds_read_b64_tr_b16 v[138:139], v62 offset:512
    ds_read_b64_tr_b16 v[140:141], v63 offset:0
    ds_read_b64_tr_b16 v[142:143], v63 offset:512
    ds_read_b64_tr_b16 v[144:145], v60 offset:4096
    ds_read_b64_tr_b16 v[146:147], v60 offset:4608
    ds_read_b64_tr_b16 v[148:149], v61 offset:4096
    ds_read_b64_tr_b16 v[150:151], v61 offset:4608
    ds_read_b64_tr_b16 v[152:153], v62 offset:4096
    ds_read_b64_tr_b16 v[154:155], v62 offset:4608
    ds_read_b64_tr_b16 v[156:157], v63 offset:4096
    ds_read_b64_tr_b16 v[158:159], v63 offset:4608
    s_waitcnt lgkmcnt(0)
    v_add_u32 v60, 131072, v56
    v_add_u32 v61, 131072, v57
    v_add_u32 v62, 131072, v58
    v_add_u32 v63, 131072, v59
    s_waitcnt vmcnt(16)
    s_barrier
    ds_read_b64_tr_b16 v[160:161], v60 offset:0
    ds_read_b64_tr_b16 v[162:163], v60 offset:512
    ds_read_b64_tr_b16 v[164:165], v61 offset:0
    ds_read_b64_tr_b16 v[166:167], v61 offset:512
    ds_read_b64_tr_b16 v[168:169], v62 offset:0
    ds_read_b64_tr_b16 v[170:171], v62 offset:512
    ds_read_b64_tr_b16 v[172:173], v63 offset:0
    ds_read_b64_tr_b16 v[174:175], v63 offset:512
    ds_read_b64_tr_b16 v[176:177], v60 offset:4096
    ds_read_b64_tr_b16 v[178:179], v60 offset:4608
    ds_read_b64_tr_b16 v[180:181], v61 offset:4096
    ds_read_b64_tr_b16 v[182:183], v61 offset:4608
    ds_read_b64_tr_b16 v[184:185], v62 offset:4096
    ds_read_b64_tr_b16 v[186:187], v62 offset:4608
    ds_read_b64_tr_b16 v[188:189], v63 offset:4096
    ds_read_b64_tr_b16 v[190:191], v63 offset:4608
    s_waitcnt lgkmcnt(0)
    v_add_u32 v60, 0, v56
    v_add_u32 v61, 0, v57
    v_add_u32 v62, 0, v58
    v_add_u32 v63, 0, v59
    s_waitcnt vmcnt(8)
    s_barrier
    ds_read_b64_tr_b16 v[192:193], v60 offset:0
    ds_read_b64_tr_b16 v[194:195], v60 offset:512
    ds_read_b64_tr_b16 v[196:197], v61 offset:0
    ds_read_b64_tr_b16 v[198:199], v61 offset:512
    ds_read_b64_tr_b16 v[200:201], v62 offset:0
    ds_read_b64_tr_b16 v[202:203], v62 offset:512
    ds_read_b64_tr_b16 v[204:205], v63 offset:0
    ds_read_b64_tr_b16 v[206:207], v63 offset:512
    ds_read_b64_tr_b16 v[208:209], v60 offset:4096
    ds_read_b64_tr_b16 v[210:211], v60 offset:4608
    ds_read_b64_tr_b16 v[212:213], v61 offset:4096
    ds_read_b64_tr_b16 v[214:215], v61 offset:4608
    ds_read_b64_tr_b16 v[216:217], v62 offset:4096
    ds_read_b64_tr_b16 v[218:219], v62 offset:4608
    ds_read_b64_tr_b16 v[220:221], v63 offset:4096
    ds_read_b64_tr_b16 v[222:223], v63 offset:4608
    s_waitcnt lgkmcnt(0)
    v_add_u32 v60, 32768, v56
    v_add_u32 v61, 32768, v57
    v_add_u32 v62, 32768, v58
    v_add_u32 v63, 32768, v59
    s_waitcnt vmcnt(0)
    s_barrier
    ds_read_b64_tr_b16 v[224:225], v60 offset:0
    ds_read_b64_tr_b16 v[226:227], v60 offset:512
    ds_read_b64_tr_b16 v[228:229], v61 offset:0
    ds_read_b64_tr_b16 v[230:231], v61 offset:512
    ds_read_b64_tr_b16 v[232:233], v62 offset:0
    ds_read_b64_tr_b16 v[234:235], v62 offset:512
    ds_read_b64_tr_b16 v[236:237], v63 offset:0
    ds_read_b64_tr_b16 v[238:239], v63 offset:512
    ds_read_b64_tr_b16 v[240:241], v60 offset:4096
    ds_read_b64_tr_b16 v[242:243], v60 offset:4608
    ds_read_b64_tr_b16 v[244:245], v61 offset:4096
    ds_read_b64_tr_b16 v[246:247], v61 offset:4608
    ds_read_b64_tr_b16 v[248:249], v62 offset:4096
    ds_read_b64_tr_b16 v[250:251], v62 offset:4608
    ds_read_b64_tr_b16 v[252:253], v63 offset:4096
    ds_read_b64_tr_b16 v[254:255], v63 offset:4608
    s_waitcnt lgkmcnt(0)
    s_barrier
    s_cmp_lg_u32 s32, 0
    s_cbranch_scc1 L_arv73
    s_add_u32 s20, s82, 0x80
    s_addc_u32 s21, s83, 0
    s_mov_b32 s22, 0x4
    s_mov_b32 s23, 0x00020000
    buffer_load_dword v80, v124, s[20:23], 0 offen sc1
    s_waitcnt vmcnt(0)
    v_cmp_eq_u32 vcc, v124, v80
    s_cbranch_vccnz L_spin74
L_back75:
L_arv73:
    s_add_u32 s96, s41, 8126464
    s_mov_b32 s98, s41
    s_mov_b32 s45, 0x5560000
    buffer_load_dword v96, v6, s[16:19], s45 offen sc1
    s_waitcnt vmcnt(0)
    v_cmp_ne_u32 vcc, 0, v96
    s_cbranch_vccnz L_spin76
L_back77:
    s_barrier
    s_add_u32 m0, s43, 0
    s_add_u32 s42, s41, 0
    buffer_load_dwordx4 v1, s[16:19], s42 offen offset:0 sc1 lds
    buffer_load_dwordx4 v1, s[16:19], s42 offen offset:1024 sc1 lds
    buffer_load_dwordx4 v1, s[16:19], s42 offen offset:2048 sc1 lds
    s_add_u32 m0, s43, 12288
    s_add_u32 s42, s41, 12288
    buffer_load_dwordx4 v1, s[16:19], s42 offen offset:0 sc1 lds
    buffer_load_dwordx4 v1, s[16:19], s42 offen offset:1024 sc1 lds
    buffer_load_dwordx4 v1, s[16:19], s42 offen offset:2048 sc1 lds
    s_add_u32 m0, s43, 24576
    s_add_u32 s42, s41, 24576
    buffer_load_dwordx4 v1, s[16:19], s42 offen offset:0 sc1 lds
    buffer_load_dwordx4 v1, s[16:19], s42 offen offset:1024 sc1 lds
    buffer_load_dwordx4 v1, s[16:19], s42 offen offset:2048 sc1 lds
    s_add_u32 s45, s45, 131072
    s_waitcnt vmcnt(0) lgkmcnt(0)
    s_barrier
    s_mov_b32 s52, 0x5e00000
    s_mov_b32 s46, 0x5e00000
    s_add_u32 s20, s84, 0x5e00000
    s_addc_u32 s21, s85, 0
    s_mov_b32 s22, 0x400000
    s_mov_b32 s23, 0x00020000
    ds_read_b128 v[80:83], v2 offset:0
    ds_read_b128 v[84:87], v3 offset:0
    s_mov_b32 s36, 0
    s_waitcnt lgkmcnt(0)
    s_nop 7
L_bs_b0:
    s_waitcnt lgkmcnt(0)
    v_mfma_f32_16x16x32_bf16 v[16:19], a[0:3], v[80:83], 0
    s_and_b32 s44, s90, 0xffffffff
    ds_read_b128 v[88:91], v2 offset:2048
    s_cmp_eq_u32 s36, 0
    v_mfma_f32_16x16x32_bf16 v[24:27], a[0:3], v[84:87], 0
    s_cselect_b32 s44, 0x5e00000, s44
    s_xor_b32 s49, s44, 0
    v_cvt_pk_bf16_f32 v48, v48, v49
    v_mfma_f32_16x16x32_bf16 v[28:31], a[4:7], v[84:87], 0
    ds_read_b128 v[92:95], v3 offset:2048
    v_cvt_pk_bf16_f32 v49, v50, v51
    v_mfma_f32_16x16x32_bf16 v[20:23], a[4:7], v[80:83], 0
    v_cvt_pk_bf16_f32 v50, v52, v53
    v_cvt_pk_bf16_f32 v51, v54, v55
    v_mfma_f32_16x16x32_bf16 v[32:35], a[8:11], v[80:83], 0
    buffer_store_dwordx4 v[48:51], v1, s[16:19], s49 offen offset:3072 sc1
    v_mfma_f32_16x16x32_bf16 v[40:43], a[8:11], v[84:87], 0
    s_xor_b32 s49, s44, 16384
    v_cvt_pk_bf16_f32 v56, v56, v57
    v_cvt_pk_bf16_f32 v57, v58, v59
    v_mfma_f32_16x16x32_bf16 v[44:47], a[12:15], v[84:87], 0
    v_cvt_pk_bf16_f32 v58, v60, v61
    v_cvt_pk_bf16_f32 v59, v62, v63
    v_mfma_f32_16x16x32_bf16 v[36:39], a[12:15], v[80:83], 0
    s_waitcnt lgkmcnt(0)
    v_mfma_f32_16x16x32_bf16 v[16:19], a[16:19], v[88:91], v[16:19]
    ds_read_b128 v[80:83], v2 offset:4096
    v_mfma_f32_16x16x32_bf16 v[24:27], a[16:19], v[92:95], v[24:27]
    buffer_store_dwordx4 v[56:59], v1, s[16:19], s49 offen offset:3072 sc1
    v_mfma_f32_16x16x32_bf16 v[28:31], a[20:23], v[92:95], v[28:31]
    s_xor_b32 s49, s44, 32768
    ds_read_b128 v[84:87], v3 offset:4096
    v_cvt_pk_bf16_f32 v64, v64, v65
    v_mfma_f32_16x16x32_bf16 v[20:23], a[20:23], v[88:91], v[20:23]
    v_cvt_pk_bf16_f32 v65, v66, v67
    v_cvt_pk_bf16_f32 v66, v68, v69
    v_mfma_f32_16x16x32_bf16 v[32:35], a[24:27], v[88:91], v[32:35]
    v_cvt_pk_bf16_f32 v67, v70, v71
    v_mfma_f32_16x16x32_bf16 v[40:43], a[24:27], v[92:95], v[40:43]
    buffer_store_dwordx4 v[64:67], v1, s[16:19], s49 offen offset:3072 sc1
    v_mfma_f32_16x16x32_bf16 v[44:47], a[28:31], v[92:95], v[44:47]
    s_xor_b32 s49, s44, 49152
    v_cvt_pk_bf16_f32 v72, v72, v73
    v_cvt_pk_bf16_f32 v73, v74, v75
    v_mfma_f32_16x16x32_bf16 v[36:39], a[28:31], v[88:91], v[36:39]
    s_waitcnt lgkmcnt(0)
    v_cvt_pk_bf16_f32 v74, v76, v77
    v_cvt_pk_bf16_f32 v75, v78, v79
    v_mfma_f32_16x16x32_bf16 v[16:19], a[32:35], v[80:83], v[16:19]
    s_add_u32 m0, s43, 36864
    ds_read_b128 v[88:91], v2 offset:6144
    s_add_u32 s42, s41, 36864
    v_mfma_f32_16x16x32_bf16 v[24:27], a[32:35], v[84:87], v[24:27]
    buffer_store_dwordx4 v[72:75], v1, s[16:19], s49 offen offset:3072 sc1
    v_mfma_f32_16x16x32_bf16 v[28:31], a[36:39], v[84:87], v[28:31]
    s_add_u32 s90, s90, 262144
    ds_read_b128 v[92:95], v3 offset:6144
    v_mfma_f32_16x16x32_bf16 v[20:23], a[36:39], v[80:83], v[20:23]
    v_mfma_f32_16x16x32_bf16 v[32:35], a[40:43], v[80:83], v[32:35]
    buffer_load_dwordx4 v1, s[16:19], s42 offen offset:0 sc1 lds
    v_mfma_f32_16x16x32_bf16 v[40:43], a[40:43], v[84:87], v[40:43]
    v_mfma_f32_16x16x32_bf16 v[44:47], a[44:47], v[84:87], v[44:47]
    v_mfma_f32_16x16x32_bf16 v[36:39], a[44:47], v[80:83], v[36:39]
    s_waitcnt lgkmcnt(0)
    v_mfma_f32_16x16x32_bf16 v[16:19], a[48:51], v[88:91], v[16:19]
    ds_read_b128 v[80:83], v2 offset:8192
    v_mfma_f32_16x16x32_bf16 v[24:27], a[48:51], v[92:95], v[24:27]
    v_mfma_f32_16x16x32_bf16 v[28:31], a[52:55], v[92:95], v[28:31]
    ds_read_b128 v[84:87], v3 offset:8192
    v_mfma_f32_16x16x32_bf16 v[20:23], a[52:55], v[88:91], v[20:23]
    buffer_load_dwordx4 v1, s[16:19], s42 offen offset:1024 sc1 lds
    v_mfma_f32_16x16x32_bf16 v[32:35], a[56:59], v[88:91], v[32:35]
    v_mfma_f32_16x16x32_bf16 v[40:43], a[56:59], v[92:95], v[40:43]
    v_mfma_f32_16x16x32_bf16 v[44:47], a[60:63], v[92:95], v[44:47]
    v_mfma_f32_16x16x32_bf16 v[36:39], a[60:63], v[88:91], v[36:39]
    s_waitcnt lgkmcnt(0)
    v_mfma_f32_16x16x32_bf16 v[16:19], a[64:67], v[80:83], v[16:19]
    ds_read_b128 v[88:91], v2 offset:10240
    v_mfma_f32_16x16x32_bf16 v[24:27], a[64:67], v[84:87], v[24:27]
    buffer_load_dwordx4 v1, s[16:19], s42 offen offset:2048 sc1 lds
    v_mfma_f32_16x16x32_bf16 v[28:31], a[68:71], v[84:87], v[28:31]
    s_add_u32 s98, s98, 262144
    ds_read_b128 v[92:95], v3 offset:10240
    s_min_u32 s98, s98, s96
    v_mfma_f32_16x16x32_bf16 v[20:23], a[68:71], v[80:83], v[20:23]
    s_and_b32 s41, s98, 0xffffffff
    v_mfma_f32_16x16x32_bf16 v[32:35], a[72:75], v[80:83], v[32:35]
    v_mfma_f32_16x16x32_bf16 v[40:43], a[72:75], v[84:87], v[40:43]
    v_mfma_f32_16x16x32_bf16 v[44:47], a[76:79], v[84:87], v[44:47]
    v_mfma_f32_16x16x32_bf16 v[36:39], a[76:79], v[80:83], v[36:39]
    s_waitcnt vmcnt(7) lgkmcnt(0)
    s_barrier
    v_mfma_f32_16x16x32_bf16 v[16:19], a[80:83], v[88:91], v[16:19]
    ds_read_b128 v[80:83], v2 offset:12288
    v_mfma_f32_16x16x32_bf16 v[24:27], a[80:83], v[92:95], v[24:27]
    v_mfma_f32_16x16x32_bf16 v[28:31], a[84:87], v[92:95], v[28:31]
    ds_read_b128 v[84:87], v3 offset:12288
    v_mfma_f32_16x16x32_bf16 v[20:23], a[84:87], v[88:91], v[20:23]
    v_mfma_f32_16x16x32_bf16 v[32:35], a[88:91], v[88:91], v[32:35]
    v_mfma_f32_16x16x32_bf16 v[40:43], a[88:91], v[92:95], v[40:43]
    v_mfma_f32_16x16x32_bf16 v[44:47], a[92:95], v[92:95], v[44:47]
    v_mfma_f32_16x16x32_bf16 v[36:39], a[92:95], v[88:91], v[36:39]
    s_waitcnt lgkmcnt(0)
    v_mfma_f32_16x16x32_bf16 v[16:19], a[96:99], v[80:83], v[16:19]
    ds_read_b128 v[88:91], v2 offset:14336
    v_mfma_f32_16x16x32_bf16 v[24:27], a[96:99], v[84:87], v[24:27]
    v_mfma_f32_16x16x32_bf16 v[28:31], a[100:103], v[84:87], v[28:31]
    ds_read_b128 v[92:95], v3 offset:14336
    v_mfma_f32_16x16x32_bf16 v[20:23], a[100:103], v[80:83], v[20:23]
    v_mfma_f32_16x16x32_bf16 v[32:35], a[104:107], v[80:83], v[32:35]
    v_mfma_f32_16x16x32_bf16 v[40:43], a[104:107], v[84:87], v[40:43]
    v_mfma_f32_16x16x32_bf16 v[44:47], a[108:111], v[84:87], v[44:47]
    v_mfma_f32_16x16x32_bf16 v[36:39], a[108:111], v[80:83], v[36:39]
    s_waitcnt lgkmcnt(0)
    v_mfma_f32_16x16x32_bf16 v[16:19], a[112:115], v[88:91], v[16:19]
    ds_read_b128 v[80:83], v2 offset:16384
    v_mfma_f32_16x16x32_bf16 v[24:27], a[112:115], v[92:95], v[24:27]
    v_mfma_f32_16x16x32_bf16 v[28:31], a[116:119], v[92:95], v[28:31]
    ds_read_b128 v[84:87], v3 offset:16384
    v_mfma_f32_16x16x32_bf16 v[20:23], a[116:119], v[88:91], v[20:23]
    v_mfma_f32_16x16x32_bf16 v[32:35], a[120:123], v[88:91], v[32:35]
    v_mfma_f32_16x16x32_bf16 v[40:43], a[120:123], v[92:95], v[40:43]
    v_mfma_f32_16x16x32_bf16 v[44:47], a[124:127], v[92:95], v[44:47]
    v_mfma_f32_16x16x32_bf16 v[36:39], a[124:127], v[88:91], v[36:39]
    s_waitcnt lgkmcnt(0)
    v_mfma_f32_16x16x32_bf16 v[16:19], a[128:131], v[80:83], v[16:19]
    ds_read_b128 v[88:91], v2 offset:18432
    v_mfma_f32_16x16x32_bf16 v[24:27], a[128:131], v[84:87], v[24:27]
    v_mfma_f32_16x16x32_bf16 v[28:31], a[132:135], v[84:87], v[28:31]
    ds_read_b128 v[92:95], v3 offset:18432
    v_mfma_f32_16x16x32_bf16 v[20:23], a[132:135], v[80:83], v[20:23]
    v_mfma_f32_16x16x32_bf16 v[32:35], a[136:139], v[80:83], v[32:35]
    v_mfma_f32_16x16x32_bf16 v[40:43], a[136:139], v[84:87], v[40:43]
    v_mfma_f32_16x16x32_bf16 v[44:47], a[140:143], v[84:87], v[44:47]
    v_mfma_f32_16x16x32_bf16 v[36:39], a[140:143], v[80:83], v[36:39]
    s_waitcnt lgkmcnt(0)
    v_mfma_f32_16x16x32_bf16 v[16:19], a[144:147], v[88:91], v[16:19]
    ds_read_b128 v[80:83], v2 offset:20480
    v_mfma_f32_16x16x32_bf16 v[24:27], a[144:147], v[92:95], v[24:27]
    v_mfma_f32_16x16x32_bf16 v[28:31], a[148:151], v[92:95], v[28:31]
    ds_read_b128 v[84:87], v3 offset:20480
    v_mfma_f32_16x16x32_bf16 v[20:23], a[148:151], v[88:91], v[20:23]
    buffer_load_dword v96, v6, s[16:19], s45 offen sc1
    v_mfma_f32_16x16x32_bf16 v[32:35], a[152:155], v[88:91], v[32:35]
    s_add_u32 m0, s43, 98304
    s_add_u32 s42, s41, 0
    v_mfma_f32_16x16x32_bf16 v[40:43], a[152:155], v[92:95], v[40:43]
    v_mfma_f32_16x16x32_bf16 v[44:47], a[156:159], v[92:95], v[44:47]
    v_mfma_f32_16x16x32_bf16 v[36:39], a[156:159], v[88:91], v[36:39]
    s_waitcnt lgkmcnt(0)
    v_mfma_f32_16x16x32_bf16 v[16:19], a[160:163], v[80:83], v[16:19]
    ds_read_b128 v[88:91], v2 offset:22528
    v_mfma_f32_16x16x32_bf16 v[24:27], a[160:163], v[84:87], v[24:27]
    v_mfma_f32_16x16x32_bf16 v[28:31], a[164:167], v[84:87], v[28:31]
    ds_read_b128 v[92:95], v3 offset:22528
    v_mfma_f32_16x16x32_bf16 v[20:23], a[164:167], v[80:83], v[20:23]
    v_mfma_f32_16x16x32_bf16 v[32:35], a[168:171], v[80:83], v[32:35]
    v_mfma_f32_16x16x32_bf16 v[40:43], a[168:171], v[84:87], v[40:43]
    v_mfma_f32_16x16x32_bf16 v[44:47], a[172:175], v[84:87], v[44:47]
    v_mfma_f32_16x16x32_bf16 v[36:39], a[172:175], v[80:83], v[36:39]
    s_waitcnt lgkmcnt(0)
    v_mfma_f32_16x16x32_bf16 v[16:19], a[176:179], v[88:91], v[16:19]
    ds_read_b128 v[80:83], v2 offset:24576
    v_mfma_f32_16x16x32_bf16 v[24:27], a[176:179], v[92:95], v[24:27]
    v_mfma_f32_16x16x32_bf16 v[28:31], a[180:183], v[92:95], v[28:31]
    ds_read_b128 v[84:87], v3 offset:24576
    v_mfma_f32_16x16x32_bf16 v[20:23], a[180:183], v[88:91], v[20:23]
    v_mfma_f32_16x16x32_bf16 v[32:35], a[184:187], v[88:91], v[32:35]
    v_mfma_f32_16x16x32_bf16 v[40:43], a[184:187], v[92:95], v[40:43]
    v_mfma_f32_16x16x32_bf16 v[44:47], a[188:191], v[92:95], v[44:47]
    v_mfma_f32_16x16x32_bf16 v[36:39], a[188:191], v[88:91], v[36:39]
    s_waitcnt lgkmcnt(0)
    v_mfma_f32_16x16x32_bf16 v[16:19], a[192:195], v[80:83], v[16:19]
    ds_read_b128 v[88:91], v2 offset:26624
    v_mfma_f32_16x16x32_bf16 v[24:27], a[192:195], v[84:87], v[24:27]
    v_mfma_f32_16x16x32_bf16 v[28:31], a[196:199], v[84:87], v[28:31]
    ds_read_b128 v[92:95], v3 offset:26624
    v_mfma_f32_16x16x32_bf16 v[20:23], a[196:199], v[80:83], v[20:23]
    v_mfma_f32_16x16x32_bf16 v[32:35], a[200:203], v[80:83], v[32:35]
    v_mfma_f32_16x16x32_bf16 v[40:43], a[200:203], v[84:87], v[40:43]
    v_mfma_f32_16x16x32_bf16 v[44:47], a[204:207], v[84:87], v[44:47]
    v_mfma_f32_16x16x32_bf16 v[36:39], a[204:207], v[80:83], v[36:39]
    s_waitcnt lgkmcnt(0)
    v_mfma_f32_16x16x32_bf16 v[16:19], a[208:211], v[88:91], v[16:19]
    ds_read_b128 v[80:83], v2 offset:28672
    v_mfma_f32_16x16x32_bf16 v[24:27], a[208:211], v[92:95], v[24:27]
    v_mfma_f32_16x16x32_bf16 v[28:31], a[212:215], v[92:95], v[28:31]
    ds_read_b128 v[84:87], v3 offset:28672
    v_mfma_f32_16x16x32_bf16 v[20:23], a[212:215], v[88:91], v[20:23]
    v_mfma_f32_16x16x32_bf16 v[32:35], a[216:219], v[88:91], v[32:35]
    v_mfma_f32_16x16x32_bf16 v[40:43], a[216:219], v[92:95], v[40:43]
    v_mfma_f32_16x16x32_bf16 v[44:47], a[220:223], v[92:95], v[44:47]
    v_mfma_f32_16x16x32_bf16 v[36:39], a[220:223], v[88:91], v[36:39]
    s_waitcnt lgkmcnt(0)
    v_mfma_f32_16x16x32_bf16 v[16:19], a[224:227], v[80:83], v[16:19]
    ds_read_b128 v[88:91], v2 offset:30720
    v_mfma_f32_16x16x32_bf16 v[24:27], a[224:227], v[84:87], v[24:27]
    v_mfma_f32_16x16x32_bf16 v[28:31], a[228:231], v[84:87], v[28:31]
    ds_read_b128 v[92:95], v3 offset:30720
    v_mfma_f32_16x16x32_bf16 v[20:23], a[228:231], v[80:83], v[20:23]
    v_mfma_f32_16x16x32_bf16 v[32:35], a[232:235], v[80:83], v[32:35]
    v_mfma_f32_16x16x32_bf16 v[40:43], a[232:235], v[84:87], v[40:43]
    v_mfma_f32_16x16x32_bf16 v[44:47], a[236:239], v[84:87], v[44:47]
    v_mfma_f32_16x16x32_bf16 v[36:39], a[236:239], v[80:83], v[36:39]
    s_waitcnt lgkmcnt(0)
    v_mfma_f32_16x16x32_bf16 v[16:19], a[240:243], v[88:91], v[16:19]
    s_waitcnt vmcnt(0)
    ds_read_b128 v[80:83], v2 offset:32768
    v_cmp_ne_u32 vcc, 0, v96
    v_mfma_f32_16x16x32_bf16 v[24:27], a[240:243], v[92:95], v[24:27]
    v_mfma_f32_16x16x32_bf16 v[28:31], a[244:247], v[92:95], v[28:31]
    s_cbranch_vccnz L_spin78
L_back79:
    ds_read_b128 v[84:87], v3 offset:32768
    s_barrier
    v_mfma_f32_16x16x32_bf16 v[20:23], a[244:247], v[88:91], v[20:23]
    buffer_load_dwordx4 v1, s[16:19], s42 offen offset:0 sc1 lds
    v_mfma_f32_16x16x32_bf16 v[32:35], a[248:251], v[88:91], v[32:35]
    v_mfma_f32_16x16x32_bf16 v[40:43], a[248:251], v[92:95], v[40:43]
    v_mfma_f32_16x16x32_bf16 v[44:47], a[252:255], v[92:95], v[44:47]
    buffer_load_dwordx4 v1, s[16:19], s42 offen offset:1024 sc1 lds
    v_mfma_f32_16x16x32_bf16 v[36:39], a[252:255], v[88:91], v[36:39]
    s_waitcnt lgkmcnt(0)
    v_mfma_f32_16x16x32_bf16 v[16:19], v[128:131], v[80:83], v[16:19]
    ds_read_b128 v[88:91], v2 offset:34816
    v_mfma_f32_16x16x32_bf16 v[24:27], v[128:131], v[84:87], v[24:27]
    buffer_load_dwordx4 v1, s[16:19], s42 offen offset:2048 sc1 lds
    v_mfma_f32_16x16x32_bf16 v[28:31], v[132:135], v[84:87], v[28:31]
    ds_read_b128 v[92:95], v3 offset:34816
    v_mfma_f32_16x16x32_bf16 v[20:23], v[132:135], v[80:83], v[20:23]
    v_mfma_f32_16x16x32_bf16 v[32:35], v[136:139], v[80:83], v[32:35]
    buffer_store_dword v124, v124, s[16:19], s91 offen sc1
    v_mfma_f32_16x16x32_bf16 v[40:43], v[136:139], v[84:87], v[40:43]
    s_add_u32 s91, s91, 131072
    s_add_u32 m0, s43, 110592
    s_add_u32 s42, s41, 12288
    v_mfma_f32_16x16x32_bf16 v[44:47], v[140:143], v[84:87], v[44:47]
    v_mfma_f32_16x16x32_bf16 v[36:39], v[140:143], v[80:83], v[36:39]
    s_waitcnt lgkmcnt(0)
    v_mfma_f32_16x16x32_bf16 v[16:19], v[144:147], v[88:91], v[16:19]
    ds_read_b128 v[80:83], v2 offset:36864
    v_mfma_f32_16x16x32_bf16 v[24:27], v[144:147], v[92:95], v[24:27]
    v_mfma_f32_16x16x32_bf16 v[28:31], v[148:151], v[92:95], v[28:31]
    ds_read_b128 v[84:87], v3 offset:36864
    v_mfma_f32_16x16x32_bf16 v[20:23], v[148:151], v[88:91], v[20:23]
    buffer_load_dwordx4 v1, s[16:19], s42 offen offset:0 sc1 lds
    v_mfma_f32_16x16x32_bf16 v[32:35], v[152:155], v[88:91], v[32:35]
    v_mfma_f32_16x16x32_bf16 v[40:43], v[152:155], v[92:95], v[40:43]
    v_mfma_f32_16x16x32_bf16 v[44:47], v[156:159], v[92:95], v[44:47]
    v_mfma_f32_16x16x32_bf16 v[36:39], v[156:159], v[88:91], v[36:39]
    s_waitcnt lgkmcnt(0)
    v_mfma_f32_16x16x32_bf16 v[16:19], v[160:163], v[80:83], v[16:19]
    ds_read_b128 v[88:91], v2 offset:38912
    v_mfma_f32_16x16x32_bf16 v[24:27], v[160:163], v[84:87], v[24:27]
    buffer_load_dwordx4 v1, s[16:19], s42 offen offset:1024 sc1 lds
    v_mfma_f32_16x16x32_bf16 v[28:31], v[164:167], v[84:87], v[28:31]
    ds_read_b128 v[92:95], v3 offset:38912
    v_mfma_f32_16x16x32_bf16 v[20:23], v[164:167], v[80:83], v[20:23]
    v_mfma_f32_16x16x32_bf16 v[32:35], v[168:171], v[80:83], v[32:35]
    v_mfma_f32_16x16x32_bf16 v[40:43], v[168:171], v[84:87], v[40:43]
    v_mfma_f32_16x16x32_bf16 v[44:47], v[172:175], v[84:87], v[44:47]
    buffer_load_dwordx4 v1, s[16:19], s42 offen offset:2048 sc1 lds
    v_mfma_f32_16x16x32_bf16 v[36:39], v[172:175], v[80:83], v[36:39]
    s_waitcnt lgkmcnt(0)
    s_add_u32 m0, s43, 122880
    s_add_u32 s42, s41, 24576
    v_mfma_f32_16x16x32_bf16 v[16:19], v[176:179], v[88:91], v[16:19]
    ds_read_b128 v[80:83], v2 offset:40960
    v_mfma_f32_16x16x32_bf16 v[24:27], v[176:179], v[92:95], v[24:27]
    v_mfma_f32_16x16x32_bf16 v[28:31], v[180:183], v[92:95], v[28:31]
    ds_read_b128 v[84:87], v3 offset:40960
    v_mfma_f32_16x16x32_bf16 v[20:23], v[180:183], v[88:91], v[20:23]
    buffer_load_dwordx4 v1, s[16:19], s42 offen offset:0 sc1 lds
    v_mfma_f32_16x16x32_bf16 v[32:35], v[184:187], v[88:91], v[32:35]
    v_mfma_f32_16x16x32_bf16 v[40:43], v[184:187], v[92:95], v[40:43]
    v_mfma_f32_16x16x32_bf16 v[44:47], v[188:191], v[92:95], v[44:47]
    v_mfma_f32_16x16x32_bf16 v[36:39], v[188:191], v[88:91], v[36:39]
    s_waitcnt lgkmcnt(0)
    v_mfma_f32_16x16x32_bf16 v[16:19], v[192:195], v[80:83], v[16:19]
    ds_read_b128 v[88:91], v2 offset:43008
    v_mfma_f32_16x16x32_bf16 v[24:27], v[192:195], v[84:87], v[24:27]
    buffer_load_dwordx4 v1, s[16:19], s42 offen offset:1024 sc1 lds
    v_mfma_f32_16x16x32_bf16 v[28:31], v[196:199], v[84:87], v[28:31]
    ds_read_b128 v[92:95], v3 offset:43008
    v_mfma_f32_16x16x32_bf16 v[20:23], v[196:199], v[80:83], v[20:23]
    v_mfma_f32_16x16x32_bf16 v[32:35], v[200:203], v[80:83], v[32:35]
    v_mfma_f32_16x16x32_bf16 v[40:43], v[200:203], v[84:87], v[40:43]
    v_mfma_f32_16x16x32_bf16 v[44:47], v[204:207], v[84:87], v[44:47]
    buffer_load_dwordx4 v1, s[16:19], s42 offen offset:2048 sc1 lds
    v_mfma_f32_16x16x32_bf16 v[36:39], v[204:207], v[80:83], v[36:39]
    s_waitcnt lgkmcnt(0)
    s_add_u32 s45, s45, 131072
    v_mfma_f32_16x16x32_bf16 v[16:19], v[208:211], v[88:91], v[16:19]
    ds_read_b128 v[80:83], v2 offset:45056
    v_mfma_f32_16x16x32_bf16 v[24:27], v[208:211], v[92:95], v[24:27]
    v_mfma_f32_16x16x32_bf16 v[28:31], v[212:215], v[92:95], v[28:31]
    ds_read_b128 v[84:87], v3 offset:45056
    v_mfma_f32_16x16x32_bf16 v[20:23], v[212:215], v[88:91], v[20:23]
    v_mfma_f32_16x16x32_bf16 v[32:35], v[216:219], v[88:91], v[32:35]
    v_mfma_f32_16x16x32_bf16 v[40:43], v[216:219], v[92:95], v[40:43]
    v_mfma_f32_16x16x32_bf16 v[44:47], v[220:223], v[92:95], v[44:47]
    v_mfma_f32_16x16x32_bf16 v[36:39], v[220:223], v[88:91], v[36:39]
    s_waitcnt lgkmcnt(0)
    v_mfma_f32_16x16x32_bf16 v[16:19], v[224:227], v[80:83], v[16:19]
    ds_read_b128 v[88:91], v2 offset:47104
    v_mfma_f32_16x16x32_bf16 v[24:27], v[224:227], v[84:87], v[24:27]
    v_mfma_f32_16x16x32_bf16 v[28:31], v[228:231], v[84:87], v[28:31]
    ds_read_b128 v[92:95], v3 offset:47104
    v_mfma_f32_16x16x32_bf16 v[20:23], v[228:231], v[80:83], v[20:23]
    v_mfma_f32_16x16x32_bf16 v[32:35], v[232:235], v[80:83], v[32:35]
    v_mfma_f32_16x16x32_bf16 v[40:43], v[232:235], v[84:87], v[40:43]
    v_mfma_f32_16x16x32_bf16 v[44:47], v[236:239], v[84:87], v[44:47]
    v_mfma_f32_16x16x32_bf16 v[36:39], v[236:239], v[80:83], v[36:39]
    s_waitcnt vmcnt(7) lgkmcnt(0)
    s_barrier
    v_mfma_f32_16x16x32_bf16 v[16:19], v[240:243], v[88:91], v[16:19]
    ds_read_b128 v[80:83], v4 offset:0
    v_mfma_f32_16x16x32_bf16 v[24:27], v[240:243], v[92:95], v[24:27]
    v_mfma_f32_16x16x32_bf16 v[28:31], v[244:247], v[92:95], v[28:31]
    ds_read_b128 v[84:87], v5 offset:0
    v_mfma_f32_16x16x32_bf16 v[20:23], v[244:247], v[88:91], v[20:23]
    v_mfma_f32_16x16x32_bf16 v[32:35], v[248:251], v[88:91], v[32:35]
    v_mfma_f32_16x16x32_bf16 v[40:43], v[248:251], v[92:95], v[40:43]
    v_mfma_f32_16x16x32_bf16 v[44:47], v[252:255], v[92:95], v[44:47]
    v_mfma_f32_16x16x32_bf16 v[36:39], v[252:255], v[88:91], v[36:39]
    s_add_u32 s36, s36, 1
L_bs_b1:
    s_waitcnt lgkmcnt(0)
    v_mfma_f32_16x16x32_bf16 v[48:51], a[0:3], v[80:83], 0
    s_and_b32 s44, s90, 0xffffffff
    ds_read_b128 v[88:91], v4 offset:2048
    s_cmp_eq_u32 s36, 0
    v_mfma_f32_16x16x32_bf16 v[56:59], a[0:3], v[84:87], 0
    s_cselect_b32 s44, 0x5e00000, s44
    s_xor_b32 s49, s44, 0
    v_cvt_pk_bf16_f32 v16, v16, v17
    v_mfma_f32_16x16x32_bf16 v[60:63], a[4:7], v[84:87], 0
    ds_read_b128 v[92:95], v5 offset:2048
    v_cvt_pk_bf16_f32 v17, v18, v19
    v_mfma_f32_16x16x32_bf16 v[52:55], a[4:7], v[80:83], 0
    v_cvt_pk_bf16_f32 v18, v20, v21
    v_cvt_pk_bf16_f32 v19, v22, v23
    v_mfma_f32_16x16x32_bf16 v[64:67], a[8:11], v[80:83], 0
    buffer_store_dwordx4 v[16:19], v1, s[16:19], s49 offen offset:3072 sc1
    v_mfma_f32_16x16x32_bf16 v[72:75], a[8:11], v[84:87], 0
    s_xor_b32 s49, s44, 16384
    v_cvt_pk_bf16_f32 v24, v24, v25
    v_cvt_pk_bf16_f32 v25, v26, v27
    v_mfma_f32_16x16x32_bf16 v[76:79], a[12:15], v[84:87], 0
    v_cvt_pk_bf16_f32 v26, v28, v29
    v_cvt_pk_bf16_f32 v27, v30, v31
    v_mfma_f32_16x16x32_bf16 v[68:71], a[12:15], v[80:83], 0
    s_waitcnt lgkmcnt(0)
    v_mfma_f32_16x16x32_bf16 v[48:51], a[16:19], v[88:91], v[48:51]
    ds_read_b128 v[80:83], v4 offset:4096
    v_mfma_f32_16x16x32_bf16 v[56:59], a[16:19], v[92:95], v[56:59]
    buffer_store_dwordx4 v[24:27], v1, s[16:19], s49 offen offset:3072 sc1
    v_mfma_f32_16x16x32_bf16 v[60:63], a[20:23], v[92:95], v[60:63]
    s_xor_b32 s49, s44, 32768
    ds_read_b128 v[84:87], v5 offset:4096
    v_cvt_pk_bf16_f32 v32, v32, v33
    v_mfma_f32_16x16x32_bf16 v[52:55], a[20:23], v[88:91], v[52:55]
    v_cvt_pk_bf16_f32 v33, v34, v35
    v_cvt_pk_bf16_f32 v34, v36, v37
    v_mfma_f32_16x16x32_bf16 v[64:67], a[24:27], v[88:91], v[64:67]
    v_cvt_pk_bf16_f32 v35, v38, v39
    v_mfma_f32_16x16x32_bf16 v[72:75], a[24:27], v[92:95], v[72:75]
    buffer_store_dwordx4 v[32:35], v1, s[16:19], s49 offen offset:3072 sc1
    v_mfma_f32_16x16x32_bf16 v[76:79], a[28:31], v[92:95], v[76:79]
    s_xor_b32 s49, s44, 49152
    v_cvt_pk_bf16_f32 v40, v40, v41
    v_cvt_pk_bf16_f32 v41, v42, v43
    v_mfma_f32_16x16x32_bf16 v[68:71], a[28:31], v[88:91], v[68:71]
    s_waitcnt lgkmcnt(0)
    v_cvt_pk_bf16_f32 v42, v44, v45
    v_cvt_pk_bf16_f32 v43, v46, v47
    v_mfma_f32_16x16x32_bf16 v[48:51], a[32:35], v[80:83], v[48:51]
    s_add_u32 m0, s43, 135168
    ds_read_b128 v[88:91], v4 offset:6144
    s_add_u32 s42, s41, 36864
    v_mfma_f32_16x16x32_bf16 v[56:59], a[32:35], v[84:87], v[56:59]
    buffer_store_dwordx4 v[40:43], v1, s[16:19], s49 offen offset:3072 sc1
    v_mfma_f32_16x16x32_bf16 v[60:63], a[36:39], v[84:87], v[60:63]
    s_add_u32 s90, s90, 262144
    ds_read_b128 v[92:95], v5 offset:6144
    v_mfma_f32_16x16x32_bf16 v[52:55], a[36:39], v[80:83], v[52:55]
    v_mfma_f32_16x16x32_bf16 v[64:67], a[40:43], v[80:83], v[64:67]
    buffer_load_dwordx4 v1, s[16:19], s42 offen offset:0 sc1 lds
    v_mfma_f32_16x16x32_bf16 v[72:75], a[40:43], v[84:87], v[72:75]
    v_mfma_f32_16x16x32_bf16 v[76:79], a[44:47], v[84:87], v[76:79]
    v_mfma_f32_16x16x32_bf16 v[68:71], a[44:47], v[80:83], v[68:71]
    s_waitcnt lgkmcnt(0)
    v_mfma_f32_16x16x32_bf16 v[48:51], a[48:51], v[88:91], v[48:51]
    ds_read_b128 v[80:83], v4 offset:8192
    v_mfma_f32_16x16x32_bf16 v[56:59], a[48:51], v[92:95], v[56:59]
    v_mfma_f32_16x16x32_bf16 v[60:63], a[52:55], v[92:95], v[60:63]
    ds_read_b128 v[84:87], v5 offset:8192
    v_mfma_f32_16x16x32_bf16 v[52:55], a[52:55], v[88:91], v[52:55]
    buffer_load_dwordx4 v1, s[16:19], s42 offen offset:1024 sc1 lds
    v_mfma_f32_16x16x32_bf16 v[64:67], a[56:59], v[88:91], v[64:67]
    v_mfma_f32_16x16x32_bf16 v[72:75], a[56:59], v[92:95], v[72:75]
    v_mfma_f32_16x16x32_bf16 v[76:79], a[60:63], v[92:95], v[76:79]
    v_mfma_f32_16x16x32_bf16 v[68:71], a[60:63], v[88:91], v[68:71]
    s_waitcnt lgkmcnt(0)
    v_mfma_f32_16x16x32_bf16 v[48:51], a[64:67], v[80:83], v[48:51]
    ds_read_b128 v[88:91], v4 offset:10240
    v_mfma_f32_16x16x32_bf16 v[56:59], a[64:67], v[84:87], v[56:59]
    buffer_load_dwordx4 v1, s[16:19], s42 offen offset:2048 sc1 lds
    v_mfma_f32_16x16x32_bf16 v[60:63], a[68:71], v[84:87], v[60:63]
    s_add_u32 s98, s98, 262144
    ds_read_b128 v[92:95], v5 offset:10240
    s_min_u32 s98, s98, s96
    v_mfma_f32_16x16x32_bf16 v[52:55], a[68:71], v[80:83], v[52:55]
    s_and_b32 s41, s98, 0xffffffff
    v_mfma_f32_16x16x32_bf16 v[64:67], a[72:75], v[80:83], v[64:67]
    v_mfma_f32_16x16x32_bf16 v[72:75], a[72:75], v[84:87], v[72:75]
    v_mfma_f32_16x16x32_bf16 v[76:79], a[76:79], v[84:87], v[76:79]
    v_mfma_f32_16x16x32_bf16 v[68:71], a[76:79], v[80:83], v[68:71]
    s_waitcnt vmcnt(7) lgkmcnt(0)
    s_barrier
    v_mfma_f32_16x16x32_bf16 v[48:51], a[80:83], v[88:91], v[48:51]
    ds_read_b128 v[80:83], v4 offset:12288
    v_mfma_f32_16x16x32_bf16 v[56:59], a[80:83], v[92:95], v[56:59]
    v_mfma_f32_16x16x32_bf16 v[60:63], a[84:87], v[92:95], v[60:63]
    ds_read_b128 v[84:87], v5 offset:12288
    v_mfma_f32_16x16x32_bf16 v[52:55], a[84:87], v[88:91], v[52:55]
    v_mfma_f32_16x16x32_bf16 v[64:67], a[88:91], v[88:91], v[64:67]
    v_mfma_f32_16x16x32_bf16 v[72:75], a[88:91], v[92:95], v[72:75]
    v_mfma_f32_16x16x32_bf16 v[76:79], a[92:95], v[92:95], v[76:79]
    v_mfma_f32_16x16x32_bf16 v[68:71], a[92:95], v[88:91], v[68:71]
    s_waitcnt lgkmcnt(0)
    v_mfma_f32_16x16x32_bf16 v[48:51], a[96:99], v[80:83], v[48:51]
    ds_read_b128 v[88:91], v4 offset:14336
    v_mfma_f32_16x16x32_bf16 v[56:59], a[96:99], v[84:87], v[56:59]
    v_mfma_f32_16x16x32_bf16 v[60:63], a[100:103], v[84:87], v[60:63]
    ds_read_b128 v[92:95], v5 offset:14336
    v_mfma_f32_16x16x32_bf16 v[52:55], a[100:103], v[80:83], v[52:55]
    v_mfma_f32_16x16x32_bf16 v[64:67], a[104:107], v[80:83], v[64:67]
    v_mfma_f32_16x16x32_bf16 v[72:75], a[104:107], v[84:87], v[72:75]
    v_mfma_f32_16x16x32_bf16 v[76:79], a[108:111], v[84:87], v[76:79]
    v_mfma_f32_16x16x32_bf16 v[68:71], a[108:111], v[80:83], v[68:71]
    s_waitcnt lgkmcnt(0)
    v_mfma_f32_16x16x32_bf16 v[48:51], a[112:115], v[88:91], v[48:51]
    ds_read_b128 v[80:83], v4 offset:16384
    v_mfma_f32_16x16x32_bf16 v[56:59], a[112:115], v[92:95], v[56:59]
    v_mfma_f32_16x16x32_bf16 v[60:63], a[116:119], v[92:95], v[60:63]
    ds_read_b128 v[84:87], v5 offset:16384
    v_mfma_f32_16x16x32_bf16 v[52:55], a[116:119], v[88:91], v[52:55]
    v_mfma_f32_16x16x32_bf16 v[64:67], a[120:123], v[88:91], v[64:67]
    v_mfma_f32_16x16x32_bf16 v[72:75], a[120:123], v[92:95], v[72:75]
    v_mfma_f32_16x16x32_bf16 v[76:79], a[124:127], v[92:95], v[76:79]
    v_mfma_f32_16x16x32_bf16 v[68:71], a[124:127], v[88:91], v[68:71]
    s_waitcnt lgkmcnt(0)
    v_mfma_f32_16x16x32_bf16 v[48:51], a[128:131], v[80:83], v[48:51]
    ds_read_b128 v[88:91], v4 offset:18432
    v_mfma_f32_16x16x32_bf16 v[56:59], a[128:131], v[84:87], v[56:59]
    v_mfma_f32_16x16x32_bf16 v[60:63], a[132:135], v[84:87], v[60:63]
    ds_read_b128 v[92:95], v5 offset:18432
    v_mfma_f32_16x16x32_bf16 v[52:55], a[132:135], v[80:83], v[52:55]
    v_mfma_f32_16x16x32_bf16 v[64:67], a[136:139], v[80:83], v[64:67]
    v_mfma_f32_16x16x32_bf16 v[72:75], a[136:139], v[84:87], v[72:75]
    v_mfma_f32_16x16x32_bf16 v[76:79], a[140:143], v[84:87], v[76:79]
    v_mfma_f32_16x16x32_bf16 v[68:71], a[140:143], v[80:83], v[68:71]
    s_waitcnt lgkmcnt(0)
    v_mfma_f32_16x16x32_bf16 v[48:51], a[144:147], v[88:91], v[48:51]
    ds_read_b128 v[80:83], v4 offset:20480
    v_mfma_f32_16x16x32_bf16 v[56:59], a[144:147], v[92:95], v[56:59]
    v_mfma_f32_16x16x32_bf16 v[60:63], a[148:151], v[92:95], v[60:63]
    ds_read_b128 v[84:87], v5 offset:20480
    v_mfma_f32_16x16x32_bf16 v[52:55], a[148:151], v[88:91], v[52:55]
    buffer_load_dword v96, v6, s[16:19], s45 offen sc1
    v_mfma_f32_16x16x32_bf16 v[64:67], a[152:155], v[88:91], v[64:67]
    s_add_u32 m0, s43, 0
    s_add_u32 s42, s41, 0
    v_mfma_f32_16x16x32_bf16 v[72:75], a[152:155], v[92:95], v[72:75]
    v_mfma_f32_16x16x32_bf16 v[76:79], a[156:159], v[92:95], v[76:79]
    v_mfma_f32_16x16x32_bf16 v[68:71], a[156:159], v[88:91], v[68:71]
    s_waitcnt lgkmcnt(0)
    v_mfma_f32_16x16x32_bf16 v[48:51], a[160:163], v[80:83], v[48:51]
    ds_read_b128 v[88:91], v4 offset:22528
    v_mfma_f32_16x16x32_bf16 v[56:59], a[160:163], v[84:87], v[56:59]
    v_mfma_f32_16x16x32_bf16 v[60:63], a[164:167], v[84:87], v[60:63]
    ds_read_b128 v[92:95], v5 offset:22528
    v_mfma_f32_16x16x32_bf16 v[52:55], a[164:167], v[80:83], v[52:55]
    v_mfma_f32_16x16x32_bf16 v[64:67], a[168:171], v[80:83], v[64:67]
    v_mfma_f32_16x16x32_bf16 v[72:75], a[168:171], v[84:87], v[72:75]
    v_mfma_f32_16x16x32_bf16 v[76:79], a[172:175], v[84:87], v[76:79]
    v_mfma_f32_16x16x32_bf16 v[68:71], a[172:175], v[80:83], v[68:71]
    s_waitcnt lgkmcnt(0)
    v_mfma_f32_16x16x32_bf16 v[48:51], a[176:179], v[88:91], v[48:51]
    ds_read_b128 v[80:83], v4 offset:24576
    v_mfma_f32_16x16x32_bf16 v[56:59], a[176:179], v[92:95], v[56:59]
    v_mfma_f32_16x16x32_bf16 v[60:63], a[180:183], v[92:95], v[60:63]
    ds_read_b128 v[84:87], v5 offset:24576
    v_mfma_f32_16x16x32_bf16 v[52:55], a[180:183], v[88:91], v[52:55]
    v_mfma_f32_16x16x32_bf16 v[64:67], a[184:187], v[88:91], v[64:67]
    v_mfma_f32_16x16x32_bf16 v[72:75], a[184:187], v[92:95], v[72:75]
    v_mfma_f32_16x16x32_bf16 v[76:79], a[188:191], v[92:95], v[76:79]
    v_mfma_f32_16x16x32_bf16 v[68:71], a[188:191], v[88:91], v[68:71]
    s_waitcnt lgkmcnt(0)
    v_mfma_f32_16x16x32_bf16 v[48:51], a[192:195], v[80:83], v[48:51]
    ds_read_b128 v[88:91], v4 offset:26624
    v_mfma_f32_16x16x32_bf16 v[56:59], a[192:195], v[84:87], v[56:59]
    v_mfma_f32_16x16x32_bf16 v[60:63], a[196:199], v[84:87], v[60:63]
    ds_read_b128 v[92:95], v5 offset:26624
    v_mfma_f32_16x16x32_bf16 v[52:55], a[196:199], v[80:83], v[52:55]
    v_mfma_f32_16x16x32_bf16 v[64:67], a[200:203], v[80:83], v[64:67]
    v_mfma_f32_16x16x32_bf16 v[72:75], a[200:203], v[84:87], v[72:75]
    v_mfma_f32_16x16x32_bf16 v[76:79], a[204:207], v[84:87], v[76:79]
    v_mfma_f32_16x16x32_bf16 v[68:71], a[204:207], v[80:83], v[68:71]
    s_waitcnt lgkmcnt(0)
    v_mfma_f32_16x16x32_bf16 v[48:51], a[208:211], v[88:91], v[48:51]
    ds_read_b128 v[80:83], v4 offset:28672
    v_mfma_f32_16x16x32_bf16 v[56:59], a[208:211], v[92:95], v[56:59]
    v_mfma_f32_16x16x32_bf16 v[60:63], a[212:215], v[92:95], v[60:63]
    ds_read_b128 v[84:87], v5 offset:28672
    v_mfma_f32_16x16x32_bf16 v[52:55], a[212:215], v[88:91], v[52:55]
    v_mfma_f32_16x16x32_bf16 v[64:67], a[216:219], v[88:91], v[64:67]
    v_mfma_f32_16x16x32_bf16 v[72:75], a[216:219], v[92:95], v[72:75]
    v_mfma_f32_16x16x32_bf16 v[76:79], a[220:223], v[92:95], v[76:79]
    v_mfma_f32_16x16x32_bf16 v[68:71], a[220:223], v[88:91], v[68:71]
    s_waitcnt lgkmcnt(0)
    v_mfma_f32_16x16x32_bf16 v[48:51], a[224:227], v[80:83], v[48:51]
    ds_read_b128 v[88:91], v4 offset:30720
    v_mfma_f32_16x16x32_bf16 v[56:59], a[224:227], v[84:87], v[56:59]
    v_mfma_f32_16x16x32_bf16 v[60:63], a[228:231], v[84:87], v[60:63]
    ds_read_b128 v[92:95], v5 offset:30720
    v_mfma_f32_16x16x32_bf16 v[52:55], a[228:231], v[80:83], v[52:55]
    v_mfma_f32_16x16x32_bf16 v[64:67], a[232:235], v[80:83], v[64:67]
    v_mfma_f32_16x16x32_bf16 v[72:75], a[232:235], v[84:87], v[72:75]
    v_mfma_f32_16x16x32_bf16 v[76:79], a[236:239], v[84:87], v[76:79]
    v_mfma_f32_16x16x32_bf16 v[68:71], a[236:239], v[80:83], v[68:71]
    s_waitcnt lgkmcnt(0)
    v_mfma_f32_16x16x32_bf16 v[48:51], a[240:243], v[88:91], v[48:51]
    s_waitcnt vmcnt(0)
    ds_read_b128 v[80:83], v4 offset:32768
    v_cmp_ne_u32 vcc, 0, v96
    v_mfma_f32_16x16x32_bf16 v[56:59], a[240:243], v[92:95], v[56:59]
    v_mfma_f32_16x16x32_bf16 v[60:63], a[244:247], v[92:95], v[60:63]
    s_cbranch_vccnz L_spin80
L_back81:
    ds_read_b128 v[84:87], v5 offset:32768
    s_barrier
    v_mfma_f32_16x16x32_bf16 v[52:55], a[244:247], v[88:91], v[52:55]
    buffer_load_dwordx4 v1, s[16:19], s42 offen offset:0 sc1 lds
    v_mfma_f32_16x16x32_bf16 v[64:67], a[248:251], v[88:91], v[64:67]
    v_mfma_f32_16x16x32_bf16 v[72:75], a[248:251], v[92:95], v[72:75]
    v_mfma_f32_16x16x32_bf16 v[76:79], a[252:255], v[92:95], v[76:79]
    buffer_load_dwordx4 v1, s[16:19], s42 offen offset:1024 sc1 lds
    v_mfma_f32_16x16x32_bf16 v[68:71], a[252:255], v[88:91], v[68:71]
    s_waitcnt lgkmcnt(0)
    v_mfma_f32_16x16x32_bf16 v[48:51], v[128:131], v[80:83], v[48:51]
    ds_read_b128 v[88:91], v4 offset:34816
    v_mfma_f32_16x16x32_bf16 v[56:59], v[128:131], v[84:87], v[56:59]
    buffer_load_dwordx4 v1, s[16:19], s42 offen offset:2048 sc1 lds
    v_mfma_f32_16x16x32_bf16 v[60:63], v[132:135], v[84:87], v[60:63]
    ds_read_b128 v[92:95], v5 offset:34816
    v_mfma_f32_16x16x32_bf16 v[52:55], v[132:135], v[80:83], v[52:55]
    v_mfma_f32_16x16x32_bf16 v[64:67], v[136:139], v[80:83], v[64:67]
    buffer_store_dword v124, v124, s[16:19], s91 offen sc1
    v_mfma_f32_16x16x32_bf16 v[72:75], v[136:139], v[84:87], v[72:75]
    s_add_u32 s91, s91, 131072
    s_add_u32 m0, s43, 12288
    s_add_u32 s42, s41, 12288
    v_mfma_f32_16x16x32_bf16 v[76:79], v[140:143], v[84:87], v[76:79]
    v_mfma_f32_16x16x32_bf16 v[68:71], v[140:143], v[80:83], v[68:71]
    s_waitcnt lgkmcnt(0)
    v_mfma_f32_16x16x32_bf16 v[48:51], v[144:147], v[88:91], v[48:51]
    ds_read_b128 v[80:83], v4 offset:36864
    v_mfma_f32_16x16x32_bf16 v[56:59], v[144:147], v[92:95], v[56:59]
    v_mfma_f32_16x16x32_bf16 v[60:63], v[148:151], v[92:95], v[60:63]
    ds_read_b128 v[84:87], v5 offset:36864
    v_mfma_f32_16x16x32_bf16 v[52:55], v[148:151], v[88:91], v[52:55]
    buffer_load_dwordx4 v1, s[16:19], s42 offen offset:0 sc1 lds
    v_mfma_f32_16x16x32_bf16 v[64:67], v[152:155], v[88:91], v[64:67]
    v_mfma_f32_16x16x32_bf16 v[72:75], v[152:155], v[92:95], v[72:75]
    v_mfma_f32_16x16x32_bf16 v[76:79], v[156:159], v[92:95], v[76:79]
    v_mfma_f32_16x16x32_bf16 v[68:71], v[156:159], v[88:91], v[68:71]
    s_waitcnt lgkmcnt(0)
    v_mfma_f32_16x16x32_bf16 v[48:51], v[160:163], v[80:83], v[48:51]
    ds_read_b128 v[88:91], v4 offset:38912
    v_mfma_f32_16x16x32_bf16 v[56:59], v[160:163], v[84:87], v[56:59]
    buffer_load_dwordx4 v1, s[16:19], s42 offen offset:1024 sc1 lds
    v_mfma_f32_16x16x32_bf16 v[60:63], v[164:167], v[84:87], v[60:63]
    ds_read_b128 v[92:95], v5 offset:38912
    v_mfma_f32_16x16x32_bf16 v[52:55], v[164:167], v[80:83], v[52:55]
    v_mfma_f32_16x16x32_bf16 v[64:67], v[168:171], v[80:83], v[64:67]
    v_mfma_f32_16x16x32_bf16 v[72:75], v[168:171], v[84:87], v[72:75]
    v_mfma_f32_16x16x32_bf16 v[76:79], v[172:175], v[84:87], v[76:79]
    buffer_load_dwordx4 v1, s[16:19], s42 offen offset:2048 sc1 lds
    v_mfma_f32_16x16x32_bf16 v[68:71], v[172:175], v[80:83], v[68:71]
    s_waitcnt lgkmcnt(0)
    s_add_u32 m0, s43, 24576
    s_add_u32 s42, s41, 24576
    v_mfma_f32_16x16x32_bf16 v[48:51], v[176:179], v[88:91], v[48:51]
    ds_read_b128 v[80:83], v4 offset:40960
    v_mfma_f32_16x16x32_bf16 v[56:59], v[176:179], v[92:95], v[56:59]
    v_mfma_f32_16x16x32_bf16 v[60:63], v[180:183], v[92:95], v[60:63]
    ds_read_b128 v[84:87], v5 offset:40960
    v_mfma_f32_16x16x32_bf16 v[52:55], v[180:183], v[88:91], v[52:55]
    buffer_load_dwordx4 v1, s[16:19], s42 offen offset:0 sc1 lds
    v_mfma_f32_16x16x32_bf16 v[64:67], v[184:187], v[88:91], v[64:67]
    v_mfma_f32_16x16x32_bf16 v[72:75], v[184:187], v[92:95], v[72:75]
    v_mfma_f32_16x16x32_bf16 v[76:79], v[188:191], v[92:95], v[76:79]
    v_mfma_f32_16x16x32_bf16 v[68:71], v[188:191], v[88:91], v[68:71]
    s_waitcnt lgkmcnt(0)
    v_mfma_f32_16x16x32_bf16 v[48:51], v[192:195], v[80:83], v[48:51]
    ds_read_b128 v[88:91], v4 offset:43008
    v_mfma_f32_16x16x32_bf16 v[56:59], v[192:195], v[84:87], v[56:59]
    buffer_load_dwordx4 v1, s[16:19], s42 offen offset:1024 sc1 lds
    v_mfma_f32_16x16x32_bf16 v[60:63], v[196:199], v[84:87], v[60:63]
    ds_read_b128 v[92:95], v5 offset:43008
    v_mfma_f32_16x16x32_bf16 v[52:55], v[196:199], v[80:83], v[52:55]
    v_mfma_f32_16x16x32_bf16 v[64:67], v[200:203], v[80:83], v[64:67]
    v_mfma_f32_16x16x32_bf16 v[72:75], v[200:203], v[84:87], v[72:75]
    v_mfma_f32_16x16x32_bf16 v[76:79], v[204:207], v[84:87], v[76:79]
    buffer_load_dwordx4 v1, s[16:19], s42 offen offset:2048 sc1 lds
    v_mfma_f32_16x16x32_bf16 v[68:71], v[204:207], v[80:83], v[68:71]
    s_waitcnt lgkmcnt(0)
    s_add_u32 s45, s45, 131072
    v_mfma_f32_16x16x32_bf16 v[48:51], v[208:211], v[88:91], v[48:51]
    ds_read_b128 v[80:83], v4 offset:45056
    v_mfma_f32_16x16x32_bf16 v[56:59], v[208:211], v[92:95], v[56:59]
    v_mfma_f32_16x16x32_bf16 v[60:63], v[212:215], v[92:95], v[60:63]
    ds_read_b128 v[84:87], v5 offset:45056
    v_mfma_f32_16x16x32_bf16 v[52:55], v[212:215], v[88:91], v[52:55]
    v_mfma_f32_16x16x32_bf16 v[64:67], v[216:219], v[88:91], v[64:67]
    v_mfma_f32_16x16x32_bf16 v[72:75], v[216:219], v[92:95], v[72:75]
    v_mfma_f32_16x16x32_bf16 v[76:79], v[220:223], v[92:95], v[76:79]
    v_mfma_f32_16x16x32_bf16 v[68:71], v[220:223], v[88:91], v[68:71]
    s_waitcnt lgkmcnt(0)
    v_mfma_f32_16x16x32_bf16 v[48:51], v[224:227], v[80:83], v[48:51]
    ds_read_b128 v[88:91], v4 offset:47104
    v_mfma_f32_16x16x32_bf16 v[56:59], v[224:227], v[84:87], v[56:59]
    v_mfma_f32_16x16x32_bf16 v[60:63], v[228:231], v[84:87], v[60:63]
    ds_read_b128 v[92:95], v5 offset:47104
    v_mfma_f32_16x16x32_bf16 v[52:55], v[228:231], v[80:83], v[52:55]
    v_mfma_f32_16x16x32_bf16 v[64:67], v[232:235], v[80:83], v[64:67]
    v_mfma_f32_16x16x32_bf16 v[72:75], v[232:235], v[84:87], v[72:75]
    v_mfma_f32_16x16x32_bf16 v[76:79], v[236:239], v[84:87], v[76:79]
    v_mfma_f32_16x16x32_bf16 v[68:71], v[236:239], v[80:83], v[68:71]
    s_waitcnt vmcnt(7) lgkmcnt(0)
    s_barrier
    v_mfma_f32_16x16x32_bf16 v[48:51], v[240:243], v[88:91], v[48:51]
    ds_read_b128 v[80:83], v2 offset:0
    v_mfma_f32_16x16x32_bf16 v[56:59], v[240:243], v[92:95], v[56:59]
    v_mfma_f32_16x16x32_bf16 v[60:63], v[244:247], v[92:95], v[60:63]
    ds_read_b128 v[84:87], v3 offset:0
    v_mfma_f32_16x16x32_bf16 v[52:55], v[244:247], v[88:91], v[52:55]
    v_mfma_f32_16x16x32_bf16 v[64:67], v[248:251], v[88:91], v[64:67]
    v_mfma_f32_16x16x32_bf16 v[72:75], v[248:251], v[92:95], v[72:75]
    v_mfma_f32_16x16x32_bf16 v[76:79], v[252:255], v[92:95], v[76:79]
    v_mfma_f32_16x16x32_bf16 v[68:71], v[252:255], v[88:91], v[68:71]
    s_add_u32 s36, s36, 1
    s_cmp_lt_u32 s36, 32
    s_cbranch_scc1 L_bs_b0
    s_nop 7
    s_and_b32 s44, s90, 0xffffffff
    s_cmp_eq_u32 s36, 0
    s_cselect_b32 s44, 0x5e00000, s44
    s_xor_b32 s49, s44, 0
    v_cvt_pk_bf16_f32 v48, v48, v49
    v_cvt_pk_bf16_f32 v49, v50, v51
    v_cvt_pk_bf16_f32 v50, v52, v53
    v_cvt_pk_bf16_f32 v51, v54, v55
    buffer_store_dwordx4 v[48:51], v1, s[16:19], s49 offen offset:3072 sc1
    s_xor_b32 s49, s44, 16384
    v_cvt_pk_bf16_f32 v56, v56, v57
    v_cvt_pk_bf16_f32 v57, v58, v59
    v_cvt_pk_bf16_f32 v58, v60, v61
    v_cvt_pk_bf16_f32 v59, v62, v63
    buffer_store_dwordx4 v[56:59], v1, s[16:19], s49 offen offset:3072 sc1
    s_xor_b32 s49, s44, 32768
    v_cvt_pk_bf16_f32 v64, v64, v65
    v_cvt_pk_bf16_f32 v65, v66, v67
    v_cvt_pk_bf16_f32 v66, v68, v69
    v_cvt_pk_bf16_f32 v67, v70, v71
    buffer_store_dwordx4 v[64:67], v1, s[16:19], s49 offen offset:3072 sc1
    s_xor_b32 s49, s44, 49152
    v_cvt_pk_bf16_f32 v72, v72, v73
    v_cvt_pk_bf16_f32 v73, v74, v75
    v_cvt_pk_bf16_f32 v74, v76, v77
    v_cvt_pk_bf16_f32 v75, v78, v79
    buffer_store_dwordx4 v[72:75], v1, s[16:19], s49 offen offset:3072 sc1
    s_add_u32 s90, s90, 262144
    s_waitcnt vmcnt(0)
    s_barrier
    buffer_store_dword v124, v124, s[16:19], s91 offen sc1
    s_add_u32 s91, s91, 131072
    s_waitcnt vmcnt(0)
    s_endpgm
L_spin69:
    s_mov_b32 s40, 0x20000
L_spin69_l:
    buffer_load_dword v48, v124, s[20:23], 0 offen sc1
    s_sub_u32 s40, s40, 1
    s_waitcnt vmcnt(0)
    v_cmp_eq_u32 vcc, v124, v48
    s_cbranch_scc1 L_back70
    s_cbranch_vccz L_back70
    s_sleep 8
    s_branch L_spin69_l
L_spin71:
    s_mov_b32 s40, 0x20000
L_spin71_l:
    buffer_load_dword v49, v48, s[16:19], s38 offen sc1
    s_sub_u32 s40, s40, 1
    s_waitcnt vmcnt(0)
    v_cmp_ne_u32 vcc, 0, v49
    s_cbranch_scc1 L_back72
    s_cbranch_vccz L_back72
    s_sleep 8
    s_branch L_spin71_l
L_spin74:
    s_mov_b32 s40, 0x20000
L_spin74_l:
    buffer_load_dword v80, v124, s[20:23], 0 offen sc1
    s_sub_u32 s40, s40, 1
    s_waitcnt vmcnt(0)
    v_cmp_eq_u32 vcc, v124, v80
    s_cbranch_scc1 L_back75
    s_cbranch_vccz L_back75
    s_sleep 8
    s_branch L_spin74_l
L_spin76:
    s_mov_b32 s40, 0x20000
L_spin76_l:
    buffer_load_dword v96, v6, s[16:19], s45 offen sc1
    s_sub_u32 s40, s40, 1
    s_waitcnt vmcnt(0)
    v_cmp_ne_u32 vcc, 0, v96
    s_cbranch_scc1 L_back77
    s_cbranch_vccz L_back77
    s_sleep 2
    s_branch L_spin76_l
L_spin78:
    s_mov_b32 s40, 0x20000
L_spin78_l:
    buffer_load_dword v96, v6, s[16:19], s45 offen sc1
    s_sub_u32 s40, s40, 1
    s_waitcnt vmcnt(0)
    v_cmp_ne_u32 vcc, 0, v96
    s_cbranch_scc1 L_back79
    s_cbranch_vccz L_back79
    s_sleep 2
    s_branch L_spin78_l
L_spin80:
    s_mov_b32 s40, 0x20000
L_spin80_l:
    buffer_load_dword v96, v6, s[16:19], s45 offen sc1
    s_sub_u32 s40, s40, 1
    s_waitcnt vmcnt(0)
    v_cmp_ne_u32 vcc, 0, v96
    s_cbranch_scc1 L_back81
    s_cbranch_vccz L_back81
    s_sleep 2
    s_branch L_spin80_l
L_code_end:
    s_endpgm
.section .rodata,"a"
.p2align 6
.amdhsa_kernel interleave_layers__sliding_local_dilated__dense_activation_squared_relu__prompt_kernel
  .amdhsa_next_free_vgpr 512
  .amdhsa_next_free_sgpr 102
  .amdhsa_accum_offset 256
  .amdhsa_group_segment_fixed_size 0
  .amdhsa_kernarg_size 88
  .amdhsa_user_sgpr_count 2
  .amdhsa_user_sgpr_kernarg_segment_ptr 1
  .amdhsa_system_sgpr_workgroup_id_x 1
.end_amdhsa_kernel
```

```asm
; @launch grid=(256,1,1) block=(256,1,1) lds=163840
.amdgcn_target "amdgcn-amd-amdhsa--gfx950"
.text
.globl interleave_layers__sliding_local_dilated__dense_activation_squared_relu__prompt_kernel
.p2align 8
.type interleave_layers__sliding_local_dilated__dense_activation_squared_relu__prompt_kernel,@function
interleave_layers__sliding_local_dilated__dense_activation_squared_relu__prompt_kernel:
    s_load_dwordx16 s[64:79], s[0:1], 0x0
    s_load_dwordx4 s[80:83], s[0:1], 0x40
    s_load_dwordx2 s[84:85], s[0:1], 0x50
    v_lshrrev_b32 v1, 6, v0
    s_cmp_ge_u32 s2, 256
    s_cbranch_scc1 L_code_end
    s_getpc_b64 s[20:21]
L_pc:
    s_mov_b32 s22, L_code_end-L_pc
    s_mov_b32 s23, 0x00020000
    v_lshlrev_b32 v7, 12, v0
    s_lshl_b32 s37, s2, 4
    buffer_load_dword v252, v7, s[20:23], s37 offen
    v_readfirstlane_b32 s32, v1
    v_and_b32 v0, 63, v0
    v_lshlrev_b32 v1, 4, v0
    s_bfe_u32 s47, s2, 0x20001
    s_and_b32 s37, s2, 0x81
    s_cmp_lg_u32 s37, 0
    s_cbranch_scc1 L_other
    s_bfe_u32 s33, s2, 0x20003
    s_lshr_b32 s34, s2, 5
    s_lshl2_add_u32 s34, s47, s34
    s_mov_b32 s35, s34
    s_movk_i32 s39, 6144
    s_lshl_b32 s54, s35, 7
    v_lshrrev_b32 v32, 3, v0
    v_lshlrev_b32 v33, 2, v0
    v_and_b32 v33, 64, v33
    v_and_b32 v34, 0x70, v1
    v_xor_b32 v33, v33, v34
    v_mad_u32_u24 v20, v32, s39, v33
    v_add_u32 v21, 49152, v20
    v_add_u32 v22, 2048, v20
    v_add_u32 v23, 51200, v20
    v_add_u32 v24, 4096, v20
    v_add_u32 v25, 53248, v20
    s_mul_i32 s38, s32, 98304
    s_add_u32 s54, s54, s38
    s_lshl_b32 s42, s32, 11
    s_lshr_b32 s51, s32, 1
    s_lshl_b32 s50, s33, 5
    s_add_u32 s50, s50, 31
    s_sub_u32 s50, s50, s51
    s_lshl_b32 s41, s50, 15
    s_lshl_b32 s43, s32, 10
    v_lshlrev_b32 v37, 1, v0
    v_and_b32 v37, 0x60, v37
    v_xor_b32 v37, v37, v34
    s_and_b32 s37, s32, 1
    s_lshl_b32 s37, s37, 14
    v_lshl_add_u32 v6, v32, 11, v37
    v_add_u32 v6, s37, v6
    s_waitcnt lgkmcnt(0)
    s_mov_b32 s12, s66
    s_mov_b32 s13, s67
    s_mov_b32 s14, 0x600000
    s_mov_b32 s15, 0x00020000
    s_mov_b32 s8, s64
    s_mov_b32 s9, s65
    s_mov_b32 s10, 0x400000
    s_mov_b32 s11, 0x00020000
    s_add_u32 m0, s43, 98304
    s_nop 0
    buffer_load_dwordx4 v6, s[8:11], s41 offen offset:0 sc1 lds
    s_add_u32 m0, s42, 73728
    s_nop 0
    buffer_load_dwordx4 v20, s[12:15], s54 offen lds
    s_add_u32 m0, s42, 74752
    s_nop 0
    buffer_load_dwordx4 v21, s[12:15], s54 offen lds
    s_add_u32 m0, s42, 81920
    s_nop 0
    buffer_load_dwordx4 v22, s[12:15], s54 offen lds
    s_add_u32 m0, s42, 82944
    s_nop 0
    buffer_load_dwordx4 v23, s[12:15], s54 offen lds
    s_add_u32 m0, s42, 90112
    s_nop 0
    buffer_load_dwordx4 v24, s[12:15], s54 offen lds
    s_add_u32 m0, s42, 91136
    s_nop 0
    buffer_load_dwordx4 v25, s[12:15], s54 offen lds
    s_add_u32 s54, s54, 393216
    v_lshrrev_b32 v32, 4, v0
    v_bfe_u32 v33, v0, 2, 2
    v_lshl_add_u32 v32, v32, 3, v33
    v_lshlrev_b32 v32, 7, v32
    v_lshrrev_b32 v33, 1, v33
    v_lshl_add_u32 v32, v33, 6, v32
    v_and_b32 v33, 3, v0
    v_lshl_add_u32 v32, v33, 4, v32
    s_lshl_b32 s37, s51, 6
    s_and_b32 s38, s32, 1
    s_lshl_b32 s38, s38, 3
    s_add_u32 s37, s37, s38
    s_add_u32 s37, s37, 0
    v_xor_b32 v26, s37, v32
    s_lshl_b32 s37, s51, 6
    s_and_b32 s38, s32, 1
    s_lshl_b32 s38, s38, 3
    s_add_u32 s37, s37, s38
    s_add_u32 s37, s37, 8192
    v_xor_b32 v27, s37, v32
    s_lshl_b32 s37, s51, 6
    s_and_b32 s38, s32, 1
    s_lshl_b32 s38, s38, 3
    s_add_u32 s37, s37, s38
    s_add_u32 s37, s37, 16384
    v_xor_b32 v28, s37, v32
    v_mov_b32 v32, 0x3f803f80
    v_mov_b32 v33, 0x3f803f80
    v_mov_b32 v34, 0x3f803f80
    v_mov_b32 v35, 0x3f803f80
    v_and_b32 v36, 15, v0
    v_lshrrev_b32 v37, 4, v0
    v_and_b32 v38, 6, v36
    v_xor_b32 v38, v37, v38
    v_lshlrev_b32 v38, 4, v38
    v_lshl_add_u32 v2, v36, 7, v38
    v_xor_b32 v3, 64, v2
    v_add_u32 v4, 98304, v2
    v_add_u32 v5, 98304, v3
    s_add_u32 m0, s43, 102272
    s_nop 0
    buffer_load_dwordx4 v6, s[8:11], s41 offen offset:128 sc1 lds
    s_add_u32 m0, s42, 0
    s_nop 0
    buffer_load_dwordx4 v20, s[12:15], s54 offen lds
    s_add_u32 m0, s42, 1024
    s_nop 0
    buffer_load_dwordx4 v21, s[12:15], s54 offen lds
    s_add_u32 m0, s42, 8192
    s_nop 0
    buffer_load_dwordx4 v22, s[12:15], s54 offen lds
    s_add_u32 m0, s42, 9216
    s_nop 0
    buffer_load_dwordx4 v23, s[12:15], s54 offen lds
    s_add_u32 m0, s42, 16384
    s_nop 0
    buffer_load_dwordx4 v24, s[12:15], s54 offen lds
    s_add_u32 m0, s42, 17408
    s_nop 0
    buffer_load_dwordx4 v25, s[12:15], s54 offen lds
    s_add_u32 s54, s54, 393216
    s_add_u32 m0, s43, 106240
    s_nop 0
    buffer_load_dwordx4 v6, s[8:11], s41 offen offset:256 sc1 lds
    s_add_u32 m0, s42, 24576
    s_nop 0
    buffer_load_dwordx4 v20, s[12:15], s54 offen lds
    s_add_u32 m0, s42, 25600
    s_nop 0
    buffer_load_dwordx4 v21, s[12:15], s54 offen lds
    s_add_u32 m0, s42, 32768
    s_nop 0
    buffer_load_dwordx4 v22, s[12:15], s54 offen lds
    s_add_u32 m0, s42, 33792
    s_nop 0
    buffer_load_dwordx4 v23, s[12:15], s54 offen lds
    s_add_u32 m0, s42, 40960
    s_nop 0
    buffer_load_dwordx4 v24, s[12:15], s54 offen lds
    s_add_u32 m0, s42, 41984
    s_nop 0
    buffer_load_dwordx4 v25, s[12:15], s54 offen lds
    s_add_u32 s54, s54, 393216
    s_mov_b32 s36, -1
    v_add_u32 v29, 73728, v26
    v_add_u32 v30, 73728, v27
    v_add_u32 v31, 73728, v28
    s_waitcnt vmcnt(14) lgkmcnt(0)
    s_barrier
    s_add_u32 m0, s43, 110208
    ds_read_b128 v[68:71], v4 offset:0
    buffer_load_dwordx4 v6, s[8:11], s41 offen offset:384 sc1 lds
    ds_read_b128 v[72:75], v4 offset:2048
    s_add_u32 m0, s42, 49152
    ds_read_b128 v[76:79], v5 offset:0
    buffer_load_dwordx4 v20, s[12:15], s54 offen lds
    ds_read_b128 v[80:83], v5 offset:2048
    s_add_u32 m0, s42, 50176
    ds_read_b64_tr_b16 a[0:1], v29 offset:0
    buffer_load_dwordx4 v21, s[12:15], s54 offen lds
    ds_read_b64_tr_b16 a[2:3], v29 offset:512
    s_add_u32 m0, s42, 57344
    ds_read_b64_tr_b16 a[4:5], v30 offset:0
    buffer_load_dwordx4 v22, s[12:15], s54 offen lds
    ds_read_b64_tr_b16 a[6:7], v30 offset:512
    s_add_u32 m0, s42, 58368
    ds_read_b64_tr_b16 a[8:9], v31 offset:0
    buffer_load_dwordx4 v23, s[12:15], s54 offen lds
    ds_read_b64_tr_b16 a[10:11], v31 offset:512
    s_add_u32 m0, s42, 65536
    ds_read_b64_tr_b16 a[12:13], v29 offset:4096
    buffer_load_dwordx4 v24, s[12:15], s54 offen lds
    ds_read_b64_tr_b16 a[14:15], v29 offset:4608
    s_add_u32 m0, s42, 66560
    ds_read_b64_tr_b16 a[16:17], v30 offset:4096
    buffer_load_dwordx4 v25, s[12:15], s54 offen lds
    ds_read_b64_tr_b16 a[18:19], v30 offset:4608
    s_add_u32 s54, s54, 393216
    ds_read_b64_tr_b16 a[20:21], v31 offset:4096
    ds_read_b64_tr_b16 a[22:23], v31 offset:4608
    s_mov_b32 s16, s84
    s_mov_b32 s17, s85
    s_mov_b32 s18, 0x5e00000
    s_mov_b32 s19, 0x00020000
    v_min_u32 v124, 1, v0
    v_lshlrev_b32 v124, 30, v124
    s_lshl_b32 s91, s33, 6
    s_add_u32 s91, s91, s34
    s_lshl_b32 s91, s91, 7
    s_add_u32 s91, s91, 0x5520000
    s_cmp_eq_u32 s32, 1
    s_cselect_b32 s91, s91, 0x5f00000
    v_add_u32 v29, 0, v26
    v_add_u32 v30, 0, v27
    v_add_u32 v31, 0, v28
    s_waitcnt vmcnt(14) lgkmcnt(0)
    s_barrier
    v_mfma_f32_16x16x32_bf16 v[44:47], a[0:3], v[68:71], 0
    s_add_u32 m0, s43, 114176
    ds_read_b128 v[84:87], v4 offset:4096
    v_mfma_f32_16x16x32_bf16 v[48:51], a[0:3], v[72:75], 0
    buffer_load_dwordx4 v6, s[8:11], s41 offen offset:512 sc1 lds
    ds_read_b128 v[88:91], v4 offset:6144
    v_mfma_f32_16x16x32_bf16 v[56:59], a[4:7], v[72:75], 0
    s_add_u32 m0, s42, 73728
    ds_read_b128 v[92:95], v5 offset:4096
    v_mfma_f32_16x16x32_bf16 v[52:55], a[4:7], v[68:71], 0
    buffer_load_dwordx4 v20, s[12:15], s54 offen lds
    ds_read_b128 v[96:99], v5 offset:6144
    v_mfma_f32_16x16x32_bf16 v[60:63], a[8:11], v[68:71], 0
    s_add_u32 m0, s42, 74752
    ds_read_b64_tr_b16 a[24:25], v29 offset:0
    v_mfma_f32_16x16x32_bf16 v[64:67], a[8:11], v[72:75], 0
    buffer_load_dwordx4 v21, s[12:15], s54 offen lds
    ds_read_b64_tr_b16 a[26:27], v29 offset:512
    v_mfma_f32_16x16x32_bf16 v[44:47], a[12:15], v[76:79], v[44:47]
    s_add_u32 m0, s42, 81920
    ds_read_b64_tr_b16 a[28:29], v30 offset:0
    v_mfma_f32_16x16x32_bf16 v[48:51], a[12:15], v[80:83], v[48:51]
    buffer_load_dwordx4 v22, s[12:15], s54 offen lds
    ds_read_b64_tr_b16 a[30:31], v30 offset:512
    v_mfma_f32_16x16x32_bf16 v[56:59], a[16:19], v[80:83], v[56:59]
    s_add_u32 m0, s42, 82944
    ds_read_b64_tr_b16 a[32:33], v31 offset:0
    v_mfma_f32_16x16x32_bf16 v[52:55], a[16:19], v[76:79], v[52:55]
    buffer_load_dwordx4 v23, s[12:15], s54 offen lds
    ds_read_b64_tr_b16 a[34:35], v31 offset:512
    v_mfma_f32_16x16x32_bf16 v[60:63], a[20:23], v[76:79], v[60:63]
    s_add_u32 m0, s42, 90112
    ds_read_b64_tr_b16 a[36:37], v29 offset:4096
    v_mfma_f32_16x16x32_bf16 v[64:67], a[20:23], v[80:83], v[64:67]
    buffer_load_dwordx4 v24, s[12:15], s54 offen lds
    ds_read_b64_tr_b16 a[38:39], v29 offset:4608
    v_mfma_f32_16x16x32_bf16 v[100:103], a[0:3], v[32:35], 0
    s_add_u32 m0, s42, 91136
    ds_read_b64_tr_b16 a[40:41], v30 offset:4096
    v_mfma_f32_16x16x32_bf16 v[104:107], a[4:7], v[32:35], 0
    buffer_load_dwordx4 v25, s[12:15], s54 offen lds
    ds_read_b64_tr_b16 a[42:43], v30 offset:4608
    v_mfma_f32_16x16x32_bf16 v[108:111], a[8:11], v[32:35], 0
    s_add_u32 s54, s54, 393216
    ds_read_b64_tr_b16 a[44:45], v31 offset:4096
    v_mfma_f32_16x16x32_bf16 v[100:103], a[12:15], v[32:35], v[100:103]
    ds_read_b64_tr_b16 a[46:47], v31 offset:4608
    v_mfma_f32_16x16x32_bf16 v[104:107], a[16:19], v[32:35], v[104:107]
    v_mfma_f32_16x16x32_bf16 v[108:111], a[20:23], v[32:35], v[108:111]
    s_add_u32 s88, s84, 0x5000000
    s_addc_u32 s89, s85, 0
    s_sub_u32 s97, 15, s51
    s_and_b32 s38, s32, 1
    v_lshlrev_b32 v40, 1, v0
    v_and_b32 v40, 0x30, v40
    v_xor_b32 v40, v40, v1
    s_mul_i32 s37, s51, 3072
    s_add_u32 s37, s37, 65536
    s_lshl_b32 s39, s38, 3
    s_add_u32 s39, s39, s37
    v_add_u32 v29, 24576, v26
    v_add_u32 v30, 24576, v27
    v_add_u32 v31, 24576, v28
    s_waitcnt vmcnt(14) lgkmcnt(0)
    s_barrier
    v_mfma_f32_16x16x32_bf16 v[44:47], a[24:27], v[84:87], v[44:47]
    s_add_u32 m0, s43, 118144
    ds_read_b128 v[68:71], v4 offset:8192
    v_mfma_f32_16x16x32_bf16 v[48:51], a[24:27], v[88:91], v[48:51]
    buffer_load_dwordx4 v6, s[8:11], s41 offen offset:640 sc1 lds
    ds_read_b128 v[72:75], v4 offset:10240
    v_mfma_f32_16x16x32_bf16 v[56:59], a[28:31], v[88:91], v[56:59]
    s_add_u32 m0, s42, 0
    ds_read_b128 v[76:79], v5 offset:8192
    v_mfma_f32_16x16x32_bf16 v[52:55], a[28:31], v[84:87], v[52:55]
    buffer_load_dwordx4 v20, s[12:15], s54 offen lds
    ds_read_b128 v[80:83], v5 offset:10240
    v_mfma_f32_16x16x32_bf16 v[60:63], a[32:35], v[84:87], v[60:63]
    s_add_u32 m0, s42, 1024
    ds_read_b64_tr_b16 a[48:49], v29 offset:0
    v_mfma_f32_16x16x32_bf16 v[64:67], a[32:35], v[88:91], v[64:67]
    buffer_load_dwordx4 v21, s[12:15], s54 offen lds
    ds_read_b64_tr_b16 a[50:51], v29 offset:512
    v_mfma_f32_16x16x32_bf16 v[44:47], a[36:39], v[92:95], v[44:47]
    s_add_u32 m0, s42, 8192
    ds_read_b64_tr_b16 a[52:53], v30 offset:0
    v_mfma_f32_16x16x32_bf16 v[48:51], a[36:39], v[96:99], v[48:51]
    buffer_load_dwordx4 v22, s[12:15], s54 offen lds
    ds_read_b64_tr_b16 a[54:55], v30 offset:512
    v_mfma_f32_16x16x32_bf16 v[56:59], a[40:43], v[96:99], v[56:59]
    s_add_u32 m0, s42, 9216
    ds_read_b64_tr_b16 a[56:57], v31 offset:0
    v_mfma_f32_16x16x32_bf16 v[52:55], a[40:43], v[92:95], v[52:55]
    buffer_load_dwordx4 v23, s[12:15], s54 offen lds
    ds_read_b64_tr_b16 a[58:59], v31 offset:512
    v_mfma_f32_16x16x32_bf16 v[60:63], a[44:47], v[92:95], v[60:63]
    s_add_u32 m0, s42, 16384
    ds_read_b64_tr_b16 a[60:61], v29 offset:4096
    v_mfma_f32_16x16x32_bf16 v[64:67], a[44:47], v[96:99], v[64:67]
    buffer_load_dwordx4 v24, s[12:15], s54 offen lds
    ds_read_b64_tr_b16 a[62:63], v29 offset:4608
    v_mfma_f32_16x16x32_bf16 v[100:103], a[24:27], v[32:35], v[100:103]
    s_add_u32 m0, s42, 17408
    ds_read_b64_tr_b16 a[64:65], v30 offset:4096
    v_mfma_f32_16x16x32_bf16 v[104:107], a[28:31], v[32:35], v[104:107]
    buffer_load_dwordx4 v25, s[12:15], s54 offen lds
    ds_read_b64_tr_b16 a[66:67], v30 offset:4608
    v_mfma_f32_16x16x32_bf16 v[108:111], a[32:35], v[32:35], v[108:111]
    s_add_u32 s54, s54, 393216
    ds_read_b64_tr_b16 a[68:69], v31 offset:4096
    v_mfma_f32_16x16x32_bf16 v[100:103], a[36:39], v[32:35], v[100:103]
    ds_read_b64_tr_b16 a[70:71], v31 offset:4608
    v_mfma_f32_16x16x32_bf16 v[104:107], a[40:43], v[32:35], v[104:107]
    v_mfma_f32_16x16x32_bf16 v[108:111], a[44:47], v[32:35], v[108:111]
    v_add_u32 v7, s39, v40
    v_bfe_u32 v38, v0, 1, 2
    v_xor_b32 v38, v38, v37
    v_lshlrev_b32 v38, 4, v38
    v_lshl_add_u32 v38, v36, 6, v38
    v_add_u32 v8, s39, v38
    s_mul_i32 s39, s38, 6144
    s_add_u32 s39, s39, s37
    v_add_u32 v9, s39, v40
    s_cmp_eq_u32 s38, 0
    s_cselect_b32 s39, 18432, 0
    v_add_u32 v29, 49152, v26
    v_add_u32 v30, 49152, v27
    v_add_u32 v31, 49152, v28
    s_waitcnt vmcnt(14) lgkmcnt(0)
    s_barrier
    v_mfma_f32_16x16x32_bf16 v[44:47], a[48:51], v[68:71], v[44:47]
    s_add_u32 m0, s43, 122112
    ds_read_b128 v[84:87], v4 offset:12288
    v_mfma_f32_16x16x32_bf16 v[48:51], a[48:51], v[72:75], v[48:51]
    buffer_load_dwordx4 v6, s[8:11], s41 offen offset:768 sc1 lds
    ds_read_b128 v[88:91], v4 offset:14336
    v_mfma_f32_16x16x32_bf16 v[56:59], a[52:55], v[72:75], v[56:59]
    s_add_u32 m0, s42, 24576
    ds_read_b128 v[92:95], v5 offset:12288
    v_mfma_f32_16x16x32_bf16 v[52:55], a[52:55], v[68:71], v[52:55]
    buffer_load_dwordx4 v20, s[12:15], s54 offen lds
    ds_read_b128 v[96:99], v5 offset:14336
    v_mfma_f32_16x16x32_bf16 v[60:63], a[56:59], v[68:71], v[60:63]
    s_add_u32 m0, s42, 25600
    ds_read_b64_tr_b16 a[72:73], v29 offset:0
    v_mfma_f32_16x16x32_bf16 v[64:67], a[56:59], v[72:75], v[64:67]
    buffer_load_dwordx4 v21, s[12:15], s54 offen lds
    ds_read_b64_tr_b16 a[74:75], v29 offset:512
    v_mfma_f32_16x16x32_bf16 v[44:47], a[60:63], v[76:79], v[44:47]
    s_add_u32 m0, s42, 32768
    ds_read_b64_tr_b16 a[76:77], v30 offset:0
    v_mfma_f32_16x16x32_bf16 v[48:51], a[60:63], v[80:83], v[48:51]
    buffer_load_dwordx4 v22, s[12:15], s54 offen lds
    ds_read_b64_tr_b16 a[78:79], v30 offset:512
    v_mfma_f32_16x16x32_bf16 v[56:59], a[64:67], v[80:83], v[56:59]
    s_add_u32 m0, s42, 33792
    ds_read_b64_tr_b16 a[80:81], v31 offset:0
    v_mfma_f32_16x16x32_bf16 v[52:55], a[64:67], v[76:79], v[52:55]
    buffer_load_dwordx4 v23, s[12:15], s54 offen lds
    ds_read_b64_tr_b16 a[82:83], v31 offset:512
    v_mfma_f32_16x16x32_bf16 v[60:63], a[68:71], v[76:79], v[60:63]
    s_add_u32 m0, s42, 40960
    ds_read_b64_tr_b16 a[84:85], v29 offset:4096
    v_mfma_f32_16x16x32_bf16 v[64:67], a[68:71], v[80:83], v[64:67]
    buffer_load_dwordx4 v24, s[12:15], s54 offen lds
    ds_read_b64_tr_b16 a[86:87], v29 offset:4608
    v_mfma_f32_16x16x32_bf16 v[100:103], a[48:51], v[32:35], v[100:103]
    s_add_u32 m0, s42, 41984
    ds_read_b64_tr_b16 a[88:89], v30 offset:4096
    v_mfma_f32_16x16x32_bf16 v[104:107], a[52:55], v[32:35], v[104:107]
    buffer_load_dwordx4 v25, s[12:15], s54 offen lds
    ds_read_b64_tr_b16 a[90:91], v30 offset:4608
    v_mfma_f32_16x16x32_bf16 v[108:111], a[56:59], v[32:35], v[108:111]
    s_add_u32 s54, s54, 393216
    ds_read_b64_tr_b16 a[92:93], v31 offset:4096
    v_mfma_f32_16x16x32_bf16 v[100:103], a[60:63], v[32:35], v[100:103]
    ds_read_b64_tr_b16 a[94:95], v31 offset:4608
    v_mfma_f32_16x16x32_bf16 v[104:107], a[64:67], v[32:35], v[104:107]
    v_mfma_f32_16x16x32_bf16 v[108:111], a[68:71], v[32:35], v[108:111]
    s_add_u32 s39, s39, s37
    v_add_u32 v10, s39, v40
    s_sub_u32 s39, s33, 1
    s_max_i32 s39, s39, 0
    v_mov_b32 v38, s33
    v_mov_b32 v39, s39
    v_mov_b32 v12, 1048576
    v_mov_b32 v41, 131072
    v_cmp_lt_u32 vcc, 15, v0
    s_nop 1
    v_cndmask_b32 v38, v38, v39, vcc
    v_cndmask_b32 v12, v12, v41, vcc
    v_add_u32 v29, 73728, v26
    v_add_u32 v30, 73728, v27
    v_add_u32 v31, 73728, v28
    s_waitcnt vmcnt(14) lgkmcnt(0)
    s_barrier
    v_mfma_f32_16x16x32_bf16 v[44:47], a[72:75], v[84:87], v[44:47]
    s_add_u32 m0, s43, 126080
    ds_read_b128 v[68:71], v4 offset:16384
    v_mfma_f32_16x16x32_bf16 v[48:51], a[72:75], v[88:91], v[48:51]
    buffer_load_dwordx4 v6, s[8:11], s41 offen offset:896 sc1 lds
    ds_read_b128 v[72:75], v4 offset:18432
    v_mfma_f32_16x16x32_bf16 v[56:59], a[76:79], v[88:91], v[56:59]
    s_add_u32 m0, s42, 49152
    ds_read_b128 v[76:79], v5 offset:16384
    v_mfma_f32_16x16x32_bf16 v[52:55], a[76:79], v[84:87], v[52:55]
    buffer_load_dwordx4 v20, s[12:15], s54 offen lds
    ds_read_b128 v[80:83], v5 offset:18432
    v_mfma_f32_16x16x32_bf16 v[60:63], a[80:83], v[84:87], v[60:63]
    s_add_u32 m0, s42, 50176
    ds_read_b64_tr_b16 a[96:97], v29 offset:0
    v_mfma_f32_16x16x32_bf16 v[64:67], a[80:83], v[88:91], v[64:67]
    buffer_load_dwordx4 v21, s[12:15], s54 offen lds
    ds_read_b64_tr_b16 a[98:99], v29 offset:512
    v_mfma_f32_16x16x32_bf16 v[44:47], a[84:87], v[92:95], v[44:47]
    s_add_u32 m0, s42, 57344
    ds_read_b64_tr_b16 a[100:101], v30 offset:0
    v_mfma_f32_16x16x32_bf16 v[48:51], a[84:87], v[96:99], v[48:51]
    buffer_load_dwordx4 v22, s[12:15], s54 offen lds
    ds_read_b64_tr_b16 a[102:103], v30 offset:512
    v_mfma_f32_16x16x32_bf16 v[56:59], a[88:91], v[96:99], v[56:59]
    s_add_u32 m0, s42, 58368
    ds_read_b64_tr_b16 a[104:105], v31 offset:0
    v_mfma_f32_16x16x32_bf16 v[52:55], a[88:91], v[92:95], v[52:55]
    buffer_load_dwordx4 v23, s[12:15], s54 offen lds
    ds_read_b64_tr_b16 a[106:107], v31 offset:512
    v_mfma_f32_16x16x32_bf16 v[60:63], a[92:95], v[92:95], v[60:63]
    s_add_u32 m0, s42, 65536
    ds_read_b64_tr_b16 a[108:109], v29 offset:4096
    v_mfma_f32_16x16x32_bf16 v[64:67], a[92:95], v[96:99], v[64:67]
    buffer_load_dwordx4 v24, s[12:15], s54 offen lds
    ds_read_b64_tr_b16 a[110:111], v29 offset:4608
    v_mfma_f32_16x16x32_bf16 v[100:103], a[72:75], v[32:35], v[100:103]
    s_add_u32 m0, s42, 66560
    ds_read_b64_tr_b16 a[112:113], v30 offset:4096
    v_mfma_f32_16x16x32_bf16 v[104:107], a[76:79], v[32:35], v[104:107]
    buffer_load_dwordx4 v25, s[12:15], s54 offen lds
    ds_read_b64_tr_b16 a[114:115], v30 offset:4608
    v_mfma_f32_16x16x32_bf16 v[108:111], a[80:83], v[32:35], v[108:111]
    s_add_u32 s54, s54, 393216
    ds_read_b64_tr_b16 a[116:117], v31 offset:4096
    v_mfma_f32_16x16x32_bf16 v[100:103], a[84:87], v[32:35], v[100:103]
    ds_read_b64_tr_b16 a[118:119], v31 offset:4608
    v_mfma_f32_16x16x32_bf16 v[104:107], a[88:91], v[32:35], v[104:107]
    v_mfma_f32_16x16x32_bf16 v[108:111], a[92:95], v[32:35], v[108:111]
    v_lshl_add_u32 v38, v38, 6, v36
    v_add_u32 v38, 697644, v38
    v_lshlrev_b32 v11, 7, v38
    s_cmp_eq_u32 s32, 0
    s_cselect_b32 s37, 32, 0
    v_cmp_le_u32 vcc, s37, v0
    s_nop 1
    v_cndmask_b32 v11, v11, 2.0, vcc
    v_mov_b32 v116, 0
    v_mov_b32 v117, v11
    s_mov_b32 s45, -786432
    v_and_b32 v13, 15, v0
    v_add_u32 v29, 0, v26
    v_add_u32 v30, 0, v27
    v_add_u32 v31, 0, v28
    s_waitcnt vmcnt(14) lgkmcnt(0)
    s_barrier
    v_mfma_f32_16x16x32_bf16 v[44:47], a[96:99], v[68:71], v[44:47]
    s_add_u32 m0, s43, 130048
    ds_read_b128 v[84:87], v4 offset:20480
    v_mfma_f32_16x16x32_bf16 v[48:51], a[96:99], v[72:75], v[48:51]
    buffer_load_dwordx4 v6, s[8:11], s41 offen offset:1024 sc1 lds
    ds_read_b128 v[88:91], v4 offset:22528
    v_mfma_f32_16x16x32_bf16 v[56:59], a[100:103], v[72:75], v[56:59]
    s_add_u32 m0, s42, 73728
    ds_read_b128 v[92:95], v5 offset:20480
    v_mfma_f32_16x16x32_bf16 v[52:55], a[100:103], v[68:71], v[52:55]
    buffer_load_dwordx4 v20, s[12:15], s54 offen lds
    ds_read_b128 v[96:99], v5 offset:22528
    v_mfma_f32_16x16x32_bf16 v[60:63], a[104:107], v[68:71], v[60:63]
    s_add_u32 m0, s42, 74752
    ds_read_b64_tr_b16 a[120:121], v29 offset:0
    v_mfma_f32_16x16x32_bf16 v[64:67], a[104:107], v[72:75], v[64:67]
    buffer_load_dwordx4 v21, s[12:15], s54 offen lds
    ds_read_b64_tr_b16 a[122:123], v29 offset:512
    v_mfma_f32_16x16x32_bf16 v[44:47], a[108:111], v[76:79], v[44:47]
    s_add_u32 m0, s42, 81920
    ds_read_b64_tr_b16 a[124:125], v30 offset:0
    v_mfma_f32_16x16x32_bf16 v[48:51], a[108:111], v[80:83], v[48:51]
    buffer_load_dwordx4 v22, s[12:15], s54 offen lds
    ds_read_b64_tr_b16 a[126:127], v30 offset:512
    v_mfma_f32_16x16x32_bf16 v[56:59], a[112:115], v[80:83], v[56:59]
    s_add_u32 m0, s42, 82944
    ds_read_b64_tr_b16 a[128:129], v31 offset:0
    v_mfma_f32_16x16x32_bf16 v[52:55], a[112:115], v[76:79], v[52:55]
    buffer_load_dwordx4 v23, s[12:15], s54 offen lds
    ds_read_b64_tr_b16 a[130:131], v31 offset:512
    v_mfma_f32_16x16x32_bf16 v[60:63], a[116:119], v[76:79], v[60:63]
    s_add_u32 m0, s42, 90112
    ds_read_b64_tr_b16 a[132:133], v29 offset:4096
    v_mfma_f32_16x16x32_bf16 v[64:67], a[116:119], v[80:83], v[64:67]
    buffer_load_dwordx4 v24, s[12:15], s54 offen lds
    ds_read_b64_tr_b16 a[134:135], v29 offset:4608
    v_mfma_f32_16x16x32_bf16 v[100:103], a[96:99], v[32:35], v[100:103]
    s_add_u32 m0, s42, 91136
    ds_read_b64_tr_b16 a[136:137], v30 offset:4096
    v_mfma_f32_16x16x32_bf16 v[104:107], a[100:103], v[32:35], v[104:107]
    buffer_load_dwordx4 v25, s[12:15], s54 offen lds
    ds_read_b64_tr_b16 a[138:139], v30 offset:4608
    v_mfma_f32_16x16x32_bf16 v[108:111], a[104:107], v[32:35], v[108:111]
    s_add_u32 s54, s54, 393216
    ds_read_b64_tr_b16 a[140:141], v31 offset:4096
    v_mfma_f32_16x16x32_bf16 v[100:103], a[108:111], v[32:35], v[100:103]
    ds_read_b64_tr_b16 a[142:143], v31 offset:4608
    v_mfma_f32_16x16x32_bf16 v[104:107], a[112:115], v[32:35], v[104:107]
    v_mfma_f32_16x16x32_bf16 v[108:111], a[116:119], v[32:35], v[108:111]
    v_lshlrev_b32 v13, 3, v13
    v_lshrrev_b32 v38, 5, v0
    v_lshl_add_u32 v13, v38, 9, v13
    v_and_b32 v38, 16, v0
    v_lshl_add_u32 v13, v38, 6, v13
    v_add_u32 v13, 90112, v13
    s_lshl_b32 s52, s51, 10
    s_mov_b32 s55, 0x541fc00
    s_lshl_b32 s46, s50, 10
    s_sub_u32 s46, s55, s46
    s_mov_b32 s56, 0xaaaaaaaa
    v_add_u32 v29, 24576, v26
    v_add_u32 v30, 24576, v27
    v_add_u32 v31, 24576, v28
    s_waitcnt vmcnt(14) lgkmcnt(0)
    s_barrier
    v_mfma_f32_16x16x32_bf16 v[44:47], a[120:123], v[84:87], v[44:47]
    s_add_u32 m0, s43, 134016
    ds_read_b128 v[68:71], v4 offset:24576
    v_mfma_f32_16x16x32_bf16 v[48:51], a[120:123], v[88:91], v[48:51]
    buffer_load_dwordx4 v6, s[8:11], s41 offen offset:1152 sc1 lds
    ds_read_b128 v[72:75], v4 offset:26624
    v_mfma_f32_16x16x32_bf16 v[56:59], a[124:127], v[88:91], v[56:59]
    s_add_u32 m0, s42, 0
    ds_read_b128 v[76:79], v5 offset:24576
    v_mfma_f32_16x16x32_bf16 v[52:55], a[124:127], v[84:87], v[52:55]
    buffer_load_dwordx4 v20, s[12:15], s54 offen lds
    ds_read_b128 v[80:83], v5 offset:26624
    v_mfma_f32_16x16x32_bf16 v[60:63], a[128:131], v[84:87], v[60:63]
    s_add_u32 m0, s42, 1024
    ds_read_b64_tr_b16 a[144:145], v29 offset:0
    v_mfma_f32_16x16x32_bf16 v[64:67], a[128:131], v[88:91], v[64:67]
    buffer_load_dwordx4 v21, s[12:15], s54 offen lds
    ds_read_b64_tr_b16 a[146:147], v29 offset:512
    v_mfma_f32_16x16x32_bf16 v[44:47], a[132:135], v[92:95], v[44:47]
    s_add_u32 m0, s42, 8192
    ds_read_b64_tr_b16 a[148:149], v30 offset:0
    v_mfma_f32_16x16x32_bf16 v[48:51], a[132:135], v[96:99], v[48:51]
    buffer_load_dwordx4 v22, s[12:15], s54 offen lds
    ds_read_b64_tr_b16 a[150:151], v30 offset:512
    v_mfma_f32_16x16x32_bf16 v[56:59], a[136:139], v[96:99], v[56:59]
    s_add_u32 m0, s42, 9216
    ds_read_b64_tr_b16 a[152:153], v31 offset:0
    v_mfma_f32_16x16x32_bf16 v[52:55], a[136:139], v[92:95], v[52:55]
    buffer_load_dwordx4 v23, s[12:15], s54 offen lds
    ds_read_b64_tr_b16 a[154:155], v31 offset:512
    v_mfma_f32_16x16x32_bf16 v[60:63], a[140:143], v[92:95], v[60:63]
    s_add_u32 m0, s42, 16384
    ds_read_b64_tr_b16 a[156:157], v29 offset:4096
    v_mfma_f32_16x16x32_bf16 v[64:67], a[140:143], v[96:99], v[64:67]
    buffer_load_dwordx4 v24, s[12:15], s54 offen lds
    ds_read_b64_tr_b16 a[158:159], v29 offset:4608
    v_mfma_f32_16x16x32_bf16 v[100:103], a[120:123], v[32:35], v[100:103]
    s_add_u32 m0, s42, 17408
    ds_read_b64_tr_b16 a[160:161], v30 offset:4096
    v_mfma_f32_16x16x32_bf16 v[104:107], a[124:127], v[32:35], v[104:107]
    buffer_load_dwordx4 v25, s[12:15], s54 offen lds
    ds_read_b64_tr_b16 a[162:163], v30 offset:4608
    v_mfma_f32_16x16x32_bf16 v[108:111], a[128:131], v[32:35], v[108:111]
    s_add_u32 s54, s54, 393216
    ds_read_b64_tr_b16 a[164:165], v31 offset:4096
    v_mfma_f32_16x16x32_bf16 v[100:103], a[132:135], v[32:35], v[100:103]
    ds_read_b64_tr_b16 a[166:167], v31 offset:4608
    v_mfma_f32_16x16x32_bf16 v[104:107], a[136:139], v[32:35], v[104:107]
    v_mfma_f32_16x16x32_bf16 v[108:111], a[140:143], v[32:35], v[108:111]
    s_mov_b32 s57, 0xaaaaaaaa
    s_mov_b32 s58, 0xfff0ffff
    s_mov_b32 s59, 0xf000ff00
    s_mov_b32 s60, 0xffc0fffc
    s_mov_b32 s61, 0xc000fc00
    s_mov_b32 s86, 0x3e8293ee
    v_mov_b32 v38, 0x0c0c0c0c
    v_mov_b32 v36, 0xc0c0100
    v_mov_b32 v37, 0x1000c0c
    v_cndmask_b32 v36, v36, v37, s[56:57]
    v_cndmask_b32 v14, v36, v38, s[58:59]
    v_add_u32 v29, 49152, v26
    v_add_u32 v30, 49152, v27
    v_add_u32 v31, 49152, v28
    s_waitcnt vmcnt(14) lgkmcnt(0)
    s_barrier
    v_mfma_f32_16x16x32_bf16 v[44:47], a[144:147], v[68:71], v[44:47]
    s_add_u32 m0, s43, 137984
    ds_read_b128 v[84:87], v4 offset:28672
    v_mfma_f32_16x16x32_bf16 v[48:51], a[144:147], v[72:75], v[48:51]
    buffer_load_dwordx4 v6, s[8:11], s41 offen offset:1280 sc1 lds
    ds_read_b128 v[88:91], v4 offset:30720
    v_mfma_f32_16x16x32_bf16 v[56:59], a[148:151], v[72:75], v[56:59]
    s_add_u32 m0, s42, 24576
    ds_read_b128 v[92:95], v5 offset:28672
    v_mfma_f32_16x16x32_bf16 v[52:55], a[148:151], v[68:71], v[52:55]
    buffer_load_dwordx4 v20, s[12:15], s54 offen lds
    ds_read_b128 v[96:99], v5 offset:30720
    v_mfma_f32_16x16x32_bf16 v[60:63], a[152:155], v[68:71], v[60:63]
    s_add_u32 m0, s42, 25600
    ds_read_b64_tr_b16 a[168:169], v29 offset:0
    v_mfma_f32_16x16x32_bf16 v[64:67], a[152:155], v[72:75], v[64:67]
    buffer_load_dwordx4 v21, s[12:15], s54 offen lds
    ds_read_b64_tr_b16 a[170:171], v29 offset:512
    v_mfma_f32_16x16x32_bf16 v[44:47], a[156:159], v[76:79], v[44:47]
    s_add_u32 m0, s42, 32768
    ds_read_b64_tr_b16 a[172:173], v30 offset:0
    v_mfma_f32_16x16x32_bf16 v[48:51], a[156:159], v[80:83], v[48:51]
    buffer_load_dwordx4 v22, s[12:15], s54 offen lds
    ds_read_b64_tr_b16 a[174:175], v30 offset:512
    v_mfma_f32_16x16x32_bf16 v[56:59], a[160:163], v[80:83], v[56:59]
    s_add_u32 m0, s42, 33792
    ds_read_b64_tr_b16 a[176:177], v31 offset:0
    v_mfma_f32_16x16x32_bf16 v[52:55], a[160:163], v[76:79], v[52:55]
    buffer_load_dwordx4 v23, s[12:15], s54 offen lds
    ds_read_b64_tr_b16 a[178:179], v31 offset:512
    v_mfma_f32_16x16x32_bf16 v[60:63], a[164:167], v[76:79], v[60:63]
    s_add_u32 m0, s42, 40960
    ds_read_b64_tr_b16 a[180:181], v29 offset:4096
    v_mfma_f32_16x16x32_bf16 v[64:67], a[164:167], v[80:83], v[64:67]
    buffer_load_dwordx4 v24, s[12:15], s54 offen lds
    ds_read_b64_tr_b16 a[182:183], v29 offset:4608
    v_mfma_f32_16x16x32_bf16 v[100:103], a[144:147], v[32:35], v[100:103]
    s_add_u32 m0, s42, 41984
    ds_read_b64_tr_b16 a[184:185], v30 offset:4096
    v_mfma_f32_16x16x32_bf16 v[104:107], a[148:151], v[32:35], v[104:107]
    buffer_load_dwordx4 v25, s[12:15], s54 offen lds
    ds_read_b64_tr_b16 a[186:187], v30 offset:4608
    v_mfma_f32_16x16x32_bf16 v[108:111], a[152:155], v[32:35], v[108:111]
    s_add_u32 s54, s54, 393216
    ds_read_b64_tr_b16 a[188:189], v31 offset:4096
    v_mfma_f32_16x16x32_bf16 v[100:103], a[156:159], v[32:35], v[100:103]
    ds_read_b64_tr_b16 a[190:191], v31 offset:4608
    v_mfma_f32_16x16x32_bf16 v[104:107], a[160:163], v[32:35], v[104:107]
    v_mfma_f32_16x16x32_bf16 v[108:111], a[164:167], v[32:35], v[108:111]
    v_cndmask_b32 v16, v38, v36, s[58:59]
    v_mov_b32 v36, 0xc0c0302
    v_mov_b32 v37, 0x3020c0c
    v_cndmask_b32 v36, v36, v37, s[56:57]
    v_cndmask_b32 v15, v36, v38, s[60:61]
    v_cndmask_b32 v17, v38, v36, s[60:61]
    v_mov_b32 v18, 0xff800000
    s_mul_i32 s90, s33, 2097152
    s_add_u32 s90, s90, 0xfffe0400
    s_lshl_b32 s37, s35, 1
    s_add_u32 s37, s37, s51
    v_add_u32 v29, 73728, v26
    v_add_u32 v30, 73728, v27
    v_add_u32 v31, 73728, v28
    s_waitcnt vmcnt(14) lgkmcnt(0)
    s_barrier
    v_mfma_f32_16x16x32_bf16 v[44:47], a[168:171], v[84:87], v[44:47]
    s_add_u32 m0, s43, 141952
    ds_read_b128 v[68:71], v4 offset:32768
    v_mfma_f32_16x16x32_bf16 v[48:51], a[168:171], v[88:91], v[48:51]
    buffer_load_dwordx4 v6, s[8:11], s41 offen offset:1408 sc1 lds
    ds_read_b128 v[72:75], v4 offset:34816
    v_mfma_f32_16x16x32_bf16 v[56:59], a[172:175], v[88:91], v[56:59]
    s_add_u32 m0, s42, 49152
    ds_read_b128 v[76:79], v5 offset:32768
    v_mfma_f32_16x16x32_bf16 v[52:55], a[172:175], v[84:87], v[52:55]
    buffer_load_dwordx4 v20, s[12:15], s54 offen lds
    ds_read_b128 v[80:83], v5 offset:34816
    v_mfma_f32_16x16x32_bf16 v[60:63], a[176:179], v[84:87], v[60:63]
    s_add_u32 m0, s42, 50176
    ds_read_b64_tr_b16 a[192:193], v29 offset:0
    v_mfma_f32_16x16x32_bf16 v[64:67], a[176:179], v[88:91], v[64:67]
    buffer_load_dwordx4 v21, s[12:15], s54 offen lds
    ds_read_b64_tr_b16 a[194:195], v29 offset:512
    v_mfma_f32_16x16x32_bf16 v[44:47], a[180:183], v[92:95], v[44:47]
    s_add_u32 m0, s42, 57344
    ds_read_b64_tr_b16 a[196:197], v30 offset:0
    v_mfma_f32_16x16x32_bf16 v[48:51], a[180:183], v[96:99], v[48:51]
    buffer_load_dwordx4 v22, s[12:15], s54 offen lds
    ds_read_b64_tr_b16 a[198:199], v30 offset:512
    v_mfma_f32_16x16x32_bf16 v[56:59], a[184:187], v[96:99], v[56:59]
    s_add_u32 m0, s42, 58368
    ds_read_b64_tr_b16 a[200:201], v31 offset:0
    v_mfma_f32_16x16x32_bf16 v[52:55], a[184:187], v[92:95], v[52:55]
    buffer_load_dwordx4 v23, s[12:15], s54 offen lds
    ds_read_b64_tr_b16 a[202:203], v31 offset:512
    v_mfma_f32_16x16x32_bf16 v[60:63], a[188:191], v[92:95], v[60:63]
    s_add_u32 m0, s42, 65536
    ds_read_b64_tr_b16 a[204:205], v29 offset:4096
    v_mfma_f32_16x16x32_bf16 v[64:67], a[188:191], v[96:99], v[64:67]
    buffer_load_dwordx4 v24, s[12:15], s54 offen lds
    ds_read_b64_tr_b16 a[206:207], v29 offset:4608
    v_mfma_f32_16x16x32_bf16 v[100:103], a[168:171], v[32:35], v[100:103]
    s_add_u32 m0, s42, 66560
    ds_read_b64_tr_b16 a[208:209], v30 offset:4096
    v_mfma_f32_16x16x32_bf16 v[104:107], a[172:175], v[32:35], v[104:107]
    buffer_load_dwordx4 v25, s[12:15], s54 offen lds
    ds_read_b64_tr_b16 a[210:211], v30 offset:4608
    v_mfma_f32_16x16x32_bf16 v[108:111], a[176:179], v[32:35], v[108:111]
    s_add_u32 s54, s54, 393216
    ds_read_b64_tr_b16 a[212:213], v31 offset:4096
    v_mfma_f32_16x16x32_bf16 v[100:103], a[180:183], v[32:35], v[100:103]
    ds_read_b64_tr_b16 a[214:215], v31 offset:4608
    v_mfma_f32_16x16x32_bf16 v[104:107], a[184:187], v[32:35], v[104:107]
    v_mfma_f32_16x16x32_bf16 v[108:111], a[188:191], v[32:35], v[108:111]
    s_lshl_b32 s37, s37, 11
    s_add_u32 s90, s90, s37
    s_mul_i32 s37, s38, 64512
    s_add_u32 s90, s90, s37
    s_cmp_eq_u32 s38, 0
    s_cselect_b32 s87, 63488, 0
    s_cselect_b32 s24, -2, 0xfffeffff
    s_cselect_b32 s26, 0x10000, 0
    s_cselect_b32 s27, 0, 1
    s_add_u32 s87, s87, 1024
    s_mov_b32 s25, -1
    s_cmp_eq_u32 s33, 0
    s_cselect_b64 s[26:27], s[26:27], 0
    s_add_u32 s20, s82, 0x80
    s_addc_u32 s21, s83, 0
    s_mov_b32 s22, 0x4
    s_mov_b32 s23, 0x00020000
    v_lshl_add_u32 v36, s32, 4, v124
    v_add_u32 v29, 0, v26
    v_add_u32 v30, 0, v27
    v_add_u32 v31, 0, v28
    s_waitcnt vmcnt(14) lgkmcnt(0)
    s_barrier
    v_mfma_f32_16x16x32_bf16 v[44:47], a[192:195], v[68:71], v[44:47]
    s_add_u32 m0, s43, 145920
    ds_read_b128 v[84:87], v4 offset:36864
    v_mfma_f32_16x16x32_bf16 v[48:51], a[192:195], v[72:75], v[48:51]
    buffer_load_dwordx4 v6, s[8:11], s41 offen offset:1536 sc1 lds
    ds_read_b128 v[88:91], v4 offset:38912
    v_mfma_f32_16x16x32_bf16 v[56:59], a[196:199], v[72:75], v[56:59]
    s_add_u32 m0, s42, 73728
    ds_read_b128 v[92:95], v5 offset:36864
    v_mfma_f32_16x16x32_bf16 v[52:55], a[196:199], v[68:71], v[52:55]
    buffer_load_dwordx4 v20, s[12:15], s54 offen lds
    ds_read_b128 v[96:99], v5 offset:38912
    v_mfma_f32_16x16x32_bf16 v[60:63], a[200:203], v[68:71], v[60:63]
    s_add_u32 m0, s42, 74752
    ds_read_b64_tr_b16 a[216:217], v29 offset:0
    v_mfma_f32_16x16x32_bf16 v[64:67], a[200:203], v[72:75], v[64:67]
    buffer_load_dwordx4 v21, s[12:15], s54 offen lds
    ds_read_b64_tr_b16 a[218:219], v29 offset:512
    v_mfma_f32_16x16x32_bf16 v[44:47], a[204:207], v[76:79], v[44:47]
    s_add_u32 m0, s42, 81920
    ds_read_b64_tr_b16 a[220:221], v30 offset:0
    v_mfma_f32_16x16x32_bf16 v[48:51], a[204:207], v[80:83], v[48:51]
    buffer_load_dwordx4 v22, s[12:15], s54 offen lds
    ds_read_b64_tr_b16 a[222:223], v30 offset:512
    v_mfma_f32_16x16x32_bf16 v[56:59], a[208:211], v[80:83], v[56:59]
    s_add_u32 m0, s42, 82944
    ds_read_b64_tr_b16 a[224:225], v31 offset:0
    v_mfma_f32_16x16x32_bf16 v[52:55], a[208:211], v[76:79], v[52:55]
    buffer_load_dwordx4 v23, s[12:15], s54 offen lds
    ds_read_b64_tr_b16 a[226:227], v31 offset:512
    v_mfma_f32_16x16x32_bf16 v[60:63], a[212:215], v[76:79], v[60:63]
    s_add_u32 m0, s42, 90112
    ds_read_b64_tr_b16 a[228:229], v29 offset:4096
    v_mfma_f32_16x16x32_bf16 v[64:67], a[212:215], v[80:83], v[64:67]
    buffer_load_dwordx4 v24, s[12:15], s54 offen lds
    ds_read_b64_tr_b16 a[230:231], v29 offset:4608
    v_mfma_f32_16x16x32_bf16 v[100:103], a[192:195], v[32:35], v[100:103]
    s_add_u32 m0, s42, 91136
    ds_read_b64_tr_b16 a[232:233], v30 offset:4096
    v_mfma_f32_16x16x32_bf16 v[104:107], a[196:199], v[32:35], v[104:107]
    buffer_load_dwordx4 v25, s[12:15], s54 offen lds
    ds_read_b64_tr_b16 a[234:235], v30 offset:4608
    v_mfma_f32_16x16x32_bf16 v[108:111], a[200:203], v[32:35], v[108:111]
    s_add_u32 s54, s54, 393216
    ds_read_b64_tr_b16 a[236:237], v31 offset:4096
    v_mfma_f32_16x16x32_bf16 v[100:103], a[204:207], v[32:35], v[100:103]
    ds_read_b64_tr_b16 a[238:239], v31 offset:4608
    v_mfma_f32_16x16x32_bf16 v[104:107], a[208:211], v[32:35], v[104:107]
    v_mfma_f32_16x16x32_bf16 v[108:111], a[212:215], v[32:35], v[108:111]
    v_add_u32 v29, 24576, v26
    v_add_u32 v30, 24576, v27
    v_add_u32 v31, 24576, v28
    s_waitcnt vmcnt(14) lgkmcnt(0)
    s_barrier
    v_mfma_f32_16x16x32_bf16 v[44:47], a[216:219], v[84:87], v[44:47]
    buffer_load_dword v37, v36, s[20:23], 0 offen sc1
    ds_read_b128 v[68:71], v4 offset:40960
    v_mfma_f32_16x16x32_bf16 v[48:51], a[216:219], v[88:91], v[48:51]
    s_add_u32 m0, s43, 149888
    ds_read_b128 v[72:75], v4 offset:43008
    v_mfma_f32_16x16x32_bf16 v[56:59], a[220:223], v[88:91], v[56:59]
    buffer_load_dwordx4 v6, s[8:11], s41 offen offset:1664 sc1 lds
    ds_read_b128 v[76:79], v5 offset:40960
    v_mfma_f32_16x16x32_bf16 v[52:55], a[220:223], v[84:87], v[52:55]
    s_add_u32 m0, s42, 0
    ds_read_b128 v[80:83], v5 offset:43008
    v_mfma_f32_16x16x32_bf16 v[60:63], a[224:227], v[84:87], v[60:63]
    buffer_load_dwordx4 v20, s[12:15], s54 offen lds
    ds_read_b64_tr_b16 a[240:241], v29 offset:0
    v_mfma_f32_16x16x32_bf16 v[64:67], a[224:227], v[88:91], v[64:67]
    s_add_u32 m0, s42, 1024
    ds_read_b64_tr_b16 a[242:243], v29 offset:512
    v_mfma_f32_16x16x32_bf16 v[44:47], a[228:231], v[92:95], v[44:47]
    buffer_load_dwordx4 v21, s[12:15], s54 offen lds
    ds_read_b64_tr_b16 a[244:245], v30 offset:0
    v_mfma_f32_16x16x32_bf16 v[48:51], a[228:231], v[96:99], v[48:51]
    s_add_u32 m0, s42, 8192
    ds_read_b64_tr_b16 a[246:247], v30 offset:512
    v_mfma_f32_16x16x32_bf16 v[56:59], a[232:235], v[96:99], v[56:59]
    buffer_load_dwordx4 v22, s[12:15], s54 offen lds
    ds_read_b64_tr_b16 a[248:249], v31 offset:0
    v_mfma_f32_16x16x32_bf16 v[52:55], a[232:235], v[92:95], v[52:55]
    s_add_u32 m0, s42, 9216
    ds_read_b64_tr_b16 a[250:251], v31 offset:512
    v_mfma_f32_16x16x32_bf16 v[60:63], a[236:239], v[92:95], v[60:63]
    buffer_load_dwordx4 v23, s[12:15], s54 offen lds
    ds_read_b64_tr_b16 a[252:253], v29 offset:4096
    v_mfma_f32_16x16x32_bf16 v[64:67], a[236:239], v[96:99], v[64:67]
    s_add_u32 m0, s42, 16384
    ds_read_b64_tr_b16 a[254:255], v29 offset:4608
    v_mfma_f32_16x16x32_bf16 v[100:103], a[216:219], v[32:35], v[100:103]
    buffer_load_dwordx4 v24, s[12:15], s54 offen lds
    ds_read_b64_tr_b16 v[128:129], v30 offset:4096
    v_mfma_f32_16x16x32_bf16 v[104:107], a[220:223], v[32:35], v[104:107]
    s_add_u32 m0, s42, 17408
    ds_read_b64_tr_b16 v[130:131], v30 offset:4608
    v_mfma_f32_16x16x32_bf16 v[108:111], a[224:227], v[32:35], v[108:111]
    buffer_load_dwordx4 v25, s[12:15], s54 offen lds
    ds_read_b64_tr_b16 v[132:133], v31 offset:4096
    v_mfma_f32_16x16x32_bf16 v[100:103], a[228:231], v[32:35], v[100:103]
    s_add_u32 s54, s54, 393216
    ds_read_b64_tr_b16 v[134:135], v31 offset:4608
    v_mfma_f32_16x16x32_bf16 v[104:107], a[232:235], v[32:35], v[104:107]
    v_mfma_f32_16x16x32_bf16 v[108:111], a[236:239], v[32:35], v[108:111]
    v_add_u32 v29, 49152, v26
    v_add_u32 v30, 49152, v27
    v_add_u32 v31, 49152, v28
    s_waitcnt vmcnt(15) lgkmcnt(0)
    s_barrier
    v_mfma_f32_16x16x32_bf16 v[44:47], a[240:243], v[68:71], v[44:47]
    s_add_u32 m0, s43, 153856
    ds_read_b128 v[84:87], v4 offset:45056
    v_mfma_f32_16x16x32_bf16 v[48:51], a[240:243], v[72:75], v[48:51]
    buffer_load_dwordx4 v6, s[8:11], s41 offen offset:1792 sc1 lds
    ds_read_b128 v[88:91], v4 offset:47104
    v_mfma_f32_16x16x32_bf16 v[56:59], a[244:247], v[72:75], v[56:59]
    s_add_u32 m0, s42, 24576
    ds_read_b128 v[92:95], v5 offset:45056
    v_mfma_f32_16x16x32_bf16 v[52:55], a[244:247], v[68:71], v[52:55]
    buffer_load_dwordx4 v20, s[12:15], s54 offen lds
    ds_read_b128 v[96:99], v5 offset:47104
    v_mfma_f32_16x16x32_bf16 v[60:63], a[248:251], v[68:71], v[60:63]
    s_add_u32 m0, s42, 25600
    ds_read_b64_tr_b16 v[136:137], v29 offset:0
    v_mfma_f32_16x16x32_bf16 v[64:67], a[248:251], v[72:75], v[64:67]
    buffer_load_dwordx4 v21, s[12:15], s54 offen lds
    ds_read_b64_tr_b16 v[138:139], v29 offset:512
    v_mfma_f32_16x16x32_bf16 v[44:47], a[252:255], v[76:79], v[44:47]
    s_add_u32 m0, s42, 32768
    ds_read_b64_tr_b16 v[140:141], v30 offset:0
    v_mfma_f32_16x16x32_bf16 v[48:51], a[252:255], v[80:83], v[48:51]
    buffer_load_dwordx4 v22, s[12:15], s54 offen lds
    ds_read_b64_tr_b16 v[142:143], v30 offset:512
    v_mfma_f32_16x16x32_bf16 v[56:59], v[128:131], v[80:83], v[56:59]
    s_add_u32 m0, s42, 33792
    ds_read_b64_tr_b16 v[144:145], v31 offset:0
    v_mfma_f32_16x16x32_bf16 v[52:55], v[128:131], v[76:79], v[52:55]
    buffer_load_dwordx4 v23, s[12:15], s54 offen lds
    ds_read_b64_tr_b16 v[146:147], v31 offset:512
    v_mfma_f32_16x16x32_bf16 v[60:63], v[132:135], v[76:79], v[60:63]
    s_add_u32 m0, s42, 40960
    ds_read_b64_tr_b16 v[148:149], v29 offset:4096
    v_mfma_f32_16x16x32_bf16 v[64:67], v[132:135], v[80:83], v[64:67]
    buffer_load_dwordx4 v24, s[12:15], s54 offen lds
    ds_read_b64_tr_b16 v[150:151], v29 offset:4608
    v_mfma_f32_16x16x32_bf16 v[100:103], a[240:243], v[32:35], v[100:103]
    s_add_u32 m0, s42, 41984
    ds_read_b64_tr_b16 v[152:153], v30 offset:4096
    v_mfma_f32_16x16x32_bf16 v[104:107], a[244:247], v[32:35], v[104:107]
    buffer_load_dwordx4 v25, s[12:15], s54 offen lds
    ds_read_b64_tr_b16 v[154:155], v30 offset:4608
    v_mfma_f32_16x16x32_bf16 v[108:111], a[248:251], v[32:35], v[108:111]
    s_add_u32 s54, s54, 393216
    ds_read_b64_tr_b16 v[156:157], v31 offset:4096
    v_mfma_f32_16x16x32_bf16 v[100:103], a[252:255], v[32:35], v[100:103]
    ds_read_b64_tr_b16 v[158:159], v31 offset:4608
    v_mfma_f32_16x16x32_bf16 v[104:107], v[128:131], v[32:35], v[104:107]
    v_mfma_f32_16x16x32_bf16 v[108:111], v[132:135], v[32:35], v[108:111]
    v_add_u32 v29, 73728, v26
    v_add_u32 v30, 73728, v27
    v_add_u32 v31, 73728, v28
    s_waitcnt vmcnt(15) lgkmcnt(0)
    s_barrier
    v_mfma_f32_16x16x32_bf16 v[44:47], v[136:139], v[84:87], v[44:47]
    s_add_u32 m0, s43, 157824
    ds_read_b128 v[68:71], v4 offset:49152
    v_mfma_f32_16x16x32_bf16 v[48:51], v[136:139], v[88:91], v[48:51]
    buffer_load_dwordx4 v6, s[8:11], s41 offen offset:1920 sc1 lds
    ds_read_b128 v[72:75], v4 offset:51200
    v_mfma_f32_16x16x32_bf16 v[56:59], v[140:143], v[88:91], v[56:59]
    s_add_u32 m0, s42, 49152
    ds_read_b128 v[76:79], v5 offset:49152
    v_mfma_f32_16x16x32_bf16 v[52:55], v[140:143], v[84:87], v[52:55]
    buffer_load_dwordx4 v20, s[12:15], s54 offen lds
    ds_read_b128 v[80:83], v5 offset:51200
    v_mfma_f32_16x16x32_bf16 v[60:63], v[144:147], v[84:87], v[60:63]
    s_add_u32 m0, s42, 50176
    ds_read_b64_tr_b16 v[160:161], v29 offset:0
    v_mfma_f32_16x16x32_bf16 v[64:67], v[144:147], v[88:91], v[64:67]
    buffer_load_dwordx4 v21, s[12:15], s54 offen lds
    ds_read_b64_tr_b16 v[162:163], v29 offset:512
    v_mfma_f32_16x16x32_bf16 v[44:47], v[148:151], v[92:95], v[44:47]
    s_add_u32 m0, s42, 57344
    ds_read_b64_tr_b16 v[164:165], v30 offset:0
    v_mfma_f32_16x16x32_bf16 v[48:51], v[148:151], v[96:99], v[48:51]
    buffer_load_dwordx4 v22, s[12:15], s54 offen lds
    ds_read_b64_tr_b16 v[166:167], v30 offset:512
    v_mfma_f32_16x16x32_bf16 v[56:59], v[152:155], v[96:99], v[56:59]
    s_add_u32 m0, s42, 58368
    ds_read_b64_tr_b16 v[168:169], v31 offset:0
    v_mfma_f32_16x16x32_bf16 v[52:55], v[152:155], v[92:95], v[52:55]
    buffer_load_dwordx4 v23, s[12:15], s54 offen lds
    ds_read_b64_tr_b16 v[170:171], v31 offset:512
    v_mfma_f32_16x16x32_bf16 v[60:63], v[156:159], v[92:95], v[60:63]
    s_add_u32 m0, s42, 65536
    ds_read_b64_tr_b16 v[172:173], v29 offset:4096
    v_mfma_f32_16x16x32_bf16 v[64:67], v[156:159], v[96:99], v[64:67]
    buffer_load_dwordx4 v24, s[12:15], s54 offen lds
    ds_read_b64_tr_b16 v[174:175], v29 offset:4608
    v_mfma_f32_16x16x32_bf16 v[100:103], v[136:139], v[32:35], v[100:103]
    s_add_u32 m0, s42, 66560
    ds_read_b64_tr_b16 v[176:177], v30 offset:4096
    v_mfma_f32_16x16x32_bf16 v[104:107], v[140:143], v[32:35], v[104:107]
    buffer_load_dwordx4 v25, s[12:15], s54 offen lds
    ds_read_b64_tr_b16 v[178:179], v30 offset:4608
    v_mfma_f32_16x16x32_bf16 v[108:111], v[144:147], v[32:35], v[108:111]
    s_add_u32 s54, s54, 393216
    ds_read_b64_tr_b16 v[180:181], v31 offset:4096
    v_mfma_f32_16x16x32_bf16 v[100:103], v[148:151], v[32:35], v[100:103]
    ds_read_b64_tr_b16 v[182:183], v31 offset:4608
    v_mfma_f32_16x16x32_bf16 v[104:107], v[152:155], v[32:35], v[104:107]
    v_mfma_f32_16x16x32_bf16 v[108:111], v[156:159], v[32:35], v[108:111]
    v_add_u32 v29, 0, v26
    v_add_u32 v30, 0, v27
    v_add_u32 v31, 0, v28
    s_waitcnt vmcnt(14) lgkmcnt(0)
    v_cmp_eq_u32 vcc, v36, v37
    s_cbranch_vccnz L_spin1
L_back2:
    s_barrier
    v_mfma_f32_16x16x32_bf16 v[44:47], v[160:163], v[68:71], v[44:47]
    s_add_u32 m0, s52, 92160
    ds_read_b128 v[84:87], v4 offset:53248
    v_mfma_f32_16x16x32_bf16 v[48:51], v[160:163], v[72:75], v[48:51]
    buffer_load_dwordx4 v1, s[16:19], s46 offen sc1 lds
    ds_read_b128 v[88:91], v4 offset:55296
    v_mfma_f32_16x16x32_bf16 v[56:59], v[164:167], v[72:75], v[56:59]
    s_cmp_eq_u32 s36, s97
    s_cselect_b32 s47, 31, -2
    s_cselect_b64 s[8:9], s[88:89], s[8:9]
    s_cselect_b32 s55, 0x543fc00, s55
    ds_read_b128 v[92:95], v5 offset:53248
    v_mfma_f32_16x16x32_bf16 v[52:55], v[164:167], v[68:71], v[52:55]
    s_add_u32 s50, s50, s47
    ds_read_b128 v[96:99], v5 offset:55296
    v_mfma_f32_16x16x32_bf16 v[60:63], v[168:171], v[68:71], v[60:63]
    s_max_i32 s47, s50, 0
    ds_read_b64_tr_b16 v[184:185], v29 offset:0
    v_mfma_f32_16x16x32_bf16 v[64:67], v[168:171], v[72:75], v[64:67]
    s_lshl_b32 s41, s47, 15
    ds_read_b64_tr_b16 v[186:187], v29 offset:512
    v_mfma_f32_16x16x32_bf16 v[44:47], v[172:175], v[76:79], v[44:47]
    s_lshl_b32 s46, s47, 10
    ds_read_b64_tr_b16 v[188:189], v30 offset:0
    v_mfma_f32_16x16x32_bf16 v[48:51], v[172:175], v[80:83], v[48:51]
    s_sub_u32 s46, s55, s46
    ds_read_b64_tr_b16 v[190:191], v30 offset:512
    v_mfma_f32_16x16x32_bf16 v[56:59], v[176:179], v[80:83], v[56:59]
    s_add_u32 m0, s52, 90112
    ds_read_b64_tr_b16 v[192:193], v31 offset:0
    v_mfma_f32_16x16x32_bf16 v[52:55], v[176:179], v[76:79], v[52:55]
    buffer_load_dwordx4 v1, s[16:19], s46 offen sc1 lds
    ds_read_b64_tr_b16 v[194:195], v31 offset:512
    v_mfma_f32_16x16x32_bf16 v[60:63], v[180:183], v[76:79], v[60:63]
    buffer_store_dword v124, v124, s[16:19], s91 offen sc1
    ds_read_b64_tr_b16 v[196:197], v29 offset:4096
    v_mfma_f32_16x16x32_bf16 v[64:67], v[180:183], v[80:83], v[64:67]
    s_add_u32 s91, s91, 65536
    ds_read_b64_tr_b16 v[198:199], v29 offset:4608
    v_mfma_f32_16x16x32_bf16 v[100:103], v[160:163], v[32:35], v[100:103]
    ds_read_b64_tr_b16 v[200:201], v30 offset:4096
    v_mfma_f32_16x16x32_bf16 v[104:107], v[164:167], v[32:35], v[104:107]
    ds_read_b64_tr_b16 v[202:203], v30 offset:4608
    v_mfma_f32_16x16x32_bf16 v[108:111], v[168:171], v[32:35], v[108:111]
    ds_read_b64_tr_b16 v[204:205], v31 offset:4096
    v_mfma_f32_16x16x32_bf16 v[100:103], v[172:175], v[32:35], v[100:103]
    ds_read_b64_tr_b16 v[206:207], v31 offset:4608
    v_mfma_f32_16x16x32_bf16 v[104:107], v[176:179], v[32:35], v[104:107]
    v_mfma_f32_16x16x32_bf16 v[108:111], v[180:183], v[32:35], v[108:111]
    v_add_u32 v29, 24576, v26
    v_add_u32 v30, 24576, v27
    v_add_u32 v31, 24576, v28
    s_waitcnt vmcnt(10) lgkmcnt(0)
    s_barrier
    v_mfma_f32_16x16x32_bf16 v[44:47], v[184:187], v[84:87], v[44:47]
    s_add_u32 m0, s43, 0
    ds_read_b128 v[68:71], v4 offset:57344
    v_mfma_f32_16x16x32_bf16 v[48:51], v[184:187], v[88:91], v[48:51]
    buffer_load_dwordx4 v6, s[8:11], s41 offen offset:0 sc1 lds
    ds_read_b128 v[72:75], v4 offset:59392
    v_mfma_f32_16x16x32_bf16 v[56:59], v[188:191], v[88:91], v[56:59]
    s_add_u32 m0, s43, 3968
    ds_read_b128 v[76:79], v5 offset:57344
    v_mfma_f32_16x16x32_bf16 v[52:55], v[188:191], v[84:87], v[52:55]
    buffer_load_dwordx4 v6, s[8:11], s41 offen offset:128 sc1 lds
    ds_read_b128 v[80:83], v5 offset:59392
    v_mfma_f32_16x16x32_bf16 v[60:63], v[192:195], v[84:87], v[60:63]
    s_add_u32 m0, s43, 7936
    ds_read_b64_tr_b16 v[208:209], v29 offset:0
    v_mfma_f32_16x16x32_bf16 v[64:67], v[192:195], v[88:91], v[64:67]
    buffer_load_dwordx4 v6, s[8:11], s41 offen offset:256 sc1 lds
    ds_read_b64_tr_b16 v[210:211], v29 offset:512
    v_mfma_f32_16x16x32_bf16 v[44:47], v[196:199], v[92:95], v[44:47]
    s_add_u32 m0, s43, 11904
    ds_read_b64_tr_b16 v[212:213], v30 offset:0
    v_mfma_f32_16x16x32_bf16 v[48:51], v[196:199], v[96:99], v[48:51]
    buffer_load_dwordx4 v6, s[8:11], s41 offen offset:384 sc1 lds
    ds_read_b64_tr_b16 v[214:215], v30 offset:512
    v_mfma_f32_16x16x32_bf16 v[56:59], v[200:203], v[96:99], v[56:59]
    s_add_u32 m0, s43, 15872
    ds_read_b64_tr_b16 v[216:217], v31 offset:0
    v_mfma_f32_16x16x32_bf16 v[52:55], v[200:203], v[92:95], v[52:55]
    buffer_load_dwordx4 v6, s[8:11], s41 offen offset:512 sc1 lds
    ds_read_b64_tr_b16 v[218:219], v31 offset:512
    v_mfma_f32_16x16x32_bf16 v[60:63], v[204:207], v[92:95], v[60:63]
    s_add_u32 m0, s43, 19840
    ds_read_b64_tr_b16 v[220:221], v29 offset:4096
    v_mfma_f32_16x16x32_bf16 v[64:67], v[204:207], v[96:99], v[64:67]
    buffer_load_dwordx4 v6, s[8:11], s41 offen offset:640 sc1 lds
    ds_read_b64_tr_b16 v[222:223], v29 offset:4608
    v_mfma_f32_16x16x32_bf16 v[100:103], v[184:187], v[32:35], v[100:103]
    ds_read_b64_tr_b16 v[224:225], v30 offset:4096
    v_mfma_f32_16x16x32_bf16 v[104:107], v[188:191], v[32:35], v[104:107]
    ds_read_b64_tr_b16 v[226:227], v30 offset:4608
    v_mfma_f32_16x16x32_bf16 v[108:111], v[192:195], v[32:35], v[108:111]
    ds_read_b64_tr_b16 v[228:229], v31 offset:4096
    v_mfma_f32_16x16x32_bf16 v[100:103], v[196:199], v[32:35], v[100:103]
    ds_read_b64_tr_b16 v[230:231], v31 offset:4608
    v_mfma_f32_16x16x32_bf16 v[104:107], v[200:203], v[32:35], v[104:107]
    v_mfma_f32_16x16x32_bf16 v[108:111], v[204:207], v[32:35], v[108:111]
    v_add_u32 v29, 49152, v26
    v_add_u32 v30, 49152, v27
    v_add_u32 v31, 49152, v28
    s_waitcnt vmcnt(9) lgkmcnt(0)
    s_barrier
    v_mfma_f32_16x16x32_bf16 v[44:47], v[208:211], v[68:71], v[44:47]
    s_add_u32 m0, s43, 23808
    ds_read_b128 v[84:87], v4 offset:61440
    v_mfma_f32_16x16x32_bf16 v[48:51], v[208:211], v[72:75], v[48:51]
    buffer_load_dwordx4 v6, s[8:11], s41 offen offset:768 sc1 lds
    ds_read_b128 v[88:91], v4 offset:63488
    v_mfma_f32_16x16x32_bf16 v[56:59], v[212:215], v[72:75], v[56:59]
    s_add_u32 m0, s43, 27776
    ds_read_b128 v[92:95], v5 offset:61440
    v_mfma_f32_16x16x32_bf16 v[52:55], v[212:215], v[68:71], v[52:55]
    buffer_load_dwordx4 v6, s[8:11], s41 offen offset:896 sc1 lds
    ds_read_b128 v[96:99], v5 offset:63488
    v_mfma_f32_16x16x32_bf16 v[60:63], v[216:219], v[68:71], v[60:63]
    s_add_u32 m0, s43, 31744
    ds_read_b64_tr_b16 v[232:233], v29 offset:0
    v_mfma_f32_16x16x32_bf16 v[64:67], v[216:219], v[72:75], v[64:67]
    buffer_load_dwordx4 v6, s[8:11], s41 offen offset:1024 sc1 lds
    ds_read_b64_tr_b16 v[234:235], v29 offset:512
    v_mfma_f32_16x16x32_bf16 v[44:47], v[220:223], v[76:79], v[44:47]
    s_add_u32 m0, s43, 35712
    ds_read_b64_tr_b16 v[236:237], v30 offset:0
    v_mfma_f32_16x16x32_bf16 v[48:51], v[220:223], v[80:83], v[48:51]
    buffer_load_dwordx4 v6, s[8:11], s41 offen offset:1152 sc1 lds
    ds_read_b64_tr_b16 v[238:239], v30 offset:512
    v_mfma_f32_16x16x32_bf16 v[56:59], v[224:227], v[80:83], v[56:59]
    s_add_u32 m0, s43, 39680
    ds_read_b64_tr_b16 v[240:241], v31 offset:0
    v_mfma_f32_16x16x32_bf16 v[52:55], v[224:227], v[76:79], v[52:55]
    buffer_load_dwordx4 v6, s[8:11], s41 offen offset:1280 sc1 lds
    ds_read_b64_tr_b16 v[242:243], v31 offset:512
    v_mfma_f32_16x16x32_bf16 v[60:63], v[228:231], v[76:79], v[60:63]
    s_add_u32 m0, s43, 43648
    ds_read_b64_tr_b16 v[244:245], v29 offset:4096
    v_mfma_f32_16x16x32_bf16 v[64:67], v[228:231], v[80:83], v[64:67]
    buffer_load_dwordx4 v6, s[8:11], s41 offen offset:1408 sc1 lds
    ds_read_b64_tr_b16 v[246:247], v29 offset:4608
    v_mfma_f32_16x16x32_bf16 v[100:103], v[208:211], v[32:35], v[100:103]
    ds_read_b64_tr_b16 v[248:249], v30 offset:4096
    v_mfma_f32_16x16x32_bf16 v[104:107], v[212:215], v[32:35], v[104:107]
    ds_read_b64_tr_b16 v[250:251], v30 offset:4608
    v_mfma_f32_16x16x32_bf16 v[108:111], v[216:219], v[32:35], v[108:111]
    ds_read_b64_tr_b16 v[252:253], v31 offset:4096
    v_mfma_f32_16x16x32_bf16 v[100:103], v[220:223], v[32:35], v[100:103]
    ds_read_b64_tr_b16 v[254:255], v31 offset:4608
    v_mfma_f32_16x16x32_bf16 v[104:107], v[224:227], v[32:35], v[104:107]
    v_mfma_f32_16x16x32_bf16 v[108:111], v[228:231], v[32:35], v[108:111]
    s_waitcnt vmcnt(13) lgkmcnt(0)
    s_barrier
    v_mfma_f32_16x16x32_bf16 v[44:47], v[232:235], v[84:87], v[44:47]
    s_add_u32 m0, s43, 47616
    v_mfma_f32_16x16x32_bf16 v[48:51], v[232:235], v[88:91], v[48:51]
    buffer_load_dwordx4 v6, s[8:11], s41 offen offset:1536 sc1 lds
    v_mfma_f32_16x16x32_bf16 v[56:59], v[236:239], v[88:91], v[56:59]
    s_add_u32 m0, s43, 51584
    v_mfma_f32_16x16x32_bf16 v[52:55], v[236:239], v[84:87], v[52:55]
    buffer_load_dwordx4 v6, s[8:11], s41 offen offset:1664 sc1 lds
    v_mfma_f32_16x16x32_bf16 v[60:63], v[240:243], v[84:87], v[60:63]
    s_add_u32 m0, s43, 55552
    v_mfma_f32_16x16x32_bf16 v[64:67], v[240:243], v[88:91], v[64:67]
    buffer_load_dwordx4 v6, s[8:11], s41 offen offset:1792 sc1 lds
    v_mfma_f32_16x16x32_bf16 v[44:47], v[244:247], v[92:95], v[44:47]
    s_add_u32 m0, s43, 59520
    v_mfma_f32_16x16x32_bf16 v[48:51], v[244:247], v[96:99], v[48:51]
    buffer_load_dwordx4 v6, s[8:11], s41 offen offset:1920 sc1 lds
    v_mfma_f32_16x16x32_bf16 v[56:59], v[248:251], v[96:99], v[56:59]
    v_mfma_f32_16x16x32_bf16 v[52:55], v[248:251], v[92:95], v[52:55]
    v_mfma_f32_16x16x32_bf16 v[60:63], v[252:255], v[92:95], v[60:63]
    v_mfma_f32_16x16x32_bf16 v[64:67], v[252:255], v[96:99], v[64:67]
    v_mfma_f32_16x16x32_bf16 v[100:103], v[232:235], v[32:35], v[100:103]
    v_mfma_f32_16x16x32_bf16 v[104:107], v[236:239], v[32:35], v[104:107]
    v_mfma_f32_16x16x32_bf16 v[108:111], v[240:243], v[32:35], v[108:111]
    v_mfma_f32_16x16x32_bf16 v[100:103], v[244:247], v[32:35], v[100:103]
    v_mfma_f32_16x16x32_bf16 v[104:107], v[248:251], v[32:35], v[104:107]
    v_mfma_f32_16x16x32_bf16 v[108:111], v[252:255], v[32:35], v[108:111]
    s_mov_b32 s36, 0
    ds_read_b64 v[20:21], v13 offset:2048
    ds_read_b64 v[22:23], v13 offset:2176
    ds_read_b64 v[24:25], v13 offset:2304
    ds_read_b64 v[26:27], v13 offset:2432
    s_waitcnt lgkmcnt(0)
    v_add_f32 v28, v24, v26
    v_add_f32 v29, v25, v27
    v_add_f32 v20, v20, v22
    v_add_f32 v21, v21, v23
    v_add_f32 v20, v20, v28
    v_add_f32 v21, v21, v29
    v_mov_b32 v28, v20
    v_mov_b32 v29, v21
    s_nop 0
    v_permlane32_swap_b32 v20, v28
    v_permlane32_swap_b32 v21, v29
    v_add_f32 v20, v20, v28
    v_add_f32 v21, v21, v29
    v_mul_f32 v112, 0xba800000, v20
    v_mul_f32 v21, 0x3a800000, v21
    v_fma_f32 v21, -v112, v112, v21
    v_mov_b32 v113, v112
    v_max_f32 v21, 0, v21
    v_add_f32 v21, 0x3727c5ac, v21
    v_rsq_f32 v114, v21
    v_permlane16_swap_b32 v112, v113
    v_mov_b32 v115, v114
    s_nop 1
    v_permlane16_swap_b32 v114, v115
    s_cmp_eq_u32 s36, s97
    s_cselect_b32 s47, 31, -2
    s_cselect_b64 s[8:9], s[88:89], s[8:9]
    s_cselect_b32 s55, 0x543fc00, s55
    s_add_u32 s50, s50, s47
    s_max_i32 s47, s50, 0
    s_lshl_b32 s41, s47, 15
    s_lshl_b32 s46, s47, 10
    s_sub_u32 s46, s55, s46
    s_cmp_eq_u32 s36, 17
    s_cselect_b32 s49, s87, 0x10000
    s_add_u32 s90, s90, s49
    s_and_b32 s49, s90, 0xffffffff
    s_bitcmp1_b64 s[24:25], s36
    s_cselect_b32 s44, s49, 0x5e00000
    s_bitcmp1_b64 s[26:27], s36
    s_cselect_b64 s[62:63], 0, -1
    v_fmac_f32 v44, v112, v100
    v_fmac_f32 v45, v112, v101
    v_fmac_f32 v46, v112, v102
    v_fmac_f32 v47, v112, v103
    v_fmac_f32 v48, v113, v100
    v_fmac_f32 v49, v113, v101
    v_fmac_f32 v50, v113, v102
    v_fmac_f32 v51, v113, v103
    v_fmac_f32 v52, v112, v104
    v_fmac_f32 v53, v112, v105
    v_fmac_f32 v54, v112, v106
    v_fmac_f32 v55, v112, v107
    v_fmac_f32 v56, v113, v104
    v_fmac_f32 v57, v113, v105
    v_fmac_f32 v58, v113, v106
    v_fmac_f32 v59, v113, v107
    v_fmac_f32 v60, v112, v108
    v_fmac_f32 v61, v112, v109
    v_fmac_f32 v62, v112, v110
    v_fmac_f32 v63, v112, v111
    v_fmac_f32 v64, v113, v108
    v_fmac_f32 v65, v113, v109
    v_fmac_f32 v66, v113, v110
    v_fmac_f32 v67, v113, v111
    s_waitcnt vmcnt(0) lgkmcnt(0)
    s_barrier
    ds_read_b128 v[68:71], v2 offset:0
    ds_read_b128 v[72:75], v2 offset:2048
    ds_read_b128 v[76:79], v3 offset:0
    ds_read_b128 v[80:83], v3 offset:2048
    s_mov_b32 s36, 1
    s_waitcnt lgkmcnt(0)
    s_nop 7
L_q_b0:
    s_waitcnt lgkmcnt(2)
    v_mfma_f32_16x16x32_bf16 v[20:23], a[0:3], v[68:71], 0
    ds_read_b128 v[84:87], v2 offset:4096
    v_mul_f32 v44, v44, v114
    v_mfma_f32_16x16x32_bf16 v[24:27], a[0:3], v[72:75], 0
    v_mul_f32 v45, v45, v114
    v_mul_f32 v46, v46, v114
    v_mfma_f32_16x16x32_bf16 v[32:35], a[4:7], v[72:75], 0
    v_mul_f32 v47, v47, v114
    v_cvt_pk_bf16_f32 v44, v44, v45
    v_mfma_f32_16x16x32_bf16 v[28:31], a[4:7], v[68:71], 0
    ds_read_b128 v[88:91], v2 offset:6144
    v_cvt_pk_bf16_f32 v45, v46, v47
    v_mfma_f32_16x16x32_bf16 v[36:39], a[8:11], v[68:71], 0
    ds_write_b64 v7, v[44:45] offset:12288
    v_mfma_f32_16x16x32_bf16 v[40:43], a[8:11], v[72:75], 0
    s_waitcnt lgkmcnt(3)
    v_mul_f32 v48, v48, v115
    v_mul_f32 v49, v49, v115
    v_mfma_f32_16x16x32_bf16 v[20:23], a[12:15], v[76:79], v[20:23]
    ds_read_b128 v[92:95], v3 offset:4096
    v_mul_f32 v50, v50, v115
    v_mfma_f32_16x16x32_bf16 v[24:27], a[12:15], v[80:83], v[24:27]
    v_mul_f32 v51, v51, v115
    v_cvt_pk_bf16_f32 v48, v48, v49
    v_mfma_f32_16x16x32_bf16 v[32:35], a[16:19], v[80:83], v[32:35]
    v_cvt_pk_bf16_f32 v49, v50, v51
    v_mfma_f32_16x16x32_bf16 v[28:31], a[16:19], v[76:79], v[28:31]
    ds_read_b128 v[96:99], v3 offset:6144
    v_mfma_f32_16x16x32_bf16 v[36:39], a[20:23], v[76:79], v[36:39]
    ds_write_b64 v7, v[48:49] offset:18432
    v_mfma_f32_16x16x32_bf16 v[40:43], a[20:23], v[80:83], v[40:43]
    s_waitcnt lgkmcnt(4)
    v_mul_f32 v52, v52, v114
    v_mul_f32 v53, v53, v114
    v_mfma_f32_16x16x32_bf16 v[20:23], a[24:27], v[84:87], v[20:23]
    ds_read_b128 v[68:71], v2 offset:8192
    v_mul_f32 v54, v54, v114
    v_mfma_f32_16x16x32_bf16 v[24:27], a[24:27], v[88:91], v[24:27]
    v_mul_f32 v55, v55, v114
    v_cvt_pk_bf16_f32 v52, v52, v53
    v_mfma_f32_16x16x32_bf16 v[32:35], a[28:31], v[88:91], v[32:35]
    v_cvt_pk_bf16_f32 v53, v54, v55
    v_mfma_f32_16x16x32_bf16 v[28:31], a[28:31], v[84:87], v[28:31]
    ds_read_b128 v[72:75], v2 offset:10240
    v_mfma_f32_16x16x32_bf16 v[36:39], a[32:35], v[84:87], v[36:39]
    ds_write_b64 v7, v[52:53] offset:13312
    v_mfma_f32_16x16x32_bf16 v[40:43], a[32:35], v[88:91], v[40:43]
    s_waitcnt lgkmcnt(4)
    v_mul_f32 v56, v56, v115
    v_mul_f32 v57, v57, v115
    v_mfma_f32_16x16x32_bf16 v[20:23], a[36:39], v[92:95], v[20:23]
    ds_read_b128 v[76:79], v3 offset:8192
    v_mul_f32 v58, v58, v115
    v_mfma_f32_16x16x32_bf16 v[24:27], a[36:39], v[96:99], v[24:27]
    v_mul_f32 v59, v59, v115
    v_cvt_pk_bf16_f32 v56, v56, v57
    v_mfma_f32_16x16x32_bf16 v[32:35], a[40:43], v[96:99], v[32:35]
    v_cvt_pk_bf16_f32 v57, v58, v59
    v_mfma_f32_16x16x32_bf16 v[28:31], a[40:43], v[92:95], v[28:31]
    ds_read_b128 v[80:83], v3 offset:10240
    v_mfma_f32_16x16x32_bf16 v[36:39], a[44:47], v[92:95], v[36:39]
    ds_write_b64 v7, v[56:57] offset:19456
    v_mfma_f32_16x16x32_bf16 v[40:43], a[44:47], v[96:99], v[40:43]
    s_waitcnt lgkmcnt(4)
    v_mul_f32 v60, v60, v114
    v_mul_f32 v61, v61, v114
    v_mfma_f32_16x16x32_bf16 v[20:23], a[48:51], v[68:71], v[20:23]
    s_waitcnt vmcnt(1)
    ds_read_b128 v[84:87], v2 offset:12288
    v_cmp_ne_u32 vcc, 0, v116
    v_mfma_f32_16x16x32_bf16 v[24:27], a[48:51], v[72:75], v[24:27]
    v_mul_f32 v62, v62, v114
    v_mul_f32 v63, v63, v114
    v_mfma_f32_16x16x32_bf16 v[32:35], a[52:55], v[72:75], v[32:35]
    s_cbranch_vccnz L_spin3
L_back4:
    v_cvt_pk_bf16_f32 v60, v60, v61
    v_cvt_pk_bf16_f32 v61, v62, v63
    v_mfma_f32_16x16x32_bf16 v[28:31], a[52:55], v[68:71], v[28:31]
    ds_read_b128 v[88:91], v2 offset:14336
    v_mfma_f32_16x16x32_bf16 v[36:39], a[56:59], v[68:71], v[36:39]
    ds_write_b64 v8, v[60:61] offset:14336
    v_mfma_f32_16x16x32_bf16 v[40:43], a[56:59], v[72:75], v[40:43]
    s_waitcnt lgkmcnt(4)
    v_mul_f32 v64, v64, v115
    v_mul_f32 v65, v65, v115
    v_mfma_f32_16x16x32_bf16 v[20:23], a[60:63], v[76:79], v[20:23]
    ds_read_b128 v[92:95], v3 offset:12288
    v_mul_f32 v66, v66, v115
    v_mfma_f32_16x16x32_bf16 v[24:27], a[60:63], v[80:83], v[24:27]
    v_mul_f32 v67, v67, v115
    v_cvt_pk_bf16_f32 v64, v64, v65
    v_mfma_f32_16x16x32_bf16 v[32:35], a[64:67], v[80:83], v[32:35]
    v_cvt_pk_bf16_f32 v65, v66, v67
    v_mfma_f32_16x16x32_bf16 v[28:31], a[64:67], v[76:79], v[28:31]
    ds_read_b128 v[96:99], v3 offset:14336
    v_mfma_f32_16x16x32_bf16 v[36:39], a[68:71], v[76:79], v[36:39]
    ds_write_b64 v8, v[64:65] offset:20480
    v_mfma_f32_16x16x32_bf16 v[40:43], a[68:71], v[80:83], v[40:43]
    s_waitcnt lgkmcnt(4)
    s_waitcnt lgkmcnt(0)
    s_barrier
    v_mfma_f32_16x16x32_bf16 v[20:23], a[72:75], v[84:87], v[20:23]
    ds_read_b128 v[68:71], v2 offset:16384
    v_mfma_f32_16x16x32_bf16 v[24:27], a[72:75], v[88:91], v[24:27]
    ds_read_b128 v[44:47], v9 offset:6144
    v_mfma_f32_16x16x32_bf16 v[32:35], a[76:79], v[88:91], v[32:35]
    ds_read_b128 v[48:51], v9 offset:13312
    v_mfma_f32_16x16x32_bf16 v[28:31], a[76:79], v[84:87], v[28:31]
    ds_read_b128 v[72:75], v2 offset:18432
    v_mfma_f32_16x16x32_bf16 v[36:39], a[80:83], v[84:87], v[36:39]
    ds_read_b128 v[52:55], v9 offset:7168
    s_add_u32 m0, s43, 98304
    v_mfma_f32_16x16x32_bf16 v[40:43], a[80:83], v[88:91], v[40:43]
    s_waitcnt lgkmcnt(6)
    ds_read_b64_tr_b16 v[56:57], v9 offset:14336
    v_mfma_f32_16x16x32_bf16 v[20:23], a[84:87], v[92:95], v[20:23]
    ds_read_b128 v[76:79], v3 offset:16384
    v_mfma_f32_16x16x32_bf16 v[24:27], a[84:87], v[96:99], v[24:27]
    buffer_load_dwordx4 v6, s[8:11], s41 offen offset:0 sc1 lds
    v_mfma_f32_16x16x32_bf16 v[32:35], a[88:91], v[96:99], v[32:35]
    s_add_u32 m0, s43, 102272
    ds_read_b64_tr_b16 v[58:59], v9 offset:8192
    s_waitcnt lgkmcnt(3)
    v_mfma_f32_16x16x32_bf16 v[28:31], a[88:91], v[92:95], v[28:31]
    ds_read_b128 v[80:83], v3 offset:18432
    v_mfma_f32_16x16x32_bf16 v[64:67], v[48:51], v[44:47], 0
    ds_read_b64_tr_b16 v[60:61], v9 offset:14344
    v_mfma_f32_16x16x32_bf16 v[118:121], v[52:55], v[44:47], 0
    ds_read_b64_tr_b16 v[62:63], v9 offset:8200
    v_mfma_f32_16x16x32_bf16 v[36:39], a[92:95], v[92:95], v[36:39]
    v_mfma_f32_16x16x32_bf16 v[40:43], a[92:95], v[96:99], v[40:43]
    s_waitcnt lgkmcnt(7)
    v_cndmask_b32 v64, v64, v65, s[56:57]
    v_cndmask_b32 v66, v66, v67, s[56:57]
    v_mfma_f32_16x16x32_bf16 v[20:23], a[96:99], v[68:71], v[20:23]
    ds_read_b128 v[84:87], v2 offset:20480
    v_cndmask_b32 v118, v118, v119, s[56:57]
    v_mfma_f32_16x16x32_bf16 v[24:27], a[96:99], v[72:75], v[24:27]
    buffer_load_dwordx4 v6, s[8:11], s41 offen offset:128 sc1 lds
    v_mfma_f32_16x16x32_bf16 v[32:35], a[100:103], v[72:75], v[32:35]
    s_add_u32 m0, s43, 106240
    v_cndmask_b32 v120, v120, v121, s[56:57]
    v_cndmask_b32 v64, v18, v64, s[62:63]
    v_mfma_f32_16x16x32_bf16 v[28:31], a[100:103], v[68:71], v[28:31]
    ds_read_b128 v[88:91], v2 offset:22528
    v_cndmask_b32 v66, v18, v66, s[62:63]
    v_mfma_f32_16x16x32_bf16 v[36:39], a[104:107], v[68:71], v[36:39]
    v_cndmask_b32 v46, v64, v118, s[58:59]
    v_cndmask_b32 v47, v66, v120, s[60:61]
    v_mfma_f32_16x16x32_bf16 v[40:43], a[104:107], v[72:75], v[40:43]
    s_waitcnt lgkmcnt(4)
    v_max_f32 v44, v46, v47
    v_mov_b32 v45, v44
    v_mfma_f32_16x16x32_bf16 v[20:23], a[108:111], v[76:79], v[20:23]
    ds_read_b128 v[92:95], v3 offset:20480
    v_mfma_f32_16x16x32_bf16 v[24:27], a[108:111], v[80:83], v[24:27]
    buffer_load_dwordx4 v6, s[8:11], s41 offen offset:256 sc1 lds
    v_mfma_f32_16x16x32_bf16 v[32:35], a[112:115], v[80:83], v[32:35]
    s_add_u32 m0, s43, 110208
    v_permlane16_swap_b32 v44, v45
    v_mfma_f32_16x16x32_bf16 v[28:31], a[112:115], v[76:79], v[28:31]
    ds_read_b128 v[96:99], v3 offset:22528
    v_max_f32 v44, v44, v45
    v_mfma_f32_16x16x32_bf16 v[36:39], a[116:119], v[76:79], v[36:39]
    v_mov_b32 v45, v44
    v_mfma_f32_16x16x32_bf16 v[40:43], a[116:119], v[80:83], v[40:43]
    s_waitcnt lgkmcnt(2)
    v_permlane32_swap_b32 v44, v45
    v_mfma_f32_16x16x32_bf16 v[20:23], a[120:123], v[84:87], v[20:23]
    ds_read_b128 v[68:71], v2 offset:24576
    v_max_f32 v44, v44, v45
    v_mfma_f32_16x16x32_bf16 v[24:27], a[120:123], v[88:91], v[24:27]
    buffer_load_dwordx4 v6, s[8:11], s41 offen offset:384 sc1 lds
    v_mfma_f32_16x16x32_bf16 v[32:35], a[124:127], v[88:91], v[32:35]
    s_add_u32 m0, s43, 114176
    v_mul_f32 v44, s86, v44
    v_fma_f32 v46, v46, s86, -v44
    v_mfma_f32_16x16x32_bf16 v[28:31], a[124:127], v[84:87], v[28:31]
    ds_read_b128 v[72:75], v2 offset:26624
    v_fma_f32 v47, v47, s86, -v44
    v_mfma_f32_16x16x32_bf16 v[36:39], a[128:131], v[84:87], v[36:39]
    v_exp_f32 v46, v46
    v_mfma_f32_16x16x32_bf16 v[40:43], a[128:131], v[88:91], v[40:43]
    s_waitcnt lgkmcnt(2)
    v_exp_f32 v47, v47
    v_mfma_f32_16x16x32_bf16 v[20:23], a[132:135], v[92:95], v[20:23]
    ds_read_b128 v[76:79], v3 offset:24576
    v_cvt_pk_bf16_f32 v52, v46, v47
    v_mfma_f32_16x16x32_bf16 v[24:27], a[132:135], v[96:99], v[24:27]
    buffer_load_dwordx4 v6, s[8:11], s41 offen offset:512 sc1 lds
    v_mfma_f32_16x16x32_bf16 v[32:35], a[136:139], v[96:99], v[32:35]
    s_add_u32 m0, s43, 118144
    v_perm_b32 v48, v52, v52, v14
    v_perm_b32 v49, v52, v52, v15
    v_mfma_f32_16x16x32_bf16 v[28:31], a[136:139], v[92:95], v[28:31]
    ds_read_b128 v[80:83], v3 offset:26624
    v_perm_b32 v50, v52, v52, v16
    v_mfma_f32_16x16x32_bf16 v[36:39], a[140:143], v[92:95], v[36:39]
    v_perm_b32 v51, v52, v52, v17
    v_add_f32 v44, v46, v47
    v_mfma_f32_16x16x32_bf16 v[40:43], a[140:143], v[96:99], v[40:43]
    s_waitcnt lgkmcnt(2)
    v_mov_b32 v45, v44
    s_waitcnt lgkmcnt(8)
    v_mfma_f32_16x16x32_bf16 v[20:23], a[144:147], v[68:71], v[20:23]
    ds_read_b128 v[84:87], v2 offset:28672
    v_mfma_f32_16x16x32_bf16 v[64:67], v[56:59], v[48:51], 0
    v_mfma_f32_16x16x32_bf16 v[118:121], v[60:63], v[48:51], 0
    v_permlane16_swap_b32 v44, v45
    v_mfma_f32_16x16x32_bf16 v[24:27], a[144:147], v[72:75], v[24:27]
    buffer_load_dwordx4 v6, s[8:11], s41 offen offset:640 sc1 lds
    v_mfma_f32_16x16x32_bf16 v[32:35], a[148:151], v[72:75], v[32:35]
    s_add_u32 m0, s43, 122112
    v_add_f32 v44, v44, v45
    v_mov_b32 v45, v44
    v_mfma_f32_16x16x32_bf16 v[28:31], a[148:151], v[68:71], v[28:31]
    ds_read_b128 v[88:91], v2 offset:30720
    v_mfma_f32_16x16x32_bf16 v[36:39], a[152:155], v[68:71], v[36:39]
    v_permlane32_swap_b32 v44, v45
    v_mfma_f32_16x16x32_bf16 v[40:43], a[152:155], v[72:75], v[40:43]
    s_waitcnt lgkmcnt(2)
    v_add_f32 v44, v44, v45
    v_mfma_f32_16x16x32_bf16 v[20:23], a[156:159], v[76:79], v[20:23]
    ds_read_b128 v[92:95], v3 offset:28672
    v_mfma_f32_16x16x32_bf16 v[24:27], a[156:159], v[80:83], v[24:27]
    buffer_load_dwordx4 v6, s[8:11], s41 offen offset:768 sc1 lds
    v_mfma_f32_16x16x32_bf16 v[32:35], a[160:163], v[80:83], v[32:35]
    s_add_u32 m0, s43, 126080
    v_rcp_f32 v44, v44
    v_mfma_f32_16x16x32_bf16 v[28:31], a[160:163], v[76:79], v[28:31]
    ds_read_b128 v[96:99], v3 offset:30720
    v_mul_f32 v64, v64, v44
    v_mfma_f32_16x16x32_bf16 v[36:39], a[164:167], v[76:79], v[36:39]
    v_mul_f32 v65, v65, v44
    v_mul_f32 v66, v66, v44
    v_mfma_f32_16x16x32_bf16 v[40:43], a[164:167], v[80:83], v[40:43]
    s_waitcnt lgkmcnt(2)
    v_mul_f32 v67, v67, v44
    v_cvt_pk_bf16_f32 v52, v64, v65
    v_mfma_f32_16x16x32_bf16 v[20:23], a[168:171], v[84:87], v[20:23]
    ds_read_b128 v[68:71], v2 offset:32768
    v_cvt_pk_bf16_f32 v53, v66, v67
    v_mfma_f32_16x16x32_bf16 v[24:27], a[168:171], v[88:91], v[24:27]
    buffer_load_dwordx4 v6, s[8:11], s41 offen offset:896 sc1 lds
    v_mfma_f32_16x16x32_bf16 v[32:35], a[172:175], v[88:91], v[32:35]
    s_add_u32 m0, s43, 130048
    v_mul_f32 v118, v118, v44
    v_mul_f32 v119, v119, v44
    v_mfma_f32_16x16x32_bf16 v[28:31], a[172:175], v[84:87], v[28:31]
    ds_read_b128 v[72:75], v2 offset:34816
    v_mul_f32 v120, v120, v44
    v_mfma_f32_16x16x32_bf16 v[36:39], a[176:179], v[84:87], v[36:39]
    v_mul_f32 v121, v121, v44
    v_cvt_pk_bf16_f32 v54, v118, v119
    v_mfma_f32_16x16x32_bf16 v[40:43], a[176:179], v[88:91], v[40:43]
    s_waitcnt lgkmcnt(2)
    v_cvt_pk_bf16_f32 v55, v120, v121
    v_mfma_f32_16x16x32_bf16 v[20:23], a[180:183], v[92:95], v[20:23]
    ds_read_b128 v[76:79], v3 offset:32768
    v_mfma_f32_16x16x32_bf16 v[24:27], a[180:183], v[96:99], v[24:27]
    buffer_load_dwordx4 v6, s[8:11], s41 offen offset:1024 sc1 lds
    v_mfma_f32_16x16x32_bf16 v[32:35], a[184:187], v[96:99], v[32:35]
    buffer_store_dwordx4 v[52:55], v1, s[16:19], s44 offen sc1
    v_mfma_f32_16x16x32_bf16 v[28:31], a[184:187], v[92:95], v[28:31]
    s_add_u32 m0, s43, 134016
    ds_read_b128 v[80:83], v3 offset:34816
    s_cmp_eq_u32 s36, 17
    v_mfma_f32_16x16x32_bf16 v[36:39], a[188:191], v[92:95], v[36:39]
    s_cselect_b32 s49, s87, 0x10000
    ds_read_b64 v[56:57], v13 offset:0
    s_add_u32 s90, s90, s49
    v_mfma_f32_16x16x32_bf16 v[40:43], a[188:191], v[96:99], v[40:43]
    s_waitcnt lgkmcnt(3)
    ds_read_b64 v[58:59], v13 offset:128
    s_and_b32 s49, s90, 0xffffffff
    v_mfma_f32_16x16x32_bf16 v[20:23], a[192:195], v[68:71], v[20:23]
    s_bitcmp1_b64 s[24:25], s36
    ds_read_b128 v[84:87], v2 offset:36864
    s_cselect_b32 s44, s49, 0x5e00000
    v_mfma_f32_16x16x32_bf16 v[24:27], a[192:195], v[72:75], v[24:27]
    buffer_load_dwordx4 v6, s[8:11], s41 offen offset:1152 sc1 lds
    v_mfma_f32_16x16x32_bf16 v[32:35], a[196:199], v[72:75], v[32:35]
    s_add_u32 m0, s43, 137984
    ds_read_b64 v[60:61], v13 offset:256
    s_bitcmp1_b64 s[26:27], s36
    v_mfma_f32_16x16x32_bf16 v[28:31], a[196:199], v[68:71], v[28:31]
    s_cselect_b64 s[62:63], 0, -1
    ds_read_b128 v[88:91], v2 offset:38912
    v_mfma_f32_16x16x32_bf16 v[36:39], a[200:203], v[68:71], v[36:39]
    ds_read_b64 v[62:63], v13 offset:384
    v_mfma_f32_16x16x32_bf16 v[40:43], a[200:203], v[72:75], v[40:43]
    s_waitcnt lgkmcnt(6)
    v_mfma_f32_16x16x32_bf16 v[20:23], a[204:207], v[76:79], v[20:23]
    ds_read_b128 v[92:95], v3 offset:36864
    v_mfma_f32_16x16x32_bf16 v[24:27], a[204:207], v[80:83], v[24:27]
    buffer_load_dwordx4 v6, s[8:11], s41 offen offset:1280 sc1 lds
    v_mfma_f32_16x16x32_bf16 v[32:35], a[208:211], v[80:83], v[32:35]
    s_add_u32 m0, s43, 141952
    v_mfma_f32_16x16x32_bf16 v[28:31], a[208:211], v[76:79], v[28:31]
    s_waitcnt lgkmcnt(1)
    ds_read_b128 v[96:99], v3 offset:38912
    v_add_f32 v64, v60, v62
    v_mfma_f32_16x16x32_bf16 v[36:39], a[212:215], v[76:79], v[36:39]
    v_add_f32 v65, v61, v63
    v_add_f32 v56, v56, v58
    v_mfma_f32_16x16x32_bf16 v[40:43], a[212:215], v[80:83], v[40:43]
    s_waitcnt lgkmcnt(3)
    v_add_f32 v57, v57, v59
    v_add_f32 v56, v56, v64
    v_mfma_f32_16x16x32_bf16 v[20:23], a[216:219], v[84:87], v[20:23]
    ds_read_b128 v[68:71], v2 offset:40960
    v_add_f32 v57, v57, v65
    v_mfma_f32_16x16x32_bf16 v[24:27], a[216:219], v[88:91], v[24:27]
    buffer_load_dwordx4 v6, s[8:11], s41 offen offset:1408 sc1 lds
    v_mfma_f32_16x16x32_bf16 v[32:35], a[220:223], v[88:91], v[32:35]
    s_add_u32 m0, s43, 145920
    v_mov_b32 v64, v56
    v_mov_b32 v65, v57
    v_mfma_f32_16x16x32_bf16 v[28:31], a[220:223], v[84:87], v[28:31]
    ds_read_b128 v[72:75], v2 offset:43008
    v_mfma_f32_16x16x32_bf16 v[36:39], a[224:227], v[84:87], v[36:39]
    v_permlane32_swap_b32 v56, v64
    v_mfma_f32_16x16x32_bf16 v[40:43], a[224:227], v[88:91], v[40:43]
    s_waitcnt lgkmcnt(2)
    v_permlane32_swap_b32 v57, v65
    v_mfma_f32_16x16x32_bf16 v[20:23], a[228:231], v[92:95], v[20:23]
    ds_read_b128 v[76:79], v3 offset:40960
    v_add_f32 v56, v56, v64
    v_mfma_f32_16x16x32_bf16 v[24:27], a[228:231], v[96:99], v[24:27]
    buffer_load_dwordx4 v6, s[8:11], s41 offen offset:1536 sc1 lds
    v_mfma_f32_16x16x32_bf16 v[32:35], a[232:235], v[96:99], v[32:35]
    s_add_u32 m0, s43, 149888
    v_add_f32 v57, v57, v65
    v_mul_f32 v112, 0xba800000, v56
    v_mfma_f32_16x16x32_bf16 v[28:31], a[232:235], v[92:95], v[28:31]
    ds_read_b128 v[80:83], v3 offset:43008
    v_mul_f32 v57, 0x3a800000, v57
    v_mfma_f32_16x16x32_bf16 v[36:39], a[236:239], v[92:95], v[36:39]
    v_fma_f32 v57, -v112, v112, v57
    v_mov_b32 v113, v112
    v_mfma_f32_16x16x32_bf16 v[40:43], a[236:239], v[96:99], v[40:43]
    s_waitcnt lgkmcnt(2)
    v_max_f32 v57, 0, v57
    v_add_f32 v57, 0x3727c5ac, v57
    v_mfma_f32_16x16x32_bf16 v[20:23], a[240:243], v[68:71], v[20:23]
    ds_read_b128 v[84:87], v2 offset:45056
    v_mfma_f32_16x16x32_bf16 v[24:27], a[240:243], v[72:75], v[24:27]
    buffer_load_dwordx4 v6, s[8:11], s41 offen offset:1664 sc1 lds
    v_mfma_f32_16x16x32_bf16 v[32:35], a[244:247], v[72:75], v[32:35]
    s_add_u32 m0, s43, 153856
    v_rsq_f32 v114, v57
    v_mfma_f32_16x16x32_bf16 v[28:31], a[244:247], v[68:71], v[28:31]
    ds_read_b128 v[88:91], v2 offset:47104
    v_mfma_f32_16x16x32_bf16 v[36:39], a[248:251], v[68:71], v[36:39]
    v_permlane16_swap_b32 v112, v113
    v_mfma_f32_16x16x32_bf16 v[40:43], a[248:251], v[72:75], v[40:43]
    s_waitcnt lgkmcnt(2)
    v_mov_b32 v115, v114
    v_fmac_f32 v24, v113, v100
    v_mfma_f32_16x16x32_bf16 v[20:23], a[252:255], v[76:79], v[20:23]
    ds_read_b128 v[92:95], v3 offset:45056
    v_fmac_f32 v28, v112, v104
    v_mfma_f32_16x16x32_bf16 v[24:27], a[252:255], v[80:83], v[24:27]
    buffer_load_dwordx4 v6, s[8:11], s41 offen offset:1792 sc1 lds
    v_mfma_f32_16x16x32_bf16 v[32:35], v[128:131], v[80:83], v[32:35]
    s_add_u32 m0, s43, 157824
    v_permlane16_swap_b32 v114, v115
    v_mfma_f32_16x16x32_bf16 v[28:31], v[128:131], v[76:79], v[28:31]
    ds_read_b128 v[96:99], v3 offset:47104
    v_fmac_f32 v20, v112, v100
    v_mfma_f32_16x16x32_bf16 v[36:39], v[132:135], v[76:79], v[36:39]
    v_fmac_f32 v21, v112, v101
    v_fmac_f32 v22, v112, v102
    v_mfma_f32_16x16x32_bf16 v[40:43], v[132:135], v[80:83], v[40:43]
    s_waitcnt lgkmcnt(2)
    v_fmac_f32 v25, v113, v101
    v_fmac_f32 v26, v113, v102
    v_mfma_f32_16x16x32_bf16 v[20:23], v[136:139], v[84:87], v[20:23]
    ds_read_b128 v[68:71], v2 offset:49152
    v_fmac_f32 v29, v112, v105
    v_mfma_f32_16x16x32_bf16 v[24:27], v[136:139], v[88:91], v[24:27]
    buffer_load_dwordx4 v6, s[8:11], s41 offen offset:1920 sc1 lds
    v_mfma_f32_16x16x32_bf16 v[32:35], v[140:143], v[88:91], v[32:35]
    s_add_u32 m0, s52, 92160
    v_fmac_f32 v23, v112, v103
    v_fmac_f32 v36, v112, v108
    v_mfma_f32_16x16x32_bf16 v[28:31], v[140:143], v[84:87], v[28:31]
    ds_read_b128 v[72:75], v2 offset:51200
    v_fmac_f32 v27, v113, v103
    v_mfma_f32_16x16x32_bf16 v[36:39], v[144:147], v[84:87], v[36:39]
    v_fmac_f32 v32, v113, v104
    v_fmac_f32 v33, v113, v105
    v_mfma_f32_16x16x32_bf16 v[40:43], v[144:147], v[88:91], v[40:43]
    s_waitcnt lgkmcnt(2)
    v_fmac_f32 v30, v112, v106
    v_fmac_f32 v31, v112, v107
    v_mfma_f32_16x16x32_bf16 v[20:23], v[148:151], v[92:95], v[20:23]
    ds_read_b128 v[76:79], v3 offset:49152
    v_fmac_f32 v34, v113, v106
    v_mfma_f32_16x16x32_bf16 v[24:27], v[148:151], v[96:99], v[24:27]
    buffer_load_dwordx4 v1, s[16:19], s46 offen sc1 lds
    v_mfma_f32_16x16x32_bf16 v[32:35], v[152:155], v[96:99], v[32:35]
    s_cmp_eq_u32 s36, s97
    v_med3_i32 v117, s45, 0, v12
    v_add_u32 v117, v117, v11
    v_mfma_f32_16x16x32_bf16 v[28:31], v[152:155], v[92:95], v[28:31]
    s_cselect_b32 s47, 31, -2
    ds_read_b128 v[80:83], v3 offset:51200
    v_fmac_f32 v40, v113, v108
    v_mfma_f32_16x16x32_bf16 v[36:39], v[156:159], v[92:95], v[36:39]
    s_cselect_b64 s[8:9], s[88:89], s[8:9]
    v_fmac_f32 v35, v113, v107
    s_cselect_b32 s55, 0x543fc00, s55
    v_mfma_f32_16x16x32_bf16 v[40:43], v[156:159], v[96:99], v[40:43]
    s_waitcnt lgkmcnt(2)
    s_add_u32 s45, s45, 65536
    s_add_u32 s50, s50, s47
    v_mfma_f32_16x16x32_bf16 v[20:23], v[160:163], v[68:71], v[20:23]
    s_max_i32 s47, s50, 0
    ds_read_b128 v[84:87], v2 offset:53248
    v_fmac_f32 v37, v112, v109
    v_mfma_f32_16x16x32_bf16 v[24:27], v[160:163], v[72:75], v[24:27]
    buffer_load_dword v116, v117, s[16:19], 0 offen sc1
    v_mfma_f32_16x16x32_bf16 v[32:35], v[164:167], v[72:75], v[32:35]
    s_lshl_b32 s41, s47, 15
    v_fmac_f32 v38, v112, v110
    v_fmac_f32 v39, v112, v111
    v_mfma_f32_16x16x32_bf16 v[28:31], v[164:167], v[68:71], v[28:31]
    s_lshl_b32 s46, s47, 10
    ds_read_b128 v[88:91], v2 offset:55296
    v_fmac_f32 v41, v113, v109
    v_mfma_f32_16x16x32_bf16 v[36:39], v[168:171], v[68:71], v[36:39]
    s_sub_u32 s46, s55, s46
    v_mfma_f32_16x16x32_bf16 v[40:43], v[168:171], v[72:75], v[40:43]
    s_waitcnt lgkmcnt(2)
    v_mfma_f32_16x16x32_bf16 v[20:23], v[172:175], v[76:79], v[20:23]
    ds_read_b128 v[92:95], v3 offset:53248
    v_mfma_f32_16x16x32_bf16 v[24:27], v[172:175], v[80:83], v[24:27]
    v_mfma_f32_16x16x32_bf16 v[32:35], v[176:179], v[80:83], v[32:35]
    v_fmac_f32 v42, v113, v110
    v_fmac_f32 v43, v113, v111
    v_mfma_f32_16x16x32_bf16 v[28:31], v[176:179], v[76:79], v[28:31]
    ds_read_b128 v[96:99], v3 offset:55296
    v_mfma_f32_16x16x32_bf16 v[36:39], v[180:183], v[76:79], v[36:39]
    v_mfma_f32_16x16x32_bf16 v[40:43], v[180:183], v[80:83], v[40:43]
    s_waitcnt lgkmcnt(2)
    v_mfma_f32_16x16x32_bf16 v[20:23], v[184:187], v[84:87], v[20:23]
    ds_read_b128 v[68:71], v2 offset:57344
    v_mfma_f32_16x16x32_bf16 v[24:27], v[184:187], v[88:91], v[24:27]
    v_mfma_f32_16x16x32_bf16 v[32:35], v[188:191], v[88:91], v[32:35]
    v_mfma_f32_16x16x32_bf16 v[28:31], v[188:191], v[84:87], v[28:31]
    ds_read_b128 v[72:75], v2 offset:59392
    v_mfma_f32_16x16x32_bf16 v[36:39], v[192:195], v[84:87], v[36:39]
    v_mfma_f32_16x16x32_bf16 v[40:43], v[192:195], v[88:91], v[40:43]
    s_waitcnt lgkmcnt(2)
    v_mfma_f32_16x16x32_bf16 v[20:23], v[196:199], v[92:95], v[20:23]
    ds_read_b128 v[76:79], v3 offset:57344
    v_mfma_f32_16x16x32_bf16 v[24:27], v[196:199], v[96:99], v[24:27]
    v_mfma_f32_16x16x32_bf16 v[32:35], v[200:203], v[96:99], v[32:35]
    v_mfma_f32_16x16x32_bf16 v[28:31], v[200:203], v[92:95], v[28:31]
    ds_read_b128 v[80:83], v3 offset:59392
    v_mfma_f32_16x16x32_bf16 v[36:39], v[204:207], v[92:95], v[36:39]
    s_waitcnt vmcnt(9)
    s_barrier
    v_mfma_f32_16x16x32_bf16 v[40:43], v[204:207], v[96:99], v[40:43]
    s_waitcnt lgkmcnt(2)
    v_mfma_f32_16x16x32_bf16 v[20:23], v[208:211], v[68:71], v[20:23]
    ds_read_b128 v[84:87], v2 offset:61440
    v_mfma_f32_16x16x32_bf16 v[24:27], v[208:211], v[72:75], v[24:27]
    buffer_store_dword v124, v124, s[16:19], s91 offen sc1
    v_mfma_f32_16x16x32_bf16 v[32:35], v[212:215], v[72:75], v[32:35]
    s_add_u32 s91, s91, 65536
    v_mfma_f32_16x16x32_bf16 v[28:31], v[212:215], v[68:71], v[28:31]
    ds_read_b128 v[88:91], v2 offset:63488
    v_mfma_f32_16x16x32_bf16 v[36:39], v[216:219], v[68:71], v[36:39]
    v_mfma_f32_16x16x32_bf16 v[40:43], v[216:219], v[72:75], v[40:43]
    s_waitcnt lgkmcnt(2)
    v_mfma_f32_16x16x32_bf16 v[20:23], v[220:223], v[76:79], v[20:23]
    ds_read_b128 v[92:95], v3 offset:61440
    v_mfma_f32_16x16x32_bf16 v[24:27], v[220:223], v[80:83], v[24:27]
    v_mfma_f32_16x16x32_bf16 v[32:35], v[224:227], v[80:83], v[32:35]
    v_mfma_f32_16x16x32_bf16 v[28:31], v[224:227], v[76:79], v[28:31]
    ds_read_b128 v[96:99], v3 offset:63488
    v_mfma_f32_16x16x32_bf16 v[36:39], v[228:231], v[76:79], v[36:39]
    v_mfma_f32_16x16x32_bf16 v[40:43], v[228:231], v[80:83], v[40:43]
    s_waitcnt lgkmcnt(2)
    v_mfma_f32_16x16x32_bf16 v[20:23], v[232:235], v[84:87], v[20:23]
    ds_read_b128 v[68:71], v4 offset:0
    v_mfma_f32_16x16x32_bf16 v[24:27], v[232:235], v[88:91], v[24:27]
    v_mfma_f32_16x16x32_bf16 v[32:35], v[236:239], v[88:91], v[32:35]
    v_mfma_f32_16x16x32_bf16 v[28:31], v[236:239], v[84:87], v[28:31]
    ds_read_b128 v[72:75], v4 offset:2048
    v_mfma_f32_16x16x32_bf16 v[36:39], v[240:243], v[84:87], v[36:39]
    v_mfma_f32_16x16x32_bf16 v[40:43], v[240:243], v[88:91], v[40:43]
    s_waitcnt lgkmcnt(2)
    v_mfma_f32_16x16x32_bf16 v[20:23], v[244:247], v[92:95], v[20:23]
    ds_read_b128 v[76:79], v5 offset:0
    v_mfma_f32_16x16x32_bf16 v[24:27], v[244:247], v[96:99], v[24:27]
    v_mfma_f32_16x16x32_bf16 v[32:35], v[248:251], v[96:99], v[32:35]
    v_mfma_f32_16x16x32_bf16 v[28:31], v[248:251], v[92:95], v[28:31]
    ds_read_b128 v[80:83], v5 offset:2048
    v_mfma_f32_16x16x32_bf16 v[36:39], v[252:255], v[92:95], v[36:39]
    v_mfma_f32_16x16x32_bf16 v[40:43], v[252:255], v[96:99], v[40:43]
    s_add_u32 s36, s36, 1
L_q_b1:
    s_waitcnt lgkmcnt(2)
    v_mfma_f32_16x16x32_bf16 v[44:47], a[0:3], v[68:71], 0
    ds_read_b128 v[84:87], v4 offset:4096
    v_mul_f32 v20, v20, v114
    v_mfma_f32_16x16x32_bf16 v[48:51], a[0:3], v[72:75], 0
    v_mul_f32 v21, v21, v114
    v_mul_f32 v22, v22, v114
    v_mfma_f32_16x16x32_bf16 v[56:59], a[4:7], v[72:75], 0
    v_mul_f32 v23, v23, v114
    v_cvt_pk_bf16_f32 v20, v20, v21
    v_mfma_f32_16x16x32_bf16 v[52:55], a[4:7], v[68:71], 0
    ds_read_b128 v[88:91], v4 offset:6144
    v_cvt_pk_bf16_f32 v21, v22, v23
    v_mfma_f32_16x16x32_bf16 v[60:63], a[8:11], v[68:71], 0
    ds_write_b64 v7, v[20:21] offset:0
    v_mfma_f32_16x16x32_bf16 v[64:67], a[8:11], v[72:75], 0
    s_waitcnt lgkmcnt(3)
    v_mul_f32 v24, v24, v115
    v_mul_f32 v25, v25, v115
    v_mfma_f32_16x16x32_bf16 v[44:47], a[12:15], v[76:79], v[44:47]
    ds_read_b128 v[92:95], v5 offset:4096
    v_mul_f32 v26, v26, v115
    v_mfma_f32_16x16x32_bf16 v[48:51], a[12:15], v[80:83], v[48:51]
    v_mul_f32 v27, v27, v115
    v_cvt_pk_bf16_f32 v24, v24, v25
    v_mfma_f32_16x16x32_bf16 v[56:59], a[16:19], v[80:83], v[56:59]
    v_cvt_pk_bf16_f32 v25, v26, v27
    v_mfma_f32_16x16x32_bf16 v[52:55], a[16:19], v[76:79], v[52:55]
    ds_read_b128 v[96:99], v5 offset:6144
    v_mfma_f32_16x16x32_bf16 v[60:63], a[20:23], v[76:79], v[60:63]
    ds_write_b64 v7, v[24:25] offset:6144
    v_mfma_f32_16x16x32_bf16 v[64:67], a[20:23], v[80:83], v[64:67]
    s_waitcnt lgkmcnt(4)
    v_mul_f32 v28, v28, v114
    v_mul_f32 v29, v29, v114
    v_mfma_f32_16x16x32_bf16 v[44:47], a[24:27], v[84:87], v[44:47]
    ds_read_b128 v[68:71], v4 offset:8192
    v_mul_f32 v30, v30, v114
    v_mfma_f32_16x16x32_bf16 v[48:51], a[24:27], v[88:91], v[48:51]
    v_mul_f32 v31, v31, v114
    v_cvt_pk_bf16_f32 v28, v28, v29
    v_mfma_f32_16x16x32_bf16 v[56:59], a[28:31], v[88:91], v[56:59]
    v_cvt_pk_bf16_f32 v29, v30, v31
    v_mfma_f32_16x16x32_bf16 v[52:55], a[28:31], v[84:87], v[52:55]
    ds_read_b128 v[72:75], v4 offset:10240
    v_mfma_f32_16x16x32_bf16 v[60:63], a[32:35], v[84:87], v[60:63]
    ds_write_b64 v7, v[28:29] offset:1024
    v_mfma_f32_16x16x32_bf16 v[64:67], a[32:35], v[88:91], v[64:67]
    s_waitcnt lgkmcnt(4)
    v_mul_f32 v32, v32, v115
    v_mul_f32 v33, v33, v115
    v_mfma_f32_16x16x32_bf16 v[44:47], a[36:39], v[92:95], v[44:47]
    ds_read_b128 v[76:79], v5 offset:8192
    v_mul_f32 v34, v34, v115
    v_mfma_f32_16x16x32_bf16 v[48:51], a[36:39], v[96:99], v[48:51]
    v_mul_f32 v35, v35, v115
    v_cvt_pk_bf16_f32 v32, v32, v33
    v_mfma_f32_16x16x32_bf16 v[56:59], a[40:43], v[96:99], v[56:59]
    v_cvt_pk_bf16_f32 v33, v34, v35
    v_mfma_f32_16x16x32_bf16 v[52:55], a[40:43], v[92:95], v[52:55]
    ds_read_b128 v[80:83], v5 offset:10240
    v_mfma_f32_16x16x32_bf16 v[60:63], a[44:47], v[92:95], v[60:63]
    ds_write_b64 v7, v[32:33] offset:7168
    v_mfma_f32_16x16x32_bf16 v[64:67], a[44:47], v[96:99], v[64:67]
    s_waitcnt lgkmcnt(4)
    v_mul_f32 v36, v36, v114
    v_mul_f32 v37, v37, v114
    v_mfma_f32_16x16x32_bf16 v[44:47], a[48:51], v[68:71], v[44:47]
    s_waitcnt vmcnt(1)
    ds_read_b128 v[84:87], v4 offset:12288
    v_cmp_ne_u32 vcc, 0, v116
    v_mfma_f32_16x16x32_bf16 v[48:51], a[48:51], v[72:75], v[48:51]
    v_mul_f32 v38, v38, v114
    v_mul_f32 v39, v39, v114
    v_mfma_f32_16x16x32_bf16 v[56:59], a[52:55], v[72:75], v[56:59]
    s_cbranch_vccnz L_spin5
L_back6:
    v_cvt_pk_bf16_f32 v36, v36, v37
    v_cvt_pk_bf16_f32 v37, v38, v39
    v_mfma_f32_16x16x32_bf16 v[52:55], a[52:55], v[68:71], v[52:55]
    ds_read_b128 v[88:91], v4 offset:14336
    v_mfma_f32_16x16x32_bf16 v[60:63], a[56:59], v[68:71], v[60:63]
    ds_write_b64 v8, v[36:37] offset:2048
    v_mfma_f32_16x16x32_bf16 v[64:67], a[56:59], v[72:75], v[64:67]
    s_waitcnt lgkmcnt(4)
    v_mul_f32 v40, v40, v115
    v_mul_f32 v41, v41, v115
    v_mfma_f32_16x16x32_bf16 v[44:47], a[60:63], v[76:79], v[44:47]
    ds_read_b128 v[92:95], v5 offset:12288
    v_mul_f32 v42, v42, v115
    v_mfma_f32_16x16x32_bf16 v[48:51], a[60:63], v[80:83], v[48:51]
    v_mul_f32 v43, v43, v115
    v_cvt_pk_bf16_f32 v40, v40, v41
    v_mfma_f32_16x16x32_bf16 v[56:59], a[64:67], v[80:83], v[56:59]
    v_cvt_pk_bf16_f32 v41, v42, v43
    v_mfma_f32_16x16x32_bf16 v[52:55], a[64:67], v[76:79], v[52:55]
    ds_read_b128 v[96:99], v5 offset:14336
    v_mfma_f32_16x16x32_bf16 v[60:63], a[68:71], v[76:79], v[60:63]
    ds_write_b64 v8, v[40:41] offset:8192
    v_mfma_f32_16x16x32_bf16 v[64:67], a[68:71], v[80:83], v[64:67]
    s_waitcnt lgkmcnt(4)
    s_waitcnt lgkmcnt(0)
    s_barrier
    v_mfma_f32_16x16x32_bf16 v[44:47], a[72:75], v[84:87], v[44:47]
    ds_read_b128 v[68:71], v4 offset:16384
    v_mfma_f32_16x16x32_bf16 v[48:51], a[72:75], v[88:91], v[48:51]
    ds_read_b128 v[20:23], v10 offset:0
    v_mfma_f32_16x16x32_bf16 v[56:59], a[76:79], v[88:91], v[56:59]
    ds_read_b128 v[24:27], v9 offset:1024
    v_mfma_f32_16x16x32_bf16 v[52:55], a[76:79], v[84:87], v[52:55]
    ds_read_b128 v[72:75], v4 offset:18432
    v_mfma_f32_16x16x32_bf16 v[60:63], a[80:83], v[84:87], v[60:63]
    ds_read_b128 v[28:31], v10 offset:1024
    s_add_u32 m0, s43, 0
    v_mfma_f32_16x16x32_bf16 v[64:67], a[80:83], v[88:91], v[64:67]
    s_waitcnt lgkmcnt(6)
    ds_read_b64_tr_b16 v[32:33], v9 offset:2048
    v_mfma_f32_16x16x32_bf16 v[44:47], a[84:87], v[92:95], v[44:47]
    ds_read_b128 v[76:79], v5 offset:16384
    v_mfma_f32_16x16x32_bf16 v[48:51], a[84:87], v[96:99], v[48:51]
    buffer_load_dwordx4 v6, s[8:11], s41 offen offset:0 sc1 lds
    v_mfma_f32_16x16x32_bf16 v[56:59], a[88:91], v[96:99], v[56:59]
    s_add_u32 m0, s43, 3968
    ds_read_b64_tr_b16 v[34:35], v10 offset:2048
    s_waitcnt lgkmcnt(3)
    v_mfma_f32_16x16x32_bf16 v[52:55], a[88:91], v[92:95], v[52:55]
    ds_read_b128 v[80:83], v5 offset:18432
    v_mfma_f32_16x16x32_bf16 v[40:43], v[24:27], v[20:23], 0
    ds_read_b64_tr_b16 v[36:37], v9 offset:2056
    v_mfma_f32_16x16x32_bf16 v[118:121], v[28:31], v[20:23], 0
    ds_read_b64_tr_b16 v[38:39], v10 offset:2056
    v_mfma_f32_16x16x32_bf16 v[60:63], a[92:95], v[92:95], v[60:63]
    v_mfma_f32_16x16x32_bf16 v[64:67], a[92:95], v[96:99], v[64:67]
    s_waitcnt lgkmcnt(7)
    v_cndmask_b32 v40, v40, v41, s[56:57]
    v_cndmask_b32 v42, v42, v43, s[56:57]
    v_mfma_f32_16x16x32_bf16 v[44:47], a[96:99], v[68:71], v[44:47]
    ds_read_b128 v[84:87], v4 offset:20480
    v_cndmask_b32 v118, v118, v119, s[56:57]
    v_mfma_f32_16x16x32_bf16 v[48:51], a[96:99], v[72:75], v[48:51]
    buffer_load_dwordx4 v6, s[8:11], s41 offen offset:128 sc1 lds
    v_mfma_f32_16x16x32_bf16 v[56:59], a[100:103], v[72:75], v[56:59]
    s_add_u32 m0, s43, 7936
    v_cndmask_b32 v120, v120, v121, s[56:57]
    v_cndmask_b32 v40, v18, v40, s[62:63]
    v_mfma_f32_16x16x32_bf16 v[52:55], a[100:103], v[68:71], v[52:55]
    ds_read_b128 v[88:91], v4 offset:22528
    v_cndmask_b32 v42, v18, v42, s[62:63]
    v_mfma_f32_16x16x32_bf16 v[60:63], a[104:107], v[68:71], v[60:63]
    v_cndmask_b32 v22, v40, v118, s[58:59]
    v_cndmask_b32 v23, v42, v120, s[60:61]
    v_mfma_f32_16x16x32_bf16 v[64:67], a[104:107], v[72:75], v[64:67]
    s_waitcnt lgkmcnt(4)
    v_max_f32 v20, v22, v23
    v_mov_b32 v21, v20
    v_mfma_f32_16x16x32_bf16 v[44:47], a[108:111], v[76:79], v[44:47]
    ds_read_b128 v[92:95], v5 offset:20480
    v_mfma_f32_16x16x32_bf16 v[48:51], a[108:111], v[80:83], v[48:51]
    buffer_load_dwordx4 v6, s[8:11], s41 offen offset:256 sc1 lds
    v_mfma_f32_16x16x32_bf16 v[56:59], a[112:115], v[80:83], v[56:59]
    s_add_u32 m0, s43, 11904
    v_permlane16_swap_b32 v20, v21
    v_mfma_f32_16x16x32_bf16 v[52:55], a[112:115], v[76:79], v[52:55]
    ds_read_b128 v[96:99], v5 offset:22528
    v_max_f32 v20, v20, v21
    v_mfma_f32_16x16x32_bf16 v[60:63], a[116:119], v[76:79], v[60:63]
    v_mov_b32 v21, v20
    v_mfma_f32_16x16x32_bf16 v[64:67], a[116:119], v[80:83], v[64:67]
    s_waitcnt lgkmcnt(2)
    v_permlane32_swap_b32 v20, v21
    v_mfma_f32_16x16x32_bf16 v[44:47], a[120:123], v[84:87], v[44:47]
    ds_read_b128 v[68:71], v4 offset:24576
    v_max_f32 v20, v20, v21
    v_mfma_f32_16x16x32_bf16 v[48:51], a[120:123], v[88:91], v[48:51]
    buffer_load_dwordx4 v6, s[8:11], s41 offen offset:384 sc1 lds
    v_mfma_f32_16x16x32_bf16 v[56:59], a[124:127], v[88:91], v[56:59]
    s_add_u32 m0, s43, 15872
    v_mul_f32 v20, s86, v20
    v_fma_f32 v22, v22, s86, -v20
    v_mfma_f32_16x16x32_bf16 v[52:55], a[124:127], v[84:87], v[52:55]
    ds_read_b128 v[72:75], v4 offset:26624
    v_fma_f32 v23, v23, s86, -v20
    v_mfma_f32_16x16x32_bf16 v[60:63], a[128:131], v[84:87], v[60:63]
    v_exp_f32 v22, v22
    v_mfma_f32_16x16x32_bf16 v[64:67], a[128:131], v[88:91], v[64:67]
    s_waitcnt lgkmcnt(2)
    v_exp_f32 v23, v23
    v_mfma_f32_16x16x32_bf16 v[44:47], a[132:135], v[92:95], v[44:47]
    ds_read_b128 v[76:79], v5 offset:24576
    v_cvt_pk_bf16_f32 v28, v22, v23
    v_mfma_f32_16x16x32_bf16 v[48:51], a[132:135], v[96:99], v[48:51]
    buffer_load_dwordx4 v6, s[8:11], s41 offen offset:512 sc1 lds
    v_mfma_f32_16x16x32_bf16 v[56:59], a[136:139], v[96:99], v[56:59]
    s_add_u32 m0, s43, 19840
    v_perm_b32 v24, v28, v28, v14
    v_perm_b32 v25, v28, v28, v15
    v_mfma_f32_16x16x32_bf16 v[52:55], a[136:139], v[92:95], v[52:55]
    ds_read_b128 v[80:83], v5 offset:26624
    v_perm_b32 v26, v28, v28, v16
    v_mfma_f32_16x16x32_bf16 v[60:63], a[140:143], v[92:95], v[60:63]
    v_perm_b32 v27, v28, v28, v17
    v_add_f32 v20, v22, v23
    v_mfma_f32_16x16x32_bf16 v[64:67], a[140:143], v[96:99], v[64:67]
    s_waitcnt lgkmcnt(2)
    v_mov_b32 v21, v20
    s_waitcnt lgkmcnt(8)
    v_mfma_f32_16x16x32_bf16 v[44:47], a[144:147], v[68:71], v[44:47]
    ds_read_b128 v[84:87], v4 offset:28672
    v_mfma_f32_16x16x32_bf16 v[40:43], v[32:35], v[24:27], 0
    v_mfma_f32_16x16x32_bf16 v[118:121], v[36:39], v[24:27], 0
    v_permlane16_swap_b32 v20, v21
    v_mfma_f32_16x16x32_bf16 v[48:51], a[144:147], v[72:75], v[48:51]
    buffer_load_dwordx4 v6, s[8:11], s41 offen offset:640 sc1 lds
    v_mfma_f32_16x16x32_bf16 v[56:59], a[148:151], v[72:75], v[56:59]
    s_add_u32 m0, s43, 23808
    v_add_f32 v20, v20, v21
    v_mov_b32 v21, v20
    v_mfma_f32_16x16x32_bf16 v[52:55], a[148:151], v[68:71], v[52:55]
    ds_read_b128 v[88:91], v4 offset:30720
    v_mfma_f32_16x16x32_bf16 v[60:63], a[152:155], v[68:71], v[60:63]
    v_permlane32_swap_b32 v20, v21
    v_mfma_f32_16x16x32_bf16 v[64:67], a[152:155], v[72:75], v[64:67]
    s_waitcnt lgkmcnt(2)
    v_add_f32 v20, v20, v21
    v_mfma_f32_16x16x32_bf16 v[44:47], a[156:159], v[76:79], v[44:47]
    ds_read_b128 v[92:95], v5 offset:28672
    v_mfma_f32_16x16x32_bf16 v[48:51], a[156:159], v[80:83], v[48:51]
    buffer_load_dwordx4 v6, s[8:11], s41 offen offset:768 sc1 lds
    v_mfma_f32_16x16x32_bf16 v[56:59], a[160:163], v[80:83], v[56:59]
    s_add_u32 m0, s43, 27776
    v_rcp_f32 v20, v20
    v_mfma_f32_16x16x32_bf16 v[52:55], a[160:163], v[76:79], v[52:55]
    ds_read_b128 v[96:99], v5 offset:30720
    v_mul_f32 v40, v40, v20
    v_mfma_f32_16x16x32_bf16 v[60:63], a[164:167], v[76:79], v[60:63]
    v_mul_f32 v41, v41, v20
    v_mul_f32 v42, v42, v20
    v_mfma_f32_16x16x32_bf16 v[64:67], a[164:167], v[80:83], v[64:67]
    s_waitcnt lgkmcnt(2)
    v_mul_f32 v43, v43, v20
    v_cvt_pk_bf16_f32 v28, v40, v41
    v_mfma_f32_16x16x32_bf16 v[44:47], a[168:171], v[84:87], v[44:47]
    ds_read_b128 v[68:71], v4 offset:32768
    v_cvt_pk_bf16_f32 v29, v42, v43
    v_mfma_f32_16x16x32_bf16 v[48:51], a[168:171], v[88:91], v[48:51]
    buffer_load_dwordx4 v6, s[8:11], s41 offen offset:896 sc1 lds
    v_mfma_f32_16x16x32_bf16 v[56:59], a[172:175], v[88:91], v[56:59]
    s_add_u32 m0, s43, 31744
    v_mul_f32 v118, v118, v20
    v_mul_f32 v119, v119, v20
    v_mfma_f32_16x16x32_bf16 v[52:55], a[172:175], v[84:87], v[52:55]
    ds_read_b128 v[72:75], v4 offset:34816
    v_mul_f32 v120, v120, v20
    v_mfma_f32_16x16x32_bf16 v[60:63], a[176:179], v[84:87], v[60:63]
    v_mul_f32 v121, v121, v20
    v_cvt_pk_bf16_f32 v30, v118, v119
    v_mfma_f32_16x16x32_bf16 v[64:67], a[176:179], v[88:91], v[64:67]
    s_waitcnt lgkmcnt(2)
    v_cvt_pk_bf16_f32 v31, v120, v121
    v_mfma_f32_16x16x32_bf16 v[44:47], a[180:183], v[92:95], v[44:47]
    ds_read_b128 v[76:79], v5 offset:32768
    v_mfma_f32_16x16x32_bf16 v[48:51], a[180:183], v[96:99], v[48:51]
    buffer_load_dwordx4 v6, s[8:11], s41 offen offset:1024 sc1 lds
    v_mfma_f32_16x16x32_bf16 v[56:59], a[184:187], v[96:99], v[56:59]
    buffer_store_dwordx4 v[28:31], v1, s[16:19], s44 offen sc1
    v_mfma_f32_16x16x32_bf16 v[52:55], a[184:187], v[92:95], v[52:55]
    s_add_u32 m0, s43, 35712
    ds_read_b128 v[80:83], v5 offset:34816
    s_cmp_eq_u32 s36, 17
    v_mfma_f32_16x16x32_bf16 v[60:63], a[188:191], v[92:95], v[60:63]
    s_cselect_b32 s49, s87, 0x10000
    ds_read_b64 v[32:33], v13 offset:2048
    s_add_u32 s90, s90, s49
    v_mfma_f32_16x16x32_bf16 v[64:67], a[188:191], v[96:99], v[64:67]
    s_waitcnt lgkmcnt(3)
    ds_read_b64 v[34:35], v13 offset:2176
    s_and_b32 s49, s90, 0xffffffff
    v_mfma_f32_16x16x32_bf16 v[44:47], a[192:195], v[68:71], v[44:47]
    s_bitcmp1_b64 s[24:25], s36
    ds_read_b128 v[84:87], v4 offset:36864
    s_cselect_b32 s44, s49, 0x5e00000
    v_mfma_f32_16x16x32_bf16 v[48:51], a[192:195], v[72:75], v[48:51]
    buffer_load_dwordx4 v6, s[8:11], s41 offen offset:1152 sc1 lds
    v_mfma_f32_16x16x32_bf16 v[56:59], a[196:199], v[72:75], v[56:59]
    s_add_u32 m0, s43, 39680
    ds_read_b64 v[36:37], v13 offset:2304
    s_bitcmp1_b64 s[26:27], s36
    v_mfma_f32_16x16x32_bf16 v[52:55], a[196:199], v[68:71], v[52:55]
    s_cselect_b64 s[62:63], 0, -1
    ds_read_b128 v[88:91], v4 offset:38912
    v_mfma_f32_16x16x32_bf16 v[60:63], a[200:203], v[68:71], v[60:63]
    ds_read_b64 v[38:39], v13 offset:2432
    v_mfma_f32_16x16x32_bf16 v[64:67], a[200:203], v[72:75], v[64:67]
    s_waitcnt lgkmcnt(6)
    v_mfma_f32_16x16x32_bf16 v[44:47], a[204:207], v[76:79], v[44:47]
    ds_read_b128 v[92:95], v5 offset:36864
    v_mfma_f32_16x16x32_bf16 v[48:51], a[204:207], v[80:83], v[48:51]
    buffer_load_dwordx4 v6, s[8:11], s41 offen offset:1280 sc1 lds
    v_mfma_f32_16x16x32_bf16 v[56:59], a[208:211], v[80:83], v[56:59]
    s_add_u32 m0, s43, 43648
    v_mfma_f32_16x16x32_bf16 v[52:55], a[208:211], v[76:79], v[52:55]
    s_waitcnt lgkmcnt(1)
    ds_read_b128 v[96:99], v5 offset:38912
    v_add_f32 v40, v36, v38
    v_mfma_f32_16x16x32_bf16 v[60:63], a[212:215], v[76:79], v[60:63]
    v_add_f32 v41, v37, v39
    v_add_f32 v32, v32, v34
    v_mfma_f32_16x16x32_bf16 v[64:67], a[212:215], v[80:83], v[64:67]
    s_waitcnt lgkmcnt(3)
    v_add_f32 v33, v33, v35
    v_add_f32 v32, v32, v40
    v_mfma_f32_16x16x32_bf16 v[44:47], a[216:219], v[84:87], v[44:47]
    ds_read_b128 v[68:71], v4 offset:40960
    v_add_f32 v33, v33, v41
    v_mfma_f32_16x16x32_bf16 v[48:51], a[216:219], v[88:91], v[48:51]
    buffer_load_dwordx4 v6, s[8:11], s41 offen offset:1408 sc1 lds
    v_mfma_f32_16x16x32_bf16 v[56:59], a[220:223], v[88:91], v[56:59]
    s_add_u32 m0, s43, 47616
    v_mov_b32 v40, v32
    v_mov_b32 v41, v33
    v_mfma_f32_16x16x32_bf16 v[52:55], a[220:223], v[84:87], v[52:55]
    ds_read_b128 v[72:75], v4 offset:43008
    v_mfma_f32_16x16x32_bf16 v[60:63], a[224:227], v[84:87], v[60:63]
    v_permlane32_swap_b32 v32, v40
    v_mfma_f32_16x16x32_bf16 v[64:67], a[224:227], v[88:91], v[64:67]
    s_waitcnt lgkmcnt(2)
    v_permlane32_swap_b32 v33, v41
    v_mfma_f32_16x16x32_bf16 v[44:47], a[228:231], v[92:95], v[44:47]
    ds_read_b128 v[76:79], v5 offset:40960
    v_add_f32 v32, v32, v40
    v_mfma_f32_16x16x32_bf16 v[48:51], a[228:231], v[96:99], v[48:51]
    buffer_load_dwordx4 v6, s[8:11], s41 offen offset:1536 sc1 lds
    v_mfma_f32_16x16x32_bf16 v[56:59], a[232:235], v[96:99], v[56:59]
    s_add_u32 m0, s43, 51584
    v_add_f32 v33, v33, v41
    v_mul_f32 v112, 0xba800000, v32
    v_mfma_f32_16x16x32_bf16 v[52:55], a[232:235], v[92:95], v[52:55]
    ds_read_b128 v[80:83], v5 offset:43008
    v_mul_f32 v33, 0x3a800000, v33
    v_mfma_f32_16x16x32_bf16 v[60:63], a[236:239], v[92:95], v[60:63]
    v_fma_f32 v33, -v112, v112, v33
    v_mov_b32 v113, v112
    v_mfma_f32_16x16x32_bf16 v[64:67], a[236:239], v[96:99], v[64:67]
    s_waitcnt lgkmcnt(2)
    v_max_f32 v33, 0, v33
    v_add_f32 v33, 0x3727c5ac, v33
    v_mfma_f32_16x16x32_bf16 v[44:47], a[240:243], v[68:71], v[44:47]
    ds_read_b128 v[84:87], v4 offset:45056
    v_mfma_f32_16x16x32_bf16 v[48:51], a[240:243], v[72:75], v[48:51]
    buffer_load_dwordx4 v6, s[8:11], s41 offen offset:1664 sc1 lds
    v_mfma_f32_16x16x32_bf16 v[56:59], a[244:247], v[72:75], v[56:59]
    s_add_u32 m0, s43, 55552
    v_rsq_f32 v114, v33
    v_mfma_f32_16x16x32_bf16 v[52:55], a[244:247], v[68:71], v[52:55]
    ds_read_b128 v[88:91], v4 offset:47104
    v_mfma_f32_16x16x32_bf16 v[60:63], a[248:251], v[68:71], v[60:63]
    v_permlane16_swap_b32 v112, v113
    v_mfma_f32_16x16x32_bf16 v[64:67], a[248:251], v[72:75], v[64:67]
    s_waitcnt lgkmcnt(2)
    v_mov_b32 v115, v114
    v_fmac_f32 v48, v113, v100
    v_mfma_f32_16x16x32_bf16 v[44:47], a[252:255], v[76:79], v[44:47]
    ds_read_b128 v[92:95], v5 offset:45056
    v_fmac_f32 v52, v112, v104
    v_mfma_f32_16x16x32_bf16 v[48:51], a[252:255], v[80:83], v[48:51]
    buffer_load_dwordx4 v6, s[8:11], s41 offen offset:1792 sc1 lds
    v_mfma_f32_16x16x32_bf16 v[56:59], v[128:131], v[80:83], v[56:59]
    s_add_u32 m0, s43, 59520
    v_permlane16_swap_b32 v114, v115
    v_mfma_f32_16x16x32_bf16 v[52:55], v[128:131], v[76:79], v[52:55]
    ds_read_b128 v[96:99], v5 offset:47104
    v_fmac_f32 v44, v112, v100
    v_mfma_f32_16x16x32_bf16 v[60:63], v[132:135], v[76:79], v[60:63]
    v_fmac_f32 v45, v112, v101
    v_fmac_f32 v46, v112, v102
    v_mfma_f32_16x16x32_bf16 v[64:67], v[132:135], v[80:83], v[64:67]
    s_waitcnt lgkmcnt(2)
    v_fmac_f32 v49, v113, v101
    v_fmac_f32 v50, v113, v102
    v_mfma_f32_16x16x32_bf16 v[44:47], v[136:139], v[84:87], v[44:47]
    ds_read_b128 v[68:71], v4 offset:49152
    v_fmac_f32 v53, v112, v105
    v_mfma_f32_16x16x32_bf16 v[48:51], v[136:139], v[88:91], v[48:51]
    buffer_load_dwordx4 v6, s[8:11], s41 offen offset:1920 sc1 lds
    v_mfma_f32_16x16x32_bf16 v[56:59], v[140:143], v[88:91], v[56:59]
    s_add_u32 m0, s52, 90112
    v_fmac_f32 v47, v112, v103
    v_fmac_f32 v60, v112, v108
    v_mfma_f32_16x16x32_bf16 v[52:55], v[140:143], v[84:87], v[52:55]
    ds_read_b128 v[72:75], v4 offset:51200
    v_fmac_f32 v51, v113, v103
    v_mfma_f32_16x16x32_bf16 v[60:63], v[144:147], v[84:87], v[60:63]
    v_fmac_f32 v56, v113, v104
    v_fmac_f32 v57, v113, v105
    v_mfma_f32_16x16x32_bf16 v[64:67], v[144:147], v[88:91], v[64:67]
    s_waitcnt lgkmcnt(2)
    v_fmac_f32 v54, v112, v106
    v_fmac_f32 v55, v112, v107
    v_mfma_f32_16x16x32_bf16 v[44:47], v[148:151], v[92:95], v[44:47]
    ds_read_b128 v[76:79], v5 offset:49152
    v_fmac_f32 v58, v113, v106
    v_mfma_f32_16x16x32_bf16 v[48:51], v[148:151], v[96:99], v[48:51]
    buffer_load_dwordx4 v1, s[16:19], s46 offen sc1 lds
    v_mfma_f32_16x16x32_bf16 v[56:59], v[152:155], v[96:99], v[56:59]
    s_cmp_eq_u32 s36, s97
    v_med3_i32 v117, s45, 0, v12
    v_add_u32 v117, v117, v11
    v_mfma_f32_16x16x32_bf16 v[52:55], v[152:155], v[92:95], v[52:55]
    s_cselect_b32 s47, 31, -2
    ds_read_b128 v[80:83], v5 offset:51200
    v_fmac_f32 v64, v113, v108
    v_mfma_f32_16x16x32_bf16 v[60:63], v[156:159], v[92:95], v[60:63]
    s_cselect_b64 s[8:9], s[88:89], s[8:9]
    v_fmac_f32 v59, v113, v107
    s_cselect_b32 s55, 0x543fc00, s55
    v_mfma_f32_16x16x32_bf16 v[64:67], v[156:159], v[96:99], v[64:67]
    s_waitcnt lgkmcnt(2)
    s_add_u32 s45, s45, 65536
    s_add_u32 s50, s50, s47
    v_mfma_f32_16x16x32_bf16 v[44:47], v[160:163], v[68:71], v[44:47]
    s_max_i32 s47, s50, 0
    ds_read_b128 v[84:87], v4 offset:53248
    v_fmac_f32 v61, v112, v109
    v_mfma_f32_16x16x32_bf16 v[48:51], v[160:163], v[72:75], v[48:51]
    buffer_load_dword v116, v117, s[16:19], 0 offen sc1
    v_mfma_f32_16x16x32_bf16 v[56:59], v[164:167], v[72:75], v[56:59]
    s_lshl_b32 s41, s47, 15
    v_fmac_f32 v62, v112, v110
    v_fmac_f32 v63, v112, v111
    v_mfma_f32_16x16x32_bf16 v[52:55], v[164:167], v[68:71], v[52:55]
    s_lshl_b32 s46, s47, 10
    ds_read_b128 v[88:91], v4 offset:55296
    v_fmac_f32 v65, v113, v109
    v_mfma_f32_16x16x32_bf16 v[60:63], v[168:171], v[68:71], v[60:63]
    s_sub_u32 s46, s55, s46
    v_mfma_f32_16x16x32_bf16 v[64:67], v[168:171], v[72:75], v[64:67]
    s_waitcnt lgkmcnt(2)
    v_mfma_f32_16x16x32_bf16 v[44:47], v[172:175], v[76:79], v[44:47]
    ds_read_b128 v[92:95], v5 offset:53248
    v_mfma_f32_16x16x32_bf16 v[48:51], v[172:175], v[80:83], v[48:51]
    v_mfma_f32_16x16x32_bf16 v[56:59], v[176:179], v[80:83], v[56:59]
    v_fmac_f32 v66, v113, v110
    v_fmac_f32 v67, v113, v111
    v_mfma_f32_16x16x32_bf16 v[52:55], v[176:179], v[76:79], v[52:55]
    ds_read_b128 v[96:99], v5 offset:55296
    v_mfma_f32_16x16x32_bf16 v[60:63], v[180:183], v[76:79], v[60:63]
    v_mfma_f32_16x16x32_bf16 v[64:67], v[180:183], v[80:83], v[64:67]
    s_waitcnt lgkmcnt(2)
    v_mfma_f32_16x16x32_bf16 v[44:47], v[184:187], v[84:87], v[44:47]
    ds_read_b128 v[68:71], v4 offset:57344
    v_mfma_f32_16x16x32_bf16 v[48:51], v[184:187], v[88:91], v[48:51]
    v_mfma_f32_16x16x32_bf16 v[56:59], v[188:191], v[88:91], v[56:59]
    v_mfma_f32_16x16x32_bf16 v[52:55], v[188:191], v[84:87], v[52:55]
    ds_read_b128 v[72:75], v4 offset:59392
    v_mfma_f32_16x16x32_bf16 v[60:63], v[192:195], v[84:87], v[60:63]
    v_mfma_f32_16x16x32_bf16 v[64:67], v[192:195], v[88:91], v[64:67]
    s_waitcnt lgkmcnt(2)
    v_mfma_f32_16x16x32_bf16 v[44:47], v[196:199], v[92:95], v[44:47]
    ds_read_b128 v[76:79], v5 offset:57344
    v_mfma_f32_16x16x32_bf16 v[48:51], v[196:199], v[96:99], v[48:51]
    v_mfma_f32_16x16x32_bf16 v[56:59], v[200:203], v[96:99], v[56:59]
    v_mfma_f32_16x16x32_bf16 v[52:55], v[200:203], v[92:95], v[52:55]
    ds_read_b128 v[80:83], v5 offset:59392
    v_mfma_f32_16x16x32_bf16 v[60:63], v[204:207], v[92:95], v[60:63]
    s_waitcnt vmcnt(9)
    s_barrier
    v_mfma_f32_16x16x32_bf16 v[64:67], v[204:207], v[96:99], v[64:67]
    s_waitcnt lgkmcnt(2)
    v_mfma_f32_16x16x32_bf16 v[44:47], v[208:211], v[68:71], v[44:47]
    ds_read_b128 v[84:87], v4 offset:61440
    v_mfma_f32_16x16x32_bf16 v[48:51], v[208:211], v[72:75], v[48:51]
    buffer_store_dword v124, v124, s[16:19], s91 offen sc1
    v_mfma_f32_16x16x32_bf16 v[56:59], v[212:215], v[72:75], v[56:59]
    s_add_u32 s91, s91, 65536
    v_mfma_f32_16x16x32_bf16 v[52:55], v[212:215], v[68:71], v[52:55]
    ds_read_b128 v[88:91], v4 offset:63488
    v_mfma_f32_16x16x32_bf16 v[60:63], v[216:219], v[68:71], v[60:63]
    v_mfma_f32_16x16x32_bf16 v[64:67], v[216:219], v[72:75], v[64:67]
    s_waitcnt lgkmcnt(2)
    v_mfma_f32_16x16x32_bf16 v[44:47], v[220:223], v[76:79], v[44:47]
    ds_read_b128 v[92:95], v5 offset:61440
    v_mfma_f32_16x16x32_bf16 v[48:51], v[220:223], v[80:83], v[48:51]
    v_mfma_f32_16x16x32_bf16 v[56:59], v[224:227], v[80:83], v[56:59]
    v_mfma_f32_16x16x32_bf16 v[52:55], v[224:227], v[76:79], v[52:55]
    ds_read_b128 v[96:99], v5 offset:63488
    v_mfma_f32_16x16x32_bf16 v[60:63], v[228:231], v[76:79], v[60:63]
    v_mfma_f32_16x16x32_bf16 v[64:67], v[228:231], v[80:83], v[64:67]
    s_waitcnt lgkmcnt(2)
    v_mfma_f32_16x16x32_bf16 v[44:47], v[232:235], v[84:87], v[44:47]
    ds_read_b128 v[68:71], v2 offset:0
    v_mfma_f32_16x16x32_bf16 v[48:51], v[232:235], v[88:91], v[48:51]
    v_mfma_f32_16x16x32_bf16 v[56:59], v[236:239], v[88:91], v[56:59]
    v_mfma_f32_16x16x32_bf16 v[52:55], v[236:239], v[84:87], v[52:55]
    ds_read_b128 v[72:75], v2 offset:2048
    v_mfma_f32_16x16x32_bf16 v[60:63], v[240:243], v[84:87], v[60:63]
    v_mfma_f32_16x16x32_bf16 v[64:67], v[240:243], v[88:91], v[64:67]
    s_waitcnt lgkmcnt(2)
    v_mfma_f32_16x16x32_bf16 v[44:47], v[244:247], v[92:95], v[44:47]
    ds_read_b128 v[76:79], v3 offset:0
    v_mfma_f32_16x16x32_bf16 v[48:51], v[244:247], v[96:99], v[48:51]
    v_mfma_f32_16x16x32_bf16 v[56:59], v[248:251], v[96:99], v[56:59]
    v_mfma_f32_16x16x32_bf16 v[52:55], v[248:251], v[92:95], v[52:55]
    ds_read_b128 v[80:83], v3 offset:2048
    v_mfma_f32_16x16x32_bf16 v[60:63], v[252:255], v[92:95], v[60:63]
    v_mfma_f32_16x16x32_bf16 v[64:67], v[252:255], v[96:99], v[64:67]
    s_add_u32 s36, s36, 1
    s_cmp_lt_u32 s36, 33
    s_cbranch_scc1 L_q_b0
    s_nop 7
    v_mul_f32 v44, v44, v114
    v_mul_f32 v45, v45, v114
    v_mul_f32 v46, v46, v114
    v_mul_f32 v47, v47, v114
    v_cvt_pk_bf16_f32 v44, v44, v45
    v_cvt_pk_bf16_f32 v45, v46, v47
    ds_write_b64 v7, v[44:45] offset:12288
    v_mul_f32 v48, v48, v115
    v_mul_f32 v49, v49, v115
    v_mul_f32 v50, v50, v115
    v_mul_f32 v51, v51, v115
    v_cvt_pk_bf16_f32 v48, v48, v49
    v_cvt_pk_bf16_f32 v49, v50, v51
    ds_write_b64 v7, v[48:49] offset:18432
    v_mul_f32 v52, v52, v114
    v_mul_f32 v53, v53, v114
    v_mul_f32 v54, v54, v114
    v_mul_f32 v55, v55, v114
    v_cvt_pk_bf16_f32 v52, v52, v53
    v_cvt_pk_bf16_f32 v53, v54, v55
    ds_write_b64 v7, v[52:53] offset:13312
    v_mul_f32 v56, v56, v115
    v_mul_f32 v57, v57, v115
    v_mul_f32 v58, v58, v115
    v_mul_f32 v59, v59, v115
    v_cvt_pk_bf16_f32 v56, v56, v57
    v_cvt_pk_bf16_f32 v57, v58, v59
    ds_write_b64 v7, v[56:57] offset:19456
    v_mul_f32 v60, v60, v114
    v_mul_f32 v61, v61, v114
    v_mul_f32 v62, v62, v114
    v_mul_f32 v63, v63, v114
    v_cvt_pk_bf16_f32 v60, v60, v61
    v_cvt_pk_bf16_f32 v61, v62, v63
    ds_write_b64 v8, v[60:61] offset:14336
    v_mul_f32 v64, v64, v115
    v_mul_f32 v65, v65, v115
    v_mul_f32 v66, v66, v115
    v_mul_f32 v67, v67, v115
    v_cvt_pk_bf16_f32 v64, v64, v65
    v_cvt_pk_bf16_f32 v65, v66, v67
    ds_write_b64 v8, v[64:65] offset:20480
    s_waitcnt lgkmcnt(0)
    s_barrier
    ds_read_b128 v[44:47], v9 offset:6144
    ds_read_b128 v[48:51], v9 offset:13312
    ds_read_b128 v[52:55], v9 offset:7168
    ds_read_b64_tr_b16 v[56:57], v9 offset:14336
    ds_read_b64_tr_b16 v[58:59], v9 offset:8192
    ds_read_b64_tr_b16 v[60:61], v9 offset:14344
    ds_read_b64_tr_b16 v[62:63], v9 offset:8200
    s_waitcnt lgkmcnt(4)
    v_mfma_f32_16x16x32_bf16 v[64:67], v[48:51], v[44:47], 0
    v_mfma_f32_16x16x32_bf16 v[118:121], v[52:55], v[44:47], 0
    s_nop 5
    v_cndmask_b32 v64, v64, v65, s[56:57]
    v_cndmask_b32 v66, v66, v67, s[56:57]
    v_cndmask_b32 v118, v118, v119, s[56:57]
    v_cndmask_b32 v120, v120, v121, s[56:57]
    v_cndmask_b32 v64, v18, v64, s[62:63]
    v_cndmask_b32 v66, v18, v66, s[62:63]
    v_cndmask_b32 v46, v64, v118, s[58:59]
    v_cndmask_b32 v47, v66, v120, s[60:61]
    v_max_f32 v44, v46, v47
    v_mov_b32 v45, v44
    s_nop 1
    v_permlane16_swap_b32 v44, v45
    v_max_f32 v44, v44, v45
    v_mov_b32 v45, v44
    s_nop 1
    v_permlane32_swap_b32 v44, v45
    v_max_f32 v44, v44, v45
    v_mul_f32 v44, s86, v44
    v_fma_f32 v46, v46, s86, -v44
    v_fma_f32 v47, v47, s86, -v44
    v_exp_f32 v46, v46
    v_exp_f32 v47, v47
    s_nop 0
    v_cvt_pk_bf16_f32 v52, v46, v47
    v_perm_b32 v48, v52, v52, v14
    v_perm_b32 v49, v52, v52, v15
    v_perm_b32 v50, v52, v52, v16
    v_perm_b32 v51, v52, v52, v17
    s_waitcnt lgkmcnt(0)
    v_add_f32 v44, v46, v47
    v_mfma_f32_16x16x32_bf16 v[64:67], v[56:59], v[48:51], 0
    v_mfma_f32_16x16x32_bf16 v[118:121], v[60:63], v[48:51], 0
    v_mov_b32 v45, v44
    s_nop 1
    v_permlane16_swap_b32 v44, v45
    v_add_f32 v44, v44, v45
    v_mov_b32 v45, v44
    s_nop 1
    v_permlane32_swap_b32 v44, v45
    v_add_f32 v44, v44, v45
    v_rcp_f32 v44, v44
    s_nop 0
    v_mul_f32 v64, v64, v44
    v_mul_f32 v65, v65, v44
    v_mul_f32 v66, v66, v44
    v_mul_f32 v67, v67, v44
    v_cvt_pk_bf16_f32 v52, v64, v65
    v_cvt_pk_bf16_f32 v53, v66, v67
    v_mul_f32 v118, v118, v44
    v_mul_f32 v119, v119, v44
    v_mul_f32 v120, v120, v44
    v_mul_f32 v121, v121, v44
    v_cvt_pk_bf16_f32 v54, v118, v119
    v_cvt_pk_bf16_f32 v55, v120, v121
    buffer_store_dwordx4 v[52:55], v1, s[16:19], s44 offen sc1
    s_waitcnt vmcnt(0)
    s_barrier
    buffer_store_dword v124, v124, s[16:19], s91 offen sc1
    s_add_u32 s91, s91, 65536
    s_waitcnt vmcnt(0)
    s_endpgm
L_spin1:
    s_mov_b32 s40, 0x20000
L_spin1_l:
    buffer_load_dword v37, v36, s[20:23], 0 offen sc1
    s_sub_u32 s40, s40, 1
    s_waitcnt vmcnt(0)
    v_cmp_eq_u32 vcc, v36, v37
    s_cbranch_scc1 L_back2
    s_cbranch_vccz L_back2
    s_sleep 8
    s_branch L_spin1_l
L_spin3:
    s_mov_b32 s40, 0x20000
L_spin3_l:
    buffer_load_dword v116, v117, s[16:19], 0 offen sc1
    s_sub_u32 s40, s40, 1
    s_waitcnt vmcnt(0)
    v_cmp_ne_u32 vcc, 0, v116
    s_cbranch_scc1 L_back4
    s_cbranch_vccz L_back4
    s_sleep 2
    s_branch L_spin3_l
L_spin5:
    s_mov_b32 s40, 0x20000
L_spin5_l:
    buffer_load_dword v116, v117, s[16:19], 0 offen sc1
    s_sub_u32 s40, s40, 1
    s_waitcnt vmcnt(0)
    v_cmp_ne_u32 vcc, 0, v116
    s_cbranch_scc1 L_back6
    s_cbranch_vccz L_back6
    s_sleep 2
    s_branch L_spin5_l
L_other:
    s_lshr_b32 s48, s2, 3
    s_bitcmp1_b32 s2, 0
    s_cbranch_scc1 L_odd
    v_lshrrev_b32 v6, 2, v0
    v_and_b32 v7, 3, v0
    v_lshlrev_b32 v7, 7, v7
    v_lshl_add_u32 v6, v6, 11, v7
    s_and_b32 s48, s48, 15
    s_lshl2_add_u32 s39, s48, s32
    s_lshl_b32 s39, s39, 15
    s_lshl_b32 s37, s47, 9
    s_add_u32 s39, s39, s37
    s_lshr_b32 s37, s48, 2
    s_lshl_b32 s37, s37, 20
    s_and_b32 s38, s48, 3
    s_lshl2_add_u32 s38, s38, s32
    s_lshl_b32 s38, s38, 13
    s_add_u32 s37, s37, s38
    v_lshlrev_b32 v5, 7, v0
    s_waitcnt lgkmcnt(0)
    s_add_u32 s8, s64, 0xe0000
    s_addc_u32 s9, s65, 0
    s_mov_b32 s10, 0x320000
    s_mov_b32 s11, 0x00020000
    buffer_load_dword v251, v5, s[8:11], s37 offen
    s_mov_b32 s12, s66
    s_mov_b32 s13, s67
    s_mov_b32 s14, 0x600000
    s_mov_b32 s15, 0x00020000
    buffer_load_dword v248, v6, s[12:15], s39 offen
    s_add_u32 s39, s39, 2097152
    buffer_load_dword v249, v6, s[12:15], s39 offen
    s_add_u32 s39, s39, 2097152
    buffer_load_dword v250, v6, s[12:15], s39 offen
    s_add_u32 s39, s39, 2097152
    s_mov_b32 s16, s84
    s_mov_b32 s17, s85
    s_mov_b32 s18, 0x5e00000
    s_mov_b32 s19, 0x00020000
    v_min_u32 v124, 1, v0
    v_lshlrev_b32 v124, 30, v124
    s_lshr_b32 s33, s47, 1
    s_lshl_b32 s33, s33, 1
    s_and_b32 s37, s48, 1
    s_add_u32 s33, s33, s37
    s_and_b32 s35, s47, 1
    s_lshl_b32 s35, s35, 3
    s_lshr_b32 s37, s48, 1
    s_add_u32 s35, s35, s37
    s_add_u32 s34, s35, 24
    s_lshl_b32 s91, s33, 6
    s_add_u32 s91, s91, s34
    s_lshl_b32 s91, s91, 7
    s_add_u32 s91, s91, 0x5520000
    s_cmp_eq_u32 s32, 1
    s_cselect_b32 s91, s91, 0x5f00000
    s_mul_i32 s51, s35, 6
    s_min_u32 s51, s51, 106
    s_lshl_b32 s54, s51, 6
    s_mov_b32 s12, s72
    s_mov_b32 s13, s73
    s_mov_b32 s14, 0x700000
    s_mov_b32 s15, 0x00020000
    s_mov_b32 s39, 7168
    v_lshrrev_b32 v68, 3, v0
    v_lshlrev_b32 v69, 2, v0
    v_and_b32 v69, 64, v69
    v_and_b32 v70, 0x70, v1
    v_xor_b32 v69, v69, v70
    v_mad_u32_u24 v56, v68, s39, v69
    v_add_u32 v57, 57344, v56
    v_add_u32 v58, 128, v56
    v_add_u32 v59, 57472, v56
    v_add_u32 v60, 256, v56
    v_add_u32 v61, 57600, v56
    s_mul_i32 s38, s32, 114688
    s_add_u32 s54, s54, s38
    s_lshl_b32 s42, s32, 11
    s_add_u32 m0, s42, 0
    s_nop 0
    buffer_load_dwordx4 v56, s[12:15], s54 offen lds
    s_add_u32 m0, s42, 1024
    s_nop 0
    buffer_load_dwordx4 v57, s[12:15], s54 offen lds
    s_add_u32 m0, s42, 8192
    s_nop 0
    buffer_load_dwordx4 v58, s[12:15], s54 offen lds
    s_add_u32 m0, s42, 9216
    s_nop 0
    buffer_load_dwordx4 v59, s[12:15], s54 offen lds
    s_add_u32 m0, s42, 16384
    s_nop 0
    buffer_load_dwordx4 v60, s[12:15], s54 offen lds
    s_add_u32 m0, s42, 17408
    s_nop 0
    buffer_load_dwordx4 v61, s[12:15], s54 offen lds
    s_add_u32 s54, s54, 458752
    s_add_u32 m0, s42, 24576
    s_nop 0
    buffer_load_dwordx4 v56, s[12:15], s54 offen lds
    s_add_u32 m0, s42, 25600
    s_nop 0
    buffer_load_dwordx4 v57, s[12:15], s54 offen lds
    s_add_u32 m0, s42, 32768
    s_nop 0
    buffer_load_dwordx4 v58, s[12:15], s54 offen lds
    s_add_u32 m0, s42, 33792
    s_nop 0
    buffer_load_dwordx4 v59, s[12:15], s54 offen lds
    s_add_u32 m0, s42, 40960
    s_nop 0
    buffer_load_dwordx4 v60, s[12:15], s54 offen lds
    s_add_u32 m0, s42, 41984
    s_nop 0
    buffer_load_dwordx4 v61, s[12:15], s54 offen lds
    s_add_u32 s54, s54, 458752
    s_add_u32 m0, s42, 49152
    s_nop 0
    buffer_load_dwordx4 v56, s[12:15], s54 offen lds
    s_add_u32 m0, s42, 50176
    s_nop 0
    buffer_load_dwordx4 v57, s[12:15], s54 offen lds
    s_add_u32 m0, s42, 57344
    s_nop 0
    buffer_load_dwordx4 v58, s[12:15], s54 offen lds
    s_add_u32 m0, s42, 58368
    s_nop 0
    buffer_load_dwordx4 v59, s[12:15], s54 offen lds
    s_add_u32 m0, s42, 65536
    s_nop 0
    buffer_load_dwordx4 v60, s[12:15], s54 offen lds
    s_add_u32 m0, s42, 66560
    s_nop 0
    buffer_load_dwordx4 v61, s[12:15], s54 offen lds
    s_add_u32 s54, s54, 458752
    s_add_u32 m0, s42, 73728
    s_nop 0
    buffer_load_dwordx4 v56, s[12:15], s54 offen lds
    s_add_u32 m0, s42, 74752
    s_nop 0
    buffer_load_dwordx4 v57, s[12:15], s54 offen lds
    s_add_u32 m0, s42, 81920
    s_nop 0
    buffer_load_dwordx4 v58, s[12:15], s54 offen lds
    s_add_u32 m0, s42, 82944
    s_nop 0
    buffer_load_dwordx4 v59, s[12:15], s54 offen lds
    s_add_u32 m0, s42, 90112
    s_nop 0
    buffer_load_dwordx4 v60, s[12:15], s54 offen lds
    s_add_u32 m0, s42, 91136
    s_nop 0
    buffer_load_dwordx4 v61, s[12:15], s54 offen lds
    s_add_u32 s54, s54, 458752
    s_add_u32 m0, s42, 98304
    s_nop 0
    buffer_load_dwordx4 v56, s[12:15], s54 offen lds
    s_add_u32 m0, s42, 99328
    s_nop 0
    buffer_load_dwordx4 v57, s[12:15], s54 offen lds
    s_add_u32 m0, s42, 106496
    s_nop 0
    buffer_load_dwordx4 v58, s[12:15], s54 offen lds
    s_add_u32 m0, s42, 107520
    s_nop 0
    buffer_load_dwordx4 v59, s[12:15], s54 offen lds
    s_add_u32 m0, s42, 114688
    s_nop 0
    buffer_load_dwordx4 v60, s[12:15], s54 offen lds
    s_add_u32 m0, s42, 115712
    s_nop 0
    buffer_load_dwordx4 v61, s[12:15], s54 offen lds
    s_add_u32 s54, s54, 458752
    v_lshrrev_b32 v68, 4, v0
    v_bfe_u32 v69, v0, 2, 2
    v_lshl_add_u32 v68, v68, 3, v69
    v_lshlrev_b32 v68, 7, v68
    v_lshrrev_b32 v69, 1, v69
    v_lshl_add_u32 v68, v69, 6, v68
    v_and_b32 v69, 3, v0
    v_lshl_add_u32 v68, v69, 4, v68
    s_lshr_b32 s37, s32, 1
    s_lshl_b32 s37, s37, 13
    s_and_b32 s38, s32, 1
    s_lshl_b32 s38, s38, 6
    s_add_u32 s37, s37, s38
    s_add_u32 s37, s37, 0
    v_xor_b32 v62, s37, v68
    s_lshr_b32 s37, s32, 1
    s_lshl_b32 s37, s37, 13
    s_and_b32 s38, s32, 1
    s_lshl_b32 s38, s38, 6
    s_add_u32 s37, s37, s38
    s_add_u32 s37, s37, 8
    v_xor_b32 v63, s37, v68
    s_lshr_b32 s37, s32, 1
    s_lshl_b32 s37, s37, 6
    s_and_b32 s38, s32, 1
    s_lshl_b32 s38, s38, 3
    s_add_u32 s37, s37, s38
    s_add_u32 s37, s37, 16384
    v_xor_b32 v64, s37, v68
    v_mov_b32 v68, 0x3f803f80
    v_mov_b32 v69, 0x3f803f80
    v_mov_b32 v70, 0x3f803f80
    v_mov_b32 v71, 0x3f803f80
    v_add_u32 v2, 98304, v1
    s_lshl_b32 s37, s33, 6
    s_add_u32 s37, s37, 16
    s_lshl_b32 s37, s37, 7
    v_lshl_add_u32 v5, v0, 7, s37
    s_cmp_eq_u32 s32, 0
    s_cselect_b32 s37, 8, 0
    v_cmp_le_u32 vcc, s37, v0
    s_nop 1
    v_cndmask_b32 v5, v5, 2.0, vcc
    s_lshl_b32 s43, s32, 12
    s_mul_i32 s41, s33, 2097152
    s_add_u32 s41, s41, 0x800000
    s_add_u32 s41, s41, s43
    s_mul_i32 s90, s33, 8388608
    s_add_u32 s90, s90, 0xfc0000
    s_add_u32 s37, s51, s32
    s_lshl_b32 s37, s37, 11
    s_add_u32 s90, s90, s37
    s_lshl_b32 s37, s32, 10
    s_sub_u32 s87, 8192, s37
    s_lshl_b32 s38, s35, 1
    s_lshr_b32 s39, s32, 1
    s_add_u32 s38, s38, s39
    s_cmp_eq_u32 s38, 36
    s_cselect_b32 s88, 0x5e00000, 0
    s_and_b32 s38, s32, 1
    s_lshl_b32 s38, s38, 3
    s_and_b32 s39, s32, 2
    s_lshl_b32 s39, s39, 10
    s_add_u32 s38, s38, s39
    s_add_u32 s38, s38, 65536
    v_add_u32 v3, s38, v1
    s_add_u32 s37, s37, 65536
    v_add_u32 v4, s37, v1
    v_and_b32 v6, 15, v0
    v_lshlrev_b32 v6, 3, v6
    v_lshrrev_b32 v8, 5, v0
    v_lshl_add_u32 v6, v8, 9, v6
    v_and_b32 v8, 16, v0
    v_lshl_add_u32 v6, v8, 6, v6
    v_add_u32 v118, 73728, v6
    s_mul_i32 s46, s33, 65536
    s_add_u32 s46, s46, 0x5440000
    s_add_u32 s55, s46, 63488
    s_and_b32 s52, s32, 1
    s_lshl_b32 s52, s52, 10
    s_mov_b32 s8, s74
    s_mov_b32 s9, s75
    s_mov_b32 s10, 0x1c00
    s_mov_b32 s11, 0x00020000
    v_and_b32 v8, 0x30, v0
    s_add_u32 s37, s51, s32
    s_lshl_b32 s37, s37, 6
    buffer_load_dwordx4 v[16:19], v8, s[8:11], s37 offen
    s_lshr_b32 s37, s32, 1
    s_add_u32 s37, s37, s51
    s_lshl_b32 s37, s37, 6
    s_and_b32 s38, s32, 1
    s_lshl_b32 s38, s38, 3
    s_add_u32 s37, s37, s38
    buffer_load_dwordx2 v[20:21], v8, s[8:11], s37 offen offset:256
    v_add_u32 v65, 0, v62
    v_add_u32 v66, 0, v63
    v_add_u32 v67, 0, v64
    s_waitcnt vmcnt(26)
    s_barrier
    ds_read_b64_tr_b16 a[0:1], v65 offset:0
    ds_read_b64_tr_b16 a[2:3], v65 offset:512
    ds_read_b64_tr_b16 a[4:5], v66 offset:0
    ds_read_b64_tr_b16 a[6:7], v66 offset:512
    ds_read_b64_tr_b16 a[8:9], v67 offset:0
    ds_read_b64_tr_b16 a[10:11], v67 offset:512
    ds_read_b64_tr_b16 a[12:13], v65 offset:4096
    ds_read_b64_tr_b16 a[14:15], v65 offset:4608
    ds_read_b64_tr_b16 a[16:17], v66 offset:4096
    ds_read_b64_tr_b16 a[18:19], v66 offset:4608
    ds_read_b64_tr_b16 a[20:21], v67 offset:4096
    ds_read_b64_tr_b16 a[22:23], v67 offset:4608
    s_add_u32 m0, s42, 122880
    s_nop 0
    buffer_load_dwordx4 v56, s[12:15], s54 offen lds
    s_add_u32 m0, s42, 123904
    s_nop 0
    buffer_load_dwordx4 v57, s[12:15], s54 offen lds
    s_add_u32 m0, s42, 131072
    s_nop 0
    buffer_load_dwordx4 v58, s[12:15], s54 offen lds
    s_add_u32 m0, s42, 132096
    s_nop 0
    buffer_load_dwordx4 v59, s[12:15], s54 offen lds
    s_add_u32 m0, s42, 139264
    s_nop 0
    buffer_load_dwordx4 v60, s[12:15], s54 offen lds
    s_add_u32 m0, s42, 140288
    s_nop 0
    buffer_load_dwordx4 v61, s[12:15], s54 offen lds
    s_add_u32 s54, s54, 458752
    s_waitcnt lgkmcnt(0)
    v_mfma_f32_16x16x32_bf16 v[88:91], a[0:3], v[68:71], 0
    v_mfma_f32_16x16x32_bf16 v[92:95], a[4:7], v[68:71], 0
    v_mfma_f32_16x16x32_bf16 v[96:99], a[8:11], v[68:71], 0
    v_mfma_f32_16x16x32_bf16 v[88:91], a[12:15], v[68:71], v[88:91]
    v_mfma_f32_16x16x32_bf16 v[92:95], a[16:19], v[68:71], v[92:95]
    v_mfma_f32_16x16x32_bf16 v[96:99], a[20:23], v[68:71], v[96:99]
    v_add_u32 v65, 24576, v62
    v_add_u32 v66, 24576, v63
    v_add_u32 v67, 24576, v64
    s_waitcnt vmcnt(26)
    s_barrier
    ds_read_b64_tr_b16 a[24:25], v65 offset:0
    ds_read_b64_tr_b16 a[26:27], v65 offset:512
    ds_read_b64_tr_b16 a[28:29], v66 offset:0
    ds_read_b64_tr_b16 a[30:31], v66 offset:512
    ds_read_b64_tr_b16 a[32:33], v67 offset:0
    ds_read_b64_tr_b16 a[34:35], v67 offset:512
    ds_read_b64_tr_b16 a[36:37], v65 offset:4096
    ds_read_b64_tr_b16 a[38:39], v65 offset:4608
    ds_read_b64_tr_b16 a[40:41], v66 offset:4096
    ds_read_b64_tr_b16 a[42:43], v66 offset:4608
    ds_read_b64_tr_b16 a[44:45], v67 offset:4096
    ds_read_b64_tr_b16 a[46:47], v67 offset:4608
    s_add_u32 m0, s42, 0
    s_nop 0
    buffer_load_dwordx4 v56, s[12:15], s54 offen lds
    s_add_u32 m0, s42, 1024
    s_nop 0
    buffer_load_dwordx4 v57, s[12:15], s54 offen lds
    s_add_u32 m0, s42, 8192
    s_nop 0
    buffer_load_dwordx4 v58, s[12:15], s54 offen lds
    s_add_u32 m0, s42, 9216
    s_nop 0
    buffer_load_dwordx4 v59, s[12:15], s54 offen lds
    s_add_u32 m0, s42, 16384
    s_nop 0
    buffer_load_dwordx4 v60, s[12:15], s54 offen lds
    s_add_u32 m0, s42, 17408
    s_nop 0
    buffer_load_dwordx4 v61, s[12:15], s54 offen lds
    s_add_u32 s54, s54, 458752
    s_waitcnt lgkmcnt(0)
    v_mfma_f32_16x16x32_bf16 v[88:91], a[24:27], v[68:71], v[88:91]
    v_mfma_f32_16x16x32_bf16 v[92:95], a[28:31], v[68:71], v[92:95]
    v_mfma_f32_16x16x32_bf16 v[96:99], a[32:35], v[68:71], v[96:99]
    v_mfma_f32_16x16x32_bf16 v[88:91], a[36:39], v[68:71], v[88:91]
    v_mfma_f32_16x16x32_bf16 v[92:95], a[40:43], v[68:71], v[92:95]
    v_mfma_f32_16x16x32_bf16 v[96:99], a[44:47], v[68:71], v[96:99]
    v_add_u32 v65, 49152, v62
    v_add_u32 v66, 49152, v63
    v_add_u32 v67, 49152, v64
    s_waitcnt vmcnt(26)
    s_barrier
    ds_read_b64_tr_b16 a[48:49], v65 offset:0
    ds_read_b64_tr_b16 a[50:51], v65 offset:512
    ds_read_b64_tr_b16 a[52:53], v66 offset:0
    ds_read_b64_tr_b16 a[54:55], v66 offset:512
    ds_read_b64_tr_b16 a[56:57], v67 offset:0
    ds_read_b64_tr_b16 a[58:59], v67 offset:512
    ds_read_b64_tr_b16 a[60:61], v65 offset:4096
    ds_read_b64_tr_b16 a[62:63], v65 offset:4608
    ds_read_b64_tr_b16 a[64:65], v66 offset:4096
    ds_read_b64_tr_b16 a[66:67], v66 offset:4608
    ds_read_b64_tr_b16 a[68:69], v67 offset:4096
    ds_read_b64_tr_b16 a[70:71], v67 offset:4608
    s_add_u32 m0, s42, 24576
    s_nop 0
    buffer_load_dwordx4 v56, s[12:15], s54 offen lds
    s_add_u32 m0, s42, 25600
    s_nop 0
    buffer_load_dwordx4 v57, s[12:15], s54 offen lds
    s_add_u32 m0, s42, 32768
    s_nop 0
    buffer_load_dwordx4 v58, s[12:15], s54 offen lds
    s_add_u32 m0, s42, 33792
    s_nop 0
    buffer_load_dwordx4 v59, s[12:15], s54 offen lds
    s_add_u32 m0, s42, 40960
    s_nop 0
    buffer_load_dwordx4 v60, s[12:15], s54 offen lds
    s_add_u32 m0, s42, 41984
    s_nop 0
    buffer_load_dwordx4 v61, s[12:15], s54 offen lds
    s_add_u32 s54, s54, 458752
    s_waitcnt lgkmcnt(0)
    v_mfma_f32_16x16x32_bf16 v[88:91], a[48:51], v[68:71], v[88:91]
    v_mfma_f32_16x16x32_bf16 v[92:95], a[52:55], v[68:71], v[92:95]
    v_mfma_f32_16x16x32_bf16 v[96:99], a[56:59], v[68:71], v[96:99]
    v_mfma_f32_16x16x32_bf16 v[88:91], a[60:63], v[68:71], v[88:91]
    v_mfma_f32_16x16x32_bf16 v[92:95], a[64:67], v[68:71], v[92:95]
    v_mfma_f32_16x16x32_bf16 v[96:99], a[68:71], v[68:71], v[96:99]
    v_add_u32 v65, 73728, v62
    v_add_u32 v66, 73728, v63
    v_add_u32 v67, 73728, v64
    s_waitcnt vmcnt(26)
    s_barrier
    ds_read_b64_tr_b16 a[72:73], v65 offset:0
    ds_read_b64_tr_b16 a[74:75], v65 offset:512
    ds_read_b64_tr_b16 a[76:77], v66 offset:0
    ds_read_b64_tr_b16 a[78:79], v66 offset:512
    ds_read_b64_tr_b16 a[80:81], v67 offset:0
    ds_read_b64_tr_b16 a[82:83], v67 offset:512
    ds_read_b64_tr_b16 a[84:85], v65 offset:4096
    ds_read_b64_tr_b16 a[86:87], v65 offset:4608
    ds_read_b64_tr_b16 a[88:89], v66 offset:4096
    ds_read_b64_tr_b16 a[90:91], v66 offset:4608
    ds_read_b64_tr_b16 a[92:93], v67 offset:4096
    ds_read_b64_tr_b16 a[94:95], v67 offset:4608
    s_add_u32 m0, s42, 49152
    s_nop 0
    buffer_load_dwordx4 v56, s[12:15], s54 offen lds
    s_add_u32 m0, s42, 50176
    s_nop 0
    buffer_load_dwordx4 v57, s[12:15], s54 offen lds
    s_add_u32 m0, s42, 57344
    s_nop 0
    buffer_load_dwordx4 v58, s[12:15], s54 offen lds
    s_add_u32 m0, s42, 58368
    s_nop 0
    buffer_load_dwordx4 v59, s[12:15], s54 offen lds
    s_add_u32 m0, s42, 65536
    s_nop 0
    buffer_load_dwordx4 v60, s[12:15], s54 offen lds
    s_add_u32 m0, s42, 66560
    s_nop 0
    buffer_load_dwordx4 v61, s[12:15], s54 offen lds
    s_add_u32 s54, s54, 458752
    s_waitcnt lgkmcnt(0)
    v_mfma_f32_16x16x32_bf16 v[88:91], a[72:75], v[68:71], v[88:91]
    v_mfma_f32_16x16x32_bf16 v[92:95], a[76:79], v[68:71], v[92:95]
    v_mfma_f32_16x16x32_bf16 v[96:99], a[80:83], v[68:71], v[96:99]
    v_mfma_f32_16x16x32_bf16 v[88:91], a[84:87], v[68:71], v[88:91]
    v_mfma_f32_16x16x32_bf16 v[92:95], a[88:91], v[68:71], v[92:95]
    v_mfma_f32_16x16x32_bf16 v[96:99], a[92:95], v[68:71], v[96:99]
    v_add_u32 v65, 98304, v62
    v_add_u32 v66, 98304, v63
    v_add_u32 v67, 98304, v64
    s_waitcnt vmcnt(26)
    s_barrier
    ds_read_b64_tr_b16 a[96:97], v65 offset:0
    ds_read_b64_tr_b16 a[98:99], v65 offset:512
    ds_read_b64_tr_b16 a[100:101], v66 offset:0
    ds_read_b64_tr_b16 a[102:103], v66 offset:512
    ds_read_b64_tr_b16 a[104:105], v67 offset:0
    ds_read_b64_tr_b16 a[106:107], v67 offset:512
    ds_read_b64_tr_b16 a[108:109], v65 offset:4096
    ds_read_b64_tr_b16 a[110:111], v65 offset:4608
    ds_read_b64_tr_b16 a[112:113], v66 offset:4096
    ds_read_b64_tr_b16 a[114:115], v66 offset:4608
    ds_read_b64_tr_b16 a[116:117], v67 offset:4096
    ds_read_b64_tr_b16 a[118:119], v67 offset:4608
    s_add_u32 m0, s42, 73728
    s_nop 0
    buffer_load_dwordx4 v56, s[12:15], s54 offen lds
    s_add_u32 m0, s42, 74752
    s_nop 0
    buffer_load_dwordx4 v57, s[12:15], s54 offen lds
    s_add_u32 m0, s42, 81920
    s_nop 0
    buffer_load_dwordx4 v58, s[12:15], s54 offen lds
    s_add_u32 m0, s42, 82944
    s_nop 0
    buffer_load_dwordx4 v59, s[12:15], s54 offen lds
    s_add_u32 m0, s42, 90112
    s_nop 0
    buffer_load_dwordx4 v60, s[12:15], s54 offen lds
    s_add_u32 m0, s42, 91136
    s_nop 0
    buffer_load_dwordx4 v61, s[12:15], s54 offen lds
    s_add_u32 s54, s54, 458752
    s_waitcnt lgkmcnt(0)
    v_mfma_f32_16x16x32_bf16 v[88:91], a[96:99], v[68:71], v[88:91]
    v_mfma_f32_16x16x32_bf16 v[92:95], a[100:103], v[68:71], v[92:95]
    v_mfma_f32_16x16x32_bf16 v[96:99], a[104:107], v[68:71], v[96:99]
    v_mfma_f32_16x16x32_bf16 v[88:91], a[108:111], v[68:71], v[88:91]
    v_mfma_f32_16x16x32_bf16 v[92:95], a[112:115], v[68:71], v[92:95]
    v_mfma_f32_16x16x32_bf16 v[96:99], a[116:119], v[68:71], v[96:99]
    v_add_u32 v65, 122880, v62
    v_add_u32 v66, 122880, v63
    v_add_u32 v67, 122880, v64
    s_waitcnt vmcnt(24)
    s_barrier
    ds_read_b64_tr_b16 a[120:121], v65 offset:0
    ds_read_b64_tr_b16 a[122:123], v65 offset:512
    ds_read_b64_tr_b16 a[124:125], v66 offset:0
    ds_read_b64_tr_b16 a[126:127], v66 offset:512
    ds_read_b64_tr_b16 a[128:129], v67 offset:0
    ds_read_b64_tr_b16 a[130:131], v67 offset:512
    ds_read_b64_tr_b16 a[132:133], v65 offset:4096
    ds_read_b64_tr_b16 a[134:135], v65 offset:4608
    ds_read_b64_tr_b16 a[136:137], v66 offset:4096
    ds_read_b64_tr_b16 a[138:139], v66 offset:4608
    ds_read_b64_tr_b16 a[140:141], v67 offset:4096
    ds_read_b64_tr_b16 a[142:143], v67 offset:4608
    s_add_u32 m0, s42, 98304
    s_nop 0
    buffer_load_dwordx4 v56, s[12:15], s54 offen lds
    s_add_u32 m0, s42, 99328
    s_nop 0
    buffer_load_dwordx4 v57, s[12:15], s54 offen lds
    s_add_u32 m0, s42, 106496
    s_nop 0
    buffer_load_dwordx4 v58, s[12:15], s54 offen lds
    s_add_u32 m0, s42, 107520
    s_nop 0
    buffer_load_dwordx4 v59, s[12:15], s54 offen lds
    s_add_u32 m0, s42, 114688
    s_nop 0
    buffer_load_dwordx4 v60, s[12:15], s54 offen lds
    s_add_u32 m0, s42, 115712
    s_nop 0
    buffer_load_dwordx4 v61, s[12:15], s54 offen lds
    s_add_u32 s54, s54, 458752
    s_waitcnt lgkmcnt(0)
    v_mfma_f32_16x16x32_bf16 v[88:91], a[120:123], v[68:71], v[88:91]
    v_mfma_f32_16x16x32_bf16 v[92:95], a[124:127], v[68:71], v[92:95]
    v_mfma_f32_16x16x32_bf16 v[96:99], a[128:131], v[68:71], v[96:99]
    v_mfma_f32_16x16x32_bf16 v[88:91], a[132:135], v[68:71], v[88:91]
    v_mfma_f32_16x16x32_bf16 v[92:95], a[136:139], v[68:71], v[92:95]
    v_mfma_f32_16x16x32_bf16 v[96:99], a[140:143], v[68:71], v[96:99]
    v_add_u32 v65, 0, v62
    v_add_u32 v66, 0, v63
    v_add_u32 v67, 0, v64
    s_waitcnt vmcnt(24)
    s_barrier
    ds_read_b64_tr_b16 a[144:145], v65 offset:0
    ds_read_b64_tr_b16 a[146:147], v65 offset:512
    ds_read_b64_tr_b16 a[148:149], v66 offset:0
    ds_read_b64_tr_b16 a[150:151], v66 offset:512
    ds_read_b64_tr_b16 a[152:153], v67 offset:0
    ds_read_b64_tr_b16 a[154:155], v67 offset:512
    ds_read_b64_tr_b16 a[156:157], v65 offset:4096
    ds_read_b64_tr_b16 a[158:159], v65 offset:4608
    ds_read_b64_tr_b16 a[160:161], v66 offset:4096
    ds_read_b64_tr_b16 a[162:163], v66 offset:4608
    ds_read_b64_tr_b16 a[164:165], v67 offset:4096
    ds_read_b64_tr_b16 a[166:167], v67 offset:4608
    s_add_u32 m0, s42, 122880
    s_nop 0
    buffer_load_dwordx4 v56, s[12:15], s54 offen lds
    s_add_u32 m0, s42, 123904
    s_nop 0
    buffer_load_dwordx4 v57, s[12:15], s54 offen lds
    s_add_u32 m0, s42, 131072
    s_nop 0
    buffer_load_dwordx4 v58, s[12:15], s54 offen lds
    s_add_u32 m0, s42, 132096
    s_nop 0
    buffer_load_dwordx4 v59, s[12:15], s54 offen lds
    s_add_u32 m0, s42, 139264
    s_nop 0
    buffer_load_dwordx4 v60, s[12:15], s54 offen lds
    s_add_u32 m0, s42, 140288
    s_nop 0
    buffer_load_dwordx4 v61, s[12:15], s54 offen lds
    s_add_u32 s54, s54, 458752
    s_waitcnt lgkmcnt(0)
    v_mfma_f32_16x16x32_bf16 v[88:91], a[144:147], v[68:71], v[88:91]
    v_mfma_f32_16x16x32_bf16 v[92:95], a[148:151], v[68:71], v[92:95]
    v_mfma_f32_16x16x32_bf16 v[96:99], a[152:155], v[68:71], v[96:99]
    v_mfma_f32_16x16x32_bf16 v[88:91], a[156:159], v[68:71], v[88:91]
    v_mfma_f32_16x16x32_bf16 v[92:95], a[160:163], v[68:71], v[92:95]
    v_mfma_f32_16x16x32_bf16 v[96:99], a[164:167], v[68:71], v[96:99]
    v_add_u32 v65, 24576, v62
    v_add_u32 v66, 24576, v63
    v_add_u32 v67, 24576, v64
    s_waitcnt vmcnt(24)
    s_barrier
    ds_read_b64_tr_b16 a[168:169], v65 offset:0
    ds_read_b64_tr_b16 a[170:171], v65 offset:512
    ds_read_b64_tr_b16 a[172:173], v66 offset:0
    ds_read_b64_tr_b16 a[174:175], v66 offset:512
    ds_read_b64_tr_b16 a[176:177], v67 offset:0
    ds_read_b64_tr_b16 a[178:179], v67 offset:512
    ds_read_b64_tr_b16 a[180:181], v65 offset:4096
    ds_read_b64_tr_b16 a[182:183], v65 offset:4608
    ds_read_b64_tr_b16 a[184:185], v66 offset:4096
    ds_read_b64_tr_b16 a[186:187], v66 offset:4608
    ds_read_b64_tr_b16 a[188:189], v67 offset:4096
    ds_read_b64_tr_b16 a[190:191], v67 offset:4608
    s_add_u32 m0, s42, 0
    s_nop 0
    buffer_load_dwordx4 v56, s[12:15], s54 offen lds
    s_add_u32 m0, s42, 1024
    s_nop 0
    buffer_load_dwordx4 v57, s[12:15], s54 offen lds
    s_add_u32 m0, s42, 8192
    s_nop 0
    buffer_load_dwordx4 v58, s[12:15], s54 offen lds
    s_add_u32 m0, s42, 9216
    s_nop 0
    buffer_load_dwordx4 v59, s[12:15], s54 offen lds
    s_add_u32 m0, s42, 16384
    s_nop 0
    buffer_load_dwordx4 v60, s[12:15], s54 offen lds
    s_add_u32 m0, s42, 17408
    s_nop 0
    buffer_load_dwordx4 v61, s[12:15], s54 offen lds
    s_add_u32 s54, s54, 458752
    s_waitcnt lgkmcnt(0)
    v_mfma_f32_16x16x32_bf16 v[88:91], a[168:171], v[68:71], v[88:91]
    v_mfma_f32_16x16x32_bf16 v[92:95], a[172:175], v[68:71], v[92:95]
    v_mfma_f32_16x16x32_bf16 v[96:99], a[176:179], v[68:71], v[96:99]
    v_mfma_f32_16x16x32_bf16 v[88:91], a[180:183], v[68:71], v[88:91]
    v_mfma_f32_16x16x32_bf16 v[92:95], a[184:187], v[68:71], v[92:95]
    v_mfma_f32_16x16x32_bf16 v[96:99], a[188:191], v[68:71], v[96:99]
    v_add_u32 v65, 49152, v62
    v_add_u32 v66, 49152, v63
    v_add_u32 v67, 49152, v64
    s_waitcnt vmcnt(24)
    s_barrier
    ds_read_b64_tr_b16 a[192:193], v65 offset:0
    ds_read_b64_tr_b16 a[194:195], v65 offset:512
    ds_read_b64_tr_b16 a[196:197], v66 offset:0
    ds_read_b64_tr_b16 a[198:199], v66 offset:512
    ds_read_b64_tr_b16 a[200:201], v67 offset:0
    ds_read_b64_tr_b16 a[202:203], v67 offset:512
    ds_read_b64_tr_b16 a[204:205], v65 offset:4096
    ds_read_b64_tr_b16 a[206:207], v65 offset:4608
    ds_read_b64_tr_b16 a[208:209], v66 offset:4096
    ds_read_b64_tr_b16 a[210:211], v66 offset:4608
    ds_read_b64_tr_b16 a[212:213], v67 offset:4096
    ds_read_b64_tr_b16 a[214:215], v67 offset:4608
    s_add_u32 m0, s42, 24576
    s_nop 0
    buffer_load_dwordx4 v56, s[12:15], s54 offen lds
    s_add_u32 m0, s42, 25600
    s_nop 0
    buffer_load_dwordx4 v57, s[12:15], s54 offen lds
    s_add_u32 m0, s42, 32768
    s_nop 0
    buffer_load_dwordx4 v58, s[12:15], s54 offen lds
    s_add_u32 m0, s42, 33792
    s_nop 0
    buffer_load_dwordx4 v59, s[12:15], s54 offen lds
    s_add_u32 m0, s42, 40960
    s_nop 0
    buffer_load_dwordx4 v60, s[12:15], s54 offen lds
    s_add_u32 m0, s42, 41984
    s_nop 0
    buffer_load_dwordx4 v61, s[12:15], s54 offen lds
    s_add_u32 s54, s54, 458752
    s_waitcnt lgkmcnt(0)
    v_mfma_f32_16x16x32_bf16 v[88:91], a[192:195], v[68:71], v[88:91]
    v_mfma_f32_16x16x32_bf16 v[92:95], a[196:199], v[68:71], v[92:95]
    v_mfma_f32_16x16x32_bf16 v[96:99], a[200:203], v[68:71], v[96:99]
    v_mfma_f32_16x16x32_bf16 v[88:91], a[204:207], v[68:71], v[88:91]
    v_mfma_f32_16x16x32_bf16 v[92:95], a[208:211], v[68:71], v[92:95]
    v_mfma_f32_16x16x32_bf16 v[96:99], a[212:215], v[68:71], v[96:99]
    v_add_u32 v65, 73728, v62
    v_add_u32 v66, 73728, v63
    v_add_u32 v67, 73728, v64
    s_waitcnt vmcnt(24)
    s_barrier
    ds_read_b64_tr_b16 a[216:217], v65 offset:0
    ds_read_b64_tr_b16 a[218:219], v65 offset:512
    ds_read_b64_tr_b16 a[220:221], v66 offset:0
    ds_read_b64_tr_b16 a[222:223], v66 offset:512
    ds_read_b64_tr_b16 a[224:225], v67 offset:0
    ds_read_b64_tr_b16 a[226:227], v67 offset:512
    ds_read_b64_tr_b16 a[228:229], v65 offset:4096
    ds_read_b64_tr_b16 a[230:231], v65 offset:4608
    ds_read_b64_tr_b16 a[232:233], v66 offset:4096
    ds_read_b64_tr_b16 a[234:235], v66 offset:4608
    ds_read_b64_tr_b16 a[236:237], v67 offset:4096
    ds_read_b64_tr_b16 a[238:239], v67 offset:4608
    s_add_u32 m0, s42, 49152
    s_nop 0
    buffer_load_dwordx4 v56, s[12:15], s54 offen lds
    s_add_u32 m0, s42, 50176
    s_nop 0
    buffer_load_dwordx4 v57, s[12:15], s54 offen lds
    s_add_u32 m0, s42, 57344
    s_nop 0
    buffer_load_dwordx4 v58, s[12:15], s54 offen lds
    s_add_u32 m0, s42, 58368
    s_nop 0
    buffer_load_dwordx4 v59, s[12:15], s54 offen lds
    s_add_u32 m0, s42, 65536
    s_nop 0
    buffer_load_dwordx4 v60, s[12:15], s54 offen lds
    s_add_u32 m0, s42, 66560
    s_nop 0
    buffer_load_dwordx4 v61, s[12:15], s54 offen lds
    s_add_u32 s54, s54, 458752
    s_waitcnt lgkmcnt(0)
    v_mfma_f32_16x16x32_bf16 v[88:91], a[216:219], v[68:71], v[88:91]
    v_mfma_f32_16x16x32_bf16 v[92:95], a[220:223], v[68:71], v[92:95]
    v_mfma_f32_16x16x32_bf16 v[96:99], a[224:227], v[68:71], v[96:99]
    v_mfma_f32_16x16x32_bf16 v[88:91], a[228:231], v[68:71], v[88:91]
    v_mfma_f32_16x16x32_bf16 v[92:95], a[232:235], v[68:71], v[92:95]
    v_mfma_f32_16x16x32_bf16 v[96:99], a[236:239], v[68:71], v[96:99]
    v_add_u32 v65, 98304, v62
    v_add_u32 v66, 98304, v63
    v_add_u32 v67, 98304, v64
    s_waitcnt vmcnt(24)
    s_barrier
    ds_read_b64_tr_b16 a[240:241], v65 offset:0
    ds_read_b64_tr_b16 a[242:243], v65 offset:512
    ds_read_b64_tr_b16 a[244:245], v66 offset:0
    ds_read_b64_tr_b16 a[246:247], v66 offset:512
    ds_read_b64_tr_b16 a[248:249], v67 offset:0
    ds_read_b64_tr_b16 a[250:251], v67 offset:512
    ds_read_b64_tr_b16 a[252:253], v65 offset:4096
    ds_read_b64_tr_b16 a[254:255], v65 offset:4608
    ds_read_b64_tr_b16 v[128:129], v66 offset:4096
    ds_read_b64_tr_b16 v[130:131], v66 offset:4608
    ds_read_b64_tr_b16 v[132:133], v67 offset:4096
    ds_read_b64_tr_b16 v[134:135], v67 offset:4608
    s_add_u32 m0, s42, 73728
    s_nop 0
    buffer_load_dwordx4 v56, s[12:15], s54 offen lds
    s_add_u32 m0, s42, 74752
    s_nop 0
    buffer_load_dwordx4 v57, s[12:15], s54 offen lds
    s_add_u32 m0, s42, 81920
    s_nop 0
    buffer_load_dwordx4 v58, s[12:15], s54 offen lds
    s_add_u32 m0, s42, 82944
    s_nop 0
    buffer_load_dwordx4 v59, s[12:15], s54 offen lds
    s_add_u32 m0, s42, 90112
    s_nop 0
    buffer_load_dwordx4 v60, s[12:15], s54 offen lds
    s_add_u32 m0, s42, 91136
    s_nop 0
    buffer_load_dwordx4 v61, s[12:15], s54 offen lds
    s_add_u32 s54, s54, 458752
    s_waitcnt lgkmcnt(0)
    v_mfma_f32_16x16x32_bf16 v[88:91], a[240:243], v[68:71], v[88:91]
    v_mfma_f32_16x16x32_bf16 v[92:95], a[244:247], v[68:71], v[92:95]
    v_mfma_f32_16x16x32_bf16 v[96:99], a[248:251], v[68:71], v[96:99]
    v_mfma_f32_16x16x32_bf16 v[88:91], a[252:255], v[68:71], v[88:91]
    v_mfma_f32_16x16x32_bf16 v[92:95], v[128:131], v[68:71], v[92:95]
    v_mfma_f32_16x16x32_bf16 v[96:99], v[132:135], v[68:71], v[96:99]
    v_add_u32 v65, 122880, v62
    v_add_u32 v66, 122880, v63
    v_add_u32 v67, 122880, v64
    s_waitcnt vmcnt(24)
    s_barrier
    ds_read_b64_tr_b16 v[136:137], v65 offset:0
    ds_read_b64_tr_b16 v[138:139], v65 offset:512
    ds_read_b64_tr_b16 v[140:141], v66 offset:0
    ds_read_b64_tr_b16 v[142:143], v66 offset:512
    ds_read_b64_tr_b16 v[144:145], v67 offset:0
    ds_read_b64_tr_b16 v[146:147], v67 offset:512
    ds_read_b64_tr_b16 v[148:149], v65 offset:4096
    ds_read_b64_tr_b16 v[150:151], v65 offset:4608
    ds_read_b64_tr_b16 v[152:153], v66 offset:4096
    ds_read_b64_tr_b16 v[154:155], v66 offset:4608
    ds_read_b64_tr_b16 v[156:157], v67 offset:4096
    ds_read_b64_tr_b16 v[158:159], v67 offset:4608
    s_waitcnt lgkmcnt(0)
    v_mfma_f32_16x16x32_bf16 v[88:91], v[136:139], v[68:71], v[88:91]
    v_mfma_f32_16x16x32_bf16 v[92:95], v[140:143], v[68:71], v[92:95]
    v_mfma_f32_16x16x32_bf16 v[96:99], v[144:147], v[68:71], v[96:99]
    v_mfma_f32_16x16x32_bf16 v[88:91], v[148:151], v[68:71], v[88:91]
    v_mfma_f32_16x16x32_bf16 v[92:95], v[152:155], v[68:71], v[92:95]
    v_mfma_f32_16x16x32_bf16 v[96:99], v[156:159], v[68:71], v[96:99]
    v_add_u32 v65, 0, v62
    v_add_u32 v66, 0, v63
    v_add_u32 v67, 0, v64
    s_waitcnt vmcnt(18)
    s_barrier
    ds_read_b64_tr_b16 v[160:161], v65 offset:0
    ds_read_b64_tr_b16 v[162:163], v65 offset:512
    ds_read_b64_tr_b16 v[164:165], v66 offset:0
    ds_read_b64_tr_b16 v[166:167], v66 offset:512
    ds_read_b64_tr_b16 v[168:169], v67 offset:0
    ds_read_b64_tr_b16 v[170:171], v67 offset:512
    ds_read_b64_tr_b16 v[172:173], v65 offset:4096
    ds_read_b64_tr_b16 v[174:175], v65 offset:4608
    ds_read_b64_tr_b16 v[176:177], v66 offset:4096
    ds_read_b64_tr_b16 v[178:179], v66 offset:4608
    ds_read_b64_tr_b16 v[180:181], v67 offset:4096
    ds_read_b64_tr_b16 v[182:183], v67 offset:4608
    s_waitcnt lgkmcnt(0)
    v_mfma_f32_16x16x32_bf16 v[88:91], v[160:163], v[68:71], v[88:91]
    v_mfma_f32_16x16x32_bf16 v[92:95], v[164:167], v[68:71], v[92:95]
    v_mfma_f32_16x16x32_bf16 v[96:99], v[168:171], v[68:71], v[96:99]
    v_mfma_f32_16x16x32_bf16 v[88:91], v[172:175], v[68:71], v[88:91]
    v_mfma_f32_16x16x32_bf16 v[92:95], v[176:179], v[68:71], v[92:95]
    v_mfma_f32_16x16x32_bf16 v[96:99], v[180:183], v[68:71], v[96:99]
    v_add_u32 v65, 24576, v62
    v_add_u32 v66, 24576, v63
    v_add_u32 v67, 24576, v64
    s_waitcnt vmcnt(12)
    s_barrier
    ds_read_b64_tr_b16 v[184:185], v65 offset:0
    ds_read_b64_tr_b16 v[186:187], v65 offset:512
    ds_read_b64_tr_b16 v[188:189], v66 offset:0
    ds_read_b64_tr_b16 v[190:191], v66 offset:512
    ds_read_b64_tr_b16 v[192:193], v67 offset:0
    ds_read_b64_tr_b16 v[194:195], v67 offset:512
    ds_read_b64_tr_b16 v[196:197], v65 offset:4096
    ds_read_b64_tr_b16 v[198:199], v65 offset:4608
    ds_read_b64_tr_b16 v[200:201], v66 offset:4096
    ds_read_b64_tr_b16 v[202:203], v66 offset:4608
    ds_read_b64_tr_b16 v[204:205], v67 offset:4096
    ds_read_b64_tr_b16 v[206:207], v67 offset:4608
    s_waitcnt lgkmcnt(0)
    v_mfma_f32_16x16x32_bf16 v[88:91], v[184:187], v[68:71], v[88:91]
    v_mfma_f32_16x16x32_bf16 v[92:95], v[188:191], v[68:71], v[92:95]
    v_mfma_f32_16x16x32_bf16 v[96:99], v[192:195], v[68:71], v[96:99]
    v_mfma_f32_16x16x32_bf16 v[88:91], v[196:199], v[68:71], v[88:91]
    v_mfma_f32_16x16x32_bf16 v[92:95], v[200:203], v[68:71], v[92:95]
    v_mfma_f32_16x16x32_bf16 v[96:99], v[204:207], v[68:71], v[96:99]
    v_add_u32 v65, 49152, v62
    v_add_u32 v66, 49152, v63
    v_add_u32 v67, 49152, v64
    s_waitcnt vmcnt(6)
    s_barrier
    ds_read_b64_tr_b16 v[208:209], v65 offset:0
    ds_read_b64_tr_b16 v[210:211], v65 offset:512
    ds_read_b64_tr_b16 v[212:213], v66 offset:0
    ds_read_b64_tr_b16 v[214:215], v66 offset:512
    ds_read_b64_tr_b16 v[216:217], v67 offset:0
    ds_read_b64_tr_b16 v[218:219], v67 offset:512
    ds_read_b64_tr_b16 v[220:221], v65 offset:4096
    ds_read_b64_tr_b16 v[222:223], v65 offset:4608
    ds_read_b64_tr_b16 v[224:225], v66 offset:4096
    ds_read_b64_tr_b16 v[226:227], v66 offset:4608
    ds_read_b64_tr_b16 v[228:229], v67 offset:4096
    ds_read_b64_tr_b16 v[230:231], v67 offset:4608
    s_waitcnt lgkmcnt(0)
    v_mfma_f32_16x16x32_bf16 v[88:91], v[208:211], v[68:71], v[88:91]
    v_mfma_f32_16x16x32_bf16 v[92:95], v[212:215], v[68:71], v[92:95]
    v_mfma_f32_16x16x32_bf16 v[96:99], v[216:219], v[68:71], v[96:99]
    v_mfma_f32_16x16x32_bf16 v[88:91], v[220:223], v[68:71], v[88:91]
    v_mfma_f32_16x16x32_bf16 v[92:95], v[224:227], v[68:71], v[92:95]
    v_mfma_f32_16x16x32_bf16 v[96:99], v[228:231], v[68:71], v[96:99]
    v_add_u32 v65, 73728, v62
    v_add_u32 v66, 73728, v63
    v_add_u32 v67, 73728, v64
    s_waitcnt vmcnt(0)
    s_barrier
    ds_read_b64_tr_b16 v[232:233], v65 offset:0
    ds_read_b64_tr_b16 v[234:235], v65 offset:512
    ds_read_b64_tr_b16 v[236:237], v66 offset:0
    ds_read_b64_tr_b16 v[238:239], v66 offset:512
    ds_read_b64_tr_b16 v[240:241], v67 offset:0
    ds_read_b64_tr_b16 v[242:243], v67 offset:512
    ds_read_b64_tr_b16 v[244:245], v65 offset:4096
    ds_read_b64_tr_b16 v[246:247], v65 offset:4608
    ds_read_b64_tr_b16 v[248:249], v66 offset:4096
    ds_read_b64_tr_b16 v[250:251], v66 offset:4608
    ds_read_b64_tr_b16 v[252:253], v67 offset:4096
    ds_read_b64_tr_b16 v[254:255], v67 offset:4608
    s_waitcnt lgkmcnt(0)
    v_mfma_f32_16x16x32_bf16 v[88:91], v[232:235], v[68:71], v[88:91]
    v_mfma_f32_16x16x32_bf16 v[92:95], v[236:239], v[68:71], v[92:95]
    v_mfma_f32_16x16x32_bf16 v[96:99], v[240:243], v[68:71], v[96:99]
    v_mfma_f32_16x16x32_bf16 v[88:91], v[244:247], v[68:71], v[88:91]
    v_mfma_f32_16x16x32_bf16 v[92:95], v[248:251], v[68:71], v[92:95]
    v_mfma_f32_16x16x32_bf16 v[96:99], v[252:255], v[68:71], v[96:99]
    s_barrier
    s_mov_b32 s37, 0xffff0000
    v_lshlrev_b32 v100, 16, v16
    v_and_b32 v101, s37, v16
    v_lshlrev_b32 v102, 16, v17
    v_and_b32 v103, s37, v17
    v_lshlrev_b32 v104, 16, v18
    v_and_b32 v105, s37, v18
    v_lshlrev_b32 v106, 16, v19
    v_and_b32 v107, s37, v19
    v_lshlrev_b32 v108, 16, v20
    v_and_b32 v109, s37, v20
    v_lshlrev_b32 v110, 16, v21
    v_and_b32 v111, s37, v21
    s_cmp_lg_u32 s32, 0
    s_cbranch_scc1 L_arv7
    s_add_u32 s20, s82, 0x80
    s_addc_u32 s21, s83, 0
    s_mov_b32 s22, 0x4
    s_mov_b32 s23, 0x00020000
    buffer_load_dword v56, v124, s[20:23], 0 offen sc1
    s_waitcnt vmcnt(0)
    v_cmp_eq_u32 vcc, v124, v56
    s_cbranch_vccnz L_spin8
L_back9:
L_arv7:
    s_add_u32 s96, s41, 2031616
    s_mov_b32 s98, s41
    s_mov_b32 s45, 0x5530000
    buffer_load_dword v7, v5, s[16:19], s45 offen sc1
    s_waitcnt vmcnt(0)
    v_cmp_ne_u32 vcc, 0, v7
    s_cbranch_vccnz L_spin10
L_back11:
    s_barrier
    s_add_u32 m0, s43, 0
    s_add_u32 s42, s41, 0
    buffer_load_dwordx4 v1, s[16:19], s42 offen offset:0 sc1 lds
    buffer_load_dwordx4 v1, s[16:19], s42 offen offset:1024 sc1 lds
    buffer_load_dwordx4 v1, s[16:19], s42 offen offset:2048 sc1 lds
    buffer_load_dwordx4 v1, s[16:19], s42 offen offset:3072 sc1 lds
    s_add_u32 m0, s43, 16384
    s_add_u32 s42, s41, 16384
    buffer_load_dwordx4 v1, s[16:19], s42 offen offset:0 sc1 lds
    buffer_load_dwordx4 v1, s[16:19], s42 offen offset:1024 sc1 lds
    buffer_load_dwordx4 v1, s[16:19], s42 offen offset:2048 sc1 lds
    buffer_load_dwordx4 v1, s[16:19], s42 offen offset:3072 sc1 lds
    s_add_u32 m0, s43, 32768
    s_add_u32 s42, s41, 32768
    buffer_load_dwordx4 v1, s[16:19], s42 offen offset:0 sc1 lds
    buffer_load_dwordx4 v1, s[16:19], s42 offen offset:1024 sc1 lds
    buffer_load_dwordx4 v1, s[16:19], s42 offen offset:2048 sc1 lds
    buffer_load_dwordx4 v1, s[16:19], s42 offen offset:3072 sc1 lds
    s_add_u32 m0, s43, 49152
    s_add_u32 s42, s41, 49152
    buffer_load_dwordx4 v1, s[16:19], s42 offen offset:0 sc1 lds
    buffer_load_dwordx4 v1, s[16:19], s42 offen offset:1024 sc1 lds
    buffer_load_dwordx4 v1, s[16:19], s42 offen offset:2048 sc1 lds
    buffer_load_dwordx4 v1, s[16:19], s42 offen offset:3072 sc1 lds
    s_add_u32 s45, s45, 65536
    s_add_u32 m0, s52, 73728
    s_add_u32 s42, s46, s52
    buffer_load_dwordx4 v1, s[16:19], s42 offen sc1 lds
    v_mov_b32 v7, -1
    s_cmp_eq_u32 s32, 0
    s_cselect_b32 s37, 1, 0
    v_cmp_le_u32 vcc, s37, v0
    s_nop 1
    v_cndmask_b32 v7, v7, 0, vcc
    s_waitcnt vmcnt(0) lgkmcnt(0)
    s_barrier
    ds_read_b128 v[56:59], v1 offset:0
    ds_read_b128 v[60:63], v1 offset:1024
    ds_read_b128 v[64:67], v1 offset:2048
    ds_read_b128 v[68:71], v1 offset:3072
    s_mov_b32 s36, 0
    s_waitcnt lgkmcnt(0)
    s_nop 7
L_a_b0:
    s_waitcnt lgkmcnt(2)
    v_mfma_f32_16x16x32_bf16 v[8:11], a[0:3], v[56:59], 0
    s_and_b32 s44, s90, 0xffffffff
    ds_read_b128 v[72:75], v1 offset:4096
    v_mul_f32 v120, v48, v116
    v_mfma_f32_16x16x32_bf16 v[16:19], a[0:3], v[60:63], 0
    s_cmp_lt_i32 s36, 1
    v_mul_f32 v121, v49, v116
    v_mul_f32 v120, v120, abs(v48)
    v_mfma_f32_16x16x32_bf16 v[20:23], a[4:7], v[60:63], 0
    s_cselect_b32 s44, 0x5e00000, s44
    v_mul_f32 v121, v121, abs(v49)
    v_cvt_pk_bf16_f32 v48, v120, v121
    v_mfma_f32_16x16x32_bf16 v[12:15], a[4:7], v[56:59], 0
    s_add_u32 s49, s44, s87
    ds_read_b128 v[76:79], v1 offset:5120
    v_pk_max_i16 v48, v48, 0
    v_mfma_f32_16x16x32_bf16 v[24:27], a[8:11], v[56:59], 0
    s_max_u32 s44, s44, s88
    v_mul_f32 v120, v50, v116
    v_mul_f32 v121, v51, v116
    v_mfma_f32_16x16x32_bf16 v[28:31], a[8:11], v[60:63], 0
    s_waitcnt lgkmcnt(2)
    v_mul_f32 v120, v120, abs(v50)
    v_mul_f32 v121, v121, abs(v51)
    v_mfma_f32_16x16x32_bf16 v[8:11], a[12:15], v[64:67], v[8:11]
    s_add_u32 s90, s90, 262144
    ds_read_b128 v[80:83], v1 offset:6144
    v_cvt_pk_bf16_f32 v49, v120, v121
    v_mfma_f32_16x16x32_bf16 v[16:19], a[12:15], v[68:71], v[16:19]
    s_add_u32 s98, s98, 65536
    v_pk_max_i16 v49, v49, 0
    s_min_i32 s98, s98, s96
    v_mfma_f32_16x16x32_bf16 v[20:23], a[16:19], v[68:71], v[20:23]
    s_and_b32 s41, s98, 0xffffffff
    ds_write_b64 v3, v[48:49] offset:4096
    v_mfma_f32_16x16x32_bf16 v[12:15], a[16:19], v[64:67], v[12:15]
    ds_read_b128 v[84:87], v1 offset:7168
    v_mul_f32 v120, v52, v117
    v_mfma_f32_16x16x32_bf16 v[24:27], a[20:23], v[64:67], v[24:27]
    v_mul_f32 v121, v53, v117
    v_mul_f32 v120, v120, abs(v52)
    v_mfma_f32_16x16x32_bf16 v[28:31], a[20:23], v[68:71], v[28:31]
    s_waitcnt lgkmcnt(3)
    v_mul_f32 v121, v121, abs(v53)
    v_cvt_pk_bf16_f32 v52, v120, v121
    v_mfma_f32_16x16x32_bf16 v[8:11], a[24:27], v[72:75], v[8:11]
    ds_read_b128 v[56:59], v1 offset:8192
    v_pk_max_i16 v52, v52, 0
    v_mfma_f32_16x16x32_bf16 v[16:19], a[24:27], v[76:79], v[16:19]
    v_mul_f32 v120, v54, v117
    v_mul_f32 v121, v55, v117
    v_mfma_f32_16x16x32_bf16 v[20:23], a[28:31], v[76:79], v[20:23]
    v_mul_f32 v120, v120, abs(v54)
    v_mul_f32 v121, v121, abs(v55)
    v_mfma_f32_16x16x32_bf16 v[12:15], a[28:31], v[72:75], v[12:15]
    ds_read_b128 v[60:63], v1 offset:9216
    v_cvt_pk_bf16_f32 v53, v120, v121
    v_mfma_f32_16x16x32_bf16 v[24:27], a[32:35], v[72:75], v[24:27]
    v_pk_max_i16 v53, v53, 0
    v_mfma_f32_16x16x32_bf16 v[28:31], a[32:35], v[76:79], v[28:31]
    s_waitcnt lgkmcnt(2)
    ds_write_b64 v3, v[52:53] offset:5120
    v_mfma_f32_16x16x32_bf16 v[8:11], a[36:39], v[80:83], v[8:11]
    ds_read_b128 v[64:67], v1 offset:10240
    v_mul_f32 v120, v32, v116
    v_mfma_f32_16x16x32_bf16 v[16:19], a[36:39], v[84:87], v[16:19]
    v_mul_f32 v121, v33, v116
    v_mul_f32 v120, v120, abs(v32)
    v_mfma_f32_16x16x32_bf16 v[20:23], a[40:43], v[84:87], v[20:23]
    v_mul_f32 v121, v121, abs(v33)
    v_cvt_pk_bf16_f32 v32, v120, v121
    v_mfma_f32_16x16x32_bf16 v[12:15], a[40:43], v[80:83], v[12:15]
    ds_read_b128 v[68:71], v1 offset:11264
    v_pk_max_i16 v32, v32, 0
    v_mfma_f32_16x16x32_bf16 v[24:27], a[44:47], v[80:83], v[24:27]
    v_mul_f32 v120, v34, v116
    v_mul_f32 v121, v35, v116
    v_mfma_f32_16x16x32_bf16 v[28:31], a[44:47], v[84:87], v[28:31]
    s_waitcnt lgkmcnt(3)
    v_mul_f32 v120, v120, abs(v34)
    v_mul_f32 v121, v121, abs(v35)
    v_mfma_f32_16x16x32_bf16 v[8:11], a[48:51], v[56:59], v[8:11]
    ds_read_b128 v[72:75], v1 offset:12288
    v_cvt_pk_bf16_f32 v33, v120, v121
    v_mfma_f32_16x16x32_bf16 v[16:19], a[48:51], v[60:63], v[16:19]
    s_waitcnt vmcnt(0)
    v_cmp_ne_u32 vcc, 0, v7
    v_pk_max_i16 v33, v33, 0
    v_mfma_f32_16x16x32_bf16 v[20:23], a[52:55], v[60:63], v[20:23]
    v_mul_f32 v120, v36, v116
    v_mul_f32 v121, v37, v116
    v_mfma_f32_16x16x32_bf16 v[12:15], a[52:55], v[56:59], v[12:15]
    s_cbranch_vccnz L_spin12
L_back13:
    ds_read_b128 v[76:79], v1 offset:13312
    v_mul_f32 v120, v120, abs(v36)
    v_mfma_f32_16x16x32_bf16 v[24:27], a[56:59], v[56:59], v[24:27]
    s_add_u32 s45, s45, 65536
    v_mul_f32 v121, v121, abs(v37)
    v_cvt_pk_bf16_f32 v34, v120, v121
    v_mfma_f32_16x16x32_bf16 v[28:31], a[56:59], v[60:63], v[28:31]
    s_waitcnt vmcnt(0) lgkmcnt(2)
    s_barrier
    v_pk_max_i16 v34, v34, 0
    v_mfma_f32_16x16x32_bf16 v[8:11], a[60:63], v[64:67], v[8:11]
    ds_read_b128 v[80:83], v1 offset:14336
    v_mul_f32 v120, v38, v116
    v_mfma_f32_16x16x32_bf16 v[16:19], a[60:63], v[68:71], v[16:19]
    ds_read_b128 v[48:51], v4 offset:4096
    v_mul_f32 v121, v39, v116
    v_mfma_f32_16x16x32_bf16 v[20:23], a[64:67], v[68:71], v[20:23]
    v_mul_f32 v120, v120, abs(v38)
    v_mul_f32 v121, v121, abs(v39)
    v_mfma_f32_16x16x32_bf16 v[12:15], a[64:67], v[64:67], v[12:15]
    ds_read_b128 v[84:87], v1 offset:15360
    v_cvt_pk_bf16_f32 v35, v120, v121
    v_mfma_f32_16x16x32_bf16 v[24:27], a[68:71], v[64:67], v[24:27]
    v_pk_max_i16 v35, v35, 0
    v_mfma_f32_16x16x32_bf16 v[28:31], a[68:71], v[68:71], v[28:31]
    s_waitcnt lgkmcnt(3)
    s_waitcnt lgkmcnt(1)
    v_mfma_f32_16x16x32_bf16 v[8:11], a[72:75], v[72:75], v[8:11]
    ds_read_b128 v[56:59], v1 offset:16384
    v_mfma_f32_16x16x32_bf16 v[16:19], a[72:75], v[76:79], v[16:19]
    buffer_store_dwordx4 v[48:51], v1, s[16:19], s49 offen sc1
    v_mfma_f32_16x16x32_bf16 v[20:23], a[76:79], v[76:79], v[20:23]
    buffer_store_dwordx4 v[32:35], v1, s[16:19], s44 offen offset:0 sc1
    v_mfma_f32_16x16x32_bf16 v[12:15], a[76:79], v[72:75], v[12:15]
    ds_read_b128 v[60:63], v1 offset:17408
    v_mul_f32 v120, v40, v117
    v_mfma_f32_16x16x32_bf16 v[24:27], a[80:83], v[72:75], v[24:27]
    v_mul_f32 v121, v41, v117
    v_mul_f32 v120, v120, abs(v40)
    v_mfma_f32_16x16x32_bf16 v[28:31], a[80:83], v[76:79], v[28:31]
    s_waitcnt lgkmcnt(2)
    v_mul_f32 v121, v121, abs(v41)
    v_cvt_pk_bf16_f32 v40, v120, v121
    v_mfma_f32_16x16x32_bf16 v[8:11], a[84:87], v[80:83], v[8:11]
    ds_read_b128 v[64:67], v1 offset:18432
    v_pk_max_i16 v40, v40, 0
    v_mfma_f32_16x16x32_bf16 v[16:19], a[84:87], v[84:87], v[16:19]
    v_mul_f32 v120, v42, v117
    v_mul_f32 v121, v43, v117
    v_mfma_f32_16x16x32_bf16 v[20:23], a[88:91], v[84:87], v[20:23]
    v_mul_f32 v120, v120, abs(v42)
    v_mul_f32 v121, v121, abs(v43)
    v_mfma_f32_16x16x32_bf16 v[12:15], a[88:91], v[80:83], v[12:15]
    ds_read_b128 v[68:71], v1 offset:19456
    v_cvt_pk_bf16_f32 v41, v120, v121
    v_mfma_f32_16x16x32_bf16 v[24:27], a[92:95], v[80:83], v[24:27]
    v_pk_max_i16 v41, v41, 0
    v_mul_f32 v120, v44, v117
    v_mfma_f32_16x16x32_bf16 v[28:31], a[92:95], v[84:87], v[28:31]
    s_waitcnt lgkmcnt(2)
    v_mul_f32 v121, v45, v117
    v_mul_f32 v120, v120, abs(v44)
    v_mfma_f32_16x16x32_bf16 v[8:11], a[96:99], v[56:59], v[8:11]
    ds_read_b128 v[72:75], v1 offset:20480
    v_mul_f32 v121, v121, abs(v45)
    v_mfma_f32_16x16x32_bf16 v[16:19], a[96:99], v[60:63], v[16:19]
    v_cvt_pk_bf16_f32 v42, v120, v121
    v_pk_max_i16 v42, v42, 0
    v_mfma_f32_16x16x32_bf16 v[20:23], a[100:103], v[60:63], v[20:23]
    v_mul_f32 v120, v46, v117
    v_mul_f32 v121, v47, v117
    v_mfma_f32_16x16x32_bf16 v[12:15], a[100:103], v[56:59], v[12:15]
    ds_read_b128 v[76:79], v1 offset:21504
    v_mul_f32 v120, v120, abs(v46)
    v_mfma_f32_16x16x32_bf16 v[24:27], a[104:107], v[56:59], v[24:27]
    v_mul_f32 v121, v121, abs(v47)
    v_cvt_pk_bf16_f32 v43, v120, v121
    v_mfma_f32_16x16x32_bf16 v[28:31], a[104:107], v[60:63], v[28:31]
    s_waitcnt lgkmcnt(2)
    v_pk_max_i16 v43, v43, 0
    v_mfma_f32_16x16x32_bf16 v[8:11], a[108:111], v[64:67], v[8:11]
    ds_read_b128 v[80:83], v1 offset:22528
    v_mfma_f32_16x16x32_bf16 v[16:19], a[108:111], v[68:71], v[16:19]
    buffer_store_dwordx4 v[40:43], v1, s[16:19], s44 offen offset:1024 sc1
    v_mfma_f32_16x16x32_bf16 v[20:23], a[112:115], v[68:71], v[20:23]
    s_add_u32 m0, s43, 98304
    ds_read_b64 v[36:37], v118 offset:0
    s_add_u32 s42, s41, 0
    v_mfma_f32_16x16x32_bf16 v[12:15], a[112:115], v[64:67], v[12:15]
    ds_read_b128 v[84:87], v1 offset:23552
    v_mfma_f32_16x16x32_bf16 v[24:27], a[116:119], v[64:67], v[24:27]
    buffer_load_dwordx4 v1, s[16:19], s42 offen offset:0 sc1 lds
    v_mfma_f32_16x16x32_bf16 v[28:31], a[116:119], v[68:71], v[28:31]
    s_waitcnt lgkmcnt(3)
    ds_read_b64 v[38:39], v118 offset:128
    v_mfma_f32_16x16x32_bf16 v[8:11], a[120:123], v[72:75], v[8:11]
    ds_read_b128 v[56:59], v1 offset:24576
    v_mfma_f32_16x16x32_bf16 v[16:19], a[120:123], v[76:79], v[16:19]
    ds_read_b64 v[40:41], v118 offset:256
    v_mfma_f32_16x16x32_bf16 v[20:23], a[124:127], v[76:79], v[20:23]
    ds_read_b64 v[42:43], v118 offset:384
    v_mfma_f32_16x16x32_bf16 v[12:15], a[124:127], v[72:75], v[12:15]
    ds_read_b128 v[60:63], v1 offset:25600
    v_mfma_f32_16x16x32_bf16 v[24:27], a[128:131], v[72:75], v[24:27]
    buffer_load_dwordx4 v1, s[16:19], s42 offen offset:1024 sc1 lds
    v_mfma_f32_16x16x32_bf16 v[28:31], a[128:131], v[76:79], v[28:31]
    s_waitcnt lgkmcnt(5)
    v_mfma_f32_16x16x32_bf16 v[8:11], a[132:135], v[80:83], v[8:11]
    ds_read_b128 v[64:67], v1 offset:26624
    v_mfma_f32_16x16x32_bf16 v[16:19], a[132:135], v[84:87], v[16:19]
    s_waitcnt lgkmcnt(2)
    v_max3_u32 v44, v36, v37, v38
    v_max3_u32 v45, v39, v40, v41
    v_mfma_f32_16x16x32_bf16 v[20:23], a[136:139], v[84:87], v[20:23]
    v_max3_u32 v44, v44, v42, v43
    v_max_u32 v44, v44, v45
    v_mfma_f32_16x16x32_bf16 v[12:15], a[136:139], v[80:83], v[12:15]
    ds_read_b128 v[68:71], v1 offset:27648
    v_cmp_eq_u32 vcc, -1, v44
    v_mfma_f32_16x16x32_bf16 v[24:27], a[140:143], v[80:83], v[24:27]
    buffer_load_dwordx4 v1, s[16:19], s42 offen offset:2048 sc1 lds
    v_mfma_f32_16x16x32_bf16 v[28:31], a[140:143], v[84:87], v[28:31]
    s_waitcnt lgkmcnt(2)
    s_cbranch_vccnz L_sspin14
L_sback15:
    v_add_f32 v44, v40, v42
    v_mfma_f32_16x16x32_bf16 v[8:11], a[144:147], v[56:59], v[8:11]
    ds_read_b128 v[72:75], v1 offset:28672
    v_add_f32 v45, v41, v43
    v_mfma_f32_16x16x32_bf16 v[16:19], a[144:147], v[60:63], v[16:19]
    v_add_f32 v36, v36, v38
    v_add_f32 v37, v37, v39
    v_mfma_f32_16x16x32_bf16 v[20:23], a[148:151], v[60:63], v[20:23]
    v_add_f32 v36, v36, v44
    v_add_f32 v37, v37, v45
    v_mfma_f32_16x16x32_bf16 v[12:15], a[148:151], v[56:59], v[12:15]
    ds_read_b128 v[76:79], v1 offset:29696
    v_mov_b32 v44, v36
    v_mfma_f32_16x16x32_bf16 v[24:27], a[152:155], v[56:59], v[24:27]
    buffer_load_dwordx4 v1, s[16:19], s42 offen offset:3072 sc1 lds
    v_mfma_f32_16x16x32_bf16 v[28:31], a[152:155], v[60:63], v[28:31]
    s_waitcnt lgkmcnt(2)
    v_mov_b32 v45, v37
    s_add_u32 m0, s43, 114688
    v_mfma_f32_16x16x32_bf16 v[8:11], a[156:159], v[64:67], v[8:11]
    s_add_u32 s42, s41, 16384
    ds_read_b128 v[80:83], v1 offset:30720
    v_mfma_f32_16x16x32_bf16 v[16:19], a[156:159], v[68:71], v[16:19]
    v_permlane32_swap_b32 v36, v44
    v_mfma_f32_16x16x32_bf16 v[20:23], a[160:163], v[68:71], v[20:23]
    v_permlane32_swap_b32 v37, v45
    v_mfma_f32_16x16x32_bf16 v[12:15], a[160:163], v[64:67], v[12:15]
    ds_read_b128 v[84:87], v1 offset:31744
    v_add_f32 v36, v36, v44
    v_mfma_f32_16x16x32_bf16 v[24:27], a[164:167], v[64:67], v[24:27]
    buffer_load_dwordx4 v1, s[16:19], s42 offen offset:0 sc1 lds
    v_mfma_f32_16x16x32_bf16 v[28:31], a[164:167], v[68:71], v[28:31]
    s_waitcnt lgkmcnt(2)
    v_add_f32 v37, v37, v45
    v_mul_f32 v112, 0xba800000, v36
    v_mfma_f32_16x16x32_bf16 v[8:11], a[168:171], v[72:75], v[8:11]
    ds_read_b128 v[56:59], v1 offset:32768
    v_mul_f32 v37, 0x3a800000, v37
    v_mfma_f32_16x16x32_bf16 v[16:19], a[168:171], v[76:79], v[16:19]
    v_fma_f32 v37, -v112, v112, v37
    v_mov_b32 v113, v112
    v_mfma_f32_16x16x32_bf16 v[20:23], a[172:175], v[76:79], v[20:23]
    v_max_f32 v37, 0, v37
    v_add_f32 v37, 0x3727c5ac, v37
    v_mfma_f32_16x16x32_bf16 v[12:15], a[172:175], v[72:75], v[12:15]
    ds_read_b128 v[60:63], v1 offset:33792
    v_mfma_f32_16x16x32_bf16 v[24:27], a[176:179], v[72:75], v[24:27]
    buffer_load_dwordx4 v1, s[16:19], s42 offen offset:1024 sc1 lds
    v_mfma_f32_16x16x32_bf16 v[28:31], a[176:179], v[76:79], v[28:31]
    s_waitcnt lgkmcnt(2)
    v_rsq_f32 v116, v37
    v_mfma_f32_16x16x32_bf16 v[8:11], a[180:183], v[80:83], v[8:11]
    ds_read_b128 v[64:67], v1 offset:34816
    v_mfma_f32_16x16x32_bf16 v[16:19], a[180:183], v[84:87], v[16:19]
    v_permlane16_swap_b32 v112, v113
    v_mfma_f32_16x16x32_bf16 v[20:23], a[184:187], v[84:87], v[20:23]
    v_mul_f32 v114, v37, v116
    v_mul_f32 v116, v116, v116
    v_mfma_f32_16x16x32_bf16 v[12:15], a[184:187], v[80:83], v[12:15]
    ds_read_b128 v[68:71], v1 offset:35840
    v_mov_b32 v115, v114
    v_mfma_f32_16x16x32_bf16 v[24:27], a[188:191], v[80:83], v[24:27]
    buffer_load_dwordx4 v1, s[16:19], s42 offen offset:2048 sc1 lds
    v_mfma_f32_16x16x32_bf16 v[28:31], a[188:191], v[84:87], v[28:31]
    s_waitcnt lgkmcnt(2)
    v_mov_b32 v117, v116
    v_fmac_f32 v16, v113, v88
    v_mfma_f32_16x16x32_bf16 v[8:11], a[192:195], v[56:59], v[8:11]
    ds_read_b128 v[72:75], v1 offset:36864
    v_fmac_f32 v12, v112, v92
    v_mfma_f32_16x16x32_bf16 v[16:19], a[192:195], v[60:63], v[16:19]
    v_permlane16_swap_b32 v114, v115
    v_mfma_f32_16x16x32_bf16 v[20:23], a[196:199], v[60:63], v[20:23]
    v_permlane16_swap_b32 v116, v117
    v_mfma_f32_16x16x32_bf16 v[12:15], a[196:199], v[56:59], v[12:15]
    s_add_u32 s46, s46, 2048
    ds_read_b128 v[76:79], v1 offset:37888
    v_fmac_f32 v8, v112, v88
    v_mfma_f32_16x16x32_bf16 v[24:27], a[200:203], v[56:59], v[24:27]
    buffer_load_dwordx4 v1, s[16:19], s42 offen offset:3072 sc1 lds
    v_mfma_f32_16x16x32_bf16 v[28:31], a[200:203], v[60:63], v[28:31]
    s_waitcnt lgkmcnt(2)
    v_fmac_f32 v17, v113, v89
    v_fmac_f32 v18, v113, v90
    v_mfma_f32_16x16x32_bf16 v[8:11], a[204:207], v[64:67], v[8:11]
    s_add_u32 m0, s43, 131072
    ds_read_b128 v[80:83], v1 offset:38912
    v_fmac_f32 v13, v112, v93
    v_mfma_f32_16x16x32_bf16 v[16:19], a[204:207], v[68:71], v[16:19]
    s_add_u32 s42, s41, 32768
    v_fmac_f32 v14, v112, v94
    v_fmac_f32 v15, v112, v95
    v_mfma_f32_16x16x32_bf16 v[20:23], a[208:211], v[68:71], v[20:23]
    s_min_u32 s46, s46, s55
    v_fmac_f32 v9, v112, v89
    v_fmac_f32 v10, v112, v90
    v_mfma_f32_16x16x32_bf16 v[12:15], a[208:211], v[64:67], v[12:15]
    ds_read_b128 v[84:87], v1 offset:39936
    v_fmac_f32 v11, v112, v91
    v_mfma_f32_16x16x32_bf16 v[24:27], a[212:215], v[64:67], v[24:27]
    buffer_load_dwordx4 v1, s[16:19], s42 offen offset:0 sc1 lds
    v_mfma_f32_16x16x32_bf16 v[28:31], a[212:215], v[68:71], v[28:31]
    s_waitcnt lgkmcnt(2)
    v_fmac_f32 v19, v113, v91
    v_fmac_f32 v16, v115, v100
    v_mfma_f32_16x16x32_bf16 v[8:11], a[216:219], v[72:75], v[8:11]
    ds_read_b128 v[56:59], v1 offset:40960
    v_fmac_f32 v12, v114, v104
    v_mfma_f32_16x16x32_bf16 v[16:19], a[216:219], v[76:79], v[16:19]
    v_fmac_f32 v13, v114, v105
    v_fmac_f32 v14, v114, v106
    v_mfma_f32_16x16x32_bf16 v[20:23], a[220:223], v[76:79], v[20:23]
    v_fmac_f32 v8, v114, v100
    v_fmac_f32 v9, v114, v101
    v_mfma_f32_16x16x32_bf16 v[12:15], a[220:223], v[72:75], v[12:15]
    ds_read_b128 v[60:63], v1 offset:41984
    v_fmac_f32 v10, v114, v102
    v_mfma_f32_16x16x32_bf16 v[24:27], a[224:227], v[72:75], v[24:27]
    buffer_load_dwordx4 v1, s[16:19], s42 offen offset:1024 sc1 lds
    v_mfma_f32_16x16x32_bf16 v[28:31], a[224:227], v[76:79], v[28:31]
    s_waitcnt lgkmcnt(2)
    v_fmac_f32 v17, v115, v101
    v_fmac_f32 v18, v115, v102
    v_mfma_f32_16x16x32_bf16 v[8:11], a[228:231], v[80:83], v[8:11]
    ds_read_b128 v[64:67], v1 offset:43008
    v_fmac_f32 v15, v114, v107
    v_mfma_f32_16x16x32_bf16 v[16:19], a[228:231], v[84:87], v[16:19]
    v_fmac_f32 v24, v112, v96
    v_fmac_f32 v25, v112, v97
    v_mfma_f32_16x16x32_bf16 v[20:23], a[232:235], v[84:87], v[20:23]
    v_fmac_f32 v11, v114, v103
    v_fmac_f32 v26, v112, v98
    v_mfma_f32_16x16x32_bf16 v[12:15], a[232:235], v[80:83], v[12:15]
    ds_read_b128 v[68:71], v1 offset:44032
    v_fmac_f32 v19, v115, v103
    v_mfma_f32_16x16x32_bf16 v[24:27], a[236:239], v[80:83], v[24:27]
    buffer_load_dwordx4 v1, s[16:19], s42 offen offset:2048 sc1 lds
    v_mfma_f32_16x16x32_bf16 v[28:31], a[236:239], v[84:87], v[28:31]
    s_waitcnt lgkmcnt(2)
    v_fmac_f32 v20, v113, v92
    v_fmac_f32 v21, v113, v93
    v_mfma_f32_16x16x32_bf16 v[8:11], a[240:243], v[56:59], v[8:11]
    s_waitcnt vmcnt(7)
    ds_read_b128 v[72:75], v1 offset:45056
    v_fmac_f32 v22, v113, v94
    v_mfma_f32_16x16x32_bf16 v[16:19], a[240:243], v[60:63], v[16:19]
    s_barrier
    v_fmac_f32 v27, v112, v99
    v_fmac_f32 v24, v114, v108
    v_mfma_f32_16x16x32_bf16 v[20:23], a[244:247], v[60:63], v[20:23]
    buffer_store_dword v124, v124, s[16:19], s91 offen sc1
    v_mfma_f32_16x16x32_bf16 v[12:15], a[244:247], v[56:59], v[12:15]
    s_add_u32 s91, s91, 65536
    ds_read_b128 v[76:79], v1 offset:46080
    v_fmac_f32 v28, v113, v96
    v_mfma_f32_16x16x32_bf16 v[24:27], a[248:251], v[56:59], v[24:27]
    buffer_load_dwordx4 v1, s[16:19], s42 offen offset:3072 sc1 lds
    v_mfma_f32_16x16x32_bf16 v[28:31], a[248:251], v[60:63], v[28:31]
    s_waitcnt lgkmcnt(2)
    v_fmac_f32 v23, v113, v95
    v_fmac_f32 v20, v115, v104
    v_mfma_f32_16x16x32_bf16 v[8:11], a[252:255], v[64:67], v[8:11]
    s_add_u32 m0, s43, 147456
    ds_read_b128 v[80:83], v1 offset:47104
    v_fmac_f32 v21, v115, v105
    v_mfma_f32_16x16x32_bf16 v[16:19], a[252:255], v[68:71], v[16:19]
    s_add_u32 s42, s41, 49152
    v_fmac_f32 v25, v114, v109
    v_fmac_f32 v26, v114, v110
    v_mfma_f32_16x16x32_bf16 v[20:23], v[128:131], v[68:71], v[20:23]
    v_fmac_f32 v27, v114, v111
    v_fmac_f32 v29, v113, v97
    v_mfma_f32_16x16x32_bf16 v[12:15], v[128:131], v[64:67], v[12:15]
    ds_read_b128 v[84:87], v1 offset:48128
    v_fmac_f32 v30, v113, v98
    v_mfma_f32_16x16x32_bf16 v[24:27], v[132:135], v[64:67], v[24:27]
    buffer_load_dwordx4 v1, s[16:19], s42 offen offset:0 sc1 lds
    v_mfma_f32_16x16x32_bf16 v[28:31], v[132:135], v[68:71], v[28:31]
    s_waitcnt lgkmcnt(2)
    v_fmac_f32 v22, v115, v106
    v_fmac_f32 v23, v115, v107
    v_mfma_f32_16x16x32_bf16 v[8:11], v[136:139], v[72:75], v[8:11]
    ds_read_b128 v[56:59], v1 offset:49152
    v_mfma_f32_16x16x32_bf16 v[16:19], v[136:139], v[76:79], v[16:19]
    v_fmac_f32 v31, v113, v99
    v_fmac_f32 v28, v115, v108
    v_mfma_f32_16x16x32_bf16 v[20:23], v[140:143], v[76:79], v[20:23]
    v_fmac_f32 v29, v115, v109
    v_fmac_f32 v30, v115, v110
    v_mfma_f32_16x16x32_bf16 v[12:15], v[140:143], v[72:75], v[12:15]
    ds_read_b128 v[60:63], v1 offset:50176
    v_fmac_f32 v31, v115, v111
    v_mfma_f32_16x16x32_bf16 v[24:27], v[144:147], v[72:75], v[24:27]
    buffer_load_dwordx4 v1, s[16:19], s42 offen offset:1024 sc1 lds
    v_mfma_f32_16x16x32_bf16 v[28:31], v[144:147], v[76:79], v[28:31]
    s_waitcnt lgkmcnt(2)
    v_mfma_f32_16x16x32_bf16 v[8:11], v[148:151], v[80:83], v[8:11]
    ds_read_b128 v[64:67], v1 offset:51200
    v_mfma_f32_16x16x32_bf16 v[16:19], v[148:151], v[84:87], v[16:19]
    v_mfma_f32_16x16x32_bf16 v[20:23], v[152:155], v[84:87], v[20:23]
    v_mfma_f32_16x16x32_bf16 v[12:15], v[152:155], v[80:83], v[12:15]
    ds_read_b128 v[68:71], v1 offset:52224
    v_mfma_f32_16x16x32_bf16 v[24:27], v[156:159], v[80:83], v[24:27]
    buffer_load_dwordx4 v1, s[16:19], s42 offen offset:2048 sc1 lds
    v_mfma_f32_16x16x32_bf16 v[28:31], v[156:159], v[84:87], v[28:31]
    s_waitcnt lgkmcnt(2)
    v_mfma_f32_16x16x32_bf16 v[8:11], v[160:163], v[56:59], v[8:11]
    ds_read_b128 v[72:75], v1 offset:53248
    v_mfma_f32_16x16x32_bf16 v[16:19], v[160:163], v[60:63], v[16:19]
    v_mfma_f32_16x16x32_bf16 v[20:23], v[164:167], v[60:63], v[20:23]
    v_mfma_f32_16x16x32_bf16 v[12:15], v[164:167], v[56:59], v[12:15]
    ds_read_b128 v[76:79], v1 offset:54272
    v_mfma_f32_16x16x32_bf16 v[24:27], v[168:171], v[56:59], v[24:27]
    buffer_load_dwordx4 v1, s[16:19], s42 offen offset:3072 sc1 lds
    v_mfma_f32_16x16x32_bf16 v[28:31], v[168:171], v[60:63], v[28:31]
    s_waitcnt lgkmcnt(2)
    s_add_u32 m0, s52, 73728
    s_add_u32 s42, s46, s52
    v_mfma_f32_16x16x32_bf16 v[8:11], v[172:175], v[64:67], v[8:11]
    ds_read_b128 v[80:83], v1 offset:55296
    v_mfma_f32_16x16x32_bf16 v[16:19], v[172:175], v[68:71], v[16:19]
    v_mfma_f32_16x16x32_bf16 v[20:23], v[176:179], v[68:71], v[20:23]
    buffer_load_dwordx4 v1, s[16:19], s42 offen sc1 lds
    v_mfma_f32_16x16x32_bf16 v[12:15], v[176:179], v[64:67], v[12:15]
    ds_read_b128 v[84:87], v1 offset:56320
    v_mfma_f32_16x16x32_bf16 v[24:27], v[180:183], v[64:67], v[24:27]
    v_mfma_f32_16x16x32_bf16 v[28:31], v[180:183], v[68:71], v[28:31]
    s_waitcnt lgkmcnt(2)
    v_mfma_f32_16x16x32_bf16 v[8:11], v[184:187], v[72:75], v[8:11]
    ds_read_b128 v[56:59], v1 offset:57344
    v_mfma_f32_16x16x32_bf16 v[16:19], v[184:187], v[76:79], v[16:19]
    v_mfma_f32_16x16x32_bf16 v[20:23], v[188:191], v[76:79], v[20:23]
    v_mfma_f32_16x16x32_bf16 v[12:15], v[188:191], v[72:75], v[12:15]
    ds_read_b128 v[60:63], v1 offset:58368
    v_mfma_f32_16x16x32_bf16 v[24:27], v[192:195], v[72:75], v[24:27]
    v_mfma_f32_16x16x32_bf16 v[28:31], v[192:195], v[76:79], v[28:31]
    s_waitcnt lgkmcnt(2)
    v_mfma_f32_16x16x32_bf16 v[8:11], v[196:199], v[80:83], v[8:11]
    ds_read_b128 v[64:67], v1 offset:59392
    v_mfma_f32_16x16x32_bf16 v[16:19], v[196:199], v[84:87], v[16:19]
    v_mfma_f32_16x16x32_bf16 v[20:23], v[200:203], v[84:87], v[20:23]
    v_mfma_f32_16x16x32_bf16 v[12:15], v[200:203], v[80:83], v[12:15]
    ds_read_b128 v[68:71], v1 offset:60416
    v_mfma_f32_16x16x32_bf16 v[24:27], v[204:207], v[80:83], v[24:27]
    v_mfma_f32_16x16x32_bf16 v[28:31], v[204:207], v[84:87], v[28:31]
    s_waitcnt lgkmcnt(2)
    v_mfma_f32_16x16x32_bf16 v[8:11], v[208:211], v[56:59], v[8:11]
    ds_read_b128 v[72:75], v1 offset:61440
    v_mfma_f32_16x16x32_bf16 v[16:19], v[208:211], v[60:63], v[16:19]
    v_mfma_f32_16x16x32_bf16 v[20:23], v[212:215], v[60:63], v[20:23]
    buffer_load_dword v7, v5, s[16:19], s45 offen sc1
    v_mfma_f32_16x16x32_bf16 v[12:15], v[212:215], v[56:59], v[12:15]
    ds_read_b128 v[76:79], v1 offset:62464
    v_mfma_f32_16x16x32_bf16 v[24:27], v[216:219], v[56:59], v[24:27]
    v_mfma_f32_16x16x32_bf16 v[28:31], v[216:219], v[60:63], v[28:31]
    s_waitcnt lgkmcnt(2)
    v_mfma_f32_16x16x32_bf16 v[8:11], v[220:223], v[64:67], v[8:11]
    ds_read_b128 v[80:83], v1 offset:63488
    v_mfma_f32_16x16x32_bf16 v[16:19], v[220:223], v[68:71], v[16:19]
    v_mfma_f32_16x16x32_bf16 v[20:23], v[224:227], v[68:71], v[20:23]
    v_mfma_f32_16x16x32_bf16 v[12:15], v[224:227], v[64:67], v[12:15]
    ds_read_b128 v[84:87], v1 offset:64512
    v_mfma_f32_16x16x32_bf16 v[24:27], v[228:231], v[64:67], v[24:27]
    v_mfma_f32_16x16x32_bf16 v[28:31], v[228:231], v[68:71], v[28:31]
    s_waitcnt lgkmcnt(2)
    v_mfma_f32_16x16x32_bf16 v[8:11], v[232:235], v[72:75], v[8:11]
    ds_read_b128 v[56:59], v2 offset:0
    v_mfma_f32_16x16x32_bf16 v[16:19], v[232:235], v[76:79], v[16:19]
    v_mfma_f32_16x16x32_bf16 v[20:23], v[236:239], v[76:79], v[20:23]
    v_mfma_f32_16x16x32_bf16 v[12:15], v[236:239], v[72:75], v[12:15]
    ds_read_b128 v[60:63], v2 offset:1024
    v_mfma_f32_16x16x32_bf16 v[24:27], v[240:243], v[72:75], v[24:27]
    v_mfma_f32_16x16x32_bf16 v[28:31], v[240:243], v[76:79], v[28:31]
    s_waitcnt lgkmcnt(2)
    v_mfma_f32_16x16x32_bf16 v[8:11], v[244:247], v[80:83], v[8:11]
    ds_read_b128 v[64:67], v2 offset:2048
    v_mfma_f32_16x16x32_bf16 v[16:19], v[244:247], v[84:87], v[16:19]
    v_mfma_f32_16x16x32_bf16 v[20:23], v[248:251], v[84:87], v[20:23]
    v_mfma_f32_16x16x32_bf16 v[12:15], v[248:251], v[80:83], v[12:15]
    ds_read_b128 v[68:71], v2 offset:3072
    v_mfma_f32_16x16x32_bf16 v[24:27], v[252:255], v[80:83], v[24:27]
    v_mfma_f32_16x16x32_bf16 v[28:31], v[252:255], v[84:87], v[28:31]
    s_add_u32 s36, s36, 1
L_a_b1:
    s_waitcnt lgkmcnt(2)
    v_mfma_f32_16x16x32_bf16 v[32:35], a[0:3], v[56:59], 0
    s_and_b32 s44, s90, 0xffffffff
    ds_read_b128 v[72:75], v2 offset:4096
    v_mul_f32 v120, v24, v116
    v_mfma_f32_16x16x32_bf16 v[40:43], a[0:3], v[60:63], 0
    s_cmp_lt_i32 s36, 1
    v_mul_f32 v121, v25, v116
    v_mul_f32 v120, v120, abs(v24)
    v_mfma_f32_16x16x32_bf16 v[44:47], a[4:7], v[60:63], 0
    s_cselect_b32 s44, 0x5e00000, s44
    v_mul_f32 v121, v121, abs(v25)
    v_cvt_pk_bf16_f32 v24, v120, v121
    v_mfma_f32_16x16x32_bf16 v[36:39], a[4:7], v[56:59], 0
    s_add_u32 s49, s44, s87
    ds_read_b128 v[76:79], v2 offset:5120
    v_pk_max_i16 v24, v24, 0
    v_mfma_f32_16x16x32_bf16 v[48:51], a[8:11], v[56:59], 0
    s_max_u32 s44, s44, s88
    v_mul_f32 v120, v26, v116
    v_mul_f32 v121, v27, v116
    v_mfma_f32_16x16x32_bf16 v[52:55], a[8:11], v[60:63], 0
    s_waitcnt lgkmcnt(2)
    v_mul_f32 v120, v120, abs(v26)
    v_mul_f32 v121, v121, abs(v27)
    v_mfma_f32_16x16x32_bf16 v[32:35], a[12:15], v[64:67], v[32:35]
    s_add_u32 s90, s90, 262144
    ds_read_b128 v[80:83], v2 offset:6144
    v_cvt_pk_bf16_f32 v25, v120, v121
    v_mfma_f32_16x16x32_bf16 v[40:43], a[12:15], v[68:71], v[40:43]
    s_add_u32 s98, s98, 65536
    v_pk_max_i16 v25, v25, 0
    s_min_i32 s98, s98, s96
    v_mfma_f32_16x16x32_bf16 v[44:47], a[16:19], v[68:71], v[44:47]
    s_and_b32 s41, s98, 0xffffffff
    ds_write_b64 v3, v[24:25] offset:0
    v_mfma_f32_16x16x32_bf16 v[36:39], a[16:19], v[64:67], v[36:39]
    ds_read_b128 v[84:87], v2 offset:7168
    v_mul_f32 v120, v28, v117
    v_mfma_f32_16x16x32_bf16 v[48:51], a[20:23], v[64:67], v[48:51]
    v_mul_f32 v121, v29, v117
    v_mul_f32 v120, v120, abs(v28)
    v_mfma_f32_16x16x32_bf16 v[52:55], a[20:23], v[68:71], v[52:55]
    s_waitcnt lgkmcnt(3)
    v_mul_f32 v121, v121, abs(v29)
    v_cvt_pk_bf16_f32 v28, v120, v121
    v_mfma_f32_16x16x32_bf16 v[32:35], a[24:27], v[72:75], v[32:35]
    ds_read_b128 v[56:59], v2 offset:8192
    v_pk_max_i16 v28, v28, 0
    v_mfma_f32_16x16x32_bf16 v[40:43], a[24:27], v[76:79], v[40:43]
    v_mul_f32 v120, v30, v117
    v_mul_f32 v121, v31, v117
    v_mfma_f32_16x16x32_bf16 v[44:47], a[28:31], v[76:79], v[44:47]
    v_mul_f32 v120, v120, abs(v30)
    v_mul_f32 v121, v121, abs(v31)
    v_mfma_f32_16x16x32_bf16 v[36:39], a[28:31], v[72:75], v[36:39]
    ds_read_b128 v[60:63], v2 offset:9216
    v_cvt_pk_bf16_f32 v29, v120, v121
    v_mfma_f32_16x16x32_bf16 v[48:51], a[32:35], v[72:75], v[48:51]
    v_pk_max_i16 v29, v29, 0
    v_mfma_f32_16x16x32_bf16 v[52:55], a[32:35], v[76:79], v[52:55]
    s_waitcnt lgkmcnt(2)
    ds_write_b64 v3, v[28:29] offset:1024
    v_mfma_f32_16x16x32_bf16 v[32:35], a[36:39], v[80:83], v[32:35]
    ds_read_b128 v[64:67], v2 offset:10240
    v_mul_f32 v120, v8, v116
    v_mfma_f32_16x16x32_bf16 v[40:43], a[36:39], v[84:87], v[40:43]
    v_mul_f32 v121, v9, v116
    v_mul_f32 v120, v120, abs(v8)
    v_mfma_f32_16x16x32_bf16 v[44:47], a[40:43], v[84:87], v[44:47]
    v_mul_f32 v121, v121, abs(v9)
    v_cvt_pk_bf16_f32 v8, v120, v121
    v_mfma_f32_16x16x32_bf16 v[36:39], a[40:43], v[80:83], v[36:39]
    ds_read_b128 v[68:71], v2 offset:11264
    v_pk_max_i16 v8, v8, 0
    v_mfma_f32_16x16x32_bf16 v[48:51], a[44:47], v[80:83], v[48:51]
    v_mul_f32 v120, v10, v116
    v_mul_f32 v121, v11, v116
    v_mfma_f32_16x16x32_bf16 v[52:55], a[44:47], v[84:87], v[52:55]
    s_waitcnt lgkmcnt(3)
    v_mul_f32 v120, v120, abs(v10)
    v_mul_f32 v121, v121, abs(v11)
    v_mfma_f32_16x16x32_bf16 v[32:35], a[48:51], v[56:59], v[32:35]
    ds_read_b128 v[72:75], v2 offset:12288
    v_cvt_pk_bf16_f32 v9, v120, v121
    v_mfma_f32_16x16x32_bf16 v[40:43], a[48:51], v[60:63], v[40:43]
    s_waitcnt vmcnt(0)
    v_cmp_ne_u32 vcc, 0, v7
    v_pk_max_i16 v9, v9, 0
    v_mfma_f32_16x16x32_bf16 v[44:47], a[52:55], v[60:63], v[44:47]
    v_mul_f32 v120, v12, v116
    v_mul_f32 v121, v13, v116
    v_mfma_f32_16x16x32_bf16 v[36:39], a[52:55], v[56:59], v[36:39]
    s_cbranch_vccnz L_spin16
L_back17:
    ds_read_b128 v[76:79], v2 offset:13312
    v_mul_f32 v120, v120, abs(v12)
    v_mfma_f32_16x16x32_bf16 v[48:51], a[56:59], v[56:59], v[48:51]
    s_add_u32 s45, s45, 65536
    v_mul_f32 v121, v121, abs(v13)
    v_cvt_pk_bf16_f32 v10, v120, v121
    v_mfma_f32_16x16x32_bf16 v[52:55], a[56:59], v[60:63], v[52:55]
    s_waitcnt vmcnt(0) lgkmcnt(2)
    s_barrier
    v_pk_max_i16 v10, v10, 0
    v_mfma_f32_16x16x32_bf16 v[32:35], a[60:63], v[64:67], v[32:35]
    ds_read_b128 v[80:83], v2 offset:14336
    v_mul_f32 v120, v14, v116
    v_mfma_f32_16x16x32_bf16 v[40:43], a[60:63], v[68:71], v[40:43]
    ds_read_b128 v[24:27], v4 offset:0
    v_mul_f32 v121, v15, v116
    v_mfma_f32_16x16x32_bf16 v[44:47], a[64:67], v[68:71], v[44:47]
    v_mul_f32 v120, v120, abs(v14)
    v_mul_f32 v121, v121, abs(v15)
    v_mfma_f32_16x16x32_bf16 v[36:39], a[64:67], v[64:67], v[36:39]
    ds_read_b128 v[84:87], v2 offset:15360
    v_cvt_pk_bf16_f32 v11, v120, v121
    v_mfma_f32_16x16x32_bf16 v[48:51], a[68:71], v[64:67], v[48:51]
    v_pk_max_i16 v11, v11, 0
    v_mfma_f32_16x16x32_bf16 v[52:55], a[68:71], v[68:71], v[52:55]
    s_waitcnt lgkmcnt(3)
    s_waitcnt lgkmcnt(1)
    v_mfma_f32_16x16x32_bf16 v[32:35], a[72:75], v[72:75], v[32:35]
    ds_read_b128 v[56:59], v2 offset:16384
    v_mfma_f32_16x16x32_bf16 v[40:43], a[72:75], v[76:79], v[40:43]
    buffer_store_dwordx4 v[24:27], v1, s[16:19], s49 offen sc1
    v_mfma_f32_16x16x32_bf16 v[44:47], a[76:79], v[76:79], v[44:47]
    buffer_store_dwordx4 v[8:11], v1, s[16:19], s44 offen offset:0 sc1
    v_mfma_f32_16x16x32_bf16 v[36:39], a[76:79], v[72:75], v[36:39]
    ds_read_b128 v[60:63], v2 offset:17408
    v_mul_f32 v120, v16, v117
    v_mfma_f32_16x16x32_bf16 v[48:51], a[80:83], v[72:75], v[48:51]
    v_mul_f32 v121, v17, v117
    v_mul_f32 v120, v120, abs(v16)
    v_mfma_f32_16x16x32_bf16 v[52:55], a[80:83], v[76:79], v[52:55]
    s_waitcnt lgkmcnt(2)
    v_mul_f32 v121, v121, abs(v17)
    v_cvt_pk_bf16_f32 v16, v120, v121
    v_mfma_f32_16x16x32_bf16 v[32:35], a[84:87], v[80:83], v[32:35]
    ds_read_b128 v[64:67], v2 offset:18432
    v_pk_max_i16 v16, v16, 0
    v_mfma_f32_16x16x32_bf16 v[40:43], a[84:87], v[84:87], v[40:43]
    v_mul_f32 v120, v18, v117
    v_mul_f32 v121, v19, v117
    v_mfma_f32_16x16x32_bf16 v[44:47], a[88:91], v[84:87], v[44:47]
    v_mul_f32 v120, v120, abs(v18)
    v_mul_f32 v121, v121, abs(v19)
    v_mfma_f32_16x16x32_bf16 v[36:39], a[88:91], v[80:83], v[36:39]
    ds_read_b128 v[68:71], v2 offset:19456
    v_cvt_pk_bf16_f32 v17, v120, v121
    v_mfma_f32_16x16x32_bf16 v[48:51], a[92:95], v[80:83], v[48:51]
    v_pk_max_i16 v17, v17, 0
    v_mul_f32 v120, v20, v117
    v_mfma_f32_16x16x32_bf16 v[52:55], a[92:95], v[84:87], v[52:55]
    s_waitcnt lgkmcnt(2)
    v_mul_f32 v121, v21, v117
    v_mul_f32 v120, v120, abs(v20)
    v_mfma_f32_16x16x32_bf16 v[32:35], a[96:99], v[56:59], v[32:35]
    ds_read_b128 v[72:75], v2 offset:20480
    v_mul_f32 v121, v121, abs(v21)
    v_mfma_f32_16x16x32_bf16 v[40:43], a[96:99], v[60:63], v[40:43]
    v_cvt_pk_bf16_f32 v18, v120, v121
    v_pk_max_i16 v18, v18, 0
    v_mfma_f32_16x16x32_bf16 v[44:47], a[100:103], v[60:63], v[44:47]
    v_mul_f32 v120, v22, v117
    v_mul_f32 v121, v23, v117
    v_mfma_f32_16x16x32_bf16 v[36:39], a[100:103], v[56:59], v[36:39]
    ds_read_b128 v[76:79], v2 offset:21504
    v_mul_f32 v120, v120, abs(v22)
    v_mfma_f32_16x16x32_bf16 v[48:51], a[104:107], v[56:59], v[48:51]
    v_mul_f32 v121, v121, abs(v23)
    v_cvt_pk_bf16_f32 v19, v120, v121
    v_mfma_f32_16x16x32_bf16 v[52:55], a[104:107], v[60:63], v[52:55]
    s_waitcnt lgkmcnt(2)
    v_pk_max_i16 v19, v19, 0
    v_mfma_f32_16x16x32_bf16 v[32:35], a[108:111], v[64:67], v[32:35]
    ds_read_b128 v[80:83], v2 offset:22528
    v_mfma_f32_16x16x32_bf16 v[40:43], a[108:111], v[68:71], v[40:43]
    buffer_store_dwordx4 v[16:19], v1, s[16:19], s44 offen offset:1024 sc1
    v_mfma_f32_16x16x32_bf16 v[44:47], a[112:115], v[68:71], v[44:47]
    s_add_u32 m0, s43, 0
    ds_read_b64 v[12:13], v118 offset:0
    s_add_u32 s42, s41, 0
    v_mfma_f32_16x16x32_bf16 v[36:39], a[112:115], v[64:67], v[36:39]
    ds_read_b128 v[84:87], v2 offset:23552
    v_mfma_f32_16x16x32_bf16 v[48:51], a[116:119], v[64:67], v[48:51]
    buffer_load_dwordx4 v1, s[16:19], s42 offen offset:0 sc1 lds
    v_mfma_f32_16x16x32_bf16 v[52:55], a[116:119], v[68:71], v[52:55]
    s_waitcnt lgkmcnt(3)
    ds_read_b64 v[14:15], v118 offset:128
    v_mfma_f32_16x16x32_bf16 v[32:35], a[120:123], v[72:75], v[32:35]
    ds_read_b128 v[56:59], v2 offset:24576
    v_mfma_f32_16x16x32_bf16 v[40:43], a[120:123], v[76:79], v[40:43]
    ds_read_b64 v[16:17], v118 offset:256
    v_mfma_f32_16x16x32_bf16 v[44:47], a[124:127], v[76:79], v[44:47]
    ds_read_b64 v[18:19], v118 offset:384
    v_mfma_f32_16x16x32_bf16 v[36:39], a[124:127], v[72:75], v[36:39]
    ds_read_b128 v[60:63], v2 offset:25600
    v_mfma_f32_16x16x32_bf16 v[48:51], a[128:131], v[72:75], v[48:51]
    buffer_load_dwordx4 v1, s[16:19], s42 offen offset:1024 sc1 lds
    v_mfma_f32_16x16x32_bf16 v[52:55], a[128:131], v[76:79], v[52:55]
    s_waitcnt lgkmcnt(5)
    v_mfma_f32_16x16x32_bf16 v[32:35], a[132:135], v[80:83], v[32:35]
    ds_read_b128 v[64:67], v2 offset:26624
    v_mfma_f32_16x16x32_bf16 v[40:43], a[132:135], v[84:87], v[40:43]
    s_waitcnt lgkmcnt(2)
    v_max3_u32 v20, v12, v13, v14
    v_max3_u32 v21, v15, v16, v17
    v_mfma_f32_16x16x32_bf16 v[44:47], a[136:139], v[84:87], v[44:47]
    v_max3_u32 v20, v20, v18, v19
    v_max_u32 v20, v20, v21
    v_mfma_f32_16x16x32_bf16 v[36:39], a[136:139], v[80:83], v[36:39]
    ds_read_b128 v[68:71], v2 offset:27648
    v_cmp_eq_u32 vcc, -1, v20
    v_mfma_f32_16x16x32_bf16 v[48:51], a[140:143], v[80:83], v[48:51]
    buffer_load_dwordx4 v1, s[16:19], s42 offen offset:2048 sc1 lds
    v_mfma_f32_16x16x32_bf16 v[52:55], a[140:143], v[84:87], v[52:55]
    s_waitcnt lgkmcnt(2)
    s_cbranch_vccnz L_sspin18
L_sback19:
    v_add_f32 v20, v16, v18
    v_mfma_f32_16x16x32_bf16 v[32:35], a[144:147], v[56:59], v[32:35]
    ds_read_b128 v[72:75], v2 offset:28672
    v_add_f32 v21, v17, v19
    v_mfma_f32_16x16x32_bf16 v[40:43], a[144:147], v[60:63], v[40:43]
    v_add_f32 v12, v12, v14
    v_add_f32 v13, v13, v15
    v_mfma_f32_16x16x32_bf16 v[44:47], a[148:151], v[60:63], v[44:47]
    v_add_f32 v12, v12, v20
    v_add_f32 v13, v13, v21
    v_mfma_f32_16x16x32_bf16 v[36:39], a[148:151], v[56:59], v[36:39]
    ds_read_b128 v[76:79], v2 offset:29696
    v_mov_b32 v20, v12
    v_mfma_f32_16x16x32_bf16 v[48:51], a[152:155], v[56:59], v[48:51]
    buffer_load_dwordx4 v1, s[16:19], s42 offen offset:3072 sc1 lds
    v_mfma_f32_16x16x32_bf16 v[52:55], a[152:155], v[60:63], v[52:55]
    s_waitcnt lgkmcnt(2)
    v_mov_b32 v21, v13
    s_add_u32 m0, s43, 16384
    v_mfma_f32_16x16x32_bf16 v[32:35], a[156:159], v[64:67], v[32:35]
    s_add_u32 s42, s41, 16384
    ds_read_b128 v[80:83], v2 offset:30720
    v_mfma_f32_16x16x32_bf16 v[40:43], a[156:159], v[68:71], v[40:43]
    v_permlane32_swap_b32 v12, v20
    v_mfma_f32_16x16x32_bf16 v[44:47], a[160:163], v[68:71], v[44:47]
    v_permlane32_swap_b32 v13, v21
    v_mfma_f32_16x16x32_bf16 v[36:39], a[160:163], v[64:67], v[36:39]
    ds_read_b128 v[84:87], v2 offset:31744
    v_add_f32 v12, v12, v20
    v_mfma_f32_16x16x32_bf16 v[48:51], a[164:167], v[64:67], v[48:51]
    buffer_load_dwordx4 v1, s[16:19], s42 offen offset:0 sc1 lds
    v_mfma_f32_16x16x32_bf16 v[52:55], a[164:167], v[68:71], v[52:55]
    s_waitcnt lgkmcnt(2)
    v_add_f32 v13, v13, v21
    v_mul_f32 v112, 0xba800000, v12
    v_mfma_f32_16x16x32_bf16 v[32:35], a[168:171], v[72:75], v[32:35]
    ds_read_b128 v[56:59], v2 offset:32768
    v_mul_f32 v13, 0x3a800000, v13
    v_mfma_f32_16x16x32_bf16 v[40:43], a[168:171], v[76:79], v[40:43]
    v_fma_f32 v13, -v112, v112, v13
    v_mov_b32 v113, v112
    v_mfma_f32_16x16x32_bf16 v[44:47], a[172:175], v[76:79], v[44:47]
    v_max_f32 v13, 0, v13
    v_add_f32 v13, 0x3727c5ac, v13
    v_mfma_f32_16x16x32_bf16 v[36:39], a[172:175], v[72:75], v[36:39]
    ds_read_b128 v[60:63], v2 offset:33792
    v_mfma_f32_16x16x32_bf16 v[48:51], a[176:179], v[72:75], v[48:51]
    buffer_load_dwordx4 v1, s[16:19], s42 offen offset:1024 sc1 lds
    v_mfma_f32_16x16x32_bf16 v[52:55], a[176:179], v[76:79], v[52:55]
    s_waitcnt lgkmcnt(2)
    v_rsq_f32 v116, v13
    v_mfma_f32_16x16x32_bf16 v[32:35], a[180:183], v[80:83], v[32:35]
    ds_read_b128 v[64:67], v2 offset:34816
    v_mfma_f32_16x16x32_bf16 v[40:43], a[180:183], v[84:87], v[40:43]
    v_permlane16_swap_b32 v112, v113
    v_mfma_f32_16x16x32_bf16 v[44:47], a[184:187], v[84:87], v[44:47]
    v_mul_f32 v114, v13, v116
    v_mul_f32 v116, v116, v116
    v_mfma_f32_16x16x32_bf16 v[36:39], a[184:187], v[80:83], v[36:39]
    ds_read_b128 v[68:71], v2 offset:35840
    v_mov_b32 v115, v114
    v_mfma_f32_16x16x32_bf16 v[48:51], a[188:191], v[80:83], v[48:51]
    buffer_load_dwordx4 v1, s[16:19], s42 offen offset:2048 sc1 lds
    v_mfma_f32_16x16x32_bf16 v[52:55], a[188:191], v[84:87], v[52:55]
    s_waitcnt lgkmcnt(2)
    v_mov_b32 v117, v116
    v_fmac_f32 v40, v113, v88
    v_mfma_f32_16x16x32_bf16 v[32:35], a[192:195], v[56:59], v[32:35]
    ds_read_b128 v[72:75], v2 offset:36864
    v_fmac_f32 v36, v112, v92
    v_mfma_f32_16x16x32_bf16 v[40:43], a[192:195], v[60:63], v[40:43]
    v_permlane16_swap_b32 v114, v115
    v_mfma_f32_16x16x32_bf16 v[44:47], a[196:199], v[60:63], v[44:47]
    v_permlane16_swap_b32 v116, v117
    v_mfma_f32_16x16x32_bf16 v[36:39], a[196:199], v[56:59], v[36:39]
    s_add_u32 s46, s46, 2048
    ds_read_b128 v[76:79], v2 offset:37888
    v_fmac_f32 v32, v112, v88
    v_mfma_f32_16x16x32_bf16 v[48:51], a[200:203], v[56:59], v[48:51]
    buffer_load_dwordx4 v1, s[16:19], s42 offen offset:3072 sc1 lds
    v_mfma_f32_16x16x32_bf16 v[52:55], a[200:203], v[60:63], v[52:55]
    s_waitcnt lgkmcnt(2)
    v_fmac_f32 v41, v113, v89
    v_fmac_f32 v42, v113, v90
    v_mfma_f32_16x16x32_bf16 v[32:35], a[204:207], v[64:67], v[32:35]
    s_add_u32 m0, s43, 32768
    ds_read_b128 v[80:83], v2 offset:38912
    v_fmac_f32 v37, v112, v93
    v_mfma_f32_16x16x32_bf16 v[40:43], a[204:207], v[68:71], v[40:43]
    s_add_u32 s42, s41, 32768
    v_fmac_f32 v38, v112, v94
    v_fmac_f32 v39, v112, v95
    v_mfma_f32_16x16x32_bf16 v[44:47], a[208:211], v[68:71], v[44:47]
    s_min_u32 s46, s46, s55
    v_fmac_f32 v33, v112, v89
    v_fmac_f32 v34, v112, v90
    v_mfma_f32_16x16x32_bf16 v[36:39], a[208:211], v[64:67], v[36:39]
    ds_read_b128 v[84:87], v2 offset:39936
    v_fmac_f32 v35, v112, v91
    v_mfma_f32_16x16x32_bf16 v[48:51], a[212:215], v[64:67], v[48:51]
    buffer_load_dwordx4 v1, s[16:19], s42 offen offset:0 sc1 lds
    v_mfma_f32_16x16x32_bf16 v[52:55], a[212:215], v[68:71], v[52:55]
    s_waitcnt lgkmcnt(2)
    v_fmac_f32 v43, v113, v91
    v_fmac_f32 v40, v115, v100
    v_mfma_f32_16x16x32_bf16 v[32:35], a[216:219], v[72:75], v[32:35]
    ds_read_b128 v[56:59], v2 offset:40960
    v_fmac_f32 v36, v114, v104
    v_mfma_f32_16x16x32_bf16 v[40:43], a[216:219], v[76:79], v[40:43]
    v_fmac_f32 v37, v114, v105
    v_fmac_f32 v38, v114, v106
    v_mfma_f32_16x16x32_bf16 v[44:47], a[220:223], v[76:79], v[44:47]
    v_fmac_f32 v32, v114, v100
    v_fmac_f32 v33, v114, v101
    v_mfma_f32_16x16x32_bf16 v[36:39], a[220:223], v[72:75], v[36:39]
    ds_read_b128 v[60:63], v2 offset:41984
    v_fmac_f32 v34, v114, v102
    v_mfma_f32_16x16x32_bf16 v[48:51], a[224:227], v[72:75], v[48:51]
    buffer_load_dwordx4 v1, s[16:19], s42 offen offset:1024 sc1 lds
    v_mfma_f32_16x16x32_bf16 v[52:55], a[224:227], v[76:79], v[52:55]
    s_waitcnt lgkmcnt(2)
    v_fmac_f32 v41, v115, v101
    v_fmac_f32 v42, v115, v102
    v_mfma_f32_16x16x32_bf16 v[32:35], a[228:231], v[80:83], v[32:35]
    ds_read_b128 v[64:67], v2 offset:43008
    v_fmac_f32 v39, v114, v107
    v_mfma_f32_16x16x32_bf16 v[40:43], a[228:231], v[84:87], v[40:43]
    v_fmac_f32 v48, v112, v96
    v_fmac_f32 v49, v112, v97
    v_mfma_f32_16x16x32_bf16 v[44:47], a[232:235], v[84:87], v[44:47]
    v_fmac_f32 v35, v114, v103
    v_fmac_f32 v50, v112, v98
    v_mfma_f32_16x16x32_bf16 v[36:39], a[232:235], v[80:83], v[36:39]
    ds_read_b128 v[68:71], v2 offset:44032
    v_fmac_f32 v43, v115, v103
    v_mfma_f32_16x16x32_bf16 v[48:51], a[236:239], v[80:83], v[48:51]
    buffer_load_dwordx4 v1, s[16:19], s42 offen offset:2048 sc1 lds
    v_mfma_f32_16x16x32_bf16 v[52:55], a[236:239], v[84:87], v[52:55]
    s_waitcnt lgkmcnt(2)
    v_fmac_f32 v44, v113, v92
    v_fmac_f32 v45, v113, v93
    v_mfma_f32_16x16x32_bf16 v[32:35], a[240:243], v[56:59], v[32:35]
    s_waitcnt vmcnt(7)
    ds_read_b128 v[72:75], v2 offset:45056
    v_fmac_f32 v46, v113, v94
    v_mfma_f32_16x16x32_bf16 v[40:43], a[240:243], v[60:63], v[40:43]
    s_barrier
    v_fmac_f32 v51, v112, v99
    v_fmac_f32 v48, v114, v108
    v_mfma_f32_16x16x32_bf16 v[44:47], a[244:247], v[60:63], v[44:47]
    buffer_store_dword v124, v124, s[16:19], s91 offen sc1
    v_mfma_f32_16x16x32_bf16 v[36:39], a[244:247], v[56:59], v[36:39]
    s_add_u32 s91, s91, 65536
    ds_read_b128 v[76:79], v2 offset:46080
    v_fmac_f32 v52, v113, v96
    v_mfma_f32_16x16x32_bf16 v[48:51], a[248:251], v[56:59], v[48:51]
    buffer_load_dwordx4 v1, s[16:19], s42 offen offset:3072 sc1 lds
    v_mfma_f32_16x16x32_bf16 v[52:55], a[248:251], v[60:63], v[52:55]
    s_waitcnt lgkmcnt(2)
    v_fmac_f32 v47, v113, v95
    v_fmac_f32 v44, v115, v104
    v_mfma_f32_16x16x32_bf16 v[32:35], a[252:255], v[64:67], v[32:35]
    s_add_u32 m0, s43, 49152
    ds_read_b128 v[80:83], v2 offset:47104
    v_fmac_f32 v45, v115, v105
    v_mfma_f32_16x16x32_bf16 v[40:43], a[252:255], v[68:71], v[40:43]
    s_add_u32 s42, s41, 49152
    v_fmac_f32 v49, v114, v109
    v_fmac_f32 v50, v114, v110
    v_mfma_f32_16x16x32_bf16 v[44:47], v[128:131], v[68:71], v[44:47]
    v_fmac_f32 v51, v114, v111
    v_fmac_f32 v53, v113, v97
    v_mfma_f32_16x16x32_bf16 v[36:39], v[128:131], v[64:67], v[36:39]
    ds_read_b128 v[84:87], v2 offset:48128
    v_fmac_f32 v54, v113, v98
    v_mfma_f32_16x16x32_bf16 v[48:51], v[132:135], v[64:67], v[48:51]
    buffer_load_dwordx4 v1, s[16:19], s42 offen offset:0 sc1 lds
    v_mfma_f32_16x16x32_bf16 v[52:55], v[132:135], v[68:71], v[52:55]
    s_waitcnt lgkmcnt(2)
    v_fmac_f32 v46, v115, v106
    v_fmac_f32 v47, v115, v107
    v_mfma_f32_16x16x32_bf16 v[32:35], v[136:139], v[72:75], v[32:35]
    ds_read_b128 v[56:59], v2 offset:49152
    v_mfma_f32_16x16x32_bf16 v[40:43], v[136:139], v[76:79], v[40:43]
    v_fmac_f32 v55, v113, v99
    v_fmac_f32 v52, v115, v108
    v_mfma_f32_16x16x32_bf16 v[44:47], v[140:143], v[76:79], v[44:47]
    v_fmac_f32 v53, v115, v109
    v_fmac_f32 v54, v115, v110
    v_mfma_f32_16x16x32_bf16 v[36:39], v[140:143], v[72:75], v[36:39]
    ds_read_b128 v[60:63], v2 offset:50176
    v_fmac_f32 v55, v115, v111
    v_mfma_f32_16x16x32_bf16 v[48:51], v[144:147], v[72:75], v[48:51]
    buffer_load_dwordx4 v1, s[16:19], s42 offen offset:1024 sc1 lds
    v_mfma_f32_16x16x32_bf16 v[52:55], v[144:147], v[76:79], v[52:55]
    s_waitcnt lgkmcnt(2)
    v_mfma_f32_16x16x32_bf16 v[32:35], v[148:151], v[80:83], v[32:35]
    ds_read_b128 v[64:67], v2 offset:51200
    v_mfma_f32_16x16x32_bf16 v[40:43], v[148:151], v[84:87], v[40:43]
    v_mfma_f32_16x16x32_bf16 v[44:47], v[152:155], v[84:87], v[44:47]
    v_mfma_f32_16x16x32_bf16 v[36:39], v[152:155], v[80:83], v[36:39]
    ds_read_b128 v[68:71], v2 offset:52224
    v_mfma_f32_16x16x32_bf16 v[48:51], v[156:159], v[80:83], v[48:51]
    buffer_load_dwordx4 v1, s[16:19], s42 offen offset:2048 sc1 lds
    v_mfma_f32_16x16x32_bf16 v[52:55], v[156:159], v[84:87], v[52:55]
    s_waitcnt lgkmcnt(2)
    v_mfma_f32_16x16x32_bf16 v[32:35], v[160:163], v[56:59], v[32:35]
    ds_read_b128 v[72:75], v2 offset:53248
    v_mfma_f32_16x16x32_bf16 v[40:43], v[160:163], v[60:63], v[40:43]
    v_mfma_f32_16x16x32_bf16 v[44:47], v[164:167], v[60:63], v[44:47]
    v_mfma_f32_16x16x32_bf16 v[36:39], v[164:167], v[56:59], v[36:39]
    ds_read_b128 v[76:79], v2 offset:54272
    v_mfma_f32_16x16x32_bf16 v[48:51], v[168:171], v[56:59], v[48:51]
    buffer_load_dwordx4 v1, s[16:19], s42 offen offset:3072 sc1 lds
    v_mfma_f32_16x16x32_bf16 v[52:55], v[168:171], v[60:63], v[52:55]
    s_waitcnt lgkmcnt(2)
    s_add_u32 m0, s52, 73728
    s_add_u32 s42, s46, s52
    v_mfma_f32_16x16x32_bf16 v[32:35], v[172:175], v[64:67], v[32:35]
    ds_read_b128 v[80:83], v2 offset:55296
    v_mfma_f32_16x16x32_bf16 v[40:43], v[172:175], v[68:71], v[40:43]
    v_mfma_f32_16x16x32_bf16 v[44:47], v[176:179], v[68:71], v[44:47]
    buffer_load_dwordx4 v1, s[16:19], s42 offen sc1 lds
    v_mfma_f32_16x16x32_bf16 v[36:39], v[176:179], v[64:67], v[36:39]
    ds_read_b128 v[84:87], v2 offset:56320
    v_mfma_f32_16x16x32_bf16 v[48:51], v[180:183], v[64:67], v[48:51]
    v_mfma_f32_16x16x32_bf16 v[52:55], v[180:183], v[68:71], v[52:55]
    s_waitcnt lgkmcnt(2)
    v_mfma_f32_16x16x32_bf16 v[32:35], v[184:187], v[72:75], v[32:35]
    ds_read_b128 v[56:59], v2 offset:57344
    v_mfma_f32_16x16x32_bf16 v[40:43], v[184:187], v[76:79], v[40:43]
    v_mfma_f32_16x16x32_bf16 v[44:47], v[188:191], v[76:79], v[44:47]
    v_mfma_f32_16x16x32_bf16 v[36:39], v[188:191], v[72:75], v[36:39]
    ds_read_b128 v[60:63], v2 offset:58368
    v_mfma_f32_16x16x32_bf16 v[48:51], v[192:195], v[72:75], v[48:51]
    v_mfma_f32_16x16x32_bf16 v[52:55], v[192:195], v[76:79], v[52:55]
    s_waitcnt lgkmcnt(2)
    v_mfma_f32_16x16x32_bf16 v[32:35], v[196:199], v[80:83], v[32:35]
    ds_read_b128 v[64:67], v2 offset:59392
    v_mfma_f32_16x16x32_bf16 v[40:43], v[196:199], v[84:87], v[40:43]
    v_mfma_f32_16x16x32_bf16 v[44:47], v[200:203], v[84:87], v[44:47]
    v_mfma_f32_16x16x32_bf16 v[36:39], v[200:203], v[80:83], v[36:39]
    ds_read_b128 v[68:71], v2 offset:60416
    v_mfma_f32_16x16x32_bf16 v[48:51], v[204:207], v[80:83], v[48:51]
    v_mfma_f32_16x16x32_bf16 v[52:55], v[204:207], v[84:87], v[52:55]
    s_waitcnt lgkmcnt(2)
    v_mfma_f32_16x16x32_bf16 v[32:35], v[208:211], v[56:59], v[32:35]
    ds_read_b128 v[72:75], v2 offset:61440
    v_mfma_f32_16x16x32_bf16 v[40:43], v[208:211], v[60:63], v[40:43]
    v_mfma_f32_16x16x32_bf16 v[44:47], v[212:215], v[60:63], v[44:47]
    buffer_load_dword v7, v5, s[16:19], s45 offen sc1
    v_mfma_f32_16x16x32_bf16 v[36:39], v[212:215], v[56:59], v[36:39]
    ds_read_b128 v[76:79], v2 offset:62464
    v_mfma_f32_16x16x32_bf16 v[48:51], v[216:219], v[56:59], v[48:51]
    v_mfma_f32_16x16x32_bf16 v[52:55], v[216:219], v[60:63], v[52:55]
    s_waitcnt lgkmcnt(2)
    v_mfma_f32_16x16x32_bf16 v[32:35], v[220:223], v[64:67], v[32:35]
    ds_read_b128 v[80:83], v2 offset:63488
    v_mfma_f32_16x16x32_bf16 v[40:43], v[220:223], v[68:71], v[40:43]
    v_mfma_f32_16x16x32_bf16 v[44:47], v[224:227], v[68:71], v[44:47]
    v_mfma_f32_16x16x32_bf16 v[36:39], v[224:227], v[64:67], v[36:39]
    ds_read_b128 v[84:87], v2 offset:64512
    v_mfma_f32_16x16x32_bf16 v[48:51], v[228:231], v[64:67], v[48:51]
    v_mfma_f32_16x16x32_bf16 v[52:55], v[228:231], v[68:71], v[52:55]
    s_waitcnt lgkmcnt(2)
    v_mfma_f32_16x16x32_bf16 v[32:35], v[232:235], v[72:75], v[32:35]
    ds_read_b128 v[56:59], v1 offset:0
    v_mfma_f32_16x16x32_bf16 v[40:43], v[232:235], v[76:79], v[40:43]
    v_mfma_f32_16x16x32_bf16 v[44:47], v[236:239], v[76:79], v[44:47]
    v_mfma_f32_16x16x32_bf16 v[36:39], v[236:239], v[72:75], v[36:39]
    ds_read_b128 v[60:63], v1 offset:1024
    v_mfma_f32_16x16x32_bf16 v[48:51], v[240:243], v[72:75], v[48:51]
    v_mfma_f32_16x16x32_bf16 v[52:55], v[240:243], v[76:79], v[52:55]
    s_waitcnt lgkmcnt(2)
    v_mfma_f32_16x16x32_bf16 v[32:35], v[244:247], v[80:83], v[32:35]
    ds_read_b128 v[64:67], v1 offset:2048
    v_mfma_f32_16x16x32_bf16 v[40:43], v[244:247], v[84:87], v[40:43]
    v_mfma_f32_16x16x32_bf16 v[44:47], v[248:251], v[84:87], v[44:47]
    v_mfma_f32_16x16x32_bf16 v[36:39], v[248:251], v[80:83], v[36:39]
    ds_read_b128 v[68:71], v1 offset:3072
    v_mfma_f32_16x16x32_bf16 v[48:51], v[252:255], v[80:83], v[48:51]
    v_mfma_f32_16x16x32_bf16 v[52:55], v[252:255], v[84:87], v[52:55]
    s_add_u32 s36, s36, 1
    s_cmp_lt_u32 s36, 32
    s_cbranch_scc1 L_a_b0
    s_nop 7
    s_and_b32 s44, s90, 0xffffffff
    s_cmp_lt_i32 s36, 1
    s_cselect_b32 s44, 0x5e00000, s44
    s_add_u32 s49, s44, s87
    s_max_u32 s44, s44, s88
    s_add_u32 s90, s90, 262144
    v_mul_f32 v120, v48, v116
    v_mul_f32 v121, v49, v116
    v_mul_f32 v120, v120, abs(v48)
    v_mul_f32 v121, v121, abs(v49)
    v_cvt_pk_bf16_f32 v48, v120, v121
    v_pk_max_i16 v48, v48, 0
    v_mul_f32 v120, v50, v116
    v_mul_f32 v121, v51, v116
    v_mul_f32 v120, v120, abs(v50)
    v_mul_f32 v121, v121, abs(v51)
    v_cvt_pk_bf16_f32 v49, v120, v121
    v_pk_max_i16 v49, v49, 0
    ds_write_b64 v3, v[48:49] offset:4096
    v_mul_f32 v120, v52, v117
    v_mul_f32 v121, v53, v117
    v_mul_f32 v120, v120, abs(v52)
    v_mul_f32 v121, v121, abs(v53)
    v_cvt_pk_bf16_f32 v52, v120, v121
    v_pk_max_i16 v52, v52, 0
    v_mul_f32 v120, v54, v117
    v_mul_f32 v121, v55, v117
    v_mul_f32 v120, v120, abs(v54)
    v_mul_f32 v121, v121, abs(v55)
    v_cvt_pk_bf16_f32 v53, v120, v121
    v_pk_max_i16 v53, v53, 0
    ds_write_b64 v3, v[52:53] offset:5120
    v_mul_f32 v120, v32, v116
    v_mul_f32 v121, v33, v116
    v_mul_f32 v120, v120, abs(v32)
    v_mul_f32 v121, v121, abs(v33)
    v_cvt_pk_bf16_f32 v32, v120, v121
    v_pk_max_i16 v32, v32, 0
    v_mul_f32 v120, v34, v116
    v_mul_f32 v121, v35, v116
    v_mul_f32 v120, v120, abs(v34)
    v_mul_f32 v121, v121, abs(v35)
    v_cvt_pk_bf16_f32 v33, v120, v121
    v_pk_max_i16 v33, v33, 0
    v_mul_f32 v120, v36, v116
    v_mul_f32 v121, v37, v116
    v_mul_f32 v120, v120, abs(v36)
    v_mul_f32 v121, v121, abs(v37)
    v_cvt_pk_bf16_f32 v34, v120, v121
    v_pk_max_i16 v34, v34, 0
    v_mul_f32 v120, v38, v116
    v_mul_f32 v121, v39, v116
    v_mul_f32 v120, v120, abs(v38)
    v_mul_f32 v121, v121, abs(v39)
    v_cvt_pk_bf16_f32 v35, v120, v121
    v_pk_max_i16 v35, v35, 0
    buffer_store_dwordx4 v[32:35], v1, s[16:19], s44 offen offset:0 sc1
    v_mul_f32 v120, v40, v117
    v_mul_f32 v121, v41, v117
    v_mul_f32 v120, v120, abs(v40)
    s_waitcnt lgkmcnt(0)
    s_barrier
    ds_read_b128 v[48:51], v4 offset:4096
    v_mul_f32 v121, v121, abs(v41)
    v_cvt_pk_bf16_f32 v40, v120, v121
    v_pk_max_i16 v40, v40, 0
    v_mul_f32 v120, v42, v117
    v_mul_f32 v121, v43, v117
    v_mul_f32 v120, v120, abs(v42)
    v_mul_f32 v121, v121, abs(v43)
    v_cvt_pk_bf16_f32 v41, v120, v121
    v_pk_max_i16 v41, v41, 0
    s_waitcnt lgkmcnt(0)
    buffer_store_dwordx4 v[48:51], v1, s[16:19], s49 offen sc1
    v_mul_f32 v120, v44, v117
    v_mul_f32 v121, v45, v117
    v_mul_f32 v120, v120, abs(v44)
    v_mul_f32 v121, v121, abs(v45)
    v_cvt_pk_bf16_f32 v42, v120, v121
    v_pk_max_i16 v42, v42, 0
    v_mul_f32 v120, v46, v117
    v_mul_f32 v121, v47, v117
    v_mul_f32 v120, v120, abs(v46)
    v_mul_f32 v121, v121, abs(v47)
    v_cvt_pk_bf16_f32 v43, v120, v121
    v_pk_max_i16 v43, v43, 0
    buffer_store_dwordx4 v[40:43], v1, s[16:19], s44 offen offset:1024 sc1
    s_waitcnt vmcnt(0)
    s_barrier
    buffer_store_dword v124, v124, s[16:19], s91 offen sc1
    s_add_u32 s91, s91, 65536
    s_waitcnt vmcnt(0)
    s_endpgm
L_spin8:
    s_mov_b32 s40, 0x20000
L_spin8_l:
    buffer_load_dword v56, v124, s[20:23], 0 offen sc1
    s_sub_u32 s40, s40, 1
    s_waitcnt vmcnt(0)
    v_cmp_eq_u32 vcc, v124, v56
    s_cbranch_scc1 L_back9
    s_cbranch_vccz L_back9
    s_sleep 8
    s_branch L_spin8_l
L_spin10:
    s_mov_b32 s40, 0x20000
L_spin10_l:
    buffer_load_dword v7, v5, s[16:19], s45 offen sc1
    s_sub_u32 s40, s40, 1
    s_waitcnt vmcnt(0)
    v_cmp_ne_u32 vcc, 0, v7
    s_cbranch_scc1 L_back11
    s_cbranch_vccz L_back11
    s_sleep 2
    s_branch L_spin10_l
L_spin12:
    s_mov_b32 s40, 0x20000
L_spin12_l:
    buffer_load_dword v7, v5, s[16:19], s45 offen sc1
    s_sub_u32 s40, s40, 1
    s_waitcnt vmcnt(0)
    v_cmp_ne_u32 vcc, 0, v7
    s_cbranch_scc1 L_back13
    s_cbranch_vccz L_back13
    s_sleep 2
    s_branch L_spin12_l
L_sspin14:
    s_mov_b32 s40, 0x20000
L_sspin14_l:
    buffer_load_dwordx2 v[36:37], v6, s[16:19], s46 offen offset:0 sc1
    buffer_load_dwordx2 v[38:39], v6, s[16:19], s46 offen offset:128 sc1
    buffer_load_dwordx2 v[40:41], v6, s[16:19], s46 offen offset:256 sc1
    buffer_load_dwordx2 v[42:43], v6, s[16:19], s46 offen offset:384 sc1
    s_sub_u32 s40, s40, 1
    s_waitcnt vmcnt(0)
    v_max3_u32 v44, v36, v37, v38
    v_max3_u32 v45, v39, v40, v41
    v_max3_u32 v44, v44, v42, v43
    v_max_u32 v44, v44, v45
    v_cmp_eq_u32 vcc, -1, v44
    s_cbranch_scc1 L_sback15
    s_cbranch_vccz L_sback15
    s_sleep 4
    s_branch L_sspin14_l
L_spin16:
    s_mov_b32 s40, 0x20000
L_spin16_l:
    buffer_load_dword v7, v5, s[16:19], s45 offen sc1
    s_sub_u32 s40, s40, 1
    s_waitcnt vmcnt(0)
    v_cmp_ne_u32 vcc, 0, v7
    s_cbranch_scc1 L_back17
    s_cbranch_vccz L_back17
    s_sleep 2
    s_branch L_spin16_l
L_sspin18:
    s_mov_b32 s40, 0x20000
L_sspin18_l:
    buffer_load_dwordx2 v[12:13], v6, s[16:19], s46 offen offset:0 sc1
    buffer_load_dwordx2 v[14:15], v6, s[16:19], s46 offen offset:128 sc1
    buffer_load_dwordx2 v[16:17], v6, s[16:19], s46 offen offset:256 sc1
    buffer_load_dwordx2 v[18:19], v6, s[16:19], s46 offen offset:384 sc1
    s_sub_u32 s40, s40, 1
    s_waitcnt vmcnt(0)
    v_max3_u32 v20, v12, v13, v14
    v_max3_u32 v21, v15, v16, v17
    v_max3_u32 v20, v20, v18, v19
    v_max_u32 v20, v20, v21
    v_cmp_eq_u32 vcc, -1, v20
    s_cbranch_scc1 L_sback19
    s_cbranch_vccz L_sback19
    s_sleep 4
    s_branch L_sspin18_l
L_odd:
    s_mov_b32 s33, s47
    s_lshl2_add_u32 s53, s48, s47
    s_cmp_lt_u32 s48, 8
    s_cselect_b32 s34, 16, 32
    s_add_u32 s34, s34, s48
    s_sub_u32 s37, s48, 8
    s_cmp_lt_u32 s37, 20
    s_cselect_b32 s44, -16, 0
    s_cmp_lt_u32 s37, 4
    s_cselect_b32 s44, 64, s44
    s_add_u32 s44, s44, s53
    s_lshl2_add_u32 s44, s44, s32
    s_lshl_b32 s44, s44, 13
    v_lshlrev_b32 v6, 7, v0
    s_waitcnt lgkmcnt(0)
    s_mov_b32 s12, s66
    s_mov_b32 s13, s67
    s_mov_b32 s14, 0x400000
    s_mov_b32 s15, 0x00020000
    s_mov_b32 s16, s84
    s_mov_b32 s17, s85
    s_mov_b32 s18, 0x5e00000
    s_mov_b32 s19, 0x00020000
    v_min_u32 v124, 1, v0
    v_lshlrev_b32 v124, 30, v124
    s_cmp_lt_u32 s48, 8
    s_cbranch_scc1 L_touch
    s_sub_u32 s37, s48, 12
    s_cmp_lt_u32 s37, 16
    s_cbranch_scc1 L_lines
    s_lshl_b32 s50, s33, 5
    s_or_b32 s37, s48, 16
    s_add_u32 s50, s50, s37
    s_lshl_b32 s46, s50, 15
    s_lshl_b32 s37, s32, 9
    s_add_u32 s46, s46, s37
    v_lshrrev_b32 v48, 3, v0
    v_and_b32 v49, 0x70, v1
    v_lshl_add_u32 v48, v48, 11, v49
    v_add_u32 v49, 16384, v48
    s_mov_b32 s8, s64
    s_mov_b32 s9, s65
    s_mov_b32 s10, 0x400000
    s_mov_b32 s11, 0x00020000
    buffer_load_dwordx4 v[16:19], v48, s[8:11], s46 offen offset:0
    buffer_load_dwordx4 v[20:23], v48, s[8:11], s46 offen offset:128
    buffer_load_dwordx4 v[24:27], v48, s[8:11], s46 offen offset:256
    buffer_load_dwordx4 v[28:31], v48, s[8:11], s46 offen offset:384
    buffer_load_dwordx4 v[32:35], v49, s[8:11], s46 offen offset:0
    buffer_load_dwordx4 v[36:39], v49, s[8:11], s46 offen offset:128
    buffer_load_dwordx4 v[40:43], v49, s[8:11], s46 offen offset:256
    buffer_load_dwordx4 v[44:47], v49, s[8:11], s46 offen offset:384
    s_mov_b32 s86, 0x3f803f80
    v_and_b32 v56, 1, v0
    v_lshlrev_b32 v56, 7, v56
    v_bfe_u32 v57, v0, 1, 1
    v_lshl_add_u32 v56, v57, 6, v56
    v_and_b32 v57, 0x38, v0
    v_add_u32 v56, v57, v56
    s_sub_u32 s46, 127, s50
    s_lshl_b32 s46, s46, 10
    s_lshl_b32 s37, s32, 8
    s_add_u32 s46, s46, s37
    s_add_u32 s46, s46, 0x5400000
    s_waitcnt vmcnt(0)
    v_dot2_f32_bf16 v48, v16, s86, 0
    v_dot2_f32_bf16 v49, v16, v16, 0
    v_dot2_f32_bf16 v50, v24, s86, 0
    v_dot2_f32_bf16 v51, v24, v24, 0
    v_dot2_f32_bf16 v52, v32, s86, 0
    v_dot2_f32_bf16 v53, v32, v32, 0
    v_dot2_f32_bf16 v54, v40, s86, 0
    v_dot2_f32_bf16 v55, v40, v40, 0
    v_dot2_f32_bf16 v48, v17, s86, v48
    v_dot2_f32_bf16 v49, v17, v17, v49
    v_dot2_f32_bf16 v50, v25, s86, v50
    v_dot2_f32_bf16 v51, v25, v25, v51
    v_dot2_f32_bf16 v52, v33, s86, v52
    v_dot2_f32_bf16 v53, v33, v33, v53
    v_dot2_f32_bf16 v54, v41, s86, v54
    v_dot2_f32_bf16 v55, v41, v41, v55
    v_dot2_f32_bf16 v48, v18, s86, v48
    v_dot2_f32_bf16 v49, v18, v18, v49
    v_dot2_f32_bf16 v50, v26, s86, v50
    v_dot2_f32_bf16 v51, v26, v26, v51
    v_dot2_f32_bf16 v52, v34, s86, v52
    v_dot2_f32_bf16 v53, v34, v34, v53
    v_dot2_f32_bf16 v54, v42, s86, v54
    v_dot2_f32_bf16 v55, v42, v42, v55
    v_dot2_f32_bf16 v48, v19, s86, v48
    v_dot2_f32_bf16 v49, v19, v19, v49
    v_dot2_f32_bf16 v50, v27, s86, v50
    v_dot2_f32_bf16 v51, v27, v27, v51
    v_dot2_f32_bf16 v52, v35, s86, v52
    v_dot2_f32_bf16 v53, v35, v35, v53
    v_dot2_f32_bf16 v54, v43, s86, v54
    v_dot2_f32_bf16 v55, v43, v43, v55
    v_dot2_f32_bf16 v48, v20, s86, v48
    v_dot2_f32_bf16 v49, v20, v20, v49
    v_dot2_f32_bf16 v50, v28, s86, v50
    v_dot2_f32_bf16 v51, v28, v28, v51
    v_dot2_f32_bf16 v52, v36, s86, v52
    v_dot2_f32_bf16 v53, v36, v36, v53
    v_dot2_f32_bf16 v54, v44, s86, v54
    v_dot2_f32_bf16 v55, v44, v44, v55
    v_dot2_f32_bf16 v48, v21, s86, v48
    v_dot2_f32_bf16 v49, v21, v21, v49
    v_dot2_f32_bf16 v50, v29, s86, v50
    v_dot2_f32_bf16 v51, v29, v29, v51
    v_dot2_f32_bf16 v52, v37, s86, v52
    v_dot2_f32_bf16 v53, v37, v37, v53
    v_dot2_f32_bf16 v54, v45, s86, v54
    v_dot2_f32_bf16 v55, v45, v45, v55
    v_dot2_f32_bf16 v48, v22, s86, v48
    v_dot2_f32_bf16 v49, v22, v22, v49
    v_dot2_f32_bf16 v50, v30, s86, v50
    v_dot2_f32_bf16 v51, v30, v30, v51
    v_dot2_f32_bf16 v52, v38, s86, v52
    v_dot2_f32_bf16 v53, v38, v38, v53
    v_dot2_f32_bf16 v54, v46, s86, v54
    v_dot2_f32_bf16 v55, v46, v46, v55
    v_dot2_f32_bf16 v48, v23, s86, v48
    v_dot2_f32_bf16 v49, v23, v23, v49
    v_dot2_f32_bf16 v50, v31, s86, v50
    v_dot2_f32_bf16 v51, v31, v31, v51
    v_dot2_f32_bf16 v52, v39, s86, v52
    v_dot2_f32_bf16 v53, v39, v39, v53
    v_dot2_f32_bf16 v54, v47, s86, v54
    v_dot2_f32_bf16 v55, v47, v47, v55
    v_add_f32_dpp v48, v48, v48 quad_perm:[1,0,3,2] row_mask:0xf bank_mask:0xf
    v_add_f32_dpp v49, v49, v49 quad_perm:[1,0,3,2] row_mask:0xf bank_mask:0xf
    v_add_f32_dpp v50, v50, v50 quad_perm:[1,0,3,2] row_mask:0xf bank_mask:0xf
    v_add_f32_dpp v51, v51, v51 quad_perm:[1,0,3,2] row_mask:0xf bank_mask:0xf
    v_add_f32_dpp v52, v52, v52 quad_perm:[1,0,3,2] row_mask:0xf bank_mask:0xf
    v_add_f32_dpp v53, v53, v53 quad_perm:[1,0,3,2] row_mask:0xf bank_mask:0xf
    v_add_f32_dpp v54, v54, v54 quad_perm:[1,0,3,2] row_mask:0xf bank_mask:0xf
    v_add_f32_dpp v55, v55, v55 quad_perm:[1,0,3,2] row_mask:0xf bank_mask:0xf
    v_add_f32_dpp v48, v48, v48 quad_perm:[2,3,0,1] row_mask:0xf bank_mask:0xf
    v_add_f32_dpp v49, v49, v49 quad_perm:[2,3,0,1] row_mask:0xf bank_mask:0xf
    v_add_f32_dpp v50, v50, v50 quad_perm:[2,3,0,1] row_mask:0xf bank_mask:0xf
    v_add_f32_dpp v51, v51, v51 quad_perm:[2,3,0,1] row_mask:0xf bank_mask:0xf
    v_add_f32_dpp v52, v52, v52 quad_perm:[2,3,0,1] row_mask:0xf bank_mask:0xf
    v_add_f32_dpp v53, v53, v53 quad_perm:[2,3,0,1] row_mask:0xf bank_mask:0xf
    v_add_f32_dpp v54, v54, v54 quad_perm:[2,3,0,1] row_mask:0xf bank_mask:0xf
    v_add_f32_dpp v55, v55, v55 quad_perm:[2,3,0,1] row_mask:0xf bank_mask:0xf
    v_add_f32_dpp v48, v48, v48 row_half_mirror row_mask:0xf bank_mask:0xf
    v_add_f32_dpp v49, v49, v49 row_half_mirror row_mask:0xf bank_mask:0xf
    v_add_f32_dpp v50, v50, v50 row_half_mirror row_mask:0xf bank_mask:0xf
    v_add_f32_dpp v51, v51, v51 row_half_mirror row_mask:0xf bank_mask:0xf
    v_add_f32_dpp v52, v52, v52 row_half_mirror row_mask:0xf bank_mask:0xf
    v_add_f32_dpp v53, v53, v53 row_half_mirror row_mask:0xf bank_mask:0xf
    v_add_f32_dpp v54, v54, v54 row_half_mirror row_mask:0xf bank_mask:0xf
    v_add_f32_dpp v55, v55, v55 row_half_mirror row_mask:0xf bank_mask:0xf
    s_mov_b32 exec_lo, 0x2020202
    s_mov_b32 exec_hi, 0x2020202
    v_mov_b32 v48, v50
    v_mov_b32 v49, v51
    s_mov_b32 exec_lo, 0x4040404
    s_mov_b32 exec_hi, 0x4040404
    v_mov_b32 v48, v52
    v_mov_b32 v49, v53
    s_mov_b32 exec_lo, 0x8080808
    s_mov_b32 exec_hi, 0x8080808
    v_mov_b32 v48, v54
    v_mov_b32 v49, v55
    s_mov_b32 exec_lo, 0x0f0f0f0f
    s_mov_b32 exec_hi, 0x0f0f0f0f
    buffer_store_dwordx2 v[48:49], v56, s[16:19], s46 offen sc1
    s_mov_b64 exec, -1
    s_branch L_job_end
L_lines:
    buffer_load_dword v248, v6, s[12:15], s44 offen
    s_mov_b32 s14, 0
    s_sub_u32 s53, s53, 48
    s_and_b32 s37, s53, 7
    s_cmp_lt_u32 s37, 2
    s_cselect_b32 s87, 2, 3
    s_cselect_b32 s36, 34, 32
    s_cmp_ge_u32 s53, 32
    s_cselect_b32 s87, 2, s87
    s_cselect_b32 s36, 35, s36
    s_cselect_b32 s38, 5, 0
    s_cmp_lt_u32 s37, s38
    s_cselect_b32 s37, 0x5e00000, 0
    s_lshl_b32 s38, s53, 10
    s_add_u32 s37, s37, s38
    s_lshl_b32 s38, s32, 16
    s_add_u32 s37, s37, s38
    s_add_u32 s37, s37, 0x5500000
    s_sub_u32 s87, s32, s87
    s_cmp_lt_u32 s87, s36
    s_cselect_b32 s38, -1, 0
    v_mov_b32 v16, s38
    s_add_u32 s87, s87, 4
    buffer_store_dwordx4 v[16:19], v1, s[16:19], s37 offen sc1
    s_add_u32 s37, s37, 262144
    s_cmp_lt_u32 s87, s36
    s_cselect_b32 s38, -1, 0
    v_mov_b32 v20, s38
    s_add_u32 s87, s87, 4
    buffer_store_dwordx4 v[20:23], v1, s[16:19], s37 offen sc1
    s_add_u32 s37, s37, 262144
    s_cmp_lt_u32 s87, s36
    s_cselect_b32 s38, -1, 0
    v_mov_b32 v24, s38
    s_add_u32 s87, s87, 4
    buffer_store_dwordx4 v[24:27], v1, s[16:19], s37 offen sc1
    s_add_u32 s37, s37, 262144
    s_cmp_lt_u32 s87, s36
    s_cselect_b32 s38, -1, 0
    v_mov_b32 v28, s38
    s_add_u32 s87, s87, 4
    buffer_store_dwordx4 v[28:31], v1, s[16:19], s37 offen sc1
    s_add_u32 s37, s37, 262144
    s_cmp_lt_u32 s87, s36
    s_cselect_b32 s38, -1, 0
    v_mov_b32 v32, s38
    s_add_u32 s87, s87, 4
    buffer_store_dwordx4 v[32:35], v1, s[16:19], s37 offen sc1
    s_add_u32 s37, s37, 262144
    s_cmp_lt_u32 s87, s36
    s_cselect_b32 s38, -1, 0
    v_mov_b32 v36, s38
    s_add_u32 s87, s87, 4
    buffer_store_dwordx4 v[36:39], v1, s[16:19], s37 offen sc1
    s_add_u32 s37, s37, 262144
    s_cmp_lt_u32 s87, s36
    s_cselect_b32 s38, -1, 0
    v_mov_b32 v40, s38
    s_add_u32 s87, s87, 4
    buffer_store_dwordx4 v[40:43], v1, s[16:19], s37 offen sc1
    s_add_u32 s37, s37, 262144
    s_cmp_lt_u32 s87, s36
    s_cselect_b32 s38, -1, 0
    v_mov_b32 v44, s38
    s_add_u32 s87, s87, 4
    buffer_store_dwordx4 v[44:47], v1, s[16:19], s37 offen sc1
    s_add_u32 s37, s37, 262144
    s_cmp_lt_u32 s87, s36
    s_cselect_b32 s38, -1, 0
    v_mov_b32 v48, s38
    s_add_u32 s87, s87, 4
    buffer_store_dwordx4 v[48:51], v1, s[16:19], s37 offen sc1
    s_add_u32 s37, s37, 262144
    s_cmp_lt_u32 s87, s36
    s_cselect_b32 s38, -1, 0
    v_mov_b32 v52, s38
    s_add_u32 s87, s87, 4
    buffer_store_dwordx4 v[52:55], v1, s[16:19], s37 offen sc1
    s_add_u32 s37, s37, 262144
    v_mov_b32 v8, -1
    v_mov_b32 v9, -1
    v_mov_b32 v10, -1
    v_mov_b32 v11, -1
    s_lshl2_add_u32 s38, s53, s32
    s_lshl_b32 s38, s38, 10
    s_add_u32 s38, s38, 0x5440000
    buffer_store_dwordx4 v[8:11], v1, s[16:19], s38 offen sc1
L_job_end:
    s_mov_b32 s8, s82
    s_mov_b32 s9, s83
    s_mov_b32 s10, 0x100
    s_mov_b32 s11, 0x00020000
    v_mov_b32 v123, 1
    s_waitcnt vmcnt(0)
    s_barrier
    s_cmp_lg_u32 s32, 3
    s_cbranch_scc1 L_arr20
    buffer_atomic_add v123, v124, s[8:11], 0 offen sc0
    s_waitcnt vmcnt(0)
    v_readfirstlane_b32 s37, v123
    s_nop 0
    s_cmp_lg_u32 s37, 95
    s_cbranch_scc1 L_arr20
    buffer_store_dword v123, v124, s[8:11], 0 offen offset:128 sc1
L_arr20:
L_touch:
    buffer_load_dword v248, v6, s[12:15], s44 offen
    s_lshl_b32 s91, s33, 6
    s_add_u32 s91, s91, s34
    s_lshl_b32 s91, s91, 7
    s_add_u32 s91, s91, 0x5520000
    s_cmp_eq_u32 s32, 1
    s_cselect_b32 s91, s91, 0x5f00000
    s_cmp_ge_u32 s34, 60
    s_cbranch_scc1 L_role_60
    s_cmp_ge_u32 s34, 44
    s_cbranch_scc1 L_role_44
    s_cmp_ge_u32 s34, 40
    s_cbranch_scc1 L_role_40
L_role_16:
    s_sub_u32 s35, s34, 16
    s_lshl_b32 s54, s35, 8
    s_mov_b32 s12, s68
    s_mov_b32 s13, s69
    s_mov_b32 s14, 0x200000
    s_mov_b32 s15, 0x00020000
    s_mov_b32 s39, 2048
    v_lshrrev_b32 v52, 3, v0
    v_lshlrev_b32 v53, 2, v0
    v_and_b32 v53, 64, v53
    v_and_b32 v54, 0x70, v1
    v_xor_b32 v53, v53, v54
    v_mad_u32_u24 v44, v52, s39, v53
    v_add_u32 v45, 16384, v44
    v_add_u32 v46, 128, v44
    v_add_u32 v47, 16512, v44
    s_mul_i32 s38, s32, 32768
    s_add_u32 s54, s54, s38
    s_lshl_b32 s42, s32, 11
    s_add_u32 m0, s42, 0
    s_nop 0
    buffer_load_dwordx4 v44, s[12:15], s54 offen lds
    s_add_u32 m0, s42, 1024
    s_nop 0
    buffer_load_dwordx4 v45, s[12:15], s54 offen lds
    s_add_u32 m0, s42, 8192
    s_nop 0
    buffer_load_dwordx4 v46, s[12:15], s54 offen lds
    s_add_u32 m0, s42, 9216
    s_nop 0
    buffer_load_dwordx4 v47, s[12:15], s54 offen lds
    s_add_u32 s54, s54, 131072
    s_add_u32 m0, s42, 16384
    s_nop 0
    buffer_load_dwordx4 v44, s[12:15], s54 offen lds
    s_add_u32 m0, s42, 17408
    s_nop 0
    buffer_load_dwordx4 v45, s[12:15], s54 offen lds
    s_add_u32 m0, s42, 24576
    s_nop 0
    buffer_load_dwordx4 v46, s[12:15], s54 offen lds
    s_add_u32 m0, s42, 25600
    s_nop 0
    buffer_load_dwordx4 v47, s[12:15], s54 offen lds
    s_add_u32 s54, s54, 131072
    s_add_u32 m0, s42, 32768
    s_nop 0
    buffer_load_dwordx4 v44, s[12:15], s54 offen lds
    s_add_u32 m0, s42, 33792
    s_nop 0
    buffer_load_dwordx4 v45, s[12:15], s54 offen lds
    s_add_u32 m0, s42, 40960
    s_nop 0
    buffer_load_dwordx4 v46, s[12:15], s54 offen lds
    s_add_u32 m0, s42, 41984
    s_nop 0
    buffer_load_dwordx4 v47, s[12:15], s54 offen lds
    s_add_u32 s54, s54, 131072
    s_add_u32 m0, s42, 49152
    s_nop 0
    buffer_load_dwordx4 v44, s[12:15], s54 offen lds
    s_add_u32 m0, s42, 50176
    s_nop 0
    buffer_load_dwordx4 v45, s[12:15], s54 offen lds
    s_add_u32 m0, s42, 57344
    s_nop 0
    buffer_load_dwordx4 v46, s[12:15], s54 offen lds
    s_add_u32 m0, s42, 58368
    s_nop 0
    buffer_load_dwordx4 v47, s[12:15], s54 offen lds
    s_add_u32 s54, s54, 131072
    s_add_u32 m0, s42, 65536
    s_nop 0
    buffer_load_dwordx4 v44, s[12:15], s54 offen lds
    s_add_u32 m0, s42, 66560
    s_nop 0
    buffer_load_dwordx4 v45, s[12:15], s54 offen lds
    s_add_u32 m0, s42, 73728
    s_nop 0
    buffer_load_dwordx4 v46, s[12:15], s54 offen lds
    s_add_u32 m0, s42, 74752
    s_nop 0
    buffer_load_dwordx4 v47, s[12:15], s54 offen lds
    s_add_u32 s54, s54, 131072
    v_lshrrev_b32 v52, 4, v0
    v_bfe_u32 v53, v0, 2, 2
    v_lshl_add_u32 v52, v52, 3, v53
    v_lshlrev_b32 v52, 7, v52
    v_lshrrev_b32 v53, 1, v53
    v_lshl_add_u32 v52, v53, 6, v52
    v_and_b32 v53, 3, v0
    v_lshl_add_u32 v52, v53, 4, v52
    s_lshr_b32 s37, s32, 1
    s_lshl_b32 s37, s37, 13
    s_and_b32 s38, s32, 1
    s_lshl_b32 s38, s38, 6
    s_add_u32 s37, s37, s38
    s_add_u32 s37, s37, 0
    v_xor_b32 v48, s37, v52
    s_lshr_b32 s37, s32, 1
    s_lshl_b32 s37, s37, 13
    s_and_b32 s38, s32, 1
    s_lshl_b32 s38, s38, 6
    s_add_u32 s37, s37, s38
    s_add_u32 s37, s37, 8
    v_xor_b32 v49, s37, v52
    v_add_u32 v2, 98304, v1
    v_mov_b32 v108, 0
    v_mov_b32 v109, 0
    v_mov_b32 v110, 0
    v_mov_b32 v111, 0
    v_mov_b32 v112, 0
    v_mov_b32 v113, 0
    v_mov_b32 v114, 0
    v_mov_b32 v115, 0
    v_mov_b32 v13, 0x3f80
    v_and_b32 v12, 1, v0
    v_lshlrev_b32 v12, 4, v12
    v_lshlrev_b32 v12, v12, v13
    s_mov_b32 exec_lo, 0x300003
    s_mov_b32 exec_hi, 0x30000300
    v_mov_b32 v108, v12
    v_mov_b32 v114, v12
    s_mov_b32 exec_lo, 0xc0000c
    s_mov_b32 exec_hi, 0xc0000c00
    v_mov_b32 v109, v12
    v_mov_b32 v115, v12
    s_mov_b64 exec, -1
    s_lshl_b32 s37, s33, 6
    s_add_u32 s37, s37, 0
    s_lshl_b32 s37, s37, 7
    v_lshl_add_u32 v4, v0, 7, s37
    s_cmp_eq_u32 s32, 0
    s_cselect_b32 s37, 16, 0
    v_cmp_le_u32 vcc, s37, v0
    s_nop 1
    v_cndmask_b32 v4, v4, 2.0, vcc
    s_mov_b32 s86, 0x3f803f80
    s_lshl_b32 s43, s32, 12
    s_mul_i32 s41, s33, 2097152
    s_add_u32 s41, s41, 0x0
    s_add_u32 s41, s41, s43
    s_lshl_b32 s38, s35, 2
    s_add_u32 s38, s38, s32
    s_mul_i32 s90, s33, 2097152
    s_add_u32 s90, s90, 0x7f0000
    s_lshl_b32 s37, s38, 11
    s_add_u32 s90, s90, s37
    v_and_b32 v12, 15, v0
    v_and_b32 v13, 0x30, v0
    v_lshl_add_u32 v3, v12, 11, v13
    s_lshl_b32 s37, s38, 6
    v_add_u32 v3, s37, v3
    s_lshl_b32 s50, s33, 20
    s_add_u32 s50, s50, 983040
    s_add_u32 s88, s84, 0x5000000
    s_addc_u32 s89, s85, 0
    s_mov_b32 s8, s64
    s_mov_b32 s9, s65
    s_mov_b32 s10, 0x400000
    s_mov_b32 s11, 0x00020000
    v_bfe_u32 v13, v0, 4, 1
    v_lshl_add_u32 v12, v12, 1, v13
    s_lshl_b32 s37, s32, 2
    s_add_u32 s37, s37, 65536
    v_lshl_add_u32 v6, v12, 4, s37
    v_add_u32 v7, 65536, v1
    v_and_b32 v12, 31, v0
    v_lshrrev_b32 v13, 5, v0
    v_lshlrev_b32 v12, 2, v12
    v_lshl_add_u32 v8, v13, 10, v12
    s_mul_i32 s46, s33, 65536
    s_add_u32 s46, s46, 0x543f800
    s_lshl_b32 s37, s35, 7
    s_add_u32 s46, s46, s37
    s_cmp_eq_u32 s32, 2
    s_cselect_b32 s46, s46, 0x5f00000
    s_mov_b32 s36, -1
    v_add_u32 v50, 0, v48
    v_add_u32 v51, 0, v49
    s_waitcnt vmcnt(16)
    s_barrier
    ds_read_b64_tr_b16 a[0:1], v50 offset:0
    ds_read_b64_tr_b16 a[2:3], v50 offset:512
    ds_read_b64_tr_b16 a[4:5], v51 offset:0
    ds_read_b64_tr_b16 a[6:7], v51 offset:512
    ds_read_b64_tr_b16 a[8:9], v50 offset:4096
    ds_read_b64_tr_b16 a[10:11], v50 offset:4608
    ds_read_b64_tr_b16 a[12:13], v51 offset:4096
    ds_read_b64_tr_b16 a[14:15], v51 offset:4608
    s_add_u32 m0, s42, 81920
    s_nop 0
    buffer_load_dwordx4 v44, s[12:15], s54 offen lds
    s_add_u32 m0, s42, 82944
    s_nop 0
    buffer_load_dwordx4 v45, s[12:15], s54 offen lds
    s_add_u32 m0, s42, 90112
    s_nop 0
    buffer_load_dwordx4 v46, s[12:15], s54 offen lds
    s_add_u32 m0, s42, 91136
    s_nop 0
    buffer_load_dwordx4 v47, s[12:15], s54 offen lds
    s_add_u32 s54, s54, 131072
    s_waitcnt lgkmcnt(0)
    v_add_u32 v50, 16384, v48
    v_add_u32 v51, 16384, v49
    s_waitcnt vmcnt(16)
    s_barrier
    ds_read_b64_tr_b16 a[16:17], v50 offset:0
    ds_read_b64_tr_b16 a[18:19], v50 offset:512
    ds_read_b64_tr_b16 a[20:21], v51 offset:0
    ds_read_b64_tr_b16 a[22:23], v51 offset:512
    ds_read_b64_tr_b16 a[24:25], v50 offset:4096
    ds_read_b64_tr_b16 a[26:27], v50 offset:4608
    ds_read_b64_tr_b16 a[28:29], v51 offset:4096
    ds_read_b64_tr_b16 a[30:31], v51 offset:4608
    s_add_u32 m0, s42, 0
    s_nop 0
    buffer_load_dwordx4 v44, s[12:15], s54 offen lds
    s_add_u32 m0, s42, 1024
    s_nop 0
    buffer_load_dwordx4 v45, s[12:15], s54 offen lds
    s_add_u32 m0, s42, 8192
    s_nop 0
    buffer_load_dwordx4 v46, s[12:15], s54 offen lds
    s_add_u32 m0, s42, 9216
    s_nop 0
    buffer_load_dwordx4 v47, s[12:15], s54 offen lds
    s_add_u32 s54, s54, 131072
    s_waitcnt lgkmcnt(0)
    v_add_u32 v50, 32768, v48
    v_add_u32 v51, 32768, v49
    s_waitcnt vmcnt(16)
    s_barrier
    ds_read_b64_tr_b16 a[32:33], v50 offset:0
    ds_read_b64_tr_b16 a[34:35], v50 offset:512
    ds_read_b64_tr_b16 a[36:37], v51 offset:0
    ds_read_b64_tr_b16 a[38:39], v51 offset:512
    ds_read_b64_tr_b16 a[40:41], v50 offset:4096
    ds_read_b64_tr_b16 a[42:43], v50 offset:4608
    ds_read_b64_tr_b16 a[44:45], v51 offset:4096
    ds_read_b64_tr_b16 a[46:47], v51 offset:4608
    s_add_u32 m0, s42, 16384
    s_nop 0
    buffer_load_dwordx4 v44, s[12:15], s54 offen lds
    s_add_u32 m0, s42, 17408
    s_nop 0
    buffer_load_dwordx4 v45, s[12:15], s54 offen lds
    s_add_u32 m0, s42, 24576
    s_nop 0
    buffer_load_dwordx4 v46, s[12:15], s54 offen lds
    s_add_u32 m0, s42, 25600
    s_nop 0
    buffer_load_dwordx4 v47, s[12:15], s54 offen lds
    s_add_u32 s54, s54, 131072
    s_waitcnt lgkmcnt(0)
    v_add_u32 v50, 49152, v48
    v_add_u32 v51, 49152, v49
    s_waitcnt vmcnt(16)
    s_barrier
    ds_read_b64_tr_b16 a[48:49], v50 offset:0
    ds_read_b64_tr_b16 a[50:51], v50 offset:512
    ds_read_b64_tr_b16 a[52:53], v51 offset:0
    ds_read_b64_tr_b16 a[54:55], v51 offset:512
    ds_read_b64_tr_b16 a[56:57], v50 offset:4096
    ds_read_b64_tr_b16 a[58:59], v50 offset:4608
    ds_read_b64_tr_b16 a[60:61], v51 offset:4096
    ds_read_b64_tr_b16 a[62:63], v51 offset:4608
    s_add_u32 m0, s42, 32768
    s_nop 0
    buffer_load_dwordx4 v44, s[12:15], s54 offen lds
    s_add_u32 m0, s42, 33792
    s_nop 0
    buffer_load_dwordx4 v45, s[12:15], s54 offen lds
    s_add_u32 m0, s42, 40960
    s_nop 0
    buffer_load_dwordx4 v46, s[12:15], s54 offen lds
    s_add_u32 m0, s42, 41984
    s_nop 0
    buffer_load_dwordx4 v47, s[12:15], s54 offen lds
    s_add_u32 s54, s54, 131072
    s_waitcnt lgkmcnt(0)
    v_add_u32 v50, 65536, v48
    v_add_u32 v51, 65536, v49
    s_waitcnt vmcnt(16)
    s_barrier
    ds_read_b64_tr_b16 a[64:65], v50 offset:0
    ds_read_b64_tr_b16 a[66:67], v50 offset:512
    ds_read_b64_tr_b16 a[68:69], v51 offset:0
    ds_read_b64_tr_b16 a[70:71], v51 offset:512
    ds_read_b64_tr_b16 a[72:73], v50 offset:4096
    ds_read_b64_tr_b16 a[74:75], v50 offset:4608
    ds_read_b64_tr_b16 a[76:77], v51 offset:4096
    ds_read_b64_tr_b16 a[78:79], v51 offset:4608
    s_add_u32 m0, s42, 49152
    s_nop 0
    buffer_load_dwordx4 v44, s[12:15], s54 offen lds
    s_add_u32 m0, s42, 50176
    s_nop 0
    buffer_load_dwordx4 v45, s[12:15], s54 offen lds
    s_add_u32 m0, s42, 57344
    s_nop 0
    buffer_load_dwordx4 v46, s[12:15], s54 offen lds
    s_add_u32 m0, s42, 58368
    s_nop 0
    buffer_load_dwordx4 v47, s[12:15], s54 offen lds
    s_add_u32 s54, s54, 131072
    s_waitcnt lgkmcnt(0)
    v_add_u32 v50, 81920, v48
    v_add_u32 v51, 81920, v49
    s_waitcnt vmcnt(16)
    s_barrier
    ds_read_b64_tr_b16 a[80:81], v50 offset:0
    ds_read_b64_tr_b16 a[82:83], v50 offset:512
    ds_read_b64_tr_b16 a[84:85], v51 offset:0
    ds_read_b64_tr_b16 a[86:87], v51 offset:512
    ds_read_b64_tr_b16 a[88:89], v50 offset:4096
    ds_read_b64_tr_b16 a[90:91], v50 offset:4608
    ds_read_b64_tr_b16 a[92:93], v51 offset:4096
    ds_read_b64_tr_b16 a[94:95], v51 offset:4608
    s_add_u32 m0, s42, 65536
    s_nop 0
    buffer_load_dwordx4 v44, s[12:15], s54 offen lds
    s_add_u32 m0, s42, 66560
    s_nop 0
    buffer_load_dwordx4 v45, s[12:15], s54 offen lds
    s_add_u32 m0, s42, 73728
    s_nop 0
    buffer_load_dwordx4 v46, s[12:15], s54 offen lds
    s_add_u32 m0, s42, 74752
    s_nop 0
    buffer_load_dwordx4 v47, s[12:15], s54 offen lds
    s_add_u32 s54, s54, 131072
    s_waitcnt lgkmcnt(0)
    v_add_u32 v50, 0, v48
    v_add_u32 v51, 0, v49
    s_waitcnt vmcnt(16)
    s_barrier
    ds_read_b64_tr_b16 a[96:97], v50 offset:0
    ds_read_b64_tr_b16 a[98:99], v50 offset:512
    ds_read_b64_tr_b16 a[100:101], v51 offset:0
    ds_read_b64_tr_b16 a[102:103], v51 offset:512
    ds_read_b64_tr_b16 a[104:105], v50 offset:4096
    ds_read_b64_tr_b16 a[106:107], v50 offset:4608
    ds_read_b64_tr_b16 a[108:109], v51 offset:4096
    ds_read_b64_tr_b16 a[110:111], v51 offset:4608
    s_add_u32 m0, s42, 81920
    s_nop 0
    buffer_load_dwordx4 v44, s[12:15], s54 offen lds
    s_add_u32 m0, s42, 82944
    s_nop 0
    buffer_load_dwordx4 v45, s[12:15], s54 offen lds
    s_add_u32 m0, s42, 90112
    s_nop 0
    buffer_load_dwordx4 v46, s[12:15], s54 offen lds
    s_add_u32 m0, s42, 91136
    s_nop 0
    buffer_load_dwordx4 v47, s[12:15], s54 offen lds
    s_add_u32 s54, s54, 131072
    s_waitcnt lgkmcnt(0)
    v_add_u32 v50, 16384, v48
    v_add_u32 v51, 16384, v49
    s_waitcnt vmcnt(16)
    s_barrier
    ds_read_b64_tr_b16 a[112:113], v50 offset:0
    ds_read_b64_tr_b16 a[114:115], v50 offset:512
    ds_read_b64_tr_b16 a[116:117], v51 offset:0
    ds_read_b64_tr_b16 a[118:119], v51 offset:512
    ds_read_b64_tr_b16 a[120:121], v50 offset:4096
    ds_read_b64_tr_b16 a[122:123], v50 offset:4608
    ds_read_b64_tr_b16 a[124:125], v51 offset:4096
    ds_read_b64_tr_b16 a[126:127], v51 offset:4608
    s_add_u32 m0, s42, 0
    s_nop 0
    buffer_load_dwordx4 v44, s[12:15], s54 offen lds
    s_add_u32 m0, s42, 1024
    s_nop 0
    buffer_load_dwordx4 v45, s[12:15], s54 offen lds
    s_add_u32 m0, s42, 8192
    s_nop 0
    buffer_load_dwordx4 v46, s[12:15], s54 offen lds
    s_add_u32 m0, s42, 9216
    s_nop 0
    buffer_load_dwordx4 v47, s[12:15], s54 offen lds
    s_add_u32 s54, s54, 131072
    s_waitcnt lgkmcnt(0)
    v_add_u32 v50, 32768, v48
    v_add_u32 v51, 32768, v49
    s_waitcnt vmcnt(16)
    s_barrier
    ds_read_b64_tr_b16 a[128:129], v50 offset:0
    ds_read_b64_tr_b16 a[130:131], v50 offset:512
    ds_read_b64_tr_b16 a[132:133], v51 offset:0
    ds_read_b64_tr_b16 a[134:135], v51 offset:512
    ds_read_b64_tr_b16 a[136:137], v50 offset:4096
    ds_read_b64_tr_b16 a[138:139], v50 offset:4608
    ds_read_b64_tr_b16 a[140:141], v51 offset:4096
    ds_read_b64_tr_b16 a[142:143], v51 offset:4608
    s_add_u32 m0, s42, 16384
    s_nop 0
    buffer_load_dwordx4 v44, s[12:15], s54 offen lds
    s_add_u32 m0, s42, 17408
    s_nop 0
    buffer_load_dwordx4 v45, s[12:15], s54 offen lds
    s_add_u32 m0, s42, 24576
    s_nop 0
    buffer_load_dwordx4 v46, s[12:15], s54 offen lds
    s_add_u32 m0, s42, 25600
    s_nop 0
    buffer_load_dwordx4 v47, s[12:15], s54 offen lds
    s_add_u32 s54, s54, 131072
    s_waitcnt lgkmcnt(0)
    v_add_u32 v50, 49152, v48
    v_add_u32 v51, 49152, v49
    s_waitcnt vmcnt(16)
    s_barrier
    ds_read_b64_tr_b16 a[144:145], v50 offset:0
    ds_read_b64_tr_b16 a[146:147], v50 offset:512
    ds_read_b64_tr_b16 a[148:149], v51 offset:0
    ds_read_b64_tr_b16 a[150:151], v51 offset:512
    ds_read_b64_tr_b16 a[152:153], v50 offset:4096
    ds_read_b64_tr_b16 a[154:155], v50 offset:4608
    ds_read_b64_tr_b16 a[156:157], v51 offset:4096
    ds_read_b64_tr_b16 a[158:159], v51 offset:4608
    s_add_u32 m0, s42, 32768
    s_nop 0
    buffer_load_dwordx4 v44, s[12:15], s54 offen lds
    s_add_u32 m0, s42, 33792
    s_nop 0
    buffer_load_dwordx4 v45, s[12:15], s54 offen lds
    s_add_u32 m0, s42, 40960
    s_nop 0
    buffer_load_dwordx4 v46, s[12:15], s54 offen lds
    s_add_u32 m0, s42, 41984
    s_nop 0
    buffer_load_dwordx4 v47, s[12:15], s54 offen lds
    s_add_u32 s54, s54, 131072
    s_waitcnt lgkmcnt(0)
    v_add_u32 v50, 65536, v48
    v_add_u32 v51, 65536, v49
    s_waitcnt vmcnt(16)
    s_barrier
    ds_read_b64_tr_b16 a[160:161], v50 offset:0
    ds_read_b64_tr_b16 a[162:163], v50 offset:512
    ds_read_b64_tr_b16 a[164:165], v51 offset:0
    ds_read_b64_tr_b16 a[166:167], v51 offset:512
    ds_read_b64_tr_b16 a[168:169], v50 offset:4096
    ds_read_b64_tr_b16 a[170:171], v50 offset:4608
    ds_read_b64_tr_b16 a[172:173], v51 offset:4096
    ds_read_b64_tr_b16 a[174:175], v51 offset:4608
    s_add_u32 m0, s42, 49152
    s_nop 0
    buffer_load_dwordx4 v44, s[12:15], s54 offen lds
    s_add_u32 m0, s42, 50176
    s_nop 0
    buffer_load_dwordx4 v45, s[12:15], s54 offen lds
    s_add_u32 m0, s42, 57344
    s_nop 0
    buffer_load_dwordx4 v46, s[12:15], s54 offen lds
    s_add_u32 m0, s42, 58368
    s_nop 0
    buffer_load_dwordx4 v47, s[12:15], s54 offen lds
    s_add_u32 s54, s54, 131072
    s_waitcnt lgkmcnt(0)
    v_add_u32 v50, 81920, v48
    v_add_u32 v51, 81920, v49
    s_waitcnt vmcnt(16)
    s_barrier
    ds_read_b64_tr_b16 a[176:177], v50 offset:0
    ds_read_b64_tr_b16 a[178:179], v50 offset:512
    ds_read_b64_tr_b16 a[180:181], v51 offset:0
    ds_read_b64_tr_b16 a[182:183], v51 offset:512
    ds_read_b64_tr_b16 a[184:185], v50 offset:4096
    ds_read_b64_tr_b16 a[186:187], v50 offset:4608
    ds_read_b64_tr_b16 a[188:189], v51 offset:4096
    ds_read_b64_tr_b16 a[190:191], v51 offset:4608
    s_waitcnt lgkmcnt(0)
    v_add_u32 v50, 0, v48
    v_add_u32 v51, 0, v49
    s_waitcnt vmcnt(12)
    s_barrier
    ds_read_b64_tr_b16 a[192:193], v50 offset:0
    ds_read_b64_tr_b16 a[194:195], v50 offset:512
    ds_read_b64_tr_b16 a[196:197], v51 offset:0
    ds_read_b64_tr_b16 a[198:199], v51 offset:512
    ds_read_b64_tr_b16 a[200:201], v50 offset:4096
    ds_read_b64_tr_b16 a[202:203], v50 offset:4608
    ds_read_b64_tr_b16 a[204:205], v51 offset:4096
    ds_read_b64_tr_b16 a[206:207], v51 offset:4608
    s_waitcnt lgkmcnt(0)
    v_add_u32 v50, 16384, v48
    v_add_u32 v51, 16384, v49
    s_waitcnt vmcnt(8)
    s_barrier
    ds_read_b64_tr_b16 a[208:209], v50 offset:0
    ds_read_b64_tr_b16 a[210:211], v50 offset:512
    ds_read_b64_tr_b16 a[212:213], v51 offset:0
    ds_read_b64_tr_b16 a[214:215], v51 offset:512
    ds_read_b64_tr_b16 a[216:217], v50 offset:4096
    ds_read_b64_tr_b16 a[218:219], v50 offset:4608
    ds_read_b64_tr_b16 a[220:221], v51 offset:4096
    ds_read_b64_tr_b16 a[222:223], v51 offset:4608
    s_waitcnt lgkmcnt(0)
    v_add_u32 v50, 32768, v48
    v_add_u32 v51, 32768, v49
    s_waitcnt vmcnt(4)
    s_barrier
    ds_read_b64_tr_b16 a[224:225], v50 offset:0
    ds_read_b64_tr_b16 a[226:227], v50 offset:512
    ds_read_b64_tr_b16 a[228:229], v51 offset:0
    ds_read_b64_tr_b16 a[230:231], v51 offset:512
    ds_read_b64_tr_b16 a[232:233], v50 offset:4096
    ds_read_b64_tr_b16 a[234:235], v50 offset:4608
    ds_read_b64_tr_b16 a[236:237], v51 offset:4096
    ds_read_b64_tr_b16 a[238:239], v51 offset:4608
    s_waitcnt lgkmcnt(0)
    v_add_u32 v50, 49152, v48
    v_add_u32 v51, 49152, v49
    s_waitcnt vmcnt(0)
    s_barrier
    ds_read_b64_tr_b16 a[240:241], v50 offset:0
    ds_read_b64_tr_b16 a[242:243], v50 offset:512
    ds_read_b64_tr_b16 a[244:245], v51 offset:0
    ds_read_b64_tr_b16 a[246:247], v51 offset:512
    ds_read_b64_tr_b16 a[248:249], v50 offset:4096
    ds_read_b64_tr_b16 a[250:251], v50 offset:4608
    ds_read_b64_tr_b16 a[252:253], v51 offset:4096
    ds_read_b64_tr_b16 a[254:255], v51 offset:4608
    s_waitcnt lgkmcnt(0)
    s_barrier
    s_cmp_lg_u32 s32, 0
    s_cbranch_scc1 L_arv21
    s_add_u32 s20, s82, 0x80
    s_addc_u32 s21, s83, 0
    s_mov_b32 s22, 0x4
    s_mov_b32 s23, 0x00020000
    buffer_load_dword v12, v124, s[20:23], 0 offen sc1
    s_waitcnt vmcnt(0)
    v_cmp_eq_u32 vcc, v124, v12
    s_cbranch_vccnz L_spin22
L_back23:
L_arv21:
    s_add_u32 s96, s41, 2031616
    s_mov_b32 s98, s41
    s_mov_b32 s45, 0x5540000
    buffer_load_dword v136, v4, s[16:19], s45 offen sc1
    s_waitcnt vmcnt(0)
    v_cmp_ne_u32 vcc, 0, v136
    s_cbranch_vccnz L_spin24
L_back25:
    s_barrier
    s_add_u32 m0, s43, 0
    s_add_u32 s42, s41, 0
    buffer_load_dwordx4 v1, s[16:19], s42 offen offset:0 sc1 lds
    buffer_load_dwordx4 v1, s[16:19], s42 offen offset:1024 sc1 lds
    buffer_load_dwordx4 v1, s[16:19], s42 offen offset:2048 sc1 lds
    buffer_load_dwordx4 v1, s[16:19], s42 offen offset:3072 sc1 lds
    s_add_u32 m0, s43, 16384
    s_add_u32 s42, s41, 16384
    buffer_load_dwordx4 v1, s[16:19], s42 offen offset:0 sc1 lds
    buffer_load_dwordx4 v1, s[16:19], s42 offen offset:1024 sc1 lds
    buffer_load_dwordx4 v1, s[16:19], s42 offen offset:2048 sc1 lds
    buffer_load_dwordx4 v1, s[16:19], s42 offen offset:3072 sc1 lds
    s_add_u32 m0, s43, 32768
    s_add_u32 s42, s41, 32768
    buffer_load_dwordx4 v1, s[16:19], s42 offen offset:0 sc1 lds
    buffer_load_dwordx4 v1, s[16:19], s42 offen offset:1024 sc1 lds
    buffer_load_dwordx4 v1, s[16:19], s42 offen offset:2048 sc1 lds
    buffer_load_dwordx4 v1, s[16:19], s42 offen offset:3072 sc1 lds
    s_add_u32 s45, s45, 65536
    s_add_u32 s47, s36, 1
    s_min_i32 s47, s47, 31
    s_max_i32 s47, s47, 0
    s_cmp_ge_u32 s47, 16
    s_cselect_b32 s8, s88, s64
    s_cselect_b32 s9, s89, s65
    s_and_b32 s47, s47, 15
    s_lshl_b32 s47, s47, 16
    s_sub_u32 s47, s50, s47
    s_add_u32 s48, s47, 32768
    buffer_load_dwordx4 v[128:131], v3, s[8:11], s48 offen sc1
    buffer_load_dwordx4 v[132:135], v3, s[8:11], s47 offen sc1
    s_waitcnt vmcnt(0) lgkmcnt(0)
    s_barrier
    v_mfma_f32_16x16x32_bf16 v[12:15], v[108:111], v[128:131], 0
    v_mfma_f32_16x16x32_bf16 v[16:19], v[112:115], v[128:131], 0
    v_mfma_f32_16x16x32_bf16 v[20:23], v[108:111], v[132:135], 0
    v_mfma_f32_16x16x32_bf16 v[24:27], v[112:115], v[132:135], 0
    ds_read_b128 v[44:47], v1 offset:0
    ds_read_b128 v[48:51], v1 offset:1024
    ds_read_b128 v[52:55], v1 offset:2048
    ds_read_b128 v[56:59], v1 offset:3072
    s_mov_b32 s36, 0
    s_waitcnt lgkmcnt(0)
    s_nop 7
L_o_b0:
    s_waitcnt lgkmcnt(2)
    v_mfma_f32_16x16x32_bf16 v[12:15], a[0:3], v[44:47], v[12:15]
    s_add_u32 m0, s43, 49152
    ds_read_b128 v[60:63], v1 offset:4096
    s_add_u32 s42, s41, 49152
    v_mfma_f32_16x16x32_bf16 v[20:23], a[0:3], v[48:51], v[20:23]
    buffer_load_dwordx4 v1, s[16:19], s42 offen offset:0 sc1 lds
    v_mfma_f32_16x16x32_bf16 v[24:27], a[4:7], v[48:51], v[24:27]
    ds_read_b128 v[64:67], v1 offset:5120
    v_mfma_f32_16x16x32_bf16 v[16:19], a[4:7], v[44:47], v[16:19]
    s_waitcnt lgkmcnt(2)
    buffer_load_dwordx4 v1, s[16:19], s42 offen offset:1024 sc1 lds
    v_mfma_f32_16x16x32_bf16 v[12:15], a[8:11], v[52:55], v[12:15]
    ds_read_b128 v[68:71], v1 offset:6144
    v_mfma_f32_16x16x32_bf16 v[20:23], a[8:11], v[56:59], v[20:23]
    buffer_load_dwordx4 v1, s[16:19], s42 offen offset:2048 sc1 lds
    v_mfma_f32_16x16x32_bf16 v[24:27], a[12:15], v[56:59], v[24:27]
    ds_read_b128 v[72:75], v1 offset:7168
    v_mfma_f32_16x16x32_bf16 v[16:19], a[12:15], v[52:55], v[16:19]
    s_waitcnt lgkmcnt(2)
    buffer_load_dwordx4 v1, s[16:19], s42 offen offset:3072 sc1 lds
    v_mfma_f32_16x16x32_bf16 v[12:15], a[16:19], v[60:63], v[12:15]
    s_add_u32 s98, s98, 65536
    ds_read_b128 v[44:47], v1 offset:8192
    s_min_i32 s98, s98, s96
    v_mfma_f32_16x16x32_bf16 v[20:23], a[16:19], v[64:67], v[20:23]
    s_and_b32 s41, s98, 0xffffffff
    s_add_u32 m0, s43, 98304
    s_add_u32 s42, s41, 0
    v_mfma_f32_16x16x32_bf16 v[24:27], a[20:23], v[64:67], v[24:27]
    s_add_u32 s47, s36, 1
    ds_read_b128 v[48:51], v1 offset:9216
    s_min_i32 s47, s47, 31
    v_mfma_f32_16x16x32_bf16 v[16:19], a[20:23], v[60:63], v[16:19]
    s_waitcnt lgkmcnt(2)
    s_max_i32 s47, s47, 0
    s_cmp_ge_u32 s47, 16
    v_mfma_f32_16x16x32_bf16 v[12:15], a[24:27], v[68:71], v[12:15]
    s_cselect_b32 s8, s88, s64
    ds_read_b128 v[52:55], v1 offset:10240
    s_cselect_b32 s9, s89, s65
    v_mfma_f32_16x16x32_bf16 v[20:23], a[24:27], v[72:75], v[20:23]
    s_and_b32 s47, s47, 15
    s_lshl_b32 s47, s47, 16
    s_sub_u32 s47, s50, s47
    v_mfma_f32_16x16x32_bf16 v[24:27], a[28:31], v[72:75], v[24:27]
    s_add_u32 s48, s47, 32768
    ds_read_b128 v[56:59], v1 offset:11264
    buffer_load_dwordx4 v[128:131], v3, s[8:11], s48 offen sc1
    v_mfma_f32_16x16x32_bf16 v[16:19], a[28:31], v[68:71], v[16:19]
    s_waitcnt lgkmcnt(2)
    buffer_load_dwordx4 v[132:135], v3, s[8:11], s47 offen sc1
    v_mfma_f32_16x16x32_bf16 v[12:15], a[32:35], v[44:47], v[12:15]
    s_waitcnt vmcnt(11)
    ds_read_b128 v[60:63], v1 offset:12288
    s_barrier
    v_mfma_f32_16x16x32_bf16 v[20:23], a[32:35], v[48:51], v[20:23]
    buffer_store_dword v124, v124, s[16:19], s91 offen sc1
    v_mfma_f32_16x16x32_bf16 v[24:27], a[36:39], v[48:51], v[24:27]
    s_add_u32 s91, s91, 65536
    ds_read_b128 v[64:67], v1 offset:13312
    s_add_u32 s90, s90, 65536
    v_mfma_f32_16x16x32_bf16 v[16:19], a[36:39], v[44:47], v[16:19]
    s_waitcnt lgkmcnt(2)
    s_add_u32 s46, s46, 2048
    s_and_b32 s44, s90, 0xffffffff
    v_mfma_f32_16x16x32_bf16 v[12:15], a[40:43], v[52:55], v[12:15]
    ds_read_b128 v[68:71], v1 offset:14336
    v_mfma_f32_16x16x32_bf16 v[20:23], a[40:43], v[56:59], v[20:23]
    v_mfma_f32_16x16x32_bf16 v[24:27], a[44:47], v[56:59], v[24:27]
    ds_read_b128 v[72:75], v1 offset:15360
    v_mfma_f32_16x16x32_bf16 v[16:19], a[44:47], v[52:55], v[16:19]
    s_waitcnt lgkmcnt(2)
    v_mfma_f32_16x16x32_bf16 v[12:15], a[48:51], v[60:63], v[12:15]
    ds_read_b128 v[44:47], v1 offset:16384
    v_mfma_f32_16x16x32_bf16 v[20:23], a[48:51], v[64:67], v[20:23]
    v_mfma_f32_16x16x32_bf16 v[24:27], a[52:55], v[64:67], v[24:27]
    ds_read_b128 v[48:51], v1 offset:17408
    v_mfma_f32_16x16x32_bf16 v[16:19], a[52:55], v[60:63], v[16:19]
    s_waitcnt lgkmcnt(2)
    v_mfma_f32_16x16x32_bf16 v[12:15], a[56:59], v[68:71], v[12:15]
    ds_read_b128 v[52:55], v1 offset:18432
    v_mfma_f32_16x16x32_bf16 v[20:23], a[56:59], v[72:75], v[20:23]
    v_mfma_f32_16x16x32_bf16 v[24:27], a[60:63], v[72:75], v[24:27]
    ds_read_b128 v[56:59], v1 offset:19456
    v_mfma_f32_16x16x32_bf16 v[16:19], a[60:63], v[68:71], v[16:19]
    s_waitcnt lgkmcnt(2)
    v_mfma_f32_16x16x32_bf16 v[12:15], a[64:67], v[44:47], v[12:15]
    ds_read_b128 v[60:63], v1 offset:20480
    v_mfma_f32_16x16x32_bf16 v[20:23], a[64:67], v[48:51], v[20:23]
    v_mfma_f32_16x16x32_bf16 v[24:27], a[68:71], v[48:51], v[24:27]
    ds_read_b128 v[64:67], v1 offset:21504
    v_mfma_f32_16x16x32_bf16 v[16:19], a[68:71], v[44:47], v[16:19]
    s_waitcnt lgkmcnt(2)
    v_mfma_f32_16x16x32_bf16 v[12:15], a[72:75], v[52:55], v[12:15]
    ds_read_b128 v[68:71], v1 offset:22528
    v_mfma_f32_16x16x32_bf16 v[20:23], a[72:75], v[56:59], v[20:23]
    v_mfma_f32_16x16x32_bf16 v[24:27], a[76:79], v[56:59], v[24:27]
    ds_read_b128 v[72:75], v1 offset:23552
    v_mfma_f32_16x16x32_bf16 v[16:19], a[76:79], v[52:55], v[16:19]
    s_waitcnt lgkmcnt(2)
    v_mfma_f32_16x16x32_bf16 v[12:15], a[80:83], v[60:63], v[12:15]
    ds_read_b128 v[44:47], v1 offset:24576
    v_mfma_f32_16x16x32_bf16 v[20:23], a[80:83], v[64:67], v[20:23]
    v_mfma_f32_16x16x32_bf16 v[24:27], a[84:87], v[64:67], v[24:27]
    ds_read_b128 v[48:51], v1 offset:25600
    v_mfma_f32_16x16x32_bf16 v[16:19], a[84:87], v[60:63], v[16:19]
    s_waitcnt lgkmcnt(2)
    v_mfma_f32_16x16x32_bf16 v[12:15], a[88:91], v[68:71], v[12:15]
    ds_read_b128 v[52:55], v1 offset:26624
    v_mfma_f32_16x16x32_bf16 v[20:23], a[88:91], v[72:75], v[20:23]
    v_mfma_f32_16x16x32_bf16 v[24:27], a[92:95], v[72:75], v[24:27]
    ds_read_b128 v[56:59], v1 offset:27648
    v_mfma_f32_16x16x32_bf16 v[16:19], a[92:95], v[68:71], v[16:19]
    s_waitcnt lgkmcnt(2)
    v_mfma_f32_16x16x32_bf16 v[12:15], a[96:99], v[44:47], v[12:15]
    ds_read_b128 v[60:63], v1 offset:28672
    v_mfma_f32_16x16x32_bf16 v[20:23], a[96:99], v[48:51], v[20:23]
    v_mfma_f32_16x16x32_bf16 v[24:27], a[100:103], v[48:51], v[24:27]
    ds_read_b128 v[64:67], v1 offset:29696
    v_mfma_f32_16x16x32_bf16 v[16:19], a[100:103], v[44:47], v[16:19]
    s_waitcnt lgkmcnt(2)
    v_mfma_f32_16x16x32_bf16 v[12:15], a[104:107], v[52:55], v[12:15]
    ds_read_b128 v[68:71], v1 offset:30720
    v_mfma_f32_16x16x32_bf16 v[20:23], a[104:107], v[56:59], v[20:23]
    v_mfma_f32_16x16x32_bf16 v[24:27], a[108:111], v[56:59], v[24:27]
    ds_read_b128 v[72:75], v1 offset:31744
    v_mfma_f32_16x16x32_bf16 v[16:19], a[108:111], v[52:55], v[16:19]
    s_waitcnt vmcnt(8) lgkmcnt(2)
    s_barrier
    v_mfma_f32_16x16x32_bf16 v[12:15], a[112:115], v[60:63], v[12:15]
    ds_read_b128 v[44:47], v1 offset:32768
    v_mfma_f32_16x16x32_bf16 v[20:23], a[112:115], v[64:67], v[20:23]
    v_mfma_f32_16x16x32_bf16 v[24:27], a[116:119], v[64:67], v[24:27]
    ds_read_b128 v[48:51], v1 offset:33792
    v_mfma_f32_16x16x32_bf16 v[16:19], a[116:119], v[60:63], v[16:19]
    s_waitcnt lgkmcnt(2)
    v_mfma_f32_16x16x32_bf16 v[12:15], a[120:123], v[68:71], v[12:15]
    ds_read_b128 v[52:55], v1 offset:34816
    v_mfma_f32_16x16x32_bf16 v[20:23], a[120:123], v[72:75], v[20:23]
    v_mfma_f32_16x16x32_bf16 v[24:27], a[124:127], v[72:75], v[24:27]
    ds_read_b128 v[56:59], v1 offset:35840
    v_mfma_f32_16x16x32_bf16 v[16:19], a[124:127], v[68:71], v[16:19]
    s_waitcnt lgkmcnt(2)
    v_mfma_f32_16x16x32_bf16 v[12:15], a[128:131], v[44:47], v[12:15]
    ds_read_b128 v[60:63], v1 offset:36864
    v_mfma_f32_16x16x32_bf16 v[20:23], a[128:131], v[48:51], v[20:23]
    v_mfma_f32_16x16x32_bf16 v[24:27], a[132:135], v[48:51], v[24:27]
    ds_read_b128 v[64:67], v1 offset:37888
    v_mfma_f32_16x16x32_bf16 v[16:19], a[132:135], v[44:47], v[16:19]
    s_waitcnt lgkmcnt(2)
    v_mfma_f32_16x16x32_bf16 v[12:15], a[136:139], v[52:55], v[12:15]
    ds_read_b128 v[68:71], v1 offset:38912
    v_mfma_f32_16x16x32_bf16 v[20:23], a[136:139], v[56:59], v[20:23]
    v_mfma_f32_16x16x32_bf16 v[24:27], a[140:143], v[56:59], v[24:27]
    ds_read_b128 v[72:75], v1 offset:39936
    v_mfma_f32_16x16x32_bf16 v[16:19], a[140:143], v[52:55], v[16:19]
    s_waitcnt lgkmcnt(2)
    v_mfma_f32_16x16x32_bf16 v[12:15], a[144:147], v[60:63], v[12:15]
    ds_read_b128 v[44:47], v1 offset:40960
    v_mfma_f32_16x16x32_bf16 v[20:23], a[144:147], v[64:67], v[20:23]
    v_mfma_f32_16x16x32_bf16 v[24:27], a[148:151], v[64:67], v[24:27]
    ds_read_b128 v[48:51], v1 offset:41984
    v_mfma_f32_16x16x32_bf16 v[16:19], a[148:151], v[60:63], v[16:19]
    s_waitcnt lgkmcnt(2)
    v_mfma_f32_16x16x32_bf16 v[12:15], a[152:155], v[68:71], v[12:15]
    ds_read_b128 v[52:55], v1 offset:43008
    v_mfma_f32_16x16x32_bf16 v[20:23], a[152:155], v[72:75], v[20:23]
    v_mfma_f32_16x16x32_bf16 v[24:27], a[156:159], v[72:75], v[24:27]
    ds_read_b128 v[56:59], v1 offset:44032
    v_mfma_f32_16x16x32_bf16 v[16:19], a[156:159], v[68:71], v[16:19]
    s_waitcnt lgkmcnt(2)
    v_mfma_f32_16x16x32_bf16 v[12:15], a[160:163], v[44:47], v[12:15]
    ds_read_b128 v[60:63], v1 offset:45056
    buffer_load_dword v136, v4, s[16:19], s45 offen sc1
    v_mfma_f32_16x16x32_bf16 v[20:23], a[160:163], v[48:51], v[20:23]
    v_mfma_f32_16x16x32_bf16 v[24:27], a[164:167], v[48:51], v[24:27]
    ds_read_b128 v[64:67], v1 offset:46080
    v_mfma_f32_16x16x32_bf16 v[16:19], a[164:167], v[44:47], v[16:19]
    s_waitcnt lgkmcnt(2)
    v_mfma_f32_16x16x32_bf16 v[12:15], a[168:171], v[52:55], v[12:15]
    ds_read_b128 v[68:71], v1 offset:47104
    v_mfma_f32_16x16x32_bf16 v[20:23], a[168:171], v[56:59], v[20:23]
    v_mfma_f32_16x16x32_bf16 v[24:27], a[172:175], v[56:59], v[24:27]
    ds_read_b128 v[72:75], v1 offset:48128
    v_mfma_f32_16x16x32_bf16 v[16:19], a[172:175], v[52:55], v[16:19]
    s_waitcnt vmcnt(4) lgkmcnt(2)
    s_barrier
    v_mfma_f32_16x16x32_bf16 v[12:15], a[176:179], v[60:63], v[12:15]
    ds_read_b128 v[44:47], v1 offset:49152
    v_mfma_f32_16x16x32_bf16 v[20:23], a[176:179], v[64:67], v[20:23]
    v_mfma_f32_16x16x32_bf16 v[24:27], a[180:183], v[64:67], v[24:27]
    ds_read_b128 v[48:51], v1 offset:50176
    v_mfma_f32_16x16x32_bf16 v[16:19], a[180:183], v[60:63], v[16:19]
    s_waitcnt lgkmcnt(2)
    v_mfma_f32_16x16x32_bf16 v[12:15], a[184:187], v[68:71], v[12:15]
    ds_read_b128 v[52:55], v1 offset:51200
    v_mfma_f32_16x16x32_bf16 v[20:23], a[184:187], v[72:75], v[20:23]
    v_mfma_f32_16x16x32_bf16 v[24:27], a[188:191], v[72:75], v[24:27]
    ds_read_b128 v[56:59], v1 offset:52224
    v_mfma_f32_16x16x32_bf16 v[16:19], a[188:191], v[68:71], v[16:19]
    s_waitcnt lgkmcnt(2)
    v_mfma_f32_16x16x32_bf16 v[12:15], a[192:195], v[44:47], v[12:15]
    ds_read_b128 v[60:63], v1 offset:53248
    v_mfma_f32_16x16x32_bf16 v[20:23], a[192:195], v[48:51], v[20:23]
    v_mfma_f32_16x16x32_bf16 v[24:27], a[196:199], v[48:51], v[24:27]
    ds_read_b128 v[64:67], v1 offset:54272
    v_mfma_f32_16x16x32_bf16 v[16:19], a[196:199], v[44:47], v[16:19]
    s_waitcnt lgkmcnt(2)
    v_mfma_f32_16x16x32_bf16 v[12:15], a[200:203], v[52:55], v[12:15]
    s_waitcnt vmcnt(2)
    ds_read_b128 v[68:71], v1 offset:55296
    v_mfma_f32_16x16x32_bf16 v[28:31], v[108:111], v[128:131], 0
    v_mfma_f32_16x16x32_bf16 v[32:35], v[112:115], v[128:131], 0
    v_mfma_f32_16x16x32_bf16 v[36:39], v[108:111], v[132:135], 0
    v_mfma_f32_16x16x32_bf16 v[40:43], v[112:115], v[132:135], 0
    v_mfma_f32_16x16x32_bf16 v[20:23], a[200:203], v[56:59], v[20:23]
    v_mfma_f32_16x16x32_bf16 v[24:27], a[204:207], v[56:59], v[24:27]
    ds_read_b128 v[72:75], v1 offset:56320
    v_mfma_f32_16x16x32_bf16 v[16:19], a[204:207], v[52:55], v[16:19]
    s_waitcnt lgkmcnt(2)
    v_mfma_f32_16x16x32_bf16 v[12:15], a[208:211], v[60:63], v[12:15]
    ds_read_b128 v[44:47], v1 offset:57344
    v_mfma_f32_16x16x32_bf16 v[20:23], a[208:211], v[64:67], v[20:23]
    v_mfma_f32_16x16x32_bf16 v[24:27], a[212:215], v[64:67], v[24:27]
    ds_read_b128 v[48:51], v1 offset:58368
    v_mfma_f32_16x16x32_bf16 v[16:19], a[212:215], v[60:63], v[16:19]
    s_waitcnt lgkmcnt(2)
    v_mfma_f32_16x16x32_bf16 v[12:15], a[216:219], v[68:71], v[12:15]
    ds_read_b128 v[52:55], v1 offset:59392
    v_mfma_f32_16x16x32_bf16 v[20:23], a[216:219], v[72:75], v[20:23]
    v_mfma_f32_16x16x32_bf16 v[24:27], a[220:223], v[72:75], v[24:27]
    ds_read_b128 v[56:59], v1 offset:60416
    v_mfma_f32_16x16x32_bf16 v[16:19], a[220:223], v[68:71], v[16:19]
    s_waitcnt lgkmcnt(2)
    v_mfma_f32_16x16x32_bf16 v[12:15], a[224:227], v[44:47], v[12:15]
    ds_read_b128 v[60:63], v1 offset:61440
    v_mfma_f32_16x16x32_bf16 v[20:23], a[224:227], v[48:51], v[20:23]
    v_mfma_f32_16x16x32_bf16 v[24:27], a[228:231], v[48:51], v[24:27]
    s_waitcnt vmcnt(0)
    ds_read_b128 v[64:67], v1 offset:62464
    v_cmp_ne_u32 vcc, 0, v136
    v_mfma_f32_16x16x32_bf16 v[16:19], a[228:231], v[44:47], v[16:19]
    s_waitcnt lgkmcnt(2)
    v_mfma_f32_16x16x32_bf16 v[12:15], a[232:235], v[52:55], v[12:15]
    s_cbranch_vccnz L_spin26
L_back27:
    ds_read_b128 v[68:71], v1 offset:63488
    s_barrier
    v_mfma_f32_16x16x32_bf16 v[20:23], a[232:235], v[56:59], v[20:23]
    buffer_load_dwordx4 v1, s[16:19], s42 offen offset:0 sc1 lds
    v_mfma_f32_16x16x32_bf16 v[24:27], a[236:239], v[56:59], v[24:27]
    ds_read_b128 v[72:75], v1 offset:64512
    buffer_load_dwordx4 v1, s[16:19], s42 offen offset:1024 sc1 lds
    v_mfma_f32_16x16x32_bf16 v[16:19], a[236:239], v[52:55], v[16:19]
    s_waitcnt lgkmcnt(2)
    buffer_load_dwordx4 v1, s[16:19], s42 offen offset:2048 sc1 lds
    v_mfma_f32_16x16x32_bf16 v[12:15], a[240:243], v[60:63], v[12:15]
    buffer_load_dwordx4 v1, s[16:19], s42 offen offset:3072 sc1 lds
    v_mfma_f32_16x16x32_bf16 v[20:23], a[240:243], v[64:67], v[20:23]
    s_add_u32 m0, s43, 114688
    s_add_u32 s42, s41, 16384
    buffer_load_dwordx4 v1, s[16:19], s42 offen offset:0 sc1 lds
    v_mfma_f32_16x16x32_bf16 v[24:27], a[244:247], v[64:67], v[24:27]
    buffer_load_dwordx4 v1, s[16:19], s42 offen offset:1024 sc1 lds
    v_mfma_f32_16x16x32_bf16 v[16:19], a[244:247], v[60:63], v[16:19]
    s_waitcnt lgkmcnt(0)
    buffer_load_dwordx4 v1, s[16:19], s42 offen offset:2048 sc1 lds
    v_mfma_f32_16x16x32_bf16 v[12:15], a[248:251], v[68:71], v[12:15]
    buffer_load_dwordx4 v1, s[16:19], s42 offen offset:3072 sc1 lds
    v_mfma_f32_16x16x32_bf16 v[20:23], a[248:251], v[72:75], v[20:23]
    s_add_u32 s45, s45, 65536
    v_mfma_f32_16x16x32_bf16 v[24:27], a[252:255], v[72:75], v[24:27]
    v_mfma_f32_16x16x32_bf16 v[16:19], a[252:255], v[68:71], v[16:19]
    v_cvt_pk_bf16_f32 v148, v12, v13
    v_cvt_pk_bf16_f32 v149, v14, v15
    s_nop 5
    v_cvt_pk_bf16_f32 v150, v16, v17
    v_cvt_pk_bf16_f32 v151, v18, v19
    buffer_store_dwordx4 v[148:151], v1, s[16:19], s44 offen offset:0 sc1
    v_cvt_pk_bf16_f32 v152, v20, v21
    v_cvt_pk_bf16_f32 v153, v22, v23
    v_cvt_pk_bf16_f32 v154, v24, v25
    v_cvt_pk_bf16_f32 v155, v26, v27
    buffer_store_dwordx4 v[152:155], v1, s[16:19], s44 offen offset:1024 sc1
    v_add_f32 v140, v12, v13
    v_add_f32 v144, v20, v21
    v_mul_f32 v141, v12, v12
    v_mul_f32 v145, v20, v20
    v_fmac_f32 v141, v13, v13
    v_fmac_f32 v145, v21, v21
    v_add_f32 v140, v140, v14
    v_add_f32 v144, v144, v22
    v_fmac_f32 v141, v14, v14
    v_fmac_f32 v145, v22, v22
    v_add_f32 v140, v140, v15
    v_add_f32 v144, v144, v23
    v_fmac_f32 v141, v15, v15
    v_fmac_f32 v145, v23, v23
    v_add_f32 v140, v140, v16
    v_add_f32 v144, v144, v24
    v_fmac_f32 v141, v16, v16
    v_fmac_f32 v145, v24, v24
    v_add_f32 v140, v140, v17
    v_add_f32 v144, v144, v25
    v_fmac_f32 v141, v17, v17
    v_fmac_f32 v145, v25, v25
    v_add_f32 v140, v140, v18
    v_add_f32 v144, v144, v26
    v_fmac_f32 v141, v18, v18
    v_fmac_f32 v145, v26, v26
    v_add_f32 v140, v140, v19
    v_add_f32 v144, v144, v27
    v_fmac_f32 v141, v19, v19
    v_fmac_f32 v145, v27, v27
    s_nop 0
    v_permlane16_swap_b32 v140, v141
    v_permlane16_swap_b32 v144, v145
    v_add_f32 v140, v140, v141
    v_add_f32 v144, v144, v145
    v_mov_b32 v142, v140
    v_mov_b32 v146, v144
    s_nop 0
    v_permlane32_swap_b32 v140, v142
    v_permlane32_swap_b32 v144, v146
    v_add_f32 v140, v140, v142
    v_add_f32 v144, v144, v146
    ds_write_b32 v6, v140 offset:0
    ds_write_b32 v6, v144 offset:512
    s_waitcnt lgkmcnt(0)
    s_barrier
    ds_read_b128 v[140:143], v7 offset:0
    s_add_u32 m0, s43, 131072
    s_add_u32 s42, s41, 32768
    buffer_load_dwordx4 v1, s[16:19], s42 offen offset:0 sc1 lds
    buffer_load_dwordx4 v1, s[16:19], s42 offen offset:1024 sc1 lds
    buffer_load_dwordx4 v1, s[16:19], s42 offen offset:2048 sc1 lds
    buffer_load_dwordx4 v1, s[16:19], s42 offen offset:3072 sc1 lds
    s_waitcnt lgkmcnt(0)
    v_add_f32 v140, v140, v141
    v_add_f32 v142, v142, v143
    v_add_f32 v140, v140, v142
    v_min_u32 v140, -2, v140
    buffer_store_dword v140, v8, s[16:19], s46 offen sc1
    s_waitcnt vmcnt(11)
    s_barrier
    ds_read_b128 v[44:47], v2 offset:0
    ds_read_b128 v[48:51], v2 offset:1024
    ds_read_b128 v[52:55], v2 offset:2048
    ds_read_b128 v[56:59], v2 offset:3072
    s_add_u32 s36, s36, 1
L_o_b1:
    s_waitcnt lgkmcnt(2)
    v_mfma_f32_16x16x32_bf16 v[28:31], a[0:3], v[44:47], v[28:31]
    s_add_u32 m0, s43, 147456
    ds_read_b128 v[60:63], v2 offset:4096
    s_add_u32 s42, s41, 49152
    v_mfma_f32_16x16x32_bf16 v[36:39], a[0:3], v[48:51], v[36:39]
    buffer_load_dwordx4 v1, s[16:19], s42 offen offset:0 sc1 lds
    v_mfma_f32_16x16x32_bf16 v[40:43], a[4:7], v[48:51], v[40:43]
    ds_read_b128 v[64:67], v2 offset:5120
    v_mfma_f32_16x16x32_bf16 v[32:35], a[4:7], v[44:47], v[32:35]
    s_waitcnt lgkmcnt(2)
    buffer_load_dwordx4 v1, s[16:19], s42 offen offset:1024 sc1 lds
    v_mfma_f32_16x16x32_bf16 v[28:31], a[8:11], v[52:55], v[28:31]
    ds_read_b128 v[68:71], v2 offset:6144
    v_mfma_f32_16x16x32_bf16 v[36:39], a[8:11], v[56:59], v[36:39]
    buffer_load_dwordx4 v1, s[16:19], s42 offen offset:2048 sc1 lds
    v_mfma_f32_16x16x32_bf16 v[40:43], a[12:15], v[56:59], v[40:43]
    ds_read_b128 v[72:75], v2 offset:7168
    v_mfma_f32_16x16x32_bf16 v[32:35], a[12:15], v[52:55], v[32:35]
    s_waitcnt lgkmcnt(2)
    buffer_load_dwordx4 v1, s[16:19], s42 offen offset:3072 sc1 lds
    v_mfma_f32_16x16x32_bf16 v[28:31], a[16:19], v[60:63], v[28:31]
    s_add_u32 s98, s98, 65536
    ds_read_b128 v[44:47], v2 offset:8192
    s_min_i32 s98, s98, s96
    v_mfma_f32_16x16x32_bf16 v[36:39], a[16:19], v[64:67], v[36:39]
    s_and_b32 s41, s98, 0xffffffff
    s_add_u32 m0, s43, 0
    s_add_u32 s42, s41, 0
    v_mfma_f32_16x16x32_bf16 v[40:43], a[20:23], v[64:67], v[40:43]
    s_add_u32 s47, s36, 1
    ds_read_b128 v[48:51], v2 offset:9216
    s_min_i32 s47, s47, 31
    v_mfma_f32_16x16x32_bf16 v[32:35], a[20:23], v[60:63], v[32:35]
    s_waitcnt lgkmcnt(2)
    s_max_i32 s47, s47, 0
    s_cmp_ge_u32 s47, 16
    v_mfma_f32_16x16x32_bf16 v[28:31], a[24:27], v[68:71], v[28:31]
    s_cselect_b32 s8, s88, s64
    ds_read_b128 v[52:55], v2 offset:10240
    s_cselect_b32 s9, s89, s65
    v_mfma_f32_16x16x32_bf16 v[36:39], a[24:27], v[72:75], v[36:39]
    s_and_b32 s47, s47, 15
    s_lshl_b32 s47, s47, 16
    s_sub_u32 s47, s50, s47
    v_mfma_f32_16x16x32_bf16 v[40:43], a[28:31], v[72:75], v[40:43]
    s_add_u32 s48, s47, 32768
    ds_read_b128 v[56:59], v2 offset:11264
    buffer_load_dwordx4 v[128:131], v3, s[8:11], s48 offen sc1
    v_mfma_f32_16x16x32_bf16 v[32:35], a[28:31], v[68:71], v[32:35]
    s_waitcnt lgkmcnt(2)
    buffer_load_dwordx4 v[132:135], v3, s[8:11], s47 offen sc1
    v_mfma_f32_16x16x32_bf16 v[28:31], a[32:35], v[44:47], v[28:31]
    s_waitcnt vmcnt(11)
    ds_read_b128 v[60:63], v2 offset:12288
    s_barrier
    v_mfma_f32_16x16x32_bf16 v[36:39], a[32:35], v[48:51], v[36:39]
    buffer_store_dword v124, v124, s[16:19], s91 offen sc1
    v_mfma_f32_16x16x32_bf16 v[40:43], a[36:39], v[48:51], v[40:43]
    s_add_u32 s91, s91, 65536
    ds_read_b128 v[64:67], v2 offset:13312
    s_add_u32 s90, s90, 65536
    v_mfma_f32_16x16x32_bf16 v[32:35], a[36:39], v[44:47], v[32:35]
    s_waitcnt lgkmcnt(2)
    s_add_u32 s46, s46, 2048
    s_and_b32 s44, s90, 0xffffffff
    v_mfma_f32_16x16x32_bf16 v[28:31], a[40:43], v[52:55], v[28:31]
    ds_read_b128 v[68:71], v2 offset:14336
    v_mfma_f32_16x16x32_bf16 v[36:39], a[40:43], v[56:59], v[36:39]
    v_mfma_f32_16x16x32_bf16 v[40:43], a[44:47], v[56:59], v[40:43]
    ds_read_b128 v[72:75], v2 offset:15360
    v_mfma_f32_16x16x32_bf16 v[32:35], a[44:47], v[52:55], v[32:35]
    s_waitcnt lgkmcnt(2)
    v_mfma_f32_16x16x32_bf16 v[28:31], a[48:51], v[60:63], v[28:31]
    ds_read_b128 v[44:47], v2 offset:16384
    v_mfma_f32_16x16x32_bf16 v[36:39], a[48:51], v[64:67], v[36:39]
    v_mfma_f32_16x16x32_bf16 v[40:43], a[52:55], v[64:67], v[40:43]
    ds_read_b128 v[48:51], v2 offset:17408
    v_mfma_f32_16x16x32_bf16 v[32:35], a[52:55], v[60:63], v[32:35]
    s_waitcnt lgkmcnt(2)
    v_mfma_f32_16x16x32_bf16 v[28:31], a[56:59], v[68:71], v[28:31]
    ds_read_b128 v[52:55], v2 offset:18432
    v_mfma_f32_16x16x32_bf16 v[36:39], a[56:59], v[72:75], v[36:39]
    v_mfma_f32_16x16x32_bf16 v[40:43], a[60:63], v[72:75], v[40:43]
    ds_read_b128 v[56:59], v2 offset:19456
    v_mfma_f32_16x16x32_bf16 v[32:35], a[60:63], v[68:71], v[32:35]
    s_waitcnt lgkmcnt(2)
    v_mfma_f32_16x16x32_bf16 v[28:31], a[64:67], v[44:47], v[28:31]
    ds_read_b128 v[60:63], v2 offset:20480
    v_mfma_f32_16x16x32_bf16 v[36:39], a[64:67], v[48:51], v[36:39]
    v_mfma_f32_16x16x32_bf16 v[40:43], a[68:71], v[48:51], v[40:43]
    ds_read_b128 v[64:67], v2 offset:21504
    v_mfma_f32_16x16x32_bf16 v[32:35], a[68:71], v[44:47], v[32:35]
    s_waitcnt lgkmcnt(2)
    v_mfma_f32_16x16x32_bf16 v[28:31], a[72:75], v[52:55], v[28:31]
    ds_read_b128 v[68:71], v2 offset:22528
    v_mfma_f32_16x16x32_bf16 v[36:39], a[72:75], v[56:59], v[36:39]
    v_mfma_f32_16x16x32_bf16 v[40:43], a[76:79], v[56:59], v[40:43]
    ds_read_b128 v[72:75], v2 offset:23552
    v_mfma_f32_16x16x32_bf16 v[32:35], a[76:79], v[52:55], v[32:35]
    s_waitcnt lgkmcnt(2)
    v_mfma_f32_16x16x32_bf16 v[28:31], a[80:83], v[60:63], v[28:31]
    ds_read_b128 v[44:47], v2 offset:24576
    v_mfma_f32_16x16x32_bf16 v[36:39], a[80:83], v[64:67], v[36:39]
    v_mfma_f32_16x16x32_bf16 v[40:43], a[84:87], v[64:67], v[40:43]
    ds_read_b128 v[48:51], v2 offset:25600
    v_mfma_f32_16x16x32_bf16 v[32:35], a[84:87], v[60:63], v[32:35]
    s_waitcnt lgkmcnt(2)
    v_mfma_f32_16x16x32_bf16 v[28:31], a[88:91], v[68:71], v[28:31]
    ds_read_b128 v[52:55], v2 offset:26624
    v_mfma_f32_16x16x32_bf16 v[36:39], a[88:91], v[72:75], v[36:39]
    v_mfma_f32_16x16x32_bf16 v[40:43], a[92:95], v[72:75], v[40:43]
    ds_read_b128 v[56:59], v2 offset:27648
    v_mfma_f32_16x16x32_bf16 v[32:35], a[92:95], v[68:71], v[32:35]
    s_waitcnt lgkmcnt(2)
    v_mfma_f32_16x16x32_bf16 v[28:31], a[96:99], v[44:47], v[28:31]
    ds_read_b128 v[60:63], v2 offset:28672
    v_mfma_f32_16x16x32_bf16 v[36:39], a[96:99], v[48:51], v[36:39]
    v_mfma_f32_16x16x32_bf16 v[40:43], a[100:103], v[48:51], v[40:43]
    ds_read_b128 v[64:67], v2 offset:29696
    v_mfma_f32_16x16x32_bf16 v[32:35], a[100:103], v[44:47], v[32:35]
    s_waitcnt lgkmcnt(2)
    v_mfma_f32_16x16x32_bf16 v[28:31], a[104:107], v[52:55], v[28:31]
    ds_read_b128 v[68:71], v2 offset:30720
    v_mfma_f32_16x16x32_bf16 v[36:39], a[104:107], v[56:59], v[36:39]
    v_mfma_f32_16x16x32_bf16 v[40:43], a[108:111], v[56:59], v[40:43]
    ds_read_b128 v[72:75], v2 offset:31744
    v_mfma_f32_16x16x32_bf16 v[32:35], a[108:111], v[52:55], v[32:35]
    s_waitcnt vmcnt(8) lgkmcnt(2)
    s_barrier
    v_mfma_f32_16x16x32_bf16 v[28:31], a[112:115], v[60:63], v[28:31]
    ds_read_b128 v[44:47], v2 offset:32768
    v_mfma_f32_16x16x32_bf16 v[36:39], a[112:115], v[64:67], v[36:39]
    v_mfma_f32_16x16x32_bf16 v[40:43], a[116:119], v[64:67], v[40:43]
    ds_read_b128 v[48:51], v2 offset:33792
    v_mfma_f32_16x16x32_bf16 v[32:35], a[116:119], v[60:63], v[32:35]
    s_waitcnt lgkmcnt(2)
    v_mfma_f32_16x16x32_bf16 v[28:31], a[120:123], v[68:71], v[28:31]
    ds_read_b128 v[52:55], v2 offset:34816
    v_mfma_f32_16x16x32_bf16 v[36:39], a[120:123], v[72:75], v[36:39]
    v_mfma_f32_16x16x32_bf16 v[40:43], a[124:127], v[72:75], v[40:43]
    ds_read_b128 v[56:59], v2 offset:35840
    v_mfma_f32_16x16x32_bf16 v[32:35], a[124:127], v[68:71], v[32:35]
    s_waitcnt lgkmcnt(2)
    v_mfma_f32_16x16x32_bf16 v[28:31], a[128:131], v[44:47], v[28:31]
    ds_read_b128 v[60:63], v2 offset:36864
    v_mfma_f32_16x16x32_bf16 v[36:39], a[128:131], v[48:51], v[36:39]
    v_mfma_f32_16x16x32_bf16 v[40:43], a[132:135], v[48:51], v[40:43]
    ds_read_b128 v[64:67], v2 offset:37888
    v_mfma_f32_16x16x32_bf16 v[32:35], a[132:135], v[44:47], v[32:35]
    s_waitcnt lgkmcnt(2)
    v_mfma_f32_16x16x32_bf16 v[28:31], a[136:139], v[52:55], v[28:31]
    ds_read_b128 v[68:71], v2 offset:38912
    v_mfma_f32_16x16x32_bf16 v[36:39], a[136:139], v[56:59], v[36:39]
    v_mfma_f32_16x16x32_bf16 v[40:43], a[140:143], v[56:59], v[40:43]
    ds_read_b128 v[72:75], v2 offset:39936
    v_mfma_f32_16x16x32_bf16 v[32:35], a[140:143], v[52:55], v[32:35]
    s_waitcnt lgkmcnt(2)
    v_mfma_f32_16x16x32_bf16 v[28:31], a[144:147], v[60:63], v[28:31]
    ds_read_b128 v[44:47], v2 offset:40960
    v_mfma_f32_16x16x32_bf16 v[36:39], a[144:147], v[64:67], v[36:39]
    v_mfma_f32_16x16x32_bf16 v[40:43], a[148:151], v[64:67], v[40:43]
    ds_read_b128 v[48:51], v2 offset:41984
    v_mfma_f32_16x16x32_bf16 v[32:35], a[148:151], v[60:63], v[32:35]
    s_waitcnt lgkmcnt(2)
    v_mfma_f32_16x16x32_bf16 v[28:31], a[152:155], v[68:71], v[28:31]
    ds_read_b128 v[52:55], v2 offset:43008
    v_mfma_f32_16x16x32_bf16 v[36:39], a[152:155], v[72:75], v[36:39]
    v_mfma_f32_16x16x32_bf16 v[40:43], a[156:159], v[72:75], v[40:43]
    ds_read_b128 v[56:59], v2 offset:44032
    v_mfma_f32_16x16x32_bf16 v[32:35], a[156:159], v[68:71], v[32:35]
    s_waitcnt lgkmcnt(2)
    v_mfma_f32_16x16x32_bf16 v[28:31], a[160:163], v[44:47], v[28:31]
    ds_read_b128 v[60:63], v2 offset:45056
    buffer_load_dword v136, v4, s[16:19], s45 offen sc1
    v_mfma_f32_16x16x32_bf16 v[36:39], a[160:163], v[48:51], v[36:39]
    v_mfma_f32_16x16x32_bf16 v[40:43], a[164:167], v[48:51], v[40:43]
    ds_read_b128 v[64:67], v2 offset:46080
    v_mfma_f32_16x16x32_bf16 v[32:35], a[164:167], v[44:47], v[32:35]
    s_waitcnt lgkmcnt(2)
    v_mfma_f32_16x16x32_bf16 v[28:31], a[168:171], v[52:55], v[28:31]
    ds_read_b128 v[68:71], v2 offset:47104
    v_mfma_f32_16x16x32_bf16 v[36:39], a[168:171], v[56:59], v[36:39]
    v_mfma_f32_16x16x32_bf16 v[40:43], a[172:175], v[56:59], v[40:43]
    ds_read_b128 v[72:75], v2 offset:48128
    v_mfma_f32_16x16x32_bf16 v[32:35], a[172:175], v[52:55], v[32:35]
    s_waitcnt vmcnt(4) lgkmcnt(2)
    s_barrier
    v_mfma_f32_16x16x32_bf16 v[28:31], a[176:179], v[60:63], v[28:31]
    ds_read_b128 v[44:47], v2 offset:49152
    v_mfma_f32_16x16x32_bf16 v[36:39], a[176:179], v[64:67], v[36:39]
    v_mfma_f32_16x16x32_bf16 v[40:43], a[180:183], v[64:67], v[40:43]
    ds_read_b128 v[48:51], v2 offset:50176
    v_mfma_f32_16x16x32_bf16 v[32:35], a[180:183], v[60:63], v[32:35]
    s_waitcnt lgkmcnt(2)
    v_mfma_f32_16x16x32_bf16 v[28:31], a[184:187], v[68:71], v[28:31]
    ds_read_b128 v[52:55], v2 offset:51200
    v_mfma_f32_16x16x32_bf16 v[36:39], a[184:187], v[72:75], v[36:39]
    v_mfma_f32_16x16x32_bf16 v[40:43], a[188:191], v[72:75], v[40:43]
    ds_read_b128 v[56:59], v2 offset:52224
    v_mfma_f32_16x16x32_bf16 v[32:35], a[188:191], v[68:71], v[32:35]
    s_waitcnt lgkmcnt(2)
    v_mfma_f32_16x16x32_bf16 v[28:31], a[192:195], v[44:47], v[28:31]
    ds_read_b128 v[60:63], v2 offset:53248
    v_mfma_f32_16x16x32_bf16 v[36:39], a[192:195], v[48:51], v[36:39]
    v_mfma_f32_16x16x32_bf16 v[40:43], a[196:199], v[48:51], v[40:43]
    ds_read_b128 v[64:67], v2 offset:54272
    v_mfma_f32_16x16x32_bf16 v[32:35], a[196:199], v[44:47], v[32:35]
    s_waitcnt lgkmcnt(2)
    v_mfma_f32_16x16x32_bf16 v[28:31], a[200:203], v[52:55], v[28:31]
    s_waitcnt vmcnt(2)
    ds_read_b128 v[68:71], v2 offset:55296
    v_mfma_f32_16x16x32_bf16 v[12:15], v[108:111], v[128:131], 0
    v_mfma_f32_16x16x32_bf16 v[16:19], v[112:115], v[128:131], 0
    v_mfma_f32_16x16x32_bf16 v[20:23], v[108:111], v[132:135], 0
    v_mfma_f32_16x16x32_bf16 v[24:27], v[112:115], v[132:135], 0
    v_mfma_f32_16x16x32_bf16 v[36:39], a[200:203], v[56:59], v[36:39]
    v_mfma_f32_16x16x32_bf16 v[40:43], a[204:207], v[56:59], v[40:43]
    ds_read_b128 v[72:75], v2 offset:56320
    v_mfma_f32_16x16x32_bf16 v[32:35], a[204:207], v[52:55], v[32:35]
    s_waitcnt lgkmcnt(2)
    v_mfma_f32_16x16x32_bf16 v[28:31], a[208:211], v[60:63], v[28:31]
    ds_read_b128 v[44:47], v2 offset:57344
    v_mfma_f32_16x16x32_bf16 v[36:39], a[208:211], v[64:67], v[36:39]
    v_mfma_f32_16x16x32_bf16 v[40:43], a[212:215], v[64:67], v[40:43]
    ds_read_b128 v[48:51], v2 offset:58368
    v_mfma_f32_16x16x32_bf16 v[32:35], a[212:215], v[60:63], v[32:35]
    s_waitcnt lgkmcnt(2)
    v_mfma_f32_16x16x32_bf16 v[28:31], a[216:219], v[68:71], v[28:31]
    ds_read_b128 v[52:55], v2 offset:59392
    v_mfma_f32_16x16x32_bf16 v[36:39], a[216:219], v[72:75], v[36:39]
    v_mfma_f32_16x16x32_bf16 v[40:43], a[220:223], v[72:75], v[40:43]
    ds_read_b128 v[56:59], v2 offset:60416
    v_mfma_f32_16x16x32_bf16 v[32:35], a[220:223], v[68:71], v[32:35]
    s_waitcnt lgkmcnt(2)
    v_mfma_f32_16x16x32_bf16 v[28:31], a[224:227], v[44:47], v[28:31]
    ds_read_b128 v[60:63], v2 offset:61440
    v_mfma_f32_16x16x32_bf16 v[36:39], a[224:227], v[48:51], v[36:39]
    v_mfma_f32_16x16x32_bf16 v[40:43], a[228:231], v[48:51], v[40:43]
    s_waitcnt vmcnt(0)
    ds_read_b128 v[64:67], v2 offset:62464
    v_cmp_ne_u32 vcc, 0, v136
    v_mfma_f32_16x16x32_bf16 v[32:35], a[228:231], v[44:47], v[32:35]
    s_waitcnt lgkmcnt(2)
    v_mfma_f32_16x16x32_bf16 v[28:31], a[232:235], v[52:55], v[28:31]
    s_cbranch_vccnz L_spin28
L_back29:
    ds_read_b128 v[68:71], v2 offset:63488
    s_barrier
    v_mfma_f32_16x16x32_bf16 v[36:39], a[232:235], v[56:59], v[36:39]
    buffer_load_dwordx4 v1, s[16:19], s42 offen offset:0 sc1 lds
    v_mfma_f32_16x16x32_bf16 v[40:43], a[236:239], v[56:59], v[40:43]
    ds_read_b128 v[72:75], v2 offset:64512
    buffer_load_dwordx4 v1, s[16:19], s42 offen offset:1024 sc1 lds
    v_mfma_f32_16x16x32_bf16 v[32:35], a[236:239], v[52:55], v[32:35]
    s_waitcnt lgkmcnt(2)
    buffer_load_dwordx4 v1, s[16:19], s42 offen offset:2048 sc1 lds
    v_mfma_f32_16x16x32_bf16 v[28:31], a[240:243], v[60:63], v[28:31]
    buffer_load_dwordx4 v1, s[16:19], s42 offen offset:3072 sc1 lds
    v_mfma_f32_16x16x32_bf16 v[36:39], a[240:243], v[64:67], v[36:39]
    s_add_u32 m0, s43, 16384
    s_add_u32 s42, s41, 16384
    buffer_load_dwordx4 v1, s[16:19], s42 offen offset:0 sc1 lds
    v_mfma_f32_16x16x32_bf16 v[40:43], a[244:247], v[64:67], v[40:43]
    buffer_load_dwordx4 v1, s[16:19], s42 offen offset:1024 sc1 lds
    v_mfma_f32_16x16x32_bf16 v[32:35], a[244:247], v[60:63], v[32:35]
    s_waitcnt lgkmcnt(0)
    buffer_load_dwordx4 v1, s[16:19], s42 offen offset:2048 sc1 lds
    v_mfma_f32_16x16x32_bf16 v[28:31], a[248:251], v[68:71], v[28:31]
    buffer_load_dwordx4 v1, s[16:19], s42 offen offset:3072 sc1 lds
    v_mfma_f32_16x16x32_bf16 v[36:39], a[248:251], v[72:75], v[36:39]
    s_add_u32 s45, s45, 65536
    v_mfma_f32_16x16x32_bf16 v[40:43], a[252:255], v[72:75], v[40:43]
    v_mfma_f32_16x16x32_bf16 v[32:35], a[252:255], v[68:71], v[32:35]
    v_cvt_pk_bf16_f32 v148, v28, v29
    v_cvt_pk_bf16_f32 v149, v30, v31
    s_nop 5
    v_cvt_pk_bf16_f32 v150, v32, v33
    v_cvt_pk_bf16_f32 v151, v34, v35
    buffer_store_dwordx4 v[148:151], v1, s[16:19], s44 offen offset:0 sc1
    v_cvt_pk_bf16_f32 v152, v36, v37
    v_cvt_pk_bf16_f32 v153, v38, v39
    v_cvt_pk_bf16_f32 v154, v40, v41
    v_cvt_pk_bf16_f32 v155, v42, v43
    buffer_store_dwordx4 v[152:155], v1, s[16:19], s44 offen offset:1024 sc1
    v_add_f32 v140, v28, v29
    v_add_f32 v144, v36, v37
    v_mul_f32 v141, v28, v28
    v_mul_f32 v145, v36, v36
    v_fmac_f32 v141, v29, v29
    v_fmac_f32 v145, v37, v37
    v_add_f32 v140, v140, v30
    v_add_f32 v144, v144, v38
    v_fmac_f32 v141, v30, v30
    v_fmac_f32 v145, v38, v38
    v_add_f32 v140, v140, v31
    v_add_f32 v144, v144, v39
    v_fmac_f32 v141, v31, v31
    v_fmac_f32 v145, v39, v39
    v_add_f32 v140, v140, v32
    v_add_f32 v144, v144, v40
    v_fmac_f32 v141, v32, v32
    v_fmac_f32 v145, v40, v40
    v_add_f32 v140, v140, v33
    v_add_f32 v144, v144, v41
    v_fmac_f32 v141, v33, v33
    v_fmac_f32 v145, v41, v41
    v_add_f32 v140, v140, v34
    v_add_f32 v144, v144, v42
    v_fmac_f32 v141, v34, v34
    v_fmac_f32 v145, v42, v42
    v_add_f32 v140, v140, v35
    v_add_f32 v144, v144, v43
    v_fmac_f32 v141, v35, v35
    v_fmac_f32 v145, v43, v43
    s_nop 0
    v_permlane16_swap_b32 v140, v141
    v_permlane16_swap_b32 v144, v145
    v_add_f32 v140, v140, v141
    v_add_f32 v144, v144, v145
    v_mov_b32 v142, v140
    v_mov_b32 v146, v144
    s_nop 0
    v_permlane32_swap_b32 v140, v142
    v_permlane32_swap_b32 v144, v146
    v_add_f32 v140, v140, v142
    v_add_f32 v144, v144, v146
    ds_write_b32 v6, v140 offset:1024
    ds_write_b32 v6, v144 offset:1536
    s_waitcnt lgkmcnt(0)
    s_barrier
    ds_read_b128 v[140:143], v7 offset:1024
    s_add_u32 m0, s43, 32768
    s_add_u32 s42, s41, 32768
    buffer_load_dwordx4 v1, s[16:19], s42 offen offset:0 sc1 lds
    buffer_load_dwordx4 v1, s[16:19], s42 offen offset:1024 sc1 lds
    buffer_load_dwordx4 v1, s[16:19], s42 offen offset:2048 sc1 lds
    buffer_load_dwordx4 v1, s[16:19], s42 offen offset:3072 sc1 lds
    s_waitcnt lgkmcnt(0)
    v_add_f32 v140, v140, v141
    v_add_f32 v142, v142, v143
    v_add_f32 v140, v140, v142
    v_min_u32 v140, -2, v140
    buffer_store_dword v140, v8, s[16:19], s46 offen sc1
    s_waitcnt vmcnt(11)
    s_barrier
    ds_read_b128 v[44:47], v1 offset:0
    ds_read_b128 v[48:51], v1 offset:1024
    ds_read_b128 v[52:55], v1 offset:2048
    ds_read_b128 v[56:59], v1 offset:3072
    s_add_u32 s36, s36, 1
    s_cmp_lt_u32 s36, 32
    s_cbranch_scc1 L_o_b0
    s_nop 7
    s_waitcnt vmcnt(5)
    s_barrier
    buffer_store_dword v124, v124, s[16:19], s91 offen sc1
    s_add_u32 s91, s91, 65536
    s_waitcnt vmcnt(0)
    s_endpgm
L_spin22:
    s_mov_b32 s40, 0x20000
L_spin22_l:
    buffer_load_dword v12, v124, s[20:23], 0 offen sc1
    s_sub_u32 s40, s40, 1
    s_waitcnt vmcnt(0)
    v_cmp_eq_u32 vcc, v124, v12
    s_cbranch_scc1 L_back23
    s_cbranch_vccz L_back23
    s_sleep 8
    s_branch L_spin22_l
L_spin24:
    s_mov_b32 s40, 0x20000
L_spin24_l:
    buffer_load_dword v136, v4, s[16:19], s45 offen sc1
    s_sub_u32 s40, s40, 1
    s_waitcnt vmcnt(0)
    v_cmp_ne_u32 vcc, 0, v136
    s_cbranch_scc1 L_back25
    s_cbranch_vccz L_back25
    s_sleep 2
    s_branch L_spin24_l
L_spin26:
    s_mov_b32 s40, 0x20000
L_spin26_l:
    buffer_load_dword v136, v4, s[16:19], s45 offen sc1
    s_sub_u32 s40, s40, 1
    s_waitcnt vmcnt(0)
    v_cmp_ne_u32 vcc, 0, v136
    s_cbranch_scc1 L_back27
    s_cbranch_vccz L_back27
    s_sleep 2
    s_branch L_spin26_l
L_spin28:
    s_mov_b32 s40, 0x20000
L_spin28_l:
    buffer_load_dword v136, v4, s[16:19], s45 offen sc1
    s_sub_u32 s40, s40, 1
    s_waitcnt vmcnt(0)
    v_cmp_ne_u32 vcc, 0, v136
    s_cbranch_scc1 L_back29
    s_cbranch_vccz L_back29
    s_sleep 2
    s_branch L_spin28_l
L_role_40:
    s_sub_u32 s35, s34, 40
    s_lshl_b32 s51, s35, 2
    s_add_u32 s51, s51, 96
    s_lshl_b32 s54, s51, 6
    s_mov_b32 s12, s72
    s_mov_b32 s13, s73
    s_mov_b32 s14, 0x700000
    s_mov_b32 s15, 0x00020000
    s_mov_b32 s39, 7168
    v_lshrrev_b32 v64, 3, v0
    v_lshlrev_b32 v65, 2, v0
    v_and_b32 v65, 64, v65
    v_and_b32 v66, 0x70, v1
    v_xor_b32 v65, v65, v66
    v_mad_u32_u24 v56, v64, s39, v65
    v_add_u32 v57, 57344, v56
    v_add_u32 v58, 128, v56
    v_add_u32 v59, 57472, v56
    s_mul_i32 s38, s32, 114688
    s_add_u32 s54, s54, s38
    s_lshl_b32 s42, s32, 11
    s_add_u32 m0, s42, 0
    s_nop 0
    buffer_load_dwordx4 v56, s[12:15], s54 offen lds
    s_add_u32 m0, s42, 1024
    s_nop 0
    buffer_load_dwordx4 v57, s[12:15], s54 offen lds
    s_add_u32 m0, s42, 8192
    s_nop 0
    buffer_load_dwordx4 v58, s[12:15], s54 offen lds
    s_add_u32 m0, s42, 9216
    s_nop 0
    buffer_load_dwordx4 v59, s[12:15], s54 offen lds
    s_add_u32 s54, s54, 458752
    s_add_u32 m0, s42, 16384
    s_nop 0
    buffer_load_dwordx4 v56, s[12:15], s54 offen lds
    s_add_u32 m0, s42, 17408
    s_nop 0
    buffer_load_dwordx4 v57, s[12:15], s54 offen lds
    s_add_u32 m0, s42, 24576
    s_nop 0
    buffer_load_dwordx4 v58, s[12:15], s54 offen lds
    s_add_u32 m0, s42, 25600
    s_nop 0
    buffer_load_dwordx4 v59, s[12:15], s54 offen lds
    s_add_u32 s54, s54, 458752
    s_add_u32 m0, s42, 32768
    s_nop 0
    buffer_load_dwordx4 v56, s[12:15], s54 offen lds
    s_add_u32 m0, s42, 33792
    s_nop 0
    buffer_load_dwordx4 v57, s[12:15], s54 offen lds
    s_add_u32 m0, s42, 40960
    s_nop 0
    buffer_load_dwordx4 v58, s[12:15], s54 offen lds
    s_add_u32 m0, s42, 41984
    s_nop 0
    buffer_load_dwordx4 v59, s[12:15], s54 offen lds
    s_add_u32 s54, s54, 458752
    s_add_u32 m0, s42, 49152
    s_nop 0
    buffer_load_dwordx4 v56, s[12:15], s54 offen lds
    s_add_u32 m0, s42, 50176
    s_nop 0
    buffer_load_dwordx4 v57, s[12:15], s54 offen lds
    s_add_u32 m0, s42, 57344
    s_nop 0
    buffer_load_dwordx4 v58, s[12:15], s54 offen lds
    s_add_u32 m0, s42, 58368
    s_nop 0
    buffer_load_dwordx4 v59, s[12:15], s54 offen lds
    s_add_u32 s54, s54, 458752
    s_add_u32 m0, s42, 65536
    s_nop 0
    buffer_load_dwordx4 v56, s[12:15], s54 offen lds
    s_add_u32 m0, s42, 66560
    s_nop 0
    buffer_load_dwordx4 v57, s[12:15], s54 offen lds
    s_add_u32 m0, s42, 73728
    s_nop 0
    buffer_load_dwordx4 v58, s[12:15], s54 offen lds
    s_add_u32 m0, s42, 74752
    s_nop 0
    buffer_load_dwordx4 v59, s[12:15], s54 offen lds
    s_add_u32 s54, s54, 458752
    v_lshrrev_b32 v64, 4, v0
    v_bfe_u32 v65, v0, 2, 2
    v_lshl_add_u32 v64, v64, 3, v65
    v_lshlrev_b32 v64, 7, v64
    v_lshrrev_b32 v65, 1, v65
    v_lshl_add_u32 v64, v65, 6, v64
    v_and_b32 v65, 3, v0
    v_lshl_add_u32 v64, v65, 4, v64
    s_lshr_b32 s37, s32, 1
    s_lshl_b32 s37, s37, 13
    s_and_b32 s38, s32, 1
    s_lshl_b32 s38, s38, 6
    s_add_u32 s37, s37, s38
    s_add_u32 s37, s37, 0
    v_xor_b32 v60, s37, v64
    s_lshr_b32 s37, s32, 1
    s_lshl_b32 s37, s37, 13
    s_and_b32 s38, s32, 1
    s_lshl_b32 s38, s38, 6
    s_add_u32 s37, s37, s38
    s_add_u32 s37, s37, 8
    v_xor_b32 v61, s37, v64
    v_mov_b32 v64, 0x3f803f80
    v_mov_b32 v65, 0x3f803f80
    v_mov_b32 v66, 0x3f803f80
    v_mov_b32 v67, 0x3f803f80
    v_add_u32 v2, 98304, v1
    s_lshl_b32 s37, s33, 6
    s_add_u32 s37, s37, 16
    s_lshl_b32 s37, s37, 7
    v_lshl_add_u32 v5, v0, 7, s37
    s_cmp_eq_u32 s32, 0
    s_cselect_b32 s37, 8, 0
    v_cmp_le_u32 vcc, s37, v0
    s_nop 1
    v_cndmask_b32 v5, v5, 2.0, vcc
    s_lshl_b32 s43, s32, 12
    s_mul_i32 s41, s33, 2097152
    s_add_u32 s41, s41, 0x800000
    s_add_u32 s41, s41, s43
    s_mul_i32 s90, s33, 8388608
    s_add_u32 s90, s90, 0xfc0000
    s_add_u32 s37, s51, s32
    s_lshl_b32 s37, s37, 11
    s_add_u32 s90, s90, s37
    s_lshl_b32 s37, s32, 10
    s_sub_u32 s87, 8192, s37
    s_lshl_b32 s38, s35, 1
    s_lshr_b32 s39, s32, 1
    s_add_u32 s38, s38, s39
    s_cmp_eq_u32 s38, 36
    s_cselect_b32 s88, 0x5e00000, 0
    s_and_b32 s38, s32, 1
    s_lshl_b32 s38, s38, 3
    s_and_b32 s39, s32, 2
    s_lshl_b32 s39, s39, 10
    s_add_u32 s38, s38, s39
    s_add_u32 s38, s38, 65536
    v_add_u32 v3, s38, v1
    s_add_u32 s37, s37, 65536
    v_add_u32 v4, s37, v1
    v_and_b32 v6, 15, v0
    v_lshlrev_b32 v6, 3, v6
    v_lshrrev_b32 v8, 5, v0
    v_lshl_add_u32 v6, v8, 9, v6
    v_and_b32 v8, 16, v0
    v_lshl_add_u32 v6, v8, 6, v6
    v_add_u32 v118, 73728, v6
    s_mul_i32 s46, s33, 65536
    s_add_u32 s46, s46, 0x5440000
    s_add_u32 s55, s46, 63488
    s_and_b32 s52, s32, 1
    s_lshl_b32 s52, s52, 10
    s_mov_b32 s8, s74
    s_mov_b32 s9, s75
    s_mov_b32 s10, 0x1c00
    s_mov_b32 s11, 0x00020000
    v_and_b32 v8, 0x30, v0
    s_add_u32 s37, s51, s32
    s_lshl_b32 s37, s37, 6
    buffer_load_dwordx4 v[16:19], v8, s[8:11], s37 offen
    s_lshr_b32 s37, s32, 1
    s_add_u32 s37, s37, s51
    s_lshl_b32 s37, s37, 6
    s_and_b32 s38, s32, 1
    s_lshl_b32 s38, s38, 3
    s_add_u32 s37, s37, s38
    buffer_load_dwordx2 v[20:21], v8, s[8:11], s37 offen offset:256
    v_add_u32 v62, 0, v60
    v_add_u32 v63, 0, v61
    s_waitcnt vmcnt(18)
    s_barrier
    ds_read_b64_tr_b16 a[0:1], v62 offset:0
    ds_read_b64_tr_b16 a[2:3], v62 offset:512
    ds_read_b64_tr_b16 a[4:5], v63 offset:0
    ds_read_b64_tr_b16 a[6:7], v63 offset:512
    ds_read_b64_tr_b16 a[8:9], v62 offset:4096
    ds_read_b64_tr_b16 a[10:11], v62 offset:4608
    ds_read_b64_tr_b16 a[12:13], v63 offset:4096
    ds_read_b64_tr_b16 a[14:15], v63 offset:4608
    s_add_u32 m0, s42, 81920
    s_nop 0
    buffer_load_dwordx4 v56, s[12:15], s54 offen lds
    s_add_u32 m0, s42, 82944
    s_nop 0
    buffer_load_dwordx4 v57, s[12:15], s54 offen lds
    s_add_u32 m0, s42, 90112
    s_nop 0
    buffer_load_dwordx4 v58, s[12:15], s54 offen lds
    s_add_u32 m0, s42, 91136
    s_nop 0
    buffer_load_dwordx4 v59, s[12:15], s54 offen lds
    s_add_u32 s54, s54, 458752
    s_waitcnt lgkmcnt(0)
    v_mfma_f32_16x16x32_bf16 v[88:91], a[0:3], v[64:67], 0
    v_mfma_f32_16x16x32_bf16 v[92:95], a[4:7], v[64:67], 0
    v_mfma_f32_16x16x32_bf16 v[88:91], a[8:11], v[64:67], v[88:91]
    v_mfma_f32_16x16x32_bf16 v[92:95], a[12:15], v[64:67], v[92:95]
    v_add_u32 v62, 16384, v60
    v_add_u32 v63, 16384, v61
    s_waitcnt vmcnt(18)
    s_barrier
    ds_read_b64_tr_b16 a[16:17], v62 offset:0
    ds_read_b64_tr_b16 a[18:19], v62 offset:512
    ds_read_b64_tr_b16 a[20:21], v63 offset:0
    ds_read_b64_tr_b16 a[22:23], v63 offset:512
    ds_read_b64_tr_b16 a[24:25], v62 offset:4096
    ds_read_b64_tr_b16 a[26:27], v62 offset:4608
    ds_read_b64_tr_b16 a[28:29], v63 offset:4096
    ds_read_b64_tr_b16 a[30:31], v63 offset:4608
    s_add_u32 m0, s42, 0
    s_nop 0
    buffer_load_dwordx4 v56, s[12:15], s54 offen lds
    s_add_u32 m0, s42, 1024
    s_nop 0
    buffer_load_dwordx4 v57, s[12:15], s54 offen lds
    s_add_u32 m0, s42, 8192
    s_nop 0
    buffer_load_dwordx4 v58, s[12:15], s54 offen lds
    s_add_u32 m0, s42, 9216
    s_nop 0
    buffer_load_dwordx4 v59, s[12:15], s54 offen lds
    s_add_u32 s54, s54, 458752
    s_waitcnt lgkmcnt(0)
    v_mfma_f32_16x16x32_bf16 v[88:91], a[16:19], v[64:67], v[88:91]
    v_mfma_f32_16x16x32_bf16 v[92:95], a[20:23], v[64:67], v[92:95]
    v_mfma_f32_16x16x32_bf16 v[88:91], a[24:27], v[64:67], v[88:91]
    v_mfma_f32_16x16x32_bf16 v[92:95], a[28:31], v[64:67], v[92:95]
    v_add_u32 v62, 32768, v60
    v_add_u32 v63, 32768, v61
    s_waitcnt vmcnt(18)
    s_barrier
    ds_read_b64_tr_b16 a[32:33], v62 offset:0
    ds_read_b64_tr_b16 a[34:35], v62 offset:512
    ds_read_b64_tr_b16 a[36:37], v63 offset:0
    ds_read_b64_tr_b16 a[38:39], v63 offset:512
    ds_read_b64_tr_b16 a[40:41], v62 offset:4096
    ds_read_b64_tr_b16 a[42:43], v62 offset:4608
    ds_read_b64_tr_b16 a[44:45], v63 offset:4096
    ds_read_b64_tr_b16 a[46:47], v63 offset:4608
    s_add_u32 m0, s42, 16384
    s_nop 0
    buffer_load_dwordx4 v56, s[12:15], s54 offen lds
    s_add_u32 m0, s42, 17408
    s_nop 0
    buffer_load_dwordx4 v57, s[12:15], s54 offen lds
    s_add_u32 m0, s42, 24576
    s_nop 0
    buffer_load_dwordx4 v58, s[12:15], s54 offen lds
    s_add_u32 m0, s42, 25600
    s_nop 0
    buffer_load_dwordx4 v59, s[12:15], s54 offen lds
    s_add_u32 s54, s54, 458752
    s_waitcnt lgkmcnt(0)
    v_mfma_f32_16x16x32_bf16 v[88:91], a[32:35], v[64:67], v[88:91]
    v_mfma_f32_16x16x32_bf16 v[92:95], a[36:39], v[64:67], v[92:95]
    v_mfma_f32_16x16x32_bf16 v[88:91], a[40:43], v[64:67], v[88:91]
    v_mfma_f32_16x16x32_bf16 v[92:95], a[44:47], v[64:67], v[92:95]
    v_add_u32 v62, 49152, v60
    v_add_u32 v63, 49152, v61
    s_waitcnt vmcnt(18)
    s_barrier
    ds_read_b64_tr_b16 a[48:49], v62 offset:0
    ds_read_b64_tr_b16 a[50:51], v62 offset:512
    ds_read_b64_tr_b16 a[52:53], v63 offset:0
    ds_read_b64_tr_b16 a[54:55], v63 offset:512
    ds_read_b64_tr_b16 a[56:57], v62 offset:4096
    ds_read_b64_tr_b16 a[58:59], v62 offset:4608
    ds_read_b64_tr_b16 a[60:61], v63 offset:4096
    ds_read_b64_tr_b16 a[62:63], v63 offset:4608
    s_add_u32 m0, s42, 32768
    s_nop 0
    buffer_load_dwordx4 v56, s[12:15], s54 offen lds
    s_add_u32 m0, s42, 33792
    s_nop 0
    buffer_load_dwordx4 v57, s[12:15], s54 offen lds
    s_add_u32 m0, s42, 40960
    s_nop 0
    buffer_load_dwordx4 v58, s[12:15], s54 offen lds
    s_add_u32 m0, s42, 41984
    s_nop 0
    buffer_load_dwordx4 v59, s[12:15], s54 offen lds
    s_add_u32 s54, s54, 458752
    s_waitcnt lgkmcnt(0)
    v_mfma_f32_16x16x32_bf16 v[88:91], a[48:51], v[64:67], v[88:91]
    v_mfma_f32_16x16x32_bf16 v[92:95], a[52:55], v[64:67], v[92:95]
    v_mfma_f32_16x16x32_bf16 v[88:91], a[56:59], v[64:67], v[88:91]
    v_mfma_f32_16x16x32_bf16 v[92:95], a[60:63], v[64:67], v[92:95]
    v_add_u32 v62, 65536, v60
    v_add_u32 v63, 65536, v61
    s_waitcnt vmcnt(18)
    s_barrier
    ds_read_b64_tr_b16 a[64:65], v62 offset:0
    ds_read_b64_tr_b16 a[66:67], v62 offset:512
    ds_read_b64_tr_b16 a[68:69], v63 offset:0
    ds_read_b64_tr_b16 a[70:71], v63 offset:512
    ds_read_b64_tr_b16 a[72:73], v62 offset:4096
    ds_read_b64_tr_b16 a[74:75], v62 offset:4608
    ds_read_b64_tr_b16 a[76:77], v63 offset:4096
    ds_read_b64_tr_b16 a[78:79], v63 offset:4608
    s_add_u32 m0, s42, 49152
    s_nop 0
    buffer_load_dwordx4 v56, s[12:15], s54 offen lds
    s_add_u32 m0, s42, 50176
    s_nop 0
    buffer_load_dwordx4 v57, s[12:15], s54 offen lds
    s_add_u32 m0, s42, 57344
    s_nop 0
    buffer_load_dwordx4 v58, s[12:15], s54 offen lds
    s_add_u32 m0, s42, 58368
    s_nop 0
    buffer_load_dwordx4 v59, s[12:15], s54 offen lds
    s_add_u32 s54, s54, 458752
    s_waitcnt lgkmcnt(0)
    v_mfma_f32_16x16x32_bf16 v[88:91], a[64:67], v[64:67], v[88:91]
    v_mfma_f32_16x16x32_bf16 v[92:95], a[68:71], v[64:67], v[92:95]
    v_mfma_f32_16x16x32_bf16 v[88:91], a[72:75], v[64:67], v[88:91]
    v_mfma_f32_16x16x32_bf16 v[92:95], a[76:79], v[64:67], v[92:95]
    v_add_u32 v62, 81920, v60
    v_add_u32 v63, 81920, v61
    s_waitcnt vmcnt(16)
    s_barrier
    ds_read_b64_tr_b16 a[80:81], v62 offset:0
    ds_read_b64_tr_b16 a[82:83], v62 offset:512
    ds_read_b64_tr_b16 a[84:85], v63 offset:0
    ds_read_b64_tr_b16 a[86:87], v63 offset:512
    ds_read_b64_tr_b16 a[88:89], v62 offset:4096
    ds_read_b64_tr_b16 a[90:91], v62 offset:4608
    ds_read_b64_tr_b16 a[92:93], v63 offset:4096
    ds_read_b64_tr_b16 a[94:95], v63 offset:4608
    s_add_u32 m0, s42, 65536
    s_nop 0
    buffer_load_dwordx4 v56, s[12:15], s54 offen lds
    s_add_u32 m0, s42, 66560
    s_nop 0
    buffer_load_dwordx4 v57, s[12:15], s54 offen lds
    s_add_u32 m0, s42, 73728
    s_nop 0
    buffer_load_dwordx4 v58, s[12:15], s54 offen lds
    s_add_u32 m0, s42, 74752
    s_nop 0
    buffer_load_dwordx4 v59, s[12:15], s54 offen lds
    s_add_u32 s54, s54, 458752
    s_waitcnt lgkmcnt(0)
    v_mfma_f32_16x16x32_bf16 v[88:91], a[80:83], v[64:67], v[88:91]
    v_mfma_f32_16x16x32_bf16 v[92:95], a[84:87], v[64:67], v[92:95]
    v_mfma_f32_16x16x32_bf16 v[88:91], a[88:91], v[64:67], v[88:91]
    v_mfma_f32_16x16x32_bf16 v[92:95], a[92:95], v[64:67], v[92:95]
    v_add_u32 v62, 0, v60
    v_add_u32 v63, 0, v61
    s_waitcnt vmcnt(16)
    s_barrier
    ds_read_b64_tr_b16 a[96:97], v62 offset:0
    ds_read_b64_tr_b16 a[98:99], v62 offset:512
    ds_read_b64_tr_b16 a[100:101], v63 offset:0
    ds_read_b64_tr_b16 a[102:103], v63 offset:512
    ds_read_b64_tr_b16 a[104:105], v62 offset:4096
    ds_read_b64_tr_b16 a[106:107], v62 offset:4608
    ds_read_b64_tr_b16 a[108:109], v63 offset:4096
    ds_read_b64_tr_b16 a[110:111], v63 offset:4608
    s_add_u32 m0, s42, 81920
    s_nop 0
    buffer_load_dwordx4 v56, s[12:15], s54 offen lds
    s_add_u32 m0, s42, 82944
    s_nop 0
    buffer_load_dwordx4 v57, s[12:15], s54 offen lds
    s_add_u32 m0, s42, 90112
    s_nop 0
    buffer_load_dwordx4 v58, s[12:15], s54 offen lds
    s_add_u32 m0, s42, 91136
    s_nop 0
    buffer_load_dwordx4 v59, s[12:15], s54 offen lds
    s_add_u32 s54, s54, 458752
    s_waitcnt lgkmcnt(0)
    v_mfma_f32_16x16x32_bf16 v[88:91], a[96:99], v[64:67], v[88:91]
    v_mfma_f32_16x16x32_bf16 v[92:95], a[100:103], v[64:67], v[92:95]
    v_mfma_f32_16x16x32_bf16 v[88:91], a[104:107], v[64:67], v[88:91]
    v_mfma_f32_16x16x32_bf16 v[92:95], a[108:111], v[64:67], v[92:95]
    v_add_u32 v62, 16384, v60
    v_add_u32 v63, 16384, v61
    s_waitcnt vmcnt(16)
    s_barrier
    ds_read_b64_tr_b16 a[112:113], v62 offset:0
    ds_read_b64_tr_b16 a[114:115], v62 offset:512
    ds_read_b64_tr_b16 a[116:117], v63 offset:0
    ds_read_b64_tr_b16 a[118:119], v63 offset:512
    ds_read_b64_tr_b16 a[120:121], v62 offset:4096
    ds_read_b64_tr_b16 a[122:123], v62 offset:4608
    ds_read_b64_tr_b16 a[124:125], v63 offset:4096
    ds_read_b64_tr_b16 a[126:127], v63 offset:4608
    s_add_u32 m0, s42, 0
    s_nop 0
    buffer_load_dwordx4 v56, s[12:15], s54 offen lds
    s_add_u32 m0, s42, 1024
    s_nop 0
    buffer_load_dwordx4 v57, s[12:15], s54 offen lds
    s_add_u32 m0, s42, 8192
    s_nop 0
    buffer_load_dwordx4 v58, s[12:15], s54 offen lds
    s_add_u32 m0, s42, 9216
    s_nop 0
    buffer_load_dwordx4 v59, s[12:15], s54 offen lds
    s_add_u32 s54, s54, 458752
    s_waitcnt lgkmcnt(0)
    v_mfma_f32_16x16x32_bf16 v[88:91], a[112:115], v[64:67], v[88:91]
    v_mfma_f32_16x16x32_bf16 v[92:95], a[116:119], v[64:67], v[92:95]
    v_mfma_f32_16x16x32_bf16 v[88:91], a[120:123], v[64:67], v[88:91]
    v_mfma_f32_16x16x32_bf16 v[92:95], a[124:127], v[64:67], v[92:95]
    v_add_u32 v62, 32768, v60
    v_add_u32 v63, 32768, v61
    s_waitcnt vmcnt(16)
    s_barrier
    ds_read_b64_tr_b16 a[128:129], v62 offset:0
    ds_read_b64_tr_b16 a[130:131], v62 offset:512
    ds_read_b64_tr_b16 a[132:133], v63 offset:0
    ds_read_b64_tr_b16 a[134:135], v63 offset:512
    ds_read_b64_tr_b16 a[136:137], v62 offset:4096
    ds_read_b64_tr_b16 a[138:139], v62 offset:4608
    ds_read_b64_tr_b16 a[140:141], v63 offset:4096
    ds_read_b64_tr_b16 a[142:143], v63 offset:4608
    s_add_u32 m0, s42, 16384
    s_nop 0
    buffer_load_dwordx4 v56, s[12:15], s54 offen lds
    s_add_u32 m0, s42, 17408
    s_nop 0
    buffer_load_dwordx4 v57, s[12:15], s54 offen lds
    s_add_u32 m0, s42, 24576
    s_nop 0
    buffer_load_dwordx4 v58, s[12:15], s54 offen lds
    s_add_u32 m0, s42, 25600
    s_nop 0
    buffer_load_dwordx4 v59, s[12:15], s54 offen lds
    s_add_u32 s54, s54, 458752
    s_waitcnt lgkmcnt(0)
    v_mfma_f32_16x16x32_bf16 v[88:91], a[128:131], v[64:67], v[88:91]
    v_mfma_f32_16x16x32_bf16 v[92:95], a[132:135], v[64:67], v[92:95]
    v_mfma_f32_16x16x32_bf16 v[88:91], a[136:139], v[64:67], v[88:91]
    v_mfma_f32_16x16x32_bf16 v[92:95], a[140:143], v[64:67], v[92:95]
    v_add_u32 v62, 49152, v60
    v_add_u32 v63, 49152, v61
    s_waitcnt vmcnt(16)
    s_barrier
    ds_read_b64_tr_b16 a[144:145], v62 offset:0
    ds_read_b64_tr_b16 a[146:147], v62 offset:512
    ds_read_b64_tr_b16 a[148:149], v63 offset:0
    ds_read_b64_tr_b16 a[150:151], v63 offset:512
    ds_read_b64_tr_b16 a[152:153], v62 offset:4096
    ds_read_b64_tr_b16 a[154:155], v62 offset:4608
    ds_read_b64_tr_b16 a[156:157], v63 offset:4096
    ds_read_b64_tr_b16 a[158:159], v63 offset:4608
    s_add_u32 m0, s42, 32768
    s_nop 0
    buffer_load_dwordx4 v56, s[12:15], s54 offen lds
    s_add_u32 m0, s42, 33792
    s_nop 0
    buffer_load_dwordx4 v57, s[12:15], s54 offen lds
    s_add_u32 m0, s42, 40960
    s_nop 0
    buffer_load_dwordx4 v58, s[12:15], s54 offen lds
    s_add_u32 m0, s42, 41984
    s_nop 0
    buffer_load_dwordx4 v59, s[12:15], s54 offen lds
    s_add_u32 s54, s54, 458752
    s_waitcnt lgkmcnt(0)
    v_mfma_f32_16x16x32_bf16 v[88:91], a[144:147], v[64:67], v[88:91]
    v_mfma_f32_16x16x32_bf16 v[92:95], a[148:151], v[64:67], v[92:95]
    v_mfma_f32_16x16x32_bf16 v[88:91], a[152:155], v[64:67], v[88:91]
    v_mfma_f32_16x16x32_bf16 v[92:95], a[156:159], v[64:67], v[92:95]
    v_add_u32 v62, 65536, v60
    v_add_u32 v63, 65536, v61
    s_waitcnt vmcnt(16)
    s_barrier
    ds_read_b64_tr_b16 a[160:161], v62 offset:0
    ds_read_b64_tr_b16 a[162:163], v62 offset:512
    ds_read_b64_tr_b16 a[164:165], v63 offset:0
    ds_read_b64_tr_b16 a[166:167], v63 offset:512
    ds_read_b64_tr_b16 a[168:169], v62 offset:4096
    ds_read_b64_tr_b16 a[170:171], v62 offset:4608
    ds_read_b64_tr_b16 a[172:173], v63 offset:4096
    ds_read_b64_tr_b16 a[174:175], v63 offset:4608
    s_add_u32 m0, s42, 49152
    s_nop 0
    buffer_load_dwordx4 v56, s[12:15], s54 offen lds
    s_add_u32 m0, s42, 50176
    s_nop 0
    buffer_load_dwordx4 v57, s[12:15], s54 offen lds
    s_add_u32 m0, s42, 57344
    s_nop 0
    buffer_load_dwordx4 v58, s[12:15], s54 offen lds
    s_add_u32 m0, s42, 58368
    s_nop 0
    buffer_load_dwordx4 v59, s[12:15], s54 offen lds
    s_add_u32 s54, s54, 458752
    s_waitcnt lgkmcnt(0)
    v_mfma_f32_16x16x32_bf16 v[88:91], a[160:163], v[64:67], v[88:91]
    v_mfma_f32_16x16x32_bf16 v[92:95], a[164:167], v[64:67], v[92:95]
    v_mfma_f32_16x16x32_bf16 v[88:91], a[168:171], v[64:67], v[88:91]
    v_mfma_f32_16x16x32_bf16 v[92:95], a[172:175], v[64:67], v[92:95]
    v_add_u32 v62, 81920, v60
    v_add_u32 v63, 81920, v61
    s_waitcnt vmcnt(16)
    s_barrier
    ds_read_b64_tr_b16 a[176:177], v62 offset:0
    ds_read_b64_tr_b16 a[178:179], v62 offset:512
    ds_read_b64_tr_b16 a[180:181], v63 offset:0
    ds_read_b64_tr_b16 a[182:183], v63 offset:512
    ds_read_b64_tr_b16 a[184:185], v62 offset:4096
    ds_read_b64_tr_b16 a[186:187], v62 offset:4608
    ds_read_b64_tr_b16 a[188:189], v63 offset:4096
    ds_read_b64_tr_b16 a[190:191], v63 offset:4608
    s_waitcnt lgkmcnt(0)
    v_mfma_f32_16x16x32_bf16 v[88:91], a[176:179], v[64:67], v[88:91]
    v_mfma_f32_16x16x32_bf16 v[92:95], a[180:183], v[64:67], v[92:95]
    v_mfma_f32_16x16x32_bf16 v[88:91], a[184:187], v[64:67], v[88:91]
    v_mfma_f32_16x16x32_bf16 v[92:95], a[188:191], v[64:67], v[92:95]
    v_add_u32 v62, 0, v60
    v_add_u32 v63, 0, v61
    s_waitcnt vmcnt(12)
    s_barrier
    ds_read_b64_tr_b16 a[192:193], v62 offset:0
    ds_read_b64_tr_b16 a[194:195], v62 offset:512
    ds_read_b64_tr_b16 a[196:197], v63 offset:0
    ds_read_b64_tr_b16 a[198:199], v63 offset:512
    ds_read_b64_tr_b16 a[200:201], v62 offset:4096
    ds_read_b64_tr_b16 a[202:203], v62 offset:4608
    ds_read_b64_tr_b16 a[204:205], v63 offset:4096
    ds_read_b64_tr_b16 a[206:207], v63 offset:4608
    s_waitcnt lgkmcnt(0)
    v_mfma_f32_16x16x32_bf16 v[88:91], a[192:195], v[64:67], v[88:91]
    v_mfma_f32_16x16x32_bf16 v[92:95], a[196:199], v[64:67], v[92:95]
    v_mfma_f32_16x16x32_bf16 v[88:91], a[200:203], v[64:67], v[88:91]
    v_mfma_f32_16x16x32_bf16 v[92:95], a[204:207], v[64:67], v[92:95]
    v_add_u32 v62, 16384, v60
    v_add_u32 v63, 16384, v61
    s_waitcnt vmcnt(8)
    s_barrier
    ds_read_b64_tr_b16 a[208:209], v62 offset:0
    ds_read_b64_tr_b16 a[210:211], v62 offset:512
    ds_read_b64_tr_b16 a[212:213], v63 offset:0
    ds_read_b64_tr_b16 a[214:215], v63 offset:512
    ds_read_b64_tr_b16 a[216:217], v62 offset:4096
    ds_read_b64_tr_b16 a[218:219], v62 offset:4608
    ds_read_b64_tr_b16 a[220:221], v63 offset:4096
    ds_read_b64_tr_b16 a[222:223], v63 offset:4608
    s_waitcnt lgkmcnt(0)
    v_mfma_f32_16x16x32_bf16 v[88:91], a[208:211], v[64:67], v[88:91]
    v_mfma_f32_16x16x32_bf16 v[92:95], a[212:215], v[64:67], v[92:95]
    v_mfma_f32_16x16x32_bf16 v[88:91], a[216:219], v[64:67], v[88:91]
    v_mfma_f32_16x16x32_bf16 v[92:95], a[220:223], v[64:67], v[92:95]
    v_add_u32 v62, 32768, v60
    v_add_u32 v63, 32768, v61
    s_waitcnt vmcnt(4)
    s_barrier
    ds_read_b64_tr_b16 a[224:225], v62 offset:0
    ds_read_b64_tr_b16 a[226:227], v62 offset:512
    ds_read_b64_tr_b16 a[228:229], v63 offset:0
    ds_read_b64_tr_b16 a[230:231], v63 offset:512
    ds_read_b64_tr_b16 a[232:233], v62 offset:4096
    ds_read_b64_tr_b16 a[234:235], v62 offset:4608
    ds_read_b64_tr_b16 a[236:237], v63 offset:4096
    ds_read_b64_tr_b16 a[238:239], v63 offset:4608
    s_waitcnt lgkmcnt(0)
    v_mfma_f32_16x16x32_bf16 v[88:91], a[224:227], v[64:67], v[88:91]
    v_mfma_f32_16x16x32_bf16 v[92:95], a[228:231], v[64:67], v[92:95]
    v_mfma_f32_16x16x32_bf16 v[88:91], a[232:235], v[64:67], v[88:91]
    v_mfma_f32_16x16x32_bf16 v[92:95], a[236:239], v[64:67], v[92:95]
    v_add_u32 v62, 49152, v60
    v_add_u32 v63, 49152, v61
    s_waitcnt vmcnt(0)
    s_barrier
    ds_read_b64_tr_b16 a[240:241], v62 offset:0
    ds_read_b64_tr_b16 a[242:243], v62 offset:512
    ds_read_b64_tr_b16 a[244:245], v63 offset:0
    ds_read_b64_tr_b16 a[246:247], v63 offset:512
    ds_read_b64_tr_b16 a[248:249], v62 offset:4096
    ds_read_b64_tr_b16 a[250:251], v62 offset:4608
    ds_read_b64_tr_b16 a[252:253], v63 offset:4096
    ds_read_b64_tr_b16 a[254:255], v63 offset:4608
    s_waitcnt lgkmcnt(0)
    v_mfma_f32_16x16x32_bf16 v[88:91], a[240:243], v[64:67], v[88:91]
    v_mfma_f32_16x16x32_bf16 v[92:95], a[244:247], v[64:67], v[92:95]
    v_mfma_f32_16x16x32_bf16 v[88:91], a[248:251], v[64:67], v[88:91]
    v_mfma_f32_16x16x32_bf16 v[92:95], a[252:255], v[64:67], v[92:95]
    s_barrier
    s_mov_b32 s37, 0xffff0000
    v_lshlrev_b32 v100, 16, v16
    v_and_b32 v101, s37, v16
    v_lshlrev_b32 v102, 16, v17
    v_and_b32 v103, s37, v17
    v_lshlrev_b32 v104, 16, v18
    v_and_b32 v105, s37, v18
    v_lshlrev_b32 v106, 16, v19
    v_and_b32 v107, s37, v19
    v_lshlrev_b32 v108, 16, v20
    v_and_b32 v109, s37, v20
    v_lshlrev_b32 v110, 16, v21
    v_and_b32 v111, s37, v21
    s_cmp_lg_u32 s32, 0
    s_cbranch_scc1 L_arv30
    s_add_u32 s20, s82, 0x80
    s_addc_u32 s21, s83, 0
    s_mov_b32 s22, 0x4
    s_mov_b32 s23, 0x00020000
    buffer_load_dword v56, v124, s[20:23], 0 offen sc1
    s_waitcnt vmcnt(0)
    v_cmp_eq_u32 vcc, v124, v56
    s_cbranch_vccnz L_spin31
L_back32:
L_arv30:
    s_add_u32 s96, s41, 2031616
    s_mov_b32 s98, s41
    s_mov_b32 s45, 0x5530000
    buffer_load_dword v7, v5, s[16:19], s45 offen sc1
    s_waitcnt vmcnt(0)
    v_cmp_ne_u32 vcc, 0, v7
    s_cbranch_vccnz L_spin33
L_back34:
    s_barrier
    s_add_u32 m0, s43, 0
    s_add_u32 s42, s41, 0
    buffer_load_dwordx4 v1, s[16:19], s42 offen offset:0 sc1 lds
    buffer_load_dwordx4 v1, s[16:19], s42 offen offset:1024 sc1 lds
    buffer_load_dwordx4 v1, s[16:19], s42 offen offset:2048 sc1 lds
    buffer_load_dwordx4 v1, s[16:19], s42 offen offset:3072 sc1 lds
    s_add_u32 m0, s43, 16384
    s_add_u32 s42, s41, 16384
    buffer_load_dwordx4 v1, s[16:19], s42 offen offset:0 sc1 lds
    buffer_load_dwordx4 v1, s[16:19], s42 offen offset:1024 sc1 lds
    buffer_load_dwordx4 v1, s[16:19], s42 offen offset:2048 sc1 lds
    buffer_load_dwordx4 v1, s[16:19], s42 offen offset:3072 sc1 lds
    s_add_u32 s45, s45, 65536
    s_waitcnt vmcnt(0) lgkmcnt(0)
    s_barrier
    ds_read_b128 v[56:59], v1 offset:0
    ds_read_b128 v[60:63], v1 offset:1024
    ds_read_b128 v[64:67], v1 offset:2048
    ds_read_b128 v[68:71], v1 offset:3072
    s_mov_b32 s36, 0
    s_waitcnt lgkmcnt(0)
    s_nop 7
L_l_b0:
    s_waitcnt lgkmcnt(2)
    v_mfma_f32_16x16x32_bf16 v[8:11], a[0:3], v[56:59], 0
    s_add_u32 m0, s52, 73728
    ds_read_b128 v[72:75], v1 offset:4096
    s_add_u32 s42, s46, s52
    v_mfma_f32_16x16x32_bf16 v[16:19], a[0:3], v[60:63], 0
    buffer_load_dwordx4 v1, s[16:19], s42 offen sc1 lds
    v_mfma_f32_16x16x32_bf16 v[20:23], a[4:7], v[60:63], 0
    s_add_u32 m0, s43, 32768
    ds_read_b128 v[76:79], v1 offset:5120
    s_add_u32 s42, s41, 32768
    v_mfma_f32_16x16x32_bf16 v[12:15], a[4:7], v[56:59], 0
    s_waitcnt lgkmcnt(2)
    buffer_load_dwordx4 v1, s[16:19], s42 offen offset:0 sc1 lds
    v_mfma_f32_16x16x32_bf16 v[8:11], a[8:11], v[64:67], v[8:11]
    s_and_b32 s44, s90, 0xffffffff
    ds_read_b128 v[80:83], v1 offset:6144
    s_cmp_lt_i32 s36, 1
    v_mfma_f32_16x16x32_bf16 v[16:19], a[8:11], v[68:71], v[16:19]
    buffer_load_dwordx4 v1, s[16:19], s42 offen offset:1024 sc1 lds
    v_mfma_f32_16x16x32_bf16 v[20:23], a[12:15], v[68:71], v[20:23]
    s_cselect_b32 s44, 0x5e00000, s44
    ds_read_b128 v[84:87], v1 offset:7168
    s_add_u32 s90, s90, 262144
    v_mfma_f32_16x16x32_bf16 v[12:15], a[12:15], v[64:67], v[12:15]
    s_waitcnt lgkmcnt(2)
    buffer_load_dwordx4 v1, s[16:19], s42 offen offset:2048 sc1 lds
    v_mfma_f32_16x16x32_bf16 v[8:11], a[16:19], v[72:75], v[8:11]
    ds_read_b128 v[56:59], v1 offset:8192
    v_add_f32 v32, v32, v128
    v_mfma_f32_16x16x32_bf16 v[16:19], a[16:19], v[76:79], v[16:19]
    buffer_load_dwordx4 v1, s[16:19], s42 offen offset:3072 sc1 lds
    v_mfma_f32_16x16x32_bf16 v[20:23], a[20:23], v[76:79], v[20:23]
    s_add_u32 m0, s43, 49152
    ds_read_b128 v[60:63], v1 offset:9216
    v_add_f32 v33, v33, v129
    v_mfma_f32_16x16x32_bf16 v[12:15], a[20:23], v[72:75], v[12:15]
    s_waitcnt lgkmcnt(2)
    v_mul_f32 v120, v32, v116
    v_mul_f32 v121, v33, v116
    v_mfma_f32_16x16x32_bf16 v[8:11], a[24:27], v[80:83], v[8:11]
    s_add_u32 s42, s41, 49152
    ds_read_b128 v[64:67], v1 offset:10240
    buffer_load_dwordx4 v1, s[16:19], s42 offen offset:0 sc1 lds
    v_mfma_f32_16x16x32_bf16 v[16:19], a[24:27], v[84:87], v[16:19]
    v_mul_f32 v120, v120, abs(v32)
    v_mul_f32 v121, v121, abs(v33)
    v_mfma_f32_16x16x32_bf16 v[20:23], a[28:31], v[84:87], v[20:23]
    ds_read_b128 v[68:71], v1 offset:11264
    buffer_load_dwordx4 v1, s[16:19], s42 offen offset:1024 sc1 lds
    v_mfma_f32_16x16x32_bf16 v[12:15], a[28:31], v[80:83], v[12:15]
    s_waitcnt lgkmcnt(2)
    v_cvt_pk_bf16_f32 v32, v120, v121
    v_pk_max_i16 v32, v32, 0
    v_mfma_f32_16x16x32_bf16 v[8:11], a[32:35], v[56:59], v[8:11]
    ds_read_b128 v[72:75], v1 offset:12288
    buffer_load_dwordx4 v1, s[16:19], s42 offen offset:2048 sc1 lds
    v_mfma_f32_16x16x32_bf16 v[16:19], a[32:35], v[60:63], v[16:19]
    v_add_f32 v34, v34, v130
    v_add_f32 v35, v35, v131
    v_mfma_f32_16x16x32_bf16 v[20:23], a[36:39], v[60:63], v[20:23]
    ds_read_b128 v[76:79], v1 offset:13312
    buffer_load_dwordx4 v1, s[16:19], s42 offen offset:3072 sc1 lds
    v_mfma_f32_16x16x32_bf16 v[12:15], a[36:39], v[56:59], v[12:15]
    s_waitcnt lgkmcnt(2)
    v_mul_f32 v120, v34, v116
    v_mul_f32 v121, v35, v116
    v_mfma_f32_16x16x32_bf16 v[8:11], a[40:43], v[64:67], v[8:11]
    s_add_u32 s98, s98, 65536
    ds_read_b128 v[80:83], v1 offset:14336
    v_mul_f32 v120, v120, abs(v34)
    v_mfma_f32_16x16x32_bf16 v[16:19], a[40:43], v[68:71], v[16:19]
    s_min_i32 s98, s98, s96
    v_mul_f32 v121, v121, abs(v35)
    v_cvt_pk_bf16_f32 v33, v120, v121
    v_mfma_f32_16x16x32_bf16 v[20:23], a[44:47], v[68:71], v[20:23]
    s_and_b32 s41, s98, 0xffffffff
    ds_read_b128 v[84:87], v1 offset:15360
    v_pk_max_i16 v33, v33, 0
    v_mfma_f32_16x16x32_bf16 v[12:15], a[44:47], v[64:67], v[12:15]
    s_waitcnt vmcnt(9) lgkmcnt(2)
    s_barrier
    v_add_f32 v36, v36, v132
    v_mfma_f32_16x16x32_bf16 v[8:11], a[48:51], v[72:75], v[8:11]
    ds_read_b128 v[56:59], v1 offset:16384
    v_add_f32 v37, v37, v133
    v_mfma_f32_16x16x32_bf16 v[16:19], a[48:51], v[76:79], v[16:19]
    v_mul_f32 v120, v36, v116
    v_mul_f32 v121, v37, v116
    v_mfma_f32_16x16x32_bf16 v[20:23], a[52:55], v[76:79], v[20:23]
    ds_read_b128 v[60:63], v1 offset:17408
    v_mul_f32 v120, v120, abs(v36)
    v_mfma_f32_16x16x32_bf16 v[12:15], a[52:55], v[72:75], v[12:15]
    s_waitcnt lgkmcnt(2)
    v_mul_f32 v121, v121, abs(v37)
    v_cvt_pk_bf16_f32 v34, v120, v121
    v_mfma_f32_16x16x32_bf16 v[8:11], a[56:59], v[80:83], v[8:11]
    ds_read_b128 v[64:67], v1 offset:18432
    v_pk_max_i16 v34, v34, 0
    v_mfma_f32_16x16x32_bf16 v[16:19], a[56:59], v[84:87], v[16:19]
    v_add_f32 v38, v38, v134
    v_add_f32 v39, v39, v135
    v_mfma_f32_16x16x32_bf16 v[20:23], a[60:63], v[84:87], v[20:23]
    ds_read_b128 v[68:71], v1 offset:19456
    v_mul_f32 v120, v38, v116
    v_mfma_f32_16x16x32_bf16 v[12:15], a[60:63], v[80:83], v[12:15]
    s_waitcnt lgkmcnt(2)
    v_mul_f32 v121, v39, v116
    v_mul_f32 v120, v120, abs(v38)
    v_mfma_f32_16x16x32_bf16 v[8:11], a[64:67], v[56:59], v[8:11]
    ds_read_b128 v[72:75], v1 offset:20480
    v_mul_f32 v121, v121, abs(v39)
    v_mfma_f32_16x16x32_bf16 v[16:19], a[64:67], v[60:63], v[16:19]
    v_cvt_pk_bf16_f32 v35, v120, v121
    v_pk_max_i16 v35, v35, 0
    v_mfma_f32_16x16x32_bf16 v[20:23], a[68:71], v[60:63], v[20:23]
    ds_read_b128 v[76:79], v1 offset:21504
    buffer_store_dwordx4 v[32:35], v1, s[16:19], s44 offen offset:0 sc1
    v_mfma_f32_16x16x32_bf16 v[12:15], a[68:71], v[56:59], v[12:15]
    s_waitcnt lgkmcnt(2)
    v_add_f32 v40, v40, v136
    v_add_f32 v41, v41, v137
    v_mfma_f32_16x16x32_bf16 v[8:11], a[72:75], v[64:67], v[8:11]
    ds_read_b128 v[80:83], v1 offset:22528
    v_mul_f32 v120, v40, v117
    v_mfma_f32_16x16x32_bf16 v[16:19], a[72:75], v[68:71], v[16:19]
    v_mul_f32 v121, v41, v117
    v_mul_f32 v120, v120, abs(v40)
    v_mfma_f32_16x16x32_bf16 v[20:23], a[76:79], v[68:71], v[20:23]
    ds_read_b128 v[84:87], v1 offset:23552
    v_mul_f32 v121, v121, abs(v41)
    v_mfma_f32_16x16x32_bf16 v[12:15], a[76:79], v[64:67], v[12:15]
    s_waitcnt lgkmcnt(2)
    v_cvt_pk_bf16_f32 v40, v120, v121
    v_pk_max_i16 v40, v40, 0
    v_mfma_f32_16x16x32_bf16 v[8:11], a[80:83], v[72:75], v[8:11]
    ds_read_b128 v[56:59], v1 offset:24576
    v_add_f32 v42, v42, v138
    v_mfma_f32_16x16x32_bf16 v[16:19], a[80:83], v[76:79], v[16:19]
    v_add_f32 v43, v43, v139
    v_mul_f32 v120, v42, v117
    v_mfma_f32_16x16x32_bf16 v[20:23], a[84:87], v[76:79], v[20:23]
    ds_read_b128 v[60:63], v1 offset:25600
    v_mul_f32 v121, v43, v117
    v_mfma_f32_16x16x32_bf16 v[12:15], a[84:87], v[72:75], v[12:15]
    s_waitcnt lgkmcnt(2)
    v_mul_f32 v120, v120, abs(v42)
    v_mul_f32 v121, v121, abs(v43)
    v_mfma_f32_16x16x32_bf16 v[8:11], a[88:91], v[80:83], v[8:11]
    ds_read_b128 v[64:67], v1 offset:26624
    v_cvt_pk_bf16_f32 v41, v120, v121
    v_mfma_f32_16x16x32_bf16 v[16:19], a[88:91], v[84:87], v[16:19]
    v_pk_max_i16 v41, v41, 0
    v_add_f32 v44, v44, v140
    v_mfma_f32_16x16x32_bf16 v[20:23], a[92:95], v[84:87], v[20:23]
    ds_read_b128 v[68:71], v1 offset:27648
    v_add_f32 v45, v45, v141
    v_mfma_f32_16x16x32_bf16 v[12:15], a[92:95], v[80:83], v[12:15]
    s_waitcnt lgkmcnt(2)
    v_mul_f32 v120, v44, v117
    v_mul_f32 v121, v45, v117
    v_mfma_f32_16x16x32_bf16 v[8:11], a[96:99], v[56:59], v[8:11]
    ds_read_b128 v[72:75], v1 offset:28672
    v_mul_f32 v120, v120, abs(v44)
    v_mfma_f32_16x16x32_bf16 v[16:19], a[96:99], v[60:63], v[16:19]
    v_mul_f32 v121, v121, abs(v45)
    v_cvt_pk_bf16_f32 v42, v120, v121
    v_mfma_f32_16x16x32_bf16 v[20:23], a[100:103], v[60:63], v[20:23]
    ds_read_b128 v[76:79], v1 offset:29696
    buffer_load_dword v7, v5, s[16:19], s45 offen sc1
    v_mfma_f32_16x16x32_bf16 v[12:15], a[100:103], v[56:59], v[12:15]
    s_waitcnt lgkmcnt(2)
    v_pk_max_i16 v42, v42, 0
    v_add_f32 v46, v46, v142
    v_mfma_f32_16x16x32_bf16 v[8:11], a[104:107], v[64:67], v[8:11]
    ds_read_b128 v[80:83], v1 offset:30720
    v_add_f32 v47, v47, v143
    v_mfma_f32_16x16x32_bf16 v[16:19], a[104:107], v[68:71], v[16:19]
    v_mul_f32 v120, v46, v117
    v_mul_f32 v121, v47, v117
    v_mfma_f32_16x16x32_bf16 v[20:23], a[108:111], v[68:71], v[20:23]
    ds_read_b128 v[84:87], v1 offset:31744
    v_mul_f32 v120, v120, abs(v46)
    v_mfma_f32_16x16x32_bf16 v[12:15], a[108:111], v[64:67], v[12:15]
    s_waitcnt vmcnt(6) lgkmcnt(2)
    s_barrier
    v_mul_f32 v121, v121, abs(v47)
    v_mfma_f32_16x16x32_bf16 v[8:11], a[112:115], v[72:75], v[8:11]
    ds_read_b128 v[56:59], v1 offset:32768
    v_cvt_pk_bf16_f32 v43, v120, v121
    v_mfma_f32_16x16x32_bf16 v[16:19], a[112:115], v[76:79], v[16:19]
    v_pk_max_i16 v43, v43, 0
    buffer_store_dwordx4 v[40:43], v1, s[16:19], s44 offen offset:1024 sc1
    v_mfma_f32_16x16x32_bf16 v[20:23], a[116:119], v[76:79], v[20:23]
    s_add_u32 m0, s43, 98304
    ds_read_b128 v[60:63], v1 offset:33792
    ds_read_b64 v[144:145], v118 offset:0
    v_mfma_f32_16x16x32_bf16 v[12:15], a[116:119], v[72:75], v[12:15]
    s_waitcnt lgkmcnt(3)
    ds_read_b64 v[146:147], v118 offset:128
    ds_read_b64 v[148:149], v118 offset:256
    v_mfma_f32_16x16x32_bf16 v[8:11], a[120:123], v[80:83], v[8:11]
    s_add_u32 s42, s41, 0
    ds_read_b128 v[64:67], v1 offset:34816
    ds_read_b64 v[150:151], v118 offset:384
    v_mfma_f32_16x16x32_bf16 v[16:19], a[120:123], v[84:87], v[16:19]
    v_mfma_f32_16x16x32_bf16 v[20:23], a[124:127], v[84:87], v[20:23]
    ds_read_b128 v[68:71], v1 offset:35840
    v_mfma_f32_16x16x32_bf16 v[12:15], a[124:127], v[80:83], v[12:15]
    s_waitcnt lgkmcnt(6)
    v_mfma_f32_16x16x32_bf16 v[8:11], a[128:131], v[56:59], v[8:11]
    ds_read_b128 v[72:75], v1 offset:36864
    v_mfma_f32_16x16x32_bf16 v[16:19], a[128:131], v[60:63], v[16:19]
    s_waitcnt lgkmcnt(2)
    v_max3_u32 v152, v144, v145, v146
    v_max3_u32 v153, v147, v148, v149
    v_mfma_f32_16x16x32_bf16 v[20:23], a[132:135], v[60:63], v[20:23]
    ds_read_b128 v[76:79], v1 offset:37888
    v_max3_u32 v152, v152, v150, v151
    v_mfma_f32_16x16x32_bf16 v[12:15], a[132:135], v[56:59], v[12:15]
    s_waitcnt lgkmcnt(2)
    v_max_u32 v152, v152, v153
    v_cmp_eq_u32 vcc, -1, v152
    v_mfma_f32_16x16x32_bf16 v[8:11], a[136:139], v[64:67], v[8:11]
    ds_read_b128 v[80:83], v1 offset:38912
    v_mfma_f32_16x16x32_bf16 v[16:19], a[136:139], v[68:71], v[16:19]
    s_cbranch_vccnz L_sspin37
L_sback38:
    v_add_f32 v152, v148, v150
    v_add_f32 v153, v149, v151
    v_mfma_f32_16x16x32_bf16 v[20:23], a[140:143], v[68:71], v[20:23]
    ds_read_b128 v[84:87], v1 offset:39936
    v_add_f32 v144, v144, v146
    v_mfma_f32_16x16x32_bf16 v[12:15], a[140:143], v[64:67], v[12:15]
    s_waitcnt lgkmcnt(2)
    v_add_f32 v145, v145, v147
    v_add_f32 v144, v144, v152
    v_mfma_f32_16x16x32_bf16 v[8:11], a[144:147], v[72:75], v[8:11]
    ds_read_b128 v[56:59], v1 offset:40960
    v_add_f32 v145, v145, v153
    v_mfma_f32_16x16x32_bf16 v[16:19], a[144:147], v[76:79], v[16:19]
    v_mov_b32 v152, v144
    v_mov_b32 v153, v145
    v_mfma_f32_16x16x32_bf16 v[20:23], a[148:151], v[76:79], v[20:23]
    ds_read_b128 v[60:63], v1 offset:41984
    v_permlane32_swap_b32 v144, v152
    v_mfma_f32_16x16x32_bf16 v[12:15], a[148:151], v[72:75], v[12:15]
    s_waitcnt lgkmcnt(2)
    v_permlane32_swap_b32 v145, v153
    v_mfma_f32_16x16x32_bf16 v[8:11], a[152:155], v[80:83], v[8:11]
    ds_read_b128 v[64:67], v1 offset:43008
    v_add_f32 v144, v144, v152
    v_mfma_f32_16x16x32_bf16 v[16:19], a[152:155], v[84:87], v[16:19]
    v_add_f32 v145, v145, v153
    v_mul_f32 v112, 0xba800000, v144
    v_mfma_f32_16x16x32_bf16 v[20:23], a[156:159], v[84:87], v[20:23]
    ds_read_b128 v[68:71], v1 offset:44032
    v_mul_f32 v145, 0x3a800000, v145
    v_mfma_f32_16x16x32_bf16 v[12:15], a[156:159], v[80:83], v[12:15]
    s_waitcnt lgkmcnt(2)
    v_fma_f32 v145, -v112, v112, v145
    v_mov_b32 v113, v112
    v_mfma_f32_16x16x32_bf16 v[8:11], a[160:163], v[56:59], v[8:11]
    ds_read_b128 v[72:75], v1 offset:45056
    v_max_f32 v145, 0, v145
    v_mfma_f32_16x16x32_bf16 v[16:19], a[160:163], v[60:63], v[16:19]
    v_add_f32 v145, 0x3727c5ac, v145
    v_rsq_f32 v116, v145
    v_mfma_f32_16x16x32_bf16 v[20:23], a[164:167], v[60:63], v[20:23]
    ds_read_b128 v[76:79], v1 offset:46080
    v_permlane16_swap_b32 v112, v113
    v_mfma_f32_16x16x32_bf16 v[12:15], a[164:167], v[56:59], v[12:15]
    s_waitcnt lgkmcnt(2)
    v_mul_f32 v114, v145, v116
    v_mul_f32 v116, v116, v116
    v_mfma_f32_16x16x32_bf16 v[8:11], a[168:171], v[64:67], v[8:11]
    s_waitcnt vmcnt(0)
    ds_read_b128 v[80:83], v1 offset:47104
    v_mov_b32 v115, v114
    v_mfma_f32_16x16x32_bf16 v[16:19], a[168:171], v[68:71], v[16:19]
    s_barrier
    buffer_store_dword v124, v124, s[16:19], s91 offen sc1
    v_mfma_f32_16x16x32_bf16 v[20:23], a[172:175], v[68:71], v[20:23]
    s_add_u32 s91, s91, 65536
    ds_read_b128 v[84:87], v1 offset:48128
    v_cmp_ne_u32 vcc, 0, v7
    v_mfma_f32_16x16x32_bf16 v[12:15], a[172:175], v[64:67], v[12:15]
    s_waitcnt lgkmcnt(2)
    v_mov_b32 v117, v116
    v_permlane16_swap_b32 v114, v115
    v_mfma_f32_16x16x32_bf16 v[8:11], a[176:179], v[72:75], v[8:11]
    s_cbranch_vccnz L_spin35
L_back36:
    ds_read_b128 v[56:59], v1 offset:49152
    v_permlane16_swap_b32 v116, v117
    v_mfma_f32_16x16x32_bf16 v[16:19], a[176:179], v[76:79], v[16:19]
    s_barrier
    buffer_load_dwordx4 v1, s[16:19], s42 offen offset:0 sc1 lds
    v_mfma_f32_16x16x32_bf16 v[20:23], a[180:183], v[76:79], v[20:23]
    s_add_u32 s46, s46, 2048
    ds_read_b128 v[60:63], v1 offset:50176
    buffer_load_dwordx4 v1, s[16:19], s42 offen offset:1024 sc1 lds
    v_mfma_f32_16x16x32_bf16 v[12:15], a[180:183], v[72:75], v[12:15]
    s_waitcnt lgkmcnt(2)
    buffer_load_dwordx4 v1, s[16:19], s42 offen offset:2048 sc1 lds
    v_mfma_f32_16x16x32_bf16 v[8:11], a[184:187], v[80:83], v[8:11]
    ds_read_b128 v[64:67], v1 offset:51200
    buffer_load_dwordx4 v1, s[16:19], s42 offen offset:3072 sc1 lds
    v_mfma_f32_16x16x32_bf16 v[16:19], a[184:187], v[84:87], v[16:19]
    s_add_u32 m0, s43, 114688
    v_mul_f32 v128, v112, v88
    v_fmac_f32 v128, v114, v100
    v_mfma_f32_16x16x32_bf16 v[20:23], a[188:191], v[84:87], v[20:23]
    s_add_u32 s42, s41, 16384
    ds_read_b128 v[68:71], v1 offset:52224
    v_mul_f32 v129, v112, v89
    v_mfma_f32_16x16x32_bf16 v[12:15], a[188:191], v[80:83], v[12:15]
    s_waitcnt lgkmcnt(2)
    v_fmac_f32 v129, v114, v101
    v_mul_f32 v130, v112, v90
    v_mfma_f32_16x16x32_bf16 v[8:11], a[192:195], v[56:59], v[8:11]
    ds_read_b128 v[72:75], v1 offset:53248
    buffer_load_dwordx4 v1, s[16:19], s42 offen offset:0 sc1 lds
    v_mfma_f32_16x16x32_bf16 v[16:19], a[192:195], v[60:63], v[16:19]
    v_fmac_f32 v130, v114, v102
    v_mul_f32 v131, v112, v91
    v_mfma_f32_16x16x32_bf16 v[20:23], a[196:199], v[60:63], v[20:23]
    ds_read_b128 v[76:79], v1 offset:54272
    v_fmac_f32 v131, v114, v103
    v_mfma_f32_16x16x32_bf16 v[12:15], a[196:199], v[56:59], v[12:15]
    s_waitcnt lgkmcnt(2)
    v_mul_f32 v132, v112, v92
    v_fmac_f32 v132, v114, v104
    v_mfma_f32_16x16x32_bf16 v[8:11], a[200:203], v[64:67], v[8:11]
    ds_read_b128 v[80:83], v1 offset:55296
    buffer_load_dwordx4 v1, s[16:19], s42 offen offset:1024 sc1 lds
    v_mfma_f32_16x16x32_bf16 v[16:19], a[200:203], v[68:71], v[16:19]
    v_mul_f32 v133, v112, v93
    v_fmac_f32 v133, v114, v105
    v_mfma_f32_16x16x32_bf16 v[20:23], a[204:207], v[68:71], v[20:23]
    ds_read_b128 v[84:87], v1 offset:56320
    v_mul_f32 v134, v112, v94
    v_mfma_f32_16x16x32_bf16 v[12:15], a[204:207], v[64:67], v[12:15]
    s_waitcnt lgkmcnt(2)
    v_fmac_f32 v134, v114, v106
    v_mul_f32 v135, v112, v95
    v_mfma_f32_16x16x32_bf16 v[8:11], a[208:211], v[72:75], v[8:11]
    ds_read_b128 v[56:59], v1 offset:57344
    buffer_load_dwordx4 v1, s[16:19], s42 offen offset:2048 sc1 lds
    v_mfma_f32_16x16x32_bf16 v[16:19], a[208:211], v[76:79], v[16:19]
    v_fmac_f32 v135, v114, v107
    v_mul_f32 v136, v113, v88
    v_mfma_f32_16x16x32_bf16 v[20:23], a[212:215], v[76:79], v[20:23]
    ds_read_b128 v[60:63], v1 offset:58368
    v_fmac_f32 v136, v115, v100
    v_mfma_f32_16x16x32_bf16 v[12:15], a[212:215], v[72:75], v[12:15]
    s_waitcnt lgkmcnt(2)
    v_mul_f32 v137, v113, v89
    v_fmac_f32 v137, v115, v101
    v_mfma_f32_16x16x32_bf16 v[8:11], a[216:219], v[80:83], v[8:11]
    ds_read_b128 v[64:67], v1 offset:59392
    buffer_load_dwordx4 v1, s[16:19], s42 offen offset:3072 sc1 lds
    v_mfma_f32_16x16x32_bf16 v[16:19], a[216:219], v[84:87], v[16:19]
    s_add_u32 s45, s45, 65536
    v_mul_f32 v138, v113, v90
    v_fmac_f32 v138, v115, v102
    v_mfma_f32_16x16x32_bf16 v[20:23], a[220:223], v[84:87], v[20:23]
    ds_read_b128 v[68:71], v1 offset:60416
    v_mul_f32 v139, v113, v91
    v_mfma_f32_16x16x32_bf16 v[12:15], a[220:223], v[80:83], v[12:15]
    s_waitcnt lgkmcnt(2)
    v_fmac_f32 v139, v115, v103
    v_mul_f32 v140, v113, v92
    v_mfma_f32_16x16x32_bf16 v[8:11], a[224:227], v[56:59], v[8:11]
    ds_read_b128 v[72:75], v1 offset:61440
    v_fmac_f32 v140, v115, v104
    v_mfma_f32_16x16x32_bf16 v[16:19], a[224:227], v[60:63], v[16:19]
    v_mul_f32 v141, v113, v93
    v_fmac_f32 v141, v115, v105
    v_mfma_f32_16x16x32_bf16 v[20:23], a[228:231], v[60:63], v[20:23]
    ds_read_b128 v[76:79], v1 offset:62464
    v_mul_f32 v142, v113, v94
    v_mfma_f32_16x16x32_bf16 v[12:15], a[228:231], v[56:59], v[12:15]
    s_waitcnt lgkmcnt(2)
    v_fmac_f32 v142, v115, v106
    v_mul_f32 v143, v113, v95
    v_mfma_f32_16x16x32_bf16 v[8:11], a[232:235], v[64:67], v[8:11]
    ds_read_b128 v[80:83], v1 offset:63488
    v_fmac_f32 v143, v115, v107
    v_mfma_f32_16x16x32_bf16 v[16:19], a[232:235], v[68:71], v[16:19]
    v_mfma_f32_16x16x32_bf16 v[20:23], a[236:239], v[68:71], v[20:23]
    ds_read_b128 v[84:87], v1 offset:64512
    v_mfma_f32_16x16x32_bf16 v[12:15], a[236:239], v[64:67], v[12:15]
    s_waitcnt vmcnt(4) lgkmcnt(2)
    s_barrier
    v_mfma_f32_16x16x32_bf16 v[8:11], a[240:243], v[72:75], v[8:11]
    ds_read_b128 v[56:59], v2 offset:0
    v_mfma_f32_16x16x32_bf16 v[16:19], a[240:243], v[76:79], v[16:19]
    v_mfma_f32_16x16x32_bf16 v[20:23], a[244:247], v[76:79], v[20:23]
    ds_read_b128 v[60:63], v2 offset:1024
    v_mfma_f32_16x16x32_bf16 v[12:15], a[244:247], v[72:75], v[12:15]
    s_waitcnt lgkmcnt(2)
    v_mfma_f32_16x16x32_bf16 v[8:11], a[248:251], v[80:83], v[8:11]
    ds_read_b128 v[64:67], v2 offset:2048
    v_mfma_f32_16x16x32_bf16 v[16:19], a[248:251], v[84:87], v[16:19]
    v_mfma_f32_16x16x32_bf16 v[20:23], a[252:255], v[84:87], v[20:23]
    ds_read_b128 v[68:71], v2 offset:3072
    v_mfma_f32_16x16x32_bf16 v[12:15], a[252:255], v[80:83], v[12:15]
    s_add_u32 s36, s36, 1
L_l_b1:
    s_waitcnt lgkmcnt(2)
    v_mfma_f32_16x16x32_bf16 v[32:35], a[0:3], v[56:59], 0
    s_add_u32 m0, s52, 73728
    ds_read_b128 v[72:75], v2 offset:4096
    s_add_u32 s42, s46, s52
    v_mfma_f32_16x16x32_bf16 v[40:43], a[0:3], v[60:63], 0
    buffer_load_dwordx4 v1, s[16:19], s42 offen sc1 lds
    v_mfma_f32_16x16x32_bf16 v[44:47], a[4:7], v[60:63], 0
    s_add_u32 m0, s43, 131072
    ds_read_b128 v[76:79], v2 offset:5120
    s_add_u32 s42, s41, 32768
    v_mfma_f32_16x16x32_bf16 v[36:39], a[4:7], v[56:59], 0
    s_waitcnt lgkmcnt(2)
    buffer_load_dwordx4 v1, s[16:19], s42 offen offset:0 sc1 lds
    v_mfma_f32_16x16x32_bf16 v[32:35], a[8:11], v[64:67], v[32:35]
    s_and_b32 s44, s90, 0xffffffff
    ds_read_b128 v[80:83], v2 offset:6144
    s_cmp_lt_i32 s36, 1
    v_mfma_f32_16x16x32_bf16 v[40:43], a[8:11], v[68:71], v[40:43]
    buffer_load_dwordx4 v1, s[16:19], s42 offen offset:1024 sc1 lds
    v_mfma_f32_16x16x32_bf16 v[44:47], a[12:15], v[68:71], v[44:47]
    s_cselect_b32 s44, 0x5e00000, s44
    ds_read_b128 v[84:87], v2 offset:7168
    s_add_u32 s90, s90, 262144
    v_mfma_f32_16x16x32_bf16 v[36:39], a[12:15], v[64:67], v[36:39]
    s_waitcnt lgkmcnt(2)
    buffer_load_dwordx4 v1, s[16:19], s42 offen offset:2048 sc1 lds
    v_mfma_f32_16x16x32_bf16 v[32:35], a[16:19], v[72:75], v[32:35]
    ds_read_b128 v[56:59], v2 offset:8192
    v_add_f32 v8, v8, v128
    v_mfma_f32_16x16x32_bf16 v[40:43], a[16:19], v[76:79], v[40:43]
    buffer_load_dwordx4 v1, s[16:19], s42 offen offset:3072 sc1 lds
    v_mfma_f32_16x16x32_bf16 v[44:47], a[20:23], v[76:79], v[44:47]
    s_add_u32 m0, s43, 147456
    ds_read_b128 v[60:63], v2 offset:9216
    v_add_f32 v9, v9, v129
    v_mfma_f32_16x16x32_bf16 v[36:39], a[20:23], v[72:75], v[36:39]
    s_waitcnt lgkmcnt(2)
    v_mul_f32 v120, v8, v116
    v_mul_f32 v121, v9, v116
    v_mfma_f32_16x16x32_bf16 v[32:35], a[24:27], v[80:83], v[32:35]
    s_add_u32 s42, s41, 49152
    ds_read_b128 v[64:67], v2 offset:10240
    buffer_load_dwordx4 v1, s[16:19], s42 offen offset:0 sc1 lds
    v_mfma_f32_16x16x32_bf16 v[40:43], a[24:27], v[84:87], v[40:43]
    v_mul_f32 v120, v120, abs(v8)
    v_mul_f32 v121, v121, abs(v9)
    v_mfma_f32_16x16x32_bf16 v[44:47], a[28:31], v[84:87], v[44:47]
    ds_read_b128 v[68:71], v2 offset:11264
    buffer_load_dwordx4 v1, s[16:19], s42 offen offset:1024 sc1 lds
    v_mfma_f32_16x16x32_bf16 v[36:39], a[28:31], v[80:83], v[36:39]
    s_waitcnt lgkmcnt(2)
    v_cvt_pk_bf16_f32 v8, v120, v121
    v_pk_max_i16 v8, v8, 0
    v_mfma_f32_16x16x32_bf16 v[32:35], a[32:35], v[56:59], v[32:35]
    ds_read_b128 v[72:75], v2 offset:12288
    buffer_load_dwordx4 v1, s[16:19], s42 offen offset:2048 sc1 lds
    v_mfma_f32_16x16x32_bf16 v[40:43], a[32:35], v[60:63], v[40:43]
    v_add_f32 v10, v10, v130
    v_add_f32 v11, v11, v131
    v_mfma_f32_16x16x32_bf16 v[44:47], a[36:39], v[60:63], v[44:47]
    ds_read_b128 v[76:79], v2 offset:13312
    buffer_load_dwordx4 v1, s[16:19], s42 offen offset:3072 sc1 lds
    v_mfma_f32_16x16x32_bf16 v[36:39], a[36:39], v[56:59], v[36:39]
    s_waitcnt lgkmcnt(2)
    v_mul_f32 v120, v10, v116
    v_mul_f32 v121, v11, v116
    v_mfma_f32_16x16x32_bf16 v[32:35], a[40:43], v[64:67], v[32:35]
    s_add_u32 s98, s98, 65536
    ds_read_b128 v[80:83], v2 offset:14336
    v_mul_f32 v120, v120, abs(v10)
    v_mfma_f32_16x16x32_bf16 v[40:43], a[40:43], v[68:71], v[40:43]
    s_min_i32 s98, s98, s96
    v_mul_f32 v121, v121, abs(v11)
    v_cvt_pk_bf16_f32 v9, v120, v121
    v_mfma_f32_16x16x32_bf16 v[44:47], a[44:47], v[68:71], v[44:47]
    s_and_b32 s41, s98, 0xffffffff
    ds_read_b128 v[84:87], v2 offset:15360
    v_pk_max_i16 v9, v9, 0
    v_mfma_f32_16x16x32_bf16 v[36:39], a[44:47], v[64:67], v[36:39]
    s_waitcnt vmcnt(9) lgkmcnt(2)
    s_barrier
    v_add_f32 v12, v12, v132
    v_mfma_f32_16x16x32_bf16 v[32:35], a[48:51], v[72:75], v[32:35]
    ds_read_b128 v[56:59], v2 offset:16384
    v_add_f32 v13, v13, v133
    v_mfma_f32_16x16x32_bf16 v[40:43], a[48:51], v[76:79], v[40:43]
    v_mul_f32 v120, v12, v116
    v_mul_f32 v121, v13, v116
    v_mfma_f32_16x16x32_bf16 v[44:47], a[52:55], v[76:79], v[44:47]
    ds_read_b128 v[60:63], v2 offset:17408
    v_mul_f32 v120, v120, abs(v12)
    v_mfma_f32_16x16x32_bf16 v[36:39], a[52:55], v[72:75], v[36:39]
    s_waitcnt lgkmcnt(2)
    v_mul_f32 v121, v121, abs(v13)
    v_cvt_pk_bf16_f32 v10, v120, v121
    v_mfma_f32_16x16x32_bf16 v[32:35], a[56:59], v[80:83], v[32:35]
    ds_read_b128 v[64:67], v2 offset:18432
    v_pk_max_i16 v10, v10, 0
    v_mfma_f32_16x16x32_bf16 v[40:43], a[56:59], v[84:87], v[40:43]
    v_add_f32 v14, v14, v134
    v_add_f32 v15, v15, v135
    v_mfma_f32_16x16x32_bf16 v[44:47], a[60:63], v[84:87], v[44:47]
    ds_read_b128 v[68:71], v2 offset:19456
    v_mul_f32 v120, v14, v116
    v_mfma_f32_16x16x32_bf16 v[36:39], a[60:63], v[80:83], v[36:39]
    s_waitcnt lgkmcnt(2)
    v_mul_f32 v121, v15, v116
    v_mul_f32 v120, v120, abs(v14)
    v_mfma_f32_16x16x32_bf16 v[32:35], a[64:67], v[56:59], v[32:35]
    ds_read_b128 v[72:75], v2 offset:20480
    v_mul_f32 v121, v121, abs(v15)
    v_mfma_f32_16x16x32_bf16 v[40:43], a[64:67], v[60:63], v[40:43]
    v_cvt_pk_bf16_f32 v11, v120, v121
    v_pk_max_i16 v11, v11, 0
    v_mfma_f32_16x16x32_bf16 v[44:47], a[68:71], v[60:63], v[44:47]
    ds_read_b128 v[76:79], v2 offset:21504
    buffer_store_dwordx4 v[8:11], v1, s[16:19], s44 offen offset:0 sc1
    v_mfma_f32_16x16x32_bf16 v[36:39], a[68:71], v[56:59], v[36:39]
    s_waitcnt lgkmcnt(2)
    v_add_f32 v16, v16, v136
    v_add_f32 v17, v17, v137
    v_mfma_f32_16x16x32_bf16 v[32:35], a[72:75], v[64:67], v[32:35]
    ds_read_b128 v[80:83], v2 offset:22528
    v_mul_f32 v120, v16, v117
    v_mfma_f32_16x16x32_bf16 v[40:43], a[72:75], v[68:71], v[40:43]
    v_mul_f32 v121, v17, v117
    v_mul_f32 v120, v120, abs(v16)
    v_mfma_f32_16x16x32_bf16 v[44:47], a[76:79], v[68:71], v[44:47]
    ds_read_b128 v[84:87], v2 offset:23552
    v_mul_f32 v121, v121, abs(v17)
    v_mfma_f32_16x16x32_bf16 v[36:39], a[76:79], v[64:67], v[36:39]
    s_waitcnt lgkmcnt(2)
    v_cvt_pk_bf16_f32 v16, v120, v121
    v_pk_max_i16 v16, v16, 0
    v_mfma_f32_16x16x32_bf16 v[32:35], a[80:83], v[72:75], v[32:35]
    ds_read_b128 v[56:59], v2 offset:24576
    v_add_f32 v18, v18, v138
    v_mfma_f32_16x16x32_bf16 v[40:43], a[80:83], v[76:79], v[40:43]
    v_add_f32 v19, v19, v139
    v_mul_f32 v120, v18, v117
    v_mfma_f32_16x16x32_bf16 v[44:47], a[84:87], v[76:79], v[44:47]
    ds_read_b128 v[60:63], v2 offset:25600
    v_mul_f32 v121, v19, v117
    v_mfma_f32_16x16x32_bf16 v[36:39], a[84:87], v[72:75], v[36:39]
    s_waitcnt lgkmcnt(2)
    v_mul_f32 v120, v120, abs(v18)
    v_mul_f32 v121, v121, abs(v19)
    v_mfma_f32_16x16x32_bf16 v[32:35], a[88:91], v[80:83], v[32:35]
    ds_read_b128 v[64:67], v2 offset:26624
    v_cvt_pk_bf16_f32 v17, v120, v121
    v_mfma_f32_16x16x32_bf16 v[40:43], a[88:91], v[84:87], v[40:43]
    v_pk_max_i16 v17, v17, 0
    v_add_f32 v20, v20, v140
    v_mfma_f32_16x16x32_bf16 v[44:47], a[92:95], v[84:87], v[44:47]
    ds_read_b128 v[68:71], v2 offset:27648
    v_add_f32 v21, v21, v141
    v_mfma_f32_16x16x32_bf16 v[36:39], a[92:95], v[80:83], v[36:39]
    s_waitcnt lgkmcnt(2)
    v_mul_f32 v120, v20, v117
    v_mul_f32 v121, v21, v117
    v_mfma_f32_16x16x32_bf16 v[32:35], a[96:99], v[56:59], v[32:35]
    ds_read_b128 v[72:75], v2 offset:28672
    v_mul_f32 v120, v120, abs(v20)
    v_mfma_f32_16x16x32_bf16 v[40:43], a[96:99], v[60:63], v[40:43]
    v_mul_f32 v121, v121, abs(v21)
    v_cvt_pk_bf16_f32 v18, v120, v121
    v_mfma_f32_16x16x32_bf16 v[44:47], a[100:103], v[60:63], v[44:47]
    ds_read_b128 v[76:79], v2 offset:29696
    buffer_load_dword v7, v5, s[16:19], s45 offen sc1
    v_mfma_f32_16x16x32_bf16 v[36:39], a[100:103], v[56:59], v[36:39]
    s_waitcnt lgkmcnt(2)
    v_pk_max_i16 v18, v18, 0
    v_add_f32 v22, v22, v142
    v_mfma_f32_16x16x32_bf16 v[32:35], a[104:107], v[64:67], v[32:35]
    ds_read_b128 v[80:83], v2 offset:30720
    v_add_f32 v23, v23, v143
    v_mfma_f32_16x16x32_bf16 v[40:43], a[104:107], v[68:71], v[40:43]
    v_mul_f32 v120, v22, v117
    v_mul_f32 v121, v23, v117
    v_mfma_f32_16x16x32_bf16 v[44:47], a[108:111], v[68:71], v[44:47]
    ds_read_b128 v[84:87], v2 offset:31744
    v_mul_f32 v120, v120, abs(v22)
    v_mfma_f32_16x16x32_bf16 v[36:39], a[108:111], v[64:67], v[36:39]
    s_waitcnt vmcnt(6) lgkmcnt(2)
    s_barrier
    v_mul_f32 v121, v121, abs(v23)
    v_mfma_f32_16x16x32_bf16 v[32:35], a[112:115], v[72:75], v[32:35]
    ds_read_b128 v[56:59], v2 offset:32768
    v_cvt_pk_bf16_f32 v19, v120, v121
    v_mfma_f32_16x16x32_bf16 v[40:43], a[112:115], v[76:79], v[40:43]
    v_pk_max_i16 v19, v19, 0
    buffer_store_dwordx4 v[16:19], v1, s[16:19], s44 offen offset:1024 sc1
    v_mfma_f32_16x16x32_bf16 v[44:47], a[116:119], v[76:79], v[44:47]
    s_add_u32 m0, s43, 0
    ds_read_b128 v[60:63], v2 offset:33792
    ds_read_b64 v[144:145], v118 offset:0
    v_mfma_f32_16x16x32_bf16 v[36:39], a[116:119], v[72:75], v[36:39]
    s_waitcnt lgkmcnt(3)
    ds_read_b64 v[146:147], v118 offset:128
    ds_read_b64 v[148:149], v118 offset:256
    v_mfma_f32_16x16x32_bf16 v[32:35], a[120:123], v[80:83], v[32:35]
    s_add_u32 s42, s41, 0
    ds_read_b128 v[64:67], v2 offset:34816
    ds_read_b64 v[150:151], v118 offset:384
    v_mfma_f32_16x16x32_bf16 v[40:43], a[120:123], v[84:87], v[40:43]
    v_mfma_f32_16x16x32_bf16 v[44:47], a[124:127], v[84:87], v[44:47]
    ds_read_b128 v[68:71], v2 offset:35840
    v_mfma_f32_16x16x32_bf16 v[36:39], a[124:127], v[80:83], v[36:39]
    s_waitcnt lgkmcnt(6)
    v_mfma_f32_16x16x32_bf16 v[32:35], a[128:131], v[56:59], v[32:35]
    ds_read_b128 v[72:75], v2 offset:36864
    v_mfma_f32_16x16x32_bf16 v[40:43], a[128:131], v[60:63], v[40:43]
    s_waitcnt lgkmcnt(2)
    v_max3_u32 v152, v144, v145, v146
    v_max3_u32 v153, v147, v148, v149
    v_mfma_f32_16x16x32_bf16 v[44:47], a[132:135], v[60:63], v[44:47]
    ds_read_b128 v[76:79], v2 offset:37888
    v_max3_u32 v152, v152, v150, v151
    v_mfma_f32_16x16x32_bf16 v[36:39], a[132:135], v[56:59], v[36:39]
    s_waitcnt lgkmcnt(2)
    v_max_u32 v152, v152, v153
    v_cmp_eq_u32 vcc, -1, v152
    v_mfma_f32_16x16x32_bf16 v[32:35], a[136:139], v[64:67], v[32:35]
    ds_read_b128 v[80:83], v2 offset:38912
    v_mfma_f32_16x16x32_bf16 v[40:43], a[136:139], v[68:71], v[40:43]
    s_cbranch_vccnz L_sspin41
L_sback42:
    v_add_f32 v152, v148, v150
    v_add_f32 v153, v149, v151
    v_mfma_f32_16x16x32_bf16 v[44:47], a[140:143], v[68:71], v[44:47]
    ds_read_b128 v[84:87], v2 offset:39936
    v_add_f32 v144, v144, v146
    v_mfma_f32_16x16x32_bf16 v[36:39], a[140:143], v[64:67], v[36:39]
    s_waitcnt lgkmcnt(2)
    v_add_f32 v145, v145, v147
    v_add_f32 v144, v144, v152
    v_mfma_f32_16x16x32_bf16 v[32:35], a[144:147], v[72:75], v[32:35]
    ds_read_b128 v[56:59], v2 offset:40960
    v_add_f32 v145, v145, v153
    v_mfma_f32_16x16x32_bf16 v[40:43], a[144:147], v[76:79], v[40:43]
    v_mov_b32 v152, v144
    v_mov_b32 v153, v145
    v_mfma_f32_16x16x32_bf16 v[44:47], a[148:151], v[76:79], v[44:47]
    ds_read_b128 v[60:63], v2 offset:41984
    v_permlane32_swap_b32 v144, v152
    v_mfma_f32_16x16x32_bf16 v[36:39], a[148:151], v[72:75], v[36:39]
    s_waitcnt lgkmcnt(2)
    v_permlane32_swap_b32 v145, v153
    v_mfma_f32_16x16x32_bf16 v[32:35], a[152:155], v[80:83], v[32:35]
    ds_read_b128 v[64:67], v2 offset:43008
    v_add_f32 v144, v144, v152
    v_mfma_f32_16x16x32_bf16 v[40:43], a[152:155], v[84:87], v[40:43]
    v_add_f32 v145, v145, v153
    v_mul_f32 v112, 0xba800000, v144
    v_mfma_f32_16x16x32_bf16 v[44:47], a[156:159], v[84:87], v[44:47]
    ds_read_b128 v[68:71], v2 offset:44032
    v_mul_f32 v145, 0x3a800000, v145
    v_mfma_f32_16x16x32_bf16 v[36:39], a[156:159], v[80:83], v[36:39]
    s_waitcnt lgkmcnt(2)
    v_fma_f32 v145, -v112, v112, v145
    v_mov_b32 v113, v112
    v_mfma_f32_16x16x32_bf16 v[32:35], a[160:163], v[56:59], v[32:35]
    ds_read_b128 v[72:75], v2 offset:45056
    v_max_f32 v145, 0, v145
    v_mfma_f32_16x16x32_bf16 v[40:43], a[160:163], v[60:63], v[40:43]
    v_add_f32 v145, 0x3727c5ac, v145
    v_rsq_f32 v116, v145
    v_mfma_f32_16x16x32_bf16 v[44:47], a[164:167], v[60:63], v[44:47]
    ds_read_b128 v[76:79], v2 offset:46080
    v_permlane16_swap_b32 v112, v113
    v_mfma_f32_16x16x32_bf16 v[36:39], a[164:167], v[56:59], v[36:39]
    s_waitcnt lgkmcnt(2)
    v_mul_f32 v114, v145, v116
    v_mul_f32 v116, v116, v116
    v_mfma_f32_16x16x32_bf16 v[32:35], a[168:171], v[64:67], v[32:35]
    s_waitcnt vmcnt(0)
    ds_read_b128 v[80:83], v2 offset:47104
    v_mov_b32 v115, v114
    v_mfma_f32_16x16x32_bf16 v[40:43], a[168:171], v[68:71], v[40:43]
    s_barrier
    buffer_store_dword v124, v124, s[16:19], s91 offen sc1
    v_mfma_f32_16x16x32_bf16 v[44:47], a[172:175], v[68:71], v[44:47]
    s_add_u32 s91, s91, 65536
    ds_read_b128 v[84:87], v2 offset:48128
    v_cmp_ne_u32 vcc, 0, v7
    v_mfma_f32_16x16x32_bf16 v[36:39], a[172:175], v[64:67], v[36:39]
    s_waitcnt lgkmcnt(2)
    v_mov_b32 v117, v116
    v_permlane16_swap_b32 v114, v115
    v_mfma_f32_16x16x32_bf16 v[32:35], a[176:179], v[72:75], v[32:35]
    s_cbranch_vccnz L_spin39
L_back40:
    ds_read_b128 v[56:59], v2 offset:49152
    v_permlane16_swap_b32 v116, v117
    v_mfma_f32_16x16x32_bf16 v[40:43], a[176:179], v[76:79], v[40:43]
    s_barrier
    buffer_load_dwordx4 v1, s[16:19], s42 offen offset:0 sc1 lds
    v_mfma_f32_16x16x32_bf16 v[44:47], a[180:183], v[76:79], v[44:47]
    s_add_u32 s46, s46, 2048
    ds_read_b128 v[60:63], v2 offset:50176
    buffer_load_dwordx4 v1, s[16:19], s42 offen offset:1024 sc1 lds
    v_mfma_f32_16x16x32_bf16 v[36:39], a[180:183], v[72:75], v[36:39]
    s_waitcnt lgkmcnt(2)
    buffer_load_dwordx4 v1, s[16:19], s42 offen offset:2048 sc1 lds
    v_mfma_f32_16x16x32_bf16 v[32:35], a[184:187], v[80:83], v[32:35]
    ds_read_b128 v[64:67], v2 offset:51200
    buffer_load_dwordx4 v1, s[16:19], s42 offen offset:3072 sc1 lds
    v_mfma_f32_16x16x32_bf16 v[40:43], a[184:187], v[84:87], v[40:43]
    s_add_u32 m0, s43, 16384
    v_mul_f32 v128, v112, v88
    v_fmac_f32 v128, v114, v100
    v_mfma_f32_16x16x32_bf16 v[44:47], a[188:191], v[84:87], v[44:47]
    s_add_u32 s42, s41, 16384
    ds_read_b128 v[68:71], v2 offset:52224
    v_mul_f32 v129, v112, v89
    v_mfma_f32_16x16x32_bf16 v[36:39], a[188:191], v[80:83], v[36:39]
    s_waitcnt lgkmcnt(2)
    v_fmac_f32 v129, v114, v101
    v_mul_f32 v130, v112, v90
    v_mfma_f32_16x16x32_bf16 v[32:35], a[192:195], v[56:59], v[32:35]
    ds_read_b128 v[72:75], v2 offset:53248
    buffer_load_dwordx4 v1, s[16:19], s42 offen offset:0 sc1 lds
    v_mfma_f32_16x16x32_bf16 v[40:43], a[192:195], v[60:63], v[40:43]
    v_fmac_f32 v130, v114, v102
    v_mul_f32 v131, v112, v91
    v_mfma_f32_16x16x32_bf16 v[44:47], a[196:199], v[60:63], v[44:47]
    ds_read_b128 v[76:79], v2 offset:54272
    v_fmac_f32 v131, v114, v103
    v_mfma_f32_16x16x32_bf16 v[36:39], a[196:199], v[56:59], v[36:39]
    s_waitcnt lgkmcnt(2)
    v_mul_f32 v132, v112, v92
    v_fmac_f32 v132, v114, v104
    v_mfma_f32_16x16x32_bf16 v[32:35], a[200:203], v[64:67], v[32:35]
    ds_read_b128 v[80:83], v2 offset:55296
    buffer_load_dwordx4 v1, s[16:19], s42 offen offset:1024 sc1 lds
    v_mfma_f32_16x16x32_bf16 v[40:43], a[200:203], v[68:71], v[40:43]
    v_mul_f32 v133, v112, v93
    v_fmac_f32 v133, v114, v105
    v_mfma_f32_16x16x32_bf16 v[44:47], a[204:207], v[68:71], v[44:47]
    ds_read_b128 v[84:87], v2 offset:56320
    v_mul_f32 v134, v112, v94
    v_mfma_f32_16x16x32_bf16 v[36:39], a[204:207], v[64:67], v[36:39]
    s_waitcnt lgkmcnt(2)
    v_fmac_f32 v134, v114, v106
    v_mul_f32 v135, v112, v95
    v_mfma_f32_16x16x32_bf16 v[32:35], a[208:211], v[72:75], v[32:35]
    ds_read_b128 v[56:59], v2 offset:57344
    buffer_load_dwordx4 v1, s[16:19], s42 offen offset:2048 sc1 lds
    v_mfma_f32_16x16x32_bf16 v[40:43], a[208:211], v[76:79], v[40:43]
    v_fmac_f32 v135, v114, v107
    v_mul_f32 v136, v113, v88
    v_mfma_f32_16x16x32_bf16 v[44:47], a[212:215], v[76:79], v[44:47]
    ds_read_b128 v[60:63], v2 offset:58368
    v_fmac_f32 v136, v115, v100
    v_mfma_f32_16x16x32_bf16 v[36:39], a[212:215], v[72:75], v[36:39]
    s_waitcnt lgkmcnt(2)
    v_mul_f32 v137, v113, v89
    v_fmac_f32 v137, v115, v101
    v_mfma_f32_16x16x32_bf16 v[32:35], a[216:219], v[80:83], v[32:35]
    ds_read_b128 v[64:67], v2 offset:59392
    buffer_load_dwordx4 v1, s[16:19], s42 offen offset:3072 sc1 lds
    v_mfma_f32_16x16x32_bf16 v[40:43], a[216:219], v[84:87], v[40:43]
    s_add_u32 s45, s45, 65536
    v_mul_f32 v138, v113, v90
    v_fmac_f32 v138, v115, v102
    v_mfma_f32_16x16x32_bf16 v[44:47], a[220:223], v[84:87], v[44:47]
    ds_read_b128 v[68:71], v2 offset:60416
    v_mul_f32 v139, v113, v91
    v_mfma_f32_16x16x32_bf16 v[36:39], a[220:223], v[80:83], v[36:39]
    s_waitcnt lgkmcnt(2)
    v_fmac_f32 v139, v115, v103
    v_mul_f32 v140, v113, v92
    v_mfma_f32_16x16x32_bf16 v[32:35], a[224:227], v[56:59], v[32:35]
    ds_read_b128 v[72:75], v2 offset:61440
    v_fmac_f32 v140, v115, v104
    v_mfma_f32_16x16x32_bf16 v[40:43], a[224:227], v[60:63], v[40:43]
    v_mul_f32 v141, v113, v93
    v_fmac_f32 v141, v115, v105
    v_mfma_f32_16x16x32_bf16 v[44:47], a[228:231], v[60:63], v[44:47]
    ds_read_b128 v[76:79], v2 offset:62464
    v_mul_f32 v142, v113, v94
    v_mfma_f32_16x16x32_bf16 v[36:39], a[228:231], v[56:59], v[36:39]
    s_waitcnt lgkmcnt(2)
    v_fmac_f32 v142, v115, v106
    v_mul_f32 v143, v113, v95
    v_mfma_f32_16x16x32_bf16 v[32:35], a[232:235], v[64:67], v[32:35]
    ds_read_b128 v[80:83], v2 offset:63488
    v_fmac_f32 v143, v115, v107
    v_mfma_f32_16x16x32_bf16 v[40:43], a[232:235], v[68:71], v[40:43]
    v_mfma_f32_16x16x32_bf16 v[44:47], a[236:239], v[68:71], v[44:47]
    ds_read_b128 v[84:87], v2 offset:64512
    v_mfma_f32_16x16x32_bf16 v[36:39], a[236:239], v[64:67], v[36:39]
    s_waitcnt vmcnt(4) lgkmcnt(2)
    s_barrier
    v_mfma_f32_16x16x32_bf16 v[32:35], a[240:243], v[72:75], v[32:35]
    ds_read_b128 v[56:59], v1 offset:0
    v_mfma_f32_16x16x32_bf16 v[40:43], a[240:243], v[76:79], v[40:43]
    v_mfma_f32_16x16x32_bf16 v[44:47], a[244:247], v[76:79], v[44:47]
    ds_read_b128 v[60:63], v1 offset:1024
    v_mfma_f32_16x16x32_bf16 v[36:39], a[244:247], v[72:75], v[36:39]
    s_waitcnt lgkmcnt(2)
    v_mfma_f32_16x16x32_bf16 v[32:35], a[248:251], v[80:83], v[32:35]
    ds_read_b128 v[64:67], v1 offset:2048
    v_mfma_f32_16x16x32_bf16 v[40:43], a[248:251], v[84:87], v[40:43]
    v_mfma_f32_16x16x32_bf16 v[44:47], a[252:255], v[84:87], v[44:47]
    ds_read_b128 v[68:71], v1 offset:3072
    v_mfma_f32_16x16x32_bf16 v[36:39], a[252:255], v[80:83], v[36:39]
    s_add_u32 s36, s36, 1
    s_cmp_lt_u32 s36, 32
    s_cbranch_scc1 L_l_b0
    s_nop 7
    s_and_b32 s44, s90, 0xffffffff
    s_cmp_lt_i32 s36, 1
    s_cselect_b32 s44, 0x5e00000, s44
    s_add_u32 s90, s90, 262144
    v_add_f32 v32, v32, v128
    v_add_f32 v33, v33, v129
    v_mul_f32 v120, v32, v116
    v_mul_f32 v121, v33, v116
    v_mul_f32 v120, v120, abs(v32)
    v_mul_f32 v121, v121, abs(v33)
    v_cvt_pk_bf16_f32 v32, v120, v121
    v_pk_max_i16 v32, v32, 0
    v_add_f32 v34, v34, v130
    v_add_f32 v35, v35, v131
    v_mul_f32 v120, v34, v116
    v_mul_f32 v121, v35, v116
    v_mul_f32 v120, v120, abs(v34)
    v_mul_f32 v121, v121, abs(v35)
    v_cvt_pk_bf16_f32 v33, v120, v121
    v_pk_max_i16 v33, v33, 0
    v_add_f32 v36, v36, v132
    v_add_f32 v37, v37, v133
    v_mul_f32 v120, v36, v116
    v_mul_f32 v121, v37, v116
    v_mul_f32 v120, v120, abs(v36)
    v_mul_f32 v121, v121, abs(v37)
    v_cvt_pk_bf16_f32 v34, v120, v121
    v_pk_max_i16 v34, v34, 0
    v_add_f32 v38, v38, v134
    v_add_f32 v39, v39, v135
    v_mul_f32 v120, v38, v116
    v_mul_f32 v121, v39, v116
    v_mul_f32 v120, v120, abs(v38)
    v_mul_f32 v121, v121, abs(v39)
    v_cvt_pk_bf16_f32 v35, v120, v121
    v_pk_max_i16 v35, v35, 0
    buffer_store_dwordx4 v[32:35], v1, s[16:19], s44 offen offset:0 sc1
    v_add_f32 v40, v40, v136
    v_add_f32 v41, v41, v137
    v_mul_f32 v120, v40, v117
    v_mul_f32 v121, v41, v117
    v_mul_f32 v120, v120, abs(v40)
    v_mul_f32 v121, v121, abs(v41)
    v_cvt_pk_bf16_f32 v40, v120, v121
    v_pk_max_i16 v40, v40, 0
    v_add_f32 v42, v42, v138
    v_add_f32 v43, v43, v139
    v_mul_f32 v120, v42, v117
    v_mul_f32 v121, v43, v117
    v_mul_f32 v120, v120, abs(v42)
    v_mul_f32 v121, v121, abs(v43)
    v_cvt_pk_bf16_f32 v41, v120, v121
    v_pk_max_i16 v41, v41, 0
    v_add_f32 v44, v44, v140
    v_add_f32 v45, v45, v141
    v_mul_f32 v120, v44, v117
    v_mul_f32 v121, v45, v117
    v_mul_f32 v120, v120, abs(v44)
    v_mul_f32 v121, v121, abs(v45)
    v_cvt_pk_bf16_f32 v42, v120, v121
    v_pk_max_i16 v42, v42, 0
    v_add_f32 v46, v46, v142
    v_add_f32 v47, v47, v143
    v_mul_f32 v120, v46, v117
    v_mul_f32 v121, v47, v117
    v_mul_f32 v120, v120, abs(v46)
    v_mul_f32 v121, v121, abs(v47)
    v_cvt_pk_bf16_f32 v43, v120, v121
    v_pk_max_i16 v43, v43, 0
    buffer_store_dwordx4 v[40:43], v1, s[16:19], s44 offen offset:1024 sc1
    s_waitcnt vmcnt(0)
    s_barrier
    buffer_store_dword v124, v124, s[16:19], s91 offen sc1
    s_add_u32 s91, s91, 65536
    s_waitcnt vmcnt(0)
    s_endpgm
L_spin31:
    s_mov_b32 s40, 0x20000
L_spin31_l:
    buffer_load_dword v56, v124, s[20:23], 0 offen sc1
    s_sub_u32 s40, s40, 1
    s_waitcnt vmcnt(0)
    v_cmp_eq_u32 vcc, v124, v56
    s_cbranch_scc1 L_back32
    s_cbranch_vccz L_back32
    s_sleep 8
    s_branch L_spin31_l
L_spin33:
    s_mov_b32 s40, 0x20000
L_spin33_l:
    buffer_load_dword v7, v5, s[16:19], s45 offen sc1
    s_sub_u32 s40, s40, 1
    s_waitcnt vmcnt(0)
    v_cmp_ne_u32 vcc, 0, v7
    s_cbranch_scc1 L_back34
    s_cbranch_vccz L_back34
    s_sleep 2
    s_branch L_spin33_l
L_spin35:
    s_mov_b32 s40, 0x20000
L_spin35_l:
    buffer_load_dword v7, v5, s[16:19], s45 offen sc1
    s_sub_u32 s40, s40, 1
    s_waitcnt vmcnt(0)
    v_cmp_ne_u32 vcc, 0, v7
    s_cbranch_scc1 L_back36
    s_cbranch_vccz L_back36
    s_sleep 2
    s_branch L_spin35_l
L_sspin37:
    s_mov_b32 s40, 0x20000
L_sspin37_l:
    buffer_load_dwordx2 v[144:145], v6, s[16:19], s46 offen offset:0 sc1
    buffer_load_dwordx2 v[146:147], v6, s[16:19], s46 offen offset:128 sc1
    buffer_load_dwordx2 v[148:149], v6, s[16:19], s46 offen offset:256 sc1
    buffer_load_dwordx2 v[150:151], v6, s[16:19], s46 offen offset:384 sc1
    s_sub_u32 s40, s40, 1
    s_waitcnt vmcnt(0)
    v_max3_u32 v152, v144, v145, v146
    v_max3_u32 v153, v147, v148, v149
    v_max3_u32 v152, v152, v150, v151
    v_max_u32 v152, v152, v153
    v_cmp_eq_u32 vcc, -1, v152
    s_cbranch_scc1 L_sback38
    s_cbranch_vccz L_sback38
    s_sleep 4
    s_branch L_sspin37_l
L_spin39:
    s_mov_b32 s40, 0x20000
L_spin39_l:
    buffer_load_dword v7, v5, s[16:19], s45 offen sc1
    s_sub_u32 s40, s40, 1
    s_waitcnt vmcnt(0)
    v_cmp_ne_u32 vcc, 0, v7
    s_cbranch_scc1 L_back40
    s_cbranch_vccz L_back40
    s_sleep 2
    s_branch L_spin39_l
L_sspin41:
    s_mov_b32 s40, 0x20000
L_sspin41_l:
    buffer_load_dwordx2 v[144:145], v6, s[16:19], s46 offen offset:0 sc1
    buffer_load_dwordx2 v[146:147], v6, s[16:19], s46 offen offset:128 sc1
    buffer_load_dwordx2 v[148:149], v6, s[16:19], s46 offen offset:256 sc1
    buffer_load_dwordx2 v[150:151], v6, s[16:19], s46 offen offset:384 sc1
    s_sub_u32 s40, s40, 1
    s_waitcnt vmcnt(0)
    v_max3_u32 v152, v144, v145, v146
    v_max3_u32 v153, v147, v148, v149
    v_max3_u32 v152, v152, v150, v151
    v_max_u32 v152, v152, v153
    v_cmp_eq_u32 vcc, -1, v152
    s_cbranch_scc1 L_sback42
    s_cbranch_vccz L_sback42
    s_sleep 4
    s_branch L_sspin41_l
L_role_44:
    s_sub_u32 s35, s34, 44
    s_lshl_b32 s50, s33, 4
    s_add_u32 s50, s50, s35
    s_lshl_b32 s50, s50, 1
    s_lshl_b32 s46, s50, 15
    s_lshl_b32 s37, s32, 9
    s_add_u32 s46, s46, s37
    v_lshrrev_b32 v48, 3, v0
    v_and_b32 v49, 0x70, v1
    v_lshl_add_u32 v48, v48, 11, v49
    v_add_u32 v49, 16384, v48
    s_mov_b32 s8, s64
    s_mov_b32 s9, s65
    s_mov_b32 s10, 0x400000
    s_mov_b32 s11, 0x00020000
    buffer_load_dwordx4 v[16:19], v48, s[8:11], s46 offen offset:0
    buffer_load_dwordx4 v[20:23], v48, s[8:11], s46 offen offset:128
    buffer_load_dwordx4 v[24:27], v48, s[8:11], s46 offen offset:256
    buffer_load_dwordx4 v[28:31], v48, s[8:11], s46 offen offset:384
    buffer_load_dwordx4 v[32:35], v49, s[8:11], s46 offen offset:0
    buffer_load_dwordx4 v[36:39], v49, s[8:11], s46 offen offset:128
    buffer_load_dwordx4 v[40:43], v49, s[8:11], s46 offen offset:256
    buffer_load_dwordx4 v[44:47], v49, s[8:11], s46 offen offset:384
    s_xor_b32 s50, s50, 1
    s_lshl_b32 s46, s50, 15
    s_lshl_b32 s37, s32, 9
    s_add_u32 s46, s46, s37
    v_lshrrev_b32 v96, 3, v0
    v_and_b32 v97, 0x70, v1
    v_lshl_add_u32 v96, v96, 11, v97
    v_add_u32 v97, 16384, v96
    s_mov_b32 s8, s64
    s_mov_b32 s9, s65
    s_mov_b32 s10, 0x400000
    s_mov_b32 s11, 0x00020000
    buffer_load_dwordx4 v[64:67], v96, s[8:11], s46 offen offset:0
    buffer_load_dwordx4 v[68:71], v96, s[8:11], s46 offen offset:128
    buffer_load_dwordx4 v[72:75], v96, s[8:11], s46 offen offset:256
    buffer_load_dwordx4 v[76:79], v96, s[8:11], s46 offen offset:384
    buffer_load_dwordx4 v[80:83], v97, s[8:11], s46 offen offset:0
    buffer_load_dwordx4 v[84:87], v97, s[8:11], s46 offen offset:128
    buffer_load_dwordx4 v[88:91], v97, s[8:11], s46 offen offset:256
    buffer_load_dwordx4 v[92:95], v97, s[8:11], s46 offen offset:384
    s_xor_b32 s50, s50, 1
    s_mov_b32 s86, 0x3f803f80
    v_and_b32 v56, 1, v0
    v_lshlrev_b32 v56, 7, v56
    v_bfe_u32 v57, v0, 1, 1
    v_lshl_add_u32 v56, v57, 6, v56
    v_and_b32 v57, 0x38, v0
    v_add_u32 v56, v57, v56
    s_sub_u32 s46, 127, s50
    s_lshl_b32 s46, s46, 10
    s_lshl_b32 s37, s32, 8
    s_add_u32 s46, s46, s37
    s_add_u32 s46, s46, 0x5400000
    s_waitcnt vmcnt(8)
    v_dot2_f32_bf16 v48, v16, s86, 0
    v_dot2_f32_bf16 v49, v16, v16, 0
    v_dot2_f32_bf16 v50, v24, s86, 0
    v_dot2_f32_bf16 v51, v24, v24, 0
    v_dot2_f32_bf16 v52, v32, s86, 0
    v_dot2_f32_bf16 v53, v32, v32, 0
    v_dot2_f32_bf16 v54, v40, s86, 0
    v_dot2_f32_bf16 v55, v40, v40, 0
    v_dot2_f32_bf16 v48, v17, s86, v48
    v_dot2_f32_bf16 v49, v17, v17, v49
    v_dot2_f32_bf16 v50, v25, s86, v50
    v_dot2_f32_bf16 v51, v25, v25, v51
    v_dot2_f32_bf16 v52, v33, s86, v52
    v_dot2_f32_bf16 v53, v33, v33, v53
    v_dot2_f32_bf16 v54, v41, s86, v54
    v_dot2_f32_bf16 v55, v41, v41, v55
    v_dot2_f32_bf16 v48, v18, s86, v48
    v_dot2_f32_bf16 v49, v18, v18, v49
    v_dot2_f32_bf16 v50, v26, s86, v50
    v_dot2_f32_bf16 v51, v26, v26, v51
    v_dot2_f32_bf16 v52, v34, s86, v52
    v_dot2_f32_bf16 v53, v34, v34, v53
    v_dot2_f32_bf16 v54, v42, s86, v54
    v_dot2_f32_bf16 v55, v42, v42, v55
    v_dot2_f32_bf16 v48, v19, s86, v48
    v_dot2_f32_bf16 v49, v19, v19, v49
    v_dot2_f32_bf16 v50, v27, s86, v50
    v_dot2_f32_bf16 v51, v27, v27, v51
    v_dot2_f32_bf16 v52, v35, s86, v52
    v_dot2_f32_bf16 v53, v35, v35, v53
    v_dot2_f32_bf16 v54, v43, s86, v54
    v_dot2_f32_bf16 v55, v43, v43, v55
    v_dot2_f32_bf16 v48, v20, s86, v48
    v_dot2_f32_bf16 v49, v20, v20, v49
    v_dot2_f32_bf16 v50, v28, s86, v50
    v_dot2_f32_bf16 v51, v28, v28, v51
    v_dot2_f32_bf16 v52, v36, s86, v52
    v_dot2_f32_bf16 v53, v36, v36, v53
    v_dot2_f32_bf16 v54, v44, s86, v54
    v_dot2_f32_bf16 v55, v44, v44, v55
    v_dot2_f32_bf16 v48, v21, s86, v48
    v_dot2_f32_bf16 v49, v21, v21, v49
    v_dot2_f32_bf16 v50, v29, s86, v50
    v_dot2_f32_bf16 v51, v29, v29, v51
    v_dot2_f32_bf16 v52, v37, s86, v52
    v_dot2_f32_bf16 v53, v37, v37, v53
    v_dot2_f32_bf16 v54, v45, s86, v54
    v_dot2_f32_bf16 v55, v45, v45, v55
    v_dot2_f32_bf16 v48, v22, s86, v48
    v_dot2_f32_bf16 v49, v22, v22, v49
    v_dot2_f32_bf16 v50, v30, s86, v50
    v_dot2_f32_bf16 v51, v30, v30, v51
    v_dot2_f32_bf16 v52, v38, s86, v52
    v_dot2_f32_bf16 v53, v38, v38, v53
    v_dot2_f32_bf16 v54, v46, s86, v54
    v_dot2_f32_bf16 v55, v46, v46, v55
    v_dot2_f32_bf16 v48, v23, s86, v48
    v_dot2_f32_bf16 v49, v23, v23, v49
    v_dot2_f32_bf16 v50, v31, s86, v50
    v_dot2_f32_bf16 v51, v31, v31, v51
    v_dot2_f32_bf16 v52, v39, s86, v52
    v_dot2_f32_bf16 v53, v39, v39, v53
    v_dot2_f32_bf16 v54, v47, s86, v54
    v_dot2_f32_bf16 v55, v47, v47, v55
    v_add_f32_dpp v48, v48, v48 quad_perm:[1,0,3,2] row_mask:0xf bank_mask:0xf
    v_add_f32_dpp v49, v49, v49 quad_perm:[1,0,3,2] row_mask:0xf bank_mask:0xf
    v_add_f32_dpp v50, v50, v50 quad_perm:[1,0,3,2] row_mask:0xf bank_mask:0xf
    v_add_f32_dpp v51, v51, v51 quad_perm:[1,0,3,2] row_mask:0xf bank_mask:0xf
    v_add_f32_dpp v52, v52, v52 quad_perm:[1,0,3,2] row_mask:0xf bank_mask:0xf
    v_add_f32_dpp v53, v53, v53 quad_perm:[1,0,3,2] row_mask:0xf bank_mask:0xf
    v_add_f32_dpp v54, v54, v54 quad_perm:[1,0,3,2] row_mask:0xf bank_mask:0xf
    v_add_f32_dpp v55, v55, v55 quad_perm:[1,0,3,2] row_mask:0xf bank_mask:0xf
    v_add_f32_dpp v48, v48, v48 quad_perm:[2,3,0,1] row_mask:0xf bank_mask:0xf
    v_add_f32_dpp v49, v49, v49 quad_perm:[2,3,0,1] row_mask:0xf bank_mask:0xf
    v_add_f32_dpp v50, v50, v50 quad_perm:[2,3,0,1] row_mask:0xf bank_mask:0xf
    v_add_f32_dpp v51, v51, v51 quad_perm:[2,3,0,1] row_mask:0xf bank_mask:0xf
    v_add_f32_dpp v52, v52, v52 quad_perm:[2,3,0,1] row_mask:0xf bank_mask:0xf
    v_add_f32_dpp v53, v53, v53 quad_perm:[2,3,0,1] row_mask:0xf bank_mask:0xf
    v_add_f32_dpp v54, v54, v54 quad_perm:[2,3,0,1] row_mask:0xf bank_mask:0xf
    v_add_f32_dpp v55, v55, v55 quad_perm:[2,3,0,1] row_mask:0xf bank_mask:0xf
    v_add_f32_dpp v48, v48, v48 row_half_mirror row_mask:0xf bank_mask:0xf
    v_add_f32_dpp v49, v49, v49 row_half_mirror row_mask:0xf bank_mask:0xf
    v_add_f32_dpp v50, v50, v50 row_half_mirror row_mask:0xf bank_mask:0xf
    v_add_f32_dpp v51, v51, v51 row_half_mirror row_mask:0xf bank_mask:0xf
    v_add_f32_dpp v52, v52, v52 row_half_mirror row_mask:0xf bank_mask:0xf
    v_add_f32_dpp v53, v53, v53 row_half_mirror row_mask:0xf bank_mask:0xf
    v_add_f32_dpp v54, v54, v54 row_half_mirror row_mask:0xf bank_mask:0xf
    v_add_f32_dpp v55, v55, v55 row_half_mirror row_mask:0xf bank_mask:0xf
    s_mov_b32 exec_lo, 0x2020202
    s_mov_b32 exec_hi, 0x2020202
    v_mov_b32 v48, v50
    v_mov_b32 v49, v51
    s_mov_b32 exec_lo, 0x4040404
    s_mov_b32 exec_hi, 0x4040404
    v_mov_b32 v48, v52
    v_mov_b32 v49, v53
    s_mov_b32 exec_lo, 0x8080808
    s_mov_b32 exec_hi, 0x8080808
    v_mov_b32 v48, v54
    v_mov_b32 v49, v55
    s_mov_b32 exec_lo, 0x0f0f0f0f
    s_mov_b32 exec_hi, 0x0f0f0f0f
    buffer_store_dwordx2 v[48:49], v56, s[16:19], s46 offen sc1
    s_mov_b64 exec, -1
    s_xor_b32 s50, s50, 1
    s_mov_b32 s86, 0x3f803f80
    v_and_b32 v104, 1, v0
    v_lshlrev_b32 v104, 7, v104
    v_bfe_u32 v105, v0, 1, 1
    v_lshl_add_u32 v104, v105, 6, v104
    v_and_b32 v105, 0x38, v0
    v_add_u32 v104, v105, v104
    s_sub_u32 s46, 127, s50
    s_lshl_b32 s46, s46, 10
    s_lshl_b32 s37, s32, 8
    s_add_u32 s46, s46, s37
    s_add_u32 s46, s46, 0x5400000
    s_waitcnt vmcnt(1)
    v_dot2_f32_bf16 v96, v64, s86, 0
    v_dot2_f32_bf16 v97, v64, v64, 0
    v_dot2_f32_bf16 v98, v72, s86, 0
    v_dot2_f32_bf16 v99, v72, v72, 0
    v_dot2_f32_bf16 v100, v80, s86, 0
    v_dot2_f32_bf16 v101, v80, v80, 0
    v_dot2_f32_bf16 v102, v88, s86, 0
    v_dot2_f32_bf16 v103, v88, v88, 0
    v_dot2_f32_bf16 v96, v65, s86, v96
    v_dot2_f32_bf16 v97, v65, v65, v97
    v_dot2_f32_bf16 v98, v73, s86, v98
    v_dot2_f32_bf16 v99, v73, v73, v99
    v_dot2_f32_bf16 v100, v81, s86, v100
    v_dot2_f32_bf16 v101, v81, v81, v101
    v_dot2_f32_bf16 v102, v89, s86, v102
    v_dot2_f32_bf16 v103, v89, v89, v103
    v_dot2_f32_bf16 v96, v66, s86, v96
    v_dot2_f32_bf16 v97, v66, v66, v97
    v_dot2_f32_bf16 v98, v74, s86, v98
    v_dot2_f32_bf16 v99, v74, v74, v99
    v_dot2_f32_bf16 v100, v82, s86, v100
    v_dot2_f32_bf16 v101, v82, v82, v101
    v_dot2_f32_bf16 v102, v90, s86, v102
    v_dot2_f32_bf16 v103, v90, v90, v103
    v_dot2_f32_bf16 v96, v67, s86, v96
    v_dot2_f32_bf16 v97, v67, v67, v97
    v_dot2_f32_bf16 v98, v75, s86, v98
    v_dot2_f32_bf16 v99, v75, v75, v99
    v_dot2_f32_bf16 v100, v83, s86, v100
    v_dot2_f32_bf16 v101, v83, v83, v101
    v_dot2_f32_bf16 v102, v91, s86, v102
    v_dot2_f32_bf16 v103, v91, v91, v103
    v_dot2_f32_bf16 v96, v68, s86, v96
    v_dot2_f32_bf16 v97, v68, v68, v97
    v_dot2_f32_bf16 v98, v76, s86, v98
    v_dot2_f32_bf16 v99, v76, v76, v99
    v_dot2_f32_bf16 v100, v84, s86, v100
    v_dot2_f32_bf16 v101, v84, v84, v101
    v_dot2_f32_bf16 v102, v92, s86, v102
    v_dot2_f32_bf16 v103, v92, v92, v103
    v_dot2_f32_bf16 v96, v69, s86, v96
    v_dot2_f32_bf16 v97, v69, v69, v97
    v_dot2_f32_bf16 v98, v77, s86, v98
    v_dot2_f32_bf16 v99, v77, v77, v99
    v_dot2_f32_bf16 v100, v85, s86, v100
    v_dot2_f32_bf16 v101, v85, v85, v101
    v_dot2_f32_bf16 v102, v93, s86, v102
    v_dot2_f32_bf16 v103, v93, v93, v103
    v_dot2_f32_bf16 v96, v70, s86, v96
    v_dot2_f32_bf16 v97, v70, v70, v97
    v_dot2_f32_bf16 v98, v78, s86, v98
    v_dot2_f32_bf16 v99, v78, v78, v99
    v_dot2_f32_bf16 v100, v86, s86, v100
    v_dot2_f32_bf16 v101, v86, v86, v101
    v_dot2_f32_bf16 v102, v94, s86, v102
    v_dot2_f32_bf16 v103, v94, v94, v103
    v_dot2_f32_bf16 v96, v71, s86, v96
    v_dot2_f32_bf16 v97, v71, v71, v97
    v_dot2_f32_bf16 v98, v79, s86, v98
    v_dot2_f32_bf16 v99, v79, v79, v99
    v_dot2_f32_bf16 v100, v87, s86, v100
    v_dot2_f32_bf16 v101, v87, v87, v101
    v_dot2_f32_bf16 v102, v95, s86, v102
    v_dot2_f32_bf16 v103, v95, v95, v103
    v_add_f32_dpp v96, v96, v96 quad_perm:[1,0,3,2] row_mask:0xf bank_mask:0xf
    v_add_f32_dpp v97, v97, v97 quad_perm:[1,0,3,2] row_mask:0xf bank_mask:0xf
    v_add_f32_dpp v98, v98, v98 quad_perm:[1,0,3,2] row_mask:0xf bank_mask:0xf
    v_add_f32_dpp v99, v99, v99 quad_perm:[1,0,3,2] row_mask:0xf bank_mask:0xf
    v_add_f32_dpp v100, v100, v100 quad_perm:[1,0,3,2] row_mask:0xf bank_mask:0xf
    v_add_f32_dpp v101, v101, v101 quad_perm:[1,0,3,2] row_mask:0xf bank_mask:0xf
    v_add_f32_dpp v102, v102, v102 quad_perm:[1,0,3,2] row_mask:0xf bank_mask:0xf
    v_add_f32_dpp v103, v103, v103 quad_perm:[1,0,3,2] row_mask:0xf bank_mask:0xf
    v_add_f32_dpp v96, v96, v96 quad_perm:[2,3,0,1] row_mask:0xf bank_mask:0xf
    v_add_f32_dpp v97, v97, v97 quad_perm:[2,3,0,1] row_mask:0xf bank_mask:0xf
    v_add_f32_dpp v98, v98, v98 quad_perm:[2,3,0,1] row_mask:0xf bank_mask:0xf
    v_add_f32_dpp v99, v99, v99 quad_perm:[2,3,0,1] row_mask:0xf bank_mask:0xf
    v_add_f32_dpp v100, v100, v100 quad_perm:[2,3,0,1] row_mask:0xf bank_mask:0xf
    v_add_f32_dpp v101, v101, v101 quad_perm:[2,3,0,1] row_mask:0xf bank_mask:0xf
    v_add_f32_dpp v102, v102, v102 quad_perm:[2,3,0,1] row_mask:0xf bank_mask:0xf
    v_add_f32_dpp v103, v103, v103 quad_perm:[2,3,0,1] row_mask:0xf bank_mask:0xf
    v_add_f32_dpp v96, v96, v96 row_half_mirror row_mask:0xf bank_mask:0xf
    v_add_f32_dpp v97, v97, v97 row_half_mirror row_mask:0xf bank_mask:0xf
    v_add_f32_dpp v98, v98, v98 row_half_mirror row_mask:0xf bank_mask:0xf
    v_add_f32_dpp v99, v99, v99 row_half_mirror row_mask:0xf bank_mask:0xf
    v_add_f32_dpp v100, v100, v100 row_half_mirror row_mask:0xf bank_mask:0xf
    v_add_f32_dpp v101, v101, v101 row_half_mirror row_mask:0xf bank_mask:0xf
    v_add_f32_dpp v102, v102, v102 row_half_mirror row_mask:0xf bank_mask:0xf
    v_add_f32_dpp v103, v103, v103 row_half_mirror row_mask:0xf bank_mask:0xf
    s_mov_b32 exec_lo, 0x2020202
    s_mov_b32 exec_hi, 0x2020202
    v_mov_b32 v96, v98
    v_mov_b32 v97, v99
    s_mov_b32 exec_lo, 0x4040404
    s_mov_b32 exec_hi, 0x4040404
    v_mov_b32 v96, v100
    v_mov_b32 v97, v101
    s_mov_b32 exec_lo, 0x8080808
    s_mov_b32 exec_hi, 0x8080808
    v_mov_b32 v96, v102
    v_mov_b32 v97, v103
    s_mov_b32 exec_lo, 0x0f0f0f0f
    s_mov_b32 exec_hi, 0x0f0f0f0f
    buffer_store_dwordx2 v[96:97], v104, s[16:19], s46 offen sc1
    s_mov_b64 exec, -1
    s_xor_b32 s50, s50, 1
    s_cmp_lg_u32 s32, 0
    s_cbranch_scc1 L_arv43
    s_add_u32 s20, s82, 0x80
    s_addc_u32 s21, s83, 0
    s_mov_b32 s22, 0x4
    s_mov_b32 s23, 0x00020000
    buffer_load_dword v8, v124, s[20:23], 0 offen sc1
    s_waitcnt vmcnt(0)
    v_cmp_eq_u32 vcc, v124, v8
    s_cbranch_vccnz L_spin44
L_back45:
L_arv43:
    s_waitcnt vmcnt(0)
    s_barrier
    s_add_u32 s39, s91, 32768
    buffer_store_dword v124, v124, s[16:19], s39 offen sc1
    s_lshr_b32 s51, s35, 2
    s_and_b32 s87, s35, 3
    s_mul_i32 s54, s51, 1441792
    s_lshl_b32 s37, s87, 9
    s_add_u32 s54, s54, s37
    s_mov_b32 s12, s76
    s_mov_b32 s13, s77
    s_mov_b32 s14, 0x700000
    s_mov_b32 s15, 0x00020000
    s_mov_b32 s39, 2048
    s_cmp_lg_u32 s32, 0
    s_cbranch_scc1 L_arv46
    s_add_u32 s20, s82, 0x80
    s_addc_u32 s21, s83, 0
    s_mov_b32 s22, 0x4
    s_mov_b32 s23, 0x00020000
    buffer_load_dword v48, v124, s[20:23], 0 offen sc1
    s_waitcnt vmcnt(0)
    v_cmp_eq_u32 vcc, v124, v48
    s_cbranch_vccnz L_spin47
L_back48:
L_arv46:
    s_and_b32 s38, s34, 15
    s_lshl_b32 s37, s33, 6
    s_add_u32 s37, s37, s38
    s_lshl_b32 s37, s37, 7
    v_lshl_add_u32 v48, v0, 7, s37
    s_cmp_eq_u32 s32, 0
    s_cselect_b32 s37, 1, 0
    v_cmp_le_u32 vcc, s37, v0
    s_nop 1
    v_cndmask_b32 v48, v48, 2.0, vcc
    s_mov_b32 s38, 0x5520000
    buffer_load_dword v49, v48, s[16:19], s38 offen sc1
    s_waitcnt vmcnt(0)
    v_cmp_ne_u32 vcc, 0, v49
    s_cbranch_vccnz L_spin49
L_back50:
    s_barrier
    v_lshrrev_b32 v64, 3, v0
    v_lshlrev_b32 v65, 2, v0
    v_and_b32 v65, 64, v65
    v_and_b32 v66, 0x70, v1
    v_xor_b32 v65, v65, v66
    v_mad_u32_u24 v48, v64, s39, v65
    v_add_u32 v49, 16384, v48
    v_add_u32 v50, 128, v48
    v_add_u32 v51, 16512, v48
    v_add_u32 v52, 256, v48
    v_add_u32 v53, 16640, v48
    v_add_u32 v54, 384, v48
    v_add_u32 v55, 16768, v48
    s_mul_i32 s38, s32, 32768
    s_add_u32 s54, s54, s38
    s_lshl_b32 s42, s32, 11
    s_add_u32 m0, s42, 0
    s_nop 0
    buffer_load_dwordx4 v48, s[12:15], s54 offen lds
    s_add_u32 m0, s42, 1024
    s_nop 0
    buffer_load_dwordx4 v49, s[12:15], s54 offen lds
    s_add_u32 m0, s42, 8192
    s_nop 0
    buffer_load_dwordx4 v50, s[12:15], s54 offen lds
    s_add_u32 m0, s42, 9216
    s_nop 0
    buffer_load_dwordx4 v51, s[12:15], s54 offen lds
    s_add_u32 m0, s42, 16384
    s_nop 0
    buffer_load_dwordx4 v52, s[12:15], s54 offen lds
    s_add_u32 m0, s42, 17408
    s_nop 0
    buffer_load_dwordx4 v53, s[12:15], s54 offen lds
    s_add_u32 m0, s42, 24576
    s_nop 0
    buffer_load_dwordx4 v54, s[12:15], s54 offen lds
    s_add_u32 m0, s42, 25600
    s_nop 0
    buffer_load_dwordx4 v55, s[12:15], s54 offen lds
    s_add_u32 s54, s54, 131072
    s_add_u32 m0, s42, 32768
    s_nop 0
    buffer_load_dwordx4 v48, s[12:15], s54 offen lds
    s_add_u32 m0, s42, 33792
    s_nop 0
    buffer_load_dwordx4 v49, s[12:15], s54 offen lds
    s_add_u32 m0, s42, 40960
    s_nop 0
    buffer_load_dwordx4 v50, s[12:15], s54 offen lds
    s_add_u32 m0, s42, 41984
    s_nop 0
    buffer_load_dwordx4 v51, s[12:15], s54 offen lds
    s_add_u32 m0, s42, 49152
    s_nop 0
    buffer_load_dwordx4 v52, s[12:15], s54 offen lds
    s_add_u32 m0, s42, 50176
    s_nop 0
    buffer_load_dwordx4 v53, s[12:15], s54 offen lds
    s_add_u32 m0, s42, 57344
    s_nop 0
    buffer_load_dwordx4 v54, s[12:15], s54 offen lds
    s_add_u32 m0, s42, 58368
    s_nop 0
    buffer_load_dwordx4 v55, s[12:15], s54 offen lds
    s_add_u32 s54, s54, 131072
    s_add_u32 m0, s42, 65536
    s_nop 0
    buffer_load_dwordx4 v48, s[12:15], s54 offen lds
    s_add_u32 m0, s42, 66560
    s_nop 0
    buffer_load_dwordx4 v49, s[12:15], s54 offen lds
    s_add_u32 m0, s42, 73728
    s_nop 0
    buffer_load_dwordx4 v50, s[12:15], s54 offen lds
    s_add_u32 m0, s42, 74752
    s_nop 0
    buffer_load_dwordx4 v51, s[12:15], s54 offen lds
    s_add_u32 m0, s42, 81920
    s_nop 0
    buffer_load_dwordx4 v52, s[12:15], s54 offen lds
    s_add_u32 m0, s42, 82944
    s_nop 0
    buffer_load_dwordx4 v53, s[12:15], s54 offen lds
    s_add_u32 m0, s42, 90112
    s_nop 0
    buffer_load_dwordx4 v54, s[12:15], s54 offen lds
    s_add_u32 m0, s42, 91136
    s_nop 0
    buffer_load_dwordx4 v55, s[12:15], s54 offen lds
    s_add_u32 s54, s54, 131072
    s_add_u32 m0, s42, 98304
    s_nop 0
    buffer_load_dwordx4 v48, s[12:15], s54 offen lds
    s_add_u32 m0, s42, 99328
    s_nop 0
    buffer_load_dwordx4 v49, s[12:15], s54 offen lds
    s_add_u32 m0, s42, 106496
    s_nop 0
    buffer_load_dwordx4 v50, s[12:15], s54 offen lds
    s_add_u32 m0, s42, 107520
    s_nop 0
    buffer_load_dwordx4 v51, s[12:15], s54 offen lds
    s_add_u32 m0, s42, 114688
    s_nop 0
    buffer_load_dwordx4 v52, s[12:15], s54 offen lds
    s_add_u32 m0, s42, 115712
    s_nop 0
    buffer_load_dwordx4 v53, s[12:15], s54 offen lds
    s_add_u32 m0, s42, 122880
    s_nop 0
    buffer_load_dwordx4 v54, s[12:15], s54 offen lds
    s_add_u32 m0, s42, 123904
    s_nop 0
    buffer_load_dwordx4 v55, s[12:15], s54 offen lds
    s_add_u32 s54, s54, 131072
    v_lshrrev_b32 v64, 4, v0
    v_bfe_u32 v65, v0, 2, 2
    v_lshl_add_u32 v64, v64, 3, v65
    v_lshlrev_b32 v64, 7, v64
    v_lshrrev_b32 v65, 1, v65
    v_lshl_add_u32 v64, v65, 6, v64
    v_and_b32 v65, 3, v0
    v_lshl_add_u32 v64, v65, 4, v64
    s_lshl_b32 s37, s32, 13
    s_and_b32 s38, s51, 2
    s_lshl_b32 s38, s38, 5
    s_xor_b32 s38, s38, 0
    s_add_u32 s37, s37, s38
    v_xor_b32 v56, s37, v64
    s_lshl_b32 s37, s32, 13
    s_and_b32 s38, s51, 2
    s_lshl_b32 s38, s38, 5
    s_xor_b32 s38, s38, 8
    s_add_u32 s37, s37, s38
    v_xor_b32 v57, s37, v64
    s_lshl_b32 s37, s32, 13
    s_and_b32 s38, s51, 2
    s_lshl_b32 s38, s38, 5
    s_xor_b32 s38, s38, 64
    s_add_u32 s37, s37, s38
    v_xor_b32 v58, s37, v64
    s_lshl_b32 s37, s32, 13
    s_and_b32 s38, s51, 2
    s_lshl_b32 s38, s38, 5
    s_xor_b32 s38, s38, 72
    s_add_u32 s37, s37, s38
    v_xor_b32 v59, s37, v64
    s_and_b32 s39, s51, 1
    s_lshl_b32 s37, s39, 10
    v_add_u32 v2, s37, v1
    v_xor_b32 v3, 1024, v2
    v_add_u32 v4, 98304, v2
    v_add_u32 v5, 98304, v3
    s_mul_i32 s38, s51, 11*43
    s_lshr_b32 s38, s38, 7
    s_add_u32 s38, s38, 24
    s_lshl_b32 s37, s33, 6
    s_add_u32 s37, s37, s38
    s_lshl_b32 s37, s37, 7
    v_lshl_add_u32 v6, v0, 7, s37
    s_cmp_eq_u32 s32, 0
    s_cselect_b32 s37, 5, 0
    v_cmp_le_u32 vcc, s37, v0
    s_nop 1
    v_cndmask_b32 v6, v6, 2.0, vcc
    s_mul_i32 s43, s32, 3072
    s_lshl_b32 s88, s32, 11
    s_sub_u32 s89, s88, s43
    s_mul_i32 s41, s33, 8388608
    s_add_u32 s41, s41, 0x1000000
    s_mul_i32 s37, s51, 45056
    s_add_u32 s41, s41, s37
    s_add_u32 s41, s41, s43
    s_mul_i32 s90, s33, 8388608
    s_add_u32 s90, s90, 0x2fc0000
    s_lshl_b32 s37, s87, 16
    s_add_u32 s90, s90, s37
    s_lshl_b32 s37, s32, 12
    s_add_u32 s90, s90, s37
    s_and_b32 s37, s51, 3
    s_lshl_b32 s37, s37, 14
    s_add_u32 s90, s90, s37
    v_mov_b32 v104, 0
    v_mov_b32 v105, 0
    v_mov_b32 v106, 0
    v_mov_b32 v107, 0
    v_mov_b32 v108, 0
    v_mov_b32 v109, 0
    v_mov_b32 v110, 0
    v_mov_b32 v111, 0
    v_mov_b32 v17, 0x3f80
    v_and_b32 v16, 1, v0
    v_lshlrev_b32 v16, 4, v16
    v_lshlrev_b32 v16, v16, v17
    s_mov_b32 exec_lo, 0x300003
    s_mov_b32 exec_hi, 0x30000300
    v_mov_b32 v104, v16
    v_mov_b32 v110, v16
    s_mov_b32 exec_lo, 0xc0000c
    s_mov_b32 exec_hi, 0xc0000c00
    v_mov_b32 v105, v16
    v_mov_b32 v111, v16
    s_mov_b64 exec, -1
    s_add_u32 s38, s87, 44
    s_lshl_b32 s37, s33, 6
    s_add_u32 s37, s37, s38
    s_lshl_b32 s37, s37, 7
    v_lshl_add_u32 v8, v0, 9, s37
    s_cmp_eq_u32 s32, 0
    s_cselect_b32 s37, 5, 0
    v_cmp_le_u32 vcc, s37, v0
    s_nop 1
    v_cndmask_b32 v8, v8, 2.0, vcc
    s_lshl_b32 s38, s87, 2
    s_add_u32 s38, s38, s32
    s_lshl_b32 s38, s38, 1
    s_lshr_b32 s37, s51, 1
    s_add_u32 s38, s38, s37
    s_mul_i32 s53, s33, 2097152
    s_add_u32 s53, s53, 0x7f0000
    s_lshl_b32 s37, s38, 11
    s_add_u32 s53, s53, s37
    s_lshl_b32 s37, s39, 10
    s_add_u32 s53, s53, s37
    v_and_b32 v16, 15, v0
    v_and_b32 v17, 0x30, v0
    s_lshl_b32 s38, s38, 6
    s_mov_b32 s8, s78
    s_mov_b32 s9, s79
    s_mov_b32 s10, 0x800
    s_mov_b32 s11, 0x00020000
    buffer_load_dwordx4 v[24:27], v17, s[8:11], s38 offen
    v_lshl_add_u32 v9, v16, 11, v17
    v_add_u32 v9, s38, v9
    s_lshl_b32 s50, s33, 5
    s_add_u32 s50, s50, 31
    s_sub_u32 s50, s50, s39
    v_bfe_u32 v17, v0, 4, 1
    v_lshl_add_u32 v16, v16, 1, v17
    s_lshl_b32 s37, s32, 2
    s_add_u32 s37, s37, 65536
    v_lshl_add_u32 v10, v16, 4, s37
    v_and_b32 v16, 31, v0
    v_lshrrev_b32 v12, 5, v0
    v_lshlrev_b32 v12, 30, v12
    v_lshl_add_u32 v12, v16, 2, v12
    v_lshlrev_b32 v16, 4, v16
    v_add_u32 v11, 65536, v16
    s_lshl_b32 s37, s87, 1
    s_lshr_b32 s38, s51, 1
    s_add_u32 s37, s37, s38
    s_lshl_b32 s37, s37, 7
    s_add_u32 s55, s37, 0x543fc00
    s_cmp_eq_u32 s32, 2
    s_cselect_b32 s55, s55, 0x5f00000
    v_add_u32 v60, 0, v56
    v_add_u32 v61, 0, v57
    v_add_u32 v62, 0, v58
    v_add_u32 v63, 0, v59
    s_waitcnt vmcnt(25)
    s_barrier
    ds_read_b64_tr_b16 a[0:1], v60 offset:0
    ds_read_b64_tr_b16 a[2:3], v60 offset:512
    ds_read_b64_tr_b16 a[4:5], v61 offset:0
    ds_read_b64_tr_b16 a[6:7], v61 offset:512
    ds_read_b64_tr_b16 a[8:9], v62 offset:0
    ds_read_b64_tr_b16 a[10:11], v62 offset:512
    ds_read_b64_tr_b16 a[12:13], v63 offset:0
    ds_read_b64_tr_b16 a[14:15], v63 offset:512
    ds_read_b64_tr_b16 a[16:17], v60 offset:4096
    ds_read_b64_tr_b16 a[18:19], v60 offset:4608
    ds_read_b64_tr_b16 a[20:21], v61 offset:4096
    ds_read_b64_tr_b16 a[22:23], v61 offset:4608
    ds_read_b64_tr_b16 a[24:25], v62 offset:4096
    ds_read_b64_tr_b16 a[26:27], v62 offset:4608
    ds_read_b64_tr_b16 a[28:29], v63 offset:4096
    ds_read_b64_tr_b16 a[30:31], v63 offset:4608
    s_add_u32 m0, s42, 131072
    s_nop 0
    buffer_load_dwordx4 v48, s[12:15], s54 offen lds
    s_add_u32 m0, s42, 132096
    s_nop 0
    buffer_load_dwordx4 v49, s[12:15], s54 offen lds
    s_add_u32 m0, s42, 139264
    s_nop 0
    buffer_load_dwordx4 v50, s[12:15], s54 offen lds
    s_add_u32 m0, s42, 140288
    s_nop 0
    buffer_load_dwordx4 v51, s[12:15], s54 offen lds
    s_add_u32 m0, s42, 147456
    s_nop 0
    buffer_load_dwordx4 v52, s[12:15], s54 offen lds
    s_add_u32 m0, s42, 148480
    s_nop 0
    buffer_load_dwordx4 v53, s[12:15], s54 offen lds
    s_add_u32 m0, s42, 155648
    s_nop 0
    buffer_load_dwordx4 v54, s[12:15], s54 offen lds
    s_add_u32 m0, s42, 156672
    s_nop 0
    buffer_load_dwordx4 v55, s[12:15], s54 offen lds
    s_add_u32 s54, s54, 131072
    s_waitcnt lgkmcnt(0)
    v_add_u32 v60, 32768, v56
    v_add_u32 v61, 32768, v57
    v_add_u32 v62, 32768, v58
    v_add_u32 v63, 32768, v59
    s_waitcnt vmcnt(25)
    s_barrier
    ds_read_b64_tr_b16 a[32:33], v60 offset:0
    ds_read_b64_tr_b16 a[34:35], v60 offset:512
    ds_read_b64_tr_b16 a[36:37], v61 offset:0
    ds_read_b64_tr_b16 a[38:39], v61 offset:512
    ds_read_b64_tr_b16 a[40:41], v62 offset:0
    ds_read_b64_tr_b16 a[42:43], v62 offset:512
    ds_read_b64_tr_b16 a[44:45], v63 offset:0
    ds_read_b64_tr_b16 a[46:47], v63 offset:512
    ds_read_b64_tr_b16 a[48:49], v60 offset:4096
    ds_read_b64_tr_b16 a[50:51], v60 offset:4608
    ds_read_b64_tr_b16 a[52:53], v61 offset:4096
    ds_read_b64_tr_b16 a[54:55], v61 offset:4608
    ds_read_b64_tr_b16 a[56:57], v62 offset:4096
    ds_read_b64_tr_b16 a[58:59], v62 offset:4608
    ds_read_b64_tr_b16 a[60:61], v63 offset:4096
    ds_read_b64_tr_b16 a[62:63], v63 offset:4608
    s_add_u32 m0, s42, 0
    s_nop 0
    buffer_load_dwordx4 v48, s[12:15], s54 offen lds
    s_add_u32 m0, s42, 1024
    s_nop 0
    buffer_load_dwordx4 v49, s[12:15], s54 offen lds
    s_add_u32 m0, s42, 8192
    s_nop 0
    buffer_load_dwordx4 v50, s[12:15], s54 offen lds
    s_add_u32 m0, s42, 9216
    s_nop 0
    buffer_load_dwordx4 v51, s[12:15], s54 offen lds
    s_add_u32 m0, s42, 16384
    s_nop 0
    buffer_load_dwordx4 v52, s[12:15], s54 offen lds
    s_add_u32 m0, s42, 17408
    s_nop 0
    buffer_load_dwordx4 v53, s[12:15], s54 offen lds
    s_add_u32 m0, s42, 24576
    s_nop 0
    buffer_load_dwordx4 v54, s[12:15], s54 offen lds
    s_add_u32 m0, s42, 25600
    s_nop 0
    buffer_load_dwordx4 v55, s[12:15], s54 offen lds
    s_add_u32 s54, s54, 131072
    s_waitcnt lgkmcnt(0)
    v_add_u32 v60, 65536, v56
    v_add_u32 v61, 65536, v57
    v_add_u32 v62, 65536, v58
    v_add_u32 v63, 65536, v59
    s_waitcnt vmcnt(25)
    s_barrier
    ds_read_b64_tr_b16 a[64:65], v60 offset:0
    ds_read_b64_tr_b16 a[66:67], v60 offset:512
    ds_read_b64_tr_b16 a[68:69], v61 offset:0
    ds_read_b64_tr_b16 a[70:71], v61 offset:512
    ds_read_b64_tr_b16 a[72:73], v62 offset:0
    ds_read_b64_tr_b16 a[74:75], v62 offset:512
    ds_read_b64_tr_b16 a[76:77], v63 offset:0
    ds_read_b64_tr_b16 a[78:79], v63 offset:512
    ds_read_b64_tr_b16 a[80:81], v60 offset:4096
    ds_read_b64_tr_b16 a[82:83], v60 offset:4608
    ds_read_b64_tr_b16 a[84:85], v61 offset:4096
    ds_read_b64_tr_b16 a[86:87], v61 offset:4608
    ds_read_b64_tr_b16 a[88:89], v62 offset:4096
    ds_read_b64_tr_b16 a[90:91], v62 offset:4608
    ds_read_b64_tr_b16 a[92:93], v63 offset:4096
    ds_read_b64_tr_b16 a[94:95], v63 offset:4608
    s_add_u32 m0, s42, 32768
    s_nop 0
    buffer_load_dwordx4 v48, s[12:15], s54 offen lds
    s_add_u32 m0, s42, 33792
    s_nop 0
    buffer_load_dwordx4 v49, s[12:15], s54 offen lds
    s_add_u32 m0, s42, 40960
    s_nop 0
    buffer_load_dwordx4 v50, s[12:15], s54 offen lds
    s_add_u32 m0, s42, 41984
    s_nop 0
    buffer_load_dwordx4 v51, s[12:15], s54 offen lds
    s_add_u32 m0, s42, 49152
    s_nop 0
    buffer_load_dwordx4 v52, s[12:15], s54 offen lds
    s_add_u32 m0, s42, 50176
    s_nop 0
    buffer_load_dwordx4 v53, s[12:15], s54 offen lds
    s_add_u32 m0, s42, 57344
    s_nop 0
    buffer_load_dwordx4 v54, s[12:15], s54 offen lds
    s_add_u32 m0, s42, 58368
    s_nop 0
    buffer_load_dwordx4 v55, s[12:15], s54 offen lds
    s_add_u32 s54, s54, 131072
    s_waitcnt lgkmcnt(0)
    v_add_u32 v60, 98304, v56
    v_add_u32 v61, 98304, v57
    v_add_u32 v62, 98304, v58
    v_add_u32 v63, 98304, v59
    s_waitcnt vmcnt(25)
    s_barrier
    ds_read_b64_tr_b16 a[96:97], v60 offset:0
    ds_read_b64_tr_b16 a[98:99], v60 offset:512
    ds_read_b64_tr_b16 a[100:101], v61 offset:0
    ds_read_b64_tr_b16 a[102:103], v61 offset:512
    ds_read_b64_tr_b16 a[104:105], v62 offset:0
    ds_read_b64_tr_b16 a[106:107], v62 offset:512
    ds_read_b64_tr_b16 a[108:109], v63 offset:0
    ds_read_b64_tr_b16 a[110:111], v63 offset:512
    ds_read_b64_tr_b16 a[112:113], v60 offset:4096
    ds_read_b64_tr_b16 a[114:115], v60 offset:4608
    ds_read_b64_tr_b16 a[116:117], v61 offset:4096
    ds_read_b64_tr_b16 a[118:119], v61 offset:4608
    ds_read_b64_tr_b16 a[120:121], v62 offset:4096
    ds_read_b64_tr_b16 a[122:123], v62 offset:4608
    ds_read_b64_tr_b16 a[124:125], v63 offset:4096
    ds_read_b64_tr_b16 a[126:127], v63 offset:4608
    s_add_u32 m0, s42, 65536
    s_nop 0
    buffer_load_dwordx4 v48, s[12:15], s54 offen lds
    s_add_u32 m0, s42, 66560
    s_nop 0
    buffer_load_dwordx4 v49, s[12:15], s54 offen lds
    s_add_u32 m0, s42, 73728
    s_nop 0
    buffer_load_dwordx4 v50, s[12:15], s54 offen lds
    s_add_u32 m0, s42, 74752
    s_nop 0
    buffer_load_dwordx4 v51, s[12:15], s54 offen lds
    s_add_u32 m0, s42, 81920
    s_nop 0
    buffer_load_dwordx4 v52, s[12:15], s54 offen lds
    s_add_u32 m0, s42, 82944
    s_nop 0
    buffer_load_dwordx4 v53, s[12:15], s54 offen lds
    s_add_u32 m0, s42, 90112
    s_nop 0
    buffer_load_dwordx4 v54, s[12:15], s54 offen lds
    s_add_u32 m0, s42, 91136
    s_nop 0
    buffer_load_dwordx4 v55, s[12:15], s54 offen lds
    s_add_u32 s54, s54, 131072
    s_waitcnt lgkmcnt(0)
    v_add_u32 v60, 131072, v56
    v_add_u32 v61, 131072, v57
    v_add_u32 v62, 131072, v58
    v_add_u32 v63, 131072, v59
    s_waitcnt vmcnt(24)
    s_barrier
    ds_read_b64_tr_b16 a[128:129], v60 offset:0
    ds_read_b64_tr_b16 a[130:131], v60 offset:512
    ds_read_b64_tr_b16 a[132:133], v61 offset:0
    ds_read_b64_tr_b16 a[134:135], v61 offset:512
    ds_read_b64_tr_b16 a[136:137], v62 offset:0
    ds_read_b64_tr_b16 a[138:139], v62 offset:512
    ds_read_b64_tr_b16 a[140:141], v63 offset:0
    ds_read_b64_tr_b16 a[142:143], v63 offset:512
    ds_read_b64_tr_b16 a[144:145], v60 offset:4096
    ds_read_b64_tr_b16 a[146:147], v60 offset:4608
    ds_read_b64_tr_b16 a[148:149], v61 offset:4096
    ds_read_b64_tr_b16 a[150:151], v61 offset:4608
    ds_read_b64_tr_b16 a[152:153], v62 offset:4096
    ds_read_b64_tr_b16 a[154:155], v62 offset:4608
    ds_read_b64_tr_b16 a[156:157], v63 offset:4096
    ds_read_b64_tr_b16 a[158:159], v63 offset:4608
    s_add_u32 m0, s42, 98304
    s_nop 0
    buffer_load_dwordx4 v48, s[12:15], s54 offen lds
    s_add_u32 m0, s42, 99328
    s_nop 0
    buffer_load_dwordx4 v49, s[12:15], s54 offen lds
    s_add_u32 m0, s42, 106496
    s_nop 0
    buffer_load_dwordx4 v50, s[12:15], s54 offen lds
    s_add_u32 m0, s42, 107520
    s_nop 0
    buffer_load_dwordx4 v51, s[12:15], s54 offen lds
    s_add_u32 m0, s42, 114688
    s_nop 0
    buffer_load_dwordx4 v52, s[12:15], s54 offen lds
    s_add_u32 m0, s42, 115712
    s_nop 0
    buffer_load_dwordx4 v53, s[12:15], s54 offen lds
    s_add_u32 m0, s42, 122880
    s_nop 0
    buffer_load_dwordx4 v54, s[12:15], s54 offen lds
    s_add_u32 m0, s42, 123904
    s_nop 0
    buffer_load_dwordx4 v55, s[12:15], s54 offen lds
    s_add_u32 s54, s54, 131072
    s_waitcnt lgkmcnt(0)
    v_add_u32 v60, 0, v56
    v_add_u32 v61, 0, v57
    v_add_u32 v62, 0, v58
    v_add_u32 v63, 0, v59
    s_waitcnt vmcnt(24)
    s_barrier
    ds_read_b64_tr_b16 a[160:161], v60 offset:0
    ds_read_b64_tr_b16 a[162:163], v60 offset:512
    ds_read_b64_tr_b16 a[164:165], v61 offset:0
    ds_read_b64_tr_b16 a[166:167], v61 offset:512
    ds_read_b64_tr_b16 a[168:169], v62 offset:0
    ds_read_b64_tr_b16 a[170:171], v62 offset:512
    ds_read_b64_tr_b16 a[172:173], v63 offset:0
    ds_read_b64_tr_b16 a[174:175], v63 offset:512
    ds_read_b64_tr_b16 a[176:177], v60 offset:4096
    ds_read_b64_tr_b16 a[178:179], v60 offset:4608
    ds_read_b64_tr_b16 a[180:181], v61 offset:4096
    ds_read_b64_tr_b16 a[182:183], v61 offset:4608
    ds_read_b64_tr_b16 a[184:185], v62 offset:4096
    ds_read_b64_tr_b16 a[186:187], v62 offset:4608
    ds_read_b64_tr_b16 a[188:189], v63 offset:4096
    ds_read_b64_tr_b16 a[190:191], v63 offset:4608
    s_add_u32 m0, s42, 131072
    s_nop 0
    buffer_load_dwordx4 v48, s[12:15], s54 offen lds
    s_add_u32 m0, s42, 132096
    s_nop 0
    buffer_load_dwordx4 v49, s[12:15], s54 offen lds
    s_add_u32 m0, s42, 139264
    s_nop 0
    buffer_load_dwordx4 v50, s[12:15], s54 offen lds
    s_add_u32 m0, s42, 140288
    s_nop 0
    buffer_load_dwordx4 v51, s[12:15], s54 offen lds
    s_add_u32 m0, s42, 147456
    s_nop 0
    buffer_load_dwordx4 v52, s[12:15], s54 offen lds
    s_add_u32 m0, s42, 148480
    s_nop 0
    buffer_load_dwordx4 v53, s[12:15], s54 offen lds
    s_add_u32 m0, s42, 155648
    s_nop 0
    buffer_load_dwordx4 v54, s[12:15], s54 offen lds
    s_add_u32 m0, s42, 156672
    s_nop 0
    buffer_load_dwordx4 v55, s[12:15], s54 offen lds
    s_add_u32 s54, s54, 131072
    s_waitcnt lgkmcnt(0)
    v_add_u32 v60, 32768, v56
    v_add_u32 v61, 32768, v57
    v_add_u32 v62, 32768, v58
    v_add_u32 v63, 32768, v59
    s_waitcnt vmcnt(24)
    s_barrier
    ds_read_b64_tr_b16 a[192:193], v60 offset:0
    ds_read_b64_tr_b16 a[194:195], v60 offset:512
    ds_read_b64_tr_b16 a[196:197], v61 offset:0
    ds_read_b64_tr_b16 a[198:199], v61 offset:512
    ds_read_b64_tr_b16 a[200:201], v62 offset:0
    ds_read_b64_tr_b16 a[202:203], v62 offset:512
    ds_read_b64_tr_b16 a[204:205], v63 offset:0
    ds_read_b64_tr_b16 a[206:207], v63 offset:512
    ds_read_b64_tr_b16 a[208:209], v60 offset:4096
    ds_read_b64_tr_b16 a[210:211], v60 offset:4608
    ds_read_b64_tr_b16 a[212:213], v61 offset:4096
    ds_read_b64_tr_b16 a[214:215], v61 offset:4608
    ds_read_b64_tr_b16 a[216:217], v62 offset:4096
    ds_read_b64_tr_b16 a[218:219], v62 offset:4608
    ds_read_b64_tr_b16 a[220:221], v63 offset:4096
    ds_read_b64_tr_b16 a[222:223], v63 offset:4608
    s_add_u32 m0, s42, 0
    s_nop 0
    buffer_load_dwordx4 v48, s[12:15], s54 offen lds
    s_add_u32 m0, s42, 1024
    s_nop 0
    buffer_load_dwordx4 v49, s[12:15], s54 offen lds
    s_add_u32 m0, s42, 8192
    s_nop 0
    buffer_load_dwordx4 v50, s[12:15], s54 offen lds
    s_add_u32 m0, s42, 9216
    s_nop 0
    buffer_load_dwordx4 v51, s[12:15], s54 offen lds
    s_add_u32 m0, s42, 16384
    s_nop 0
    buffer_load_dwordx4 v52, s[12:15], s54 offen lds
    s_add_u32 m0, s42, 17408
    s_nop 0
    buffer_load_dwordx4 v53, s[12:15], s54 offen lds
    s_add_u32 m0, s42, 24576
    s_nop 0
    buffer_load_dwordx4 v54, s[12:15], s54 offen lds
    s_add_u32 m0, s42, 25600
    s_nop 0
    buffer_load_dwordx4 v55, s[12:15], s54 offen lds
    s_add_u32 s54, s54, 131072
    s_waitcnt lgkmcnt(0)
    v_add_u32 v60, 65536, v56
    v_add_u32 v61, 65536, v57
    v_add_u32 v62, 65536, v58
    v_add_u32 v63, 65536, v59
    s_waitcnt vmcnt(24)
    s_barrier
    ds_read_b64_tr_b16 a[224:225], v60 offset:0
    ds_read_b64_tr_b16 a[226:227], v60 offset:512
    ds_read_b64_tr_b16 a[228:229], v61 offset:0
    ds_read_b64_tr_b16 a[230:231], v61 offset:512
    ds_read_b64_tr_b16 a[232:233], v62 offset:0
    ds_read_b64_tr_b16 a[234:235], v62 offset:512
    ds_read_b64_tr_b16 a[236:237], v63 offset:0
    ds_read_b64_tr_b16 a[238:239], v63 offset:512
    ds_read_b64_tr_b16 a[240:241], v60 offset:4096
    ds_read_b64_tr_b16 a[242:243], v60 offset:4608
    ds_read_b64_tr_b16 a[244:245], v61 offset:4096
    ds_read_b64_tr_b16 a[246:247], v61 offset:4608
    ds_read_b64_tr_b16 a[248:249], v62 offset:4096
    ds_read_b64_tr_b16 a[250:251], v62 offset:4608
    ds_read_b64_tr_b16 a[252:253], v63 offset:4096
    ds_read_b64_tr_b16 a[254:255], v63 offset:4608
    s_waitcnt lgkmcnt(0)
    v_add_u32 v60, 98304, v56
    v_add_u32 v61, 98304, v57
    v_add_u32 v62, 98304, v58
    v_add_u32 v63, 98304, v59
    s_waitcnt vmcnt(16)
    s_barrier
    ds_read_b64_tr_b16 v[160:161], v60 offset:0
    ds_read_b64_tr_b16 v[162:163], v60 offset:512
    ds_read_b64_tr_b16 v[164:165], v61 offset:0
    ds_read_b64_tr_b16 v[166:167], v61 offset:512
    ds_read_b64_tr_b16 v[168:169], v62 offset:0
    ds_read_b64_tr_b16 v[170:171], v62 offset:512
    ds_read_b64_tr_b16 v[172:173], v63 offset:0
    ds_read_b64_tr_b16 v[174:175], v63 offset:512
    ds_read_b64_tr_b16 v[176:177], v60 offset:4096
    ds_read_b64_tr_b16 v[178:179], v60 offset:4608
    ds_read_b64_tr_b16 v[180:181], v61 offset:4096
    ds_read_b64_tr_b16 v[182:183], v61 offset:4608
    ds_read_b64_tr_b16 v[184:185], v62 offset:4096
    ds_read_b64_tr_b16 v[186:187], v62 offset:4608
    ds_read_b64_tr_b16 v[188:189], v63 offset:4096
    ds_read_b64_tr_b16 v[190:191], v63 offset:4608
    s_waitcnt lgkmcnt(0)
    v_add_u32 v60, 131072, v56
    v_add_u32 v61, 131072, v57
    v_add_u32 v62, 131072, v58
    v_add_u32 v63, 131072, v59
    s_waitcnt vmcnt(8)
    s_barrier
    ds_read_b64_tr_b16 v[192:193], v60 offset:0
    ds_read_b64_tr_b16 v[194:195], v60 offset:512
    ds_read_b64_tr_b16 v[196:197], v61 offset:0
    ds_read_b64_tr_b16 v[198:199], v61 offset:512
    ds_read_b64_tr_b16 v[200:201], v62 offset:0
    ds_read_b64_tr_b16 v[202:203], v62 offset:512
    ds_read_b64_tr_b16 v[204:205], v63 offset:0
    ds_read_b64_tr_b16 v[206:207], v63 offset:512
    ds_read_b64_tr_b16 v[208:209], v60 offset:4096
    ds_read_b64_tr_b16 v[210:211], v60 offset:4608
    ds_read_b64_tr_b16 v[212:213], v61 offset:4096
    ds_read_b64_tr_b16 v[214:215], v61 offset:4608
    ds_read_b64_tr_b16 v[216:217], v62 offset:4096
    ds_read_b64_tr_b16 v[218:219], v62 offset:4608
    ds_read_b64_tr_b16 v[220:221], v63 offset:4096
    ds_read_b64_tr_b16 v[222:223], v63 offset:4608
    s_waitcnt lgkmcnt(0)
    v_add_u32 v60, 0, v56
    v_add_u32 v61, 0, v57
    v_add_u32 v62, 0, v58
    v_add_u32 v63, 0, v59
    s_waitcnt vmcnt(0)
    s_barrier
    ds_read_b64_tr_b16 v[224:225], v60 offset:0
    ds_read_b64_tr_b16 v[226:227], v60 offset:512
    ds_read_b64_tr_b16 v[228:229], v61 offset:0
    ds_read_b64_tr_b16 v[230:231], v61 offset:512
    ds_read_b64_tr_b16 v[232:233], v62 offset:0
    ds_read_b64_tr_b16 v[234:235], v62 offset:512
    ds_read_b64_tr_b16 v[236:237], v63 offset:0
    ds_read_b64_tr_b16 v[238:239], v63 offset:512
    ds_read_b64_tr_b16 v[240:241], v60 offset:4096
    ds_read_b64_tr_b16 v[242:243], v60 offset:4608
    ds_read_b64_tr_b16 v[244:245], v61 offset:4096
    ds_read_b64_tr_b16 v[246:247], v61 offset:4608
    ds_read_b64_tr_b16 v[248:249], v62 offset:4096
    ds_read_b64_tr_b16 v[250:251], v62 offset:4608
    ds_read_b64_tr_b16 v[252:253], v63 offset:4096
    ds_read_b64_tr_b16 v[254:255], v63 offset:4608
    s_waitcnt lgkmcnt(0)
    s_barrier
    s_mov_b32 s37, 0xffff0000
    v_lshlrev_b32 v112, 16, v24
    v_and_b32 v113, s37, v24
    v_lshlrev_b32 v114, 16, v25
    v_and_b32 v115, s37, v25
    v_lshlrev_b32 v116, 16, v26
    v_and_b32 v117, s37, v26
    v_lshlrev_b32 v118, 16, v27
    v_and_b32 v119, s37, v27
    s_cmp_lg_u32 s32, 0
    s_cbranch_scc1 L_arv51
    s_add_u32 s20, s82, 0x80
    s_addc_u32 s21, s83, 0
    s_mov_b32 s22, 0x4
    s_mov_b32 s23, 0x00020000
    buffer_load_dword v80, v124, s[20:23], 0 offen sc1
    s_waitcnt vmcnt(0)
    v_cmp_eq_u32 vcc, v124, v80
    s_cbranch_vccnz L_spin52
L_back53:
L_arv51:
    s_add_u32 s96, s41, 8126464
    s_mov_b32 s98, s41
    s_mov_b32 s45, 0x5530000
    buffer_load_dword v96, v6, s[16:19], s45 offen sc1
    s_waitcnt vmcnt(0)
    v_cmp_ne_u32 vcc, 0, v96
    s_cbranch_vccnz L_spin54
L_back55:
    s_barrier
    s_add_u32 m0, s43, 0
    s_add_u32 s42, s41, 0
    buffer_load_dwordx4 v1, s[16:19], s42 offen offset:0 sc1 lds
    buffer_load_dwordx4 v1, s[16:19], s42 offen offset:1024 sc1 lds
    buffer_load_dwordx4 v1, s[16:19], s42 offen offset:2048 sc1 lds
    s_add_u32 m0, s43, 12288
    s_add_u32 s42, s41, 12288
    buffer_load_dwordx4 v1, s[16:19], s42 offen offset:0 sc1 lds
    buffer_load_dwordx4 v1, s[16:19], s42 offen offset:1024 sc1 lds
    buffer_load_dwordx4 v1, s[16:19], s42 offen offset:2048 sc1 lds
    s_add_u32 m0, s43, 24576
    s_add_u32 s42, s41, 24576
    buffer_load_dwordx4 v1, s[16:19], s42 offen offset:0 sc1 lds
    buffer_load_dwordx4 v1, s[16:19], s42 offen offset:1024 sc1 lds
    buffer_load_dwordx4 v1, s[16:19], s42 offen offset:2048 sc1 lds
    s_add_u32 s45, s45, 65536
    s_waitcnt vmcnt(0) lgkmcnt(0)
    s_barrier
    s_mov_b32 s52, 0x5e00000
    s_mov_b32 s46, 0x5e00000
    s_add_u32 s20, s84, 0x5e00000
    s_addc_u32 s21, s85, 0
    s_mov_b32 s22, 0x400000
    s_mov_b32 s23, 0x00020000
    ds_read_b128 v[80:83], v2 offset:0
    ds_read_b128 v[84:87], v3 offset:0
    s_mov_b32 s36, 0
    s_waitcnt lgkmcnt(0)
    s_nop 7
L_bf_b0:
    s_waitcnt lgkmcnt(0)
    v_mfma_f32_16x16x32_bf16 v[16:19], a[0:3], v[80:83], v[112:115]
    s_sub_u32 s47, s45, 196608
    ds_read_b128 v[88:91], v2 offset:2048
    s_max_u32 s47, s47, 0x5500000
    v_mfma_f32_16x16x32_bf16 v[24:27], a[0:3], v[84:87], 0
    buffer_load_dword v13, v8, s[16:19], s47 offen sc1
    v_mfma_f32_16x16x32_bf16 v[28:31], a[4:7], v[84:87], 0
    s_and_b32 s38, s53, 0xffffffff
    ds_read_b128 v[92:95], v3 offset:2048
    s_cmp_lt_i32 s36, 1
    v_mfma_f32_16x16x32_bf16 v[20:23], a[4:7], v[80:83], v[116:119]
    s_cselect_b32 s38, 0x5e00000, s38
    v_mfma_f32_16x16x32_bf16 v[32:35], a[8:11], v[80:83], 0
    buffer_load_dwordx4 v[136:139], v1, s[16:19], s38 offen sc1
    v_mfma_f32_16x16x32_bf16 v[40:43], a[8:11], v[84:87], 0
    s_add_u32 s53, s53, 65536
    ds_read_b128 v[144:147], v11 offset:0
    s_and_b32 s44, s90, 0xffffffff
    v_mfma_f32_16x16x32_bf16 v[44:47], a[12:15], v[84:87], 0
    s_cmp_lt_i32 s36, 1
    s_cselect_b32 s44, 0x5e00000, s44
    s_xor_b32 s49, s44, 16384
    v_mfma_f32_16x16x32_bf16 v[36:39], a[12:15], v[80:83], 0
    s_waitcnt lgkmcnt(1)
    v_cvt_pk_bf16_f32 v56, v56, v57
    v_cvt_pk_bf16_f32 v57, v58, v59
    v_mfma_f32_16x16x32_bf16 v[16:19], a[16:19], v[88:91], v[16:19]
    ds_read_b128 v[80:83], v2 offset:4096
    v_cvt_pk_bf16_f32 v58, v60, v61
    v_mfma_f32_16x16x32_bf16 v[24:27], a[16:19], v[92:95], v[24:27]
    v_cvt_pk_bf16_f32 v59, v62, v63
    v_mfma_f32_16x16x32_bf16 v[28:31], a[20:23], v[92:95], v[28:31]
    s_waitcnt lgkmcnt(1)
    ds_read_b128 v[84:87], v3 offset:4096
    v_add_f32 v144, v144, v145
    v_mfma_f32_16x16x32_bf16 v[20:23], a[20:23], v[88:91], v[20:23]
    buffer_store_dwordx4 v[56:59], v1, s[16:19], s49 offen offset:0 sc1
    v_mfma_f32_16x16x32_bf16 v[32:35], a[24:27], v[88:91], v[32:35]
    s_xor_b32 s49, s44, 32768
    v_cvt_pk_bf16_f32 v64, v64, v65
    v_cvt_pk_bf16_f32 v65, v66, v67
    v_mfma_f32_16x16x32_bf16 v[40:43], a[24:27], v[92:95], v[40:43]
    v_cvt_pk_bf16_f32 v66, v68, v69
    v_cvt_pk_bf16_f32 v67, v70, v71
    v_mfma_f32_16x16x32_bf16 v[44:47], a[28:31], v[92:95], v[44:47]
    buffer_store_dwordx4 v[64:67], v1, s[16:19], s49 offen offset:1024 sc1
    v_mfma_f32_16x16x32_bf16 v[36:39], a[28:31], v[88:91], v[36:39]
    s_waitcnt lgkmcnt(0)
    v_add_f32 v146, v146, v147
    v_add_f32 v144, v144, v146
    v_mfma_f32_16x16x32_bf16 v[16:19], a[32:35], v[80:83], v[16:19]
    s_xor_b32 s49, s44, 49152
    ds_read_b128 v[88:91], v2 offset:6144
    v_cvt_pk_bf16_f32 v72, v72, v73
    v_mfma_f32_16x16x32_bf16 v[24:27], a[32:35], v[84:87], v[24:27]
    s_add_u32 m0, s88, 36864
    v_cvt_pk_bf16_f32 v73, v74, v75
    v_cvt_pk_bf16_f32 v74, v76, v77
    v_mfma_f32_16x16x32_bf16 v[28:31], a[36:39], v[84:87], v[28:31]
    s_add_u32 s42, s41, 36864
    ds_read_b128 v[92:95], v3 offset:6144
    v_cvt_pk_bf16_f32 v75, v78, v79
    v_mfma_f32_16x16x32_bf16 v[20:23], a[36:39], v[80:83], v[20:23]
    buffer_store_dwordx4 v[72:75], v1, s[16:19], s49 offen offset:2048 sc1
    v_mfma_f32_16x16x32_bf16 v[32:35], a[40:43], v[80:83], v[32:35]
    s_add_u32 s42, s42, s89
    s_add_u32 s90, s90, 262144
    v_mfma_f32_16x16x32_bf16 v[40:43], a[40:43], v[84:87], v[40:43]
    v_mfma_f32_16x16x32_bf16 v[44:47], a[44:47], v[84:87], v[44:47]
    buffer_load_dwordx4 v1, s[16:19], s42 offen offset:0 sc1 lds
    v_mfma_f32_16x16x32_bf16 v[36:39], a[44:47], v[80:83], v[36:39]
    s_waitcnt lgkmcnt(0)
    v_mfma_f32_16x16x32_bf16 v[16:19], a[48:51], v[88:91], v[16:19]
    ds_read_b128 v[80:83], v2 offset:8192
    v_mfma_f32_16x16x32_bf16 v[24:27], a[48:51], v[92:95], v[24:27]
    buffer_store_dword v144, v12, s[16:19], s46 offen sc1
    v_mfma_f32_16x16x32_bf16 v[28:31], a[52:55], v[92:95], v[28:31]
    ds_read_b128 v[84:87], v3 offset:8192
    v_mfma_f32_16x16x32_bf16 v[20:23], a[52:55], v[88:91], v[20:23]
    v_mfma_f32_16x16x32_bf16 v[32:35], a[56:59], v[88:91], v[32:35]
    buffer_load_dwordx4 v1, s[16:19], s42 offen offset:1024 sc1 lds
    v_mfma_f32_16x16x32_bf16 v[40:43], a[56:59], v[92:95], v[40:43]
    s_add_u32 s98, s98, 262144
    s_min_i32 s98, s98, s96
    s_and_b32 s41, s98, 0xffffffff
    v_mfma_f32_16x16x32_bf16 v[44:47], a[60:63], v[92:95], v[44:47]
    v_mfma_f32_16x16x32_bf16 v[36:39], a[60:63], v[88:91], v[36:39]
    s_waitcnt lgkmcnt(0)
    v_mfma_f32_16x16x32_bf16 v[16:19], a[64:67], v[80:83], v[16:19]
    ds_read_b128 v[88:91], v2 offset:10240
    v_mfma_f32_16x16x32_bf16 v[24:27], a[64:67], v[84:87], v[24:27]
    v_mfma_f32_16x16x32_bf16 v[28:31], a[68:71], v[84:87], v[28:31]
    ds_read_b128 v[92:95], v3 offset:10240
    v_mfma_f32_16x16x32_bf16 v[20:23], a[68:71], v[80:83], v[20:23]
    s_waitcnt vmcnt(7)
    v_cmp_ne_u32 vcc, 0, v13
    v_mfma_f32_16x16x32_bf16 v[32:35], a[72:75], v[80:83], v[32:35]
    v_mfma_f32_16x16x32_bf16 v[40:43], a[72:75], v[84:87], v[40:43]
    s_cbranch_vccnz L_spin56
L_back57:
    v_mfma_f32_16x16x32_bf16 v[44:47], a[76:79], v[84:87], v[44:47]
    v_mfma_f32_16x16x32_bf16 v[36:39], a[76:79], v[80:83], v[36:39]
    s_waitcnt vmcnt(8) lgkmcnt(0)
    s_barrier
    v_mfma_f32_16x16x32_bf16 v[16:19], a[80:83], v[88:91], v[16:19]
    s_sub_u32 s48, s90, 524288
    ds_read_b128 v[80:83], v2 offset:12288
    s_and_b32 s48, s48, 0xffffffff
    v_mfma_f32_16x16x32_bf16 v[24:27], a[80:83], v[92:95], v[24:27]
    s_cmp_lt_i32 s36, 2
    s_cselect_b32 s48, s52, s48
    v_mfma_f32_16x16x32_bf16 v[28:31], a[84:87], v[92:95], v[28:31]
    ds_read_b128 v[84:87], v3 offset:12288
    v_mfma_f32_16x16x32_bf16 v[20:23], a[84:87], v[88:91], v[20:23]
    buffer_load_dwordx4 v[140:143], v1, s[16:19], s48 offen offset:0 sc1
    v_mfma_f32_16x16x32_bf16 v[32:35], a[88:91], v[88:91], v[32:35]
    v_mfma_f32_16x16x32_bf16 v[40:43], a[88:91], v[92:95], v[40:43]
    v_mfma_f32_16x16x32_bf16 v[44:47], a[92:95], v[92:95], v[44:47]
    buffer_load_dwordx4 v[144:147], v1, s[16:19], s48 offen offset:1024 sc1
    v_mfma_f32_16x16x32_bf16 v[36:39], a[92:95], v[88:91], v[36:39]
    s_waitcnt lgkmcnt(0)
    v_mfma_f32_16x16x32_bf16 v[16:19], a[96:99], v[80:83], v[16:19]
    ds_read_b128 v[88:91], v2 offset:14336
    v_mfma_f32_16x16x32_bf16 v[24:27], a[96:99], v[84:87], v[24:27]
    buffer_load_dwordx4 v[148:151], v1, s[16:19], s48 offen offset:2048 sc1
    v_mfma_f32_16x16x32_bf16 v[28:31], a[100:103], v[84:87], v[28:31]
    ds_read_b128 v[92:95], v3 offset:14336
    v_mfma_f32_16x16x32_bf16 v[20:23], a[100:103], v[80:83], v[20:23]
    v_mfma_f32_16x16x32_bf16 v[32:35], a[104:107], v[80:83], v[32:35]
    buffer_load_dwordx4 v[152:155], v1, s[16:19], s48 offen offset:3072 sc1
    v_mfma_f32_16x16x32_bf16 v[40:43], a[104:107], v[84:87], v[40:43]
    s_sub_u32 s47, s36, 2
    s_cmp_lt_u32 s47, 16
    s_cselect_b32 s48, 0x5000000, s52
    v_mfma_f32_16x16x32_bf16 v[44:47], a[108:111], v[84:87], v[44:47]
    s_add_u32 s20, s84, s48
    s_addc_u32 s21, s85, 0
    s_cmp_ge_i32 s47, 16
    v_mfma_f32_16x16x32_bf16 v[36:39], a[108:111], v[80:83], v[36:39]
    s_waitcnt lgkmcnt(0)
    s_cselect_b32 s20, s80, s20
    s_cselect_b32 s21, s81, s21
    v_mfma_f32_16x16x32_bf16 v[16:19], a[112:115], v[88:91], v[16:19]
    s_and_b32 s48, s47, 15
    ds_read_b128 v[80:83], v2 offset:16384
    s_lshl_b32 s48, s48, 1
    v_mfma_f32_16x16x32_bf16 v[24:27], a[112:115], v[92:95], v[24:27]
    s_sub_u32 s48, s50, s48
    s_lshl_b32 s46, s48, 10
    s_sub_u32 s46, s55, s46
    v_mfma_f32_16x16x32_bf16 v[28:31], a[116:119], v[92:95], v[28:31]
    s_cmp_lt_u32 s47, 16
    ds_read_b128 v[84:87], v3 offset:16384
    s_cselect_b32 s46, s46, s52
    v_mfma_f32_16x16x32_bf16 v[20:23], a[116:119], v[88:91], v[20:23]
    buffer_load_dword v96, v6, s[16:19], s45 offen sc1
    v_mfma_f32_16x16x32_bf16 v[32:35], a[120:123], v[88:91], v[32:35]
    s_add_u32 m0, s43, 98304
    s_add_u32 s42, s41, 0
    s_lshl_b32 s48, s48, 15
    v_mfma_f32_16x16x32_bf16 v[40:43], a[120:123], v[92:95], v[40:43]
    v_mfma_f32_16x16x32_bf16 v[44:47], a[124:127], v[92:95], v[44:47]
    v_mfma_f32_16x16x32_bf16 v[36:39], a[124:127], v[88:91], v[36:39]
    s_waitcnt lgkmcnt(0)
    v_mfma_f32_16x16x32_bf16 v[16:19], a[128:131], v[80:83], v[16:19]
    ds_read_b128 v[88:91], v2 offset:18432
    v_mfma_f32_16x16x32_bf16 v[24:27], a[128:131], v[84:87], v[24:27]
    v_mfma_f32_16x16x32_bf16 v[28:31], a[132:135], v[84:87], v[28:31]
    ds_read_b128 v[92:95], v3 offset:18432
    v_mfma_f32_16x16x32_bf16 v[20:23], a[132:135], v[80:83], v[20:23]
    v_mfma_f32_16x16x32_bf16 v[32:35], a[136:139], v[80:83], v[32:35]
    v_mfma_f32_16x16x32_bf16 v[40:43], a[136:139], v[84:87], v[40:43]
    v_mfma_f32_16x16x32_bf16 v[44:47], a[140:143], v[84:87], v[44:47]
    v_mfma_f32_16x16x32_bf16 v[36:39], a[140:143], v[80:83], v[36:39]
    s_waitcnt lgkmcnt(0)
    v_mfma_f32_16x16x32_bf16 v[16:19], a[144:147], v[88:91], v[16:19]
    ds_read_b128 v[80:83], v2 offset:20480
    v_mfma_f32_16x16x32_bf16 v[24:27], a[144:147], v[92:95], v[24:27]
    v_mfma_f32_16x16x32_bf16 v[28:31], a[148:151], v[92:95], v[28:31]
    ds_read_b128 v[84:87], v3 offset:20480
    v_mfma_f32_16x16x32_bf16 v[20:23], a[148:151], v[88:91], v[20:23]
    v_mfma_f32_16x16x32_bf16 v[32:35], a[152:155], v[88:91], v[32:35]
    v_mfma_f32_16x16x32_bf16 v[40:43], a[152:155], v[92:95], v[40:43]
    v_mfma_f32_16x16x32_bf16 v[44:47], a[156:159], v[92:95], v[44:47]
    v_mfma_f32_16x16x32_bf16 v[36:39], a[156:159], v[88:91], v[36:39]
    s_waitcnt lgkmcnt(0)
    v_mfma_f32_16x16x32_bf16 v[16:19], a[160:163], v[80:83], v[16:19]
    ds_read_b128 v[88:91], v2 offset:22528
    v_mfma_f32_16x16x32_bf16 v[24:27], a[160:163], v[84:87], v[24:27]
    v_mfma_f32_16x16x32_bf16 v[28:31], a[164:167], v[84:87], v[28:31]
    ds_read_b128 v[92:95], v3 offset:22528
    v_mfma_f32_16x16x32_bf16 v[20:23], a[164:167], v[80:83], v[20:23]
    v_mfma_f32_16x16x32_bf16 v[32:35], a[168:171], v[80:83], v[32:35]
    v_mfma_f32_16x16x32_bf16 v[40:43], a[168:171], v[84:87], v[40:43]
    v_mfma_f32_16x16x32_bf16 v[44:47], a[172:175], v[84:87], v[44:47]
    v_mfma_f32_16x16x32_bf16 v[36:39], a[172:175], v[80:83], v[36:39]
    s_waitcnt lgkmcnt(0)
    v_mfma_f32_16x16x32_bf16 v[16:19], a[176:179], v[88:91], v[16:19]
    ds_read_b128 v[80:83], v2 offset:24576
    v_mfma_f32_16x16x32_bf16 v[24:27], a[176:179], v[92:95], v[24:27]
    v_mfma_f32_16x16x32_bf16 v[28:31], a[180:183], v[92:95], v[28:31]
    ds_read_b128 v[84:87], v3 offset:24576
    v_mfma_f32_16x16x32_bf16 v[20:23], a[180:183], v[88:91], v[20:23]
    v_mfma_f32_16x16x32_bf16 v[32:35], a[184:187], v[88:91], v[32:35]
    v_mfma_f32_16x16x32_bf16 v[40:43], a[184:187], v[92:95], v[40:43]
    v_mfma_f32_16x16x32_bf16 v[44:47], a[188:191], v[92:95], v[44:47]
    v_mfma_f32_16x16x32_bf16 v[36:39], a[188:191], v[88:91], v[36:39]
    s_waitcnt lgkmcnt(0)
    v_mfma_f32_16x16x32_bf16 v[16:19], a[192:195], v[80:83], v[16:19]
    ds_read_b128 v[88:91], v2 offset:26624
    v_mfma_f32_16x16x32_bf16 v[24:27], a[192:195], v[84:87], v[24:27]
    v_mfma_f32_16x16x32_bf16 v[28:31], a[196:199], v[84:87], v[28:31]
    ds_read_b128 v[92:95], v3 offset:26624
    v_mfma_f32_16x16x32_bf16 v[20:23], a[196:199], v[80:83], v[20:23]
    v_mfma_f32_16x16x32_bf16 v[32:35], a[200:203], v[80:83], v[32:35]
    v_mfma_f32_16x16x32_bf16 v[40:43], a[200:203], v[84:87], v[40:43]
    v_mfma_f32_16x16x32_bf16 v[44:47], a[204:207], v[84:87], v[44:47]
    v_mfma_f32_16x16x32_bf16 v[36:39], a[204:207], v[80:83], v[36:39]
    s_waitcnt lgkmcnt(0)
    v_mfma_f32_16x16x32_bf16 v[16:19], a[208:211], v[88:91], v[16:19]
    s_waitcnt vmcnt(0)
    ds_read_b128 v[80:83], v2 offset:28672
    v_cmp_ne_u32 vcc, 0, v96
    v_mfma_f32_16x16x32_bf16 v[24:27], a[208:211], v[92:95], v[24:27]
    v_mfma_f32_16x16x32_bf16 v[28:31], a[212:215], v[92:95], v[28:31]
    s_cbranch_vccnz L_spin58
L_back59:
    ds_read_b128 v[84:87], v3 offset:28672
    s_barrier
    v_mfma_f32_16x16x32_bf16 v[20:23], a[212:215], v[88:91], v[20:23]
    buffer_load_dwordx4 v1, s[16:19], s42 offen offset:0 sc1 lds
    v_mfma_f32_16x16x32_bf16 v[32:35], a[216:219], v[88:91], v[32:35]
    v_mfma_f32_16x16x32_bf16 v[40:43], a[216:219], v[92:95], v[40:43]
    v_mfma_f32_16x16x32_bf16 v[44:47], a[220:223], v[92:95], v[44:47]
    buffer_load_dwordx4 v1, s[16:19], s42 offen offset:1024 sc1 lds
    v_mfma_f32_16x16x32_bf16 v[36:39], a[220:223], v[88:91], v[36:39]
    s_waitcnt lgkmcnt(0)
    v_mfma_f32_16x16x32_bf16 v[16:19], a[224:227], v[80:83], v[16:19]
    ds_read_b128 v[88:91], v2 offset:30720
    v_mfma_f32_16x16x32_bf16 v[24:27], a[224:227], v[84:87], v[24:27]
    buffer_load_dwordx4 v1, s[16:19], s42 offen offset:2048 sc1 lds
    v_mfma_f32_16x16x32_bf16 v[28:31], a[228:231], v[84:87], v[28:31]
    ds_read_b128 v[92:95], v3 offset:30720
    v_mfma_f32_16x16x32_bf16 v[20:23], a[228:231], v[80:83], v[20:23]
    v_mfma_f32_16x16x32_bf16 v[32:35], a[232:235], v[80:83], v[32:35]
    buffer_store_dword v124, v124, s[16:19], s91 offen sc1
    v_mfma_f32_16x16x32_bf16 v[40:43], a[232:235], v[84:87], v[40:43]
    s_add_u32 s91, s91, 65536
    s_add_u32 m0, s43, 110592
    s_add_u32 s42, s41, 12288
    v_mfma_f32_16x16x32_bf16 v[44:47], a[236:239], v[84:87], v[44:47]
    s_add_u32 s39, s91, -163840
    v_mfma_f32_16x16x32_bf16 v[36:39], a[236:239], v[80:83], v[36:39]
    s_waitcnt lgkmcnt(0)
    v_mfma_f32_16x16x32_bf16 v[16:19], a[240:243], v[88:91], v[16:19]
    ds_read_b128 v[80:83], v2 offset:32768
    v_mfma_f32_16x16x32_bf16 v[24:27], a[240:243], v[92:95], v[24:27]
    buffer_store_dword v124, v124, s[16:19], s39 offen sc1
    v_mfma_f32_16x16x32_bf16 v[28:31], a[244:247], v[92:95], v[28:31]
    s_waitcnt vmcnt(6)
    ds_read_b128 v[84:87], v3 offset:32768
    v_mfma_f32_16x16x32_bf16 v[128:131], v[104:107], v[140:143], v[128:131]
    v_mfma_f32_16x16x32_bf16 v[132:135], v[108:111], v[140:143], v[132:135]
    v_mfma_f32_16x16x32_bf16 v[128:131], v[104:107], v[144:147], v[128:131]
    v_mfma_f32_16x16x32_bf16 v[132:135], v[108:111], v[144:147], v[132:135]
    v_mfma_f32_16x16x32_bf16 v[128:131], v[104:107], v[148:151], v[128:131]
    v_mfma_f32_16x16x32_bf16 v[132:135], v[108:111], v[148:151], v[132:135]
    v_mfma_f32_16x16x32_bf16 v[128:131], v[104:107], v[152:155], v[128:131]
    v_mfma_f32_16x16x32_bf16 v[132:135], v[108:111], v[152:155], v[132:135]
    v_mfma_f32_16x16x32_bf16 v[20:23], a[244:247], v[88:91], v[20:23]
    v_mfma_f32_16x16x32_bf16 v[32:35], a[248:251], v[88:91], v[32:35]
    buffer_load_dwordx4 v1, s[16:19], s42 offen offset:0 sc1 lds
    v_mfma_f32_16x16x32_bf16 v[40:43], a[248:251], v[92:95], v[40:43]
    v_cvt_pk_bf16_f32 v140, v128, v129
    v_cvt_pk_bf16_f32 v141, v130, v131
    v_mfma_f32_16x16x32_bf16 v[44:47], a[252:255], v[92:95], v[44:47]
    v_cvt_pk_bf16_f32 v142, v132, v133
    v_cvt_pk_bf16_f32 v143, v134, v135
    v_mfma_f32_16x16x32_bf16 v[36:39], a[252:255], v[88:91], v[36:39]
    s_waitcnt lgkmcnt(0)
    v_mfma_f32_16x16x32_bf16 v[16:19], v[160:163], v[80:83], v[16:19]
    ds_read_b128 v[88:91], v2 offset:34816
    v_mfma_f32_16x16x32_bf16 v[24:27], v[160:163], v[84:87], v[24:27]
    buffer_load_dwordx4 v1, s[16:19], s42 offen offset:1024 sc1 lds
    v_mfma_f32_16x16x32_bf16 v[28:31], v[164:167], v[84:87], v[28:31]
    ds_read_b128 v[92:95], v3 offset:34816
    v_mfma_f32_16x16x32_bf16 v[20:23], v[164:167], v[80:83], v[20:23]
    v_mfma_f32_16x16x32_bf16 v[32:35], v[168:171], v[80:83], v[32:35]
    buffer_store_dwordx4 v[140:143], v9, s[20:23], s48 offen sc1
    v_mfma_f32_16x16x32_bf16 v[40:43], v[168:171], v[84:87], v[40:43]
    v_add_f32 v100, v128, v129
    v_mul_f32 v101, v128, v128
    v_mfma_f32_16x16x32_bf16 v[44:47], v[172:175], v[84:87], v[44:47]
    v_fmac_f32 v101, v129, v129
    v_add_f32 v100, v100, v130
    v_mfma_f32_16x16x32_bf16 v[36:39], v[172:175], v[80:83], v[36:39]
    s_waitcnt lgkmcnt(0)
    v_fmac_f32 v101, v130, v130
    v_add_f32 v100, v100, v131
    v_mfma_f32_16x16x32_bf16 v[16:19], v[176:179], v[88:91], v[16:19]
    ds_read_b128 v[80:83], v2 offset:36864
    v_fmac_f32 v101, v131, v131
    v_mfma_f32_16x16x32_bf16 v[24:27], v[176:179], v[92:95], v[24:27]
    buffer_load_dwordx4 v1, s[16:19], s42 offen offset:2048 sc1 lds
    v_mfma_f32_16x16x32_bf16 v[28:31], v[180:183], v[92:95], v[28:31]
    s_add_u32 m0, s43, 122880
    ds_read_b128 v[84:87], v3 offset:36864
    v_add_f32 v100, v100, v132
    v_mfma_f32_16x16x32_bf16 v[20:23], v[180:183], v[88:91], v[20:23]
    s_add_u32 s42, s41, 24576
    v_fmac_f32 v101, v132, v132
    v_add_f32 v100, v100, v133
    v_mfma_f32_16x16x32_bf16 v[32:35], v[184:187], v[88:91], v[32:35]
    v_fmac_f32 v101, v133, v133
    v_add_f32 v100, v100, v134
    v_mfma_f32_16x16x32_bf16 v[40:43], v[184:187], v[92:95], v[40:43]
    v_fmac_f32 v101, v134, v134
    v_add_f32 v100, v100, v135
    v_mfma_f32_16x16x32_bf16 v[44:47], v[188:191], v[92:95], v[44:47]
    buffer_load_dwordx4 v1, s[16:19], s42 offen offset:0 sc1 lds
    v_mfma_f32_16x16x32_bf16 v[36:39], v[188:191], v[88:91], v[36:39]
    s_waitcnt lgkmcnt(0)
    v_fmac_f32 v101, v135, v135
    v_mfma_f32_16x16x32_bf16 v[16:19], v[192:195], v[80:83], v[16:19]
    ds_read_b128 v[88:91], v2 offset:38912
    v_mfma_f32_16x16x32_bf16 v[24:27], v[192:195], v[84:87], v[24:27]
    v_permlane16_swap_b32 v100, v101
    v_mfma_f32_16x16x32_bf16 v[28:31], v[196:199], v[84:87], v[28:31]
    ds_read_b128 v[92:95], v3 offset:38912
    v_add_f32 v100, v100, v101
    v_mfma_f32_16x16x32_bf16 v[20:23], v[196:199], v[80:83], v[20:23]
    buffer_load_dwordx4 v1, s[16:19], s42 offen offset:1024 sc1 lds
    v_mfma_f32_16x16x32_bf16 v[32:35], v[200:203], v[80:83], v[32:35]
    v_mov_b32 v102, v100
    v_mfma_f32_16x16x32_bf16 v[40:43], v[200:203], v[84:87], v[40:43]
    v_permlane32_swap_b32 v100, v102
    v_mfma_f32_16x16x32_bf16 v[44:47], v[204:207], v[84:87], v[44:47]
    v_add_f32 v100, v100, v102
    v_mfma_f32_16x16x32_bf16 v[36:39], v[204:207], v[80:83], v[36:39]
    s_waitcnt lgkmcnt(0)
    ds_write_b32 v10, v100 offset:512
    v_mfma_f32_16x16x32_bf16 v[16:19], v[208:211], v[88:91], v[16:19]
    s_waitcnt vmcnt(22)
    ds_read_b128 v[80:83], v2 offset:40960
    v_mfma_f32_16x16x32_bf16 v[128:131], v[104:107], v[136:139], v[48:51]
    buffer_load_dwordx4 v1, s[16:19], s42 offen offset:2048 sc1 lds
    v_mfma_f32_16x16x32_bf16 v[24:27], v[208:211], v[92:95], v[24:27]
    v_mfma_f32_16x16x32_bf16 v[132:135], v[108:111], v[136:139], v[52:55]
    s_add_u32 s45, s45, 65536
    v_mfma_f32_16x16x32_bf16 v[28:31], v[212:215], v[92:95], v[28:31]
    ds_read_b128 v[84:87], v3 offset:40960
    v_mfma_f32_16x16x32_bf16 v[20:23], v[212:215], v[88:91], v[20:23]
    v_mfma_f32_16x16x32_bf16 v[32:35], v[216:219], v[88:91], v[32:35]
    v_mfma_f32_16x16x32_bf16 v[40:43], v[216:219], v[92:95], v[40:43]
    v_mfma_f32_16x16x32_bf16 v[44:47], v[220:223], v[92:95], v[44:47]
    v_mfma_f32_16x16x32_bf16 v[36:39], v[220:223], v[88:91], v[36:39]
    s_waitcnt lgkmcnt(0)
    v_mfma_f32_16x16x32_bf16 v[16:19], v[224:227], v[80:83], v[16:19]
    ds_read_b128 v[88:91], v2 offset:43008
    v_mfma_f32_16x16x32_bf16 v[24:27], v[224:227], v[84:87], v[24:27]
    v_mfma_f32_16x16x32_bf16 v[28:31], v[228:231], v[84:87], v[28:31]
    ds_read_b128 v[92:95], v3 offset:43008
    v_mfma_f32_16x16x32_bf16 v[20:23], v[228:231], v[80:83], v[20:23]
    v_mfma_f32_16x16x32_bf16 v[32:35], v[232:235], v[80:83], v[32:35]
    v_mfma_f32_16x16x32_bf16 v[40:43], v[232:235], v[84:87], v[40:43]
    v_mfma_f32_16x16x32_bf16 v[44:47], v[236:239], v[84:87], v[44:47]
    v_mfma_f32_16x16x32_bf16 v[36:39], v[236:239], v[80:83], v[36:39]
    s_waitcnt vmcnt(9) lgkmcnt(0)
    s_barrier
    v_mfma_f32_16x16x32_bf16 v[16:19], v[240:243], v[88:91], v[16:19]
    ds_read_b128 v[80:83], v4 offset:0
    v_mfma_f32_16x16x32_bf16 v[24:27], v[240:243], v[92:95], v[24:27]
    v_mfma_f32_16x16x32_bf16 v[28:31], v[244:247], v[92:95], v[28:31]
    ds_read_b128 v[84:87], v5 offset:0
    v_mfma_f32_16x16x32_bf16 v[20:23], v[244:247], v[88:91], v[20:23]
    v_mfma_f32_16x16x32_bf16 v[32:35], v[248:251], v[88:91], v[32:35]
    v_mfma_f32_16x16x32_bf16 v[40:43], v[248:251], v[92:95], v[40:43]
    v_mfma_f32_16x16x32_bf16 v[44:47], v[252:255], v[92:95], v[44:47]
    v_mfma_f32_16x16x32_bf16 v[36:39], v[252:255], v[88:91], v[36:39]
    s_add_u32 s36, s36, 1
L_bf_b1:
    s_waitcnt lgkmcnt(0)
    v_mfma_f32_16x16x32_bf16 v[48:51], a[0:3], v[80:83], v[112:115]
    s_sub_u32 s47, s45, 196608
    ds_read_b128 v[88:91], v4 offset:2048
    s_max_u32 s47, s47, 0x5500000
    v_mfma_f32_16x16x32_bf16 v[56:59], a[0:3], v[84:87], 0
    buffer_load_dword v13, v8, s[16:19], s47 offen sc1
    v_mfma_f32_16x16x32_bf16 v[60:63], a[4:7], v[84:87], 0
    s_and_b32 s38, s53, 0xffffffff
    ds_read_b128 v[92:95], v5 offset:2048
    s_cmp_lt_i32 s36, 1
    v_mfma_f32_16x16x32_bf16 v[52:55], a[4:7], v[80:83], v[116:119]
    s_cselect_b32 s38, 0x5e00000, s38
    v_mfma_f32_16x16x32_bf16 v[64:67], a[8:11], v[80:83], 0
    buffer_load_dwordx4 v[136:139], v1, s[16:19], s38 offen sc1
    v_mfma_f32_16x16x32_bf16 v[72:75], a[8:11], v[84:87], 0
    s_add_u32 s53, s53, 65536
    ds_read_b128 v[144:147], v11 offset:512
    s_and_b32 s44, s90, 0xffffffff
    v_mfma_f32_16x16x32_bf16 v[76:79], a[12:15], v[84:87], 0
    s_cmp_lt_i32 s36, 1
    s_cselect_b32 s44, 0x5e00000, s44
    s_xor_b32 s49, s44, 16384
    v_mfma_f32_16x16x32_bf16 v[68:71], a[12:15], v[80:83], 0
    s_waitcnt lgkmcnt(1)
    v_cvt_pk_bf16_f32 v24, v24, v25
    v_cvt_pk_bf16_f32 v25, v26, v27
    v_mfma_f32_16x16x32_bf16 v[48:51], a[16:19], v[88:91], v[48:51]
    ds_read_b128 v[80:83], v4 offset:4096
    v_cvt_pk_bf16_f32 v26, v28, v29
    v_mfma_f32_16x16x32_bf16 v[56:59], a[16:19], v[92:95], v[56:59]
    v_cvt_pk_bf16_f32 v27, v30, v31
    v_mfma_f32_16x16x32_bf16 v[60:63], a[20:23], v[92:95], v[60:63]
    s_waitcnt lgkmcnt(1)
    ds_read_b128 v[84:87], v5 offset:4096
    v_add_f32 v144, v144, v145
    v_mfma_f32_16x16x32_bf16 v[52:55], a[20:23], v[88:91], v[52:55]
    buffer_store_dwordx4 v[24:27], v1, s[16:19], s49 offen offset:0 sc1
    v_mfma_f32_16x16x32_bf16 v[64:67], a[24:27], v[88:91], v[64:67]
    s_xor_b32 s49, s44, 32768
    v_cvt_pk_bf16_f32 v32, v32, v33
    v_cvt_pk_bf16_f32 v33, v34, v35
    v_mfma_f32_16x16x32_bf16 v[72:75], a[24:27], v[92:95], v[72:75]
    v_cvt_pk_bf16_f32 v34, v36, v37
    v_cvt_pk_bf16_f32 v35, v38, v39
    v_mfma_f32_16x16x32_bf16 v[76:79], a[28:31], v[92:95], v[76:79]
    buffer_store_dwordx4 v[32:35], v1, s[16:19], s49 offen offset:1024 sc1
    v_mfma_f32_16x16x32_bf16 v[68:71], a[28:31], v[88:91], v[68:71]
    s_waitcnt lgkmcnt(0)
    v_add_f32 v146, v146, v147
    v_add_f32 v144, v144, v146
    v_mfma_f32_16x16x32_bf16 v[48:51], a[32:35], v[80:83], v[48:51]
    s_xor_b32 s49, s44, 49152
    ds_read_b128 v[88:91], v4 offset:6144
    v_cvt_pk_bf16_f32 v40, v40, v41
    v_mfma_f32_16x16x32_bf16 v[56:59], a[32:35], v[84:87], v[56:59]
    s_add_u32 m0, s88, 135168
    v_cvt_pk_bf16_f32 v41, v42, v43
    v_cvt_pk_bf16_f32 v42, v44, v45
    v_mfma_f32_16x16x32_bf16 v[60:63], a[36:39], v[84:87], v[60:63]
    s_add_u32 s42, s41, 36864
    ds_read_b128 v[92:95], v5 offset:6144
    v_cvt_pk_bf16_f32 v43, v46, v47
    v_mfma_f32_16x16x32_bf16 v[52:55], a[36:39], v[80:83], v[52:55]
    buffer_store_dwordx4 v[40:43], v1, s[16:19], s49 offen offset:2048 sc1
    v_mfma_f32_16x16x32_bf16 v[64:67], a[40:43], v[80:83], v[64:67]
    s_add_u32 s42, s42, s89
    s_add_u32 s90, s90, 262144
    v_mfma_f32_16x16x32_bf16 v[72:75], a[40:43], v[84:87], v[72:75]
    v_mfma_f32_16x16x32_bf16 v[76:79], a[44:47], v[84:87], v[76:79]
    buffer_load_dwordx4 v1, s[16:19], s42 offen offset:0 sc1 lds
    v_mfma_f32_16x16x32_bf16 v[68:71], a[44:47], v[80:83], v[68:71]
    s_waitcnt lgkmcnt(0)
    v_mfma_f32_16x16x32_bf16 v[48:51], a[48:51], v[88:91], v[48:51]
    ds_read_b128 v[80:83], v4 offset:8192
    v_mfma_f32_16x16x32_bf16 v[56:59], a[48:51], v[92:95], v[56:59]
    buffer_store_dword v144, v12, s[16:19], s46 offen sc1
    v_mfma_f32_16x16x32_bf16 v[60:63], a[52:55], v[92:95], v[60:63]
    ds_read_b128 v[84:87], v5 offset:8192
    v_mfma_f32_16x16x32_bf16 v[52:55], a[52:55], v[88:91], v[52:55]
    v_mfma_f32_16x16x32_bf16 v[64:67], a[56:59], v[88:91], v[64:67]
    buffer_load_dwordx4 v1, s[16:19], s42 offen offset:1024 sc1 lds
    v_mfma_f32_16x16x32_bf16 v[72:75], a[56:59], v[92:95], v[72:75]
    s_add_u32 s98, s98, 262144
    s_min_i32 s98, s98, s96
    s_and_b32 s41, s98, 0xffffffff
    v_mfma_f32_16x16x32_bf16 v[76:79], a[60:63], v[92:95], v[76:79]
    v_mfma_f32_16x16x32_bf16 v[68:71], a[60:63], v[88:91], v[68:71]
    s_waitcnt lgkmcnt(0)
    v_mfma_f32_16x16x32_bf16 v[48:51], a[64:67], v[80:83], v[48:51]
    ds_read_b128 v[88:91], v4 offset:10240
    v_mfma_f32_16x16x32_bf16 v[56:59], a[64:67], v[84:87], v[56:59]
    v_mfma_f32_16x16x32_bf16 v[60:63], a[68:71], v[84:87], v[60:63]
    ds_read_b128 v[92:95], v5 offset:10240
    v_mfma_f32_16x16x32_bf16 v[52:55], a[68:71], v[80:83], v[52:55]
    s_waitcnt vmcnt(7)
    v_cmp_ne_u32 vcc, 0, v13
    v_mfma_f32_16x16x32_bf16 v[64:67], a[72:75], v[80:83], v[64:67]
    v_mfma_f32_16x16x32_bf16 v[72:75], a[72:75], v[84:87], v[72:75]
    s_cbranch_vccnz L_spin60
L_back61:
    v_mfma_f32_16x16x32_bf16 v[76:79], a[76:79], v[84:87], v[76:79]
    v_mfma_f32_16x16x32_bf16 v[68:71], a[76:79], v[80:83], v[68:71]
    s_waitcnt vmcnt(8) lgkmcnt(0)
    s_barrier
    v_mfma_f32_16x16x32_bf16 v[48:51], a[80:83], v[88:91], v[48:51]
    s_sub_u32 s48, s90, 524288
    ds_read_b128 v[80:83], v4 offset:12288
    s_and_b32 s48, s48, 0xffffffff
    v_mfma_f32_16x16x32_bf16 v[56:59], a[80:83], v[92:95], v[56:59]
    s_cmp_lt_i32 s36, 2
    s_cselect_b32 s48, s52, s48
    v_mfma_f32_16x16x32_bf16 v[60:63], a[84:87], v[92:95], v[60:63]
    ds_read_b128 v[84:87], v5 offset:12288
    v_mfma_f32_16x16x32_bf16 v[52:55], a[84:87], v[88:91], v[52:55]
    buffer_load_dwordx4 v[140:143], v1, s[16:19], s48 offen offset:0 sc1
    v_mfma_f32_16x16x32_bf16 v[64:67], a[88:91], v[88:91], v[64:67]
    v_mfma_f32_16x16x32_bf16 v[72:75], a[88:91], v[92:95], v[72:75]
    v_mfma_f32_16x16x32_bf16 v[76:79], a[92:95], v[92:95], v[76:79]
    buffer_load_dwordx4 v[144:147], v1, s[16:19], s48 offen offset:1024 sc1
    v_mfma_f32_16x16x32_bf16 v[68:71], a[92:95], v[88:91], v[68:71]
    s_waitcnt lgkmcnt(0)
    v_mfma_f32_16x16x32_bf16 v[48:51], a[96:99], v[80:83], v[48:51]
    ds_read_b128 v[88:91], v4 offset:14336
    v_mfma_f32_16x16x32_bf16 v[56:59], a[96:99], v[84:87], v[56:59]
    buffer_load_dwordx4 v[148:151], v1, s[16:19], s48 offen offset:2048 sc1
    v_mfma_f32_16x16x32_bf16 v[60:63], a[100:103], v[84:87], v[60:63]
    ds_read_b128 v[92:95], v5 offset:14336
    v_mfma_f32_16x16x32_bf16 v[52:55], a[100:103], v[80:83], v[52:55]
    v_mfma_f32_16x16x32_bf16 v[64:67], a[104:107], v[80:83], v[64:67]
    buffer_load_dwordx4 v[152:155], v1, s[16:19], s48 offen offset:3072 sc1
    v_mfma_f32_16x16x32_bf16 v[72:75], a[104:107], v[84:87], v[72:75]
    s_sub_u32 s47, s36, 2
    s_cmp_lt_u32 s47, 16
    s_cselect_b32 s48, 0x5000000, s52
    v_mfma_f32_16x16x32_bf16 v[76:79], a[108:111], v[84:87], v[76:79]
    s_add_u32 s20, s84, s48
    s_addc_u32 s21, s85, 0
    s_cmp_ge_i32 s47, 16
    v_mfma_f32_16x16x32_bf16 v[68:71], a[108:111], v[80:83], v[68:71]
    s_waitcnt lgkmcnt(0)
    s_cselect_b32 s20, s80, s20
    s_cselect_b32 s21, s81, s21
    v_mfma_f32_16x16x32_bf16 v[48:51], a[112:115], v[88:91], v[48:51]
    s_and_b32 s48, s47, 15
    ds_read_b128 v[80:83], v4 offset:16384
    s_lshl_b32 s48, s48, 1
    v_mfma_f32_16x16x32_bf16 v[56:59], a[112:115], v[92:95], v[56:59]
    s_sub_u32 s48, s50, s48
    s_lshl_b32 s46, s48, 10
    s_sub_u32 s46, s55, s46
    v_mfma_f32_16x16x32_bf16 v[60:63], a[116:119], v[92:95], v[60:63]
    s_cmp_lt_u32 s47, 16
    ds_read_b128 v[84:87], v5 offset:16384
    s_cselect_b32 s46, s46, s52
    v_mfma_f32_16x16x32_bf16 v[52:55], a[116:119], v[88:91], v[52:55]
    buffer_load_dword v96, v6, s[16:19], s45 offen sc1
    v_mfma_f32_16x16x32_bf16 v[64:67], a[120:123], v[88:91], v[64:67]
    s_add_u32 m0, s43, 0
    s_add_u32 s42, s41, 0
    s_lshl_b32 s48, s48, 15
    v_mfma_f32_16x16x32_bf16 v[72:75], a[120:123], v[92:95], v[72:75]
    v_mfma_f32_16x16x32_bf16 v[76:79], a[124:127], v[92:95], v[76:79]
    v_mfma_f32_16x16x32_bf16 v[68:71], a[124:127], v[88:91], v[68:71]
    s_waitcnt lgkmcnt(0)
    v_mfma_f32_16x16x32_bf16 v[48:51], a[128:131], v[80:83], v[48:51]
    ds_read_b128 v[88:91], v4 offset:18432
    v_mfma_f32_16x16x32_bf16 v[56:59], a[128:131], v[84:87], v[56:59]
    v_mfma_f32_16x16x32_bf16 v[60:63], a[132:135], v[84:87], v[60:63]
    ds_read_b128 v[92:95], v5 offset:18432
    v_mfma_f32_16x16x32_bf16 v[52:55], a[132:135], v[80:83], v[52:55]
    v_mfma_f32_16x16x32_bf16 v[64:67], a[136:139], v[80:83], v[64:67]
    v_mfma_f32_16x16x32_bf16 v[72:75], a[136:139], v[84:87], v[72:75]
    v_mfma_f32_16x16x32_bf16 v[76:79], a[140:143], v[84:87], v[76:79]
    v_mfma_f32_16x16x32_bf16 v[68:71], a[140:143], v[80:83], v[68:71]
    s_waitcnt lgkmcnt(0)
    v_mfma_f32_16x16x32_bf16 v[48:51], a[144:147], v[88:91], v[48:51]
    ds_read_b128 v[80:83], v4 offset:20480
    v_mfma_f32_16x16x32_bf16 v[56:59], a[144:147], v[92:95], v[56:59]
    v_mfma_f32_16x16x32_bf16 v[60:63], a[148:151], v[92:95], v[60:63]
    ds_read_b128 v[84:87], v5 offset:20480
    v_mfma_f32_16x16x32_bf16 v[52:55], a[148:151], v[88:91], v[52:55]
    v_mfma_f32_16x16x32_bf16 v[64:67], a[152:155], v[88:91], v[64:67]
    v_mfma_f32_16x16x32_bf16 v[72:75], a[152:155], v[92:95], v[72:75]
    v_mfma_f32_16x16x32_bf16 v[76:79], a[156:159], v[92:95], v[76:79]
    v_mfma_f32_16x16x32_bf16 v[68:71], a[156:159], v[88:91], v[68:71]
    s_waitcnt lgkmcnt(0)
    v_mfma_f32_16x16x32_bf16 v[48:51], a[160:163], v[80:83], v[48:51]
    ds_read_b128 v[88:91], v4 offset:22528
    v_mfma_f32_16x16x32_bf16 v[56:59], a[160:163], v[84:87], v[56:59]
    v_mfma_f32_16x16x32_bf16 v[60:63], a[164:167], v[84:87], v[60:63]
    ds_read_b128 v[92:95], v5 offset:22528
    v_mfma_f32_16x16x32_bf16 v[52:55], a[164:167], v[80:83], v[52:55]
    v_mfma_f32_16x16x32_bf16 v[64:67], a[168:171], v[80:83], v[64:67]
    v_mfma_f32_16x16x32_bf16 v[72:75], a[168:171], v[84:87], v[72:75]
    v_mfma_f32_16x16x32_bf16 v[76:79], a[172:175], v[84:87], v[76:79]
    v_mfma_f32_16x16x32_bf16 v[68:71], a[172:175], v[80:83], v[68:71]
    s_waitcnt lgkmcnt(0)
    v_mfma_f32_16x16x32_bf16 v[48:51], a[176:179], v[88:91], v[48:51]
    ds_read_b128 v[80:83], v4 offset:24576
    v_mfma_f32_16x16x32_bf16 v[56:59], a[176:179], v[92:95], v[56:59]
    v_mfma_f32_16x16x32_bf16 v[60:63], a[180:183], v[92:95], v[60:63]
    ds_read_b128 v[84:87], v5 offset:24576
    v_mfma_f32_16x16x32_bf16 v[52:55], a[180:183], v[88:91], v[52:55]
    v_mfma_f32_16x16x32_bf16 v[64:67], a[184:187], v[88:91], v[64:67]
    v_mfma_f32_16x16x32_bf16 v[72:75], a[184:187], v[92:95], v[72:75]
    v_mfma_f32_16x16x32_bf16 v[76:79], a[188:191], v[92:95], v[76:79]
    v_mfma_f32_16x16x32_bf16 v[68:71], a[188:191], v[88:91], v[68:71]
    s_waitcnt lgkmcnt(0)
    v_mfma_f32_16x16x32_bf16 v[48:51], a[192:195], v[80:83], v[48:51]
    ds_read_b128 v[88:91], v4 offset:26624
    v_mfma_f32_16x16x32_bf16 v[56:59], a[192:195], v[84:87], v[56:59]
    v_mfma_f32_16x16x32_bf16 v[60:63], a[196:199], v[84:87], v[60:63]
    ds_read_b128 v[92:95], v5 offset:26624
    v_mfma_f32_16x16x32_bf16 v[52:55], a[196:199], v[80:83], v[52:55]
    v_mfma_f32_16x16x32_bf16 v[64:67], a[200:203], v[80:83], v[64:67]
    v_mfma_f32_16x16x32_bf16 v[72:75], a[200:203], v[84:87], v[72:75]
    v_mfma_f32_16x16x32_bf16 v[76:79], a[204:207], v[84:87], v[76:79]
    v_mfma_f32_16x16x32_bf16 v[68:71], a[204:207], v[80:83], v[68:71]
    s_waitcnt lgkmcnt(0)
    v_mfma_f32_16x16x32_bf16 v[48:51], a[208:211], v[88:91], v[48:51]
    s_waitcnt vmcnt(0)
    ds_read_b128 v[80:83], v4 offset:28672
    v_cmp_ne_u32 vcc, 0, v96
    v_mfma_f32_16x16x32_bf16 v[56:59], a[208:211], v[92:95], v[56:59]
    v_mfma_f32_16x16x32_bf16 v[60:63], a[212:215], v[92:95], v[60:63]
    s_cbranch_vccnz L_spin62
L_back63:
    ds_read_b128 v[84:87], v5 offset:28672
    s_barrier
    v_mfma_f32_16x16x32_bf16 v[52:55], a[212:215], v[88:91], v[52:55]
    buffer_load_dwordx4 v1, s[16:19], s42 offen offset:0 sc1 lds
    v_mfma_f32_16x16x32_bf16 v[64:67], a[216:219], v[88:91], v[64:67]
    v_mfma_f32_16x16x32_bf16 v[72:75], a[216:219], v[92:95], v[72:75]
    v_mfma_f32_16x16x32_bf16 v[76:79], a[220:223], v[92:95], v[76:79]
    buffer_load_dwordx4 v1, s[16:19], s42 offen offset:1024 sc1 lds
    v_mfma_f32_16x16x32_bf16 v[68:71], a[220:223], v[88:91], v[68:71]
    s_waitcnt lgkmcnt(0)
    v_mfma_f32_16x16x32_bf16 v[48:51], a[224:227], v[80:83], v[48:51]
    ds_read_b128 v[88:91], v4 offset:30720
    v_mfma_f32_16x16x32_bf16 v[56:59], a[224:227], v[84:87], v[56:59]
    buffer_load_dwordx4 v1, s[16:19], s42 offen offset:2048 sc1 lds
    v_mfma_f32_16x16x32_bf16 v[60:63], a[228:231], v[84:87], v[60:63]
    ds_read_b128 v[92:95], v5 offset:30720
    v_mfma_f32_16x16x32_bf16 v[52:55], a[228:231], v[80:83], v[52:55]
    v_mfma_f32_16x16x32_bf16 v[64:67], a[232:235], v[80:83], v[64:67]
    buffer_store_dword v124, v124, s[16:19], s91 offen sc1
    v_mfma_f32_16x16x32_bf16 v[72:75], a[232:235], v[84:87], v[72:75]
    s_add_u32 s91, s91, 65536
    s_add_u32 m0, s43, 12288
    s_add_u32 s42, s41, 12288
    v_mfma_f32_16x16x32_bf16 v[76:79], a[236:239], v[84:87], v[76:79]
    s_add_u32 s39, s91, -163840
    v_mfma_f32_16x16x32_bf16 v[68:71], a[236:239], v[80:83], v[68:71]
    s_waitcnt lgkmcnt(0)
    v_mfma_f32_16x16x32_bf16 v[48:51], a[240:243], v[88:91], v[48:51]
    ds_read_b128 v[80:83], v4 offset:32768
    v_mfma_f32_16x16x32_bf16 v[56:59], a[240:243], v[92:95], v[56:59]
    buffer_store_dword v124, v124, s[16:19], s39 offen sc1
    v_mfma_f32_16x16x32_bf16 v[60:63], a[244:247], v[92:95], v[60:63]
    s_waitcnt vmcnt(6)
    ds_read_b128 v[84:87], v5 offset:32768
    v_mfma_f32_16x16x32_bf16 v[128:131], v[104:107], v[140:143], v[128:131]
    v_mfma_f32_16x16x32_bf16 v[132:135], v[108:111], v[140:143], v[132:135]
    v_mfma_f32_16x16x32_bf16 v[128:131], v[104:107], v[144:147], v[128:131]
    v_mfma_f32_16x16x32_bf16 v[132:135], v[108:111], v[144:147], v[132:135]
    v_mfma_f32_16x16x32_bf16 v[128:131], v[104:107], v[148:151], v[128:131]
    v_mfma_f32_16x16x32_bf16 v[132:135], v[108:111], v[148:151], v[132:135]
    v_mfma_f32_16x16x32_bf16 v[128:131], v[104:107], v[152:155], v[128:131]
    v_mfma_f32_16x16x32_bf16 v[132:135], v[108:111], v[152:155], v[132:135]
    v_mfma_f32_16x16x32_bf16 v[52:55], a[244:247], v[88:91], v[52:55]
    v_mfma_f32_16x16x32_bf16 v[64:67], a[248:251], v[88:91], v[64:67]
    buffer_load_dwordx4 v1, s[16:19], s42 offen offset:0 sc1 lds
    v_mfma_f32_16x16x32_bf16 v[72:75], a[248:251], v[92:95], v[72:75]
    v_cvt_pk_bf16_f32 v140, v128, v129
    v_cvt_pk_bf16_f32 v141, v130, v131
    v_mfma_f32_16x16x32_bf16 v[76:79], a[252:255], v[92:95], v[76:79]
    v_cvt_pk_bf16_f32 v142, v132, v133
    v_cvt_pk_bf16_f32 v143, v134, v135
    v_mfma_f32_16x16x32_bf16 v[68:71], a[252:255], v[88:91], v[68:71]
    s_waitcnt lgkmcnt(0)
    v_mfma_f32_16x16x32_bf16 v[48:51], v[160:163], v[80:83], v[48:51]
    ds_read_b128 v[88:91], v4 offset:34816
    v_mfma_f32_16x16x32_bf16 v[56:59], v[160:163], v[84:87], v[56:59]
    buffer_load_dwordx4 v1, s[16:19], s42 offen offset:1024 sc1 lds
    v_mfma_f32_16x16x32_bf16 v[60:63], v[164:167], v[84:87], v[60:63]
    ds_read_b128 v[92:95], v5 offset:34816
    v_mfma_f32_16x16x32_bf16 v[52:55], v[164:167], v[80:83], v[52:55]
    v_mfma_f32_16x16x32_bf16 v[64:67], v[168:171], v[80:83], v[64:67]
    buffer_store_dwordx4 v[140:143], v9, s[20:23], s48 offen sc1
    v_mfma_f32_16x16x32_bf16 v[72:75], v[168:171], v[84:87], v[72:75]
    v_add_f32 v100, v128, v129
    v_mul_f32 v101, v128, v128
    v_mfma_f32_16x16x32_bf16 v[76:79], v[172:175], v[84:87], v[76:79]
    v_fmac_f32 v101, v129, v129
    v_add_f32 v100, v100, v130
    v_mfma_f32_16x16x32_bf16 v[68:71], v[172:175], v[80:83], v[68:71]
    s_waitcnt lgkmcnt(0)
    v_fmac_f32 v101, v130, v130
    v_add_f32 v100, v100, v131
    v_mfma_f32_16x16x32_bf16 v[48:51], v[176:179], v[88:91], v[48:51]
    ds_read_b128 v[80:83], v4 offset:36864
    v_fmac_f32 v101, v131, v131
    v_mfma_f32_16x16x32_bf16 v[56:59], v[176:179], v[92:95], v[56:59]
    buffer_load_dwordx4 v1, s[16:19], s42 offen offset:2048 sc1 lds
    v_mfma_f32_16x16x32_bf16 v[60:63], v[180:183], v[92:95], v[60:63]
    s_add_u32 m0, s43, 24576
    ds_read_b128 v[84:87], v5 offset:36864
    v_add_f32 v100, v100, v132
    v_mfma_f32_16x16x32_bf16 v[52:55], v[180:183], v[88:91], v[52:55]
    s_add_u32 s42, s41, 24576
    v_fmac_f32 v101, v132, v132
    v_add_f32 v100, v100, v133
    v_mfma_f32_16x16x32_bf16 v[64:67], v[184:187], v[88:91], v[64:67]
    v_fmac_f32 v101, v133, v133
    v_add_f32 v100, v100, v134
    v_mfma_f32_16x16x32_bf16 v[72:75], v[184:187], v[92:95], v[72:75]
    v_fmac_f32 v101, v134, v134
    v_add_f32 v100, v100, v135
    v_mfma_f32_16x16x32_bf16 v[76:79], v[188:191], v[92:95], v[76:79]
    buffer_load_dwordx4 v1, s[16:19], s42 offen offset:0 sc1 lds
    v_mfma_f32_16x16x32_bf16 v[68:71], v[188:191], v[88:91], v[68:71]
    s_waitcnt lgkmcnt(0)
    v_fmac_f32 v101, v135, v135
    v_mfma_f32_16x16x32_bf16 v[48:51], v[192:195], v[80:83], v[48:51]
    ds_read_b128 v[88:91], v4 offset:38912
    v_mfma_f32_16x16x32_bf16 v[56:59], v[192:195], v[84:87], v[56:59]
    v_permlane16_swap_b32 v100, v101
    v_mfma_f32_16x16x32_bf16 v[60:63], v[196:199], v[84:87], v[60:63]
    ds_read_b128 v[92:95], v5 offset:38912
    v_add_f32 v100, v100, v101
    v_mfma_f32_16x16x32_bf16 v[52:55], v[196:199], v[80:83], v[52:55]
    buffer_load_dwordx4 v1, s[16:19], s42 offen offset:1024 sc1 lds
    v_mfma_f32_16x16x32_bf16 v[64:67], v[200:203], v[80:83], v[64:67]
    v_mov_b32 v102, v100
    v_mfma_f32_16x16x32_bf16 v[72:75], v[200:203], v[84:87], v[72:75]
    v_permlane32_swap_b32 v100, v102
    v_mfma_f32_16x16x32_bf16 v[76:79], v[204:207], v[84:87], v[76:79]
    v_add_f32 v100, v100, v102
    v_mfma_f32_16x16x32_bf16 v[68:71], v[204:207], v[80:83], v[68:71]
    s_waitcnt lgkmcnt(0)
    ds_write_b32 v10, v100 offset:0
    v_mfma_f32_16x16x32_bf16 v[48:51], v[208:211], v[88:91], v[48:51]
    s_waitcnt vmcnt(22)
    ds_read_b128 v[80:83], v4 offset:40960
    v_mfma_f32_16x16x32_bf16 v[128:131], v[104:107], v[136:139], v[16:19]
    buffer_load_dwordx4 v1, s[16:19], s42 offen offset:2048 sc1 lds
    v_mfma_f32_16x16x32_bf16 v[56:59], v[208:211], v[92:95], v[56:59]
    v_mfma_f32_16x16x32_bf16 v[132:135], v[108:111], v[136:139], v[20:23]
    s_add_u32 s45, s45, 65536
    v_mfma_f32_16x16x32_bf16 v[60:63], v[212:215], v[92:95], v[60:63]
    ds_read_b128 v[84:87], v5 offset:40960
    v_mfma_f32_16x16x32_bf16 v[52:55], v[212:215], v[88:91], v[52:55]
    v_mfma_f32_16x16x32_bf16 v[64:67], v[216:219], v[88:91], v[64:67]
    v_mfma_f32_16x16x32_bf16 v[72:75], v[216:219], v[92:95], v[72:75]
    v_mfma_f32_16x16x32_bf16 v[76:79], v[220:223], v[92:95], v[76:79]
    v_mfma_f32_16x16x32_bf16 v[68:71], v[220:223], v[88:91], v[68:71]
    s_waitcnt lgkmcnt(0)
    v_mfma_f32_16x16x32_bf16 v[48:51], v[224:227], v[80:83], v[48:51]
    ds_read_b128 v[88:91], v4 offset:43008
    v_mfma_f32_16x16x32_bf16 v[56:59], v[224:227], v[84:87], v[56:59]
    v_mfma_f32_16x16x32_bf16 v[60:63], v[228:231], v[84:87], v[60:63]
    ds_read_b128 v[92:95], v5 offset:43008
    v_mfma_f32_16x16x32_bf16 v[52:55], v[228:231], v[80:83], v[52:55]
    v_mfma_f32_16x16x32_bf16 v[64:67], v[232:235], v[80:83], v[64:67]
    v_mfma_f32_16x16x32_bf16 v[72:75], v[232:235], v[84:87], v[72:75]
    v_mfma_f32_16x16x32_bf16 v[76:79], v[236:239], v[84:87], v[76:79]
    v_mfma_f32_16x16x32_bf16 v[68:71], v[236:239], v[80:83], v[68:71]
    s_waitcnt vmcnt(9) lgkmcnt(0)
    s_barrier
    v_mfma_f32_16x16x32_bf16 v[48:51], v[240:243], v[88:91], v[48:51]
    ds_read_b128 v[80:83], v2 offset:0
    v_mfma_f32_16x16x32_bf16 v[56:59], v[240:243], v[92:95], v[56:59]
    v_mfma_f32_16x16x32_bf16 v[60:63], v[244:247], v[92:95], v[60:63]
    ds_read_b128 v[84:87], v3 offset:0
    v_mfma_f32_16x16x32_bf16 v[52:55], v[244:247], v[88:91], v[52:55]
    v_mfma_f32_16x16x32_bf16 v[64:67], v[248:251], v[88:91], v[64:67]
    v_mfma_f32_16x16x32_bf16 v[72:75], v[248:251], v[92:95], v[72:75]
    v_mfma_f32_16x16x32_bf16 v[76:79], v[252:255], v[92:95], v[76:79]
    v_mfma_f32_16x16x32_bf16 v[68:71], v[252:255], v[88:91], v[68:71]
    s_add_u32 s36, s36, 1
    s_cmp_lt_u32 s36, 32
    s_cbranch_scc1 L_bf_b0
    s_nop 7
    s_sub_u32 s47, s45, 196608
    s_max_u32 s47, s47, 0x5500000
    buffer_load_dword v13, v8, s[16:19], s47 offen sc1
    s_and_b32 s38, s53, 0xffffffff
    s_cmp_lt_i32 s36, 1
    s_cselect_b32 s38, 0x5e00000, s38
    buffer_load_dwordx4 v[136:139], v1, s[16:19], s38 offen sc1
    s_add_u32 s53, s53, 65536
    s_and_b32 s44, s90, 0xffffffff
    s_cmp_lt_i32 s36, 1
    s_cselect_b32 s44, 0x5e00000, s44
    s_xor_b32 s49, s44, 16384
    v_cvt_pk_bf16_f32 v56, v56, v57
    v_cvt_pk_bf16_f32 v57, v58, v59
    v_cvt_pk_bf16_f32 v58, v60, v61
    v_cvt_pk_bf16_f32 v59, v62, v63
    buffer_store_dwordx4 v[56:59], v1, s[16:19], s49 offen offset:0 sc1
    s_xor_b32 s49, s44, 32768
    v_cvt_pk_bf16_f32 v64, v64, v65
    v_cvt_pk_bf16_f32 v65, v66, v67
    v_cvt_pk_bf16_f32 v66, v68, v69
    v_cvt_pk_bf16_f32 v67, v70, v71
    buffer_store_dwordx4 v[64:67], v1, s[16:19], s49 offen offset:1024 sc1
    s_xor_b32 s49, s44, 49152
    v_cvt_pk_bf16_f32 v72, v72, v73
    v_cvt_pk_bf16_f32 v73, v74, v75
    v_cvt_pk_bf16_f32 v74, v76, v77
    v_cvt_pk_bf16_f32 v75, v78, v79
    buffer_store_dwordx4 v[72:75], v1, s[16:19], s49 offen offset:2048 sc1
    s_add_u32 s90, s90, 262144
    s_waitcnt vmcnt(4)
    v_cmp_ne_u32 vcc, 0, v13
    s_cbranch_vccnz L_spin64
L_back65:
    s_barrier
    s_sub_u32 s48, s90, 524288
    s_and_b32 s48, s48, 0xffffffff
    s_cmp_lt_i32 s36, 2
    s_cselect_b32 s48, s52, s48
    buffer_load_dwordx4 v[140:143], v1, s[16:19], s48 offen offset:0 sc1
    buffer_load_dwordx4 v[144:147], v1, s[16:19], s48 offen offset:1024 sc1
    buffer_load_dwordx4 v[148:151], v1, s[16:19], s48 offen offset:2048 sc1
    buffer_load_dwordx4 v[152:155], v1, s[16:19], s48 offen offset:3072 sc1
    s_sub_u32 s47, s36, 2
    s_cmp_lt_u32 s47, 16
    s_cselect_b32 s48, 0x5000000, s52
    s_add_u32 s20, s84, s48
    s_addc_u32 s21, s85, 0
    s_cmp_ge_i32 s47, 16
    s_cselect_b32 s20, s80, s20
    s_cselect_b32 s21, s81, s21
    s_and_b32 s48, s47, 15
    s_lshl_b32 s48, s48, 1
    s_sub_u32 s48, s50, s48
    s_lshl_b32 s46, s48, 10
    s_sub_u32 s46, s55, s46
    s_cmp_lt_u32 s47, 16
    s_cselect_b32 s46, s46, s52
    s_lshl_b32 s48, s48, 15
    s_waitcnt vmcnt(4)
    s_barrier
    buffer_store_dword v124, v124, s[16:19], s91 offen sc1
    s_add_u32 s91, s91, 65536
    s_waitcnt vmcnt(1)
    v_mfma_f32_16x16x32_bf16 v[128:131], v[104:107], v[140:143], v[128:131]
    v_mfma_f32_16x16x32_bf16 v[132:135], v[108:111], v[140:143], v[132:135]
    v_mfma_f32_16x16x32_bf16 v[128:131], v[104:107], v[144:147], v[128:131]
    v_mfma_f32_16x16x32_bf16 v[132:135], v[108:111], v[144:147], v[132:135]
    v_mfma_f32_16x16x32_bf16 v[128:131], v[104:107], v[148:151], v[128:131]
    v_mfma_f32_16x16x32_bf16 v[132:135], v[108:111], v[148:151], v[132:135]
    v_mfma_f32_16x16x32_bf16 v[128:131], v[104:107], v[152:155], v[128:131]
    v_mfma_f32_16x16x32_bf16 v[132:135], v[108:111], v[152:155], v[132:135]
    s_nop 5
    v_cvt_pk_bf16_f32 v140, v128, v129
    v_cvt_pk_bf16_f32 v141, v130, v131
    v_cvt_pk_bf16_f32 v142, v132, v133
    v_cvt_pk_bf16_f32 v143, v134, v135
    buffer_store_dwordx4 v[140:143], v9, s[20:23], s48 offen sc1
    s_waitcnt vmcnt(9)
    v_mfma_f32_16x16x32_bf16 v[128:131], v[104:107], v[136:139], v[48:51]
    v_mfma_f32_16x16x32_bf16 v[132:135], v[108:111], v[136:139], v[52:55]
    s_sub_u32 s47, s45, 131072
    s_max_u32 s47, s47, 0x5500000
    buffer_load_dword v13, v8, s[16:19], s47 offen sc1
    s_waitcnt vmcnt(0)
    v_cmp_ne_u32 vcc, 0, v13
    s_cbranch_vccnz L_spin66
L_back67:
    s_barrier
    s_sub_u32 s48, s90, 262144
    s_and_b32 s48, s48, 0xffffffff
    s_cmp_lt_i32 s36, 1
    s_cselect_b32 s48, s52, s48
    buffer_load_dwordx4 v[140:143], v1, s[16:19], s48 offen offset:0 sc1
    buffer_load_dwordx4 v[144:147], v1, s[16:19], s48 offen offset:1024 sc1
    buffer_load_dwordx4 v[148:151], v1, s[16:19], s48 offen offset:2048 sc1
    buffer_load_dwordx4 v[152:155], v1, s[16:19], s48 offen offset:3072 sc1
    s_sub_u32 s47, s36, 1
    s_cmp_lt_u32 s47, 16
    s_cselect_b32 s48, 0x5000000, s52
    s_add_u32 s20, s84, s48
    s_addc_u32 s21, s85, 0
    s_cmp_ge_i32 s47, 16
    s_cselect_b32 s20, s80, s20
    s_cselect_b32 s21, s81, s21
    s_and_b32 s48, s47, 15
    s_lshl_b32 s48, s48, 1
    s_sub_u32 s48, s50, s48
    s_lshl_b32 s46, s48, 10
    s_sub_u32 s46, s55, s46
    s_cmp_lt_u32 s47, 16
    s_cselect_b32 s46, s46, s52
    s_lshl_b32 s48, s48, 15
    s_waitcnt vmcnt(0)
    v_mfma_f32_16x16x32_bf16 v[128:131], v[104:107], v[140:143], v[128:131]
    v_mfma_f32_16x16x32_bf16 v[132:135], v[108:111], v[140:143], v[132:135]
    v_mfma_f32_16x16x32_bf16 v[128:131], v[104:107], v[144:147], v[128:131]
    v_mfma_f32_16x16x32_bf16 v[132:135], v[108:111], v[144:147], v[132:135]
    v_mfma_f32_16x16x32_bf16 v[128:131], v[104:107], v[148:151], v[128:131]
    v_mfma_f32_16x16x32_bf16 v[132:135], v[108:111], v[148:151], v[132:135]
    v_mfma_f32_16x16x32_bf16 v[128:131], v[104:107], v[152:155], v[128:131]
    v_mfma_f32_16x16x32_bf16 v[132:135], v[108:111], v[152:155], v[132:135]
    s_nop 5
    v_cvt_pk_bf16_f32 v140, v128, v129
    v_cvt_pk_bf16_f32 v141, v130, v131
    v_cvt_pk_bf16_f32 v142, v132, v133
    v_cvt_pk_bf16_f32 v143, v134, v135
    buffer_store_dwordx4 v[140:143], v9, s[20:23], s48 offen sc1
    s_waitcnt vmcnt(0)
    s_endpgm
L_spin44:
    s_mov_b32 s40, 0x20000
L_spin44_l:
    buffer_load_dword v8, v124, s[20:23], 0 offen sc1
    s_sub_u32 s40, s40, 1
    s_waitcnt vmcnt(0)
    v_cmp_eq_u32 vcc, v124, v8
    s_cbranch_scc1 L_back45
    s_cbranch_vccz L_back45
    s_sleep 8
    s_branch L_spin44_l
L_spin47:
    s_mov_b32 s40, 0x20000
L_spin47_l:
    buffer_load_dword v48, v124, s[20:23], 0 offen sc1
    s_sub_u32 s40, s40, 1
    s_waitcnt vmcnt(0)
    v_cmp_eq_u32 vcc, v124, v48
    s_cbranch_scc1 L_back48
    s_cbranch_vccz L_back48
    s_sleep 8
    s_branch L_spin47_l
L_spin49:
    s_mov_b32 s40, 0x20000
L_spin49_l:
    buffer_load_dword v49, v48, s[16:19], s38 offen sc1
    s_sub_u32 s40, s40, 1
    s_waitcnt vmcnt(0)
    v_cmp_ne_u32 vcc, 0, v49
    s_cbranch_scc1 L_back50
    s_cbranch_vccz L_back50
    s_sleep 8
    s_branch L_spin49_l
L_spin52:
    s_mov_b32 s40, 0x20000
L_spin52_l:
    buffer_load_dword v80, v124, s[20:23], 0 offen sc1
    s_sub_u32 s40, s40, 1
    s_waitcnt vmcnt(0)
    v_cmp_eq_u32 vcc, v124, v80
    s_cbranch_scc1 L_back53
    s_cbranch_vccz L_back53
    s_sleep 8
    s_branch L_spin52_l
L_spin54:
    s_mov_b32 s40, 0x20000
L_spin54_l:
    buffer_load_dword v96, v6, s[16:19], s45 offen sc1
    s_sub_u32 s40, s40, 1
    s_waitcnt vmcnt(0)
    v_cmp_ne_u32 vcc, 0, v96
    s_cbranch_scc1 L_back55
    s_cbranch_vccz L_back55
    s_sleep 2
    s_branch L_spin54_l
L_spin56:
    s_mov_b32 s40, 0x20000
L_spin56_l:
    buffer_load_dword v13, v8, s[16:19], s47 offen sc1
    s_sub_u32 s40, s40, 1
    s_waitcnt vmcnt(0)
    v_cmp_ne_u32 vcc, 0, v13
    s_cbranch_scc1 L_back57
    s_cbranch_vccz L_back57
    s_sleep 2
    s_branch L_spin56_l
L_spin58:
    s_mov_b32 s40, 0x20000
L_spin58_l:
    buffer_load_dword v96, v6, s[16:19], s45 offen sc1
    s_sub_u32 s40, s40, 1
    s_waitcnt vmcnt(0)
    v_cmp_ne_u32 vcc, 0, v96
    s_cbranch_scc1 L_back59
    s_cbranch_vccz L_back59
    s_sleep 2
    s_branch L_spin58_l
L_spin60:
    s_mov_b32 s40, 0x20000
L_spin60_l:
    buffer_load_dword v13, v8, s[16:19], s47 offen sc1
    s_sub_u32 s40, s40, 1
    s_waitcnt vmcnt(0)
    v_cmp_ne_u32 vcc, 0, v13
    s_cbranch_scc1 L_back61
    s_cbranch_vccz L_back61
    s_sleep 2
    s_branch L_spin60_l
L_spin62:
    s_mov_b32 s40, 0x20000
L_spin62_l:
    buffer_load_dword v96, v6, s[16:19], s45 offen sc1
    s_sub_u32 s40, s40, 1
    s_waitcnt vmcnt(0)
    v_cmp_ne_u32 vcc, 0, v96
    s_cbranch_scc1 L_back63
    s_cbranch_vccz L_back63
    s_sleep 2
    s_branch L_spin62_l
L_spin64:
    s_mov_b32 s40, 0x20000
L_spin64_l:
    buffer_load_dword v13, v8, s[16:19], s47 offen sc1
    s_sub_u32 s40, s40, 1
    s_waitcnt vmcnt(0)
    v_cmp_ne_u32 vcc, 0, v13
    s_cbranch_scc1 L_back65
    s_cbranch_vccz L_back65
    s_sleep 2
    s_branch L_spin64_l
L_spin66:
    s_mov_b32 s40, 0x20000
L_spin66_l:
    buffer_load_dword v13, v8, s[16:19], s47 offen sc1
    s_sub_u32 s40, s40, 1
    s_waitcnt vmcnt(0)
    v_cmp_ne_u32 vcc, 0, v13
    s_cbranch_scc1 L_back67
    s_cbranch_vccz L_back67
    s_sleep 2
    s_branch L_spin66_l
L_role_60:
    s_sub_u32 s35, s34, 44
    s_lshr_b32 s51, s35, 2
    s_and_b32 s87, s35, 3
    s_mul_i32 s54, s51, 1441792
    s_lshl_b32 s37, s87, 9
    s_add_u32 s54, s54, s37
    s_mov_b32 s12, s76
    s_mov_b32 s13, s77
    s_mov_b32 s14, 0x700000
    s_mov_b32 s15, 0x00020000
    s_mov_b32 s39, 2048
    s_cmp_lg_u32 s32, 0
    s_cbranch_scc1 L_arv68
    s_add_u32 s20, s82, 0x80
    s_addc_u32 s21, s83, 0
    s_mov_b32 s22, 0x4
    s_mov_b32 s23, 0x00020000
    buffer_load_dword v48, v124, s[20:23], 0 offen sc1
    s_waitcnt vmcnt(0)
    v_cmp_eq_u32 vcc, v124, v48
    s_cbranch_vccnz L_spin69
L_back70:
L_arv68:
    s_and_b32 s38, s34, 15
    s_lshl_b32 s37, s33, 6
    s_add_u32 s37, s37, s38
    s_lshl_b32 s37, s37, 7
    v_lshl_add_u32 v48, v0, 7, s37
    s_cmp_eq_u32 s32, 0
    s_cselect_b32 s37, 1, 0
    v_cmp_le_u32 vcc, s37, v0
    s_nop 1
    v_cndmask_b32 v48, v48, 2.0, vcc
    s_mov_b32 s38, 0x5520000
    buffer_load_dword v49, v48, s[16:19], s38 offen sc1
    s_waitcnt vmcnt(0)
    v_cmp_ne_u32 vcc, 0, v49
    s_cbranch_vccnz L_spin71
L_back72:
    s_barrier
    v_lshrrev_b32 v64, 3, v0
    v_lshlrev_b32 v65, 2, v0
    v_and_b32 v65, 64, v65
    v_and_b32 v66, 0x70, v1
    v_xor_b32 v65, v65, v66
    v_mad_u32_u24 v48, v64, s39, v65
    v_add_u32 v49, 16384, v48
    v_add_u32 v50, 128, v48
    v_add_u32 v51, 16512, v48
    v_add_u32 v52, 256, v48
    v_add_u32 v53, 16640, v48
    v_add_u32 v54, 384, v48
    v_add_u32 v55, 16768, v48
    s_mul_i32 s38, s32, 32768
    s_add_u32 s54, s54, s38
    s_lshl_b32 s42, s32, 11
    s_add_u32 m0, s42, 0
    s_nop 0
    buffer_load_dwordx4 v48, s[12:15], s54 offen lds
    s_add_u32 m0, s42, 1024
    s_nop 0
    buffer_load_dwordx4 v49, s[12:15], s54 offen lds
    s_add_u32 m0, s42, 8192
    s_nop 0
    buffer_load_dwordx4 v50, s[12:15], s54 offen lds
    s_add_u32 m0, s42, 9216
    s_nop 0
    buffer_load_dwordx4 v51, s[12:15], s54 offen lds
    s_add_u32 m0, s42, 16384
    s_nop 0
    buffer_load_dwordx4 v52, s[12:15], s54 offen lds
    s_add_u32 m0, s42, 17408
    s_nop 0
    buffer_load_dwordx4 v53, s[12:15], s54 offen lds
    s_add_u32 m0, s42, 24576
    s_nop 0
    buffer_load_dwordx4 v54, s[12:15], s54 offen lds
    s_add_u32 m0, s42, 25600
    s_nop 0
    buffer_load_dwordx4 v55, s[12:15], s54 offen lds
    s_add_u32 s54, s54, 131072
    s_add_u32 m0, s42, 32768
    s_nop 0
    buffer_load_dwordx4 v48, s[12:15], s54 offen lds
    s_add_u32 m0, s42, 33792
    s_nop 0
    buffer_load_dwordx4 v49, s[12:15], s54 offen lds
    s_add_u32 m0, s42, 40960
    s_nop 0
    buffer_load_dwordx4 v50, s[12:15], s54 offen lds
    s_add_u32 m0, s42, 41984
    s_nop 0
    buffer_load_dwordx4 v51, s[12:15], s54 offen lds
    s_add_u32 m0, s42, 49152
    s_nop 0
    buffer_load_dwordx4 v52, s[12:15], s54 offen lds
    s_add_u32 m0, s42, 50176
    s_nop 0
    buffer_load_dwordx4 v53, s[12:15], s54 offen lds
    s_add_u32 m0, s42, 57344
    s_nop 0
    buffer_load_dwordx4 v54, s[12:15], s54 offen lds
    s_add_u32 m0, s42, 58368
    s_nop 0
    buffer_load_dwordx4 v55, s[12:15], s54 offen lds
    s_add_u32 s54, s54, 131072
    s_add_u32 m0, s42, 65536
    s_nop 0
    buffer_load_dwordx4 v48, s[12:15], s54 offen lds
    s_add_u32 m0, s42, 66560
    s_nop 0
    buffer_load_dwordx4 v49, s[12:15], s54 offen lds
    s_add_u32 m0, s42, 73728
    s_nop 0
    buffer_load_dwordx4 v50, s[12:15], s54 offen lds
    s_add_u32 m0, s42, 74752
    s_nop 0
    buffer_load_dwordx4 v51, s[12:15], s54 offen lds
    s_add_u32 m0, s42, 81920
    s_nop 0
    buffer_load_dwordx4 v52, s[12:15], s54 offen lds
    s_add_u32 m0, s42, 82944
    s_nop 0
    buffer_load_dwordx4 v53, s[12:15], s54 offen lds
    s_add_u32 m0, s42, 90112
    s_nop 0
    buffer_load_dwordx4 v54, s[12:15], s54 offen lds
    s_add_u32 m0, s42, 91136
    s_nop 0
    buffer_load_dwordx4 v55, s[12:15], s54 offen lds
    s_add_u32 s54, s54, 131072
    s_add_u32 m0, s42, 98304
    s_nop 0
    buffer_load_dwordx4 v48, s[12:15], s54 offen lds
    s_add_u32 m0, s42, 99328
    s_nop 0
    buffer_load_dwordx4 v49, s[12:15], s54 offen lds
    s_add_u32 m0, s42, 106496
    s_nop 0
    buffer_load_dwordx4 v50, s[12:15], s54 offen lds
    s_add_u32 m0, s42, 107520
    s_nop 0
    buffer_load_dwordx4 v51, s[12:15], s54 offen lds
    s_add_u32 m0, s42, 114688
    s_nop 0
    buffer_load_dwordx4 v52, s[12:15], s54 offen lds
    s_add_u32 m0, s42, 115712
    s_nop 0
    buffer_load_dwordx4 v53, s[12:15], s54 offen lds
    s_add_u32 m0, s42, 122880
    s_nop 0
    buffer_load_dwordx4 v54, s[12:15], s54 offen lds
    s_add_u32 m0, s42, 123904
    s_nop 0
    buffer_load_dwordx4 v55, s[12:15], s54 offen lds
    s_add_u32 s54, s54, 131072
    v_lshrrev_b32 v64, 4, v0
    v_bfe_u32 v65, v0, 2, 2
    v_lshl_add_u32 v64, v64, 3, v65
    v_lshlrev_b32 v64, 7, v64
    v_lshrrev_b32 v65, 1, v65
    v_lshl_add_u32 v64, v65, 6, v64
    v_and_b32 v65, 3, v0
    v_lshl_add_u32 v64, v65, 4, v64
    s_lshl_b32 s37, s32, 13
    s_and_b32 s38, s51, 2
    s_lshl_b32 s38, s38, 5
    s_xor_b32 s38, s38, 0
    s_add_u32 s37, s37, s38
    v_xor_b32 v56, s37, v64
    s_lshl_b32 s37, s32, 13
    s_and_b32 s38, s51, 2
    s_lshl_b32 s38, s38, 5
    s_xor_b32 s38, s38, 8
    s_add_u32 s37, s37, s38
    v_xor_b32 v57, s37, v64
    s_lshl_b32 s37, s32, 13
    s_and_b32 s38, s51, 2
    s_lshl_b32 s38, s38, 5
    s_xor_b32 s38, s38, 64
    s_add_u32 s37, s37, s38
    v_xor_b32 v58, s37, v64
    s_lshl_b32 s37, s32, 13
    s_and_b32 s38, s51, 2
    s_lshl_b32 s38, s38, 5
    s_xor_b32 s38, s38, 72
    s_add_u32 s37, s37, s38
    v_xor_b32 v59, s37, v64
    s_and_b32 s39, s51, 1
    s_lshl_b32 s37, s39, 10
    v_add_u32 v2, s37, v1
    v_xor_b32 v3, 1024, v2
    v_add_u32 v4, 98304, v2
    v_add_u32 v5, 98304, v3
    s_mul_i32 s38, s51, 11*43
    s_lshr_b32 s38, s38, 7
    s_add_u32 s38, s38, 24
    s_lshl_b32 s37, s33, 6
    s_add_u32 s37, s37, s38
    s_lshl_b32 s37, s37, 7
    v_lshl_add_u32 v6, v0, 7, s37
    s_cmp_eq_u32 s32, 0
    s_cselect_b32 s37, 6, 0
    v_cmp_le_u32 vcc, s37, v0
    s_nop 1
    v_cndmask_b32 v6, v6, 2.0, vcc
    s_mul_i32 s43, s32, 3072
    s_lshl_b32 s88, s32, 11
    s_sub_u32 s89, s88, s43
    s_mul_i32 s41, s33, 8388608
    s_add_u32 s41, s41, 0x1000000
    s_mul_i32 s37, s51, 45056
    s_add_u32 s41, s41, s37
    s_add_u32 s41, s41, s43
    s_mul_i32 s90, s33, 8388608
    s_add_u32 s90, s90, 0x2fc0000
    s_lshl_b32 s37, s87, 16
    s_add_u32 s90, s90, s37
    s_lshl_b32 s37, s32, 12
    s_add_u32 s90, s90, s37
    s_and_b32 s37, s51, 3
    s_lshl_b32 s37, s37, 14
    s_add_u32 s90, s90, s37
    v_add_u32 v60, 0, v56
    v_add_u32 v61, 0, v57
    v_add_u32 v62, 0, v58
    v_add_u32 v63, 0, v59
    s_waitcnt vmcnt(24)
    s_barrier
    ds_read_b64_tr_b16 a[0:1], v60 offset:0
    ds_read_b64_tr_b16 a[2:3], v60 offset:512
    ds_read_b64_tr_b16 a[4:5], v61 offset:0
    ds_read_b64_tr_b16 a[6:7], v61 offset:512
    ds_read_b64_tr_b16 a[8:9], v62 offset:0
    ds_read_b64_tr_b16 a[10:11], v62 offset:512
    ds_read_b64_tr_b16 a[12:13], v63 offset:0
    ds_read_b64_tr_b16 a[14:15], v63 offset:512
    ds_read_b64_tr_b16 a[16:17], v60 offset:4096
    ds_read_b64_tr_b16 a[18:19], v60 offset:4608
    ds_read_b64_tr_b16 a[20:21], v61 offset:4096
    ds_read_b64_tr_b16 a[22:23], v61 offset:4608
    ds_read_b64_tr_b16 a[24:25], v62 offset:4096
    ds_read_b64_tr_b16 a[26:27], v62 offset:4608
    ds_read_b64_tr_b16 a[28:29], v63 offset:4096
    ds_read_b64_tr_b16 a[30:31], v63 offset:4608
    s_add_u32 m0, s42, 131072
    s_nop 0
    buffer_load_dwordx4 v48, s[12:15], s54 offen lds
    s_add_u32 m0, s42, 132096
    s_nop 0
    buffer_load_dwordx4 v49, s[12:15], s54 offen lds
    s_add_u32 m0, s42, 139264
    s_nop 0
    buffer_load_dwordx4 v50, s[12:15], s54 offen lds
    s_add_u32 m0, s42, 140288
    s_nop 0
    buffer_load_dwordx4 v51, s[12:15], s54 offen lds
    s_add_u32 m0, s42, 147456
    s_nop 0
    buffer_load_dwordx4 v52, s[12:15], s54 offen lds
    s_add_u32 m0, s42, 148480
    s_nop 0
    buffer_load_dwordx4 v53, s[12:15], s54 offen lds
    s_add_u32 m0, s42, 155648
    s_nop 0
    buffer_load_dwordx4 v54, s[12:15], s54 offen lds
    s_add_u32 m0, s42, 156672
    s_nop 0
    buffer_load_dwordx4 v55, s[12:15], s54 offen lds
    s_add_u32 s54, s54, 131072
    s_waitcnt lgkmcnt(0)
    v_add_u32 v60, 32768, v56
    v_add_u32 v61, 32768, v57
    v_add_u32 v62, 32768, v58
    v_add_u32 v63, 32768, v59
    s_waitcnt vmcnt(24)
    s_barrier
    ds_read_b64_tr_b16 a[32:33], v60 offset:0
    ds_read_b64_tr_b16 a[34:35], v60 offset:512
    ds_read_b64_tr_b16 a[36:37], v61 offset:0
    ds_read_b64_tr_b16 a[38:39], v61 offset:512
    ds_read_b64_tr_b16 a[40:41], v62 offset:0
    ds_read_b64_tr_b16 a[42:43], v62 offset:512
    ds_read_b64_tr_b16 a[44:45], v63 offset:0
    ds_read_b64_tr_b16 a[46:47], v63 offset:512
    ds_read_b64_tr_b16 a[48:49], v60 offset:4096
    ds_read_b64_tr_b16 a[50:51], v60 offset:4608
    ds_read_b64_tr_b16 a[52:53], v61 offset:4096
    ds_read_b64_tr_b16 a[54:55], v61 offset:4608
    ds_read_b64_tr_b16 a[56:57], v62 offset:4096
    ds_read_b64_tr_b16 a[58:59], v62 offset:4608
    ds_read_b64_tr_b16 a[60:61], v63 offset:4096
    ds_read_b64_tr_b16 a[62:63], v63 offset:4608
    s_add_u32 m0, s42, 0
    s_nop 0
    buffer_load_dwordx4 v48, s[12:15], s54 offen lds
    s_add_u32 m0, s42, 1024
    s_nop 0
    buffer_load_dwordx4 v49, s[12:15], s54 offen lds
    s_add_u32 m0, s42, 8192
    s_nop 0
    buffer_load_dwordx4 v50, s[12:15], s54 offen lds
    s_add_u32 m0, s42, 9216
    s_nop 0
    buffer_load_dwordx4 v51, s[12:15], s54 offen lds
    s_add_u32 m0, s42, 16384
    s_nop 0
    buffer_load_dwordx4 v52, s[12:15], s54 offen lds
    s_add_u32 m0, s42, 17408
    s_nop 0
    buffer_load_dwordx4 v53, s[12:15], s54 offen lds
    s_add_u32 m0, s42, 24576
    s_nop 0
    buffer_load_dwordx4 v54, s[12:15], s54 offen lds
    s_add_u32 m0, s42, 25600
    s_nop 0
    buffer_load_dwordx4 v55, s[12:15], s54 offen lds
    s_add_u32 s54, s54, 131072
    s_waitcnt lgkmcnt(0)
    v_add_u32 v60, 65536, v56
    v_add_u32 v61, 65536, v57
    v_add_u32 v62, 65536, v58
    v_add_u32 v63, 65536, v59
    s_waitcnt vmcnt(24)
    s_barrier
    ds_read_b64_tr_b16 a[64:65], v60 offset:0
    ds_read_b64_tr_b16 a[66:67], v60 offset:512
    ds_read_b64_tr_b16 a[68:69], v61 offset:0
    ds_read_b64_tr_b16 a[70:71], v61 offset:512
    ds_read_b64_tr_b16 a[72:73], v62 offset:0
    ds_read_b64_tr_b16 a[74:75], v62 offset:512
    ds_read_b64_tr_b16 a[76:77], v63 offset:0
    ds_read_b64_tr_b16 a[78:79], v63 offset:512
    ds_read_b64_tr_b16 a[80:81], v60 offset:4096
    ds_read_b64_tr_b16 a[82:83], v60 offset:4608
    ds_read_b64_tr_b16 a[84:85], v61 offset:4096
    ds_read_b64_tr_b16 a[86:87], v61 offset:4608
    ds_read_b64_tr_b16 a[88:89], v62 offset:4096
    ds_read_b64_tr_b16 a[90:91], v62 offset:4608
    ds_read_b64_tr_b16 a[92:93], v63 offset:4096
    ds_read_b64_tr_b16 a[94:95], v63 offset:4608
    s_add_u32 m0, s42, 32768
    s_nop 0
    buffer_load_dwordx4 v48, s[12:15], s54 offen lds
    s_add_u32 m0, s42, 33792
    s_nop 0
    buffer_load_dwordx4 v49, s[12:15], s54 offen lds
    s_add_u32 m0, s42, 40960
    s_nop 0
    buffer_load_dwordx4 v50, s[12:15], s54 offen lds
    s_add_u32 m0, s42, 41984
    s_nop 0
    buffer_load_dwordx4 v51, s[12:15], s54 offen lds
    s_add_u32 m0, s42, 49152
    s_nop 0
    buffer_load_dwordx4 v52, s[12:15], s54 offen lds
    s_add_u32 m0, s42, 50176
    s_nop 0
    buffer_load_dwordx4 v53, s[12:15], s54 offen lds
    s_add_u32 m0, s42, 57344
    s_nop 0
    buffer_load_dwordx4 v54, s[12:15], s54 offen lds
    s_add_u32 m0, s42, 58368
    s_nop 0
    buffer_load_dwordx4 v55, s[12:15], s54 offen lds
    s_add_u32 s54, s54, 131072
    s_waitcnt lgkmcnt(0)
    v_add_u32 v60, 98304, v56
    v_add_u32 v61, 98304, v57
    v_add_u32 v62, 98304, v58
    v_add_u32 v63, 98304, v59
    s_waitcnt vmcnt(24)
    s_barrier
    ds_read_b64_tr_b16 a[96:97], v60 offset:0
    ds_read_b64_tr_b16 a[98:99], v60 offset:512
    ds_read_b64_tr_b16 a[100:101], v61 offset:0
    ds_read_b64_tr_b16 a[102:103], v61 offset:512
    ds_read_b64_tr_b16 a[104:105], v62 offset:0
    ds_read_b64_tr_b16 a[106:107], v62 offset:512
    ds_read_b64_tr_b16 a[108:109], v63 offset:0
    ds_read_b64_tr_b16 a[110:111], v63 offset:512
    ds_read_b64_tr_b16 a[112:113], v60 offset:4096
    ds_read_b64_tr_b16 a[114:115], v60 offset:4608
    ds_read_b64_tr_b16 a[116:117], v61 offset:4096
    ds_read_b64_tr_b16 a[118:119], v61 offset:4608
    ds_read_b64_tr_b16 a[120:121], v62 offset:4096
    ds_read_b64_tr_b16 a[122:123], v62 offset:4608
    ds_read_b64_tr_b16 a[124:125], v63 offset:4096
    ds_read_b64_tr_b16 a[126:127], v63 offset:4608
    s_add_u32 m0, s42, 65536
    s_nop 0
    buffer_load_dwordx4 v48, s[12:15], s54 offen lds
    s_add_u32 m0, s42, 66560
    s_nop 0
    buffer_load_dwordx4 v49, s[12:15], s54 offen lds
    s_add_u32 m0, s42, 73728
    s_nop 0
    buffer_load_dwordx4 v50, s[12:15], s54 offen lds
    s_add_u32 m0, s42, 74752
    s_nop 0
    buffer_load_dwordx4 v51, s[12:15], s54 offen lds
    s_add_u32 m0, s42, 81920
    s_nop 0
    buffer_load_dwordx4 v52, s[12:15], s54 offen lds
    s_add_u32 m0, s42, 82944
    s_nop 0
    buffer_load_dwordx4 v53, s[12:15], s54 offen lds
    s_add_u32 m0, s42, 90112
    s_nop 0
    buffer_load_dwordx4 v54, s[12:15], s54 offen lds
    s_add_u32 m0, s42, 91136
    s_nop 0
    buffer_load_dwordx4 v55, s[12:15], s54 offen lds
    s_add_u32 s54, s54, 131072
    s_waitcnt lgkmcnt(0)
    v_add_u32 v60, 131072, v56
    v_add_u32 v61, 131072, v57
    v_add_u32 v62, 131072, v58
    v_add_u32 v63, 131072, v59
    s_waitcnt vmcnt(24)
    s_barrier
    ds_read_b64_tr_b16 a[128:129], v60 offset:0
    ds_read_b64_tr_b16 a[130:131], v60 offset:512
    ds_read_b64_tr_b16 a[132:133], v61 offset:0
    ds_read_b64_tr_b16 a[134:135], v61 offset:512
    ds_read_b64_tr_b16 a[136:137], v62 offset:0
    ds_read_b64_tr_b16 a[138:139], v62 offset:512
    ds_read_b64_tr_b16 a[140:141], v63 offset:0
    ds_read_b64_tr_b16 a[142:143], v63 offset:512
    ds_read_b64_tr_b16 a[144:145], v60 offset:4096
    ds_read_b64_tr_b16 a[146:147], v60 offset:4608
    ds_read_b64_tr_b16 a[148:149], v61 offset:4096
    ds_read_b64_tr_b16 a[150:151], v61 offset:4608
    ds_read_b64_tr_b16 a[152:153], v62 offset:4096
    ds_read_b64_tr_b16 a[154:155], v62 offset:4608
    ds_read_b64_tr_b16 a[156:157], v63 offset:4096
    ds_read_b64_tr_b16 a[158:159], v63 offset:4608
    s_add_u32 m0, s42, 98304
    s_nop 0
    buffer_load_dwordx4 v48, s[12:15], s54 offen lds
    s_add_u32 m0, s42, 99328
    s_nop 0
    buffer_load_dwordx4 v49, s[12:15], s54 offen lds
    s_add_u32 m0, s42, 106496
    s_nop 0
    buffer_load_dwordx4 v50, s[12:15], s54 offen lds
    s_add_u32 m0, s42, 107520
    s_nop 0
    buffer_load_dwordx4 v51, s[12:15], s54 offen lds
    s_add_u32 m0, s42, 114688
    s_nop 0
    buffer_load_dwordx4 v52, s[12:15], s54 offen lds
    s_add_u32 m0, s42, 115712
    s_nop 0
    buffer_load_dwordx4 v53, s[12:15], s54 offen lds
    s_add_u32 m0, s42, 122880
    s_nop 0
    buffer_load_dwordx4 v54, s[12:15], s54 offen lds
    s_add_u32 m0, s42, 123904
    s_nop 0
    buffer_load_dwordx4 v55, s[12:15], s54 offen lds
    s_add_u32 s54, s54, 131072
    s_waitcnt lgkmcnt(0)
    v_add_u32 v60, 0, v56
    v_add_u32 v61, 0, v57
    v_add_u32 v62, 0, v58
    v_add_u32 v63, 0, v59
    s_waitcnt vmcnt(24)
    s_barrier
    ds_read_b64_tr_b16 a[160:161], v60 offset:0
    ds_read_b64_tr_b16 a[162:163], v60 offset:512
    ds_read_b64_tr_b16 a[164:165], v61 offset:0
    ds_read_b64_tr_b16 a[166:167], v61 offset:512
    ds_read_b64_tr_b16 a[168:169], v62 offset:0
    ds_read_b64_tr_b16 a[170:171], v62 offset:512
    ds_read_b64_tr_b16 a[172:173], v63 offset:0
    ds_read_b64_tr_b16 a[174:175], v63 offset:512
    ds_read_b64_tr_b16 a[176:177], v60 offset:4096
    ds_read_b64_tr_b16 a[178:179], v60 offset:4608
    ds_read_b64_tr_b16 a[180:181], v61 offset:4096
    ds_read_b64_tr_b16 a[182:183], v61 offset:4608
    ds_read_b64_tr_b16 a[184:185], v62 offset:4096
    ds_read_b64_tr_b16 a[186:187], v62 offset:4608
    ds_read_b64_tr_b16 a[188:189], v63 offset:4096
    ds_read_b64_tr_b16 a[190:191], v63 offset:4608
    s_add_u32 m0, s42, 131072
    s_nop 0
    buffer_load_dwordx4 v48, s[12:15], s54 offen lds
    s_add_u32 m0, s42, 132096
    s_nop 0
    buffer_load_dwordx4 v49, s[12:15], s54 offen lds
    s_add_u32 m0, s42, 139264
    s_nop 0
    buffer_load_dwordx4 v50, s[12:15], s54 offen lds
    s_add_u32 m0, s42, 140288
    s_nop 0
    buffer_load_dwordx4 v51, s[12:15], s54 offen lds
    s_add_u32 m0, s42, 147456
    s_nop 0
    buffer_load_dwordx4 v52, s[12:15], s54 offen lds
    s_add_u32 m0, s42, 148480
    s_nop 0
    buffer_load_dwordx4 v53, s[12:15], s54 offen lds
    s_add_u32 m0, s42, 155648
    s_nop 0
    buffer_load_dwordx4 v54, s[12:15], s54 offen lds
    s_add_u32 m0, s42, 156672
    s_nop 0
    buffer_load_dwordx4 v55, s[12:15], s54 offen lds
    s_add_u32 s54, s54, 131072
    s_waitcnt lgkmcnt(0)
    v_add_u32 v60, 32768, v56
    v_add_u32 v61, 32768, v57
    v_add_u32 v62, 32768, v58
    v_add_u32 v63, 32768, v59
    s_waitcnt vmcnt(24)
    s_barrier
    ds_read_b64_tr_b16 a[192:193], v60 offset:0
    ds_read_b64_tr_b16 a[194:195], v60 offset:512
    ds_read_b64_tr_b16 a[196:197], v61 offset:0
    ds_read_b64_tr_b16 a[198:199], v61 offset:512
    ds_read_b64_tr_b16 a[200:201], v62 offset:0
    ds_read_b64_tr_b16 a[202:203], v62 offset:512
    ds_read_b64_tr_b16 a[204:205], v63 offset:0
    ds_read_b64_tr_b16 a[206:207], v63 offset:512
    ds_read_b64_tr_b16 a[208:209], v60 offset:4096
    ds_read_b64_tr_b16 a[210:211], v60 offset:4608
    ds_read_b64_tr_b16 a[212:213], v61 offset:4096
    ds_read_b64_tr_b16 a[214:215], v61 offset:4608
    ds_read_b64_tr_b16 a[216:217], v62 offset:4096
    ds_read_b64_tr_b16 a[218:219], v62 offset:4608
    ds_read_b64_tr_b16 a[220:221], v63 offset:4096
    ds_read_b64_tr_b16 a[222:223], v63 offset:4608
    s_add_u32 m0, s42, 0
    s_nop 0
    buffer_load_dwordx4 v48, s[12:15], s54 offen lds
    s_add_u32 m0, s42, 1024
    s_nop 0
    buffer_load_dwordx4 v49, s[12:15], s54 offen lds
    s_add_u32 m0, s42, 8192
    s_nop 0
    buffer_load_dwordx4 v50, s[12:15], s54 offen lds
    s_add_u32 m0, s42, 9216
    s_nop 0
    buffer_load_dwordx4 v51, s[12:15], s54 offen lds
    s_add_u32 m0, s42, 16384
    s_nop 0
    buffer_load_dwordx4 v52, s[12:15], s54 offen lds
    s_add_u32 m0, s42, 17408
    s_nop 0
    buffer_load_dwordx4 v53, s[12:15], s54 offen lds
    s_add_u32 m0, s42, 24576
    s_nop 0
    buffer_load_dwordx4 v54, s[12:15], s54 offen lds
    s_add_u32 m0, s42, 25600
    s_nop 0
    buffer_load_dwordx4 v55, s[12:15], s54 offen lds
    s_add_u32 s54, s54, 131072
    s_waitcnt lgkmcnt(0)
    v_add_u32 v60, 65536, v56
    v_add_u32 v61, 65536, v57
    v_add_u32 v62, 65536, v58
    v_add_u32 v63, 65536, v59
    s_waitcnt vmcnt(24)
    s_barrier
    ds_read_b64_tr_b16 a[224:225], v60 offset:0
    ds_read_b64_tr_b16 a[226:227], v60 offset:512
    ds_read_b64_tr_b16 a[228:229], v61 offset:0
    ds_read_b64_tr_b16 a[230:231], v61 offset:512
    ds_read_b64_tr_b16 a[232:233], v62 offset:0
    ds_read_b64_tr_b16 a[234:235], v62 offset:512
    ds_read_b64_tr_b16 a[236:237], v63 offset:0
    ds_read_b64_tr_b16 a[238:239], v63 offset:512
    ds_read_b64_tr_b16 a[240:241], v60 offset:4096
    ds_read_b64_tr_b16 a[242:243], v60 offset:4608
    ds_read_b64_tr_b16 a[244:245], v61 offset:4096
    ds_read_b64_tr_b16 a[246:247], v61 offset:4608
    ds_read_b64_tr_b16 a[248:249], v62 offset:4096
    ds_read_b64_tr_b16 a[250:251], v62 offset:4608
    ds_read_b64_tr_b16 a[252:253], v63 offset:4096
    ds_read_b64_tr_b16 a[254:255], v63 offset:4608
    s_add_u32 m0, s42, 32768
    s_nop 0
    buffer_load_dwordx4 v48, s[12:15], s54 offen lds
    s_add_u32 m0, s42, 33792
    s_nop 0
    buffer_load_dwordx4 v49, s[12:15], s54 offen lds
    s_add_u32 m0, s42, 40960
    s_nop 0
    buffer_load_dwordx4 v50, s[12:15], s54 offen lds
    s_add_u32 m0, s42, 41984
    s_nop 0
    buffer_load_dwordx4 v51, s[12:15], s54 offen lds
    s_add_u32 m0, s42, 49152
    s_nop 0
    buffer_load_dwordx4 v52, s[12:15], s54 offen lds
    s_add_u32 m0, s42, 50176
    s_nop 0
    buffer_load_dwordx4 v53, s[12:15], s54 offen lds
    s_add_u32 m0, s42, 57344
    s_nop 0
    buffer_load_dwordx4 v54, s[12:15], s54 offen lds
    s_add_u32 m0, s42, 58368
    s_nop 0
    buffer_load_dwordx4 v55, s[12:15], s54 offen lds
    s_add_u32 s54, s54, 131072
    s_waitcnt lgkmcnt(0)
    v_add_u32 v60, 98304, v56
    v_add_u32 v61, 98304, v57
    v_add_u32 v62, 98304, v58
    v_add_u32 v63, 98304, v59
    s_waitcnt vmcnt(24)
    s_barrier
    ds_read_b64_tr_b16 v[128:129], v60 offset:0
    ds_read_b64_tr_b16 v[130:131], v60 offset:512
    ds_read_b64_tr_b16 v[132:133], v61 offset:0
    ds_read_b64_tr_b16 v[134:135], v61 offset:512
    ds_read_b64_tr_b16 v[136:137], v62 offset:0
    ds_read_b64_tr_b16 v[138:139], v62 offset:512
    ds_read_b64_tr_b16 v[140:141], v63 offset:0
    ds_read_b64_tr_b16 v[142:143], v63 offset:512
    ds_read_b64_tr_b16 v[144:145], v60 offset:4096
    ds_read_b64_tr_b16 v[146:147], v60 offset:4608
    ds_read_b64_tr_b16 v[148:149], v61 offset:4096
    ds_read_b64_tr_b16 v[150:151], v61 offset:4608
    ds_read_b64_tr_b16 v[152:153], v62 offset:4096
    ds_read_b64_tr_b16 v[154:155], v62 offset:4608
    ds_read_b64_tr_b16 v[156:157], v63 offset:4096
    ds_read_b64_tr_b16 v[158:159], v63 offset:4608
    s_waitcnt lgkmcnt(0)
    v_add_u32 v60, 131072, v56
    v_add_u32 v61, 131072, v57
    v_add_u32 v62, 131072, v58
    v_add_u32 v63, 131072, v59
    s_waitcnt vmcnt(16)
    s_barrier
    ds_read_b64_tr_b16 v[160:161], v60 offset:0
    ds_read_b64_tr_b16 v[162:163], v60 offset:512
    ds_read_b64_tr_b16 v[164:165], v61 offset:0
    ds_read_b64_tr_b16 v[166:167], v61 offset:512
    ds_read_b64_tr_b16 v[168:169], v62 offset:0
    ds_read_b64_tr_b16 v[170:171], v62 offset:512
    ds_read_b64_tr_b16 v[172:173], v63 offset:0
    ds_read_b64_tr_b16 v[174:175], v63 offset:512
    ds_read_b64_tr_b16 v[176:177], v60 offset:4096
    ds_read_b64_tr_b16 v[178:179], v60 offset:4608
    ds_read_b64_tr_b16 v[180:181], v61 offset:4096
    ds_read_b64_tr_b16 v[182:183], v61 offset:4608
    ds_read_b64_tr_b16 v[184:185], v62 offset:4096
    ds_read_b64_tr_b16 v[186:187], v62 offset:4608
    ds_read_b64_tr_b16 v[188:189], v63 offset:4096
    ds_read_b64_tr_b16 v[190:191], v63 offset:4608
    s_waitcnt lgkmcnt(0)
    v_add_u32 v60, 0, v56
    v_add_u32 v61, 0, v57
    v_add_u32 v62, 0, v58
    v_add_u32 v63, 0, v59
    s_waitcnt vmcnt(8)
    s_barrier
    ds_read_b64_tr_b16 v[192:193], v60 offset:0
    ds_read_b64_tr_b16 v[194:195], v60 offset:512
    ds_read_b64_tr_b16 v[196:197], v61 offset:0
    ds_read_b64_tr_b16 v[198:199], v61 offset:512
    ds_read_b64_tr_b16 v[200:201], v62 offset:0
    ds_read_b64_tr_b16 v[202:203], v62 offset:512
    ds_read_b64_tr_b16 v[204:205], v63 offset:0
    ds_read_b64_tr_b16 v[206:207], v63 offset:512
    ds_read_b64_tr_b16 v[208:209], v60 offset:4096
    ds_read_b64_tr_b16 v[210:211], v60 offset:4608
    ds_read_b64_tr_b16 v[212:213], v61 offset:4096
    ds_read_b64_tr_b16 v[214:215], v61 offset:4608
    ds_read_b64_tr_b16 v[216:217], v62 offset:4096
    ds_read_b64_tr_b16 v[218:219], v62 offset:4608
    ds_read_b64_tr_b16 v[220:221], v63 offset:4096
    ds_read_b64_tr_b16 v[222:223], v63 offset:4608
    s_waitcnt lgkmcnt(0)
    v_add_u32 v60, 32768, v56
    v_add_u32 v61, 32768, v57
    v_add_u32 v62, 32768, v58
    v_add_u32 v63, 32768, v59
    s_waitcnt vmcnt(0)
    s_barrier
    ds_read_b64_tr_b16 v[224:225], v60 offset:0
    ds_read_b64_tr_b16 v[226:227], v60 offset:512
    ds_read_b64_tr_b16 v[228:229], v61 offset:0
    ds_read_b64_tr_b16 v[230:231], v61 offset:512
    ds_read_b64_tr_b16 v[232:233], v62 offset:0
    ds_read_b64_tr_b16 v[234:235], v62 offset:512
    ds_read_b64_tr_b16 v[236:237], v63 offset:0
    ds_read_b64_tr_b16 v[238:239], v63 offset:512
    ds_read_b64_tr_b16 v[240:241], v60 offset:4096
    ds_read_b64_tr_b16 v[242:243], v60 offset:4608
    ds_read_b64_tr_b16 v[244:245], v61 offset:4096
    ds_read_b64_tr_b16 v[246:247], v61 offset:4608
    ds_read_b64_tr_b16 v[248:249], v62 offset:4096
    ds_read_b64_tr_b16 v[250:251], v62 offset:4608
    ds_read_b64_tr_b16 v[252:253], v63 offset:4096
    ds_read_b64_tr_b16 v[254:255], v63 offset:4608
    s_waitcnt lgkmcnt(0)
    s_barrier
    s_cmp_lg_u32 s32, 0
    s_cbranch_scc1 L_arv73
    s_add_u32 s20, s82, 0x80
    s_addc_u32 s21, s83, 0
    s_mov_b32 s22, 0x4
    s_mov_b32 s23, 0x00020000
    buffer_load_dword v80, v124, s[20:23], 0 offen sc1
    s_waitcnt vmcnt(0)
    v_cmp_eq_u32 vcc, v124, v80
    s_cbranch_vccnz L_spin74
L_back75:
L_arv73:
    s_add_u32 s96, s41, 8126464
    s_mov_b32 s98, s41
    s_mov_b32 s45, 0x5530000
    buffer_load_dword v96, v6, s[16:19], s45 offen sc1
    s_waitcnt vmcnt(0)
    v_cmp_ne_u32 vcc, 0, v96
    s_cbranch_vccnz L_spin76
L_back77:
    s_barrier
    s_add_u32 m0, s43, 0
    s_add_u32 s42, s41, 0
    buffer_load_dwordx4 v1, s[16:19], s42 offen offset:0 sc1 lds
    buffer_load_dwordx4 v1, s[16:19], s42 offen offset:1024 sc1 lds
    buffer_load_dwordx4 v1, s[16:19], s42 offen offset:2048 sc1 lds
    s_add_u32 m0, s43, 12288
    s_add_u32 s42, s41, 12288
    buffer_load_dwordx4 v1, s[16:19], s42 offen offset:0 sc1 lds
    buffer_load_dwordx4 v1, s[16:19], s42 offen offset:1024 sc1 lds
    buffer_load_dwordx4 v1, s[16:19], s42 offen offset:2048 sc1 lds
    s_add_u32 m0, s43, 24576
    s_add_u32 s42, s41, 24576
    buffer_load_dwordx4 v1, s[16:19], s42 offen offset:0 sc1 lds
    buffer_load_dwordx4 v1, s[16:19], s42 offen offset:1024 sc1 lds
    buffer_load_dwordx4 v1, s[16:19], s42 offen offset:2048 sc1 lds
    s_add_u32 s45, s45, 65536
    s_waitcnt vmcnt(0) lgkmcnt(0)
    s_barrier
    s_mov_b32 s52, 0x5e00000
    s_mov_b32 s46, 0x5e00000
    s_add_u32 s20, s84, 0x5e00000
    s_addc_u32 s21, s85, 0
    s_mov_b32 s22, 0x400000
    s_mov_b32 s23, 0x00020000
    ds_read_b128 v[80:83], v2 offset:0
    ds_read_b128 v[84:87], v3 offset:0
    s_mov_b32 s36, 0
    s_waitcnt lgkmcnt(0)
    s_nop 7
L_bs_b0:
    s_waitcnt lgkmcnt(0)
    v_mfma_f32_16x16x32_bf16 v[16:19], a[0:3], v[80:83], 0
    s_and_b32 s44, s90, 0xffffffff
    ds_read_b128 v[88:91], v2 offset:2048
    s_cmp_lt_i32 s36, 1
    v_mfma_f32_16x16x32_bf16 v[24:27], a[0:3], v[84:87], 0
    s_cselect_b32 s44, 0x5e00000, s44
    s_xor_b32 s49, s44, 0
    v_cvt_pk_bf16_f32 v48, v48, v49
    v_mfma_f32_16x16x32_bf16 v[28:31], a[4:7], v[84:87], 0
    ds_read_b128 v[92:95], v3 offset:2048
    v_cvt_pk_bf16_f32 v49, v50, v51
    v_mfma_f32_16x16x32_bf16 v[20:23], a[4:7], v[80:83], 0
    v_cvt_pk_bf16_f32 v50, v52, v53
    v_cvt_pk_bf16_f32 v51, v54, v55
    v_mfma_f32_16x16x32_bf16 v[32:35], a[8:11], v[80:83], 0
    buffer_store_dwordx4 v[48:51], v1, s[16:19], s49 offen offset:3072 sc1
    v_mfma_f32_16x16x32_bf16 v[40:43], a[8:11], v[84:87], 0
    s_xor_b32 s49, s44, 16384
    v_cvt_pk_bf16_f32 v56, v56, v57
    v_cvt_pk_bf16_f32 v57, v58, v59
    v_mfma_f32_16x16x32_bf16 v[44:47], a[12:15], v[84:87], 0
    v_cvt_pk_bf16_f32 v58, v60, v61
    v_cvt_pk_bf16_f32 v59, v62, v63
    v_mfma_f32_16x16x32_bf16 v[36:39], a[12:15], v[80:83], 0
    s_waitcnt lgkmcnt(0)
    v_mfma_f32_16x16x32_bf16 v[16:19], a[16:19], v[88:91], v[16:19]
    ds_read_b128 v[80:83], v2 offset:4096
    v_mfma_f32_16x16x32_bf16 v[24:27], a[16:19], v[92:95], v[24:27]
    buffer_store_dwordx4 v[56:59], v1, s[16:19], s49 offen offset:3072 sc1
    v_mfma_f32_16x16x32_bf16 v[28:31], a[20:23], v[92:95], v[28:31]
    s_xor_b32 s49, s44, 32768
    ds_read_b128 v[84:87], v3 offset:4096
    v_cvt_pk_bf16_f32 v64, v64, v65
    v_mfma_f32_16x16x32_bf16 v[20:23], a[20:23], v[88:91], v[20:23]
    v_cvt_pk_bf16_f32 v65, v66, v67
    v_cvt_pk_bf16_f32 v66, v68, v69
    v_mfma_f32_16x16x32_bf16 v[32:35], a[24:27], v[88:91], v[32:35]
    v_cvt_pk_bf16_f32 v67, v70, v71
    v_mfma_f32_16x16x32_bf16 v[40:43], a[24:27], v[92:95], v[40:43]
    buffer_store_dwordx4 v[64:67], v1, s[16:19], s49 offen offset:3072 sc1
    v_mfma_f32_16x16x32_bf16 v[44:47], a[28:31], v[92:95], v[44:47]
    s_xor_b32 s49, s44, 49152
    v_cvt_pk_bf16_f32 v72, v72, v73
    v_cvt_pk_bf16_f32 v73, v74, v75
    v_mfma_f32_16x16x32_bf16 v[36:39], a[28:31], v[88:91], v[36:39]
    s_waitcnt lgkmcnt(0)
    v_cvt_pk_bf16_f32 v74, v76, v77
    v_cvt_pk_bf16_f32 v75, v78, v79
    v_mfma_f32_16x16x32_bf16 v[16:19], a[32:35], v[80:83], v[16:19]
    s_add_u32 m0, s43, 36864
    ds_read_b128 v[88:91], v2 offset:6144
    s_add_u32 s42, s41, 36864
    v_mfma_f32_16x16x32_bf16 v[24:27], a[32:35], v[84:87], v[24:27]
    buffer_store_dwordx4 v[72:75], v1, s[16:19], s49 offen offset:3072 sc1
    v_mfma_f32_16x16x32_bf16 v[28:31], a[36:39], v[84:87], v[28:31]
    s_add_u32 s90, s90, 262144
    ds_read_b128 v[92:95], v3 offset:6144
    v_mfma_f32_16x16x32_bf16 v[20:23], a[36:39], v[80:83], v[20:23]
    v_mfma_f32_16x16x32_bf16 v[32:35], a[40:43], v[80:83], v[32:35]
    buffer_load_dwordx4 v1, s[16:19], s42 offen offset:0 sc1 lds
    v_mfma_f32_16x16x32_bf16 v[40:43], a[40:43], v[84:87], v[40:43]
    v_mfma_f32_16x16x32_bf16 v[44:47], a[44:47], v[84:87], v[44:47]
    v_mfma_f32_16x16x32_bf16 v[36:39], a[44:47], v[80:83], v[36:39]
    s_waitcnt lgkmcnt(0)
    v_mfma_f32_16x16x32_bf16 v[16:19], a[48:51], v[88:91], v[16:19]
    ds_read_b128 v[80:83], v2 offset:8192
    v_mfma_f32_16x16x32_bf16 v[24:27], a[48:51], v[92:95], v[24:27]
    v_mfma_f32_16x16x32_bf16 v[28:31], a[52:55], v[92:95], v[28:31]
    ds_read_b128 v[84:87], v3 offset:8192
    v_mfma_f32_16x16x32_bf16 v[20:23], a[52:55], v[88:91], v[20:23]
    buffer_load_dwordx4 v1, s[16:19], s42 offen offset:1024 sc1 lds
    v_mfma_f32_16x16x32_bf16 v[32:35], a[56:59], v[88:91], v[32:35]
    v_mfma_f32_16x16x32_bf16 v[40:43], a[56:59], v[92:95], v[40:43]
    v_mfma_f32_16x16x32_bf16 v[44:47], a[60:63], v[92:95], v[44:47]
    v_mfma_f32_16x16x32_bf16 v[36:39], a[60:63], v[88:91], v[36:39]
    s_waitcnt lgkmcnt(0)
    v_mfma_f32_16x16x32_bf16 v[16:19], a[64:67], v[80:83], v[16:19]
    ds_read_b128 v[88:91], v2 offset:10240
    v_mfma_f32_16x16x32_bf16 v[24:27], a[64:67], v[84:87], v[24:27]
    buffer_load_dwordx4 v1, s[16:19], s42 offen offset:2048 sc1 lds
    v_mfma_f32_16x16x32_bf16 v[28:31], a[68:71], v[84:87], v[28:31]
    s_add_u32 s98, s98, 262144
    ds_read_b128 v[92:95], v3 offset:10240
    s_min_i32 s98, s98, s96
    v_mfma_f32_16x16x32_bf16 v[20:23], a[68:71], v[80:83], v[20:23]
    s_and_b32 s41, s98, 0xffffffff
    v_mfma_f32_16x16x32_bf16 v[32:35], a[72:75], v[80:83], v[32:35]
    v_mfma_f32_16x16x32_bf16 v[40:43], a[72:75], v[84:87], v[40:43]
    v_mfma_f32_16x16x32_bf16 v[44:47], a[76:79], v[84:87], v[44:47]
    v_mfma_f32_16x16x32_bf16 v[36:39], a[76:79], v[80:83], v[36:39]
    s_waitcnt vmcnt(7) lgkmcnt(0)
    s_barrier
    v_mfma_f32_16x16x32_bf16 v[16:19], a[80:83], v[88:91], v[16:19]
    ds_read_b128 v[80:83], v2 offset:12288
    v_mfma_f32_16x16x32_bf16 v[24:27], a[80:83], v[92:95], v[24:27]
    v_mfma_f32_16x16x32_bf16 v[28:31], a[84:87], v[92:95], v[28:31]
    ds_read_b128 v[84:87], v3 offset:12288
    v_mfma_f32_16x16x32_bf16 v[20:23], a[84:87], v[88:91], v[20:23]
    v_mfma_f32_16x16x32_bf16 v[32:35], a[88:91], v[88:91], v[32:35]
    v_mfma_f32_16x16x32_bf16 v[40:43], a[88:91], v[92:95], v[40:43]
    v_mfma_f32_16x16x32_bf16 v[44:47], a[92:95], v[92:95], v[44:47]
    v_mfma_f32_16x16x32_bf16 v[36:39], a[92:95], v[88:91], v[36:39]
    s_waitcnt lgkmcnt(0)
    v_mfma_f32_16x16x32_bf16 v[16:19], a[96:99], v[80:83], v[16:19]
    ds_read_b128 v[88:91], v2 offset:14336
    v_mfma_f32_16x16x32_bf16 v[24:27], a[96:99], v[84:87], v[24:27]
    v_mfma_f32_16x16x32_bf16 v[28:31], a[100:103], v[84:87], v[28:31]
    ds_read_b128 v[92:95], v3 offset:14336
    v_mfma_f32_16x16x32_bf16 v[20:23], a[100:103], v[80:83], v[20:23]
    v_mfma_f32_16x16x32_bf16 v[32:35], a[104:107], v[80:83], v[32:35]
    v_mfma_f32_16x16x32_bf16 v[40:43], a[104:107], v[84:87], v[40:43]
    v_mfma_f32_16x16x32_bf16 v[44:47], a[108:111], v[84:87], v[44:47]
    v_mfma_f32_16x16x32_bf16 v[36:39], a[108:111], v[80:83], v[36:39]
    s_waitcnt lgkmcnt(0)
    v_mfma_f32_16x16x32_bf16 v[16:19], a[112:115], v[88:91], v[16:19]
    ds_read_b128 v[80:83], v2 offset:16384
    v_mfma_f32_16x16x32_bf16 v[24:27], a[112:115], v[92:95], v[24:27]
    v_mfma_f32_16x16x32_bf16 v[28:31], a[116:119], v[92:95], v[28:31]
    ds_read_b128 v[84:87], v3 offset:16384
    v_mfma_f32_16x16x32_bf16 v[20:23], a[116:119], v[88:91], v[20:23]
    v_mfma_f32_16x16x32_bf16 v[32:35], a[120:123], v[88:91], v[32:35]
    v_mfma_f32_16x16x32_bf16 v[40:43], a[120:123], v[92:95], v[40:43]
    v_mfma_f32_16x16x32_bf16 v[44:47], a[124:127], v[92:95], v[44:47]
    v_mfma_f32_16x16x32_bf16 v[36:39], a[124:127], v[88:91], v[36:39]
    s_waitcnt lgkmcnt(0)
    v_mfma_f32_16x16x32_bf16 v[16:19], a[128:131], v[80:83], v[16:19]
    ds_read_b128 v[88:91], v2 offset:18432
    v_mfma_f32_16x16x32_bf16 v[24:27], a[128:131], v[84:87], v[24:27]
    v_mfma_f32_16x16x32_bf16 v[28:31], a[132:135], v[84:87], v[28:31]
    ds_read_b128 v[92:95], v3 offset:18432
    v_mfma_f32_16x16x32_bf16 v[20:23], a[132:135], v[80:83], v[20:23]
    v_mfma_f32_16x16x32_bf16 v[32:35], a[136:139], v[80:83], v[32:35]
    v_mfma_f32_16x16x32_bf16 v[40:43], a[136:139], v[84:87], v[40:43]
    v_mfma_f32_16x16x32_bf16 v[44:47], a[140:143], v[84:87], v[44:47]
    v_mfma_f32_16x16x32_bf16 v[36:39], a[140:143], v[80:83], v[36:39]
    s_waitcnt lgkmcnt(0)
    v_mfma_f32_16x16x32_bf16 v[16:19], a[144:147], v[88:91], v[16:19]
    ds_read_b128 v[80:83], v2 offset:20480
    v_mfma_f32_16x16x32_bf16 v[24:27], a[144:147], v[92:95], v[24:27]
    v_mfma_f32_16x16x32_bf16 v[28:31], a[148:151], v[92:95], v[28:31]
    ds_read_b128 v[84:87], v3 offset:20480
    v_mfma_f32_16x16x32_bf16 v[20:23], a[148:151], v[88:91], v[20:23]
    buffer_load_dword v96, v6, s[16:19], s45 offen sc1
    v_mfma_f32_16x16x32_bf16 v[32:35], a[152:155], v[88:91], v[32:35]
    s_add_u32 m0, s43, 98304
    s_add_u32 s42, s41, 0
    v_mfma_f32_16x16x32_bf16 v[40:43], a[152:155], v[92:95], v[40:43]
    v_mfma_f32_16x16x32_bf16 v[44:47], a[156:159], v[92:95], v[44:47]
    v_mfma_f32_16x16x32_bf16 v[36:39], a[156:159], v[88:91], v[36:39]
    s_waitcnt lgkmcnt(0)
    v_mfma_f32_16x16x32_bf16 v[16:19], a[160:163], v[80:83], v[16:19]
    ds_read_b128 v[88:91], v2 offset:22528
    v_mfma_f32_16x16x32_bf16 v[24:27], a[160:163], v[84:87], v[24:27]
    v_mfma_f32_16x16x32_bf16 v[28:31], a[164:167], v[84:87], v[28:31]
    ds_read_b128 v[92:95], v3 offset:22528
    v_mfma_f32_16x16x32_bf16 v[20:23], a[164:167], v[80:83], v[20:23]
    v_mfma_f32_16x16x32_bf16 v[32:35], a[168:171], v[80:83], v[32:35]
    v_mfma_f32_16x16x32_bf16 v[40:43], a[168:171], v[84:87], v[40:43]
    v_mfma_f32_16x16x32_bf16 v[44:47], a[172:175], v[84:87], v[44:47]
    v_mfma_f32_16x16x32_bf16 v[36:39], a[172:175], v[80:83], v[36:39]
    s_waitcnt lgkmcnt(0)
    v_mfma_f32_16x16x32_bf16 v[16:19], a[176:179], v[88:91], v[16:19]
    ds_read_b128 v[80:83], v2 offset:24576
    v_mfma_f32_16x16x32_bf16 v[24:27], a[176:179], v[92:95], v[24:27]
    v_mfma_f32_16x16x32_bf16 v[28:31], a[180:183], v[92:95], v[28:31]
    ds_read_b128 v[84:87], v3 offset:24576
    v_mfma_f32_16x16x32_bf16 v[20:23], a[180:183], v[88:91], v[20:23]
    v_mfma_f32_16x16x32_bf16 v[32:35], a[184:187], v[88:91], v[32:35]
    v_mfma_f32_16x16x32_bf16 v[40:43], a[184:187], v[92:95], v[40:43]
    v_mfma_f32_16x16x32_bf16 v[44:47], a[188:191], v[92:95], v[44:47]
    v_mfma_f32_16x16x32_bf16 v[36:39], a[188:191], v[88:91], v[36:39]
    s_waitcnt lgkmcnt(0)
    v_mfma_f32_16x16x32_bf16 v[16:19], a[192:195], v[80:83], v[16:19]
    ds_read_b128 v[88:91], v2 offset:26624
    v_mfma_f32_16x16x32_bf16 v[24:27], a[192:195], v[84:87], v[24:27]
    v_mfma_f32_16x16x32_bf16 v[28:31], a[196:199], v[84:87], v[28:31]
    ds_read_b128 v[92:95], v3 offset:26624
    v_mfma_f32_16x16x32_bf16 v[20:23], a[196:199], v[80:83], v[20:23]
    v_mfma_f32_16x16x32_bf16 v[32:35], a[200:203], v[80:83], v[32:35]
    v_mfma_f32_16x16x32_bf16 v[40:43], a[200:203], v[84:87], v[40:43]
    v_mfma_f32_16x16x32_bf16 v[44:47], a[204:207], v[84:87], v[44:47]
    v_mfma_f32_16x16x32_bf16 v[36:39], a[204:207], v[80:83], v[36:39]
    s_waitcnt lgkmcnt(0)
    v_mfma_f32_16x16x32_bf16 v[16:19], a[208:211], v[88:91], v[16:19]
    ds_read_b128 v[80:83], v2 offset:28672
    v_mfma_f32_16x16x32_bf16 v[24:27], a[208:211], v[92:95], v[24:27]
    v_mfma_f32_16x16x32_bf16 v[28:31], a[212:215], v[92:95], v[28:31]
    ds_read_b128 v[84:87], v3 offset:28672
    v_mfma_f32_16x16x32_bf16 v[20:23], a[212:215], v[88:91], v[20:23]
    v_mfma_f32_16x16x32_bf16 v[32:35], a[216:219], v[88:91], v[32:35]
    v_mfma_f32_16x16x32_bf16 v[40:43], a[216:219], v[92:95], v[40:43]
    v_mfma_f32_16x16x32_bf16 v[44:47], a[220:223], v[92:95], v[44:47]
    v_mfma_f32_16x16x32_bf16 v[36:39], a[220:223], v[88:91], v[36:39]
    s_waitcnt lgkmcnt(0)
    v_mfma_f32_16x16x32_bf16 v[16:19], a[224:227], v[80:83], v[16:19]
    ds_read_b128 v[88:91], v2 offset:30720
    v_mfma_f32_16x16x32_bf16 v[24:27], a[224:227], v[84:87], v[24:27]
    v_mfma_f32_16x16x32_bf16 v[28:31], a[228:231], v[84:87], v[28:31]
    ds_read_b128 v[92:95], v3 offset:30720
    v_mfma_f32_16x16x32_bf16 v[20:23], a[228:231], v[80:83], v[20:23]
    v_mfma_f32_16x16x32_bf16 v[32:35], a[232:235], v[80:83], v[32:35]
    v_mfma_f32_16x16x32_bf16 v[40:43], a[232:235], v[84:87], v[40:43]
    v_mfma_f32_16x16x32_bf16 v[44:47], a[236:239], v[84:87], v[44:47]
    v_mfma_f32_16x16x32_bf16 v[36:39], a[236:239], v[80:83], v[36:39]
    s_waitcnt lgkmcnt(0)
    v_mfma_f32_16x16x32_bf16 v[16:19], a[240:243], v[88:91], v[16:19]
    s_waitcnt vmcnt(0)
    ds_read_b128 v[80:83], v2 offset:32768
    v_cmp_ne_u32 vcc, 0, v96
    v_mfma_f32_16x16x32_bf16 v[24:27], a[240:243], v[92:95], v[24:27]
    v_mfma_f32_16x16x32_bf16 v[28:31], a[244:247], v[92:95], v[28:31]
    s_cbranch_vccnz L_spin78
L_back79:
    ds_read_b128 v[84:87], v3 offset:32768
    s_barrier
    v_mfma_f32_16x16x32_bf16 v[20:23], a[244:247], v[88:91], v[20:23]
    buffer_load_dwordx4 v1, s[16:19], s42 offen offset:0 sc1 lds
    v_mfma_f32_16x16x32_bf16 v[32:35], a[248:251], v[88:91], v[32:35]
    v_mfma_f32_16x16x32_bf16 v[40:43], a[248:251], v[92:95], v[40:43]
    v_mfma_f32_16x16x32_bf16 v[44:47], a[252:255], v[92:95], v[44:47]
    buffer_load_dwordx4 v1, s[16:19], s42 offen offset:1024 sc1 lds
    v_mfma_f32_16x16x32_bf16 v[36:39], a[252:255], v[88:91], v[36:39]
    s_waitcnt lgkmcnt(0)
    v_mfma_f32_16x16x32_bf16 v[16:19], v[128:131], v[80:83], v[16:19]
    ds_read_b128 v[88:91], v2 offset:34816
    v_mfma_f32_16x16x32_bf16 v[24:27], v[128:131], v[84:87], v[24:27]
    buffer_load_dwordx4 v1, s[16:19], s42 offen offset:2048 sc1 lds
    v_mfma_f32_16x16x32_bf16 v[28:31], v[132:135], v[84:87], v[28:31]
    ds_read_b128 v[92:95], v3 offset:34816
    v_mfma_f32_16x16x32_bf16 v[20:23], v[132:135], v[80:83], v[20:23]
    v_mfma_f32_16x16x32_bf16 v[32:35], v[136:139], v[80:83], v[32:35]
    buffer_store_dword v124, v124, s[16:19], s91 offen sc1
    v_mfma_f32_16x16x32_bf16 v[40:43], v[136:139], v[84:87], v[40:43]
    s_add_u32 s91, s91, 65536
    s_add_u32 m0, s43, 110592
    s_add_u32 s42, s41, 12288
    v_mfma_f32_16x16x32_bf16 v[44:47], v[140:143], v[84:87], v[44:47]
    v_mfma_f32_16x16x32_bf16 v[36:39], v[140:143], v[80:83], v[36:39]
    s_waitcnt lgkmcnt(0)
    v_mfma_f32_16x16x32_bf16 v[16:19], v[144:147], v[88:91], v[16:19]
    ds_read_b128 v[80:83], v2 offset:36864
    v_mfma_f32_16x16x32_bf16 v[24:27], v[144:147], v[92:95], v[24:27]
    v_mfma_f32_16x16x32_bf16 v[28:31], v[148:151], v[92:95], v[28:31]
    ds_read_b128 v[84:87], v3 offset:36864
    v_mfma_f32_16x16x32_bf16 v[20:23], v[148:151], v[88:91], v[20:23]
    buffer_load_dwordx4 v1, s[16:19], s42 offen offset:0 sc1 lds
    v_mfma_f32_16x16x32_bf16 v[32:35], v[152:155], v[88:91], v[32:35]
    v_mfma_f32_16x16x32_bf16 v[40:43], v[152:155], v[92:95], v[40:43]
    v_mfma_f32_16x16x32_bf16 v[44:47], v[156:159], v[92:95], v[44:47]
    v_mfma_f32_16x16x32_bf16 v[36:39], v[156:159], v[88:91], v[36:39]
    s_waitcnt lgkmcnt(0)
    v_mfma_f32_16x16x32_bf16 v[16:19], v[160:163], v[80:83], v[16:19]
    ds_read_b128 v[88:91], v2 offset:38912
    v_mfma_f32_16x16x32_bf16 v[24:27], v[160:163], v[84:87], v[24:27]
    buffer_load_dwordx4 v1, s[16:19], s42 offen offset:1024 sc1 lds
    v_mfma_f32_16x16x32_bf16 v[28:31], v[164:167], v[84:87], v[28:31]
    ds_read_b128 v[92:95], v3 offset:38912
    v_mfma_f32_16x16x32_bf16 v[20:23], v[164:167], v[80:83], v[20:23]
    v_mfma_f32_16x16x32_bf16 v[32:35], v[168:171], v[80:83], v[32:35]
    v_mfma_f32_16x16x32_bf16 v[40:43], v[168:171], v[84:87], v[40:43]
    v_mfma_f32_16x16x32_bf16 v[44:47], v[172:175], v[84:87], v[44:47]
    buffer_load_dwordx4 v1, s[16:19], s42 offen offset:2048 sc1 lds
    v_mfma_f32_16x16x32_bf16 v[36:39], v[172:175], v[80:83], v[36:39]
    s_waitcnt lgkmcnt(0)
    s_add_u32 m0, s43, 122880
    s_add_u32 s42, s41, 24576
    v_mfma_f32_16x16x32_bf16 v[16:19], v[176:179], v[88:91], v[16:19]
    ds_read_b128 v[80:83], v2 offset:40960
    v_mfma_f32_16x16x32_bf16 v[24:27], v[176:179], v[92:95], v[24:27]
    v_mfma_f32_16x16x32_bf16 v[28:31], v[180:183], v[92:95], v[28:31]
    ds_read_b128 v[84:87], v3 offset:40960
    v_mfma_f32_16x16x32_bf16 v[20:23], v[180:183], v[88:91], v[20:23]
    buffer_load_dwordx4 v1, s[16:19], s42 offen offset:0 sc1 lds
    v_mfma_f32_16x16x32_bf16 v[32:35], v[184:187], v[88:91], v[32:35]
    v_mfma_f32_16x16x32_bf16 v[40:43], v[184:187], v[92:95], v[40:43]
    v_mfma_f32_16x16x32_bf16 v[44:47], v[188:191], v[92:95], v[44:47]
    v_mfma_f32_16x16x32_bf16 v[36:39], v[188:191], v[88:91], v[36:39]
    s_waitcnt lgkmcnt(0)
    v_mfma_f32_16x16x32_bf16 v[16:19], v[192:195], v[80:83], v[16:19]
    ds_read_b128 v[88:91], v2 offset:43008
    v_mfma_f32_16x16x32_bf16 v[24:27], v[192:195], v[84:87], v[24:27]
    buffer_load_dwordx4 v1, s[16:19], s42 offen offset:1024 sc1 lds
    v_mfma_f32_16x16x32_bf16 v[28:31], v[196:199], v[84:87], v[28:31]
    ds_read_b128 v[92:95], v3 offset:43008
    v_mfma_f32_16x16x32_bf16 v[20:23], v[196:199], v[80:83], v[20:23]
    v_mfma_f32_16x16x32_bf16 v[32:35], v[200:203], v[80:83], v[32:35]
    v_mfma_f32_16x16x32_bf16 v[40:43], v[200:203], v[84:87], v[40:43]
    v_mfma_f32_16x16x32_bf16 v[44:47], v[204:207], v[84:87], v[44:47]
    buffer_load_dwordx4 v1, s[16:19], s42 offen offset:2048 sc1 lds
    v_mfma_f32_16x16x32_bf16 v[36:39], v[204:207], v[80:83], v[36:39]
    s_waitcnt lgkmcnt(0)
    s_add_u32 s45, s45, 65536
    v_mfma_f32_16x16x32_bf16 v[16:19], v[208:211], v[88:91], v[16:19]
    ds_read_b128 v[80:83], v2 offset:45056
    v_mfma_f32_16x16x32_bf16 v[24:27], v[208:211], v[92:95], v[24:27]
    v_mfma_f32_16x16x32_bf16 v[28:31], v[212:215], v[92:95], v[28:31]
    ds_read_b128 v[84:87], v3 offset:45056
    v_mfma_f32_16x16x32_bf16 v[20:23], v[212:215], v[88:91], v[20:23]
    v_mfma_f32_16x16x32_bf16 v[32:35], v[216:219], v[88:91], v[32:35]
    v_mfma_f32_16x16x32_bf16 v[40:43], v[216:219], v[92:95], v[40:43]
    v_mfma_f32_16x16x32_bf16 v[44:47], v[220:223], v[92:95], v[44:47]
    v_mfma_f32_16x16x32_bf16 v[36:39], v[220:223], v[88:91], v[36:39]
    s_waitcnt lgkmcnt(0)
    v_mfma_f32_16x16x32_bf16 v[16:19], v[224:227], v[80:83], v[16:19]
    ds_read_b128 v[88:91], v2 offset:47104
    v_mfma_f32_16x16x32_bf16 v[24:27], v[224:227], v[84:87], v[24:27]
    v_mfma_f32_16x16x32_bf16 v[28:31], v[228:231], v[84:87], v[28:31]
    ds_read_b128 v[92:95], v3 offset:47104
    v_mfma_f32_16x16x32_bf16 v[20:23], v[228:231], v[80:83], v[20:23]
    v_mfma_f32_16x16x32_bf16 v[32:35], v[232:235], v[80:83], v[32:35]
    v_mfma_f32_16x16x32_bf16 v[40:43], v[232:235], v[84:87], v[40:43]
    v_mfma_f32_16x16x32_bf16 v[44:47], v[236:239], v[84:87], v[44:47]
    v_mfma_f32_16x16x32_bf16 v[36:39], v[236:239], v[80:83], v[36:39]
    s_waitcnt vmcnt(7) lgkmcnt(0)
    s_barrier
    v_mfma_f32_16x16x32_bf16 v[16:19], v[240:243], v[88:91], v[16:19]
    ds_read_b128 v[80:83], v4 offset:0
    v_mfma_f32_16x16x32_bf16 v[24:27], v[240:243], v[92:95], v[24:27]
    v_mfma_f32_16x16x32_bf16 v[28:31], v[244:247], v[92:95], v[28:31]
    ds_read_b128 v[84:87], v5 offset:0
    v_mfma_f32_16x16x32_bf16 v[20:23], v[244:247], v[88:91], v[20:23]
    v_mfma_f32_16x16x32_bf16 v[32:35], v[248:251], v[88:91], v[32:35]
    v_mfma_f32_16x16x32_bf16 v[40:43], v[248:251], v[92:95], v[40:43]
    v_mfma_f32_16x16x32_bf16 v[44:47], v[252:255], v[92:95], v[44:47]
    v_mfma_f32_16x16x32_bf16 v[36:39], v[252:255], v[88:91], v[36:39]
    s_add_u32 s36, s36, 1
L_bs_b1:
    s_waitcnt lgkmcnt(0)
    v_mfma_f32_16x16x32_bf16 v[48:51], a[0:3], v[80:83], 0
    s_and_b32 s44, s90, 0xffffffff
    ds_read_b128 v[88:91], v4 offset:2048
    s_cmp_lt_i32 s36, 1
    v_mfma_f32_16x16x32_bf16 v[56:59], a[0:3], v[84:87], 0
    s_cselect_b32 s44, 0x5e00000, s44
    s_xor_b32 s49, s44, 0
    v_cvt_pk_bf16_f32 v16, v16, v17
    v_mfma_f32_16x16x32_bf16 v[60:63], a[4:7], v[84:87], 0
    ds_read_b128 v[92:95], v5 offset:2048
    v_cvt_pk_bf16_f32 v17, v18, v19
    v_mfma_f32_16x16x32_bf16 v[52:55], a[4:7], v[80:83], 0
    v_cvt_pk_bf16_f32 v18, v20, v21
    v_cvt_pk_bf16_f32 v19, v22, v23
    v_mfma_f32_16x16x32_bf16 v[64:67], a[8:11], v[80:83], 0
    buffer_store_dwordx4 v[16:19], v1, s[16:19], s49 offen offset:3072 sc1
    v_mfma_f32_16x16x32_bf16 v[72:75], a[8:11], v[84:87], 0
    s_xor_b32 s49, s44, 16384
    v_cvt_pk_bf16_f32 v24, v24, v25
    v_cvt_pk_bf16_f32 v25, v26, v27
    v_mfma_f32_16x16x32_bf16 v[76:79], a[12:15], v[84:87], 0
    v_cvt_pk_bf16_f32 v26, v28, v29
    v_cvt_pk_bf16_f32 v27, v30, v31
    v_mfma_f32_16x16x32_bf16 v[68:71], a[12:15], v[80:83], 0
    s_waitcnt lgkmcnt(0)
    v_mfma_f32_16x16x32_bf16 v[48:51], a[16:19], v[88:91], v[48:51]
    ds_read_b128 v[80:83], v4 offset:4096
    v_mfma_f32_16x16x32_bf16 v[56:59], a[16:19], v[92:95], v[56:59]
    buffer_store_dwordx4 v[24:27], v1, s[16:19], s49 offen offset:3072 sc1
    v_mfma_f32_16x16x32_bf16 v[60:63], a[20:23], v[92:95], v[60:63]
    s_xor_b32 s49, s44, 32768
    ds_read_b128 v[84:87], v5 offset:4096
    v_cvt_pk_bf16_f32 v32, v32, v33
    v_mfma_f32_16x16x32_bf16 v[52:55], a[20:23], v[88:91], v[52:55]
    v_cvt_pk_bf16_f32 v33, v34, v35
    v_cvt_pk_bf16_f32 v34, v36, v37
    v_mfma_f32_16x16x32_bf16 v[64:67], a[24:27], v[88:91], v[64:67]
    v_cvt_pk_bf16_f32 v35, v38, v39
    v_mfma_f32_16x16x32_bf16 v[72:75], a[24:27], v[92:95], v[72:75]
    buffer_store_dwordx4 v[32:35], v1, s[16:19], s49 offen offset:3072 sc1
    v_mfma_f32_16x16x32_bf16 v[76:79], a[28:31], v[92:95], v[76:79]
    s_xor_b32 s49, s44, 49152
    v_cvt_pk_bf16_f32 v40, v40, v41
    v_cvt_pk_bf16_f32 v41, v42, v43
    v_mfma_f32_16x16x32_bf16 v[68:71], a[28:31], v[88:91], v[68:71]
    s_waitcnt lgkmcnt(0)
    v_cvt_pk_bf16_f32 v42, v44, v45
    v_cvt_pk_bf16_f32 v43, v46, v47
    v_mfma_f32_16x16x32_bf16 v[48:51], a[32:35], v[80:83], v[48:51]
    s_add_u32 m0, s43, 135168
    ds_read_b128 v[88:91], v4 offset:6144
    s_add_u32 s42, s41, 36864
    v_mfma_f32_16x16x32_bf16 v[56:59], a[32:35], v[84:87], v[56:59]
    buffer_store_dwordx4 v[40:43], v1, s[16:19], s49 offen offset:3072 sc1
    v_mfma_f32_16x16x32_bf16 v[60:63], a[36:39], v[84:87], v[60:63]
    s_add_u32 s90, s90, 262144
    ds_read_b128 v[92:95], v5 offset:6144
    v_mfma_f32_16x16x32_bf16 v[52:55], a[36:39], v[80:83], v[52:55]
    v_mfma_f32_16x16x32_bf16 v[64:67], a[40:43], v[80:83], v[64:67]
    buffer_load_dwordx4 v1, s[16:19], s42 offen offset:0 sc1 lds
    v_mfma_f32_16x16x32_bf16 v[72:75], a[40:43], v[84:87], v[72:75]
    v_mfma_f32_16x16x32_bf16 v[76:79], a[44:47], v[84:87], v[76:79]
    v_mfma_f32_16x16x32_bf16 v[68:71], a[44:47], v[80:83], v[68:71]
    s_waitcnt lgkmcnt(0)
    v_mfma_f32_16x16x32_bf16 v[48:51], a[48:51], v[88:91], v[48:51]
    ds_read_b128 v[80:83], v4 offset:8192
    v_mfma_f32_16x16x32_bf16 v[56:59], a[48:51], v[92:95], v[56:59]
    v_mfma_f32_16x16x32_bf16 v[60:63], a[52:55], v[92:95], v[60:63]
    ds_read_b128 v[84:87], v5 offset:8192
    v_mfma_f32_16x16x32_bf16 v[52:55], a[52:55], v[88:91], v[52:55]
    buffer_load_dwordx4 v1, s[16:19], s42 offen offset:1024 sc1 lds
    v_mfma_f32_16x16x32_bf16 v[64:67], a[56:59], v[88:91], v[64:67]
    v_mfma_f32_16x16x32_bf16 v[72:75], a[56:59], v[92:95], v[72:75]
    v_mfma_f32_16x16x32_bf16 v[76:79], a[60:63], v[92:95], v[76:79]
    v_mfma_f32_16x16x32_bf16 v[68:71], a[60:63], v[88:91], v[68:71]
    s_waitcnt lgkmcnt(0)
    v_mfma_f32_16x16x32_bf16 v[48:51], a[64:67], v[80:83], v[48:51]
    ds_read_b128 v[88:91], v4 offset:10240
    v_mfma_f32_16x16x32_bf16 v[56:59], a[64:67], v[84:87], v[56:59]
    buffer_load_dwordx4 v1, s[16:19], s42 offen offset:2048 sc1 lds
    v_mfma_f32_16x16x32_bf16 v[60:63], a[68:71], v[84:87], v[60:63]
    s_add_u32 s98, s98, 262144
    ds_read_b128 v[92:95], v5 offset:10240
    s_min_i32 s98, s98, s96
    v_mfma_f32_16x16x32_bf16 v[52:55], a[68:71], v[80:83], v[52:55]
    s_and_b32 s41, s98, 0xffffffff
    v_mfma_f32_16x16x32_bf16 v[64:67], a[72:75], v[80:83], v[64:67]
    v_mfma_f32_16x16x32_bf16 v[72:75], a[72:75], v[84:87], v[72:75]
    v_mfma_f32_16x16x32_bf16 v[76:79], a[76:79], v[84:87], v[76:79]
    v_mfma_f32_16x16x32_bf16 v[68:71], a[76:79], v[80:83], v[68:71]
    s_waitcnt vmcnt(7) lgkmcnt(0)
    s_barrier
    v_mfma_f32_16x16x32_bf16 v[48:51], a[80:83], v[88:91], v[48:51]
    ds_read_b128 v[80:83], v4 offset:12288
    v_mfma_f32_16x16x32_bf16 v[56:59], a[80:83], v[92:95], v[56:59]
    v_mfma_f32_16x16x32_bf16 v[60:63], a[84:87], v[92:95], v[60:63]
    ds_read_b128 v[84:87], v5 offset:12288
    v_mfma_f32_16x16x32_bf16 v[52:55], a[84:87], v[88:91], v[52:55]
    v_mfma_f32_16x16x32_bf16 v[64:67], a[88:91], v[88:91], v[64:67]
    v_mfma_f32_16x16x32_bf16 v[72:75], a[88:91], v[92:95], v[72:75]
    v_mfma_f32_16x16x32_bf16 v[76:79], a[92:95], v[92:95], v[76:79]
    v_mfma_f32_16x16x32_bf16 v[68:71], a[92:95], v[88:91], v[68:71]
    s_waitcnt lgkmcnt(0)
    v_mfma_f32_16x16x32_bf16 v[48:51], a[96:99], v[80:83], v[48:51]
    ds_read_b128 v[88:91], v4 offset:14336
    v_mfma_f32_16x16x32_bf16 v[56:59], a[96:99], v[84:87], v[56:59]
    v_mfma_f32_16x16x32_bf16 v[60:63], a[100:103], v[84:87], v[60:63]
    ds_read_b128 v[92:95], v5 offset:14336
    v_mfma_f32_16x16x32_bf16 v[52:55], a[100:103], v[80:83], v[52:55]
    v_mfma_f32_16x16x32_bf16 v[64:67], a[104:107], v[80:83], v[64:67]
    v_mfma_f32_16x16x32_bf16 v[72:75], a[104:107], v[84:87], v[72:75]
    v_mfma_f32_16x16x32_bf16 v[76:79], a[108:111], v[84:87], v[76:79]
    v_mfma_f32_16x16x32_bf16 v[68:71], a[108:111], v[80:83], v[68:71]
    s_waitcnt lgkmcnt(0)
    v_mfma_f32_16x16x32_bf16 v[48:51], a[112:115], v[88:91], v[48:51]
    ds_read_b128 v[80:83], v4 offset:16384
    v_mfma_f32_16x16x32_bf16 v[56:59], a[112:115], v[92:95], v[56:59]
    v_mfma_f32_16x16x32_bf16 v[60:63], a[116:119], v[92:95], v[60:63]
    ds_read_b128 v[84:87], v5 offset:16384
    v_mfma_f32_16x16x32_bf16 v[52:55], a[116:119], v[88:91], v[52:55]
    v_mfma_f32_16x16x32_bf16 v[64:67], a[120:123], v[88:91], v[64:67]
    v_mfma_f32_16x16x32_bf16 v[72:75], a[120:123], v[92:95], v[72:75]
    v_mfma_f32_16x16x32_bf16 v[76:79], a[124:127], v[92:95], v[76:79]
    v_mfma_f32_16x16x32_bf16 v[68:71], a[124:127], v[88:91], v[68:71]
    s_waitcnt lgkmcnt(0)
    v_mfma_f32_16x16x32_bf16 v[48:51], a[128:131], v[80:83], v[48:51]
    ds_read_b128 v[88:91], v4 offset:18432
    v_mfma_f32_16x16x32_bf16 v[56:59], a[128:131], v[84:87], v[56:59]
    v_mfma_f32_16x16x32_bf16 v[60:63], a[132:135], v[84:87], v[60:63]
    ds_read_b128 v[92:95], v5 offset:18432
    v_mfma_f32_16x16x32_bf16 v[52:55], a[132:135], v[80:83], v[52:55]
    v_mfma_f32_16x16x32_bf16 v[64:67], a[136:139], v[80:83], v[64:67]
    v_mfma_f32_16x16x32_bf16 v[72:75], a[136:139], v[84:87], v[72:75]
    v_mfma_f32_16x16x32_bf16 v[76:79], a[140:143], v[84:87], v[76:79]
    v_mfma_f32_16x16x32_bf16 v[68:71], a[140:143], v[80:83], v[68:71]
    s_waitcnt lgkmcnt(0)
    v_mfma_f32_16x16x32_bf16 v[48:51], a[144:147], v[88:91], v[48:51]
    ds_read_b128 v[80:83], v4 offset:20480
    v_mfma_f32_16x16x32_bf16 v[56:59], a[144:147], v[92:95], v[56:59]
    v_mfma_f32_16x16x32_bf16 v[60:63], a[148:151], v[92:95], v[60:63]
    ds_read_b128 v[84:87], v5 offset:20480
    v_mfma_f32_16x16x32_bf16 v[52:55], a[148:151], v[88:91], v[52:55]
    buffer_load_dword v96, v6, s[16:19], s45 offen sc1
    v_mfma_f32_16x16x32_bf16 v[64:67], a[152:155], v[88:91], v[64:67]
    s_add_u32 m0, s43, 0
    s_add_u32 s42, s41, 0
    v_mfma_f32_16x16x32_bf16 v[72:75], a[152:155], v[92:95], v[72:75]
    v_mfma_f32_16x16x32_bf16 v[76:79], a[156:159], v[92:95], v[76:79]
    v_mfma_f32_16x16x32_bf16 v[68:71], a[156:159], v[88:91], v[68:71]
    s_waitcnt lgkmcnt(0)
    v_mfma_f32_16x16x32_bf16 v[48:51], a[160:163], v[80:83], v[48:51]
    ds_read_b128 v[88:91], v4 offset:22528
    v_mfma_f32_16x16x32_bf16 v[56:59], a[160:163], v[84:87], v[56:59]
    v_mfma_f32_16x16x32_bf16 v[60:63], a[164:167], v[84:87], v[60:63]
    ds_read_b128 v[92:95], v5 offset:22528
    v_mfma_f32_16x16x32_bf16 v[52:55], a[164:167], v[80:83], v[52:55]
    v_mfma_f32_16x16x32_bf16 v[64:67], a[168:171], v[80:83], v[64:67]
    v_mfma_f32_16x16x32_bf16 v[72:75], a[168:171], v[84:87], v[72:75]
    v_mfma_f32_16x16x32_bf16 v[76:79], a[172:175], v[84:87], v[76:79]
    v_mfma_f32_16x16x32_bf16 v[68:71], a[172:175], v[80:83], v[68:71]
    s_waitcnt lgkmcnt(0)
    v_mfma_f32_16x16x32_bf16 v[48:51], a[176:179], v[88:91], v[48:51]
    ds_read_b128 v[80:83], v4 offset:24576
    v_mfma_f32_16x16x32_bf16 v[56:59], a[176:179], v[92:95], v[56:59]
    v_mfma_f32_16x16x32_bf16 v[60:63], a[180:183], v[92:95], v[60:63]
    ds_read_b128 v[84:87], v5 offset:24576
    v_mfma_f32_16x16x32_bf16 v[52:55], a[180:183], v[88:91], v[52:55]
    v_mfma_f32_16x16x32_bf16 v[64:67], a[184:187], v[88:91], v[64:67]
    v_mfma_f32_16x16x32_bf16 v[72:75], a[184:187], v[92:95], v[72:75]
    v_mfma_f32_16x16x32_bf16 v[76:79], a[188:191], v[92:95], v[76:79]
    v_mfma_f32_16x16x32_bf16 v[68:71], a[188:191], v[88:91], v[68:71]
    s_waitcnt lgkmcnt(0)
    v_mfma_f32_16x16x32_bf16 v[48:51], a[192:195], v[80:83], v[48:51]
    ds_read_b128 v[88:91], v4 offset:26624
    v_mfma_f32_16x16x32_bf16 v[56:59], a[192:195], v[84:87], v[56:59]
    v_mfma_f32_16x16x32_bf16 v[60:63], a[196:199], v[84:87], v[60:63]
    ds_read_b128 v[92:95], v5 offset:26624
    v_mfma_f32_16x16x32_bf16 v[52:55], a[196:199], v[80:83], v[52:55]
    v_mfma_f32_16x16x32_bf16 v[64:67], a[200:203], v[80:83], v[64:67]
    v_mfma_f32_16x16x32_bf16 v[72:75], a[200:203], v[84:87], v[72:75]
    v_mfma_f32_16x16x32_bf16 v[76:79], a[204:207], v[84:87], v[76:79]
    v_mfma_f32_16x16x32_bf16 v[68:71], a[204:207], v[80:83], v[68:71]
    s_waitcnt lgkmcnt(0)
    v_mfma_f32_16x16x32_bf16 v[48:51], a[208:211], v[88:91], v[48:51]
    ds_read_b128 v[80:83], v4 offset:28672
    v_mfma_f32_16x16x32_bf16 v[56:59], a[208:211], v[92:95], v[56:59]
    v_mfma_f32_16x16x32_bf16 v[60:63], a[212:215], v[92:95], v[60:63]
    ds_read_b128 v[84:87], v5 offset:28672
    v_mfma_f32_16x16x32_bf16 v[52:55], a[212:215], v[88:91], v[52:55]
    v_mfma_f32_16x16x32_bf16 v[64:67], a[216:219], v[88:91], v[64:67]
    v_mfma_f32_16x16x32_bf16 v[72:75], a[216:219], v[92:95], v[72:75]
    v_mfma_f32_16x16x32_bf16 v[76:79], a[220:223], v[92:95], v[76:79]
    v_mfma_f32_16x16x32_bf16 v[68:71], a[220:223], v[88:91], v[68:71]
    s_waitcnt lgkmcnt(0)
    v_mfma_f32_16x16x32_bf16 v[48:51], a[224:227], v[80:83], v[48:51]
    ds_read_b128 v[88:91], v4 offset:30720
    v_mfma_f32_16x16x32_bf16 v[56:59], a[224:227], v[84:87], v[56:59]
    v_mfma_f32_16x16x32_bf16 v[60:63], a[228:231], v[84:87], v[60:63]
    ds_read_b128 v[92:95], v5 offset:30720
    v_mfma_f32_16x16x32_bf16 v[52:55], a[228:231], v[80:83], v[52:55]
    v_mfma_f32_16x16x32_bf16 v[64:67], a[232:235], v[80:83], v[64:67]
    v_mfma_f32_16x16x32_bf16 v[72:75], a[232:235], v[84:87], v[72:75]
    v_mfma_f32_16x16x32_bf16 v[76:79], a[236:239], v[84:87], v[76:79]
    v_mfma_f32_16x16x32_bf16 v[68:71], a[236:239], v[80:83], v[68:71]
    s_waitcnt lgkmcnt(0)
    v_mfma_f32_16x16x32_bf16 v[48:51], a[240:243], v[88:91], v[48:51]
    s_waitcnt vmcnt(0)
    ds_read_b128 v[80:83], v4 offset:32768
    v_cmp_ne_u32 vcc, 0, v96
    v_mfma_f32_16x16x32_bf16 v[56:59], a[240:243], v[92:95], v[56:59]
    v_mfma_f32_16x16x32_bf16 v[60:63], a[244:247], v[92:95], v[60:63]
    s_cbranch_vccnz L_spin80
L_back81:
    ds_read_b128 v[84:87], v5 offset:32768
    s_barrier
    v_mfma_f32_16x16x32_bf16 v[52:55], a[244:247], v[88:91], v[52:55]
    buffer_load_dwordx4 v1, s[16:19], s42 offen offset:0 sc1 lds
    v_mfma_f32_16x16x32_bf16 v[64:67], a[248:251], v[88:91], v[64:67]
    v_mfma_f32_16x16x32_bf16 v[72:75], a[248:251], v[92:95], v[72:75]
    v_mfma_f32_16x16x32_bf16 v[76:79], a[252:255], v[92:95], v[76:79]
    buffer_load_dwordx4 v1, s[16:19], s42 offen offset:1024 sc1 lds
    v_mfma_f32_16x16x32_bf16 v[68:71], a[252:255], v[88:91], v[68:71]
    s_waitcnt lgkmcnt(0)
    v_mfma_f32_16x16x32_bf16 v[48:51], v[128:131], v[80:83], v[48:51]
    ds_read_b128 v[88:91], v4 offset:34816
    v_mfma_f32_16x16x32_bf16 v[56:59], v[128:131], v[84:87], v[56:59]
    buffer_load_dwordx4 v1, s[16:19], s42 offen offset:2048 sc1 lds
    v_mfma_f32_16x16x32_bf16 v[60:63], v[132:135], v[84:87], v[60:63]
    ds_read_b128 v[92:95], v5 offset:34816
    v_mfma_f32_16x16x32_bf16 v[52:55], v[132:135], v[80:83], v[52:55]
    v_mfma_f32_16x16x32_bf16 v[64:67], v[136:139], v[80:83], v[64:67]
    buffer_store_dword v124, v124, s[16:19], s91 offen sc1
    v_mfma_f32_16x16x32_bf16 v[72:75], v[136:139], v[84:87], v[72:75]
    s_add_u32 s91, s91, 65536
    s_add_u32 m0, s43, 12288
    s_add_u32 s42, s41, 12288
    v_mfma_f32_16x16x32_bf16 v[76:79], v[140:143], v[84:87], v[76:79]
    v_mfma_f32_16x16x32_bf16 v[68:71], v[140:143], v[80:83], v[68:71]
    s_waitcnt lgkmcnt(0)
    v_mfma_f32_16x16x32_bf16 v[48:51], v[144:147], v[88:91], v[48:51]
    ds_read_b128 v[80:83], v4 offset:36864
    v_mfma_f32_16x16x32_bf16 v[56:59], v[144:147], v[92:95], v[56:59]
    v_mfma_f32_16x16x32_bf16 v[60:63], v[148:151], v[92:95], v[60:63]
    ds_read_b128 v[84:87], v5 offset:36864
    v_mfma_f32_16x16x32_bf16 v[52:55], v[148:151], v[88:91], v[52:55]
    buffer_load_dwordx4 v1, s[16:19], s42 offen offset:0 sc1 lds
    v_mfma_f32_16x16x32_bf16 v[64:67], v[152:155], v[88:91], v[64:67]
    v_mfma_f32_16x16x32_bf16 v[72:75], v[152:155], v[92:95], v[72:75]
    v_mfma_f32_16x16x32_bf16 v[76:79], v[156:159], v[92:95], v[76:79]
    v_mfma_f32_16x16x32_bf16 v[68:71], v[156:159], v[88:91], v[68:71]
    s_waitcnt lgkmcnt(0)
    v_mfma_f32_16x16x32_bf16 v[48:51], v[160:163], v[80:83], v[48:51]
    ds_read_b128 v[88:91], v4 offset:38912
    v_mfma_f32_16x16x32_bf16 v[56:59], v[160:163], v[84:87], v[56:59]
    buffer_load_dwordx4 v1, s[16:19], s42 offen offset:1024 sc1 lds
    v_mfma_f32_16x16x32_bf16 v[60:63], v[164:167], v[84:87], v[60:63]
    ds_read_b128 v[92:95], v5 offset:38912
    v_mfma_f32_16x16x32_bf16 v[52:55], v[164:167], v[80:83], v[52:55]
    v_mfma_f32_16x16x32_bf16 v[64:67], v[168:171], v[80:83], v[64:67]
    v_mfma_f32_16x16x32_bf16 v[72:75], v[168:171], v[84:87], v[72:75]
    v_mfma_f32_16x16x32_bf16 v[76:79], v[172:175], v[84:87], v[76:79]
    buffer_load_dwordx4 v1, s[16:19], s42 offen offset:2048 sc1 lds
    v_mfma_f32_16x16x32_bf16 v[68:71], v[172:175], v[80:83], v[68:71]
    s_waitcnt lgkmcnt(0)
    s_add_u32 m0, s43, 24576
    s_add_u32 s42, s41, 24576
    v_mfma_f32_16x16x32_bf16 v[48:51], v[176:179], v[88:91], v[48:51]
    ds_read_b128 v[80:83], v4 offset:40960
    v_mfma_f32_16x16x32_bf16 v[56:59], v[176:179], v[92:95], v[56:59]
    v_mfma_f32_16x16x32_bf16 v[60:63], v[180:183], v[92:95], v[60:63]
    ds_read_b128 v[84:87], v5 offset:40960
    v_mfma_f32_16x16x32_bf16 v[52:55], v[180:183], v[88:91], v[52:55]
    buffer_load_dwordx4 v1, s[16:19], s42 offen offset:0 sc1 lds
    v_mfma_f32_16x16x32_bf16 v[64:67], v[184:187], v[88:91], v[64:67]
    v_mfma_f32_16x16x32_bf16 v[72:75], v[184:187], v[92:95], v[72:75]
    v_mfma_f32_16x16x32_bf16 v[76:79], v[188:191], v[92:95], v[76:79]
    v_mfma_f32_16x16x32_bf16 v[68:71], v[188:191], v[88:91], v[68:71]
    s_waitcnt lgkmcnt(0)
    v_mfma_f32_16x16x32_bf16 v[48:51], v[192:195], v[80:83], v[48:51]
    ds_read_b128 v[88:91], v4 offset:43008
    v_mfma_f32_16x16x32_bf16 v[56:59], v[192:195], v[84:87], v[56:59]
    buffer_load_dwordx4 v1, s[16:19], s42 offen offset:1024 sc1 lds
    v_mfma_f32_16x16x32_bf16 v[60:63], v[196:199], v[84:87], v[60:63]
    ds_read_b128 v[92:95], v5 offset:43008
    v_mfma_f32_16x16x32_bf16 v[52:55], v[196:199], v[80:83], v[52:55]
    v_mfma_f32_16x16x32_bf16 v[64:67], v[200:203], v[80:83], v[64:67]
    v_mfma_f32_16x16x32_bf16 v[72:75], v[200:203], v[84:87], v[72:75]
    v_mfma_f32_16x16x32_bf16 v[76:79], v[204:207], v[84:87], v[76:79]
    buffer_load_dwordx4 v1, s[16:19], s42 offen offset:2048 sc1 lds
    v_mfma_f32_16x16x32_bf16 v[68:71], v[204:207], v[80:83], v[68:71]
    s_waitcnt lgkmcnt(0)
    s_add_u32 s45, s45, 65536
    v_mfma_f32_16x16x32_bf16 v[48:51], v[208:211], v[88:91], v[48:51]
    ds_read_b128 v[80:83], v4 offset:45056
    v_mfma_f32_16x16x32_bf16 v[56:59], v[208:211], v[92:95], v[56:59]
    v_mfma_f32_16x16x32_bf16 v[60:63], v[212:215], v[92:95], v[60:63]
    ds_read_b128 v[84:87], v5 offset:45056
    v_mfma_f32_16x16x32_bf16 v[52:55], v[212:215], v[88:91], v[52:55]
    v_mfma_f32_16x16x32_bf16 v[64:67], v[216:219], v[88:91], v[64:67]
    v_mfma_f32_16x16x32_bf16 v[72:75], v[216:219], v[92:95], v[72:75]
    v_mfma_f32_16x16x32_bf16 v[76:79], v[220:223], v[92:95], v[76:79]
    v_mfma_f32_16x16x32_bf16 v[68:71], v[220:223], v[88:91], v[68:71]
    s_waitcnt lgkmcnt(0)
    v_mfma_f32_16x16x32_bf16 v[48:51], v[224:227], v[80:83], v[48:51]
    ds_read_b128 v[88:91], v4 offset:47104
    v_mfma_f32_16x16x32_bf16 v[56:59], v[224:227], v[84:87], v[56:59]
    v_mfma_f32_16x16x32_bf16 v[60:63], v[228:231], v[84:87], v[60:63]
    ds_read_b128 v[92:95], v5 offset:47104
    v_mfma_f32_16x16x32_bf16 v[52:55], v[228:231], v[80:83], v[52:55]
    v_mfma_f32_16x16x32_bf16 v[64:67], v[232:235], v[80:83], v[64:67]
    v_mfma_f32_16x16x32_bf16 v[72:75], v[232:235], v[84:87], v[72:75]
    v_mfma_f32_16x16x32_bf16 v[76:79], v[236:239], v[84:87], v[76:79]
    v_mfma_f32_16x16x32_bf16 v[68:71], v[236:239], v[80:83], v[68:71]
    s_waitcnt vmcnt(7) lgkmcnt(0)
    s_barrier
    v_mfma_f32_16x16x32_bf16 v[48:51], v[240:243], v[88:91], v[48:51]
    ds_read_b128 v[80:83], v2 offset:0
    v_mfma_f32_16x16x32_bf16 v[56:59], v[240:243], v[92:95], v[56:59]
    v_mfma_f32_16x16x32_bf16 v[60:63], v[244:247], v[92:95], v[60:63]
    ds_read_b128 v[84:87], v3 offset:0
    v_mfma_f32_16x16x32_bf16 v[52:55], v[244:247], v[88:91], v[52:55]
    v_mfma_f32_16x16x32_bf16 v[64:67], v[248:251], v[88:91], v[64:67]
    v_mfma_f32_16x16x32_bf16 v[72:75], v[248:251], v[92:95], v[72:75]
    v_mfma_f32_16x16x32_bf16 v[76:79], v[252:255], v[92:95], v[76:79]
    v_mfma_f32_16x16x32_bf16 v[68:71], v[252:255], v[88:91], v[68:71]
    s_add_u32 s36, s36, 1
    s_cmp_lt_u32 s36, 32
    s_cbranch_scc1 L_bs_b0
    s_nop 7
    s_and_b32 s44, s90, 0xffffffff
    s_cmp_lt_i32 s36, 1
    s_cselect_b32 s44, 0x5e00000, s44
    s_xor_b32 s49, s44, 0
    v_cvt_pk_bf16_f32 v48, v48, v49
    v_cvt_pk_bf16_f32 v49, v50, v51
    v_cvt_pk_bf16_f32 v50, v52, v53
    v_cvt_pk_bf16_f32 v51, v54, v55
    buffer_store_dwordx4 v[48:51], v1, s[16:19], s49 offen offset:3072 sc1
    s_xor_b32 s49, s44, 16384
    v_cvt_pk_bf16_f32 v56, v56, v57
    v_cvt_pk_bf16_f32 v57, v58, v59
    v_cvt_pk_bf16_f32 v58, v60, v61
    v_cvt_pk_bf16_f32 v59, v62, v63
    buffer_store_dwordx4 v[56:59], v1, s[16:19], s49 offen offset:3072 sc1
    s_xor_b32 s49, s44, 32768
    v_cvt_pk_bf16_f32 v64, v64, v65
    v_cvt_pk_bf16_f32 v65, v66, v67
    v_cvt_pk_bf16_f32 v66, v68, v69
    v_cvt_pk_bf16_f32 v67, v70, v71
    buffer_store_dwordx4 v[64:67], v1, s[16:19], s49 offen offset:3072 sc1
    s_xor_b32 s49, s44, 49152
    v_cvt_pk_bf16_f32 v72, v72, v73
    v_cvt_pk_bf16_f32 v73, v74, v75
    v_cvt_pk_bf16_f32 v74, v76, v77
    v_cvt_pk_bf16_f32 v75, v78, v79
    buffer_store_dwordx4 v[72:75], v1, s[16:19], s49 offen offset:3072 sc1
    s_add_u32 s90, s90, 262144
    s_waitcnt vmcnt(0)
    s_barrier
    buffer_store_dword v124, v124, s[16:19], s91 offen sc1
    s_add_u32 s91, s91, 65536
    s_waitcnt vmcnt(0)
    s_endpgm
L_spin69:
    s_mov_b32 s40, 0x20000
L_spin69_l:
    buffer_load_dword v48, v124, s[20:23], 0 offen sc1
    s_sub_u32 s40, s40, 1
    s_waitcnt vmcnt(0)
    v_cmp_eq_u32 vcc, v124, v48
    s_cbranch_scc1 L_back70
    s_cbranch_vccz L_back70
    s_sleep 8
    s_branch L_spin69_l
L_spin71:
    s_mov_b32 s40, 0x20000
L_spin71_l:
    buffer_load_dword v49, v48, s[16:19], s38 offen sc1
    s_sub_u32 s40, s40, 1
    s_waitcnt vmcnt(0)
    v_cmp_ne_u32 vcc, 0, v49
    s_cbranch_scc1 L_back72
    s_cbranch_vccz L_back72
    s_sleep 8
    s_branch L_spin71_l
L_spin74:
    s_mov_b32 s40, 0x20000
L_spin74_l:
    buffer_load_dword v80, v124, s[20:23], 0 offen sc1
    s_sub_u32 s40, s40, 1
    s_waitcnt vmcnt(0)
    v_cmp_eq_u32 vcc, v124, v80
    s_cbranch_scc1 L_back75
    s_cbranch_vccz L_back75
    s_sleep 8
    s_branch L_spin74_l
L_spin76:
    s_mov_b32 s40, 0x20000
L_spin76_l:
    buffer_load_dword v96, v6, s[16:19], s45 offen sc1
    s_sub_u32 s40, s40, 1
    s_waitcnt vmcnt(0)
    v_cmp_ne_u32 vcc, 0, v96
    s_cbranch_scc1 L_back77
    s_cbranch_vccz L_back77
    s_sleep 2
    s_branch L_spin76_l
L_spin78:
    s_mov_b32 s40, 0x20000
L_spin78_l:
    buffer_load_dword v96, v6, s[16:19], s45 offen sc1
    s_sub_u32 s40, s40, 1
    s_waitcnt vmcnt(0)
    v_cmp_ne_u32 vcc, 0, v96
    s_cbranch_scc1 L_back79
    s_cbranch_vccz L_back79
    s_sleep 2
    s_branch L_spin78_l
L_spin80:
    s_mov_b32 s40, 0x20000
L_spin80_l:
    buffer_load_dword v96, v6, s[16:19], s45 offen sc1
    s_sub_u32 s40, s40, 1
    s_waitcnt vmcnt(0)
    v_cmp_ne_u32 vcc, 0, v96
    s_cbranch_scc1 L_back81
    s_cbranch_vccz L_back81
    s_sleep 2
    s_branch L_spin80_l
L_code_end:
    s_endpgm
.section .rodata,"a"
.p2align 6
.amdhsa_kernel interleave_layers__sliding_local_dilated__dense_activation_squared_relu__prompt_kernel
  .amdhsa_next_free_vgpr 512
  .amdhsa_next_free_sgpr 102
  .amdhsa_accum_offset 256
  .amdhsa_group_segment_fixed_size 0
  .amdhsa_kernarg_size 88
  .amdhsa_user_sgpr_count 2
  .amdhsa_user_sgpr_kernarg_segment_ptr 1
  .amdhsa_system_sgpr_workgroup_id_x 1
.end_amdhsa_kernel
```

```asm
; @launch grid=(256,1,1) block=(256,1,1) lds=163840
.amdgcn_target "amdgcn-amd-amdhsa--gfx950"
.text
.globl interleave_layers__sliding_local_dilated__dense_activation_squared_relu__prompt_kernel
.p2align 8
.type interleave_layers__sliding_local_dilated__dense_activation_squared_relu__prompt_kernel,@function
interleave_layers__sliding_local_dilated__dense_activation_squared_relu__prompt_kernel:
    s_load_dwordx16 s[64:79], s[0:1], 0x0
    s_load_dwordx4 s[80:83], s[0:1], 0x40
    s_load_dwordx2 s[84:85], s[0:1], 0x50
    v_lshrrev_b32 v1, 6, v0
    s_cmp_ge_u32 s2, 256
    s_cbranch_scc1 L_code_end
    s_getpc_b64 s[20:21]
L_pc:
    s_mov_b32 s22, L_code_end-L_pc
    s_mov_b32 s23, 0x00020000
    v_lshlrev_b32 v7, 12, v0
    s_lshl_b32 s37, s2, 4
    buffer_load_dword v252, v7, s[20:23], s37 offen
    v_readfirstlane_b32 s32, v1
    v_and_b32 v0, 63, v0
    v_lshlrev_b32 v1, 4, v0
    s_bfe_u32 s47, s2, 0x20001
    s_and_b32 s37, s2, 0x81
    s_cmp_lg_u32 s37, 0
    s_cbranch_scc1 L_other
    s_bfe_u32 s33, s2, 0x20003
    s_lshr_b32 s34, s2, 5
    s_lshl2_add_u32 s34, s47, s34
    s_mov_b32 s35, s34
    s_movk_i32 s39, 6144
    s_lshl_b32 s54, s35, 7
    v_lshrrev_b32 v32, 3, v0
    v_lshlrev_b32 v33, 2, v0
    v_and_b32 v33, 64, v33
    v_and_b32 v34, 0x70, v1
    v_xor_b32 v33, v33, v34
    v_mad_u32_u24 v20, v32, s39, v33
    v_add_u32 v21, 49152, v20
    v_add_u32 v22, 2048, v20
    v_add_u32 v23, 51200, v20
    v_add_u32 v24, 4096, v20
    v_add_u32 v25, 53248, v20
    s_mul_i32 s38, s32, 98304
    s_add_u32 s54, s54, s38
    s_lshl_b32 s42, s32, 11
    s_lshr_b32 s51, s32, 1
    s_lshl_b32 s50, s33, 5
    s_add_u32 s53, s50, 31
    s_lshl_b32 s53, s53, 8
    s_add_u32 s53, s53, s51
    s_lshl_b32 s53, s53, 7
    s_add_u32 s50, s50, 30
    s_sub_u32 s50, s50, s51
    s_lshl_b32 s41, s50, 15
    s_lshl_b32 s43, s32, 10
    v_lshlrev_b32 v37, 1, v0
    v_and_b32 v37, 0x60, v37
    v_xor_b32 v37, v37, v34
    s_and_b32 s37, s32, 1
    s_lshl_b32 s37, s37, 14
    v_lshl_add_u32 v6, v32, 11, v37
    v_add_u32 v6, s37, v6
    s_waitcnt lgkmcnt(0)
    s_mov_b32 s12, s66
    s_mov_b32 s13, s67
    s_mov_b32 s14, 0x600000
    s_mov_b32 s15, 0x00020000
    s_mov_b32 s8, s64
    s_mov_b32 s9, s65
    s_mov_b32 s10, 0x400000
    s_mov_b32 s11, 0x00020000
    s_add_u32 m0, s43, 131072
    s_nop 0
    buffer_load_dwordx4 v6, s[8:11], s53 offen offset:0 sc1 lds
    s_add_u32 m0, s43, 98304
    s_nop 0
    buffer_load_dwordx4 v6, s[8:11], s41 offen offset:0 sc1 lds
    s_add_u32 m0, s42, 73728
    s_nop 0
    buffer_load_dwordx4 v20, s[12:15], s54 offen lds
    s_add_u32 m0, s42, 74752
    s_nop 0
    buffer_load_dwordx4 v21, s[12:15], s54 offen lds
    s_add_u32 m0, s42, 81920
    s_nop 0
    buffer_load_dwordx4 v22, s[12:15], s54 offen lds
    s_add_u32 m0, s42, 82944
    s_nop 0
    buffer_load_dwordx4 v23, s[12:15], s54 offen lds
    s_add_u32 m0, s42, 90112
    s_nop 0
    buffer_load_dwordx4 v24, s[12:15], s54 offen lds
    s_add_u32 m0, s42, 91136
    s_nop 0
    buffer_load_dwordx4 v25, s[12:15], s54 offen lds
    s_add_u32 s54, s54, 393216
    v_lshrrev_b32 v32, 4, v0
    v_bfe_u32 v33, v0, 2, 2
    v_lshl_add_u32 v32, v32, 3, v33
    v_lshlrev_b32 v32, 7, v32
    v_lshrrev_b32 v33, 1, v33
    v_lshl_add_u32 v32, v33, 6, v32
    v_and_b32 v33, 3, v0
    v_lshl_add_u32 v32, v33, 4, v32
    s_lshl_b32 s37, s51, 6
    s_and_b32 s38, s32, 1
    s_lshl_b32 s38, s38, 3
    s_add_u32 s37, s37, s38
    s_add_u32 s37, s37, 0
    v_xor_b32 v26, s37, v32
    s_lshl_b32 s37, s51, 6
    s_and_b32 s38, s32, 1
    s_lshl_b32 s38, s38, 3
    s_add_u32 s37, s37, s38
    s_add_u32 s37, s37, 8192
    v_xor_b32 v27, s37, v32
    s_lshl_b32 s37, s51, 6
    s_and_b32 s38, s32, 1
    s_lshl_b32 s38, s38, 3
    s_add_u32 s37, s37, s38
    s_add_u32 s37, s37, 16384
    v_xor_b32 v28, s37, v32
    v_mov_b32 v32, 0x3f803f80
    v_mov_b32 v33, 0x3f803f80
    v_mov_b32 v34, 0x3f803f80
    v_mov_b32 v35, 0x3f803f80
    v_and_b32 v36, 15, v0
    v_lshrrev_b32 v37, 4, v0
    v_and_b32 v38, 6, v36
    v_xor_b32 v38, v37, v38
    v_lshlrev_b32 v38, 4, v38
    v_lshl_add_u32 v2, v36, 7, v38
    v_xor_b32 v3, 64, v2
    v_add_u32 v4, 98304, v2
    v_add_u32 v5, 98304, v3
    s_add_u32 m0, s43, 102272
    s_nop 0
    buffer_load_dwordx4 v6, s[8:11], s41 offen offset:128 sc1 lds
    s_add_u32 m0, s42, 0
    s_nop 0
    buffer_load_dwordx4 v20, s[12:15], s54 offen lds
    s_add_u32 m0, s42, 1024
    s_nop 0
    buffer_load_dwordx4 v21, s[12:15], s54 offen lds
    s_add_u32 m0, s42, 8192
    s_nop 0
    buffer_load_dwordx4 v22, s[12:15], s54 offen lds
    s_add_u32 m0, s42, 9216
    s_nop 0
    buffer_load_dwordx4 v23, s[12:15], s54 offen lds
    s_add_u32 m0, s42, 16384
    s_nop 0
    buffer_load_dwordx4 v24, s[12:15], s54 offen lds
    s_add_u32 m0, s42, 17408
    s_nop 0
    buffer_load_dwordx4 v25, s[12:15], s54 offen lds
    s_add_u32 s54, s54, 393216
    s_add_u32 m0, s43, 134912
    s_nop 0
    buffer_load_dwordx4 v6, s[8:11], s53 offen offset:256 sc1 lds
    s_add_u32 m0, s43, 106240
    s_nop 0
    buffer_load_dwordx4 v6, s[8:11], s41 offen offset:256 sc1 lds
    s_add_u32 m0, s42, 24576
    s_nop 0
    buffer_load_dwordx4 v20, s[12:15], s54 offen lds
    s_add_u32 m0, s42, 25600
    s_nop 0
    buffer_load_dwordx4 v21, s[12:15], s54 offen lds
    s_add_u32 m0, s42, 32768
    s_nop 0
    buffer_load_dwordx4 v22, s[12:15], s54 offen lds
    s_add_u32 m0, s42, 33792
    s_nop 0
    buffer_load_dwordx4 v23, s[12:15], s54 offen lds
    s_add_u32 m0, s42, 40960
    s_nop 0
    buffer_load_dwordx4 v24, s[12:15], s54 offen lds
    s_add_u32 m0, s42, 41984
    s_nop 0
    buffer_load_dwordx4 v25, s[12:15], s54 offen lds
    s_add_u32 s54, s54, 393216
    s_mov_b32 s36, -1
    v_add_u32 v29, 73728, v26
    v_add_u32 v30, 73728, v27
    v_add_u32 v31, 73728, v28
    s_waitcnt vmcnt(15) lgkmcnt(0)
    s_barrier
    ds_read_b128 v[68:71], v4 offset:0
    s_add_u32 m0, s43, 110208
    ds_read_b128 v[72:75], v4 offset:2048
    buffer_load_dwordx4 v6, s[8:11], s41 offen offset:384 sc1 lds
    ds_read_b128 v[76:79], v4 offset:32768
    s_add_u32 m0, s42, 49152
    ds_read_b64_tr_b16 a[0:1], v29 offset:0
    buffer_load_dwordx4 v20, s[12:15], s54 offen lds
    ds_read_b64_tr_b16 a[2:3], v29 offset:512
    s_add_u32 m0, s42, 50176
    ds_read_b64_tr_b16 a[4:5], v30 offset:0
    buffer_load_dwordx4 v21, s[12:15], s54 offen lds
    ds_read_b64_tr_b16 a[6:7], v30 offset:512
    s_add_u32 m0, s42, 57344
    ds_read_b64_tr_b16 a[8:9], v31 offset:0
    buffer_load_dwordx4 v22, s[12:15], s54 offen lds
    ds_read_b64_tr_b16 a[10:11], v31 offset:512
    s_waitcnt lgkmcnt(0)
    v_mfma_f32_16x16x32_bf16 v[44:47], a[0:3], v[68:71], 0
    ds_read_b128 v[80:83], v5 offset:0
    s_add_u32 m0, s42, 58368
    v_mfma_f32_16x16x32_bf16 v[48:51], a[0:3], v[72:75], 0
    ds_read_b128 v[84:87], v5 offset:2048
    buffer_load_dwordx4 v23, s[12:15], s54 offen lds
    v_mfma_f32_16x16x32_bf16 v[92:95], a[0:3], v[76:79], 0
    ds_read_b128 v[88:91], v5 offset:32768
    s_add_u32 m0, s42, 65536
    v_mfma_f32_16x16x32_bf16 v[52:55], a[4:7], v[68:71], 0
    ds_read_b64_tr_b16 a[12:13], v29 offset:4096
    buffer_load_dwordx4 v24, s[12:15], s54 offen lds
    v_mfma_f32_16x16x32_bf16 v[56:59], a[4:7], v[72:75], 0
    ds_read_b64_tr_b16 a[14:15], v29 offset:4608
    s_add_u32 m0, s42, 66560
    v_mfma_f32_16x16x32_bf16 v[96:99], a[4:7], v[76:79], 0
    ds_read_b64_tr_b16 a[16:17], v30 offset:4096
    buffer_load_dwordx4 v25, s[12:15], s54 offen lds
    v_mfma_f32_16x16x32_bf16 v[60:63], a[8:11], v[68:71], 0
    ds_read_b64_tr_b16 a[18:19], v30 offset:4608
    s_add_u32 s54, s54, 393216
    v_mfma_f32_16x16x32_bf16 v[64:67], a[8:11], v[72:75], 0
    ds_read_b64_tr_b16 a[20:21], v31 offset:4096
    v_mfma_f32_16x16x32_bf16 v[118:121], a[8:11], v[76:79], 0
    ds_read_b64_tr_b16 a[22:23], v31 offset:4608
    v_mfma_f32_16x16x32_bf16 v[100:103], a[0:3], v[32:35], 0
    v_mfma_f32_16x16x32_bf16 v[104:107], a[4:7], v[32:35], 0
    v_mfma_f32_16x16x32_bf16 v[108:111], a[8:11], v[32:35], 0
    s_mov_b32 s16, s84
    s_mov_b32 s17, s85
    s_mov_b32 s18, 0x5e00000
    s_mov_b32 s19, 0x00020000
    v_min_u32 v124, 1, v0
    v_lshlrev_b32 v124, 30, v124
    s_lshl_b32 s91, s33, 6
    s_add_u32 s91, s91, s34
    s_lshl_b32 s91, s91, 7
    s_add_u32 s91, s91, 0x5520000
    s_cmp_eq_u32 s32, 1
    s_cselect_b32 s91, s91, 0x5f00000
    v_add_u32 v29, 0, v26
    v_add_u32 v30, 0, v27
    v_add_u32 v31, 0, v28
    s_waitcnt vmcnt(15) lgkmcnt(0)
    s_barrier
    v_mfma_f32_16x16x32_bf16 v[44:47], a[12:15], v[80:83], v[44:47]
    ds_read_b128 v[68:71], v4 offset:4096
    s_add_u32 m0, s43, 138752
    v_mfma_f32_16x16x32_bf16 v[48:51], a[12:15], v[84:87], v[48:51]
    ds_read_b128 v[72:75], v4 offset:6144
    buffer_load_dwordx4 v6, s[8:11], s53 offen offset:512 sc1 lds
    v_mfma_f32_16x16x32_bf16 v[92:95], a[12:15], v[88:91], v[92:95]
    ds_read_b128 v[76:79], v4 offset:34816
    s_add_u32 m0, s43, 114176
    v_mfma_f32_16x16x32_bf16 v[52:55], a[16:19], v[80:83], v[52:55]
    ds_read_b64_tr_b16 a[24:25], v29 offset:0
    buffer_load_dwordx4 v6, s[8:11], s41 offen offset:512 sc1 lds
    v_mfma_f32_16x16x32_bf16 v[56:59], a[16:19], v[84:87], v[56:59]
    ds_read_b64_tr_b16 a[26:27], v29 offset:512
    s_add_u32 m0, s42, 73728
    v_mfma_f32_16x16x32_bf16 v[96:99], a[16:19], v[88:91], v[96:99]
    ds_read_b64_tr_b16 a[28:29], v30 offset:0
    buffer_load_dwordx4 v20, s[12:15], s54 offen lds
    v_mfma_f32_16x16x32_bf16 v[60:63], a[20:23], v[80:83], v[60:63]
    ds_read_b64_tr_b16 a[30:31], v30 offset:512
    s_add_u32 m0, s42, 74752
    v_mfma_f32_16x16x32_bf16 v[64:67], a[20:23], v[84:87], v[64:67]
    ds_read_b64_tr_b16 a[32:33], v31 offset:0
    buffer_load_dwordx4 v21, s[12:15], s54 offen lds
    v_mfma_f32_16x16x32_bf16 v[118:121], a[20:23], v[88:91], v[118:121]
    ds_read_b64_tr_b16 a[34:35], v31 offset:512
    v_mfma_f32_16x16x32_bf16 v[100:103], a[12:15], v[32:35], v[100:103]
    v_mfma_f32_16x16x32_bf16 v[104:107], a[16:19], v[32:35], v[104:107]
    v_mfma_f32_16x16x32_bf16 v[108:111], a[20:23], v[32:35], v[108:111]
    s_waitcnt lgkmcnt(0)
    v_mfma_f32_16x16x32_bf16 v[44:47], a[24:27], v[68:71], v[44:47]
    ds_read_b128 v[80:83], v5 offset:4096
    s_add_u32 m0, s42, 81920
    v_mfma_f32_16x16x32_bf16 v[48:51], a[24:27], v[72:75], v[48:51]
    ds_read_b128 v[84:87], v5 offset:6144
    buffer_load_dwordx4 v22, s[12:15], s54 offen lds
    v_mfma_f32_16x16x32_bf16 v[92:95], a[24:27], v[76:79], v[92:95]
    ds_read_b128 v[88:91], v5 offset:34816
    s_add_u32 m0, s42, 82944
    v_mfma_f32_16x16x32_bf16 v[52:55], a[28:31], v[68:71], v[52:55]
    ds_read_b64_tr_b16 a[36:37], v29 offset:4096
    buffer_load_dwordx4 v23, s[12:15], s54 offen lds
    v_mfma_f32_16x16x32_bf16 v[56:59], a[28:31], v[72:75], v[56:59]
    ds_read_b64_tr_b16 a[38:39], v29 offset:4608
    s_add_u32 m0, s42, 90112
    v_mfma_f32_16x16x32_bf16 v[96:99], a[28:31], v[76:79], v[96:99]
    ds_read_b64_tr_b16 a[40:41], v30 offset:4096
    buffer_load_dwordx4 v24, s[12:15], s54 offen lds
    v_mfma_f32_16x16x32_bf16 v[60:63], a[32:35], v[68:71], v[60:63]
    ds_read_b64_tr_b16 a[42:43], v30 offset:4608
    s_add_u32 m0, s42, 91136
    v_mfma_f32_16x16x32_bf16 v[64:67], a[32:35], v[72:75], v[64:67]
    ds_read_b64_tr_b16 a[44:45], v31 offset:4096
    buffer_load_dwordx4 v25, s[12:15], s54 offen lds
    v_mfma_f32_16x16x32_bf16 v[118:121], a[32:35], v[76:79], v[118:121]
    ds_read_b64_tr_b16 a[46:47], v31 offset:4608
    s_add_u32 s54, s54, 393216
    v_mfma_f32_16x16x32_bf16 v[100:103], a[24:27], v[32:35], v[100:103]
    v_mfma_f32_16x16x32_bf16 v[104:107], a[28:31], v[32:35], v[104:107]
    v_mfma_f32_16x16x32_bf16 v[108:111], a[32:35], v[32:35], v[108:111]
    s_add_u32 s88, s84, 0x5000000
    s_addc_u32 s89, s85, 0
    s_mov_b32 s97, 14
    s_and_b32 s38, s32, 1
    v_lshlrev_b32 v40, 1, v0
    v_and_b32 v40, 0x30, v40
    v_xor_b32 v40, v40, v1
    s_mul_i32 s37, s51, 3072
    s_add_u32 s37, s37, 65536
    s_lshl_b32 s39, s38, 3
    s_add_u32 s39, s39, s37
    v_add_u32 v29, 24576, v26
    v_add_u32 v30, 24576, v27
    v_add_u32 v31, 24576, v28
    s_waitcnt vmcnt(15) lgkmcnt(0)
    s_barrier
    v_mfma_f32_16x16x32_bf16 v[44:47], a[36:39], v[80:83], v[44:47]
    ds_read_b128 v[68:71], v4 offset:8192
    s_add_u32 m0, s43, 118144
    v_mfma_f32_16x16x32_bf16 v[48:51], a[36:39], v[84:87], v[48:51]
    ds_read_b128 v[72:75], v4 offset:10240
    buffer_load_dwordx4 v6, s[8:11], s41 offen offset:640 sc1 lds
    v_mfma_f32_16x16x32_bf16 v[92:95], a[36:39], v[88:91], v[92:95]
    ds_read_b128 v[76:79], v4 offset:36864
    s_add_u32 m0, s42, 0
    v_mfma_f32_16x16x32_bf16 v[52:55], a[40:43], v[80:83], v[52:55]
    ds_read_b64_tr_b16 a[48:49], v29 offset:0
    buffer_load_dwordx4 v20, s[12:15], s54 offen lds
    v_mfma_f32_16x16x32_bf16 v[56:59], a[40:43], v[84:87], v[56:59]
    ds_read_b64_tr_b16 a[50:51], v29 offset:512
    s_add_u32 m0, s42, 1024
    v_mfma_f32_16x16x32_bf16 v[96:99], a[40:43], v[88:91], v[96:99]
    ds_read_b64_tr_b16 a[52:53], v30 offset:0
    buffer_load_dwordx4 v21, s[12:15], s54 offen lds
    v_mfma_f32_16x16x32_bf16 v[60:63], a[44:47], v[80:83], v[60:63]
    ds_read_b64_tr_b16 a[54:55], v30 offset:512
    s_add_u32 m0, s42, 8192
    v_mfma_f32_16x16x32_bf16 v[64:67], a[44:47], v[84:87], v[64:67]
    ds_read_b64_tr_b16 a[56:57], v31 offset:0
    buffer_load_dwordx4 v22, s[12:15], s54 offen lds
    v_mfma_f32_16x16x32_bf16 v[118:121], a[44:47], v[88:91], v[118:121]
    ds_read_b64_tr_b16 a[58:59], v31 offset:512
    v_mfma_f32_16x16x32_bf16 v[100:103], a[36:39], v[32:35], v[100:103]
    v_mfma_f32_16x16x32_bf16 v[104:107], a[40:43], v[32:35], v[104:107]
    v_mfma_f32_16x16x32_bf16 v[108:111], a[44:47], v[32:35], v[108:111]
    s_waitcnt lgkmcnt(0)
    v_mfma_f32_16x16x32_bf16 v[44:47], a[48:51], v[68:71], v[44:47]
    ds_read_b128 v[80:83], v5 offset:8192
    s_add_u32 m0, s42, 9216
    v_mfma_f32_16x16x32_bf16 v[48:51], a[48:51], v[72:75], v[48:51]
    ds_read_b128 v[84:87], v5 offset:10240
    buffer_load_dwordx4 v23, s[12:15], s54 offen lds
    v_mfma_f32_16x16x32_bf16 v[92:95], a[48:51], v[76:79], v[92:95]
    ds_read_b128 v[88:91], v5 offset:36864
    s_add_u32 m0, s42, 16384
    v_mfma_f32_16x16x32_bf16 v[52:55], a[52:55], v[68:71], v[52:55]
    ds_read_b64_tr_b16 a[60:61], v29 offset:4096
    buffer_load_dwordx4 v24, s[12:15], s54 offen lds
    v_mfma_f32_16x16x32_bf16 v[56:59], a[52:55], v[72:75], v[56:59]
    ds_read_b64_tr_b16 a[62:63], v29 offset:4608
    s_add_u32 m0, s42, 17408
    v_mfma_f32_16x16x32_bf16 v[96:99], a[52:55], v[76:79], v[96:99]
    ds_read_b64_tr_b16 a[64:65], v30 offset:4096
    buffer_load_dwordx4 v25, s[12:15], s54 offen lds
    v_mfma_f32_16x16x32_bf16 v[60:63], a[56:59], v[68:71], v[60:63]
    ds_read_b64_tr_b16 a[66:67], v30 offset:4608
    s_add_u32 s54, s54, 393216
    v_mfma_f32_16x16x32_bf16 v[64:67], a[56:59], v[72:75], v[64:67]
    ds_read_b64_tr_b16 a[68:69], v31 offset:4096
    v_mfma_f32_16x16x32_bf16 v[118:121], a[56:59], v[76:79], v[118:121]
    ds_read_b64_tr_b16 a[70:71], v31 offset:4608
    v_mfma_f32_16x16x32_bf16 v[100:103], a[48:51], v[32:35], v[100:103]
    v_mfma_f32_16x16x32_bf16 v[104:107], a[52:55], v[32:35], v[104:107]
    v_mfma_f32_16x16x32_bf16 v[108:111], a[56:59], v[32:35], v[108:111]
    v_add_u32 v7, s39, v40
    v_bfe_u32 v38, v0, 1, 2
    v_xor_b32 v38, v38, v37
    v_lshlrev_b32 v38, 4, v38
    v_lshl_add_u32 v38, v36, 6, v38
    v_add_u32 v8, s39, v38
    s_mul_i32 s39, s38, 6144
    s_add_u32 s39, s39, s37
    v_add_u32 v9, s39, v40
    s_cmp_eq_u32 s38, 0
    s_cselect_b32 s39, 18432, 0
    v_add_u32 v29, 49152, v26
    v_add_u32 v30, 49152, v27
    v_add_u32 v31, 49152, v28
    s_waitcnt vmcnt(15) lgkmcnt(0)
    s_barrier
    v_mfma_f32_16x16x32_bf16 v[44:47], a[60:63], v[80:83], v[44:47]
    ds_read_b128 v[68:71], v4 offset:12288
    s_add_u32 m0, s43, 142592
    v_mfma_f32_16x16x32_bf16 v[48:51], a[60:63], v[84:87], v[48:51]
    ds_read_b128 v[72:75], v4 offset:14336
    buffer_load_dwordx4 v6, s[8:11], s53 offen offset:768 sc1 lds
    v_mfma_f32_16x16x32_bf16 v[92:95], a[60:63], v[88:91], v[92:95]
    ds_read_b128 v[76:79], v4 offset:38912
    s_add_u32 m0, s43, 122112
    v_mfma_f32_16x16x32_bf16 v[52:55], a[64:67], v[80:83], v[52:55]
    ds_read_b64_tr_b16 a[72:73], v29 offset:0
    buffer_load_dwordx4 v6, s[8:11], s41 offen offset:768 sc1 lds
    v_mfma_f32_16x16x32_bf16 v[56:59], a[64:67], v[84:87], v[56:59]
    ds_read_b64_tr_b16 a[74:75], v29 offset:512
    s_add_u32 m0, s42, 24576
    v_mfma_f32_16x16x32_bf16 v[96:99], a[64:67], v[88:91], v[96:99]
    ds_read_b64_tr_b16 a[76:77], v30 offset:0
    buffer_load_dwordx4 v20, s[12:15], s54 offen lds
    v_mfma_f32_16x16x32_bf16 v[60:63], a[68:71], v[80:83], v[60:63]
    ds_read_b64_tr_b16 a[78:79], v30 offset:512
    s_add_u32 m0, s42, 25600
    v_mfma_f32_16x16x32_bf16 v[64:67], a[68:71], v[84:87], v[64:67]
    ds_read_b64_tr_b16 a[80:81], v31 offset:0
    buffer_load_dwordx4 v21, s[12:15], s54 offen lds
    v_mfma_f32_16x16x32_bf16 v[118:121], a[68:71], v[88:91], v[118:121]
    ds_read_b64_tr_b16 a[82:83], v31 offset:512
    v_mfma_f32_16x16x32_bf16 v[100:103], a[60:63], v[32:35], v[100:103]
    v_mfma_f32_16x16x32_bf16 v[104:107], a[64:67], v[32:35], v[104:107]
    v_mfma_f32_16x16x32_bf16 v[108:111], a[68:71], v[32:35], v[108:111]
    s_waitcnt lgkmcnt(0)
    v_mfma_f32_16x16x32_bf16 v[44:47], a[72:75], v[68:71], v[44:47]
    ds_read_b128 v[80:83], v5 offset:12288
    s_add_u32 m0, s42, 32768
    v_mfma_f32_16x16x32_bf16 v[48:51], a[72:75], v[72:75], v[48:51]
    ds_read_b128 v[84:87], v5 offset:14336
    buffer_load_dwordx4 v22, s[12:15], s54 offen lds
    v_mfma_f32_16x16x32_bf16 v[92:95], a[72:75], v[76:79], v[92:95]
    ds_read_b128 v[88:91], v5 offset:38912
    s_add_u32 m0, s42, 33792
    v_mfma_f32_16x16x32_bf16 v[52:55], a[76:79], v[68:71], v[52:55]
    ds_read_b64_tr_b16 a[84:85], v29 offset:4096
    buffer_load_dwordx4 v23, s[12:15], s54 offen lds
    v_mfma_f32_16x16x32_bf16 v[56:59], a[76:79], v[72:75], v[56:59]
    ds_read_b64_tr_b16 a[86:87], v29 offset:4608
    s_add_u32 m0, s42, 40960
    v_mfma_f32_16x16x32_bf16 v[96:99], a[76:79], v[76:79], v[96:99]
    ds_read_b64_tr_b16 a[88:89], v30 offset:4096
    buffer_load_dwordx4 v24, s[12:15], s54 offen lds
    v_mfma_f32_16x16x32_bf16 v[60:63], a[80:83], v[68:71], v[60:63]
    ds_read_b64_tr_b16 a[90:91], v30 offset:4608
    s_add_u32 m0, s42, 41984
    v_mfma_f32_16x16x32_bf16 v[64:67], a[80:83], v[72:75], v[64:67]
    ds_read_b64_tr_b16 a[92:93], v31 offset:4096
    buffer_load_dwordx4 v25, s[12:15], s54 offen lds
    v_mfma_f32_16x16x32_bf16 v[118:121], a[80:83], v[76:79], v[118:121]
    ds_read_b64_tr_b16 a[94:95], v31 offset:4608
    s_add_u32 s54, s54, 393216
    v_mfma_f32_16x16x32_bf16 v[100:103], a[72:75], v[32:35], v[100:103]
    v_mfma_f32_16x16x32_bf16 v[104:107], a[76:79], v[32:35], v[104:107]
    v_mfma_f32_16x16x32_bf16 v[108:111], a[80:83], v[32:35], v[108:111]
    s_add_u32 s39, s39, s37
    v_add_u32 v10, s39, v40
    s_sub_u32 s39, s33, 1
    s_max_i32 s39, s39, 0
    v_mov_b32 v38, s33
    v_mov_b32 v39, s39
    v_mov_b32 v12, 1048576
    v_mov_b32 v41, 131072
    v_cmp_lt_u32 vcc, 15, v0
    s_nop 1
    v_cndmask_b32 v38, v38, v39, vcc
    v_cndmask_b32 v12, v12, v41, vcc
    v_add_u32 v29, 73728, v26
    v_add_u32 v30, 73728, v27
    v_add_u32 v31, 73728, v28
    s_waitcnt vmcnt(15) lgkmcnt(0)
    s_barrier
    v_mfma_f32_16x16x32_bf16 v[44:47], a[84:87], v[80:83], v[44:47]
    ds_read_b128 v[68:71], v4 offset:16384
    s_add_u32 m0, s43, 126080
    v_mfma_f32_16x16x32_bf16 v[48:51], a[84:87], v[84:87], v[48:51]
    ds_read_b128 v[72:75], v4 offset:18432
    buffer_load_dwordx4 v6, s[8:11], s41 offen offset:896 sc1 lds
    v_mfma_f32_16x16x32_bf16 v[92:95], a[84:87], v[88:91], v[92:95]
    ds_read_b128 v[76:79], v4 offset:40960
    s_add_u32 m0, s42, 49152
    v_mfma_f32_16x16x32_bf16 v[52:55], a[88:91], v[80:83], v[52:55]
    ds_read_b64_tr_b16 a[96:97], v29 offset:0
    buffer_load_dwordx4 v20, s[12:15], s54 offen lds
    v_mfma_f32_16x16x32_bf16 v[56:59], a[88:91], v[84:87], v[56:59]
    ds_read_b64_tr_b16 a[98:99], v29 offset:512
    s_add_u32 m0, s42, 50176
    v_mfma_f32_16x16x32_bf16 v[96:99], a[88:91], v[88:91], v[96:99]
    ds_read_b64_tr_b16 a[100:101], v30 offset:0
    buffer_load_dwordx4 v21, s[12:15], s54 offen lds
    v_mfma_f32_16x16x32_bf16 v[60:63], a[92:95], v[80:83], v[60:63]
    ds_read_b64_tr_b16 a[102:103], v30 offset:512
    s_add_u32 m0, s42, 57344
    v_mfma_f32_16x16x32_bf16 v[64:67], a[92:95], v[84:87], v[64:67]
    ds_read_b64_tr_b16 a[104:105], v31 offset:0
    buffer_load_dwordx4 v22, s[12:15], s54 offen lds
    v_mfma_f32_16x16x32_bf16 v[118:121], a[92:95], v[88:91], v[118:121]
    ds_read_b64_tr_b16 a[106:107], v31 offset:512
    v_mfma_f32_16x16x32_bf16 v[100:103], a[84:87], v[32:35], v[100:103]
    v_mfma_f32_16x16x32_bf16 v[104:107], a[88:91], v[32:35], v[104:107]
    v_mfma_f32_16x16x32_bf16 v[108:111], a[92:95], v[32:35], v[108:111]
    s_waitcnt lgkmcnt(0)
    v_mfma_f32_16x16x32_bf16 v[44:47], a[96:99], v[68:71], v[44:47]
    ds_read_b128 v[80:83], v5 offset:16384
    s_add_u32 m0, s42, 58368
    v_mfma_f32_16x16x32_bf16 v[48:51], a[96:99], v[72:75], v[48:51]
    ds_read_b128 v[84:87], v5 offset:18432
    buffer_load_dwordx4 v23, s[12:15], s54 offen lds
    v_mfma_f32_16x16x32_bf16 v[92:95], a[96:99], v[76:79], v[92:95]
    ds_read_b128 v[88:91], v5 offset:40960
    s_add_u32 m0, s42, 65536
    v_mfma_f32_16x16x32_bf16 v[52:55], a[100:103], v[68:71], v[52:55]
    ds_read_b64_tr_b16 a[108:109], v29 offset:4096
    buffer_load_dwordx4 v24, s[12:15], s54 offen lds
    v_mfma_f32_16x16x32_bf16 v[56:59], a[100:103], v[72:75], v[56:59]
    ds_read_b64_tr_b16 a[110:111], v29 offset:4608
    s_add_u32 m0, s42, 66560
    v_mfma_f32_16x16x32_bf16 v[96:99], a[100:103], v[76:79], v[96:99]
    ds_read_b64_tr_b16 a[112:113], v30 offset:4096
    buffer_load_dwordx4 v25, s[12:15], s54 offen lds
    v_mfma_f32_16x16x32_bf16 v[60:63], a[104:107], v[68:71], v[60:63]
    ds_read_b64_tr_b16 a[114:115], v30 offset:4608
    s_add_u32 s54, s54, 393216
    v_mfma_f32_16x16x32_bf16 v[64:67], a[104:107], v[72:75], v[64:67]
    ds_read_b64_tr_b16 a[116:117], v31 offset:4096
    v_mfma_f32_16x16x32_bf16 v[118:121], a[104:107], v[76:79], v[118:121]
    ds_read_b64_tr_b16 a[118:119], v31 offset:4608
    v_mfma_f32_16x16x32_bf16 v[100:103], a[96:99], v[32:35], v[100:103]
    v_mfma_f32_16x16x32_bf16 v[104:107], a[100:103], v[32:35], v[104:107]
    v_mfma_f32_16x16x32_bf16 v[108:111], a[104:107], v[32:35], v[108:111]
    v_lshl_add_u32 v38, v38, 6, v36
    v_add_u32 v38, 697644, v38
    v_lshlrev_b32 v11, 7, v38
    s_cmp_eq_u32 s32, 0
    s_cselect_b32 s37, 32, 0
    v_cmp_le_u32 vcc, s37, v0
    s_nop 1
    v_cndmask_b32 v11, v11, 2.0, vcc
    v_mov_b32 v116, 0
    v_mov_b32 v117, v11
    s_mov_b32 s45, -786432
    v_and_b32 v13, 15, v0
    v_add_u32 v29, 0, v26
    v_add_u32 v30, 0, v27
    v_add_u32 v31, 0, v28
    s_waitcnt vmcnt(15) lgkmcnt(0)
    s_barrier
    v_mfma_f32_16x16x32_bf16 v[44:47], a[108:111], v[80:83], v[44:47]
    ds_read_b128 v[68:71], v4 offset:20480
    s_add_u32 m0, s43, 146432
    v_mfma_f32_16x16x32_bf16 v[48:51], a[108:111], v[84:87], v[48:51]
    ds_read_b128 v[72:75], v4 offset:22528
    buffer_load_dwordx4 v6, s[8:11], s53 offen offset:1024 sc1 lds
    v_mfma_f32_16x16x32_bf16 v[92:95], a[108:111], v[88:91], v[92:95]
    ds_read_b128 v[76:79], v4 offset:43008
    s_add_u32 m0, s43, 97280
    v_mfma_f32_16x16x32_bf16 v[52:55], a[112:115], v[80:83], v[52:55]
    ds_read_b64_tr_b16 a[120:121], v29 offset:0
    buffer_load_dwordx4 v6, s[8:11], s41 offen offset:1024 sc1 lds
    v_mfma_f32_16x16x32_bf16 v[56:59], a[112:115], v[84:87], v[56:59]
    ds_read_b64_tr_b16 a[122:123], v29 offset:512
    s_add_u32 m0, s42, 73728
    v_mfma_f32_16x16x32_bf16 v[96:99], a[112:115], v[88:91], v[96:99]
    ds_read_b64_tr_b16 a[124:125], v30 offset:0
    buffer_load_dwordx4 v20, s[12:15], s54 offen lds
    v_mfma_f32_16x16x32_bf16 v[60:63], a[116:119], v[80:83], v[60:63]
    ds_read_b64_tr_b16 a[126:127], v30 offset:512
    s_add_u32 m0, s42, 74752
    v_mfma_f32_16x16x32_bf16 v[64:67], a[116:119], v[84:87], v[64:67]
    ds_read_b64_tr_b16 a[128:129], v31 offset:0
    buffer_load_dwordx4 v21, s[12:15], s54 offen lds
    v_mfma_f32_16x16x32_bf16 v[118:121], a[116:119], v[88:91], v[118:121]
    ds_read_b64_tr_b16 a[130:131], v31 offset:512
    v_mfma_f32_16x16x32_bf16 v[100:103], a[108:111], v[32:35], v[100:103]
    v_mfma_f32_16x16x32_bf16 v[104:107], a[112:115], v[32:35], v[104:107]
    v_mfma_f32_16x16x32_bf16 v[108:111], a[116:119], v[32:35], v[108:111]
    s_waitcnt lgkmcnt(0)
    v_mfma_f32_16x16x32_bf16 v[44:47], a[120:123], v[68:71], v[44:47]
    ds_read_b128 v[80:83], v5 offset:20480
    s_add_u32 m0, s42, 81920
    v_mfma_f32_16x16x32_bf16 v[48:51], a[120:123], v[72:75], v[48:51]
    ds_read_b128 v[84:87], v5 offset:22528
    buffer_load_dwordx4 v22, s[12:15], s54 offen lds
    v_mfma_f32_16x16x32_bf16 v[92:95], a[120:123], v[76:79], v[92:95]
    ds_read_b128 v[88:91], v5 offset:43008
    s_add_u32 m0, s42, 82944
    v_mfma_f32_16x16x32_bf16 v[52:55], a[124:127], v[68:71], v[52:55]
    ds_read_b64_tr_b16 a[132:133], v29 offset:4096
    buffer_load_dwordx4 v23, s[12:15], s54 offen lds
    v_mfma_f32_16x16x32_bf16 v[56:59], a[124:127], v[72:75], v[56:59]
    ds_read_b64_tr_b16 a[134:135], v29 offset:4608
    s_add_u32 m0, s42, 90112
    v_mfma_f32_16x16x32_bf16 v[96:99], a[124:127], v[76:79], v[96:99]
    ds_read_b64_tr_b16 a[136:137], v30 offset:4096
    buffer_load_dwordx4 v24, s[12:15], s54 offen lds
    v_mfma_f32_16x16x32_bf16 v[60:63], a[128:131], v[68:71], v[60:63]
    ds_read_b64_tr_b16 a[138:139], v30 offset:4608
    s_add_u32 m0, s42, 91136
    v_mfma_f32_16x16x32_bf16 v[64:67], a[128:131], v[72:75], v[64:67]
    ds_read_b64_tr_b16 a[140:141], v31 offset:4096
    buffer_load_dwordx4 v25, s[12:15], s54 offen lds
    v_mfma_f32_16x16x32_bf16 v[118:121], a[128:131], v[76:79], v[118:121]
    ds_read_b64_tr_b16 a[142:143], v31 offset:4608
    s_add_u32 s54, s54, 393216
    v_mfma_f32_16x16x32_bf16 v[100:103], a[120:123], v[32:35], v[100:103]
    v_mfma_f32_16x16x32_bf16 v[104:107], a[124:127], v[32:35], v[104:107]
    v_mfma_f32_16x16x32_bf16 v[108:111], a[128:131], v[32:35], v[108:111]
    v_lshlrev_b32 v13, 3, v13
    v_lshrrev_b32 v38, 5, v0
    v_lshl_add_u32 v13, v38, 9, v13
    v_and_b32 v38, 16, v0
    v_lshl_add_u32 v13, v38, 6, v13
    v_add_u32 v13, 90112, v13
    s_lshl_b32 s52, s51, 10
    s_or_b32 s96, s50, 31
    s_mov_b32 s55, 0x541fc00
    s_lshl_b32 s46, s50, 10
    s_sub_u32 s46, s55, s46
    v_add_u32 v29, 24576, v26
    v_add_u32 v30, 24576, v27
    v_add_u32 v31, 24576, v28
    s_waitcnt vmcnt(15) lgkmcnt(0)
    s_barrier
    v_mfma_f32_16x16x32_bf16 v[44:47], a[132:135], v[80:83], v[44:47]
    ds_read_b128 v[68:71], v4 offset:24576
    s_add_u32 m0, s43, 101248
    v_mfma_f32_16x16x32_bf16 v[48:51], a[132:135], v[84:87], v[48:51]
    ds_read_b128 v[72:75], v4 offset:26624
    buffer_load_dwordx4 v6, s[8:11], s41 offen offset:1152 sc1 lds
    v_mfma_f32_16x16x32_bf16 v[92:95], a[132:135], v[88:91], v[92:95]
    ds_read_b128 v[76:79], v4 offset:45056
    s_add_u32 m0, s42, 0
    v_mfma_f32_16x16x32_bf16 v[52:55], a[136:139], v[80:83], v[52:55]
    ds_read_b64_tr_b16 a[144:145], v29 offset:0
    buffer_load_dwordx4 v20, s[12:15], s54 offen lds
    v_mfma_f32_16x16x32_bf16 v[56:59], a[136:139], v[84:87], v[56:59]
    ds_read_b64_tr_b16 a[146:147], v29 offset:512
    s_add_u32 m0, s42, 1024
    v_mfma_f32_16x16x32_bf16 v[96:99], a[136:139], v[88:91], v[96:99]
    ds_read_b64_tr_b16 a[148:149], v30 offset:0
    buffer_load_dwordx4 v21, s[12:15], s54 offen lds
    v_mfma_f32_16x16x32_bf16 v[60:63], a[140:143], v[80:83], v[60:63]
    ds_read_b64_tr_b16 a[150:151], v30 offset:512
    s_add_u32 m0, s42, 8192
    v_mfma_f32_16x16x32_bf16 v[64:67], a[140:143], v[84:87], v[64:67]
    ds_read_b64_tr_b16 a[152:153], v31 offset:0
    buffer_load_dwordx4 v22, s[12:15], s54 offen lds
    v_mfma_f32_16x16x32_bf16 v[118:121], a[140:143], v[88:91], v[118:121]
    ds_read_b64_tr_b16 a[154:155], v31 offset:512
    v_mfma_f32_16x16x32_bf16 v[100:103], a[132:135], v[32:35], v[100:103]
    v_mfma_f32_16x16x32_bf16 v[104:107], a[136:139], v[32:35], v[104:107]
    v_mfma_f32_16x16x32_bf16 v[108:111], a[140:143], v[32:35], v[108:111]
    s_waitcnt lgkmcnt(0)
    v_mfma_f32_16x16x32_bf16 v[44:47], a[144:147], v[68:71], v[44:47]
    ds_read_b128 v[80:83], v5 offset:24576
    s_add_u32 m0, s42, 9216
    v_mfma_f32_16x16x32_bf16 v[48:51], a[144:147], v[72:75], v[48:51]
    ds_read_b128 v[84:87], v5 offset:26624
    buffer_load_dwordx4 v23, s[12:15], s54 offen lds
    v_mfma_f32_16x16x32_bf16 v[92:95], a[144:147], v[76:79], v[92:95]
    ds_read_b128 v[88:91], v5 offset:45056
    s_add_u32 m0, s42, 16384
    v_mfma_f32_16x16x32_bf16 v[52:55], a[148:151], v[68:71], v[52:55]
    ds_read_b64_tr_b16 a[156:157], v29 offset:4096
    buffer_load_dwordx4 v24, s[12:15], s54 offen lds
    v_mfma_f32_16x16x32_bf16 v[56:59], a[148:151], v[72:75], v[56:59]
    ds_read_b64_tr_b16 a[158:159], v29 offset:4608
    s_add_u32 m0, s42, 17408
    v_mfma_f32_16x16x32_bf16 v[96:99], a[148:151], v[76:79], v[96:99]
    ds_read_b64_tr_b16 a[160:161], v30 offset:4096
    buffer_load_dwordx4 v25, s[12:15], s54 offen lds
    v_mfma_f32_16x16x32_bf16 v[60:63], a[152:155], v[68:71], v[60:63]
    ds_read_b64_tr_b16 a[162:163], v30 offset:4608
    s_add_u32 s54, s54, 393216
    v_mfma_f32_16x16x32_bf16 v[64:67], a[152:155], v[72:75], v[64:67]
    ds_read_b64_tr_b16 a[164:165], v31 offset:4096
    v_mfma_f32_16x16x32_bf16 v[118:121], a[152:155], v[76:79], v[118:121]
    ds_read_b64_tr_b16 a[166:167], v31 offset:4608
    v_mfma_f32_16x16x32_bf16 v[100:103], a[144:147], v[32:35], v[100:103]
    v_mfma_f32_16x16x32_bf16 v[104:107], a[148:151], v[32:35], v[104:107]
    v_mfma_f32_16x16x32_bf16 v[108:111], a[152:155], v[32:35], v[108:111]
    s_mov_b32 s56, 0xaaaaaaaa
    s_mov_b32 s57, 0xaaaaaaaa
    s_mov_b32 s58, 0xfff0ffff
    s_mov_b32 s59, 0xf000ff00
    s_mov_b32 s60, 0xffc0fffc
    s_mov_b32 s61, 0xc000fc00
    s_mov_b32 s86, 0x3e8293ee
    v_mov_b32 v38, 0x0c0c0c0c
    v_mov_b32 v36, 0xc0c0100
    v_mov_b32 v37, 0x1000c0c
    v_cndmask_b32 v36, v36, v37, s[56:57]
    v_add_u32 v29, 49152, v26
    v_add_u32 v30, 49152, v27
    v_add_u32 v31, 49152, v28
    s_waitcnt vmcnt(15) lgkmcnt(0)
    s_barrier
    v_mfma_f32_16x16x32_bf16 v[44:47], a[156:159], v[80:83], v[44:47]
    ds_read_b128 v[68:71], v4 offset:28672
    s_add_u32 m0, s43, 150272
    v_mfma_f32_16x16x32_bf16 v[48:51], a[156:159], v[84:87], v[48:51]
    ds_read_b128 v[72:75], v4 offset:30720
    buffer_load_dwordx4 v6, s[8:11], s53 offen offset:1280 sc1 lds
    v_mfma_f32_16x16x32_bf16 v[92:95], a[156:159], v[88:91], v[92:95]
    ds_read_b128 v[76:79], v4 offset:47104
    s_add_u32 m0, s43, 105216
    v_mfma_f32_16x16x32_bf16 v[52:55], a[160:163], v[80:83], v[52:55]
    ds_read_b64_tr_b16 a[168:169], v29 offset:0
    buffer_load_dwordx4 v6, s[8:11], s41 offen offset:1280 sc1 lds
    v_mfma_f32_16x16x32_bf16 v[56:59], a[160:163], v[84:87], v[56:59]
    ds_read_b64_tr_b16 a[170:171], v29 offset:512
    s_add_u32 m0, s42, 24576
    v_mfma_f32_16x16x32_bf16 v[96:99], a[160:163], v[88:91], v[96:99]
    ds_read_b64_tr_b16 a[172:173], v30 offset:0
    buffer_load_dwordx4 v20, s[12:15], s54 offen lds
    v_mfma_f32_16x16x32_bf16 v[60:63], a[164:167], v[80:83], v[60:63]
    ds_read_b64_tr_b16 a[174:175], v30 offset:512
    s_add_u32 m0, s42, 25600
    v_mfma_f32_16x16x32_bf16 v[64:67], a[164:167], v[84:87], v[64:67]
    ds_read_b64_tr_b16 a[176:177], v31 offset:0
    buffer_load_dwordx4 v21, s[12:15], s54 offen lds
    v_mfma_f32_16x16x32_bf16 v[118:121], a[164:167], v[88:91], v[118:121]
    ds_read_b64_tr_b16 a[178:179], v31 offset:512
    v_mfma_f32_16x16x32_bf16 v[100:103], a[156:159], v[32:35], v[100:103]
    v_mfma_f32_16x16x32_bf16 v[104:107], a[160:163], v[32:35], v[104:107]
    v_mfma_f32_16x16x32_bf16 v[108:111], a[164:167], v[32:35], v[108:111]
    s_waitcnt lgkmcnt(0)
    v_mfma_f32_16x16x32_bf16 v[44:47], a[168:171], v[68:71], v[44:47]
    ds_read_b128 v[80:83], v5 offset:28672
    s_add_u32 m0, s42, 32768
    v_mfma_f32_16x16x32_bf16 v[48:51], a[168:171], v[72:75], v[48:51]
    ds_read_b128 v[84:87], v5 offset:30720
    buffer_load_dwordx4 v22, s[12:15], s54 offen lds
    v_mfma_f32_16x16x32_bf16 v[92:95], a[168:171], v[76:79], v[92:95]
    ds_read_b128 v[88:91], v5 offset:47104
    s_add_u32 m0, s42, 33792
    v_mfma_f32_16x16x32_bf16 v[52:55], a[172:175], v[68:71], v[52:55]
    ds_read_b64_tr_b16 a[180:181], v29 offset:4096
    buffer_load_dwordx4 v23, s[12:15], s54 offen lds
    v_mfma_f32_16x16x32_bf16 v[56:59], a[172:175], v[72:75], v[56:59]
    ds_read_b64_tr_b16 a[182:183], v29 offset:4608
    s_add_u32 m0, s42, 40960
    v_mfma_f32_16x16x32_bf16 v[96:99], a[172:175], v[76:79], v[96:99]
    ds_read_b64_tr_b16 a[184:185], v30 offset:4096
    buffer_load_dwordx4 v24, s[12:15], s54 offen lds
    v_mfma_f32_16x16x32_bf16 v[60:63], a[176:179], v[68:71], v[60:63]
    ds_read_b64_tr_b16 a[186:187], v30 offset:4608
    s_add_u32 m0, s42, 41984
    v_mfma_f32_16x16x32_bf16 v[64:67], a[176:179], v[72:75], v[64:67]
    ds_read_b64_tr_b16 a[188:189], v31 offset:4096
    buffer_load_dwordx4 v25, s[12:15], s54 offen lds
    v_mfma_f32_16x16x32_bf16 v[118:121], a[176:179], v[76:79], v[118:121]
    ds_read_b64_tr_b16 a[190:191], v31 offset:4608
    s_add_u32 s54, s54, 393216
    v_mfma_f32_16x16x32_bf16 v[100:103], a[168:171], v[32:35], v[100:103]
    v_mfma_f32_16x16x32_bf16 v[104:107], a[172:175], v[32:35], v[104:107]
    v_mfma_f32_16x16x32_bf16 v[108:111], a[176:179], v[32:35], v[108:111]
    v_cndmask_b32 v14, v36, v38, s[58:59]
    v_cndmask_b32 v16, v38, v36, s[58:59]
    v_mov_b32 v36, 0xc0c0302
    v_mov_b32 v37, 0x3020c0c
    v_cndmask_b32 v36, v36, v37, s[56:57]
    v_cndmask_b32 v15, v36, v38, s[60:61]
    v_cndmask_b32 v17, v38, v36, s[60:61]
    v_mov_b32 v18, 0xff800000
    s_mul_i32 s90, s33, 2097152
    s_add_u32 s90, s90, 0xffff0000
    s_lshl_b32 s37, s35, 1
    v_add_u32 v29, 73728, v26
    v_add_u32 v30, 73728, v27
    v_add_u32 v31, 73728, v28
    s_waitcnt vmcnt(15) lgkmcnt(0)
    s_barrier
    v_mfma_f32_16x16x32_bf16 v[44:47], a[180:183], v[80:83], v[44:47]
    ds_read_b128 v[68:71], v4 offset:0
    s_add_u32 m0, s43, 109184
    v_mfma_f32_16x16x32_bf16 v[48:51], a[180:183], v[84:87], v[48:51]
    ds_read_b128 v[72:75], v4 offset:2048
    buffer_load_dwordx4 v6, s[8:11], s41 offen offset:1408 sc1 lds
    v_mfma_f32_16x16x32_bf16 v[92:95], a[180:183], v[88:91], v[92:95]
    ds_read_b128 v[76:79], v4 offset:49152
    s_add_u32 m0, s42, 49152
    v_mfma_f32_16x16x32_bf16 v[52:55], a[184:187], v[80:83], v[52:55]
    ds_read_b64_tr_b16 a[192:193], v29 offset:0
    buffer_load_dwordx4 v20, s[12:15], s54 offen lds
    v_mfma_f32_16x16x32_bf16 v[56:59], a[184:187], v[84:87], v[56:59]
    ds_read_b64_tr_b16 a[194:195], v29 offset:512
    s_add_u32 m0, s42, 50176
    v_mfma_f32_16x16x32_bf16 v[96:99], a[184:187], v[88:91], v[96:99]
    ds_read_b64_tr_b16 a[196:197], v30 offset:0
    buffer_load_dwordx4 v21, s[12:15], s54 offen lds
    v_mfma_f32_16x16x32_bf16 v[60:63], a[188:191], v[80:83], v[60:63]
    ds_read_b64_tr_b16 a[198:199], v30 offset:512
    s_add_u32 m0, s42, 57344
    v_mfma_f32_16x16x32_bf16 v[64:67], a[188:191], v[84:87], v[64:67]
    ds_read_b64_tr_b16 a[200:201], v31 offset:0
    buffer_load_dwordx4 v22, s[12:15], s54 offen lds
    v_mfma_f32_16x16x32_bf16 v[118:121], a[188:191], v[88:91], v[118:121]
    ds_read_b64_tr_b16 a[202:203], v31 offset:512
    v_mfma_f32_16x16x32_bf16 v[100:103], a[180:183], v[32:35], v[100:103]
    v_mfma_f32_16x16x32_bf16 v[104:107], a[184:187], v[32:35], v[104:107]
    v_mfma_f32_16x16x32_bf16 v[108:111], a[188:191], v[32:35], v[108:111]
    s_waitcnt lgkmcnt(0)
    v_mfma_f32_16x16x32_bf16 v[44:47], a[192:195], v[68:71], v[44:47]
    ds_read_b128 v[80:83], v5 offset:0
    s_add_u32 m0, s42, 58368
    v_mfma_f32_16x16x32_bf16 v[48:51], a[192:195], v[72:75], v[48:51]
    ds_read_b128 v[84:87], v5 offset:2048
    buffer_load_dwordx4 v23, s[12:15], s54 offen lds
    v_mfma_f32_16x16x32_bf16 v[92:95], a[192:195], v[76:79], v[92:95]
    ds_read_b128 v[88:91], v5 offset:49152
    s_add_u32 m0, s42, 65536
    v_mfma_f32_16x16x32_bf16 v[52:55], a[196:199], v[68:71], v[52:55]
    ds_read_b64_tr_b16 a[204:205], v29 offset:4096
    buffer_load_dwordx4 v24, s[12:15], s54 offen lds
    v_mfma_f32_16x16x32_bf16 v[56:59], a[196:199], v[72:75], v[56:59]
    ds_read_b64_tr_b16 a[206:207], v29 offset:4608
    s_add_u32 m0, s42, 66560
    v_mfma_f32_16x16x32_bf16 v[96:99], a[196:199], v[76:79], v[96:99]
    ds_read_b64_tr_b16 a[208:209], v30 offset:4096
    buffer_load_dwordx4 v25, s[12:15], s54 offen lds
    v_mfma_f32_16x16x32_bf16 v[60:63], a[200:203], v[68:71], v[60:63]
    ds_read_b64_tr_b16 a[210:211], v30 offset:4608
    s_add_u32 s54, s54, 393216
    v_mfma_f32_16x16x32_bf16 v[64:67], a[200:203], v[72:75], v[64:67]
    ds_read_b64_tr_b16 a[212:213], v31 offset:4096
    v_mfma_f32_16x16x32_bf16 v[118:121], a[200:203], v[76:79], v[118:121]
    ds_read_b64_tr_b16 a[214:215], v31 offset:4608
    v_mfma_f32_16x16x32_bf16 v[100:103], a[192:195], v[32:35], v[100:103]
    v_mfma_f32_16x16x32_bf16 v[104:107], a[196:199], v[32:35], v[104:107]
    v_mfma_f32_16x16x32_bf16 v[108:111], a[200:203], v[32:35], v[108:111]
    s_add_u32 s37, s37, s51
    s_lshl_b32 s37, s37, 11
    s_add_u32 s90, s90, s37
    s_mul_i32 s37, s38, 1024
    s_add_u32 s90, s90, s37
    s_mov_b32 s87, -1024
    s_mov_b32 s24, 0xfffeffff
    s_mov_b32 s25, -1
    s_lshl_b32 s26, s38, 15
    s_mov_b32 s27, s38
    s_add_u32 s87, s87, 1024
    s_cmp_eq_u32 s33, 0
    s_cselect_b64 s[26:27], s[26:27], 0
    s_add_u32 s20, s82, 0x80
    s_addc_u32 s21, s83, 0
    s_mov_b32 s22, 0x4
    s_mov_b32 s23, 0x00020000
    v_lshl_add_u32 v36, s32, 4, v124
    v_add_u32 v29, 0, v26
    v_add_u32 v30, 0, v27
    v_add_u32 v31, 0, v28
    s_waitcnt vmcnt(15) lgkmcnt(0)
    s_barrier
    v_mfma_f32_16x16x32_bf16 v[44:47], a[204:207], v[80:83], v[44:47]
    ds_read_b128 v[68:71], v4 offset:4096
    s_add_u32 m0, s43, 154112
    v_mfma_f32_16x16x32_bf16 v[48:51], a[204:207], v[84:87], v[48:51]
    ds_read_b128 v[72:75], v4 offset:6144
    buffer_load_dwordx4 v6, s[8:11], s53 offen offset:1536 sc1 lds
    v_mfma_f32_16x16x32_bf16 v[92:95], a[204:207], v[88:91], v[92:95]
    ds_read_b128 v[76:79], v4 offset:51200
    s_add_u32 m0, s43, 113152
    v_mfma_f32_16x16x32_bf16 v[52:55], a[208:211], v[80:83], v[52:55]
    ds_read_b64_tr_b16 a[216:217], v29 offset:0
    buffer_load_dwordx4 v6, s[8:11], s41 offen offset:1536 sc1 lds
    v_mfma_f32_16x16x32_bf16 v[56:59], a[208:211], v[84:87], v[56:59]
    ds_read_b64_tr_b16 a[218:219], v29 offset:512
    s_add_u32 m0, s42, 73728
    v_mfma_f32_16x16x32_bf16 v[96:99], a[208:211], v[88:91], v[96:99]
    ds_read_b64_tr_b16 a[220:221], v30 offset:0
    buffer_load_dwordx4 v20, s[12:15], s54 offen lds
    v_mfma_f32_16x16x32_bf16 v[60:63], a[212:215], v[80:83], v[60:63]
    ds_read_b64_tr_b16 a[222:223], v30 offset:512
    s_add_u32 m0, s42, 74752
    v_mfma_f32_16x16x32_bf16 v[64:67], a[212:215], v[84:87], v[64:67]
    ds_read_b64_tr_b16 a[224:225], v31 offset:0
    buffer_load_dwordx4 v21, s[12:15], s54 offen lds
    v_mfma_f32_16x16x32_bf16 v[118:121], a[212:215], v[88:91], v[118:121]
    ds_read_b64_tr_b16 a[226:227], v31 offset:512
    v_mfma_f32_16x16x32_bf16 v[100:103], a[204:207], v[32:35], v[100:103]
    v_mfma_f32_16x16x32_bf16 v[104:107], a[208:211], v[32:35], v[104:107]
    v_mfma_f32_16x16x32_bf16 v[108:111], a[212:215], v[32:35], v[108:111]
    s_waitcnt lgkmcnt(0)
    v_mfma_f32_16x16x32_bf16 v[44:47], a[216:219], v[68:71], v[44:47]
    ds_read_b128 v[80:83], v5 offset:4096
    s_add_u32 m0, s42, 81920
    v_mfma_f32_16x16x32_bf16 v[48:51], a[216:219], v[72:75], v[48:51]
    ds_read_b128 v[84:87], v5 offset:6144
    buffer_load_dwordx4 v22, s[12:15], s54 offen lds
    v_mfma_f32_16x16x32_bf16 v[92:95], a[216:219], v[76:79], v[92:95]
    ds_read_b128 v[88:91], v5 offset:51200
    s_add_u32 m0, s42, 82944
    v_mfma_f32_16x16x32_bf16 v[52:55], a[220:223], v[68:71], v[52:55]
    ds_read_b64_tr_b16 a[228:229], v29 offset:4096
    buffer_load_dwordx4 v23, s[12:15], s54 offen lds
    v_mfma_f32_16x16x32_bf16 v[56:59], a[220:223], v[72:75], v[56:59]
    ds_read_b64_tr_b16 a[230:231], v29 offset:4608
    s_add_u32 m0, s42, 90112
    v_mfma_f32_16x16x32_bf16 v[96:99], a[220:223], v[76:79], v[96:99]
    ds_read_b64_tr_b16 a[232:233], v30 offset:4096
    buffer_load_dwordx4 v24, s[12:15], s54 offen lds
    v_mfma_f32_16x16x32_bf16 v[60:63], a[224:227], v[68:71], v[60:63]
    ds_read_b64_tr_b16 a[234:235], v30 offset:4608
    s_add_u32 m0, s42, 91136
    v_mfma_f32_16x16x32_bf16 v[64:67], a[224:227], v[72:75], v[64:67]
    ds_read_b64_tr_b16 a[236:237], v31 offset:4096
    buffer_load_dwordx4 v25, s[12:15], s54 offen lds
    v_mfma_f32_16x16x32_bf16 v[118:121], a[224:227], v[76:79], v[118:121]
    ds_read_b64_tr_b16 a[238:239], v31 offset:4608
    s_add_u32 s54, s54, 393216
    v_mfma_f32_16x16x32_bf16 v[100:103], a[216:219], v[32:35], v[100:103]
    v_mfma_f32_16x16x32_bf16 v[104:107], a[220:223], v[32:35], v[104:107]
    v_mfma_f32_16x16x32_bf16 v[108:111], a[224:227], v[32:35], v[108:111]
    v_add_u32 v29, 24576, v26
    v_add_u32 v30, 24576, v27
    v_add_u32 v31, 24576, v28
    s_waitcnt vmcnt(15) lgkmcnt(0)
    s_barrier
    v_mfma_f32_16x16x32_bf16 v[44:47], a[228:231], v[80:83], v[44:47]
    ds_read_b128 v[68:71], v4 offset:8192
    buffer_load_dword v37, v36, s[20:23], 0 offen sc1
    v_mfma_f32_16x16x32_bf16 v[48:51], a[228:231], v[84:87], v[48:51]
    ds_read_b128 v[72:75], v4 offset:10240
    s_add_u32 m0, s43, 117120
    v_mfma_f32_16x16x32_bf16 v[92:95], a[228:231], v[88:91], v[92:95]
    ds_read_b128 v[76:79], v4 offset:53248
    buffer_load_dwordx4 v6, s[8:11], s41 offen offset:1664 sc1 lds
    v_mfma_f32_16x16x32_bf16 v[52:55], a[232:235], v[80:83], v[52:55]
    ds_read_b64_tr_b16 a[240:241], v29 offset:0
    s_add_u32 m0, s42, 0
    v_mfma_f32_16x16x32_bf16 v[56:59], a[232:235], v[84:87], v[56:59]
    ds_read_b64_tr_b16 a[242:243], v29 offset:512
    buffer_load_dwordx4 v20, s[12:15], s54 offen lds
    v_mfma_f32_16x16x32_bf16 v[96:99], a[232:235], v[88:91], v[96:99]
    ds_read_b64_tr_b16 a[244:245], v30 offset:0
    s_add_u32 m0, s42, 1024
    v_mfma_f32_16x16x32_bf16 v[60:63], a[236:239], v[80:83], v[60:63]
    ds_read_b64_tr_b16 a[246:247], v30 offset:512
    buffer_load_dwordx4 v21, s[12:15], s54 offen lds
    v_mfma_f32_16x16x32_bf16 v[64:67], a[236:239], v[84:87], v[64:67]
    ds_read_b64_tr_b16 a[248:249], v31 offset:0
    s_add_u32 m0, s42, 8192
    v_mfma_f32_16x16x32_bf16 v[118:121], a[236:239], v[88:91], v[118:121]
    ds_read_b64_tr_b16 a[250:251], v31 offset:512
    v_mfma_f32_16x16x32_bf16 v[100:103], a[228:231], v[32:35], v[100:103]
    v_mfma_f32_16x16x32_bf16 v[104:107], a[232:235], v[32:35], v[104:107]
    v_mfma_f32_16x16x32_bf16 v[108:111], a[236:239], v[32:35], v[108:111]
    s_waitcnt lgkmcnt(0)
    v_mfma_f32_16x16x32_bf16 v[44:47], a[240:243], v[68:71], v[44:47]
    ds_read_b128 v[80:83], v5 offset:8192
    buffer_load_dwordx4 v22, s[12:15], s54 offen lds
    v_mfma_f32_16x16x32_bf16 v[48:51], a[240:243], v[72:75], v[48:51]
    ds_read_b128 v[84:87], v5 offset:10240
    s_add_u32 m0, s42, 9216
    v_mfma_f32_16x16x32_bf16 v[92:95], a[240:243], v[76:79], v[92:95]
    ds_read_b128 v[88:91], v5 offset:53248
    buffer_load_dwordx4 v23, s[12:15], s54 offen lds
    v_mfma_f32_16x16x32_bf16 v[52:55], a[244:247], v[68:71], v[52:55]
    ds_read_b64_tr_b16 a[252:253], v29 offset:4096
    s_add_u32 m0, s42, 16384
    v_mfma_f32_16x16x32_bf16 v[56:59], a[244:247], v[72:75], v[56:59]
    ds_read_b64_tr_b16 a[254:255], v29 offset:4608
    buffer_load_dwordx4 v24, s[12:15], s54 offen lds
    v_mfma_f32_16x16x32_bf16 v[96:99], a[244:247], v[76:79], v[96:99]
    ds_read_b64_tr_b16 v[128:129], v30 offset:4096
    s_add_u32 m0, s42, 17408
    v_mfma_f32_16x16x32_bf16 v[60:63], a[248:251], v[68:71], v[60:63]
    ds_read_b64_tr_b16 v[130:131], v30 offset:4608
    buffer_load_dwordx4 v25, s[12:15], s54 offen lds
    v_mfma_f32_16x16x32_bf16 v[64:67], a[248:251], v[72:75], v[64:67]
    ds_read_b64_tr_b16 v[132:133], v31 offset:4096
    s_add_u32 s54, s54, 393216
    v_mfma_f32_16x16x32_bf16 v[118:121], a[248:251], v[76:79], v[118:121]
    ds_read_b64_tr_b16 v[134:135], v31 offset:4608
    v_mfma_f32_16x16x32_bf16 v[100:103], a[240:243], v[32:35], v[100:103]
    v_mfma_f32_16x16x32_bf16 v[104:107], a[244:247], v[32:35], v[104:107]
    v_mfma_f32_16x16x32_bf16 v[108:111], a[248:251], v[32:35], v[108:111]
    v_add_u32 v29, 49152, v26
    v_add_u32 v30, 49152, v27
    v_add_u32 v31, 49152, v28
    s_waitcnt vmcnt(16) lgkmcnt(0)
    s_barrier
    v_mfma_f32_16x16x32_bf16 v[44:47], a[252:255], v[80:83], v[44:47]
    ds_read_b128 v[68:71], v4 offset:12288
    s_add_u32 m0, s43, 157952
    v_mfma_f32_16x16x32_bf16 v[48:51], a[252:255], v[84:87], v[48:51]
    ds_read_b128 v[72:75], v4 offset:14336
    buffer_load_dwordx4 v6, s[8:11], s53 offen offset:1792 sc1 lds
    v_mfma_f32_16x16x32_bf16 v[92:95], a[252:255], v[88:91], v[92:95]
    ds_read_b128 v[76:79], v4 offset:55296
    s_add_u32 m0, s43, 121088
    v_mfma_f32_16x16x32_bf16 v[52:55], v[128:131], v[80:83], v[52:55]
    ds_read_b64_tr_b16 v[136:137], v29 offset:0
    buffer_load_dwordx4 v6, s[8:11], s41 offen offset:1792 sc1 lds
    v_mfma_f32_16x16x32_bf16 v[56:59], v[128:131], v[84:87], v[56:59]
    ds_read_b64_tr_b16 v[138:139], v29 offset:512
    s_add_u32 m0, s42, 24576
    v_mfma_f32_16x16x32_bf16 v[96:99], v[128:131], v[88:91], v[96:99]
    ds_read_b64_tr_b16 v[140:141], v30 offset:0
    buffer_load_dwordx4 v20, s[12:15], s54 offen lds
    v_mfma_f32_16x16x32_bf16 v[60:63], v[132:135], v[80:83], v[60:63]
    ds_read_b64_tr_b16 v[142:143], v30 offset:512
    s_add_u32 m0, s42, 25600
    v_mfma_f32_16x16x32_bf16 v[64:67], v[132:135], v[84:87], v[64:67]
    ds_read_b64_tr_b16 v[144:145], v31 offset:0
    buffer_load_dwordx4 v21, s[12:15], s54 offen lds
    v_mfma_f32_16x16x32_bf16 v[118:121], v[132:135], v[88:91], v[118:121]
    ds_read_b64_tr_b16 v[146:147], v31 offset:512
    v_mfma_f32_16x16x32_bf16 v[100:103], a[252:255], v[32:35], v[100:103]
    v_mfma_f32_16x16x32_bf16 v[104:107], v[128:131], v[32:35], v[104:107]
    v_mfma_f32_16x16x32_bf16 v[108:111], v[132:135], v[32:35], v[108:111]
    s_waitcnt lgkmcnt(0)
    v_mfma_f32_16x16x32_bf16 v[44:47], v[136:139], v[68:71], v[44:47]
    ds_read_b128 v[80:83], v5 offset:12288
    s_add_u32 m0, s42, 32768
    v_mfma_f32_16x16x32_bf16 v[48:51], v[136:139], v[72:75], v[48:51]
    ds_read_b128 v[84:87], v5 offset:14336
    buffer_load_dwordx4 v22, s[12:15], s54 offen lds
    v_mfma_f32_16x16x32_bf16 v[92:95], v[136:139], v[76:79], v[92:95]
    ds_read_b128 v[88:91], v5 offset:55296
    s_add_u32 m0, s42, 33792
    v_mfma_f32_16x16x32_bf16 v[52:55], v[140:143], v[68:71], v[52:55]
    ds_read_b64_tr_b16 v[148:149], v29 offset:4096
    buffer_load_dwordx4 v23, s[12:15], s54 offen lds
    v_mfma_f32_16x16x32_bf16 v[56:59], v[140:143], v[72:75], v[56:59]
    ds_read_b64_tr_b16 v[150:151], v29 offset:4608
    s_add_u32 m0, s42, 40960
    v_mfma_f32_16x16x32_bf16 v[96:99], v[140:143], v[76:79], v[96:99]
    ds_read_b64_tr_b16 v[152:153], v30 offset:4096
    buffer_load_dwordx4 v24, s[12:15], s54 offen lds
    v_mfma_f32_16x16x32_bf16 v[60:63], v[144:147], v[68:71], v[60:63]
    ds_read_b64_tr_b16 v[154:155], v30 offset:4608
    s_add_u32 m0, s42, 41984
    v_mfma_f32_16x16x32_bf16 v[64:67], v[144:147], v[72:75], v[64:67]
    ds_read_b64_tr_b16 v[156:157], v31 offset:4096
    buffer_load_dwordx4 v25, s[12:15], s54 offen lds
    v_mfma_f32_16x16x32_bf16 v[118:121], v[144:147], v[76:79], v[118:121]
    ds_read_b64_tr_b16 v[158:159], v31 offset:4608
    s_add_u32 s54, s54, 393216
    v_mfma_f32_16x16x32_bf16 v[100:103], v[136:139], v[32:35], v[100:103]
    v_mfma_f32_16x16x32_bf16 v[104:107], v[140:143], v[32:35], v[104:107]
    v_mfma_f32_16x16x32_bf16 v[108:111], v[144:147], v[32:35], v[108:111]
    v_add_u32 v29, 73728, v26
    v_add_u32 v30, 73728, v27
    v_add_u32 v31, 73728, v28
    s_waitcnt vmcnt(16) lgkmcnt(0)
    s_barrier
    v_mfma_f32_16x16x32_bf16 v[44:47], v[148:151], v[80:83], v[44:47]
    ds_read_b128 v[68:71], v4 offset:16384
    s_add_u32 m0, s43, 125056
    v_mfma_f32_16x16x32_bf16 v[48:51], v[148:151], v[84:87], v[48:51]
    ds_read_b128 v[72:75], v4 offset:18432
    buffer_load_dwordx4 v6, s[8:11], s41 offen offset:1920 sc1 lds
    v_mfma_f32_16x16x32_bf16 v[92:95], v[148:151], v[88:91], v[92:95]
    ds_read_b128 v[76:79], v4 offset:57344
    s_add_u32 m0, s42, 49152
    v_mfma_f32_16x16x32_bf16 v[52:55], v[152:155], v[80:83], v[52:55]
    ds_read_b64_tr_b16 v[160:161], v29 offset:0
    buffer_load_dwordx4 v20, s[12:15], s54 offen lds
    v_mfma_f32_16x16x32_bf16 v[56:59], v[152:155], v[84:87], v[56:59]
    ds_read_b64_tr_b16 v[162:163], v29 offset:512
    s_add_u32 m0, s42, 50176
    v_mfma_f32_16x16x32_bf16 v[96:99], v[152:155], v[88:91], v[96:99]
    ds_read_b64_tr_b16 v[164:165], v30 offset:0
    buffer_load_dwordx4 v21, s[12:15], s54 offen lds
    v_mfma_f32_16x16x32_bf16 v[60:63], v[156:159], v[80:83], v[60:63]
    ds_read_b64_tr_b16 v[166:167], v30 offset:512
    s_add_u32 m0, s42, 57344
    v_mfma_f32_16x16x32_bf16 v[64:67], v[156:159], v[84:87], v[64:67]
    ds_read_b64_tr_b16 v[168:169], v31 offset:0
    buffer_load_dwordx4 v22, s[12:15], s54 offen lds
    v_mfma_f32_16x16x32_bf16 v[118:121], v[156:159], v[88:91], v[118:121]
    ds_read_b64_tr_b16 v[170:171], v31 offset:512
    v_mfma_f32_16x16x32_bf16 v[100:103], v[148:151], v[32:35], v[100:103]
    v_mfma_f32_16x16x32_bf16 v[104:107], v[152:155], v[32:35], v[104:107]
    v_mfma_f32_16x16x32_bf16 v[108:111], v[156:159], v[32:35], v[108:111]
    s_waitcnt lgkmcnt(0)
    v_mfma_f32_16x16x32_bf16 v[44:47], v[160:163], v[68:71], v[44:47]
    ds_read_b128 v[80:83], v5 offset:16384
    s_add_u32 m0, s42, 58368
    v_mfma_f32_16x16x32_bf16 v[48:51], v[160:163], v[72:75], v[48:51]
    ds_read_b128 v[84:87], v5 offset:18432
    buffer_load_dwordx4 v23, s[12:15], s54 offen lds
    v_mfma_f32_16x16x32_bf16 v[92:95], v[160:163], v[76:79], v[92:95]
    ds_read_b128 v[88:91], v5 offset:57344
    s_add_u32 m0, s42, 65536
    v_mfma_f32_16x16x32_bf16 v[52:55], v[164:167], v[68:71], v[52:55]
    ds_read_b64_tr_b16 v[172:173], v29 offset:4096
    buffer_load_dwordx4 v24, s[12:15], s54 offen lds
    v_mfma_f32_16x16x32_bf16 v[56:59], v[164:167], v[72:75], v[56:59]
    ds_read_b64_tr_b16 v[174:175], v29 offset:4608
    s_add_u32 m0, s42, 66560
    v_mfma_f32_16x16x32_bf16 v[96:99], v[164:167], v[76:79], v[96:99]
    ds_read_b64_tr_b16 v[176:177], v30 offset:4096
    buffer_load_dwordx4 v25, s[12:15], s54 offen lds
    v_mfma_f32_16x16x32_bf16 v[60:63], v[168:171], v[68:71], v[60:63]
    ds_read_b64_tr_b16 v[178:179], v30 offset:4608
    s_add_u32 s54, s54, 393216
    v_mfma_f32_16x16x32_bf16 v[64:67], v[168:171], v[72:75], v[64:67]
    ds_read_b64_tr_b16 v[180:181], v31 offset:4096
    v_mfma_f32_16x16x32_bf16 v[118:121], v[168:171], v[76:79], v[118:121]
    ds_read_b64_tr_b16 v[182:183], v31 offset:4608
    v_mfma_f32_16x16x32_bf16 v[100:103], v[160:163], v[32:35], v[100:103]
    v_mfma_f32_16x16x32_bf16 v[104:107], v[164:167], v[32:35], v[104:107]
    v_mfma_f32_16x16x32_bf16 v[108:111], v[168:171], v[32:35], v[108:111]
    v_add_u32 v29, 0, v26
    v_add_u32 v30, 0, v27
    v_add_u32 v31, 0, v28
    s_waitcnt vmcnt(15) lgkmcnt(0)
    v_cmp_eq_u32 vcc, v36, v37
    s_cbranch_vccnz L_spin1
L_back2:
    s_barrier
    v_mfma_f32_16x16x32_bf16 v[44:47], v[172:175], v[80:83], v[44:47]
    ds_read_b128 v[68:71], v4 offset:20480
    s_lshl_b32 s53, s33, 15
    v_mfma_f32_16x16x32_bf16 v[48:51], v[172:175], v[84:87], v[48:51]
    ds_read_b128 v[72:75], v4 offset:22528
    s_sub_u32 s53, 0x5418000, s53
    v_mfma_f32_16x16x32_bf16 v[92:95], v[172:175], v[88:91], v[92:95]
    ds_read_b128 v[76:79], v4 offset:59392
    s_add_u32 m0, s52, 94208
    v_mfma_f32_16x16x32_bf16 v[52:55], v[176:179], v[80:83], v[52:55]
    ds_read_b64_tr_b16 v[184:185], v29 offset:0
    buffer_load_dwordx4 v1, s[16:19], s53 offen sc1 lds
    v_mfma_f32_16x16x32_bf16 v[56:59], v[176:179], v[84:87], v[56:59]
    ds_read_b64_tr_b16 v[186:187], v29 offset:512
    s_add_u32 m0, s52, 92160
    v_mfma_f32_16x16x32_bf16 v[96:99], v[176:179], v[88:91], v[96:99]
    ds_read_b64_tr_b16 v[188:189], v30 offset:0
    buffer_load_dwordx4 v1, s[16:19], s46 offen sc1 lds
    v_mfma_f32_16x16x32_bf16 v[60:63], v[180:183], v[80:83], v[60:63]
    ds_read_b64_tr_b16 v[190:191], v30 offset:512
    s_cmp_eq_u32 s36, s97
    s_cselect_b32 s47, 32, -2
    s_cselect_b64 s[8:9], s[88:89], s[8:9]
    s_cselect_b32 s55, 0x543fc00, s55
    v_mfma_f32_16x16x32_bf16 v[64:67], v[180:183], v[84:87], v[64:67]
    ds_read_b64_tr_b16 v[192:193], v31 offset:0
    s_add_u32 s50, s50, s47
    v_mfma_f32_16x16x32_bf16 v[118:121], v[180:183], v[88:91], v[118:121]
    ds_read_b64_tr_b16 v[194:195], v31 offset:512
    s_max_i32 s47, s50, 0
    v_mfma_f32_16x16x32_bf16 v[100:103], v[172:175], v[32:35], v[100:103]
    s_min_i32 s47, s47, s96
    v_mfma_f32_16x16x32_bf16 v[104:107], v[176:179], v[32:35], v[104:107]
    v_mfma_f32_16x16x32_bf16 v[108:111], v[180:183], v[32:35], v[108:111]
    s_waitcnt lgkmcnt(0)
    v_mfma_f32_16x16x32_bf16 v[44:47], v[184:187], v[68:71], v[44:47]
    ds_read_b128 v[80:83], v5 offset:20480
    s_lshl_b32 s41, s47, 15
    v_mfma_f32_16x16x32_bf16 v[48:51], v[184:187], v[72:75], v[48:51]
    ds_read_b128 v[84:87], v5 offset:22528
    s_lshl_b32 s46, s47, 10
    v_mfma_f32_16x16x32_bf16 v[92:95], v[184:187], v[76:79], v[92:95]
    ds_read_b128 v[88:91], v5 offset:59392
    s_sub_u32 s46, s55, s46
    v_mfma_f32_16x16x32_bf16 v[52:55], v[188:191], v[68:71], v[52:55]
    ds_read_b64_tr_b16 v[196:197], v29 offset:4096
    s_add_u32 m0, s52, 90112
    v_mfma_f32_16x16x32_bf16 v[56:59], v[188:191], v[72:75], v[56:59]
    ds_read_b64_tr_b16 v[198:199], v29 offset:4608
    buffer_load_dwordx4 v1, s[16:19], s46 offen sc1 lds
    v_mfma_f32_16x16x32_bf16 v[96:99], v[188:191], v[76:79], v[96:99]
    ds_read_b64_tr_b16 v[200:201], v30 offset:4096
    buffer_store_dword v124, v124, s[16:19], s91 offen sc1
    v_mfma_f32_16x16x32_bf16 v[60:63], v[192:195], v[68:71], v[60:63]
    ds_read_b64_tr_b16 v[202:203], v30 offset:4608
    s_add_u32 s91, s91, 65536
    v_mfma_f32_16x16x32_bf16 v[64:67], v[192:195], v[72:75], v[64:67]
    ds_read_b64_tr_b16 v[204:205], v31 offset:4096
    s_add_u32 s91, s91, 65536
    v_mfma_f32_16x16x32_bf16 v[118:121], v[192:195], v[76:79], v[118:121]
    ds_read_b64_tr_b16 v[206:207], v31 offset:4608
    v_mfma_f32_16x16x32_bf16 v[100:103], v[184:187], v[32:35], v[100:103]
    v_mfma_f32_16x16x32_bf16 v[104:107], v[188:191], v[32:35], v[104:107]
    v_mfma_f32_16x16x32_bf16 v[108:111], v[192:195], v[32:35], v[108:111]
    v_add_u32 v29, 24576, v26
    v_add_u32 v30, 24576, v27
    v_add_u32 v31, 24576, v28
    s_waitcnt vmcnt(11) lgkmcnt(0)
    s_barrier
    v_mfma_f32_16x16x32_bf16 v[44:47], v[196:199], v[80:83], v[44:47]
    ds_read_b128 v[68:71], v4 offset:24576
    s_add_u32 m0, s43, 0
    v_mfma_f32_16x16x32_bf16 v[48:51], v[196:199], v[84:87], v[48:51]
    ds_read_b128 v[72:75], v4 offset:26624
    buffer_load_dwordx4 v6, s[8:11], s41 offen offset:0 sc1 lds
    v_mfma_f32_16x16x32_bf16 v[92:95], v[196:199], v[88:91], v[92:95]
    ds_read_b128 v[76:79], v4 offset:61440
    s_add_u32 m0, s43, 3968
    v_mfma_f32_16x16x32_bf16 v[52:55], v[200:203], v[80:83], v[52:55]
    ds_read_b64_tr_b16 v[208:209], v29 offset:0
    buffer_load_dwordx4 v6, s[8:11], s41 offen offset:128 sc1 lds
    v_mfma_f32_16x16x32_bf16 v[56:59], v[200:203], v[84:87], v[56:59]
    ds_read_b64_tr_b16 v[210:211], v29 offset:512
    s_add_u32 m0, s43, 7936
    v_mfma_f32_16x16x32_bf16 v[96:99], v[200:203], v[88:91], v[96:99]
    ds_read_b64_tr_b16 v[212:213], v30 offset:0
    buffer_load_dwordx4 v6, s[8:11], s41 offen offset:256 sc1 lds
    v_mfma_f32_16x16x32_bf16 v[60:63], v[204:207], v[80:83], v[60:63]
    ds_read_b64_tr_b16 v[214:215], v30 offset:512
    v_mfma_f32_16x16x32_bf16 v[64:67], v[204:207], v[84:87], v[64:67]
    ds_read_b64_tr_b16 v[216:217], v31 offset:0
    v_mfma_f32_16x16x32_bf16 v[118:121], v[204:207], v[88:91], v[118:121]
    ds_read_b64_tr_b16 v[218:219], v31 offset:512
    v_mfma_f32_16x16x32_bf16 v[100:103], v[196:199], v[32:35], v[100:103]
    v_mfma_f32_16x16x32_bf16 v[104:107], v[200:203], v[32:35], v[104:107]
    v_mfma_f32_16x16x32_bf16 v[108:111], v[204:207], v[32:35], v[108:111]
    s_waitcnt lgkmcnt(0)
    v_mfma_f32_16x16x32_bf16 v[44:47], v[208:211], v[68:71], v[44:47]
    ds_read_b128 v[80:83], v5 offset:24576
    s_add_u32 m0, s43, 11904
    v_mfma_f32_16x16x32_bf16 v[48:51], v[208:211], v[72:75], v[48:51]
    ds_read_b128 v[84:87], v5 offset:26624
    buffer_load_dwordx4 v6, s[8:11], s41 offen offset:384 sc1 lds
    v_mfma_f32_16x16x32_bf16 v[92:95], v[208:211], v[76:79], v[92:95]
    ds_read_b128 v[88:91], v5 offset:61440
    s_add_u32 m0, s43, 15872
    v_mfma_f32_16x16x32_bf16 v[52:55], v[212:215], v[68:71], v[52:55]
    ds_read_b64_tr_b16 v[220:221], v29 offset:4096
    buffer_load_dwordx4 v6, s[8:11], s41 offen offset:512 sc1 lds
    v_mfma_f32_16x16x32_bf16 v[56:59], v[212:215], v[72:75], v[56:59]
    ds_read_b64_tr_b16 v[222:223], v29 offset:4608
    s_add_u32 m0, s43, 19840
    v_mfma_f32_16x16x32_bf16 v[96:99], v[212:215], v[76:79], v[96:99]
    ds_read_b64_tr_b16 v[224:225], v30 offset:4096
    buffer_load_dwordx4 v6, s[8:11], s41 offen offset:640 sc1 lds
    v_mfma_f32_16x16x32_bf16 v[60:63], v[216:219], v[68:71], v[60:63]
    ds_read_b64_tr_b16 v[226:227], v30 offset:4608
    v_mfma_f32_16x16x32_bf16 v[64:67], v[216:219], v[72:75], v[64:67]
    ds_read_b64_tr_b16 v[228:229], v31 offset:4096
    v_mfma_f32_16x16x32_bf16 v[118:121], v[216:219], v[76:79], v[118:121]
    ds_read_b64_tr_b16 v[230:231], v31 offset:4608
    v_mfma_f32_16x16x32_bf16 v[100:103], v[208:211], v[32:35], v[100:103]
    v_mfma_f32_16x16x32_bf16 v[104:107], v[212:215], v[32:35], v[104:107]
    v_mfma_f32_16x16x32_bf16 v[108:111], v[216:219], v[32:35], v[108:111]
    v_add_u32 v29, 49152, v26
    v_add_u32 v30, 49152, v27
    v_add_u32 v31, 49152, v28
    s_waitcnt vmcnt(10) lgkmcnt(0)
    s_barrier
    v_mfma_f32_16x16x32_bf16 v[44:47], v[220:223], v[80:83], v[44:47]
    ds_read_b128 v[68:71], v4 offset:28672
    s_add_u32 m0, s43, 23808
    v_mfma_f32_16x16x32_bf16 v[48:51], v[220:223], v[84:87], v[48:51]
    ds_read_b128 v[72:75], v4 offset:30720
    buffer_load_dwordx4 v6, s[8:11], s41 offen offset:768 sc1 lds
    v_mfma_f32_16x16x32_bf16 v[92:95], v[220:223], v[88:91], v[92:95]
    ds_read_b128 v[76:79], v4 offset:63488
    s_add_u32 m0, s43, 27776
    v_mfma_f32_16x16x32_bf16 v[52:55], v[224:227], v[80:83], v[52:55]
    ds_read_b64_tr_b16 v[232:233], v29 offset:0
    buffer_load_dwordx4 v6, s[8:11], s41 offen offset:896 sc1 lds
    v_mfma_f32_16x16x32_bf16 v[56:59], v[224:227], v[84:87], v[56:59]
    ds_read_b64_tr_b16 v[234:235], v29 offset:512
    s_add_u32 m0, s43, 31744
    v_mfma_f32_16x16x32_bf16 v[96:99], v[224:227], v[88:91], v[96:99]
    ds_read_b64_tr_b16 v[236:237], v30 offset:0
    buffer_load_dwordx4 v6, s[8:11], s41 offen offset:1024 sc1 lds
    v_mfma_f32_16x16x32_bf16 v[60:63], v[228:231], v[80:83], v[60:63]
    ds_read_b64_tr_b16 v[238:239], v30 offset:512
    v_mfma_f32_16x16x32_bf16 v[64:67], v[228:231], v[84:87], v[64:67]
    ds_read_b64_tr_b16 v[240:241], v31 offset:0
    v_mfma_f32_16x16x32_bf16 v[118:121], v[228:231], v[88:91], v[118:121]
    ds_read_b64_tr_b16 v[242:243], v31 offset:512
    v_mfma_f32_16x16x32_bf16 v[100:103], v[220:223], v[32:35], v[100:103]
    v_mfma_f32_16x16x32_bf16 v[104:107], v[224:227], v[32:35], v[104:107]
    v_mfma_f32_16x16x32_bf16 v[108:111], v[228:231], v[32:35], v[108:111]
    s_waitcnt lgkmcnt(0)
    v_mfma_f32_16x16x32_bf16 v[44:47], v[232:235], v[68:71], v[44:47]
    ds_read_b128 v[80:83], v5 offset:28672
    s_add_u32 m0, s43, 35712
    v_mfma_f32_16x16x32_bf16 v[48:51], v[232:235], v[72:75], v[48:51]
    ds_read_b128 v[84:87], v5 offset:30720
    buffer_load_dwordx4 v6, s[8:11], s41 offen offset:1152 sc1 lds
    v_mfma_f32_16x16x32_bf16 v[92:95], v[232:235], v[76:79], v[92:95]
    ds_read_b128 v[88:91], v5 offset:63488
    s_add_u32 m0, s43, 39680
    v_mfma_f32_16x16x32_bf16 v[52:55], v[236:239], v[68:71], v[52:55]
    ds_read_b64_tr_b16 v[244:245], v29 offset:4096
    buffer_load_dwordx4 v6, s[8:11], s41 offen offset:1280 sc1 lds
    v_mfma_f32_16x16x32_bf16 v[56:59], v[236:239], v[72:75], v[56:59]
    ds_read_b64_tr_b16 v[246:247], v29 offset:4608
    s_add_u32 m0, s43, 43648
    v_mfma_f32_16x16x32_bf16 v[96:99], v[236:239], v[76:79], v[96:99]
    ds_read_b64_tr_b16 v[248:249], v30 offset:4096
    buffer_load_dwordx4 v6, s[8:11], s41 offen offset:1408 sc1 lds
    v_mfma_f32_16x16x32_bf16 v[60:63], v[240:243], v[68:71], v[60:63]
    ds_read_b64_tr_b16 v[250:251], v30 offset:4608
    v_mfma_f32_16x16x32_bf16 v[64:67], v[240:243], v[72:75], v[64:67]
    ds_read_b64_tr_b16 v[252:253], v31 offset:4096
    v_mfma_f32_16x16x32_bf16 v[118:121], v[240:243], v[76:79], v[118:121]
    ds_read_b64_tr_b16 v[254:255], v31 offset:4608
    v_mfma_f32_16x16x32_bf16 v[100:103], v[232:235], v[32:35], v[100:103]
    v_mfma_f32_16x16x32_bf16 v[104:107], v[236:239], v[32:35], v[104:107]
    v_mfma_f32_16x16x32_bf16 v[108:111], v[240:243], v[32:35], v[108:111]
    s_waitcnt vmcnt(13) lgkmcnt(0)
    s_barrier
    v_mfma_f32_16x16x32_bf16 v[44:47], v[244:247], v[80:83], v[44:47]
    s_add_u32 m0, s43, 47616
    v_mfma_f32_16x16x32_bf16 v[48:51], v[244:247], v[84:87], v[48:51]
    buffer_load_dwordx4 v6, s[8:11], s41 offen offset:1536 sc1 lds
    v_mfma_f32_16x16x32_bf16 v[92:95], v[244:247], v[88:91], v[92:95]
    s_add_u32 m0, s43, 51584
    v_mfma_f32_16x16x32_bf16 v[52:55], v[248:251], v[80:83], v[52:55]
    buffer_load_dwordx4 v6, s[8:11], s41 offen offset:1664 sc1 lds
    v_mfma_f32_16x16x32_bf16 v[56:59], v[248:251], v[84:87], v[56:59]
    s_add_u32 m0, s43, 55552
    v_mfma_f32_16x16x32_bf16 v[96:99], v[248:251], v[88:91], v[96:99]
    buffer_load_dwordx4 v6, s[8:11], s41 offen offset:1792 sc1 lds
    v_mfma_f32_16x16x32_bf16 v[60:63], v[252:255], v[80:83], v[60:63]
    s_add_u32 m0, s43, 59520
    v_mfma_f32_16x16x32_bf16 v[64:67], v[252:255], v[84:87], v[64:67]
    buffer_load_dwordx4 v6, s[8:11], s41 offen offset:1920 sc1 lds
    v_mfma_f32_16x16x32_bf16 v[118:121], v[252:255], v[88:91], v[118:121]
    v_mfma_f32_16x16x32_bf16 v[100:103], v[244:247], v[32:35], v[100:103]
    v_mfma_f32_16x16x32_bf16 v[104:107], v[248:251], v[32:35], v[104:107]
    v_mfma_f32_16x16x32_bf16 v[108:111], v[252:255], v[32:35], v[108:111]
    s_mov_b32 s36, 0
    ds_read_b64 v[20:21], v13 offset:2048
    ds_read_b64 v[22:23], v13 offset:2176
    ds_read_b64 v[24:25], v13 offset:2304
    ds_read_b64 v[26:27], v13 offset:2432
    ds_read_b64 v[30:31], v13 offset:4096
    ds_read_b64 v[32:33], v13 offset:4224
    ds_read_b64 v[34:35], v13 offset:4352
    ds_read_b64 v[36:37], v13 offset:4480
    s_waitcnt lgkmcnt(0)
    v_add_f32 v38, v34, v36
    v_add_f32 v39, v35, v37
    v_add_f32 v30, v30, v32
    v_add_f32 v31, v31, v33
    v_add_f32 v30, v30, v38
    v_add_f32 v31, v31, v39
    v_mov_b32 v38, v30
    v_mov_b32 v39, v31
    s_nop 0
    v_permlane32_swap_b32 v30, v38
    v_permlane32_swap_b32 v31, v39
    v_add_f32 v30, v30, v38
    v_add_f32 v31, v31, v39
    v_mul_f32 v112, 0xba800000, v30
    v_mul_f32 v31, 0x3a800000, v31
    v_fma_f32 v31, -v112, v112, v31
    v_mov_b32 v113, v112
    v_max_f32 v31, 0, v31
    v_add_f32 v31, 0x3727c5ac, v31
    v_rsq_f32 v114, v31
    v_permlane16_swap_b32 v112, v113
    v_mov_b32 v115, v114
    s_nop 1
    v_permlane16_swap_b32 v114, v115
    v_fmac_f32 v92, v112, v100
    v_fmac_f32 v93, v112, v101
    v_fmac_f32 v94, v112, v102
    v_fmac_f32 v95, v112, v103
    v_mul_f32 v92, v92, v114
    v_mul_f32 v93, v93, v114
    v_mul_f32 v94, v94, v114
    v_mul_f32 v95, v95, v114
    v_cvt_pk_bf16_f32 v92, v92, v93
    v_cvt_pk_bf16_f32 v93, v94, v95
    ds_write_b64 v7, v[92:93] offset:6144
    v_fmac_f32 v96, v112, v104
    v_fmac_f32 v97, v112, v105
    v_fmac_f32 v98, v112, v106
    v_fmac_f32 v99, v112, v107
    v_mul_f32 v96, v96, v114
    v_mul_f32 v97, v97, v114
    v_mul_f32 v98, v98, v114
    v_mul_f32 v99, v99, v114
    v_cvt_pk_bf16_f32 v96, v96, v97
    v_cvt_pk_bf16_f32 v97, v98, v99
    ds_write_b64 v7, v[96:97] offset:7168
    v_fmac_f32 v118, v112, v108
    v_fmac_f32 v119, v112, v109
    v_fmac_f32 v120, v112, v110
    v_fmac_f32 v121, v112, v111
    v_mul_f32 v118, v118, v114
    v_mul_f32 v119, v119, v114
    v_mul_f32 v120, v120, v114
    v_mul_f32 v121, v121, v114
    v_cvt_pk_bf16_f32 v118, v118, v119
    v_cvt_pk_bf16_f32 v119, v120, v121
    ds_write_b64 v8, v[118:119] offset:8192
    s_waitcnt lgkmcnt(3)
    v_add_f32 v28, v24, v26
    v_add_f32 v29, v25, v27
    v_add_f32 v20, v20, v22
    v_add_f32 v21, v21, v23
    v_add_f32 v20, v20, v28
    v_add_f32 v21, v21, v29
    v_mov_b32 v28, v20
    v_mov_b32 v29, v21
    s_nop 0
    v_permlane32_swap_b32 v20, v28
    v_permlane32_swap_b32 v21, v29
    v_add_f32 v20, v20, v28
    v_add_f32 v21, v21, v29
    v_mul_f32 v112, 0xba800000, v20
    v_mul_f32 v21, 0x3a800000, v21
    v_fma_f32 v21, -v112, v112, v21
    v_mov_b32 v113, v112
    v_max_f32 v21, 0, v21
    v_add_f32 v21, 0x3727c5ac, v21
    v_rsq_f32 v114, v21
    v_permlane16_swap_b32 v112, v113
    v_mov_b32 v115, v114
    s_nop 1
    v_permlane16_swap_b32 v114, v115
    s_cmp_eq_u32 s36, s97
    s_cselect_b32 s47, 32, -2
    s_cselect_b64 s[8:9], s[88:89], s[8:9]
    s_cselect_b32 s55, 0x543fc00, s55
    s_add_u32 s50, s50, s47
    s_max_i32 s47, s50, 0
    s_min_i32 s47, s47, s96
    s_lshl_b32 s41, s47, 15
    s_lshl_b32 s46, s47, 10
    s_sub_u32 s46, s55, s46
    s_cmp_eq_u32 s36, 17
    s_cselect_b32 s49, s87, 0x10000
    s_add_u32 s90, s90, s49
    s_and_b32 s49, s90, 0xffffffff
    s_bitcmp1_b64 s[24:25], s36
    s_cselect_b32 s44, s49, 0x5e00000
    s_bitcmp1_b64 s[26:27], s36
    s_cselect_b64 s[62:63], 0, -1
    v_fmac_f32 v44, v112, v100
    v_fmac_f32 v45, v112, v101
    v_fmac_f32 v46, v112, v102
    v_fmac_f32 v47, v112, v103
    v_fmac_f32 v48, v113, v100
    v_fmac_f32 v49, v113, v101
    v_fmac_f32 v50, v113, v102
    v_fmac_f32 v51, v113, v103
    v_fmac_f32 v52, v112, v104
    v_fmac_f32 v53, v112, v105
    v_fmac_f32 v54, v112, v106
    v_fmac_f32 v55, v112, v107
    v_fmac_f32 v56, v113, v104
    v_fmac_f32 v57, v113, v105
    v_fmac_f32 v58, v113, v106
    v_fmac_f32 v59, v113, v107
    v_fmac_f32 v60, v112, v108
    v_fmac_f32 v61, v112, v109
    v_fmac_f32 v62, v112, v110
    v_fmac_f32 v63, v112, v111
    v_fmac_f32 v64, v113, v108
    v_fmac_f32 v65, v113, v109
    v_fmac_f32 v66, v113, v110
    v_fmac_f32 v67, v113, v111
    s_waitcnt vmcnt(0) lgkmcnt(0)
    s_barrier
    ds_read_b128 v[68:71], v2 offset:0
    ds_read_b128 v[72:75], v2 offset:2048
    ds_read_b128 v[76:79], v3 offset:0
    ds_read_b128 v[80:83], v3 offset:2048
    s_mov_b32 s36, 1
    s_waitcnt lgkmcnt(0)
    s_nop 7
L_q_b0:
    v_mfma_f32_16x16x32_bf16 v[20:23], a[0:3], v[68:71], 0
    ds_read_b128 v[84:87], v2 offset:4096
    v_mul_f32 v44, v44, v114
    v_mfma_f32_16x16x32_bf16 v[24:27], a[0:3], v[72:75], 0
    v_mul_f32 v45, v45, v114
    v_mul_f32 v46, v46, v114
    v_mfma_f32_16x16x32_bf16 v[32:35], a[4:7], v[72:75], 0
    v_mul_f32 v47, v47, v114
    v_cvt_pk_bf16_f32 v44, v44, v45
    v_mfma_f32_16x16x32_bf16 v[28:31], a[4:7], v[68:71], 0
    ds_read_b128 v[88:91], v2 offset:6144
    v_cvt_pk_bf16_f32 v45, v46, v47
    v_mfma_f32_16x16x32_bf16 v[36:39], a[8:11], v[68:71], 0
    ds_write_b64 v7, v[44:45] offset:12288
    v_mfma_f32_16x16x32_bf16 v[40:43], a[8:11], v[72:75], 0
    s_waitcnt lgkmcnt(3)
    v_mul_f32 v48, v48, v115
    v_mul_f32 v49, v49, v115
    v_mfma_f32_16x16x32_bf16 v[20:23], a[12:15], v[76:79], v[20:23]
    ds_read_b128 v[92:95], v3 offset:4096
    v_mul_f32 v50, v50, v115
    v_mfma_f32_16x16x32_bf16 v[24:27], a[12:15], v[80:83], v[24:27]
    v_mul_f32 v51, v51, v115
    v_cvt_pk_bf16_f32 v48, v48, v49
    v_mfma_f32_16x16x32_bf16 v[32:35], a[16:19], v[80:83], v[32:35]
    v_cvt_pk_bf16_f32 v49, v50, v51
    v_mfma_f32_16x16x32_bf16 v[28:31], a[16:19], v[76:79], v[28:31]
    ds_read_b128 v[96:99], v3 offset:6144
    v_mfma_f32_16x16x32_bf16 v[36:39], a[20:23], v[76:79], v[36:39]
    ds_write_b64 v7, v[48:49] offset:18432
    v_mfma_f32_16x16x32_bf16 v[40:43], a[20:23], v[80:83], v[40:43]
    s_waitcnt lgkmcnt(4)
    v_mul_f32 v52, v52, v114
    v_mul_f32 v53, v53, v114
    v_mfma_f32_16x16x32_bf16 v[20:23], a[24:27], v[84:87], v[20:23]
    ds_read_b128 v[68:71], v2 offset:8192
    v_mul_f32 v54, v54, v114
    v_mfma_f32_16x16x32_bf16 v[24:27], a[24:27], v[88:91], v[24:27]
    v_mul_f32 v55, v55, v114
    v_cvt_pk_bf16_f32 v52, v52, v53
    v_mfma_f32_16x16x32_bf16 v[32:35], a[28:31], v[88:91], v[32:35]
    v_cvt_pk_bf16_f32 v53, v54, v55
    v_mfma_f32_16x16x32_bf16 v[28:31], a[28:31], v[84:87], v[28:31]
    ds_read_b128 v[72:75], v2 offset:10240
    v_mfma_f32_16x16x32_bf16 v[36:39], a[32:35], v[84:87], v[36:39]
    ds_write_b64 v7, v[52:53] offset:13312
    v_mfma_f32_16x16x32_bf16 v[40:43], a[32:35], v[88:91], v[40:43]
    s_waitcnt lgkmcnt(4)
    v_mul_f32 v56, v56, v115
    v_mul_f32 v57, v57, v115
    v_mfma_f32_16x16x32_bf16 v[20:23], a[36:39], v[92:95], v[20:23]
    ds_read_b128 v[76:79], v3 offset:8192
    v_mul_f32 v58, v58, v115
    v_mfma_f32_16x16x32_bf16 v[24:27], a[36:39], v[96:99], v[24:27]
    v_mul_f32 v59, v59, v115
    v_cvt_pk_bf16_f32 v56, v56, v57
    v_mfma_f32_16x16x32_bf16 v[32:35], a[40:43], v[96:99], v[32:35]
    v_cvt_pk_bf16_f32 v57, v58, v59
    v_mfma_f32_16x16x32_bf16 v[28:31], a[40:43], v[92:95], v[28:31]
    ds_read_b128 v[80:83], v3 offset:10240
    v_mfma_f32_16x16x32_bf16 v[36:39], a[44:47], v[92:95], v[36:39]
    ds_write_b64 v7, v[56:57] offset:19456
    v_mfma_f32_16x16x32_bf16 v[40:43], a[44:47], v[96:99], v[40:43]
    s_waitcnt lgkmcnt(4)
    v_mul_f32 v60, v60, v114
    v_mul_f32 v61, v61, v114
    v_mfma_f32_16x16x32_bf16 v[20:23], a[48:51], v[68:71], v[20:23]
    s_waitcnt vmcnt(1)
    ds_read_b128 v[84:87], v2 offset:12288
    v_cmp_ne_u32 vcc, 0, v116
    v_mfma_f32_16x16x32_bf16 v[24:27], a[48:51], v[72:75], v[24:27]
    v_mul_f32 v62, v62, v114
    v_mul_f32 v63, v63, v114
    v_mfma_f32_16x16x32_bf16 v[32:35], a[52:55], v[72:75], v[32:35]
    s_cbranch_vccnz L_spin3
L_back4:
    v_cvt_pk_bf16_f32 v60, v60, v61
    v_cvt_pk_bf16_f32 v61, v62, v63
    v_mfma_f32_16x16x32_bf16 v[28:31], a[52:55], v[68:71], v[28:31]
    ds_read_b128 v[88:91], v2 offset:14336
    v_mfma_f32_16x16x32_bf16 v[36:39], a[56:59], v[68:71], v[36:39]
    ds_write_b64 v8, v[60:61] offset:14336
    v_mfma_f32_16x16x32_bf16 v[40:43], a[56:59], v[72:75], v[40:43]
    s_waitcnt lgkmcnt(4)
    v_mul_f32 v64, v64, v115
    v_mul_f32 v65, v65, v115
    v_mfma_f32_16x16x32_bf16 v[20:23], a[60:63], v[76:79], v[20:23]
    ds_read_b128 v[92:95], v3 offset:12288
    v_mul_f32 v66, v66, v115
    v_mfma_f32_16x16x32_bf16 v[24:27], a[60:63], v[80:83], v[24:27]
    v_mul_f32 v67, v67, v115
    v_cvt_pk_bf16_f32 v64, v64, v65
    v_mfma_f32_16x16x32_bf16 v[32:35], a[64:67], v[80:83], v[32:35]
    v_cvt_pk_bf16_f32 v65, v66, v67
    v_mfma_f32_16x16x32_bf16 v[28:31], a[64:67], v[76:79], v[28:31]
    ds_read_b128 v[96:99], v3 offset:14336
    v_mfma_f32_16x16x32_bf16 v[36:39], a[68:71], v[76:79], v[36:39]
    ds_write_b64 v8, v[64:65] offset:20480
    v_mfma_f32_16x16x32_bf16 v[40:43], a[68:71], v[80:83], v[40:43]
    s_waitcnt lgkmcnt(4)
    v_mfma_f32_16x16x32_bf16 v[20:23], a[72:75], v[84:87], v[20:23]
    ds_read_b128 v[68:71], v2 offset:16384
    v_mfma_f32_16x16x32_bf16 v[24:27], a[72:75], v[88:91], v[24:27]
    v_mfma_f32_16x16x32_bf16 v[32:35], a[76:79], v[88:91], v[32:35]
    s_waitcnt lgkmcnt(1)
    s_barrier
    v_mfma_f32_16x16x32_bf16 v[28:31], a[76:79], v[84:87], v[28:31]
    ds_read_b128 v[72:75], v2 offset:18432
    v_mfma_f32_16x16x32_bf16 v[36:39], a[80:83], v[84:87], v[36:39]
    ds_read_b128 v[44:47], v9 offset:6144
    v_mfma_f32_16x16x32_bf16 v[40:43], a[80:83], v[88:91], v[40:43]
    s_waitcnt lgkmcnt(4)
    ds_read_b128 v[48:51], v9 offset:13312
    v_mfma_f32_16x16x32_bf16 v[20:23], a[84:87], v[92:95], v[20:23]
    ds_read_b128 v[76:79], v3 offset:16384
    v_mfma_f32_16x16x32_bf16 v[24:27], a[84:87], v[96:99], v[24:27]
    ds_read_b128 v[52:55], v9 offset:7168
    s_add_u32 m0, s43, 98304
    v_mfma_f32_16x16x32_bf16 v[32:35], a[88:91], v[96:99], v[32:35]
    buffer_load_dwordx4 v6, s[8:11], s41 offen offset:0 sc1 lds
    v_mfma_f32_16x16x32_bf16 v[28:31], a[88:91], v[92:95], v[28:31]
    s_add_u32 m0, s43, 102272
    ds_read_b128 v[80:83], v3 offset:18432
    v_mfma_f32_16x16x32_bf16 v[36:39], a[92:95], v[92:95], v[36:39]
    ds_read_b64_tr_b16 v[56:57], v9 offset:14336
    v_mfma_f32_16x16x32_bf16 v[40:43], a[92:95], v[96:99], v[40:43]
    s_waitcnt lgkmcnt(6)
    ds_read_b64_tr_b16 v[58:59], v9 offset:8192
    s_waitcnt lgkmcnt(3)
    v_mfma_f32_16x16x32_bf16 v[20:23], a[96:99], v[68:71], v[20:23]
    ds_read_b128 v[84:87], v2 offset:20480
    v_mfma_f32_16x16x32_bf16 v[64:67], v[48:51], v[44:47], 0
    ds_read_b64_tr_b16 v[60:61], v9 offset:14344
    v_mfma_f32_16x16x32_bf16 v[118:121], v[52:55], v[44:47], 0
    ds_read_b64_tr_b16 v[62:63], v9 offset:8200
    v_mfma_f32_16x16x32_bf16 v[24:27], a[96:99], v[72:75], v[24:27]
    v_mfma_f32_16x16x32_bf16 v[32:35], a[100:103], v[72:75], v[32:35]
    buffer_load_dwordx4 v6, s[8:11], s41 offen offset:128 sc1 lds
    v_mfma_f32_16x16x32_bf16 v[28:31], a[100:103], v[68:71], v[28:31]
    s_add_u32 m0, s43, 106240
    ds_read_b128 v[88:91], v2 offset:22528
    v_cndmask_b32 v64, v64, v65, s[56:57]
    v_mfma_f32_16x16x32_bf16 v[36:39], a[104:107], v[68:71], v[36:39]
    v_cndmask_b32 v66, v66, v67, s[56:57]
    v_cndmask_b32 v118, v118, v119, s[56:57]
    v_mfma_f32_16x16x32_bf16 v[40:43], a[104:107], v[72:75], v[40:43]
    s_waitcnt lgkmcnt(6)
    v_cndmask_b32 v120, v120, v121, s[56:57]
    v_cndmask_b32 v64, v18, v64, s[62:63]
    v_mfma_f32_16x16x32_bf16 v[20:23], a[108:111], v[76:79], v[20:23]
    ds_read_b128 v[92:95], v3 offset:20480
    v_cndmask_b32 v66, v18, v66, s[62:63]
    v_mfma_f32_16x16x32_bf16 v[24:27], a[108:111], v[80:83], v[24:27]
    v_cndmask_b32 v46, v64, v118, s[58:59]
    v_cndmask_b32 v47, v66, v120, s[60:61]
    v_mfma_f32_16x16x32_bf16 v[32:35], a[112:115], v[80:83], v[32:35]
    buffer_load_dwordx4 v6, s[8:11], s41 offen offset:256 sc1 lds
    v_mfma_f32_16x16x32_bf16 v[28:31], a[112:115], v[76:79], v[28:31]
    s_add_u32 m0, s43, 110208
    ds_read_b128 v[96:99], v3 offset:22528
    v_max_f32 v44, v46, v47
    v_mfma_f32_16x16x32_bf16 v[36:39], a[116:119], v[76:79], v[36:39]
    v_mov_b32 v45, v44
    v_mfma_f32_16x16x32_bf16 v[40:43], a[116:119], v[80:83], v[40:43]
    s_waitcnt lgkmcnt(2)
    v_permlane16_swap_b32 v44, v45
    v_mfma_f32_16x16x32_bf16 v[20:23], a[120:123], v[84:87], v[20:23]
    ds_read_b128 v[68:71], v2 offset:24576
    v_max_f32 v44, v44, v45
    v_mfma_f32_16x16x32_bf16 v[24:27], a[120:123], v[88:91], v[24:27]
    v_mov_b32 v45, v44
    v_mfma_f32_16x16x32_bf16 v[32:35], a[124:127], v[88:91], v[32:35]
    buffer_load_dwordx4 v6, s[8:11], s41 offen offset:384 sc1 lds
    v_mfma_f32_16x16x32_bf16 v[28:31], a[124:127], v[84:87], v[28:31]
    s_add_u32 m0, s43, 114176
    ds_read_b128 v[72:75], v2 offset:26624
    v_mfma_f32_16x16x32_bf16 v[36:39], a[128:131], v[84:87], v[36:39]
    v_permlane32_swap_b32 v44, v45
    v_mfma_f32_16x16x32_bf16 v[40:43], a[128:131], v[88:91], v[40:43]
    s_waitcnt lgkmcnt(2)
    v_max_f32 v44, v44, v45
    v_mul_f32 v44, s86, v44
    v_mfma_f32_16x16x32_bf16 v[20:23], a[132:135], v[92:95], v[20:23]
    ds_read_b128 v[76:79], v3 offset:24576
    v_fma_f32 v46, v46, s86, -v44
    v_mfma_f32_16x16x32_bf16 v[24:27], a[132:135], v[96:99], v[24:27]
    v_fma_f32 v47, v47, s86, -v44
    v_mfma_f32_16x16x32_bf16 v[32:35], a[136:139], v[96:99], v[32:35]
    buffer_load_dwordx4 v6, s[8:11], s41 offen offset:512 sc1 lds
    v_mfma_f32_16x16x32_bf16 v[28:31], a[136:139], v[92:95], v[28:31]
    s_add_u32 m0, s43, 118144
    ds_read_b128 v[80:83], v3 offset:26624
    v_mfma_f32_16x16x32_bf16 v[36:39], a[140:143], v[92:95], v[36:39]
    v_exp_f32 v46, v46
    v_mfma_f32_16x16x32_bf16 v[40:43], a[140:143], v[96:99], v[40:43]
    s_waitcnt lgkmcnt(2)
    v_exp_f32 v47, v47
    v_mfma_f32_16x16x32_bf16 v[20:23], a[144:147], v[68:71], v[20:23]
    ds_read_b128 v[84:87], v2 offset:28672
    v_cvt_pk_bf16_f32 v52, v46, v47
    v_mfma_f32_16x16x32_bf16 v[24:27], a[144:147], v[72:75], v[24:27]
    v_perm_b32 v48, v52, v52, v14
    v_perm_b32 v49, v52, v52, v15
    v_mfma_f32_16x16x32_bf16 v[32:35], a[148:151], v[72:75], v[32:35]
    buffer_load_dwordx4 v6, s[8:11], s41 offen offset:640 sc1 lds
    v_mfma_f32_16x16x32_bf16 v[28:31], a[148:151], v[68:71], v[28:31]
    s_add_u32 m0, s43, 122112
    ds_read_b128 v[88:91], v2 offset:30720
    v_perm_b32 v50, v52, v52, v16
    v_mfma_f32_16x16x32_bf16 v[36:39], a[152:155], v[68:71], v[36:39]
    v_perm_b32 v51, v52, v52, v17
    v_add_f32 v44, v46, v47
    v_mfma_f32_16x16x32_bf16 v[40:43], a[152:155], v[72:75], v[40:43]
    s_waitcnt lgkmcnt(2)
    v_mov_b32 v45, v44
    s_waitcnt lgkmcnt(9)
    v_mfma_f32_16x16x32_bf16 v[20:23], a[156:159], v[76:79], v[20:23]
    ds_read_b128 v[92:95], v3 offset:28672
    v_mfma_f32_16x16x32_bf16 v[64:67], v[56:59], v[48:51], 0
    v_mfma_f32_16x16x32_bf16 v[118:121], v[60:63], v[48:51], 0
    v_permlane16_swap_b32 v44, v45
    v_mfma_f32_16x16x32_bf16 v[24:27], a[156:159], v[80:83], v[24:27]
    v_add_f32 v44, v44, v45
    v_mov_b32 v45, v44
    v_mfma_f32_16x16x32_bf16 v[32:35], a[160:163], v[80:83], v[32:35]
    buffer_load_dwordx4 v6, s[8:11], s41 offen offset:768 sc1 lds
    v_mfma_f32_16x16x32_bf16 v[28:31], a[160:163], v[76:79], v[28:31]
    s_add_u32 m0, s43, 126080
    ds_read_b128 v[96:99], v3 offset:30720
    v_mfma_f32_16x16x32_bf16 v[36:39], a[164:167], v[76:79], v[36:39]
    v_permlane32_swap_b32 v44, v45
    v_mfma_f32_16x16x32_bf16 v[40:43], a[164:167], v[80:83], v[40:43]
    s_waitcnt lgkmcnt(2)
    v_add_f32 v44, v44, v45
    v_mfma_f32_16x16x32_bf16 v[20:23], a[168:171], v[84:87], v[20:23]
    ds_read_b128 v[68:71], v2 offset:32768
    v_mfma_f32_16x16x32_bf16 v[24:27], a[168:171], v[88:91], v[24:27]
    v_rcp_f32 v44, v44
    v_mfma_f32_16x16x32_bf16 v[32:35], a[172:175], v[88:91], v[32:35]
    buffer_load_dwordx4 v6, s[8:11], s41 offen offset:896 sc1 lds
    v_mfma_f32_16x16x32_bf16 v[28:31], a[172:175], v[84:87], v[28:31]
    s_add_u32 m0, s43, 130048
    ds_read_b128 v[72:75], v2 offset:34816
    v_mul_f32 v64, v64, v44
    v_mfma_f32_16x16x32_bf16 v[36:39], a[176:179], v[84:87], v[36:39]
    v_mul_f32 v65, v65, v44
    v_mul_f32 v66, v66, v44
    v_mfma_f32_16x16x32_bf16 v[40:43], a[176:179], v[88:91], v[40:43]
    s_waitcnt lgkmcnt(2)
    v_mul_f32 v67, v67, v44
    v_cvt_pk_bf16_f32 v52, v64, v65
    v_mfma_f32_16x16x32_bf16 v[20:23], a[180:183], v[92:95], v[20:23]
    ds_read_b128 v[76:79], v3 offset:32768
    v_cvt_pk_bf16_f32 v53, v66, v67
    v_mfma_f32_16x16x32_bf16 v[24:27], a[180:183], v[96:99], v[24:27]
    v_mul_f32 v118, v118, v44
    v_mul_f32 v119, v119, v44
    v_mfma_f32_16x16x32_bf16 v[32:35], a[184:187], v[96:99], v[32:35]
    buffer_load_dwordx4 v6, s[8:11], s41 offen offset:1024 sc1 lds
    v_mfma_f32_16x16x32_bf16 v[28:31], a[184:187], v[92:95], v[28:31]
    s_add_u32 m0, s43, 134016
    ds_read_b128 v[80:83], v3 offset:34816
    v_mul_f32 v120, v120, v44
    v_mfma_f32_16x16x32_bf16 v[36:39], a[188:191], v[92:95], v[36:39]
    v_mul_f32 v121, v121, v44
    v_cvt_pk_bf16_f32 v54, v118, v119
    v_mfma_f32_16x16x32_bf16 v[40:43], a[188:191], v[96:99], v[40:43]
    s_waitcnt lgkmcnt(2)
    v_cvt_pk_bf16_f32 v55, v120, v121
    v_mfma_f32_16x16x32_bf16 v[20:23], a[192:195], v[68:71], v[20:23]
    ds_read_b128 v[84:87], v2 offset:36864
    v_mfma_f32_16x16x32_bf16 v[24:27], a[192:195], v[72:75], v[24:27]
    buffer_store_dwordx4 v[52:55], v1, s[16:19], s44 offen sc1
    v_mfma_f32_16x16x32_bf16 v[32:35], a[196:199], v[72:75], v[32:35]
    buffer_load_dwordx4 v6, s[8:11], s41 offen offset:1152 sc1 lds
    v_mfma_f32_16x16x32_bf16 v[28:31], a[196:199], v[68:71], v[28:31]
    s_add_u32 m0, s43, 137984
    ds_read_b128 v[88:91], v2 offset:38912
    s_cmp_eq_u32 s36, 17
    v_mfma_f32_16x16x32_bf16 v[36:39], a[200:203], v[68:71], v[36:39]
    s_cselect_b32 s49, s87, 0x10000
    ds_read_b64 v[56:57], v13 offset:0
    s_add_u32 s90, s90, s49
    v_mfma_f32_16x16x32_bf16 v[40:43], a[200:203], v[72:75], v[40:43]
    s_waitcnt lgkmcnt(3)
    ds_read_b64 v[58:59], v13 offset:128
    s_and_b32 s49, s90, 0xffffffff
    v_mfma_f32_16x16x32_bf16 v[20:23], a[204:207], v[76:79], v[20:23]
    s_bitcmp1_b64 s[24:25], s36
    ds_read_b128 v[92:95], v3 offset:36864
    s_cselect_b32 s44, s49, 0x5e00000
    v_mfma_f32_16x16x32_bf16 v[24:27], a[204:207], v[80:83], v[24:27]
    s_bitcmp1_b64 s[26:27], s36
    ds_read_b64 v[60:61], v13 offset:256
    s_cselect_b64 s[62:63], 0, -1
    v_mfma_f32_16x16x32_bf16 v[32:35], a[208:211], v[80:83], v[32:35]
    buffer_load_dwordx4 v6, s[8:11], s41 offen offset:1280 sc1 lds
    v_mfma_f32_16x16x32_bf16 v[28:31], a[208:211], v[76:79], v[28:31]
    s_add_u32 m0, s43, 141952
    ds_read_b128 v[96:99], v3 offset:38912
    v_mfma_f32_16x16x32_bf16 v[36:39], a[212:215], v[76:79], v[36:39]
    ds_read_b64 v[62:63], v13 offset:384
    v_mfma_f32_16x16x32_bf16 v[40:43], a[212:215], v[80:83], v[40:43]
    s_waitcnt lgkmcnt(6)
    v_mfma_f32_16x16x32_bf16 v[20:23], a[216:219], v[84:87], v[20:23]
    ds_read_b128 v[68:71], v2 offset:40960
    v_mfma_f32_16x16x32_bf16 v[24:27], a[216:219], v[88:91], v[24:27]
    v_mfma_f32_16x16x32_bf16 v[32:35], a[220:223], v[88:91], v[32:35]
    buffer_load_dwordx4 v6, s[8:11], s41 offen offset:1408 sc1 lds
    v_mfma_f32_16x16x32_bf16 v[28:31], a[220:223], v[84:87], v[28:31]
    s_add_u32 m0, s43, 145920
    ds_read_b128 v[72:75], v2 offset:43008
    s_waitcnt lgkmcnt(2)
    v_mfma_f32_16x16x32_bf16 v[36:39], a[224:227], v[84:87], v[36:39]
    v_add_f32 v64, v60, v62
    v_add_f32 v65, v61, v63
    v_mfma_f32_16x16x32_bf16 v[40:43], a[224:227], v[88:91], v[40:43]
    s_waitcnt lgkmcnt(3)
    v_add_f32 v56, v56, v58
    v_add_f32 v57, v57, v59
    v_mfma_f32_16x16x32_bf16 v[20:23], a[228:231], v[92:95], v[20:23]
    ds_read_b128 v[76:79], v3 offset:40960
    v_add_f32 v56, v56, v64
    v_mfma_f32_16x16x32_bf16 v[24:27], a[228:231], v[96:99], v[24:27]
    v_add_f32 v57, v57, v65
    v_mov_b32 v64, v56
    v_mfma_f32_16x16x32_bf16 v[32:35], a[232:235], v[96:99], v[32:35]
    buffer_load_dwordx4 v6, s[8:11], s41 offen offset:1536 sc1 lds
    v_mfma_f32_16x16x32_bf16 v[28:31], a[232:235], v[92:95], v[28:31]
    s_add_u32 m0, s43, 149888
    ds_read_b128 v[80:83], v3 offset:43008
    v_mov_b32 v65, v57
    v_mfma_f32_16x16x32_bf16 v[36:39], a[236:239], v[92:95], v[36:39]
    v_permlane32_swap_b32 v56, v64
    v_mfma_f32_16x16x32_bf16 v[40:43], a[236:239], v[96:99], v[40:43]
    s_waitcnt lgkmcnt(2)
    v_permlane32_swap_b32 v57, v65
    v_mfma_f32_16x16x32_bf16 v[20:23], a[240:243], v[68:71], v[20:23]
    ds_read_b128 v[84:87], v2 offset:45056
    v_add_f32 v56, v56, v64
    v_mfma_f32_16x16x32_bf16 v[24:27], a[240:243], v[72:75], v[24:27]
    v_add_f32 v57, v57, v65
    v_mul_f32 v112, 0xba800000, v56
    v_mfma_f32_16x16x32_bf16 v[32:35], a[244:247], v[72:75], v[32:35]
    buffer_load_dwordx4 v6, s[8:11], s41 offen offset:1664 sc1 lds
    v_mfma_f32_16x16x32_bf16 v[28:31], a[244:247], v[68:71], v[28:31]
    s_add_u32 m0, s43, 153856
    ds_read_b128 v[88:91], v2 offset:47104
    v_mul_f32 v57, 0x3a800000, v57
    v_mfma_f32_16x16x32_bf16 v[36:39], a[248:251], v[68:71], v[36:39]
    v_fma_f32 v57, -v112, v112, v57
    v_mov_b32 v113, v112
    v_mfma_f32_16x16x32_bf16 v[40:43], a[248:251], v[72:75], v[40:43]
    s_waitcnt lgkmcnt(2)
    v_max_f32 v57, 0, v57
    v_add_f32 v57, 0x3727c5ac, v57
    v_mfma_f32_16x16x32_bf16 v[20:23], a[252:255], v[76:79], v[20:23]
    ds_read_b128 v[92:95], v3 offset:45056
    v_mfma_f32_16x16x32_bf16 v[24:27], a[252:255], v[80:83], v[24:27]
    v_rsq_f32 v114, v57
    v_mfma_f32_16x16x32_bf16 v[32:35], v[128:131], v[80:83], v[32:35]
    buffer_load_dwordx4 v6, s[8:11], s41 offen offset:1792 sc1 lds
    v_mfma_f32_16x16x32_bf16 v[28:31], v[128:131], v[76:79], v[28:31]
    s_add_u32 m0, s43, 157824
    ds_read_b128 v[96:99], v3 offset:47104
    v_mfma_f32_16x16x32_bf16 v[36:39], v[132:135], v[76:79], v[36:39]
    v_permlane16_swap_b32 v112, v113
    v_mfma_f32_16x16x32_bf16 v[40:43], v[132:135], v[80:83], v[40:43]
    s_waitcnt lgkmcnt(2)
    v_mov_b32 v115, v114
    v_fmac_f32 v24, v113, v100
    v_mfma_f32_16x16x32_bf16 v[20:23], v[136:139], v[84:87], v[20:23]
    ds_read_b128 v[68:71], v2 offset:49152
    v_fmac_f32 v28, v112, v104
    v_mfma_f32_16x16x32_bf16 v[24:27], v[136:139], v[88:91], v[24:27]
    v_permlane16_swap_b32 v114, v115
    v_mfma_f32_16x16x32_bf16 v[32:35], v[140:143], v[88:91], v[32:35]
    buffer_load_dwordx4 v6, s[8:11], s41 offen offset:1920 sc1 lds
    v_mfma_f32_16x16x32_bf16 v[28:31], v[140:143], v[84:87], v[28:31]
    s_add_u32 m0, s52, 92160
    ds_read_b128 v[72:75], v2 offset:51200
    v_fmac_f32 v20, v112, v100
    v_mfma_f32_16x16x32_bf16 v[36:39], v[144:147], v[84:87], v[36:39]
    v_fmac_f32 v21, v112, v101
    v_fmac_f32 v22, v112, v102
    v_mfma_f32_16x16x32_bf16 v[40:43], v[144:147], v[88:91], v[40:43]
    s_waitcnt lgkmcnt(2)
    v_fmac_f32 v25, v113, v101
    v_fmac_f32 v26, v113, v102
    v_mfma_f32_16x16x32_bf16 v[20:23], v[148:151], v[92:95], v[20:23]
    ds_read_b128 v[76:79], v3 offset:49152
    v_fmac_f32 v29, v112, v105
    v_mfma_f32_16x16x32_bf16 v[24:27], v[148:151], v[96:99], v[24:27]
    v_fmac_f32 v30, v112, v106
    v_fmac_f32 v31, v112, v107
    v_mfma_f32_16x16x32_bf16 v[32:35], v[152:155], v[96:99], v[32:35]
    buffer_load_dwordx4 v1, s[16:19], s46 offen sc1 lds
    v_mfma_f32_16x16x32_bf16 v[28:31], v[152:155], v[92:95], v[28:31]
    s_cmp_eq_u32 s36, s97
    ds_read_b128 v[80:83], v3 offset:51200
    v_med3_i32 v117, s45, 0, v12
    v_mfma_f32_16x16x32_bf16 v[36:39], v[156:159], v[92:95], v[36:39]
    s_cselect_b32 s47, 32, -2
    v_add_u32 v117, v117, v11
    v_fmac_f32 v23, v112, v103
    v_mfma_f32_16x16x32_bf16 v[40:43], v[156:159], v[96:99], v[40:43]
    s_waitcnt lgkmcnt(2)
    v_fmac_f32 v27, v113, v103
    v_fmac_f32 v32, v113, v104
    v_mfma_f32_16x16x32_bf16 v[20:23], v[160:163], v[68:71], v[20:23]
    s_cselect_b64 s[8:9], s[88:89], s[8:9]
    ds_read_b128 v[84:87], v2 offset:53248
    v_fmac_f32 v33, v113, v105
    v_mfma_f32_16x16x32_bf16 v[24:27], v[160:163], v[72:75], v[24:27]
    s_cselect_b32 s55, 0x543fc00, s55
    v_fmac_f32 v36, v112, v108
    v_fmac_f32 v37, v112, v109
    v_mfma_f32_16x16x32_bf16 v[32:35], v[164:167], v[72:75], v[32:35]
    s_add_u32 s45, s45, 65536
    v_fmac_f32 v38, v112, v110
    v_fmac_f32 v39, v112, v111
    v_mfma_f32_16x16x32_bf16 v[28:31], v[164:167], v[68:71], v[28:31]
    s_add_u32 s50, s50, s47
    ds_read_b128 v[88:91], v2 offset:55296
    v_fmac_f32 v40, v113, v108
    v_mfma_f32_16x16x32_bf16 v[36:39], v[168:171], v[68:71], v[36:39]
    buffer_load_dword v116, v117, s[16:19], 0 offen sc1
    v_mfma_f32_16x16x32_bf16 v[40:43], v[168:171], v[72:75], v[40:43]
    s_waitcnt lgkmcnt(2)
    v_fmac_f32 v34, v113, v106
    v_fmac_f32 v35, v113, v107
    v_mfma_f32_16x16x32_bf16 v[20:23], v[172:175], v[76:79], v[20:23]
    s_max_i32 s47, s50, 0
    ds_read_b128 v[92:95], v3 offset:53248
    s_min_i32 s47, s47, s96
    v_mfma_f32_16x16x32_bf16 v[24:27], v[172:175], v[80:83], v[24:27]
    s_lshl_b32 s41, s47, 15
    v_fmac_f32 v41, v113, v109
    v_fmac_f32 v42, v113, v110
    v_mfma_f32_16x16x32_bf16 v[32:35], v[176:179], v[80:83], v[32:35]
    s_lshl_b32 s46, s47, 10
    v_fmac_f32 v43, v113, v111
    s_sub_u32 s46, s55, s46
    v_mfma_f32_16x16x32_bf16 v[28:31], v[176:179], v[76:79], v[28:31]
    ds_read_b128 v[96:99], v3 offset:55296
    v_mfma_f32_16x16x32_bf16 v[36:39], v[180:183], v[76:79], v[36:39]
    v_mfma_f32_16x16x32_bf16 v[40:43], v[180:183], v[80:83], v[40:43]
    s_waitcnt lgkmcnt(2)
    v_mfma_f32_16x16x32_bf16 v[20:23], v[184:187], v[84:87], v[20:23]
    ds_read_b128 v[68:71], v2 offset:57344
    v_mfma_f32_16x16x32_bf16 v[24:27], v[184:187], v[88:91], v[24:27]
    v_mfma_f32_16x16x32_bf16 v[32:35], v[188:191], v[88:91], v[32:35]
    v_mfma_f32_16x16x32_bf16 v[28:31], v[188:191], v[84:87], v[28:31]
    ds_read_b128 v[72:75], v2 offset:59392
    v_mfma_f32_16x16x32_bf16 v[36:39], v[192:195], v[84:87], v[36:39]
    v_mfma_f32_16x16x32_bf16 v[40:43], v[192:195], v[88:91], v[40:43]
    s_waitcnt lgkmcnt(2)
    v_mfma_f32_16x16x32_bf16 v[20:23], v[196:199], v[92:95], v[20:23]
    ds_read_b128 v[76:79], v3 offset:57344
    v_mfma_f32_16x16x32_bf16 v[24:27], v[196:199], v[96:99], v[24:27]
    v_mfma_f32_16x16x32_bf16 v[32:35], v[200:203], v[96:99], v[32:35]
    v_mfma_f32_16x16x32_bf16 v[28:31], v[200:203], v[92:95], v[28:31]
    ds_read_b128 v[80:83], v3 offset:59392
    v_mfma_f32_16x16x32_bf16 v[36:39], v[204:207], v[92:95], v[36:39]
    s_waitcnt vmcnt(9)
    s_barrier
    v_mfma_f32_16x16x32_bf16 v[40:43], v[204:207], v[96:99], v[40:43]
    s_waitcnt lgkmcnt(2)
    v_mfma_f32_16x16x32_bf16 v[20:23], v[208:211], v[68:71], v[20:23]
    ds_read_b128 v[84:87], v2 offset:61440
    v_mfma_f32_16x16x32_bf16 v[24:27], v[208:211], v[72:75], v[24:27]
    buffer_store_dword v124, v124, s[16:19], s91 offen sc1
    v_mfma_f32_16x16x32_bf16 v[32:35], v[212:215], v[72:75], v[32:35]
    s_add_u32 s91, s91, 65536
    v_mfma_f32_16x16x32_bf16 v[28:31], v[212:215], v[68:71], v[28:31]
    ds_read_b128 v[88:91], v2 offset:63488
    v_mfma_f32_16x16x32_bf16 v[36:39], v[216:219], v[68:71], v[36:39]
    v_mfma_f32_16x16x32_bf16 v[40:43], v[216:219], v[72:75], v[40:43]
    s_waitcnt lgkmcnt(2)
    v_mfma_f32_16x16x32_bf16 v[20:23], v[220:223], v[76:79], v[20:23]
    ds_read_b128 v[92:95], v3 offset:61440
    v_mfma_f32_16x16x32_bf16 v[24:27], v[220:223], v[80:83], v[24:27]
    v_mfma_f32_16x16x32_bf16 v[32:35], v[224:227], v[80:83], v[32:35]
    v_mfma_f32_16x16x32_bf16 v[28:31], v[224:227], v[76:79], v[28:31]
    ds_read_b128 v[96:99], v3 offset:63488
    v_mfma_f32_16x16x32_bf16 v[36:39], v[228:231], v[76:79], v[36:39]
    v_mfma_f32_16x16x32_bf16 v[40:43], v[228:231], v[80:83], v[40:43]
    s_waitcnt lgkmcnt(2)
    v_mfma_f32_16x16x32_bf16 v[20:23], v[232:235], v[84:87], v[20:23]
    ds_read_b128 v[68:71], v4 offset:0
    v_mfma_f32_16x16x32_bf16 v[24:27], v[232:235], v[88:91], v[24:27]
    v_mfma_f32_16x16x32_bf16 v[32:35], v[236:239], v[88:91], v[32:35]
    v_mfma_f32_16x16x32_bf16 v[28:31], v[236:239], v[84:87], v[28:31]
    ds_read_b128 v[72:75], v4 offset:2048
    v_mfma_f32_16x16x32_bf16 v[36:39], v[240:243], v[84:87], v[36:39]
    v_mfma_f32_16x16x32_bf16 v[40:43], v[240:243], v[88:91], v[40:43]
    s_waitcnt lgkmcnt(2)
    v_mfma_f32_16x16x32_bf16 v[20:23], v[244:247], v[92:95], v[20:23]
    ds_read_b128 v[76:79], v5 offset:0
    v_mfma_f32_16x16x32_bf16 v[24:27], v[244:247], v[96:99], v[24:27]
    v_mfma_f32_16x16x32_bf16 v[32:35], v[248:251], v[96:99], v[32:35]
    v_mfma_f32_16x16x32_bf16 v[28:31], v[248:251], v[92:95], v[28:31]
    ds_read_b128 v[80:83], v5 offset:2048
    v_mfma_f32_16x16x32_bf16 v[36:39], v[252:255], v[92:95], v[36:39]
    s_add_u32 s36, s36, 1
    v_mfma_f32_16x16x32_bf16 v[40:43], v[252:255], v[96:99], v[40:43]
    s_waitcnt lgkmcnt(2)
    s_cmp_eq_u32 s36, 16
    s_cbranch_scc1 L_q_short
L_q_b1:
    v_mfma_f32_16x16x32_bf16 v[44:47], a[0:3], v[68:71], 0
    ds_read_b128 v[84:87], v4 offset:4096
    v_mul_f32 v20, v20, v114
    v_mfma_f32_16x16x32_bf16 v[48:51], a[0:3], v[72:75], 0
    v_mul_f32 v21, v21, v114
    v_mul_f32 v22, v22, v114
    v_mfma_f32_16x16x32_bf16 v[56:59], a[4:7], v[72:75], 0
    v_mul_f32 v23, v23, v114
    v_cvt_pk_bf16_f32 v20, v20, v21
    v_mfma_f32_16x16x32_bf16 v[52:55], a[4:7], v[68:71], 0
    ds_read_b128 v[88:91], v4 offset:6144
    v_cvt_pk_bf16_f32 v21, v22, v23
    v_mfma_f32_16x16x32_bf16 v[60:63], a[8:11], v[68:71], 0
    ds_write_b64 v7, v[20:21] offset:0
    v_mfma_f32_16x16x32_bf16 v[64:67], a[8:11], v[72:75], 0
    s_waitcnt lgkmcnt(3)
    v_mul_f32 v24, v24, v115
    v_mul_f32 v25, v25, v115
    v_mfma_f32_16x16x32_bf16 v[44:47], a[12:15], v[76:79], v[44:47]
    ds_read_b128 v[92:95], v5 offset:4096
    v_mul_f32 v26, v26, v115
    v_mfma_f32_16x16x32_bf16 v[48:51], a[12:15], v[80:83], v[48:51]
    v_mul_f32 v27, v27, v115
    v_cvt_pk_bf16_f32 v24, v24, v25
    v_mfma_f32_16x16x32_bf16 v[56:59], a[16:19], v[80:83], v[56:59]
    v_cvt_pk_bf16_f32 v25, v26, v27
    v_mfma_f32_16x16x32_bf16 v[52:55], a[16:19], v[76:79], v[52:55]
    ds_read_b128 v[96:99], v5 offset:6144
    v_mfma_f32_16x16x32_bf16 v[60:63], a[20:23], v[76:79], v[60:63]
    ds_write_b64 v7, v[24:25] offset:6144
    v_mfma_f32_16x16x32_bf16 v[64:67], a[20:23], v[80:83], v[64:67]
    s_waitcnt lgkmcnt(4)
    v_mul_f32 v28, v28, v114
    v_mul_f32 v29, v29, v114
    v_mfma_f32_16x16x32_bf16 v[44:47], a[24:27], v[84:87], v[44:47]
    ds_read_b128 v[68:71], v4 offset:8192
    v_mul_f32 v30, v30, v114
    v_mfma_f32_16x16x32_bf16 v[48:51], a[24:27], v[88:91], v[48:51]
    v_mul_f32 v31, v31, v114
    v_cvt_pk_bf16_f32 v28, v28, v29
    v_mfma_f32_16x16x32_bf16 v[56:59], a[28:31], v[88:91], v[56:59]
    v_cvt_pk_bf16_f32 v29, v30, v31
    v_mfma_f32_16x16x32_bf16 v[52:55], a[28:31], v[84:87], v[52:55]
    ds_read_b128 v[72:75], v4 offset:10240
    v_mfma_f32_16x16x32_bf16 v[60:63], a[32:35], v[84:87], v[60:63]
    ds_write_b64 v7, v[28:29] offset:1024
    v_mfma_f32_16x16x32_bf16 v[64:67], a[32:35], v[88:91], v[64:67]
    s_waitcnt lgkmcnt(4)
    v_mul_f32 v32, v32, v115
    v_mul_f32 v33, v33, v115
    v_mfma_f32_16x16x32_bf16 v[44:47], a[36:39], v[92:95], v[44:47]
    ds_read_b128 v[76:79], v5 offset:8192
    v_mul_f32 v34, v34, v115
    v_mfma_f32_16x16x32_bf16 v[48:51], a[36:39], v[96:99], v[48:51]
    v_mul_f32 v35, v35, v115
    v_cvt_pk_bf16_f32 v32, v32, v33
    v_mfma_f32_16x16x32_bf16 v[56:59], a[40:43], v[96:99], v[56:59]
    v_cvt_pk_bf16_f32 v33, v34, v35
    v_mfma_f32_16x16x32_bf16 v[52:55], a[40:43], v[92:95], v[52:55]
    ds_read_b128 v[80:83], v5 offset:10240
    v_mfma_f32_16x16x32_bf16 v[60:63], a[44:47], v[92:95], v[60:63]
    ds_write_b64 v7, v[32:33] offset:7168
    v_mfma_f32_16x16x32_bf16 v[64:67], a[44:47], v[96:99], v[64:67]
    s_waitcnt lgkmcnt(4)
    v_mul_f32 v36, v36, v114
    v_mul_f32 v37, v37, v114
    v_mfma_f32_16x16x32_bf16 v[44:47], a[48:51], v[68:71], v[44:47]
    s_waitcnt vmcnt(1)
    ds_read_b128 v[84:87], v4 offset:12288
    v_cmp_ne_u32 vcc, 0, v116
    v_mfma_f32_16x16x32_bf16 v[48:51], a[48:51], v[72:75], v[48:51]
    v_mul_f32 v38, v38, v114
    v_mul_f32 v39, v39, v114
    v_mfma_f32_16x16x32_bf16 v[56:59], a[52:55], v[72:75], v[56:59]
    s_cbranch_vccnz L_spin5
L_back6:
    v_cvt_pk_bf16_f32 v36, v36, v37
    v_cvt_pk_bf16_f32 v37, v38, v39
    v_mfma_f32_16x16x32_bf16 v[52:55], a[52:55], v[68:71], v[52:55]
    ds_read_b128 v[88:91], v4 offset:14336
    v_mfma_f32_16x16x32_bf16 v[60:63], a[56:59], v[68:71], v[60:63]
    ds_write_b64 v8, v[36:37] offset:2048
    v_mfma_f32_16x16x32_bf16 v[64:67], a[56:59], v[72:75], v[64:67]
    s_waitcnt lgkmcnt(4)
    v_mul_f32 v40, v40, v115
    v_mul_f32 v41, v41, v115
    v_mfma_f32_16x16x32_bf16 v[44:47], a[60:63], v[76:79], v[44:47]
    ds_read_b128 v[92:95], v5 offset:12288
    v_mul_f32 v42, v42, v115
    v_mfma_f32_16x16x32_bf16 v[48:51], a[60:63], v[80:83], v[48:51]
    v_mul_f32 v43, v43, v115
    v_cvt_pk_bf16_f32 v40, v40, v41
    v_mfma_f32_16x16x32_bf16 v[56:59], a[64:67], v[80:83], v[56:59]
    v_cvt_pk_bf16_f32 v41, v42, v43
    v_mfma_f32_16x16x32_bf16 v[52:55], a[64:67], v[76:79], v[52:55]
    ds_read_b128 v[96:99], v5 offset:14336
    v_mfma_f32_16x16x32_bf16 v[60:63], a[68:71], v[76:79], v[60:63]
    ds_write_b64 v8, v[40:41] offset:8192
    v_mfma_f32_16x16x32_bf16 v[64:67], a[68:71], v[80:83], v[64:67]
    s_waitcnt lgkmcnt(4)
    v_mfma_f32_16x16x32_bf16 v[44:47], a[72:75], v[84:87], v[44:47]
    ds_read_b128 v[68:71], v4 offset:16384
    v_mfma_f32_16x16x32_bf16 v[48:51], a[72:75], v[88:91], v[48:51]
    v_mfma_f32_16x16x32_bf16 v[56:59], a[76:79], v[88:91], v[56:59]
    s_waitcnt lgkmcnt(1)
    s_barrier
    v_mfma_f32_16x16x32_bf16 v[52:55], a[76:79], v[84:87], v[52:55]
    ds_read_b128 v[72:75], v4 offset:18432
    v_mfma_f32_16x16x32_bf16 v[60:63], a[80:83], v[84:87], v[60:63]
    ds_read_b128 v[20:23], v10 offset:0
    v_mfma_f32_16x16x32_bf16 v[64:67], a[80:83], v[88:91], v[64:67]
    s_waitcnt lgkmcnt(4)
    ds_read_b128 v[24:27], v9 offset:1024
    v_mfma_f32_16x16x32_bf16 v[44:47], a[84:87], v[92:95], v[44:47]
    ds_read_b128 v[76:79], v5 offset:16384
    v_mfma_f32_16x16x32_bf16 v[48:51], a[84:87], v[96:99], v[48:51]
    ds_read_b128 v[28:31], v10 offset:1024
    s_add_u32 m0, s43, 0
    v_mfma_f32_16x16x32_bf16 v[56:59], a[88:91], v[96:99], v[56:59]
    buffer_load_dwordx4 v6, s[8:11], s41 offen offset:0 sc1 lds
    v_mfma_f32_16x16x32_bf16 v[52:55], a[88:91], v[92:95], v[52:55]
    s_add_u32 m0, s43, 3968
    ds_read_b128 v[80:83], v5 offset:18432
    v_mfma_f32_16x16x32_bf16 v[60:63], a[92:95], v[92:95], v[60:63]
    ds_read_b64_tr_b16 v[32:33], v9 offset:2048
    v_mfma_f32_16x16x32_bf16 v[64:67], a[92:95], v[96:99], v[64:67]
    s_waitcnt lgkmcnt(6)
    ds_read_b64_tr_b16 v[34:35], v10 offset:2048
    s_waitcnt lgkmcnt(3)
    v_mfma_f32_16x16x32_bf16 v[44:47], a[96:99], v[68:71], v[44:47]
    ds_read_b128 v[84:87], v4 offset:20480
    v_mfma_f32_16x16x32_bf16 v[40:43], v[24:27], v[20:23], 0
    ds_read_b64_tr_b16 v[36:37], v9 offset:2056
    v_mfma_f32_16x16x32_bf16 v[118:121], v[28:31], v[20:23], 0
    ds_read_b64_tr_b16 v[38:39], v10 offset:2056
    v_mfma_f32_16x16x32_bf16 v[48:51], a[96:99], v[72:75], v[48:51]
    v_mfma_f32_16x16x32_bf16 v[56:59], a[100:103], v[72:75], v[56:59]
    buffer_load_dwordx4 v6, s[8:11], s41 offen offset:128 sc1 lds
    v_mfma_f32_16x16x32_bf16 v[52:55], a[100:103], v[68:71], v[52:55]
    s_add_u32 m0, s43, 7936
    ds_read_b128 v[88:91], v4 offset:22528
    v_cndmask_b32 v40, v40, v41, s[56:57]
    v_mfma_f32_16x16x32_bf16 v[60:63], a[104:107], v[68:71], v[60:63]
    v_cndmask_b32 v42, v42, v43, s[56:57]
    v_cndmask_b32 v118, v118, v119, s[56:57]
    v_mfma_f32_16x16x32_bf16 v[64:67], a[104:107], v[72:75], v[64:67]
    s_waitcnt lgkmcnt(6)
    v_cndmask_b32 v120, v120, v121, s[56:57]
    v_cndmask_b32 v40, v18, v40, s[62:63]
    v_mfma_f32_16x16x32_bf16 v[44:47], a[108:111], v[76:79], v[44:47]
    ds_read_b128 v[92:95], v5 offset:20480
    v_cndmask_b32 v42, v18, v42, s[62:63]
    v_mfma_f32_16x16x32_bf16 v[48:51], a[108:111], v[80:83], v[48:51]
    v_cndmask_b32 v22, v40, v118, s[58:59]
    v_cndmask_b32 v23, v42, v120, s[60:61]
    v_mfma_f32_16x16x32_bf16 v[56:59], a[112:115], v[80:83], v[56:59]
    buffer_load_dwordx4 v6, s[8:11], s41 offen offset:256 sc1 lds
    v_mfma_f32_16x16x32_bf16 v[52:55], a[112:115], v[76:79], v[52:55]
    s_add_u32 m0, s43, 11904
    ds_read_b128 v[96:99], v5 offset:22528
    v_max_f32 v20, v22, v23
    v_mfma_f32_16x16x32_bf16 v[60:63], a[116:119], v[76:79], v[60:63]
    v_mov_b32 v21, v20
    v_mfma_f32_16x16x32_bf16 v[64:67], a[116:119], v[80:83], v[64:67]
    s_waitcnt lgkmcnt(2)
    v_permlane16_swap_b32 v20, v21
    v_mfma_f32_16x16x32_bf16 v[44:47], a[120:123], v[84:87], v[44:47]
    ds_read_b128 v[68:71], v4 offset:24576
    v_max_f32 v20, v20, v21
    v_mfma_f32_16x16x32_bf16 v[48:51], a[120:123], v[88:91], v[48:51]
    v_mov_b32 v21, v20
    v_mfma_f32_16x16x32_bf16 v[56:59], a[124:127], v[88:91], v[56:59]
    buffer_load_dwordx4 v6, s[8:11], s41 offen offset:384 sc1 lds
    v_mfma_f32_16x16x32_bf16 v[52:55], a[124:127], v[84:87], v[52:55]
    s_add_u32 m0, s43, 15872
    ds_read_b128 v[72:75], v4 offset:26624
    v_mfma_f32_16x16x32_bf16 v[60:63], a[128:131], v[84:87], v[60:63]
    v_permlane32_swap_b32 v20, v21
    v_mfma_f32_16x16x32_bf16 v[64:67], a[128:131], v[88:91], v[64:67]
    s_waitcnt lgkmcnt(2)
    v_max_f32 v20, v20, v21
    v_mul_f32 v20, s86, v20
    v_mfma_f32_16x16x32_bf16 v[44:47], a[132:135], v[92:95], v[44:47]
    ds_read_b128 v[76:79], v5 offset:24576
    v_fma_f32 v22, v22, s86, -v20
    v_mfma_f32_16x16x32_bf16 v[48:51], a[132:135], v[96:99], v[48:51]
    v_fma_f32 v23, v23, s86, -v20
    v_mfma_f32_16x16x32_bf16 v[56:59], a[136:139], v[96:99], v[56:59]
    buffer_load_dwordx4 v6, s[8:11], s41 offen offset:512 sc1 lds
    v_mfma_f32_16x16x32_bf16 v[52:55], a[136:139], v[92:95], v[52:55]
    s_add_u32 m0, s43, 19840
    ds_read_b128 v[80:83], v5 offset:26624
    v_mfma_f32_16x16x32_bf16 v[60:63], a[140:143], v[92:95], v[60:63]
    v_exp_f32 v22, v22
    v_mfma_f32_16x16x32_bf16 v[64:67], a[140:143], v[96:99], v[64:67]
    s_waitcnt lgkmcnt(2)
    v_exp_f32 v23, v23
    v_mfma_f32_16x16x32_bf16 v[44:47], a[144:147], v[68:71], v[44:47]
    ds_read_b128 v[84:87], v4 offset:28672
    v_cvt_pk_bf16_f32 v28, v22, v23
    v_mfma_f32_16x16x32_bf16 v[48:51], a[144:147], v[72:75], v[48:51]
    v_perm_b32 v24, v28, v28, v14
    v_perm_b32 v25, v28, v28, v15
    v_mfma_f32_16x16x32_bf16 v[56:59], a[148:151], v[72:75], v[56:59]
    buffer_load_dwordx4 v6, s[8:11], s41 offen offset:640 sc1 lds
    v_mfma_f32_16x16x32_bf16 v[52:55], a[148:151], v[68:71], v[52:55]
    s_add_u32 m0, s43, 23808
    ds_read_b128 v[88:91], v4 offset:30720
    v_perm_b32 v26, v28, v28, v16
    v_mfma_f32_16x16x32_bf16 v[60:63], a[152:155], v[68:71], v[60:63]
    v_perm_b32 v27, v28, v28, v17
    v_add_f32 v20, v22, v23
    v_mfma_f32_16x16x32_bf16 v[64:67], a[152:155], v[72:75], v[64:67]
    s_waitcnt lgkmcnt(2)
    v_mov_b32 v21, v20
    s_waitcnt lgkmcnt(9)
    v_mfma_f32_16x16x32_bf16 v[44:47], a[156:159], v[76:79], v[44:47]
    ds_read_b128 v[92:95], v5 offset:28672
    v_mfma_f32_16x16x32_bf16 v[40:43], v[32:35], v[24:27], 0
    v_mfma_f32_16x16x32_bf16 v[118:121], v[36:39], v[24:27], 0
    v_permlane16_swap_b32 v20, v21
    v_mfma_f32_16x16x32_bf16 v[48:51], a[156:159], v[80:83], v[48:51]
    v_add_f32 v20, v20, v21
    v_mov_b32 v21, v20
    v_mfma_f32_16x16x32_bf16 v[56:59], a[160:163], v[80:83], v[56:59]
    buffer_load_dwordx4 v6, s[8:11], s41 offen offset:768 sc1 lds
    v_mfma_f32_16x16x32_bf16 v[52:55], a[160:163], v[76:79], v[52:55]
    s_add_u32 m0, s43, 27776
    ds_read_b128 v[96:99], v5 offset:30720
    v_mfma_f32_16x16x32_bf16 v[60:63], a[164:167], v[76:79], v[60:63]
    v_permlane32_swap_b32 v20, v21
    v_mfma_f32_16x16x32_bf16 v[64:67], a[164:167], v[80:83], v[64:67]
    s_waitcnt lgkmcnt(2)
    v_add_f32 v20, v20, v21
    v_mfma_f32_16x16x32_bf16 v[44:47], a[168:171], v[84:87], v[44:47]
    ds_read_b128 v[68:71], v4 offset:32768
    v_mfma_f32_16x16x32_bf16 v[48:51], a[168:171], v[88:91], v[48:51]
    v_rcp_f32 v20, v20
    v_mfma_f32_16x16x32_bf16 v[56:59], a[172:175], v[88:91], v[56:59]
    buffer_load_dwordx4 v6, s[8:11], s41 offen offset:896 sc1 lds
    v_mfma_f32_16x16x32_bf16 v[52:55], a[172:175], v[84:87], v[52:55]
    s_add_u32 m0, s43, 31744
    ds_read_b128 v[72:75], v4 offset:34816
    v_mul_f32 v40, v40, v20
    v_mfma_f32_16x16x32_bf16 v[60:63], a[176:179], v[84:87], v[60:63]
    v_mul_f32 v41, v41, v20
    v_mul_f32 v42, v42, v20
    v_mfma_f32_16x16x32_bf16 v[64:67], a[176:179], v[88:91], v[64:67]
    s_waitcnt lgkmcnt(2)
    v_mul_f32 v43, v43, v20
    v_cvt_pk_bf16_f32 v28, v40, v41
    v_mfma_f32_16x16x32_bf16 v[44:47], a[180:183], v[92:95], v[44:47]
    ds_read_b128 v[76:79], v5 offset:32768
    v_cvt_pk_bf16_f32 v29, v42, v43
    v_mfma_f32_16x16x32_bf16 v[48:51], a[180:183], v[96:99], v[48:51]
    v_mul_f32 v118, v118, v20
    v_mul_f32 v119, v119, v20
    v_mfma_f32_16x16x32_bf16 v[56:59], a[184:187], v[96:99], v[56:59]
    buffer_load_dwordx4 v6, s[8:11], s41 offen offset:1024 sc1 lds
    v_mfma_f32_16x16x32_bf16 v[52:55], a[184:187], v[92:95], v[52:55]
    s_add_u32 m0, s43, 35712
    ds_read_b128 v[80:83], v5 offset:34816
    v_mul_f32 v120, v120, v20
    v_mfma_f32_16x16x32_bf16 v[60:63], a[188:191], v[92:95], v[60:63]
    v_mul_f32 v121, v121, v20
    v_cvt_pk_bf16_f32 v30, v118, v119
    v_mfma_f32_16x16x32_bf16 v[64:67], a[188:191], v[96:99], v[64:67]
    s_waitcnt lgkmcnt(2)
    v_cvt_pk_bf16_f32 v31, v120, v121
    v_mfma_f32_16x16x32_bf16 v[44:47], a[192:195], v[68:71], v[44:47]
    ds_read_b128 v[84:87], v4 offset:36864
    v_mfma_f32_16x16x32_bf16 v[48:51], a[192:195], v[72:75], v[48:51]
    buffer_store_dwordx4 v[28:31], v1, s[16:19], s44 offen sc1
    v_mfma_f32_16x16x32_bf16 v[56:59], a[196:199], v[72:75], v[56:59]
    buffer_load_dwordx4 v6, s[8:11], s41 offen offset:1152 sc1 lds
    v_mfma_f32_16x16x32_bf16 v[52:55], a[196:199], v[68:71], v[52:55]
    s_add_u32 m0, s43, 39680
    ds_read_b128 v[88:91], v4 offset:38912
    s_cmp_eq_u32 s36, 17
    v_mfma_f32_16x16x32_bf16 v[60:63], a[200:203], v[68:71], v[60:63]
    s_cselect_b32 s49, s87, 0x10000
    ds_read_b64 v[32:33], v13 offset:2048
    s_add_u32 s90, s90, s49
    v_mfma_f32_16x16x32_bf16 v[64:67], a[200:203], v[72:75], v[64:67]
    s_waitcnt lgkmcnt(3)
    ds_read_b64 v[34:35], v13 offset:2176
    s_and_b32 s49, s90, 0xffffffff
    v_mfma_f32_16x16x32_bf16 v[44:47], a[204:207], v[76:79], v[44:47]
    s_bitcmp1_b64 s[24:25], s36
    ds_read_b128 v[92:95], v5 offset:36864
    s_cselect_b32 s44, s49, 0x5e00000
    v_mfma_f32_16x16x32_bf16 v[48:51], a[204:207], v[80:83], v[48:51]
    s_bitcmp1_b64 s[26:27], s36
    ds_read_b64 v[36:37], v13 offset:2304
    s_cselect_b64 s[62:63], 0, -1
    v_mfma_f32_16x16x32_bf16 v[56:59], a[208:211], v[80:83], v[56:59]
    buffer_load_dwordx4 v6, s[8:11], s41 offen offset:1280 sc1 lds
    v_mfma_f32_16x16x32_bf16 v[52:55], a[208:211], v[76:79], v[52:55]
    s_add_u32 m0, s43, 43648
    ds_read_b128 v[96:99], v5 offset:38912
    v_mfma_f32_16x16x32_bf16 v[60:63], a[212:215], v[76:79], v[60:63]
    ds_read_b64 v[38:39], v13 offset:2432
    v_mfma_f32_16x16x32_bf16 v[64:67], a[212:215], v[80:83], v[64:67]
    s_waitcnt lgkmcnt(6)
    v_mfma_f32_16x16x32_bf16 v[44:47], a[216:219], v[84:87], v[44:47]
    ds_read_b128 v[68:71], v4 offset:40960
    v_mfma_f32_16x16x32_bf16 v[48:51], a[216:219], v[88:91], v[48:51]
    v_mfma_f32_16x16x32_bf16 v[56:59], a[220:223], v[88:91], v[56:59]
    buffer_load_dwordx4 v6, s[8:11], s41 offen offset:1408 sc1 lds
    v_mfma_f32_16x16x32_bf16 v[52:55], a[220:223], v[84:87], v[52:55]
    s_add_u32 m0, s43, 47616
    ds_read_b128 v[72:75], v4 offset:43008
    s_waitcnt lgkmcnt(2)
    v_mfma_f32_16x16x32_bf16 v[60:63], a[224:227], v[84:87], v[60:63]
    v_add_f32 v40, v36, v38
    v_add_f32 v41, v37, v39
    v_mfma_f32_16x16x32_bf16 v[64:67], a[224:227], v[88:91], v[64:67]
    s_waitcnt lgkmcnt(3)
    v_add_f32 v32, v32, v34
    v_add_f32 v33, v33, v35
    v_mfma_f32_16x16x32_bf16 v[44:47], a[228:231], v[92:95], v[44:47]
    ds_read_b128 v[76:79], v5 offset:40960
    v_add_f32 v32, v32, v40
    v_mfma_f32_16x16x32_bf16 v[48:51], a[228:231], v[96:99], v[48:51]
    v_add_f32 v33, v33, v41
    v_mov_b32 v40, v32
    v_mfma_f32_16x16x32_bf16 v[56:59], a[232:235], v[96:99], v[56:59]
    buffer_load_dwordx4 v6, s[8:11], s41 offen offset:1536 sc1 lds
    v_mfma_f32_16x16x32_bf16 v[52:55], a[232:235], v[92:95], v[52:55]
    s_add_u32 m0, s43, 51584
    ds_read_b128 v[80:83], v5 offset:43008
    v_mov_b32 v41, v33
    v_mfma_f32_16x16x32_bf16 v[60:63], a[236:239], v[92:95], v[60:63]
    v_permlane32_swap_b32 v32, v40
    v_mfma_f32_16x16x32_bf16 v[64:67], a[236:239], v[96:99], v[64:67]
    s_waitcnt lgkmcnt(2)
    v_permlane32_swap_b32 v33, v41
    v_mfma_f32_16x16x32_bf16 v[44:47], a[240:243], v[68:71], v[44:47]
    ds_read_b128 v[84:87], v4 offset:45056
    v_add_f32 v32, v32, v40
    v_mfma_f32_16x16x32_bf16 v[48:51], a[240:243], v[72:75], v[48:51]
    v_add_f32 v33, v33, v41
    v_mul_f32 v112, 0xba800000, v32
    v_mfma_f32_16x16x32_bf16 v[56:59], a[244:247], v[72:75], v[56:59]
    buffer_load_dwordx4 v6, s[8:11], s41 offen offset:1664 sc1 lds
    v_mfma_f32_16x16x32_bf16 v[52:55], a[244:247], v[68:71], v[52:55]
    s_add_u32 m0, s43, 55552
    ds_read_b128 v[88:91], v4 offset:47104
    v_mul_f32 v33, 0x3a800000, v33
    v_mfma_f32_16x16x32_bf16 v[60:63], a[248:251], v[68:71], v[60:63]
    v_fma_f32 v33, -v112, v112, v33
    v_mov_b32 v113, v112
    v_mfma_f32_16x16x32_bf16 v[64:67], a[248:251], v[72:75], v[64:67]
    s_waitcnt lgkmcnt(2)
    v_max_f32 v33, 0, v33
    v_add_f32 v33, 0x3727c5ac, v33
    v_mfma_f32_16x16x32_bf16 v[44:47], a[252:255], v[76:79], v[44:47]
    ds_read_b128 v[92:95], v5 offset:45056
    v_mfma_f32_16x16x32_bf16 v[48:51], a[252:255], v[80:83], v[48:51]
    v_rsq_f32 v114, v33
    v_mfma_f32_16x16x32_bf16 v[56:59], v[128:131], v[80:83], v[56:59]
    buffer_load_dwordx4 v6, s[8:11], s41 offen offset:1792 sc1 lds
    v_mfma_f32_16x16x32_bf16 v[52:55], v[128:131], v[76:79], v[52:55]
    s_add_u32 m0, s43, 59520
    ds_read_b128 v[96:99], v5 offset:47104
    v_mfma_f32_16x16x32_bf16 v[60:63], v[132:135], v[76:79], v[60:63]
    v_permlane16_swap_b32 v112, v113
    v_mfma_f32_16x16x32_bf16 v[64:67], v[132:135], v[80:83], v[64:67]
    s_waitcnt lgkmcnt(2)
    v_mov_b32 v115, v114
    v_fmac_f32 v48, v113, v100
    v_mfma_f32_16x16x32_bf16 v[44:47], v[136:139], v[84:87], v[44:47]
    ds_read_b128 v[68:71], v4 offset:49152
    v_fmac_f32 v52, v112, v104
    v_mfma_f32_16x16x32_bf16 v[48:51], v[136:139], v[88:91], v[48:51]
    v_permlane16_swap_b32 v114, v115
    v_mfma_f32_16x16x32_bf16 v[56:59], v[140:143], v[88:91], v[56:59]
    buffer_load_dwordx4 v6, s[8:11], s41 offen offset:1920 sc1 lds
    v_mfma_f32_16x16x32_bf16 v[52:55], v[140:143], v[84:87], v[52:55]
    s_add_u32 m0, s52, 90112
    ds_read_b128 v[72:75], v4 offset:51200
    v_fmac_f32 v44, v112, v100
    v_mfma_f32_16x16x32_bf16 v[60:63], v[144:147], v[84:87], v[60:63]
    v_fmac_f32 v45, v112, v101
    v_fmac_f32 v46, v112, v102
    v_mfma_f32_16x16x32_bf16 v[64:67], v[144:147], v[88:91], v[64:67]
    s_waitcnt lgkmcnt(2)
    v_fmac_f32 v49, v113, v101
    v_fmac_f32 v50, v113, v102
    v_mfma_f32_16x16x32_bf16 v[44:47], v[148:151], v[92:95], v[44:47]
    ds_read_b128 v[76:79], v5 offset:49152
    v_fmac_f32 v53, v112, v105
    v_mfma_f32_16x16x32_bf16 v[48:51], v[148:151], v[96:99], v[48:51]
    v_fmac_f32 v54, v112, v106
    v_fmac_f32 v55, v112, v107
    v_mfma_f32_16x16x32_bf16 v[56:59], v[152:155], v[96:99], v[56:59]
    buffer_load_dwordx4 v1, s[16:19], s46 offen sc1 lds
    v_mfma_f32_16x16x32_bf16 v[52:55], v[152:155], v[92:95], v[52:55]
    s_cmp_eq_u32 s36, s97
    ds_read_b128 v[80:83], v5 offset:51200
    v_med3_i32 v117, s45, 0, v12
    v_mfma_f32_16x16x32_bf16 v[60:63], v[156:159], v[92:95], v[60:63]
    s_cselect_b32 s47, 32, -2
    v_add_u32 v117, v117, v11
    v_fmac_f32 v47, v112, v103
    v_mfma_f32_16x16x32_bf16 v[64:67], v[156:159], v[96:99], v[64:67]
    s_waitcnt lgkmcnt(2)
    v_fmac_f32 v51, v113, v103
    v_fmac_f32 v56, v113, v104
    v_mfma_f32_16x16x32_bf16 v[44:47], v[160:163], v[68:71], v[44:47]
    s_cselect_b64 s[8:9], s[88:89], s[8:9]
    ds_read_b128 v[84:87], v4 offset:53248
    v_fmac_f32 v57, v113, v105
    v_mfma_f32_16x16x32_bf16 v[48:51], v[160:163], v[72:75], v[48:51]
    s_cselect_b32 s55, 0x543fc00, s55
    v_fmac_f32 v60, v112, v108
    v_fmac_f32 v61, v112, v109
    v_mfma_f32_16x16x32_bf16 v[56:59], v[164:167], v[72:75], v[56:59]
    s_add_u32 s45, s45, 65536
    v_fmac_f32 v62, v112, v110
    v_fmac_f32 v63, v112, v111
    v_mfma_f32_16x16x32_bf16 v[52:55], v[164:167], v[68:71], v[52:55]
    s_add_u32 s50, s50, s47
    ds_read_b128 v[88:91], v4 offset:55296
    v_fmac_f32 v64, v113, v108
    v_mfma_f32_16x16x32_bf16 v[60:63], v[168:171], v[68:71], v[60:63]
    buffer_load_dword v116, v117, s[16:19], 0 offen sc1
    v_mfma_f32_16x16x32_bf16 v[64:67], v[168:171], v[72:75], v[64:67]
    s_waitcnt lgkmcnt(2)
    v_fmac_f32 v58, v113, v106
    v_fmac_f32 v59, v113, v107
    v_mfma_f32_16x16x32_bf16 v[44:47], v[172:175], v[76:79], v[44:47]
    s_max_i32 s47, s50, 0
    ds_read_b128 v[92:95], v5 offset:53248
    s_min_i32 s47, s47, s96
    v_mfma_f32_16x16x32_bf16 v[48:51], v[172:175], v[80:83], v[48:51]
    s_lshl_b32 s41, s47, 15
    v_fmac_f32 v65, v113, v109
    v_fmac_f32 v66, v113, v110
    v_mfma_f32_16x16x32_bf16 v[56:59], v[176:179], v[80:83], v[56:59]
    s_lshl_b32 s46, s47, 10
    v_fmac_f32 v67, v113, v111
    s_sub_u32 s46, s55, s46
    v_mfma_f32_16x16x32_bf16 v[52:55], v[176:179], v[76:79], v[52:55]
    ds_read_b128 v[96:99], v5 offset:55296
    v_mfma_f32_16x16x32_bf16 v[60:63], v[180:183], v[76:79], v[60:63]
    v_mfma_f32_16x16x32_bf16 v[64:67], v[180:183], v[80:83], v[64:67]
    s_waitcnt lgkmcnt(2)
    v_mfma_f32_16x16x32_bf16 v[44:47], v[184:187], v[84:87], v[44:47]
    ds_read_b128 v[68:71], v4 offset:57344
    v_mfma_f32_16x16x32_bf16 v[48:51], v[184:187], v[88:91], v[48:51]
    v_mfma_f32_16x16x32_bf16 v[56:59], v[188:191], v[88:91], v[56:59]
    v_mfma_f32_16x16x32_bf16 v[52:55], v[188:191], v[84:87], v[52:55]
    ds_read_b128 v[72:75], v4 offset:59392
    v_mfma_f32_16x16x32_bf16 v[60:63], v[192:195], v[84:87], v[60:63]
    v_mfma_f32_16x16x32_bf16 v[64:67], v[192:195], v[88:91], v[64:67]
    s_waitcnt lgkmcnt(2)
    v_mfma_f32_16x16x32_bf16 v[44:47], v[196:199], v[92:95], v[44:47]
    ds_read_b128 v[76:79], v5 offset:57344
    v_mfma_f32_16x16x32_bf16 v[48:51], v[196:199], v[96:99], v[48:51]
    v_mfma_f32_16x16x32_bf16 v[56:59], v[200:203], v[96:99], v[56:59]
    v_mfma_f32_16x16x32_bf16 v[52:55], v[200:203], v[92:95], v[52:55]
    ds_read_b128 v[80:83], v5 offset:59392
    v_mfma_f32_16x16x32_bf16 v[60:63], v[204:207], v[92:95], v[60:63]
    s_waitcnt vmcnt(9)
    s_barrier
    v_mfma_f32_16x16x32_bf16 v[64:67], v[204:207], v[96:99], v[64:67]
    s_waitcnt lgkmcnt(2)
    v_mfma_f32_16x16x32_bf16 v[44:47], v[208:211], v[68:71], v[44:47]
    ds_read_b128 v[84:87], v4 offset:61440
    v_mfma_f32_16x16x32_bf16 v[48:51], v[208:211], v[72:75], v[48:51]
    buffer_store_dword v124, v124, s[16:19], s91 offen sc1
    v_mfma_f32_16x16x32_bf16 v[56:59], v[212:215], v[72:75], v[56:59]
    s_add_u32 s91, s91, 65536
    v_mfma_f32_16x16x32_bf16 v[52:55], v[212:215], v[68:71], v[52:55]
    ds_read_b128 v[88:91], v4 offset:63488
    v_mfma_f32_16x16x32_bf16 v[60:63], v[216:219], v[68:71], v[60:63]
    v_mfma_f32_16x16x32_bf16 v[64:67], v[216:219], v[72:75], v[64:67]
    s_waitcnt lgkmcnt(2)
    v_mfma_f32_16x16x32_bf16 v[44:47], v[220:223], v[76:79], v[44:47]
    ds_read_b128 v[92:95], v5 offset:61440
    v_mfma_f32_16x16x32_bf16 v[48:51], v[220:223], v[80:83], v[48:51]
    v_mfma_f32_16x16x32_bf16 v[56:59], v[224:227], v[80:83], v[56:59]
    v_mfma_f32_16x16x32_bf16 v[52:55], v[224:227], v[76:79], v[52:55]
    ds_read_b128 v[96:99], v5 offset:63488
    v_mfma_f32_16x16x32_bf16 v[60:63], v[228:231], v[76:79], v[60:63]
    v_mfma_f32_16x16x32_bf16 v[64:67], v[228:231], v[80:83], v[64:67]
    s_waitcnt lgkmcnt(2)
    v_mfma_f32_16x16x32_bf16 v[44:47], v[232:235], v[84:87], v[44:47]
    ds_read_b128 v[68:71], v2 offset:0
    v_mfma_f32_16x16x32_bf16 v[48:51], v[232:235], v[88:91], v[48:51]
    v_mfma_f32_16x16x32_bf16 v[56:59], v[236:239], v[88:91], v[56:59]
    v_mfma_f32_16x16x32_bf16 v[52:55], v[236:239], v[84:87], v[52:55]
    ds_read_b128 v[72:75], v2 offset:2048
    v_mfma_f32_16x16x32_bf16 v[60:63], v[240:243], v[84:87], v[60:63]
    v_mfma_f32_16x16x32_bf16 v[64:67], v[240:243], v[88:91], v[64:67]
    s_waitcnt lgkmcnt(2)
    v_mfma_f32_16x16x32_bf16 v[44:47], v[244:247], v[92:95], v[44:47]
    ds_read_b128 v[76:79], v3 offset:0
    v_mfma_f32_16x16x32_bf16 v[48:51], v[244:247], v[96:99], v[48:51]
    v_mfma_f32_16x16x32_bf16 v[56:59], v[248:251], v[96:99], v[56:59]
    v_mfma_f32_16x16x32_bf16 v[52:55], v[248:251], v[92:95], v[52:55]
    ds_read_b128 v[80:83], v3 offset:2048
    v_mfma_f32_16x16x32_bf16 v[60:63], v[252:255], v[92:95], v[60:63]
    s_add_u32 s36, s36, 1
    v_mfma_f32_16x16x32_bf16 v[64:67], v[252:255], v[96:99], v[64:67]
    s_waitcnt lgkmcnt(2)
    s_cmp_lt_u32 s36, 33
    s_cbranch_scc1 L_q_b0
    s_nop 7
    v_mul_f32 v44, v44, v114
    v_mul_f32 v45, v45, v114
    v_mul_f32 v46, v46, v114
    v_mul_f32 v47, v47, v114
    v_cvt_pk_bf16_f32 v44, v44, v45
    v_cvt_pk_bf16_f32 v45, v46, v47
    ds_write_b64 v7, v[44:45] offset:12288
    v_mul_f32 v48, v48, v115
    v_mul_f32 v49, v49, v115
    v_mul_f32 v50, v50, v115
    v_mul_f32 v51, v51, v115
    v_cvt_pk_bf16_f32 v48, v48, v49
    v_cvt_pk_bf16_f32 v49, v50, v51
    ds_write_b64 v7, v[48:49] offset:18432
    v_mul_f32 v52, v52, v114
    v_mul_f32 v53, v53, v114
    v_mul_f32 v54, v54, v114
    v_mul_f32 v55, v55, v114
    v_cvt_pk_bf16_f32 v52, v52, v53
    v_cvt_pk_bf16_f32 v53, v54, v55
    ds_write_b64 v7, v[52:53] offset:13312
    v_mul_f32 v56, v56, v115
    v_mul_f32 v57, v57, v115
    v_mul_f32 v58, v58, v115
    v_mul_f32 v59, v59, v115
    v_cvt_pk_bf16_f32 v56, v56, v57
    v_cvt_pk_bf16_f32 v57, v58, v59
    ds_write_b64 v7, v[56:57] offset:19456
    v_mul_f32 v60, v60, v114
    v_mul_f32 v61, v61, v114
    v_mul_f32 v62, v62, v114
    v_mul_f32 v63, v63, v114
    v_cvt_pk_bf16_f32 v60, v60, v61
    v_cvt_pk_bf16_f32 v61, v62, v63
    ds_write_b64 v8, v[60:61] offset:14336
    v_mul_f32 v64, v64, v115
    v_mul_f32 v65, v65, v115
    v_mul_f32 v66, v66, v115
    v_mul_f32 v67, v67, v115
    v_cvt_pk_bf16_f32 v64, v64, v65
    v_cvt_pk_bf16_f32 v65, v66, v67
    ds_write_b64 v8, v[64:65] offset:20480
    s_waitcnt lgkmcnt(0)
    s_barrier
    ds_read_b128 v[44:47], v9 offset:6144
    ds_read_b128 v[48:51], v9 offset:13312
    ds_read_b128 v[52:55], v9 offset:7168
    ds_read_b64_tr_b16 v[56:57], v9 offset:14336
    ds_read_b64_tr_b16 v[58:59], v9 offset:8192
    ds_read_b64_tr_b16 v[60:61], v9 offset:14344
    ds_read_b64_tr_b16 v[62:63], v9 offset:8200
    s_waitcnt lgkmcnt(4)
    v_mfma_f32_16x16x32_bf16 v[64:67], v[48:51], v[44:47], 0
    v_mfma_f32_16x16x32_bf16 v[118:121], v[52:55], v[44:47], 0
    s_nop 5
    v_cndmask_b32 v64, v64, v65, s[56:57]
    v_cndmask_b32 v66, v66, v67, s[56:57]
    v_cndmask_b32 v118, v118, v119, s[56:57]
    v_cndmask_b32 v120, v120, v121, s[56:57]
    v_cndmask_b32 v64, v18, v64, s[62:63]
    v_cndmask_b32 v66, v18, v66, s[62:63]
    v_cndmask_b32 v46, v64, v118, s[58:59]
    v_cndmask_b32 v47, v66, v120, s[60:61]
    v_max_f32 v44, v46, v47
    v_mov_b32 v45, v44
    s_nop 1
    v_permlane16_swap_b32 v44, v45
    v_max_f32 v44, v44, v45
    v_mov_b32 v45, v44
    s_nop 1
    v_permlane32_swap_b32 v44, v45
    v_max_f32 v44, v44, v45
    v_mul_f32 v44, s86, v44
    v_fma_f32 v46, v46, s86, -v44
    v_fma_f32 v47, v47, s86, -v44
    v_exp_f32 v46, v46
    v_exp_f32 v47, v47
    s_nop 0
    v_cvt_pk_bf16_f32 v52, v46, v47
    v_perm_b32 v48, v52, v52, v14
    v_perm_b32 v49, v52, v52, v15
    v_perm_b32 v50, v52, v52, v16
    v_perm_b32 v51, v52, v52, v17
    s_waitcnt lgkmcnt(0)
    v_add_f32 v44, v46, v47
    v_mfma_f32_16x16x32_bf16 v[64:67], v[56:59], v[48:51], 0
    v_mfma_f32_16x16x32_bf16 v[118:121], v[60:63], v[48:51], 0
    v_mov_b32 v45, v44
    s_nop 1
    v_permlane16_swap_b32 v44, v45
    v_add_f32 v44, v44, v45
    v_mov_b32 v45, v44
    s_nop 1
    v_permlane32_swap_b32 v44, v45
    v_add_f32 v44, v44, v45
    v_rcp_f32 v44, v44
    s_nop 0
    v_mul_f32 v64, v64, v44
    v_mul_f32 v65, v65, v44
    v_mul_f32 v66, v66, v44
    v_mul_f32 v67, v67, v44
    v_cvt_pk_bf16_f32 v52, v64, v65
    v_cvt_pk_bf16_f32 v53, v66, v67
    v_mul_f32 v118, v118, v44
    v_mul_f32 v119, v119, v44
    v_mul_f32 v120, v120, v44
    v_mul_f32 v121, v121, v44
    v_cvt_pk_bf16_f32 v54, v118, v119
    v_cvt_pk_bf16_f32 v55, v120, v121
    buffer_store_dwordx4 v[52:55], v1, s[16:19], s44 offen sc1
    s_waitcnt vmcnt(0)
    s_barrier
    buffer_store_dword v124, v124, s[16:19], s91 offen sc1
    s_add_u32 s91, s91, 65536
    s_waitcnt vmcnt(0)
    s_endpgm
L_q_short:
    s_nop 5
    s_waitcnt lgkmcnt(2)
    v_mfma_f32_16x16x32_bf16 v[48:51], a[0:3], v[72:75], 0
    s_mov_b32 s39, 0x5e00000
    ds_read_b128 v[96:99], v5 offset:6144
    v_mul_f32 v20, v20, v114
    v_mfma_f32_16x16x32_bf16 v[56:59], a[4:7], v[72:75], 0
    ds_read_b128 v[88:91], v4 offset:6144
    v_mul_f32 v21, v21, v114
    v_mfma_f32_16x16x32_bf16 v[64:67], a[8:11], v[72:75], 0
    s_waitcnt lgkmcnt(2)
    v_mul_f32 v22, v22, v114
    v_mul_f32 v23, v23, v114
    v_mfma_f32_16x16x32_bf16 v[48:51], a[12:15], v[80:83], v[48:51]
    ds_read_b128 v[72:75], v4 offset:10240
    v_cvt_pk_bf16_f32 v20, v20, v21
    v_mfma_f32_16x16x32_bf16 v[56:59], a[16:19], v[80:83], v[56:59]
    v_cvt_pk_bf16_f32 v21, v22, v23
    ds_write_b64 v7, v[20:21] offset:0
    v_mfma_f32_16x16x32_bf16 v[64:67], a[20:23], v[80:83], v[64:67]
    s_waitcnt lgkmcnt(2)
    v_mul_f32 v24, v24, v115
    v_mul_f32 v25, v25, v115
    v_mfma_f32_16x16x32_bf16 v[48:51], a[24:27], v[88:91], v[48:51]
    ds_read_b128 v[80:83], v5 offset:10240
    v_mul_f32 v26, v26, v115
    v_mfma_f32_16x16x32_bf16 v[56:59], a[28:31], v[88:91], v[56:59]
    v_mul_f32 v27, v27, v115
    v_cvt_pk_bf16_f32 v24, v24, v25
    v_mfma_f32_16x16x32_bf16 v[64:67], a[32:35], v[88:91], v[64:67]
    s_waitcnt lgkmcnt(4)
    v_cvt_pk_bf16_f32 v25, v26, v27
    ds_write_b64 v7, v[24:25] offset:6144
    v_mfma_f32_16x16x32_bf16 v[48:51], a[36:39], v[96:99], v[48:51]
    ds_read_b128 v[88:91], v4 offset:14336
    v_mul_f32 v28, v28, v114
    v_mfma_f32_16x16x32_bf16 v[56:59], a[40:43], v[96:99], v[56:59]
    v_mul_f32 v29, v29, v114
    v_mul_f32 v30, v30, v114
    v_mfma_f32_16x16x32_bf16 v[64:67], a[44:47], v[96:99], v[64:67]
    s_waitcnt lgkmcnt(4)
    v_mul_f32 v31, v31, v114
    v_cvt_pk_bf16_f32 v28, v28, v29
    v_mfma_f32_16x16x32_bf16 v[48:51], a[48:51], v[72:75], v[48:51]
    ds_read_b128 v[96:99], v5 offset:14336
    v_cvt_pk_bf16_f32 v29, v30, v31
    v_mfma_f32_16x16x32_bf16 v[56:59], a[52:55], v[72:75], v[56:59]
    ds_write_b64 v7, v[28:29] offset:1024
    v_mfma_f32_16x16x32_bf16 v[64:67], a[56:59], v[72:75], v[64:67]
    s_waitcnt lgkmcnt(4)
    v_mul_f32 v32, v32, v115
    v_mul_f32 v33, v33, v115
    v_mfma_f32_16x16x32_bf16 v[48:51], a[60:63], v[80:83], v[48:51]
    ds_read_b128 v[72:75], v4 offset:18432
    v_mul_f32 v34, v34, v115
    v_mfma_f32_16x16x32_bf16 v[56:59], a[64:67], v[80:83], v[56:59]
    v_mul_f32 v35, v35, v115
    v_cvt_pk_bf16_f32 v32, v32, v33
    v_mfma_f32_16x16x32_bf16 v[64:67], a[68:71], v[80:83], v[64:67]
    s_waitcnt lgkmcnt(3)
    v_cvt_pk_bf16_f32 v33, v34, v35
    ds_write_b64 v7, v[32:33] offset:7168
    v_mfma_f32_16x16x32_bf16 v[48:51], a[72:75], v[88:91], v[48:51]
    ds_read_b128 v[80:83], v5 offset:18432
    v_mul_f32 v36, v36, v114
    v_mfma_f32_16x16x32_bf16 v[56:59], a[76:79], v[88:91], v[56:59]
    v_mul_f32 v37, v37, v114
    v_mul_f32 v38, v38, v114
    v_mfma_f32_16x16x32_bf16 v[64:67], a[80:83], v[88:91], v[64:67]
    s_waitcnt lgkmcnt(4)
    v_mul_f32 v39, v39, v114
    v_cvt_pk_bf16_f32 v36, v36, v37
    v_mfma_f32_16x16x32_bf16 v[48:51], a[84:87], v[96:99], v[48:51]
    s_waitcnt vmcnt(1)
    ds_read_b128 v[88:91], v4 offset:22528
    v_cmp_ne_u32 vcc, 0, v116
    v_mfma_f32_16x16x32_bf16 v[56:59], a[88:91], v[96:99], v[56:59]
    v_cvt_pk_bf16_f32 v37, v38, v39
    ds_write_b64 v8, v[36:37] offset:2048
    v_mfma_f32_16x16x32_bf16 v[64:67], a[92:95], v[96:99], v[64:67]
    s_waitcnt lgkmcnt(4)
    v_mul_f32 v40, v40, v115
    v_mul_f32 v41, v41, v115
    v_mfma_f32_16x16x32_bf16 v[48:51], a[96:99], v[72:75], v[48:51]
    s_cbranch_vccnz L_spin7
L_back8:
    ds_read_b128 v[96:99], v5 offset:22528
    v_mul_f32 v42, v42, v115
    v_mfma_f32_16x16x32_bf16 v[56:59], a[100:103], v[72:75], v[56:59]
    v_mul_f32 v43, v43, v115
    v_cvt_pk_bf16_f32 v40, v40, v41
    v_mfma_f32_16x16x32_bf16 v[64:67], a[104:107], v[72:75], v[64:67]
    s_waitcnt lgkmcnt(3)
    v_cvt_pk_bf16_f32 v41, v42, v43
    ds_write_b64 v8, v[40:41] offset:8192
    v_mfma_f32_16x16x32_bf16 v[48:51], a[108:111], v[80:83], v[48:51]
    ds_read_b128 v[72:75], v4 offset:26624
    v_mfma_f32_16x16x32_bf16 v[56:59], a[112:115], v[80:83], v[56:59]
    v_mfma_f32_16x16x32_bf16 v[64:67], a[116:119], v[80:83], v[64:67]
    s_waitcnt lgkmcnt(4)
    s_waitcnt lgkmcnt(1)
    s_barrier
    v_mfma_f32_16x16x32_bf16 v[48:51], a[120:123], v[88:91], v[48:51]
    s_add_u32 m0, s43, 0
    ds_read_b128 v[80:83], v5 offset:26624
    buffer_load_dwordx4 v6, s[8:11], s41 offen offset:0 sc1 lds
    v_mfma_f32_16x16x32_bf16 v[56:59], a[124:127], v[88:91], v[56:59]
    s_add_u32 m0, s43, 3968
    ds_read_b128 v[20:23], v10 offset:0
    ds_read_b128 v[24:27], v9 offset:1024
    v_mfma_f32_16x16x32_bf16 v[64:67], a[128:131], v[88:91], v[64:67]
    s_waitcnt lgkmcnt(5)
    ds_read_b128 v[28:31], v10 offset:1024
    ds_read_b64_tr_b16 v[32:33], v9 offset:2048
    v_mfma_f32_16x16x32_bf16 v[48:51], a[132:135], v[96:99], v[48:51]
    ds_read_b128 v[88:91], v4 offset:30720
    buffer_load_dwordx4 v6, s[8:11], s41 offen offset:128 sc1 lds
    v_mfma_f32_16x16x32_bf16 v[56:59], a[136:139], v[96:99], v[56:59]
    s_add_u32 m0, s43, 7936
    ds_read_b64_tr_b16 v[34:35], v10 offset:2048
    ds_read_b64_tr_b16 v[36:37], v9 offset:2056
    v_mfma_f32_16x16x32_bf16 v[64:67], a[140:143], v[96:99], v[64:67]
    s_waitcnt lgkmcnt(8)
    ds_read_b64_tr_b16 v[38:39], v10 offset:2056
    ds_read_b64 v[44:45], v13 offset:2048
    v_mfma_f32_16x16x32_bf16 v[48:51], a[144:147], v[72:75], v[48:51]
    s_waitcnt lgkmcnt(6)
    ds_read_b128 v[96:99], v5 offset:30720
    buffer_load_dwordx4 v6, s[8:11], s41 offen offset:256 sc1 lds
    v_mfma_f32_16x16x32_bf16 v[56:59], a[148:151], v[72:75], v[56:59]
    v_mfma_f32_16x16x32_bf16 v[40:43], v[24:27], v[20:23], 0
    v_mfma_f32_16x16x32_bf16 v[118:121], v[28:31], v[20:23], 0
    s_add_u32 m0, s43, 11904
    ds_read_b64 v[46:47], v13 offset:2176
    ds_read_b64 v[52:53], v13 offset:2304
    v_mfma_f32_16x16x32_bf16 v[64:67], a[152:155], v[72:75], v[64:67]
    s_waitcnt lgkmcnt(12)
    v_cndmask_b32 v40, v40, v41, s[56:57]
    v_cndmask_b32 v42, v42, v43, s[56:57]
    v_mfma_f32_16x16x32_bf16 v[48:51], a[156:159], v[80:83], v[48:51]
    ds_read_b128 v[72:75], v4 offset:34816
    buffer_load_dwordx4 v6, s[8:11], s41 offen offset:384 sc1 lds
    v_mfma_f32_16x16x32_bf16 v[56:59], a[160:163], v[80:83], v[56:59]
    s_add_u32 m0, s43, 15872
    v_cndmask_b32 v118, v118, v119, s[56:57]
    v_cndmask_b32 v120, v120, v121, s[56:57]
    v_mfma_f32_16x16x32_bf16 v[64:67], a[164:167], v[80:83], v[64:67]
    s_waitcnt lgkmcnt(8)
    v_cndmask_b32 v40, v18, v40, s[62:63]
    v_cndmask_b32 v42, v18, v42, s[62:63]
    v_mfma_f32_16x16x32_bf16 v[48:51], a[168:171], v[88:91], v[48:51]
    ds_read_b128 v[80:83], v5 offset:34816
    buffer_load_dwordx4 v6, s[8:11], s41 offen offset:512 sc1 lds
    v_mfma_f32_16x16x32_bf16 v[56:59], a[172:175], v[88:91], v[56:59]
    s_add_u32 m0, s43, 19840
    v_cndmask_b32 v22, v40, v118, s[58:59]
    v_cndmask_b32 v23, v42, v120, s[60:61]
    v_mfma_f32_16x16x32_bf16 v[64:67], a[176:179], v[88:91], v[64:67]
    s_waitcnt lgkmcnt(4)
    v_max_f32 v20, v22, v23
    v_mov_b32 v21, v20
    v_mfma_f32_16x16x32_bf16 v[48:51], a[180:183], v[96:99], v[48:51]
    ds_read_b128 v[88:91], v4 offset:38912
    buffer_load_dwordx4 v6, s[8:11], s41 offen offset:640 sc1 lds
    v_mfma_f32_16x16x32_bf16 v[56:59], a[184:187], v[96:99], v[56:59]
    s_add_u32 m0, s43, 23808
    v_permlane16_swap_b32 v20, v21
    v_mfma_f32_16x16x32_bf16 v[64:67], a[188:191], v[96:99], v[64:67]
    s_waitcnt lgkmcnt(2)
    v_max_f32 v20, v20, v21
    v_mov_b32 v21, v20
    v_mfma_f32_16x16x32_bf16 v[48:51], a[192:195], v[72:75], v[48:51]
    ds_read_b128 v[96:99], v5 offset:38912
    buffer_load_dwordx4 v6, s[8:11], s41 offen offset:768 sc1 lds
    v_mfma_f32_16x16x32_bf16 v[56:59], a[196:199], v[72:75], v[56:59]
    s_add_u32 m0, s43, 27776
    v_permlane32_swap_b32 v20, v21
    v_mfma_f32_16x16x32_bf16 v[64:67], a[200:203], v[72:75], v[64:67]
    s_waitcnt lgkmcnt(2)
    v_max_f32 v20, v20, v21
    v_mul_f32 v20, s86, v20
    v_mfma_f32_16x16x32_bf16 v[48:51], a[204:207], v[80:83], v[48:51]
    ds_read_b128 v[72:75], v4 offset:43008
    buffer_load_dwordx4 v6, s[8:11], s41 offen offset:896 sc1 lds
    v_mfma_f32_16x16x32_bf16 v[56:59], a[208:211], v[80:83], v[56:59]
    s_add_u32 m0, s43, 31744
    v_fma_f32 v22, v22, s86, -v20
    v_fma_f32 v23, v23, s86, -v20
    v_mfma_f32_16x16x32_bf16 v[64:67], a[212:215], v[80:83], v[64:67]
    s_waitcnt lgkmcnt(2)
    v_exp_f32 v22, v22
    v_mfma_f32_16x16x32_bf16 v[48:51], a[216:219], v[88:91], v[48:51]
    ds_read_b128 v[80:83], v5 offset:43008
    buffer_load_dwordx4 v6, s[8:11], s41 offen offset:1024 sc1 lds
    v_mfma_f32_16x16x32_bf16 v[56:59], a[220:223], v[88:91], v[56:59]
    s_add_u32 m0, s43, 35712
    v_exp_f32 v23, v23
    v_mfma_f32_16x16x32_bf16 v[64:67], a[224:227], v[88:91], v[64:67]
    s_waitcnt lgkmcnt(2)
    v_cvt_pk_bf16_f32 v28, v22, v23
    v_perm_b32 v24, v28, v28, v14
    v_mfma_f32_16x16x32_bf16 v[48:51], a[228:231], v[96:99], v[48:51]
    ds_read_b128 v[88:91], v4 offset:47104
    buffer_load_dwordx4 v6, s[8:11], s41 offen offset:1152 sc1 lds
    v_mfma_f32_16x16x32_bf16 v[56:59], a[232:235], v[96:99], v[56:59]
    s_add_u32 m0, s43, 39680
    v_perm_b32 v25, v28, v28, v15
    v_perm_b32 v26, v28, v28, v16
    v_mfma_f32_16x16x32_bf16 v[64:67], a[236:239], v[96:99], v[64:67]
    s_waitcnt lgkmcnt(2)
    v_perm_b32 v27, v28, v28, v17
    v_add_f32 v20, v22, v23
    v_mfma_f32_16x16x32_bf16 v[48:51], a[240:243], v[72:75], v[48:51]
    s_waitcnt lgkmcnt(11)
    ds_read_b128 v[96:99], v5 offset:47104
    buffer_load_dwordx4 v6, s[8:11], s41 offen offset:1280 sc1 lds
    v_mfma_f32_16x16x32_bf16 v[56:59], a[244:247], v[72:75], v[56:59]
    v_mfma_f32_16x16x32_bf16 v[40:43], v[32:35], v[24:27], 0
    v_mfma_f32_16x16x32_bf16 v[118:121], v[36:39], v[24:27], 0
    s_add_u32 m0, s43, 43648
    v_mov_b32 v21, v20
    ds_read_b64 v[54:55], v13 offset:2432
    v_mfma_f32_16x16x32_bf16 v[64:67], a[248:251], v[72:75], v[64:67]
    s_waitcnt lgkmcnt(3)
    v_permlane16_swap_b32 v20, v21
    v_mfma_f32_16x16x32_bf16 v[48:51], a[252:255], v[80:83], v[48:51]
    ds_read_b128 v[72:75], v4 offset:51200
    buffer_load_dwordx4 v6, s[8:11], s41 offen offset:1408 sc1 lds
    v_mfma_f32_16x16x32_bf16 v[56:59], v[128:131], v[80:83], v[56:59]
    s_add_u32 m0, s43, 47616
    v_add_f32 v20, v20, v21
    v_mov_b32 v21, v20
    v_mfma_f32_16x16x32_bf16 v[64:67], v[132:135], v[80:83], v[64:67]
    s_waitcnt lgkmcnt(3)
    v_permlane32_swap_b32 v20, v21
    v_mfma_f32_16x16x32_bf16 v[48:51], v[136:139], v[88:91], v[48:51]
    s_waitcnt lgkmcnt(1)
    ds_read_b128 v[80:83], v5 offset:51200
    buffer_load_dwordx4 v6, s[8:11], s41 offen offset:1536 sc1 lds
    v_mfma_f32_16x16x32_bf16 v[56:59], v[140:143], v[88:91], v[56:59]
    s_add_u32 m0, s43, 51584
    v_add_f32 v20, v20, v21
    v_rcp_f32 v20, v20
    v_mfma_f32_16x16x32_bf16 v[64:67], v[144:147], v[88:91], v[64:67]
    s_waitcnt lgkmcnt(3)
    v_mul_f32 v40, v40, v20
    v_mul_f32 v41, v41, v20
    v_mfma_f32_16x16x32_bf16 v[48:51], v[148:151], v[96:99], v[48:51]
    ds_read_b128 v[88:91], v4 offset:55296
    buffer_load_dwordx4 v6, s[8:11], s41 offen offset:1664 sc1 lds
    v_mfma_f32_16x16x32_bf16 v[56:59], v[152:155], v[96:99], v[56:59]
    s_add_u32 m0, s43, 55552
    v_mul_f32 v42, v42, v20
    v_mul_f32 v43, v43, v20
    v_mfma_f32_16x16x32_bf16 v[64:67], v[156:159], v[96:99], v[64:67]
    s_waitcnt lgkmcnt(2)
    v_cvt_pk_bf16_f32 v28, v40, v41
    v_cvt_pk_bf16_f32 v29, v42, v43
    v_mfma_f32_16x16x32_bf16 v[48:51], v[160:163], v[72:75], v[48:51]
    ds_read_b128 v[96:99], v5 offset:55296
    buffer_load_dwordx4 v6, s[8:11], s41 offen offset:1792 sc1 lds
    v_mfma_f32_16x16x32_bf16 v[56:59], v[164:167], v[72:75], v[56:59]
    s_add_u32 m0, s43, 59520
    v_mul_f32 v118, v118, v20
    v_mul_f32 v119, v119, v20
    v_mfma_f32_16x16x32_bf16 v[64:67], v[168:171], v[72:75], v[64:67]
    s_waitcnt lgkmcnt(2)
    v_mul_f32 v120, v120, v20
    v_mul_f32 v121, v121, v20
    v_mfma_f32_16x16x32_bf16 v[48:51], v[172:175], v[80:83], v[48:51]
    ds_read_b128 v[72:75], v4 offset:59392
    buffer_load_dwordx4 v6, s[8:11], s41 offen offset:1920 sc1 lds
    v_mfma_f32_16x16x32_bf16 v[56:59], v[176:179], v[80:83], v[56:59]
    s_add_u32 m0, s52, 90112
    v_cvt_pk_bf16_f32 v30, v118, v119
    v_cvt_pk_bf16_f32 v31, v120, v121
    v_mfma_f32_16x16x32_bf16 v[64:67], v[180:183], v[80:83], v[64:67]
    s_waitcnt lgkmcnt(2)
    buffer_store_dwordx4 v[28:31], v1, s[16:19], s44 offen sc1
    v_mfma_f32_16x16x32_bf16 v[48:51], v[184:187], v[88:91], v[48:51]
    s_cmp_eq_u32 s36, 17
    ds_read_b128 v[80:83], v5 offset:59392
    buffer_load_dwordx4 v1, s[16:19], s46 offen sc1 lds
    v_mfma_f32_16x16x32_bf16 v[56:59], v[188:191], v[88:91], v[56:59]
    s_cselect_b32 s49, s87, 0x10000
    v_med3_i32 v117, s45, 0, v12
    v_add_u32 v117, v117, v11
    v_mfma_f32_16x16x32_bf16 v[64:67], v[192:195], v[88:91], v[64:67]
    s_waitcnt lgkmcnt(2)
    v_add_f32 v60, v52, v54
    v_add_f32 v61, v53, v55
    v_mfma_f32_16x16x32_bf16 v[48:51], v[196:199], v[96:99], v[48:51]
    s_add_u32 s45, s45, 65536
    ds_read_b128 v[88:91], v4 offset:63488
    buffer_load_dword v116, v117, s[16:19], 0 offen sc1
    v_mfma_f32_16x16x32_bf16 v[56:59], v[200:203], v[96:99], v[56:59]
    buffer_store_dword v124, v124, s[16:19], s39 offen sc1
    v_mfma_f32_16x16x32_bf16 v[64:67], v[204:207], v[96:99], v[64:67]
    s_waitcnt lgkmcnt(2)
    v_add_f32 v44, v44, v46
    v_add_f32 v45, v45, v47
    v_mfma_f32_16x16x32_bf16 v[48:51], v[208:211], v[72:75], v[48:51]
    s_add_u32 s90, s90, s49
    ds_read_b128 v[96:99], v5 offset:63488
    v_add_f32 v44, v44, v60
    v_mfma_f32_16x16x32_bf16 v[56:59], v[212:215], v[72:75], v[56:59]
    s_and_b32 s49, s90, 0xffffffff
    v_add_f32 v45, v45, v61
    v_mov_b32 v60, v44
    v_mfma_f32_16x16x32_bf16 v[64:67], v[216:219], v[72:75], v[64:67]
    s_waitcnt lgkmcnt(2)
    v_mov_b32 v61, v45
    v_permlane32_swap_b32 v44, v60
    v_mfma_f32_16x16x32_bf16 v[48:51], v[220:223], v[80:83], v[48:51]
    s_bitcmp1_b64 s[24:25], s36
    v_permlane32_swap_b32 v45, v61
    v_mfma_f32_16x16x32_bf16 v[56:59], v[224:227], v[80:83], v[56:59]
    s_cselect_b32 s44, s49, 0x5e00000
    v_add_f32 v44, v44, v60
    v_add_f32 v45, v45, v61
    v_mfma_f32_16x16x32_bf16 v[64:67], v[228:231], v[80:83], v[64:67]
    s_waitcnt lgkmcnt(1)
    v_mul_f32 v112, 0xba800000, v44
    v_mul_f32 v45, 0x3a800000, v45
    v_mfma_f32_16x16x32_bf16 v[48:51], v[232:235], v[88:91], v[48:51]
    s_bitcmp1_b64 s[26:27], s36
    v_fma_f32 v45, -v112, v112, v45
    v_mov_b32 v113, v112
    v_mfma_f32_16x16x32_bf16 v[56:59], v[236:239], v[88:91], v[56:59]
    s_cselect_b64 s[62:63], 0, -1
    v_max_f32 v45, 0, v45
    v_add_f32 v45, 0x3727c5ac, v45
    v_mfma_f32_16x16x32_bf16 v[64:67], v[240:243], v[88:91], v[64:67]
    s_waitcnt lgkmcnt(0)
    v_rsq_f32 v114, v45
    v_mfma_f32_16x16x32_bf16 v[48:51], v[244:247], v[96:99], v[48:51]
    s_cmp_eq_u32 s36, s97
    v_permlane16_swap_b32 v112, v113
    v_mfma_f32_16x16x32_bf16 v[56:59], v[248:251], v[96:99], v[56:59]
    s_cselect_b32 s47, 32, -2
    v_mov_b32 v115, v114
    s_cselect_b64 s[8:9], s[88:89], s[8:9]
    v_mfma_f32_16x16x32_bf16 v[64:67], v[252:255], v[96:99], v[64:67]
    s_cselect_b32 s55, 0x543fc00, s55
    v_permlane16_swap_b32 v114, v115
    s_add_u32 s50, s50, s47
    s_max_i32 s47, s50, 0
    s_min_i32 s47, s47, s96
    s_lshl_b32 s41, s47, 15
    s_lshl_b32 s46, s47, 10
    s_sub_u32 s46, s55, s46
    v_fmac_f32 v48, v113, v100
    v_fmac_f32 v49, v113, v101
    v_fmac_f32 v50, v113, v102
    v_fmac_f32 v51, v113, v103
    v_fmac_f32 v56, v113, v104
    v_fmac_f32 v57, v113, v105
    v_fmac_f32 v58, v113, v106
    v_fmac_f32 v59, v113, v107
    v_fmac_f32 v64, v113, v108
    v_fmac_f32 v65, v113, v109
    v_fmac_f32 v66, v113, v110
    v_fmac_f32 v67, v113, v111
    s_waitcnt vmcnt(12)
    s_barrier
    ds_read_b128 v[68:71], v2 offset:0
    ds_read_b128 v[72:75], v2 offset:2048
    ds_read_b128 v[76:79], v3 offset:0
    ds_read_b128 v[80:83], v3 offset:2048
    s_waitcnt lgkmcnt(0)
    s_add_u32 s36, s36, 1
    s_branch L_q_b0
L_spin1:
    s_mov_b32 s40, 0x20000
L_spin1_l:
    buffer_load_dword v37, v36, s[20:23], 0 offen sc1
    s_sub_u32 s40, s40, 1
    s_waitcnt vmcnt(0)
    v_cmp_eq_u32 vcc, v36, v37
    s_cbranch_scc1 L_back2
    s_cbranch_vccz L_back2
    s_sleep 8
    s_branch L_spin1_l
L_spin3:
    s_mov_b32 s40, 0x20000
L_spin3_l:
    buffer_load_dword v116, v117, s[16:19], 0 offen sc1
    s_sub_u32 s40, s40, 1
    s_waitcnt vmcnt(0)
    v_cmp_ne_u32 vcc, 0, v116
    s_cbranch_scc1 L_back4
    s_cbranch_vccz L_back4
    s_sleep 2
    s_branch L_spin3_l
L_spin5:
    s_mov_b32 s40, 0x20000
L_spin5_l:
    buffer_load_dword v116, v117, s[16:19], 0 offen sc1
    s_sub_u32 s40, s40, 1
    s_waitcnt vmcnt(0)
    v_cmp_ne_u32 vcc, 0, v116
    s_cbranch_scc1 L_back6
    s_cbranch_vccz L_back6
    s_sleep 2
    s_branch L_spin5_l
L_spin7:
    s_mov_b32 s40, 0x20000
L_spin7_l:
    buffer_load_dword v116, v117, s[16:19], 0 offen sc1
    s_sub_u32 s40, s40, 1
    s_waitcnt vmcnt(0)
    v_cmp_ne_u32 vcc, 0, v116
    s_cbranch_scc1 L_back8
    s_cbranch_vccz L_back8
    s_sleep 2
    s_branch L_spin7_l
L_other:
    s_lshr_b32 s48, s2, 3
    s_bitcmp1_b32 s2, 0
    s_cbranch_scc1 L_odd
    v_lshrrev_b32 v6, 2, v0
    v_and_b32 v7, 3, v0
    v_lshlrev_b32 v7, 7, v7
    v_lshl_add_u32 v6, v6, 11, v7
    s_and_b32 s48, s48, 15
    s_lshl2_add_u32 s39, s48, s32
    s_lshl_b32 s39, s39, 15
    s_lshl_b32 s37, s47, 9
    s_add_u32 s39, s39, s37
    s_lshr_b32 s37, s48, 2
    s_lshl_b32 s37, s37, 20
    s_and_b32 s38, s48, 3
    s_lshl2_add_u32 s38, s38, s32
    s_lshl_b32 s38, s38, 13
    s_add_u32 s37, s37, s38
    v_lshlrev_b32 v5, 7, v0
    s_waitcnt lgkmcnt(0)
    s_add_u32 s8, s64, 0xe0000
    s_addc_u32 s9, s65, 0
    s_mov_b32 s10, 0x320000
    s_mov_b32 s11, 0x00020000
    buffer_load_dword v251, v5, s[8:11], s37 offen
    s_mov_b32 s12, s66
    s_mov_b32 s13, s67
    s_mov_b32 s14, 0x600000
    s_mov_b32 s15, 0x00020000
    buffer_load_dword v248, v6, s[12:15], s39 offen
    s_add_u32 s39, s39, 2097152
    buffer_load_dword v249, v6, s[12:15], s39 offen
    s_add_u32 s39, s39, 2097152
    buffer_load_dword v250, v6, s[12:15], s39 offen
    s_add_u32 s39, s39, 2097152
    s_mov_b32 s16, s84
    s_mov_b32 s17, s85
    s_mov_b32 s18, 0x5e00000
    s_mov_b32 s19, 0x00020000
    v_min_u32 v124, 1, v0
    v_lshlrev_b32 v124, 30, v124
    s_lshr_b32 s33, s47, 1
    s_lshl_b32 s33, s33, 1
    s_and_b32 s37, s48, 1
    s_add_u32 s33, s33, s37
    s_and_b32 s35, s47, 1
    s_lshl_b32 s35, s35, 3
    s_lshr_b32 s37, s48, 1
    s_add_u32 s35, s35, s37
    s_add_u32 s34, s35, 24
    s_lshl_b32 s91, s33, 6
    s_add_u32 s91, s91, s34
    s_lshl_b32 s91, s91, 7
    s_add_u32 s91, s91, 0x5520000
    s_cmp_eq_u32 s32, 1
    s_cselect_b32 s91, s91, 0x5f00000
    s_mul_i32 s51, s35, 6
    s_min_u32 s51, s51, 106
    s_lshl_b32 s54, s51, 6
    s_mov_b32 s12, s72
    s_mov_b32 s13, s73
    s_mov_b32 s14, 0x700000
    s_mov_b32 s15, 0x00020000
    s_mov_b32 s39, 7168
    v_lshrrev_b32 v68, 3, v0
    v_lshlrev_b32 v69, 2, v0
    v_and_b32 v69, 64, v69
    v_and_b32 v70, 0x70, v1
    v_xor_b32 v69, v69, v70
    v_mad_u32_u24 v56, v68, s39, v69
    v_add_u32 v57, 57344, v56
    v_add_u32 v58, 128, v56
    v_add_u32 v59, 57472, v56
    v_add_u32 v60, 256, v56
    v_add_u32 v61, 57600, v56
    s_mul_i32 s38, s32, 114688
    s_add_u32 s54, s54, s38
    s_lshl_b32 s42, s32, 11
    s_add_u32 m0, s42, 0
    s_nop 0
    buffer_load_dwordx4 v56, s[12:15], s54 offen lds
    s_add_u32 m0, s42, 1024
    s_nop 0
    buffer_load_dwordx4 v57, s[12:15], s54 offen lds
    s_add_u32 m0, s42, 8192
    s_nop 0
    buffer_load_dwordx4 v58, s[12:15], s54 offen lds
    s_add_u32 m0, s42, 9216
    s_nop 0
    buffer_load_dwordx4 v59, s[12:15], s54 offen lds
    s_add_u32 m0, s42, 16384
    s_nop 0
    buffer_load_dwordx4 v60, s[12:15], s54 offen lds
    s_add_u32 m0, s42, 17408
    s_nop 0
    buffer_load_dwordx4 v61, s[12:15], s54 offen lds
    s_add_u32 s54, s54, 458752
    s_add_u32 m0, s42, 24576
    s_nop 0
    buffer_load_dwordx4 v56, s[12:15], s54 offen lds
    s_add_u32 m0, s42, 25600
    s_nop 0
    buffer_load_dwordx4 v57, s[12:15], s54 offen lds
    s_add_u32 m0, s42, 32768
    s_nop 0
    buffer_load_dwordx4 v58, s[12:15], s54 offen lds
    s_add_u32 m0, s42, 33792
    s_nop 0
    buffer_load_dwordx4 v59, s[12:15], s54 offen lds
    s_add_u32 m0, s42, 40960
    s_nop 0
    buffer_load_dwordx4 v60, s[12:15], s54 offen lds
    s_add_u32 m0, s42, 41984
    s_nop 0
    buffer_load_dwordx4 v61, s[12:15], s54 offen lds
    s_add_u32 s54, s54, 458752
    s_add_u32 m0, s42, 49152
    s_nop 0
    buffer_load_dwordx4 v56, s[12:15], s54 offen lds
    s_add_u32 m0, s42, 50176
    s_nop 0
    buffer_load_dwordx4 v57, s[12:15], s54 offen lds
    s_add_u32 m0, s42, 57344
    s_nop 0
    buffer_load_dwordx4 v58, s[12:15], s54 offen lds
    s_add_u32 m0, s42, 58368
    s_nop 0
    buffer_load_dwordx4 v59, s[12:15], s54 offen lds
    s_add_u32 m0, s42, 65536
    s_nop 0
    buffer_load_dwordx4 v60, s[12:15], s54 offen lds
    s_add_u32 m0, s42, 66560
    s_nop 0
    buffer_load_dwordx4 v61, s[12:15], s54 offen lds
    s_add_u32 s54, s54, 458752
    s_add_u32 m0, s42, 73728
    s_nop 0
    buffer_load_dwordx4 v56, s[12:15], s54 offen lds
    s_add_u32 m0, s42, 74752
    s_nop 0
    buffer_load_dwordx4 v57, s[12:15], s54 offen lds
    s_add_u32 m0, s42, 81920
    s_nop 0
    buffer_load_dwordx4 v58, s[12:15], s54 offen lds
    s_add_u32 m0, s42, 82944
    s_nop 0
    buffer_load_dwordx4 v59, s[12:15], s54 offen lds
    s_add_u32 m0, s42, 90112
    s_nop 0
    buffer_load_dwordx4 v60, s[12:15], s54 offen lds
    s_add_u32 m0, s42, 91136
    s_nop 0
    buffer_load_dwordx4 v61, s[12:15], s54 offen lds
    s_add_u32 s54, s54, 458752
    s_add_u32 m0, s42, 98304
    s_nop 0
    buffer_load_dwordx4 v56, s[12:15], s54 offen lds
    s_add_u32 m0, s42, 99328
    s_nop 0
    buffer_load_dwordx4 v57, s[12:15], s54 offen lds
    s_add_u32 m0, s42, 106496
    s_nop 0
    buffer_load_dwordx4 v58, s[12:15], s54 offen lds
    s_add_u32 m0, s42, 107520
    s_nop 0
    buffer_load_dwordx4 v59, s[12:15], s54 offen lds
    s_add_u32 m0, s42, 114688
    s_nop 0
    buffer_load_dwordx4 v60, s[12:15], s54 offen lds
    s_add_u32 m0, s42, 115712
    s_nop 0
    buffer_load_dwordx4 v61, s[12:15], s54 offen lds
    s_add_u32 s54, s54, 458752
    v_lshrrev_b32 v68, 4, v0
    v_bfe_u32 v69, v0, 2, 2
    v_lshl_add_u32 v68, v68, 3, v69
    v_lshlrev_b32 v68, 7, v68
    v_lshrrev_b32 v69, 1, v69
    v_lshl_add_u32 v68, v69, 6, v68
    v_and_b32 v69, 3, v0
    v_lshl_add_u32 v68, v69, 4, v68
    s_lshr_b32 s37, s32, 1
    s_lshl_b32 s37, s37, 13
    s_and_b32 s38, s32, 1
    s_lshl_b32 s38, s38, 6
    s_add_u32 s37, s37, s38
    s_add_u32 s37, s37, 0
    v_xor_b32 v62, s37, v68
    s_lshr_b32 s37, s32, 1
    s_lshl_b32 s37, s37, 13
    s_and_b32 s38, s32, 1
    s_lshl_b32 s38, s38, 6
    s_add_u32 s37, s37, s38
    s_add_u32 s37, s37, 8
    v_xor_b32 v63, s37, v68
    s_lshr_b32 s37, s32, 1
    s_lshl_b32 s37, s37, 6
    s_and_b32 s38, s32, 1
    s_lshl_b32 s38, s38, 3
    s_add_u32 s37, s37, s38
    s_add_u32 s37, s37, 16384
    v_xor_b32 v64, s37, v68
    v_mov_b32 v68, 0x3f803f80
    v_mov_b32 v69, 0x3f803f80
    v_mov_b32 v70, 0x3f803f80
    v_mov_b32 v71, 0x3f803f80
    v_add_u32 v2, 98304, v1
    s_lshl_b32 s37, s33, 6
    s_add_u32 s37, s37, 16
    s_lshl_b32 s37, s37, 7
    v_lshl_add_u32 v5, v0, 7, s37
    s_cmp_eq_u32 s32, 0
    s_cselect_b32 s37, 8, 0
    v_cmp_le_u32 vcc, s37, v0
    s_nop 1
    v_cndmask_b32 v5, v5, 2.0, vcc
    s_lshl_b32 s43, s32, 12
    s_mul_i32 s41, s33, 2097152
    s_add_u32 s41, s41, 0x800000
    s_add_u32 s41, s41, s43
    s_mul_i32 s90, s33, 8388608
    s_add_u32 s90, s90, 0xfc0000
    s_add_u32 s37, s51, s32
    s_lshl_b32 s37, s37, 11
    s_add_u32 s90, s90, s37
    s_lshl_b32 s37, s32, 10
    s_sub_u32 s87, 8192, s37
    s_lshl_b32 s38, s35, 1
    s_lshr_b32 s39, s32, 1
    s_add_u32 s38, s38, s39
    s_cmp_eq_u32 s38, 36
    s_cselect_b32 s88, 0x5e00000, 0
    s_and_b32 s38, s32, 1
    s_lshl_b32 s38, s38, 3
    s_and_b32 s39, s32, 2
    s_lshl_b32 s39, s39, 10
    s_add_u32 s38, s38, s39
    s_add_u32 s38, s38, 65536
    v_add_u32 v3, s38, v1
    s_add_u32 s37, s37, 65536
    v_add_u32 v4, s37, v1
    v_and_b32 v6, 15, v0
    v_lshlrev_b32 v6, 3, v6
    v_lshrrev_b32 v8, 5, v0
    v_lshl_add_u32 v6, v8, 9, v6
    v_and_b32 v8, 16, v0
    v_lshl_add_u32 v6, v8, 6, v6
    v_add_u32 v118, 73728, v6
    s_mul_i32 s46, s33, 65536
    s_add_u32 s46, s46, 0x5440000
    s_add_u32 s55, s46, 63488
    s_and_b32 s52, s32, 1
    s_lshl_b32 s52, s52, 10
    s_mov_b32 s8, s74
    s_mov_b32 s9, s75
    s_mov_b32 s10, 0x1c00
    s_mov_b32 s11, 0x00020000
    v_and_b32 v8, 0x30, v0
    s_add_u32 s37, s51, s32
    s_lshl_b32 s37, s37, 6
    buffer_load_dwordx4 v[16:19], v8, s[8:11], s37 offen
    s_lshr_b32 s37, s32, 1
    s_add_u32 s37, s37, s51
    s_lshl_b32 s37, s37, 6
    s_and_b32 s38, s32, 1
    s_lshl_b32 s38, s38, 3
    s_add_u32 s37, s37, s38
    buffer_load_dwordx2 v[20:21], v8, s[8:11], s37 offen offset:256
    v_add_u32 v65, 0, v62
    v_add_u32 v66, 0, v63
    v_add_u32 v67, 0, v64
    s_waitcnt vmcnt(26)
    s_barrier
    ds_read_b64_tr_b16 a[0:1], v65 offset:0
    ds_read_b64_tr_b16 a[2:3], v65 offset:512
    ds_read_b64_tr_b16 a[4:5], v66 offset:0
    ds_read_b64_tr_b16 a[6:7], v66 offset:512
    ds_read_b64_tr_b16 a[8:9], v67 offset:0
    ds_read_b64_tr_b16 a[10:11], v67 offset:512
    ds_read_b64_tr_b16 a[12:13], v65 offset:4096
    ds_read_b64_tr_b16 a[14:15], v65 offset:4608
    ds_read_b64_tr_b16 a[16:17], v66 offset:4096
    ds_read_b64_tr_b16 a[18:19], v66 offset:4608
    ds_read_b64_tr_b16 a[20:21], v67 offset:4096
    ds_read_b64_tr_b16 a[22:23], v67 offset:4608
    s_add_u32 m0, s42, 122880
    s_nop 0
    buffer_load_dwordx4 v56, s[12:15], s54 offen lds
    s_add_u32 m0, s42, 123904
    s_nop 0
    buffer_load_dwordx4 v57, s[12:15], s54 offen lds
    s_add_u32 m0, s42, 131072
    s_nop 0
    buffer_load_dwordx4 v58, s[12:15], s54 offen lds
    s_add_u32 m0, s42, 132096
    s_nop 0
    buffer_load_dwordx4 v59, s[12:15], s54 offen lds
    s_add_u32 m0, s42, 139264
    s_nop 0
    buffer_load_dwordx4 v60, s[12:15], s54 offen lds
    s_add_u32 m0, s42, 140288
    s_nop 0
    buffer_load_dwordx4 v61, s[12:15], s54 offen lds
    s_add_u32 s54, s54, 458752
    s_waitcnt lgkmcnt(0)
    v_mfma_f32_16x16x32_bf16 v[88:91], a[0:3], v[68:71], 0
    v_mfma_f32_16x16x32_bf16 v[92:95], a[4:7], v[68:71], 0
    v_mfma_f32_16x16x32_bf16 v[96:99], a[8:11], v[68:71], 0
    v_mfma_f32_16x16x32_bf16 v[88:91], a[12:15], v[68:71], v[88:91]
    v_mfma_f32_16x16x32_bf16 v[92:95], a[16:19], v[68:71], v[92:95]
    v_mfma_f32_16x16x32_bf16 v[96:99], a[20:23], v[68:71], v[96:99]
    v_add_u32 v65, 24576, v62
    v_add_u32 v66, 24576, v63
    v_add_u32 v67, 24576, v64
    s_waitcnt vmcnt(26)
    s_barrier
    ds_read_b64_tr_b16 a[24:25], v65 offset:0
    ds_read_b64_tr_b16 a[26:27], v65 offset:512
    ds_read_b64_tr_b16 a[28:29], v66 offset:0
    ds_read_b64_tr_b16 a[30:31], v66 offset:512
    ds_read_b64_tr_b16 a[32:33], v67 offset:0
    ds_read_b64_tr_b16 a[34:35], v67 offset:512
    ds_read_b64_tr_b16 a[36:37], v65 offset:4096
    ds_read_b64_tr_b16 a[38:39], v65 offset:4608
    ds_read_b64_tr_b16 a[40:41], v66 offset:4096
    ds_read_b64_tr_b16 a[42:43], v66 offset:4608
    ds_read_b64_tr_b16 a[44:45], v67 offset:4096
    ds_read_b64_tr_b16 a[46:47], v67 offset:4608
    s_add_u32 m0, s42, 0
    s_nop 0
    buffer_load_dwordx4 v56, s[12:15], s54 offen lds
    s_add_u32 m0, s42, 1024
    s_nop 0
    buffer_load_dwordx4 v57, s[12:15], s54 offen lds
    s_add_u32 m0, s42, 8192
    s_nop 0
    buffer_load_dwordx4 v58, s[12:15], s54 offen lds
    s_add_u32 m0, s42, 9216
    s_nop 0
    buffer_load_dwordx4 v59, s[12:15], s54 offen lds
    s_add_u32 m0, s42, 16384
    s_nop 0
    buffer_load_dwordx4 v60, s[12:15], s54 offen lds
    s_add_u32 m0, s42, 17408
    s_nop 0
    buffer_load_dwordx4 v61, s[12:15], s54 offen lds
    s_add_u32 s54, s54, 458752
    s_waitcnt lgkmcnt(0)
    v_mfma_f32_16x16x32_bf16 v[88:91], a[24:27], v[68:71], v[88:91]
    v_mfma_f32_16x16x32_bf16 v[92:95], a[28:31], v[68:71], v[92:95]
    v_mfma_f32_16x16x32_bf16 v[96:99], a[32:35], v[68:71], v[96:99]
    v_mfma_f32_16x16x32_bf16 v[88:91], a[36:39], v[68:71], v[88:91]
    v_mfma_f32_16x16x32_bf16 v[92:95], a[40:43], v[68:71], v[92:95]
    v_mfma_f32_16x16x32_bf16 v[96:99], a[44:47], v[68:71], v[96:99]
    v_add_u32 v65, 49152, v62
    v_add_u32 v66, 49152, v63
    v_add_u32 v67, 49152, v64
    s_waitcnt vmcnt(26)
    s_barrier
    ds_read_b64_tr_b16 a[48:49], v65 offset:0
    ds_read_b64_tr_b16 a[50:51], v65 offset:512
    ds_read_b64_tr_b16 a[52:53], v66 offset:0
    ds_read_b64_tr_b16 a[54:55], v66 offset:512
    ds_read_b64_tr_b16 a[56:57], v67 offset:0
    ds_read_b64_tr_b16 a[58:59], v67 offset:512
    ds_read_b64_tr_b16 a[60:61], v65 offset:4096
    ds_read_b64_tr_b16 a[62:63], v65 offset:4608
    ds_read_b64_tr_b16 a[64:65], v66 offset:4096
    ds_read_b64_tr_b16 a[66:67], v66 offset:4608
    ds_read_b64_tr_b16 a[68:69], v67 offset:4096
    ds_read_b64_tr_b16 a[70:71], v67 offset:4608
    s_add_u32 m0, s42, 24576
    s_nop 0
    buffer_load_dwordx4 v56, s[12:15], s54 offen lds
    s_add_u32 m0, s42, 25600
    s_nop 0
    buffer_load_dwordx4 v57, s[12:15], s54 offen lds
    s_add_u32 m0, s42, 32768
    s_nop 0
    buffer_load_dwordx4 v58, s[12:15], s54 offen lds
    s_add_u32 m0, s42, 33792
    s_nop 0
    buffer_load_dwordx4 v59, s[12:15], s54 offen lds
    s_add_u32 m0, s42, 40960
    s_nop 0
    buffer_load_dwordx4 v60, s[12:15], s54 offen lds
    s_add_u32 m0, s42, 41984
    s_nop 0
    buffer_load_dwordx4 v61, s[12:15], s54 offen lds
    s_add_u32 s54, s54, 458752
    s_waitcnt lgkmcnt(0)
    v_mfma_f32_16x16x32_bf16 v[88:91], a[48:51], v[68:71], v[88:91]
    v_mfma_f32_16x16x32_bf16 v[92:95], a[52:55], v[68:71], v[92:95]
    v_mfma_f32_16x16x32_bf16 v[96:99], a[56:59], v[68:71], v[96:99]
    v_mfma_f32_16x16x32_bf16 v[88:91], a[60:63], v[68:71], v[88:91]
    v_mfma_f32_16x16x32_bf16 v[92:95], a[64:67], v[68:71], v[92:95]
    v_mfma_f32_16x16x32_bf16 v[96:99], a[68:71], v[68:71], v[96:99]
    v_add_u32 v65, 73728, v62
    v_add_u32 v66, 73728, v63
    v_add_u32 v67, 73728, v64
    s_waitcnt vmcnt(26)
    s_barrier
    ds_read_b64_tr_b16 a[72:73], v65 offset:0
    ds_read_b64_tr_b16 a[74:75], v65 offset:512
    ds_read_b64_tr_b16 a[76:77], v66 offset:0
    ds_read_b64_tr_b16 a[78:79], v66 offset:512
    ds_read_b64_tr_b16 a[80:81], v67 offset:0
    ds_read_b64_tr_b16 a[82:83], v67 offset:512
    ds_read_b64_tr_b16 a[84:85], v65 offset:4096
    ds_read_b64_tr_b16 a[86:87], v65 offset:4608
    ds_read_b64_tr_b16 a[88:89], v66 offset:4096
    ds_read_b64_tr_b16 a[90:91], v66 offset:4608
    ds_read_b64_tr_b16 a[92:93], v67 offset:4096
    ds_read_b64_tr_b16 a[94:95], v67 offset:4608
    s_add_u32 m0, s42, 49152
    s_nop 0
    buffer_load_dwordx4 v56, s[12:15], s54 offen lds
    s_add_u32 m0, s42, 50176
    s_nop 0
    buffer_load_dwordx4 v57, s[12:15], s54 offen lds
    s_add_u32 m0, s42, 57344
    s_nop 0
    buffer_load_dwordx4 v58, s[12:15], s54 offen lds
    s_add_u32 m0, s42, 58368
    s_nop 0
    buffer_load_dwordx4 v59, s[12:15], s54 offen lds
    s_add_u32 m0, s42, 65536
    s_nop 0
    buffer_load_dwordx4 v60, s[12:15], s54 offen lds
    s_add_u32 m0, s42, 66560
    s_nop 0
    buffer_load_dwordx4 v61, s[12:15], s54 offen lds
    s_add_u32 s54, s54, 458752
    s_waitcnt lgkmcnt(0)
    v_mfma_f32_16x16x32_bf16 v[88:91], a[72:75], v[68:71], v[88:91]
    v_mfma_f32_16x16x32_bf16 v[92:95], a[76:79], v[68:71], v[92:95]
    v_mfma_f32_16x16x32_bf16 v[96:99], a[80:83], v[68:71], v[96:99]
    v_mfma_f32_16x16x32_bf16 v[88:91], a[84:87], v[68:71], v[88:91]
    v_mfma_f32_16x16x32_bf16 v[92:95], a[88:91], v[68:71], v[92:95]
    v_mfma_f32_16x16x32_bf16 v[96:99], a[92:95], v[68:71], v[96:99]
    v_add_u32 v65, 98304, v62
    v_add_u32 v66, 98304, v63
    v_add_u32 v67, 98304, v64
    s_waitcnt vmcnt(26)
    s_barrier
    ds_read_b64_tr_b16 a[96:97], v65 offset:0
    ds_read_b64_tr_b16 a[98:99], v65 offset:512
    ds_read_b64_tr_b16 a[100:101], v66 offset:0
    ds_read_b64_tr_b16 a[102:103], v66 offset:512
    ds_read_b64_tr_b16 a[104:105], v67 offset:0
    ds_read_b64_tr_b16 a[106:107], v67 offset:512
    ds_read_b64_tr_b16 a[108:109], v65 offset:4096
    ds_read_b64_tr_b16 a[110:111], v65 offset:4608
    ds_read_b64_tr_b16 a[112:113], v66 offset:4096
    ds_read_b64_tr_b16 a[114:115], v66 offset:4608
    ds_read_b64_tr_b16 a[116:117], v67 offset:4096
    ds_read_b64_tr_b16 a[118:119], v67 offset:4608
    s_add_u32 m0, s42, 73728
    s_nop 0
    buffer_load_dwordx4 v56, s[12:15], s54 offen lds
    s_add_u32 m0, s42, 74752
    s_nop 0
    buffer_load_dwordx4 v57, s[12:15], s54 offen lds
    s_add_u32 m0, s42, 81920
    s_nop 0
    buffer_load_dwordx4 v58, s[12:15], s54 offen lds
    s_add_u32 m0, s42, 82944
    s_nop 0
    buffer_load_dwordx4 v59, s[12:15], s54 offen lds
    s_add_u32 m0, s42, 90112
    s_nop 0
    buffer_load_dwordx4 v60, s[12:15], s54 offen lds
    s_add_u32 m0, s42, 91136
    s_nop 0
    buffer_load_dwordx4 v61, s[12:15], s54 offen lds
    s_add_u32 s54, s54, 458752
    s_waitcnt lgkmcnt(0)
    v_mfma_f32_16x16x32_bf16 v[88:91], a[96:99], v[68:71], v[88:91]
    v_mfma_f32_16x16x32_bf16 v[92:95], a[100:103], v[68:71], v[92:95]
    v_mfma_f32_16x16x32_bf16 v[96:99], a[104:107], v[68:71], v[96:99]
    v_mfma_f32_16x16x32_bf16 v[88:91], a[108:111], v[68:71], v[88:91]
    v_mfma_f32_16x16x32_bf16 v[92:95], a[112:115], v[68:71], v[92:95]
    v_mfma_f32_16x16x32_bf16 v[96:99], a[116:119], v[68:71], v[96:99]
    v_add_u32 v65, 122880, v62
    v_add_u32 v66, 122880, v63
    v_add_u32 v67, 122880, v64
    s_waitcnt vmcnt(24)
    s_barrier
    ds_read_b64_tr_b16 a[120:121], v65 offset:0
    ds_read_b64_tr_b16 a[122:123], v65 offset:512
    ds_read_b64_tr_b16 a[124:125], v66 offset:0
    ds_read_b64_tr_b16 a[126:127], v66 offset:512
    ds_read_b64_tr_b16 a[128:129], v67 offset:0
    ds_read_b64_tr_b16 a[130:131], v67 offset:512
    ds_read_b64_tr_b16 a[132:133], v65 offset:4096
    ds_read_b64_tr_b16 a[134:135], v65 offset:4608
    ds_read_b64_tr_b16 a[136:137], v66 offset:4096
    ds_read_b64_tr_b16 a[138:139], v66 offset:4608
    ds_read_b64_tr_b16 a[140:141], v67 offset:4096
    ds_read_b64_tr_b16 a[142:143], v67 offset:4608
    s_add_u32 m0, s42, 98304
    s_nop 0
    buffer_load_dwordx4 v56, s[12:15], s54 offen lds
    s_add_u32 m0, s42, 99328
    s_nop 0
    buffer_load_dwordx4 v57, s[12:15], s54 offen lds
    s_add_u32 m0, s42, 106496
    s_nop 0
    buffer_load_dwordx4 v58, s[12:15], s54 offen lds
    s_add_u32 m0, s42, 107520
    s_nop 0
    buffer_load_dwordx4 v59, s[12:15], s54 offen lds
    s_add_u32 m0, s42, 114688
    s_nop 0
    buffer_load_dwordx4 v60, s[12:15], s54 offen lds
    s_add_u32 m0, s42, 115712
    s_nop 0
    buffer_load_dwordx4 v61, s[12:15], s54 offen lds
    s_add_u32 s54, s54, 458752
    s_waitcnt lgkmcnt(0)
    v_mfma_f32_16x16x32_bf16 v[88:91], a[120:123], v[68:71], v[88:91]
    v_mfma_f32_16x16x32_bf16 v[92:95], a[124:127], v[68:71], v[92:95]
    v_mfma_f32_16x16x32_bf16 v[96:99], a[128:131], v[68:71], v[96:99]
    v_mfma_f32_16x16x32_bf16 v[88:91], a[132:135], v[68:71], v[88:91]
    v_mfma_f32_16x16x32_bf16 v[92:95], a[136:139], v[68:71], v[92:95]
    v_mfma_f32_16x16x32_bf16 v[96:99], a[140:143], v[68:71], v[96:99]
    v_add_u32 v65, 0, v62
    v_add_u32 v66, 0, v63
    v_add_u32 v67, 0, v64
    s_waitcnt vmcnt(24)
    s_barrier
    ds_read_b64_tr_b16 a[144:145], v65 offset:0
    ds_read_b64_tr_b16 a[146:147], v65 offset:512
    ds_read_b64_tr_b16 a[148:149], v66 offset:0
    ds_read_b64_tr_b16 a[150:151], v66 offset:512
    ds_read_b64_tr_b16 a[152:153], v67 offset:0
    ds_read_b64_tr_b16 a[154:155], v67 offset:512
    ds_read_b64_tr_b16 a[156:157], v65 offset:4096
    ds_read_b64_tr_b16 a[158:159], v65 offset:4608
    ds_read_b64_tr_b16 a[160:161], v66 offset:4096
    ds_read_b64_tr_b16 a[162:163], v66 offset:4608
    ds_read_b64_tr_b16 a[164:165], v67 offset:4096
    ds_read_b64_tr_b16 a[166:167], v67 offset:4608
    s_add_u32 m0, s42, 122880
    s_nop 0
    buffer_load_dwordx4 v56, s[12:15], s54 offen lds
    s_add_u32 m0, s42, 123904
    s_nop 0
    buffer_load_dwordx4 v57, s[12:15], s54 offen lds
    s_add_u32 m0, s42, 131072
    s_nop 0
    buffer_load_dwordx4 v58, s[12:15], s54 offen lds
    s_add_u32 m0, s42, 132096
    s_nop 0
    buffer_load_dwordx4 v59, s[12:15], s54 offen lds
    s_add_u32 m0, s42, 139264
    s_nop 0
    buffer_load_dwordx4 v60, s[12:15], s54 offen lds
    s_add_u32 m0, s42, 140288
    s_nop 0
    buffer_load_dwordx4 v61, s[12:15], s54 offen lds
    s_add_u32 s54, s54, 458752
    s_waitcnt lgkmcnt(0)
    v_mfma_f32_16x16x32_bf16 v[88:91], a[144:147], v[68:71], v[88:91]
    v_mfma_f32_16x16x32_bf16 v[92:95], a[148:151], v[68:71], v[92:95]
    v_mfma_f32_16x16x32_bf16 v[96:99], a[152:155], v[68:71], v[96:99]
    v_mfma_f32_16x16x32_bf16 v[88:91], a[156:159], v[68:71], v[88:91]
    v_mfma_f32_16x16x32_bf16 v[92:95], a[160:163], v[68:71], v[92:95]
    v_mfma_f32_16x16x32_bf16 v[96:99], a[164:167], v[68:71], v[96:99]
    v_add_u32 v65, 24576, v62
    v_add_u32 v66, 24576, v63
    v_add_u32 v67, 24576, v64
    s_waitcnt vmcnt(24)
    s_barrier
    ds_read_b64_tr_b16 a[168:169], v65 offset:0
    ds_read_b64_tr_b16 a[170:171], v65 offset:512
    ds_read_b64_tr_b16 a[172:173], v66 offset:0
    ds_read_b64_tr_b16 a[174:175], v66 offset:512
    ds_read_b64_tr_b16 a[176:177], v67 offset:0
    ds_read_b64_tr_b16 a[178:179], v67 offset:512
    ds_read_b64_tr_b16 a[180:181], v65 offset:4096
    ds_read_b64_tr_b16 a[182:183], v65 offset:4608
    ds_read_b64_tr_b16 a[184:185], v66 offset:4096
    ds_read_b64_tr_b16 a[186:187], v66 offset:4608
    ds_read_b64_tr_b16 a[188:189], v67 offset:4096
    ds_read_b64_tr_b16 a[190:191], v67 offset:4608
    s_add_u32 m0, s42, 0
    s_nop 0
    buffer_load_dwordx4 v56, s[12:15], s54 offen lds
    s_add_u32 m0, s42, 1024
    s_nop 0
    buffer_load_dwordx4 v57, s[12:15], s54 offen lds
    s_add_u32 m0, s42, 8192
    s_nop 0
    buffer_load_dwordx4 v58, s[12:15], s54 offen lds
    s_add_u32 m0, s42, 9216
    s_nop 0
    buffer_load_dwordx4 v59, s[12:15], s54 offen lds
    s_add_u32 m0, s42, 16384
    s_nop 0
    buffer_load_dwordx4 v60, s[12:15], s54 offen lds
    s_add_u32 m0, s42, 17408
    s_nop 0
    buffer_load_dwordx4 v61, s[12:15], s54 offen lds
    s_add_u32 s54, s54, 458752
    s_waitcnt lgkmcnt(0)
    v_mfma_f32_16x16x32_bf16 v[88:91], a[168:171], v[68:71], v[88:91]
    v_mfma_f32_16x16x32_bf16 v[92:95], a[172:175], v[68:71], v[92:95]
    v_mfma_f32_16x16x32_bf16 v[96:99], a[176:179], v[68:71], v[96:99]
    v_mfma_f32_16x16x32_bf16 v[88:91], a[180:183], v[68:71], v[88:91]
    v_mfma_f32_16x16x32_bf16 v[92:95], a[184:187], v[68:71], v[92:95]
    v_mfma_f32_16x16x32_bf16 v[96:99], a[188:191], v[68:71], v[96:99]
    v_add_u32 v65, 49152, v62
    v_add_u32 v66, 49152, v63
    v_add_u32 v67, 49152, v64
    s_waitcnt vmcnt(24)
    s_barrier
    ds_read_b64_tr_b16 a[192:193], v65 offset:0
    ds_read_b64_tr_b16 a[194:195], v65 offset:512
    ds_read_b64_tr_b16 a[196:197], v66 offset:0
    ds_read_b64_tr_b16 a[198:199], v66 offset:512
    ds_read_b64_tr_b16 a[200:201], v67 offset:0
    ds_read_b64_tr_b16 a[202:203], v67 offset:512
    ds_read_b64_tr_b16 a[204:205], v65 offset:4096
    ds_read_b64_tr_b16 a[206:207], v65 offset:4608
    ds_read_b64_tr_b16 a[208:209], v66 offset:4096
    ds_read_b64_tr_b16 a[210:211], v66 offset:4608
    ds_read_b64_tr_b16 a[212:213], v67 offset:4096
    ds_read_b64_tr_b16 a[214:215], v67 offset:4608
    s_add_u32 m0, s42, 24576
    s_nop 0
    buffer_load_dwordx4 v56, s[12:15], s54 offen lds
    s_add_u32 m0, s42, 25600
    s_nop 0
    buffer_load_dwordx4 v57, s[12:15], s54 offen lds
    s_add_u32 m0, s42, 32768
    s_nop 0
    buffer_load_dwordx4 v58, s[12:15], s54 offen lds
    s_add_u32 m0, s42, 33792
    s_nop 0
    buffer_load_dwordx4 v59, s[12:15], s54 offen lds
    s_add_u32 m0, s42, 40960
    s_nop 0
    buffer_load_dwordx4 v60, s[12:15], s54 offen lds
    s_add_u32 m0, s42, 41984
    s_nop 0
    buffer_load_dwordx4 v61, s[12:15], s54 offen lds
    s_add_u32 s54, s54, 458752
    s_waitcnt lgkmcnt(0)
    v_mfma_f32_16x16x32_bf16 v[88:91], a[192:195], v[68:71], v[88:91]
    v_mfma_f32_16x16x32_bf16 v[92:95], a[196:199], v[68:71], v[92:95]
    v_mfma_f32_16x16x32_bf16 v[96:99], a[200:203], v[68:71], v[96:99]
    v_mfma_f32_16x16x32_bf16 v[88:91], a[204:207], v[68:71], v[88:91]
    v_mfma_f32_16x16x32_bf16 v[92:95], a[208:211], v[68:71], v[92:95]
    v_mfma_f32_16x16x32_bf16 v[96:99], a[212:215], v[68:71], v[96:99]
    v_add_u32 v65, 73728, v62
    v_add_u32 v66, 73728, v63
    v_add_u32 v67, 73728, v64
    s_waitcnt vmcnt(24)
    s_barrier
    ds_read_b64_tr_b16 a[216:217], v65 offset:0
    ds_read_b64_tr_b16 a[218:219], v65 offset:512
    ds_read_b64_tr_b16 a[220:221], v66 offset:0
    ds_read_b64_tr_b16 a[222:223], v66 offset:512
    ds_read_b64_tr_b16 a[224:225], v67 offset:0
    ds_read_b64_tr_b16 a[226:227], v67 offset:512
    ds_read_b64_tr_b16 a[228:229], v65 offset:4096
    ds_read_b64_tr_b16 a[230:231], v65 offset:4608
    ds_read_b64_tr_b16 a[232:233], v66 offset:4096
    ds_read_b64_tr_b16 a[234:235], v66 offset:4608
    ds_read_b64_tr_b16 a[236:237], v67 offset:4096
    ds_read_b64_tr_b16 a[238:239], v67 offset:4608
    s_add_u32 m0, s42, 49152
    s_nop 0
    buffer_load_dwordx4 v56, s[12:15], s54 offen lds
    s_add_u32 m0, s42, 50176
    s_nop 0
    buffer_load_dwordx4 v57, s[12:15], s54 offen lds
    s_add_u32 m0, s42, 57344
    s_nop 0
    buffer_load_dwordx4 v58, s[12:15], s54 offen lds
    s_add_u32 m0, s42, 58368
    s_nop 0
    buffer_load_dwordx4 v59, s[12:15], s54 offen lds
    s_add_u32 m0, s42, 65536
    s_nop 0
    buffer_load_dwordx4 v60, s[12:15], s54 offen lds
    s_add_u32 m0, s42, 66560
    s_nop 0
    buffer_load_dwordx4 v61, s[12:15], s54 offen lds
    s_add_u32 s54, s54, 458752
    s_waitcnt lgkmcnt(0)
    v_mfma_f32_16x16x32_bf16 v[88:91], a[216:219], v[68:71], v[88:91]
    v_mfma_f32_16x16x32_bf16 v[92:95], a[220:223], v[68:71], v[92:95]
    v_mfma_f32_16x16x32_bf16 v[96:99], a[224:227], v[68:71], v[96:99]
    v_mfma_f32_16x16x32_bf16 v[88:91], a[228:231], v[68:71], v[88:91]
    v_mfma_f32_16x16x32_bf16 v[92:95], a[232:235], v[68:71], v[92:95]
    v_mfma_f32_16x16x32_bf16 v[96:99], a[236:239], v[68:71], v[96:99]
    v_add_u32 v65, 98304, v62
    v_add_u32 v66, 98304, v63
    v_add_u32 v67, 98304, v64
    s_waitcnt vmcnt(24)
    s_barrier
    ds_read_b64_tr_b16 a[240:241], v65 offset:0
    ds_read_b64_tr_b16 a[242:243], v65 offset:512
    ds_read_b64_tr_b16 a[244:245], v66 offset:0
    ds_read_b64_tr_b16 a[246:247], v66 offset:512
    ds_read_b64_tr_b16 a[248:249], v67 offset:0
    ds_read_b64_tr_b16 a[250:251], v67 offset:512
    ds_read_b64_tr_b16 a[252:253], v65 offset:4096
    ds_read_b64_tr_b16 a[254:255], v65 offset:4608
    ds_read_b64_tr_b16 v[128:129], v66 offset:4096
    ds_read_b64_tr_b16 v[130:131], v66 offset:4608
    ds_read_b64_tr_b16 v[132:133], v67 offset:4096
    ds_read_b64_tr_b16 v[134:135], v67 offset:4608
    s_add_u32 m0, s42, 73728
    s_nop 0
    buffer_load_dwordx4 v56, s[12:15], s54 offen lds
    s_add_u32 m0, s42, 74752
    s_nop 0
    buffer_load_dwordx4 v57, s[12:15], s54 offen lds
    s_add_u32 m0, s42, 81920
    s_nop 0
    buffer_load_dwordx4 v58, s[12:15], s54 offen lds
    s_add_u32 m0, s42, 82944
    s_nop 0
    buffer_load_dwordx4 v59, s[12:15], s54 offen lds
    s_add_u32 m0, s42, 90112
    s_nop 0
    buffer_load_dwordx4 v60, s[12:15], s54 offen lds
    s_add_u32 m0, s42, 91136
    s_nop 0
    buffer_load_dwordx4 v61, s[12:15], s54 offen lds
    s_add_u32 s54, s54, 458752
    s_waitcnt lgkmcnt(0)
    v_mfma_f32_16x16x32_bf16 v[88:91], a[240:243], v[68:71], v[88:91]
    v_mfma_f32_16x16x32_bf16 v[92:95], a[244:247], v[68:71], v[92:95]
    v_mfma_f32_16x16x32_bf16 v[96:99], a[248:251], v[68:71], v[96:99]
    v_mfma_f32_16x16x32_bf16 v[88:91], a[252:255], v[68:71], v[88:91]
    v_mfma_f32_16x16x32_bf16 v[92:95], v[128:131], v[68:71], v[92:95]
    v_mfma_f32_16x16x32_bf16 v[96:99], v[132:135], v[68:71], v[96:99]
    v_add_u32 v65, 122880, v62
    v_add_u32 v66, 122880, v63
    v_add_u32 v67, 122880, v64
    s_waitcnt vmcnt(24)
    s_barrier
    ds_read_b64_tr_b16 v[136:137], v65 offset:0
    ds_read_b64_tr_b16 v[138:139], v65 offset:512
    ds_read_b64_tr_b16 v[140:141], v66 offset:0
    ds_read_b64_tr_b16 v[142:143], v66 offset:512
    ds_read_b64_tr_b16 v[144:145], v67 offset:0
    ds_read_b64_tr_b16 v[146:147], v67 offset:512
    ds_read_b64_tr_b16 v[148:149], v65 offset:4096
    ds_read_b64_tr_b16 v[150:151], v65 offset:4608
    ds_read_b64_tr_b16 v[152:153], v66 offset:4096
    ds_read_b64_tr_b16 v[154:155], v66 offset:4608
    ds_read_b64_tr_b16 v[156:157], v67 offset:4096
    ds_read_b64_tr_b16 v[158:159], v67 offset:4608
    s_waitcnt lgkmcnt(0)
    v_mfma_f32_16x16x32_bf16 v[88:91], v[136:139], v[68:71], v[88:91]
    v_mfma_f32_16x16x32_bf16 v[92:95], v[140:143], v[68:71], v[92:95]
    v_mfma_f32_16x16x32_bf16 v[96:99], v[144:147], v[68:71], v[96:99]
    v_mfma_f32_16x16x32_bf16 v[88:91], v[148:151], v[68:71], v[88:91]
    v_mfma_f32_16x16x32_bf16 v[92:95], v[152:155], v[68:71], v[92:95]
    v_mfma_f32_16x16x32_bf16 v[96:99], v[156:159], v[68:71], v[96:99]
    v_add_u32 v65, 0, v62
    v_add_u32 v66, 0, v63
    v_add_u32 v67, 0, v64
    s_waitcnt vmcnt(18)
    s_barrier
    ds_read_b64_tr_b16 v[160:161], v65 offset:0
    ds_read_b64_tr_b16 v[162:163], v65 offset:512
    ds_read_b64_tr_b16 v[164:165], v66 offset:0
    ds_read_b64_tr_b16 v[166:167], v66 offset:512
    ds_read_b64_tr_b16 v[168:169], v67 offset:0
    ds_read_b64_tr_b16 v[170:171], v67 offset:512
    ds_read_b64_tr_b16 v[172:173], v65 offset:4096
    ds_read_b64_tr_b16 v[174:175], v65 offset:4608
    ds_read_b64_tr_b16 v[176:177], v66 offset:4096
    ds_read_b64_tr_b16 v[178:179], v66 offset:4608
    ds_read_b64_tr_b16 v[180:181], v67 offset:4096
    ds_read_b64_tr_b16 v[182:183], v67 offset:4608
    s_waitcnt lgkmcnt(0)
    v_mfma_f32_16x16x32_bf16 v[88:91], v[160:163], v[68:71], v[88:91]
    v_mfma_f32_16x16x32_bf16 v[92:95], v[164:167], v[68:71], v[92:95]
    v_mfma_f32_16x16x32_bf16 v[96:99], v[168:171], v[68:71], v[96:99]
    v_mfma_f32_16x16x32_bf16 v[88:91], v[172:175], v[68:71], v[88:91]
    v_mfma_f32_16x16x32_bf16 v[92:95], v[176:179], v[68:71], v[92:95]
    v_mfma_f32_16x16x32_bf16 v[96:99], v[180:183], v[68:71], v[96:99]
    v_add_u32 v65, 24576, v62
    v_add_u32 v66, 24576, v63
    v_add_u32 v67, 24576, v64
    s_waitcnt vmcnt(12)
    s_barrier
    ds_read_b64_tr_b16 v[184:185], v65 offset:0
    ds_read_b64_tr_b16 v[186:187], v65 offset:512
    ds_read_b64_tr_b16 v[188:189], v66 offset:0
    ds_read_b64_tr_b16 v[190:191], v66 offset:512
    ds_read_b64_tr_b16 v[192:193], v67 offset:0
    ds_read_b64_tr_b16 v[194:195], v67 offset:512
    ds_read_b64_tr_b16 v[196:197], v65 offset:4096
    ds_read_b64_tr_b16 v[198:199], v65 offset:4608
    ds_read_b64_tr_b16 v[200:201], v66 offset:4096
    ds_read_b64_tr_b16 v[202:203], v66 offset:4608
    ds_read_b64_tr_b16 v[204:205], v67 offset:4096
    ds_read_b64_tr_b16 v[206:207], v67 offset:4608
    s_waitcnt lgkmcnt(0)
    v_mfma_f32_16x16x32_bf16 v[88:91], v[184:187], v[68:71], v[88:91]
    v_mfma_f32_16x16x32_bf16 v[92:95], v[188:191], v[68:71], v[92:95]
    v_mfma_f32_16x16x32_bf16 v[96:99], v[192:195], v[68:71], v[96:99]
    v_mfma_f32_16x16x32_bf16 v[88:91], v[196:199], v[68:71], v[88:91]
    v_mfma_f32_16x16x32_bf16 v[92:95], v[200:203], v[68:71], v[92:95]
    v_mfma_f32_16x16x32_bf16 v[96:99], v[204:207], v[68:71], v[96:99]
    v_add_u32 v65, 49152, v62
    v_add_u32 v66, 49152, v63
    v_add_u32 v67, 49152, v64
    s_waitcnt vmcnt(6)
    s_barrier
    ds_read_b64_tr_b16 v[208:209], v65 offset:0
    ds_read_b64_tr_b16 v[210:211], v65 offset:512
    ds_read_b64_tr_b16 v[212:213], v66 offset:0
    ds_read_b64_tr_b16 v[214:215], v66 offset:512
    ds_read_b64_tr_b16 v[216:217], v67 offset:0
    ds_read_b64_tr_b16 v[218:219], v67 offset:512
    ds_read_b64_tr_b16 v[220:221], v65 offset:4096
    ds_read_b64_tr_b16 v[222:223], v65 offset:4608
    ds_read_b64_tr_b16 v[224:225], v66 offset:4096
    ds_read_b64_tr_b16 v[226:227], v66 offset:4608
    ds_read_b64_tr_b16 v[228:229], v67 offset:4096
    ds_read_b64_tr_b16 v[230:231], v67 offset:4608
    s_waitcnt lgkmcnt(0)
    v_mfma_f32_16x16x32_bf16 v[88:91], v[208:211], v[68:71], v[88:91]
    v_mfma_f32_16x16x32_bf16 v[92:95], v[212:215], v[68:71], v[92:95]
    v_mfma_f32_16x16x32_bf16 v[96:99], v[216:219], v[68:71], v[96:99]
    v_mfma_f32_16x16x32_bf16 v[88:91], v[220:223], v[68:71], v[88:91]
    v_mfma_f32_16x16x32_bf16 v[92:95], v[224:227], v[68:71], v[92:95]
    v_mfma_f32_16x16x32_bf16 v[96:99], v[228:231], v[68:71], v[96:99]
    v_add_u32 v65, 73728, v62
    v_add_u32 v66, 73728, v63
    v_add_u32 v67, 73728, v64
    s_waitcnt vmcnt(0)
    s_barrier
    ds_read_b64_tr_b16 v[232:233], v65 offset:0
    ds_read_b64_tr_b16 v[234:235], v65 offset:512
    ds_read_b64_tr_b16 v[236:237], v66 offset:0
    ds_read_b64_tr_b16 v[238:239], v66 offset:512
    ds_read_b64_tr_b16 v[240:241], v67 offset:0
    ds_read_b64_tr_b16 v[242:243], v67 offset:512
    ds_read_b64_tr_b16 v[244:245], v65 offset:4096
    ds_read_b64_tr_b16 v[246:247], v65 offset:4608
    ds_read_b64_tr_b16 v[248:249], v66 offset:4096
    ds_read_b64_tr_b16 v[250:251], v66 offset:4608
    ds_read_b64_tr_b16 v[252:253], v67 offset:4096
    ds_read_b64_tr_b16 v[254:255], v67 offset:4608
    s_waitcnt lgkmcnt(0)
    v_mfma_f32_16x16x32_bf16 v[88:91], v[232:235], v[68:71], v[88:91]
    v_mfma_f32_16x16x32_bf16 v[92:95], v[236:239], v[68:71], v[92:95]
    v_mfma_f32_16x16x32_bf16 v[96:99], v[240:243], v[68:71], v[96:99]
    v_mfma_f32_16x16x32_bf16 v[88:91], v[244:247], v[68:71], v[88:91]
    v_mfma_f32_16x16x32_bf16 v[92:95], v[248:251], v[68:71], v[92:95]
    v_mfma_f32_16x16x32_bf16 v[96:99], v[252:255], v[68:71], v[96:99]
    s_barrier
    s_mov_b32 s37, 0xffff0000
    v_lshlrev_b32 v100, 16, v16
    v_and_b32 v101, s37, v16
    v_lshlrev_b32 v102, 16, v17
    v_and_b32 v103, s37, v17
    v_lshlrev_b32 v104, 16, v18
    v_and_b32 v105, s37, v18
    v_lshlrev_b32 v106, 16, v19
    v_and_b32 v107, s37, v19
    v_lshlrev_b32 v108, 16, v20
    v_and_b32 v109, s37, v20
    v_lshlrev_b32 v110, 16, v21
    v_and_b32 v111, s37, v21
    s_cmp_lg_u32 s32, 0
    s_cbranch_scc1 L_arv9
    s_add_u32 s20, s82, 0x80
    s_addc_u32 s21, s83, 0
    s_mov_b32 s22, 0x4
    s_mov_b32 s23, 0x00020000
    buffer_load_dword v56, v124, s[20:23], 0 offen sc1
    s_waitcnt vmcnt(0)
    v_cmp_eq_u32 vcc, v124, v56
    s_cbranch_vccnz L_spin10
L_back11:
L_arv9:
    s_add_u32 s96, s41, 2031616
    s_mov_b32 s98, s41
    s_mov_b32 s45, 0x5530000
    buffer_load_dword v7, v5, s[16:19], s45 offen sc1
    s_waitcnt vmcnt(0)
    v_cmp_ne_u32 vcc, 0, v7
    s_cbranch_vccnz L_spin12
L_back13:
    s_barrier
    s_add_u32 m0, s43, 0
    s_add_u32 s42, s41, 0
    buffer_load_dwordx4 v1, s[16:19], s42 offen offset:0 sc1 lds
    buffer_load_dwordx4 v1, s[16:19], s42 offen offset:1024 sc1 lds
    buffer_load_dwordx4 v1, s[16:19], s42 offen offset:2048 sc1 lds
    buffer_load_dwordx4 v1, s[16:19], s42 offen offset:3072 sc1 lds
    s_add_u32 m0, s43, 16384
    s_add_u32 s42, s41, 16384
    buffer_load_dwordx4 v1, s[16:19], s42 offen offset:0 sc1 lds
    buffer_load_dwordx4 v1, s[16:19], s42 offen offset:1024 sc1 lds
    buffer_load_dwordx4 v1, s[16:19], s42 offen offset:2048 sc1 lds
    buffer_load_dwordx4 v1, s[16:19], s42 offen offset:3072 sc1 lds
    s_add_u32 m0, s43, 32768
    s_add_u32 s42, s41, 32768
    buffer_load_dwordx4 v1, s[16:19], s42 offen offset:0 sc1 lds
    buffer_load_dwordx4 v1, s[16:19], s42 offen offset:1024 sc1 lds
    buffer_load_dwordx4 v1, s[16:19], s42 offen offset:2048 sc1 lds
    buffer_load_dwordx4 v1, s[16:19], s42 offen offset:3072 sc1 lds
    s_add_u32 m0, s43, 49152
    s_add_u32 s42, s41, 49152
    buffer_load_dwordx4 v1, s[16:19], s42 offen offset:0 sc1 lds
    buffer_load_dwordx4 v1, s[16:19], s42 offen offset:1024 sc1 lds
    buffer_load_dwordx4 v1, s[16:19], s42 offen offset:2048 sc1 lds
    buffer_load_dwordx4 v1, s[16:19], s42 offen offset:3072 sc1 lds
    s_add_u32 s45, s45, 65536
    s_add_u32 m0, s52, 73728
    s_add_u32 s42, s46, s52
    buffer_load_dwordx4 v1, s[16:19], s42 offen sc1 lds
    v_mov_b32 v7, -1
    s_cmp_eq_u32 s32, 0
    s_cselect_b32 s37, 1, 0
    v_cmp_le_u32 vcc, s37, v0
    s_nop 1
    v_cndmask_b32 v7, v7, 0, vcc
    s_waitcnt vmcnt(0) lgkmcnt(0)
    s_barrier
    ds_read_b128 v[56:59], v1 offset:0
    ds_read_b128 v[60:63], v1 offset:1024
    ds_read_b128 v[64:67], v1 offset:2048
    ds_read_b128 v[68:71], v1 offset:3072
    s_mov_b32 s36, 0
    s_waitcnt lgkmcnt(0)
    s_nop 7
L_a_b0:
    v_mfma_f32_16x16x32_bf16 v[8:11], a[0:3], v[56:59], 0
    s_and_b32 s44, s90, 0xffffffff
    ds_read_b128 v[72:75], v1 offset:4096
    v_mul_f32 v120, v48, v116
    v_mfma_f32_16x16x32_bf16 v[16:19], a[0:3], v[60:63], 0
    s_cmp_lt_i32 s36, 1
    v_mul_f32 v121, v49, v116
    v_mul_f32 v120, v120, abs(v48)
    v_mfma_f32_16x16x32_bf16 v[20:23], a[4:7], v[60:63], 0
    s_cselect_b32 s44, 0x5e00000, s44
    v_mul_f32 v121, v121, abs(v49)
    v_cvt_pk_bf16_f32 v48, v120, v121
    v_mfma_f32_16x16x32_bf16 v[12:15], a[4:7], v[56:59], 0
    s_add_u32 s49, s44, s87
    ds_read_b128 v[76:79], v1 offset:5120
    v_pk_max_i16 v48, v48, 0
    v_mfma_f32_16x16x32_bf16 v[24:27], a[8:11], v[56:59], 0
    s_max_u32 s44, s44, s88
    v_mul_f32 v120, v50, v116
    v_mul_f32 v121, v51, v116
    v_mfma_f32_16x16x32_bf16 v[28:31], a[8:11], v[60:63], 0
    s_waitcnt lgkmcnt(2)
    v_mul_f32 v120, v120, abs(v50)
    v_mul_f32 v121, v121, abs(v51)
    v_mfma_f32_16x16x32_bf16 v[8:11], a[12:15], v[64:67], v[8:11]
    s_add_u32 s90, s90, 262144
    ds_read_b128 v[80:83], v1 offset:6144
    v_cvt_pk_bf16_f32 v49, v120, v121
    v_mfma_f32_16x16x32_bf16 v[16:19], a[12:15], v[68:71], v[16:19]
    s_add_u32 s98, s98, 65536
    v_pk_max_i16 v49, v49, 0
    s_min_i32 s98, s98, s96
    v_mfma_f32_16x16x32_bf16 v[20:23], a[16:19], v[68:71], v[20:23]
    s_and_b32 s41, s98, 0xffffffff
    ds_write_b64 v3, v[48:49] offset:4096
    v_mfma_f32_16x16x32_bf16 v[12:15], a[16:19], v[64:67], v[12:15]
    ds_read_b128 v[84:87], v1 offset:7168
    v_mul_f32 v120, v52, v117
    v_mfma_f32_16x16x32_bf16 v[24:27], a[20:23], v[64:67], v[24:27]
    v_mul_f32 v121, v53, v117
    v_mul_f32 v120, v120, abs(v52)
    v_mfma_f32_16x16x32_bf16 v[28:31], a[20:23], v[68:71], v[28:31]
    s_waitcnt lgkmcnt(3)
    v_mul_f32 v121, v121, abs(v53)
    v_cvt_pk_bf16_f32 v52, v120, v121
    v_mfma_f32_16x16x32_bf16 v[8:11], a[24:27], v[72:75], v[8:11]
    ds_read_b128 v[56:59], v1 offset:8192
    v_pk_max_i16 v52, v52, 0
    v_mfma_f32_16x16x32_bf16 v[16:19], a[24:27], v[76:79], v[16:19]
    v_mul_f32 v120, v54, v117
    v_mul_f32 v121, v55, v117
    v_mfma_f32_16x16x32_bf16 v[20:23], a[28:31], v[76:79], v[20:23]
    v_mul_f32 v120, v120, abs(v54)
    v_mul_f32 v121, v121, abs(v55)
    v_mfma_f32_16x16x32_bf16 v[12:15], a[28:31], v[72:75], v[12:15]
    ds_read_b128 v[60:63], v1 offset:9216
    v_cvt_pk_bf16_f32 v53, v120, v121
    v_mfma_f32_16x16x32_bf16 v[24:27], a[32:35], v[72:75], v[24:27]
    v_pk_max_i16 v53, v53, 0
    v_mfma_f32_16x16x32_bf16 v[28:31], a[32:35], v[76:79], v[28:31]
    s_waitcnt lgkmcnt(2)
    ds_write_b64 v3, v[52:53] offset:5120
    v_mfma_f32_16x16x32_bf16 v[8:11], a[36:39], v[80:83], v[8:11]
    ds_read_b128 v[64:67], v1 offset:10240
    v_mul_f32 v120, v32, v116
    v_mfma_f32_16x16x32_bf16 v[16:19], a[36:39], v[84:87], v[16:19]
    v_mul_f32 v121, v33, v116
    v_mul_f32 v120, v120, abs(v32)
    v_mfma_f32_16x16x32_bf16 v[20:23], a[40:43], v[84:87], v[20:23]
    v_mul_f32 v121, v121, abs(v33)
    v_cvt_pk_bf16_f32 v32, v120, v121
    v_mfma_f32_16x16x32_bf16 v[12:15], a[40:43], v[80:83], v[12:15]
    ds_read_b128 v[68:71], v1 offset:11264
    v_pk_max_i16 v32, v32, 0
    v_mfma_f32_16x16x32_bf16 v[24:27], a[44:47], v[80:83], v[24:27]
    v_mul_f32 v120, v34, v116
    v_mul_f32 v121, v35, v116
    v_mfma_f32_16x16x32_bf16 v[28:31], a[44:47], v[84:87], v[28:31]
    s_waitcnt lgkmcnt(3)
    v_mul_f32 v120, v120, abs(v34)
    v_mul_f32 v121, v121, abs(v35)
    v_mfma_f32_16x16x32_bf16 v[8:11], a[48:51], v[56:59], v[8:11]
    ds_read_b128 v[72:75], v1 offset:12288
    v_cvt_pk_bf16_f32 v33, v120, v121
    v_mfma_f32_16x16x32_bf16 v[16:19], a[48:51], v[60:63], v[16:19]
    s_waitcnt vmcnt(0)
    v_cmp_ne_u32 vcc, 0, v7
    v_pk_max_i16 v33, v33, 0
    v_mfma_f32_16x16x32_bf16 v[20:23], a[52:55], v[60:63], v[20:23]
    v_mul_f32 v120, v36, v116
    v_mul_f32 v121, v37, v116
    v_mfma_f32_16x16x32_bf16 v[12:15], a[52:55], v[56:59], v[12:15]
    s_cbranch_vccnz L_spin14
L_back15:
    ds_read_b128 v[76:79], v1 offset:13312
    v_mul_f32 v120, v120, abs(v36)
    v_mfma_f32_16x16x32_bf16 v[24:27], a[56:59], v[56:59], v[24:27]
    s_waitcnt lgkmcnt(4)
    v_mul_f32 v121, v121, abs(v37)
    v_cvt_pk_bf16_f32 v34, v120, v121
    v_mfma_f32_16x16x32_bf16 v[28:31], a[56:59], v[60:63], v[28:31]
    s_waitcnt lgkmcnt(2)
    v_pk_max_i16 v34, v34, 0
    v_mul_f32 v120, v38, v116
    v_mfma_f32_16x16x32_bf16 v[8:11], a[60:63], v[64:67], v[8:11]
    s_barrier
    ds_read_b128 v[80:83], v1 offset:14336
    v_mul_f32 v121, v39, v116
    v_mfma_f32_16x16x32_bf16 v[16:19], a[60:63], v[68:71], v[16:19]
    s_add_u32 s45, s45, 65536
    ds_read_b128 v[48:51], v4 offset:4096
    v_mul_f32 v120, v120, abs(v38)
    v_mfma_f32_16x16x32_bf16 v[20:23], a[64:67], v[68:71], v[20:23]
    v_mul_f32 v121, v121, abs(v39)
    v_cvt_pk_bf16_f32 v35, v120, v121
    v_mfma_f32_16x16x32_bf16 v[12:15], a[64:67], v[64:67], v[12:15]
    ds_read_b128 v[84:87], v1 offset:15360
    v_pk_max_i16 v35, v35, 0
    v_mfma_f32_16x16x32_bf16 v[24:27], a[68:71], v[64:67], v[24:27]
    buffer_store_dwordx4 v[32:35], v1, s[16:19], s44 offen offset:0 sc1
    v_mfma_f32_16x16x32_bf16 v[28:31], a[68:71], v[68:71], v[28:31]
    s_waitcnt lgkmcnt(3)
    v_mul_f32 v120, v40, v117
    v_mul_f32 v121, v41, v117
    v_mfma_f32_16x16x32_bf16 v[8:11], a[72:75], v[72:75], v[8:11]
    s_waitcnt lgkmcnt(1)
    ds_read_b128 v[56:59], v1 offset:16384
    v_mul_f32 v120, v120, abs(v40)
    v_mfma_f32_16x16x32_bf16 v[16:19], a[72:75], v[76:79], v[16:19]
    buffer_store_dwordx4 v[48:51], v1, s[16:19], s49 offen sc1
    v_mfma_f32_16x16x32_bf16 v[20:23], a[76:79], v[76:79], v[20:23]
    v_mul_f32 v121, v121, abs(v41)
    v_cvt_pk_bf16_f32 v40, v120, v121
    v_mfma_f32_16x16x32_bf16 v[12:15], a[76:79], v[72:75], v[12:15]
    ds_read_b128 v[60:63], v1 offset:17408
    v_pk_max_i16 v40, v40, 0
    v_mfma_f32_16x16x32_bf16 v[24:27], a[80:83], v[72:75], v[24:27]
    v_mul_f32 v120, v42, v117
    v_mul_f32 v121, v43, v117
    v_mfma_f32_16x16x32_bf16 v[28:31], a[80:83], v[76:79], v[28:31]
    s_waitcnt lgkmcnt(2)
    v_mul_f32 v120, v120, abs(v42)
    v_mul_f32 v121, v121, abs(v43)
    v_mfma_f32_16x16x32_bf16 v[8:11], a[84:87], v[80:83], v[8:11]
    ds_read_b128 v[64:67], v1 offset:18432
    v_cvt_pk_bf16_f32 v41, v120, v121
    v_mfma_f32_16x16x32_bf16 v[16:19], a[84:87], v[84:87], v[16:19]
    v_pk_max_i16 v41, v41, 0
    v_mul_f32 v120, v44, v117
    v_mfma_f32_16x16x32_bf16 v[20:23], a[88:91], v[84:87], v[20:23]
    v_mul_f32 v121, v45, v117
    v_mul_f32 v120, v120, abs(v44)
    v_mfma_f32_16x16x32_bf16 v[12:15], a[88:91], v[80:83], v[12:15]
    ds_read_b128 v[68:71], v1 offset:19456
    v_mul_f32 v121, v121, abs(v45)
    v_mfma_f32_16x16x32_bf16 v[24:27], a[92:95], v[80:83], v[24:27]
    v_cvt_pk_bf16_f32 v42, v120, v121
    v_pk_max_i16 v42, v42, 0
    v_mfma_f32_16x16x32_bf16 v[28:31], a[92:95], v[84:87], v[28:31]
    s_waitcnt lgkmcnt(2)
    v_mul_f32 v120, v46, v117
    v_mul_f32 v121, v47, v117
    v_mfma_f32_16x16x32_bf16 v[8:11], a[96:99], v[56:59], v[8:11]
    ds_read_b128 v[72:75], v1 offset:20480
    v_mul_f32 v120, v120, abs(v46)
    v_mfma_f32_16x16x32_bf16 v[16:19], a[96:99], v[60:63], v[16:19]
    v_mul_f32 v121, v121, abs(v47)
    v_cvt_pk_bf16_f32 v43, v120, v121
    v_mfma_f32_16x16x32_bf16 v[20:23], a[100:103], v[60:63], v[20:23]
    v_pk_max_i16 v43, v43, 0
    v_mfma_f32_16x16x32_bf16 v[12:15], a[100:103], v[56:59], v[12:15]
    ds_read_b128 v[76:79], v1 offset:21504
    v_mfma_f32_16x16x32_bf16 v[24:27], a[104:107], v[56:59], v[24:27]
    buffer_store_dwordx4 v[40:43], v1, s[16:19], s44 offen offset:1024 sc1
    v_mfma_f32_16x16x32_bf16 v[28:31], a[104:107], v[60:63], v[28:31]
    s_waitcnt lgkmcnt(2)
    ds_read_b64 v[36:37], v118 offset:0
    s_add_u32 m0, s43, 98304
    v_mfma_f32_16x16x32_bf16 v[8:11], a[108:111], v[64:67], v[8:11]
    s_add_u32 s42, s41, 0
    ds_read_b128 v[80:83], v1 offset:22528
    v_mfma_f32_16x16x32_bf16 v[16:19], a[108:111], v[68:71], v[16:19]
    buffer_load_dwordx4 v1, s[16:19], s42 offen offset:0 sc1 lds
    v_mfma_f32_16x16x32_bf16 v[20:23], a[112:115], v[68:71], v[20:23]
    ds_read_b64 v[38:39], v118 offset:128
    v_mfma_f32_16x16x32_bf16 v[12:15], a[112:115], v[64:67], v[12:15]
    ds_read_b128 v[84:87], v1 offset:23552
    v_mfma_f32_16x16x32_bf16 v[24:27], a[116:119], v[64:67], v[24:27]
    ds_read_b64 v[40:41], v118 offset:256
    v_mfma_f32_16x16x32_bf16 v[28:31], a[116:119], v[68:71], v[28:31]
    s_waitcnt lgkmcnt(5)
    ds_read_b64 v[42:43], v118 offset:384
    v_mfma_f32_16x16x32_bf16 v[8:11], a[120:123], v[72:75], v[8:11]
    ds_read_b128 v[56:59], v1 offset:24576
    v_mfma_f32_16x16x32_bf16 v[16:19], a[120:123], v[76:79], v[16:19]
    buffer_load_dwordx4 v1, s[16:19], s42 offen offset:1024 sc1 lds
    v_mfma_f32_16x16x32_bf16 v[20:23], a[124:127], v[76:79], v[20:23]
    v_mfma_f32_16x16x32_bf16 v[12:15], a[124:127], v[72:75], v[12:15]
    ds_read_b128 v[60:63], v1 offset:25600
    v_mfma_f32_16x16x32_bf16 v[24:27], a[128:131], v[72:75], v[24:27]
    s_waitcnt lgkmcnt(2)
    v_max3_u32 v44, v36, v37, v38
    v_max3_u32 v45, v39, v40, v41
    v_mfma_f32_16x16x32_bf16 v[28:31], a[128:131], v[76:79], v[28:31]
    s_waitcnt lgkmcnt(4)
    v_max3_u32 v44, v44, v42, v43
    v_max_u32 v44, v44, v45
    v_mfma_f32_16x16x32_bf16 v[8:11], a[132:135], v[80:83], v[8:11]
    ds_read_b128 v[64:67], v1 offset:26624
    v_cmp_eq_u32 vcc, -1, v44
    v_mfma_f32_16x16x32_bf16 v[16:19], a[132:135], v[84:87], v[16:19]
    buffer_load_dwordx4 v1, s[16:19], s42 offen offset:2048 sc1 lds
    v_mfma_f32_16x16x32_bf16 v[20:23], a[136:139], v[84:87], v[20:23]
    s_cbranch_vccnz L_sspin16
L_sback17:
    v_add_f32 v44, v40, v42
    v_add_f32 v45, v41, v43
    v_mfma_f32_16x16x32_bf16 v[12:15], a[136:139], v[80:83], v[12:15]
    ds_read_b128 v[68:71], v1 offset:27648
    v_add_f32 v36, v36, v38
    v_mfma_f32_16x16x32_bf16 v[24:27], a[140:143], v[80:83], v[24:27]
    v_add_f32 v37, v37, v39
    v_add_f32 v36, v36, v44
    v_mfma_f32_16x16x32_bf16 v[28:31], a[140:143], v[84:87], v[28:31]
    s_waitcnt lgkmcnt(2)
    v_add_f32 v37, v37, v45
    v_mov_b32 v44, v36
    v_mfma_f32_16x16x32_bf16 v[8:11], a[144:147], v[56:59], v[8:11]
    ds_read_b128 v[72:75], v1 offset:28672
    v_mov_b32 v45, v37
    v_mfma_f32_16x16x32_bf16 v[16:19], a[144:147], v[60:63], v[16:19]
    buffer_load_dwordx4 v1, s[16:19], s42 offen offset:3072 sc1 lds
    v_mfma_f32_16x16x32_bf16 v[20:23], a[148:151], v[60:63], v[20:23]
    s_add_u32 m0, s43, 114688
    v_permlane32_swap_b32 v36, v44
    v_mfma_f32_16x16x32_bf16 v[12:15], a[148:151], v[56:59], v[12:15]
    s_add_u32 s42, s41, 16384
    ds_read_b128 v[76:79], v1 offset:29696
    v_mfma_f32_16x16x32_bf16 v[24:27], a[152:155], v[56:59], v[24:27]
    v_permlane32_swap_b32 v37, v45
    v_mfma_f32_16x16x32_bf16 v[28:31], a[152:155], v[60:63], v[28:31]
    s_waitcnt lgkmcnt(2)
    v_add_f32 v36, v36, v44
    v_add_f32 v37, v37, v45
    v_mfma_f32_16x16x32_bf16 v[8:11], a[156:159], v[64:67], v[8:11]
    ds_read_b128 v[80:83], v1 offset:30720
    v_mul_f32 v112, 0xba800000, v36
    v_mfma_f32_16x16x32_bf16 v[16:19], a[156:159], v[68:71], v[16:19]
    buffer_load_dwordx4 v1, s[16:19], s42 offen offset:0 sc1 lds
    v_mfma_f32_16x16x32_bf16 v[20:23], a[160:163], v[68:71], v[20:23]
    v_mul_f32 v37, 0x3a800000, v37
    v_fma_f32 v37, -v112, v112, v37
    v_mfma_f32_16x16x32_bf16 v[12:15], a[160:163], v[64:67], v[12:15]
    ds_read_b128 v[84:87], v1 offset:31744
    v_mov_b32 v113, v112
    v_mfma_f32_16x16x32_bf16 v[24:27], a[164:167], v[64:67], v[24:27]
    v_max_f32 v37, 0, v37
    v_add_f32 v37, 0x3727c5ac, v37
    v_mfma_f32_16x16x32_bf16 v[28:31], a[164:167], v[68:71], v[28:31]
    s_waitcnt lgkmcnt(2)
    v_rsq_f32 v116, v37
    v_mfma_f32_16x16x32_bf16 v[8:11], a[168:171], v[72:75], v[8:11]
    ds_read_b128 v[56:59], v1 offset:32768
    v_mfma_f32_16x16x32_bf16 v[16:19], a[168:171], v[76:79], v[16:19]
    buffer_load_dwordx4 v1, s[16:19], s42 offen offset:1024 sc1 lds
    v_mfma_f32_16x16x32_bf16 v[20:23], a[172:175], v[76:79], v[20:23]
    v_permlane16_swap_b32 v112, v113
    v_mfma_f32_16x16x32_bf16 v[12:15], a[172:175], v[72:75], v[12:15]
    s_nop 0
    ds_read_b128 v[60:63], v1 offset:33792
    v_mul_f32 v114, v37, v116
    v_mfma_f32_16x16x32_bf16 v[24:27], a[176:179], v[72:75], v[24:27]
    v_mul_f32 v116, v116, v116
    v_mov_b32 v115, v114
    v_mfma_f32_16x16x32_bf16 v[28:31], a[176:179], v[76:79], v[28:31]
    s_waitcnt lgkmcnt(2)
    v_mov_b32 v117, v116
    v_fmac_f32 v16, v113, v88
    v_mfma_f32_16x16x32_bf16 v[8:11], a[180:183], v[80:83], v[8:11]
    ds_read_b128 v[64:67], v1 offset:34816
    v_fmac_f32 v12, v112, v92
    v_mfma_f32_16x16x32_bf16 v[16:19], a[180:183], v[84:87], v[16:19]
    buffer_load_dwordx4 v1, s[16:19], s42 offen offset:2048 sc1 lds
    v_mfma_f32_16x16x32_bf16 v[20:23], a[184:187], v[84:87], v[20:23]
    v_permlane16_swap_b32 v114, v115
    v_mfma_f32_16x16x32_bf16 v[12:15], a[184:187], v[80:83], v[12:15]
    s_nop 0
    ds_read_b128 v[68:71], v1 offset:35840
    v_fmac_f32 v8, v112, v88
    v_mfma_f32_16x16x32_bf16 v[24:27], a[188:191], v[80:83], v[24:27]
    v_permlane16_swap_b32 v116, v117
    v_mfma_f32_16x16x32_bf16 v[28:31], a[188:191], v[84:87], v[28:31]
    s_waitcnt lgkmcnt(2)
    v_fmac_f32 v17, v113, v89
    v_fmac_f32 v18, v113, v90
    v_mfma_f32_16x16x32_bf16 v[8:11], a[192:195], v[56:59], v[8:11]
    s_add_u32 s46, s46, 2048
    ds_read_b128 v[72:75], v1 offset:36864
    v_fmac_f32 v13, v112, v93
    v_mfma_f32_16x16x32_bf16 v[16:19], a[192:195], v[60:63], v[16:19]
    buffer_load_dwordx4 v1, s[16:19], s42 offen offset:3072 sc1 lds
    v_mfma_f32_16x16x32_bf16 v[20:23], a[196:199], v[60:63], v[20:23]
    s_add_u32 m0, s43, 131072
    v_fmac_f32 v9, v112, v89
    v_fmac_f32 v10, v112, v90
    v_mfma_f32_16x16x32_bf16 v[12:15], a[196:199], v[56:59], v[12:15]
    s_add_u32 s42, s41, 32768
    ds_read_b128 v[76:79], v1 offset:37888
    v_fmac_f32 v11, v112, v91
    v_mfma_f32_16x16x32_bf16 v[24:27], a[200:203], v[56:59], v[24:27]
    s_min_u32 s46, s46, s55
    v_fmac_f32 v8, v114, v100
    v_fmac_f32 v9, v114, v101
    v_mfma_f32_16x16x32_bf16 v[28:31], a[200:203], v[60:63], v[28:31]
    s_waitcnt lgkmcnt(2)
    v_fmac_f32 v19, v113, v91
    v_fmac_f32 v16, v115, v100
    v_mfma_f32_16x16x32_bf16 v[8:11], a[204:207], v[64:67], v[8:11]
    ds_read_b128 v[80:83], v1 offset:38912
    v_fmac_f32 v14, v112, v94
    v_mfma_f32_16x16x32_bf16 v[16:19], a[204:207], v[68:71], v[16:19]
    buffer_load_dwordx4 v1, s[16:19], s42 offen offset:0 sc1 lds
    v_mfma_f32_16x16x32_bf16 v[20:23], a[208:211], v[68:71], v[20:23]
    v_fmac_f32 v24, v112, v96
    v_fmac_f32 v10, v114, v102
    v_mfma_f32_16x16x32_bf16 v[12:15], a[208:211], v[64:67], v[12:15]
    ds_read_b128 v[84:87], v1 offset:39936
    v_fmac_f32 v11, v114, v103
    v_mfma_f32_16x16x32_bf16 v[24:27], a[212:215], v[64:67], v[24:27]
    v_fmac_f32 v17, v115, v101
    v_fmac_f32 v18, v115, v102
    v_mfma_f32_16x16x32_bf16 v[28:31], a[212:215], v[68:71], v[28:31]
    s_waitcnt lgkmcnt(2)
    v_fmac_f32 v19, v115, v103
    v_fmac_f32 v15, v112, v95
    v_mfma_f32_16x16x32_bf16 v[8:11], a[216:219], v[72:75], v[8:11]
    ds_read_b128 v[56:59], v1 offset:40960
    v_fmac_f32 v12, v114, v104
    v_mfma_f32_16x16x32_bf16 v[16:19], a[216:219], v[76:79], v[16:19]
    buffer_load_dwordx4 v1, s[16:19], s42 offen offset:1024 sc1 lds
    v_mfma_f32_16x16x32_bf16 v[20:23], a[220:223], v[76:79], v[20:23]
    v_fmac_f32 v25, v112, v97
    v_fmac_f32 v26, v112, v98
    v_mfma_f32_16x16x32_bf16 v[12:15], a[220:223], v[72:75], v[12:15]
    ds_read_b128 v[60:63], v1 offset:41984
    v_fmac_f32 v28, v113, v96
    v_mfma_f32_16x16x32_bf16 v[24:27], a[224:227], v[72:75], v[24:27]
    v_fmac_f32 v20, v113, v92
    v_fmac_f32 v21, v113, v93
    v_mfma_f32_16x16x32_bf16 v[28:31], a[224:227], v[76:79], v[28:31]
    s_waitcnt lgkmcnt(2)
    v_fmac_f32 v13, v114, v105
    v_fmac_f32 v14, v114, v106
    v_mfma_f32_16x16x32_bf16 v[8:11], a[228:231], v[80:83], v[8:11]
    ds_read_b128 v[64:67], v1 offset:43008
    v_fmac_f32 v15, v114, v107
    v_mfma_f32_16x16x32_bf16 v[16:19], a[228:231], v[84:87], v[16:19]
    buffer_load_dwordx4 v1, s[16:19], s42 offen offset:2048 sc1 lds
    v_mfma_f32_16x16x32_bf16 v[20:23], a[232:235], v[84:87], v[20:23]
    v_fmac_f32 v27, v112, v99
    v_fmac_f32 v24, v114, v108
    v_mfma_f32_16x16x32_bf16 v[12:15], a[232:235], v[80:83], v[12:15]
    ds_read_b128 v[68:71], v1 offset:44032
    v_fmac_f32 v29, v113, v97
    v_mfma_f32_16x16x32_bf16 v[24:27], a[236:239], v[80:83], v[24:27]
    s_waitcnt vmcnt(7)
    v_fmac_f32 v22, v113, v94
    v_fmac_f32 v23, v113, v95
    v_mfma_f32_16x16x32_bf16 v[28:31], a[236:239], v[84:87], v[28:31]
    s_waitcnt lgkmcnt(2)
    v_fmac_f32 v20, v115, v104
    v_fmac_f32 v21, v115, v105
    v_mfma_f32_16x16x32_bf16 v[8:11], a[240:243], v[56:59], v[8:11]
    s_barrier
    ds_read_b128 v[72:75], v1 offset:45056
    v_fmac_f32 v22, v115, v106
    v_mfma_f32_16x16x32_bf16 v[16:19], a[240:243], v[60:63], v[16:19]
    buffer_store_dword v124, v124, s[16:19], s91 offen sc1
    v_mfma_f32_16x16x32_bf16 v[20:23], a[244:247], v[60:63], v[20:23]
    buffer_load_dwordx4 v1, s[16:19], s42 offen offset:3072 sc1 lds
    v_mfma_f32_16x16x32_bf16 v[12:15], a[244:247], v[56:59], v[12:15]
    s_add_u32 s91, s91, 65536
    ds_read_b128 v[76:79], v1 offset:46080
    v_fmac_f32 v30, v113, v98
    v_mfma_f32_16x16x32_bf16 v[24:27], a[248:251], v[56:59], v[24:27]
    s_add_u32 m0, s43, 147456
    v_fmac_f32 v23, v115, v107
    s_add_u32 s42, s41, 49152
    v_mfma_f32_16x16x32_bf16 v[28:31], a[248:251], v[60:63], v[28:31]
    s_waitcnt lgkmcnt(2)
    v_mfma_f32_16x16x32_bf16 v[8:11], a[252:255], v[64:67], v[8:11]
    ds_read_b128 v[80:83], v1 offset:47104
    v_fmac_f32 v25, v114, v109
    v_mfma_f32_16x16x32_bf16 v[16:19], a[252:255], v[68:71], v[16:19]
    v_fmac_f32 v26, v114, v110
    v_fmac_f32 v27, v114, v111
    v_mfma_f32_16x16x32_bf16 v[20:23], v[128:131], v[68:71], v[20:23]
    buffer_load_dwordx4 v1, s[16:19], s42 offen offset:0 sc1 lds
    v_mfma_f32_16x16x32_bf16 v[12:15], v[128:131], v[64:67], v[12:15]
    ds_read_b128 v[84:87], v1 offset:48128
    v_fmac_f32 v31, v113, v99
    v_mfma_f32_16x16x32_bf16 v[24:27], v[132:135], v[64:67], v[24:27]
    v_mfma_f32_16x16x32_bf16 v[28:31], v[132:135], v[68:71], v[28:31]
    s_waitcnt lgkmcnt(2)
    v_mfma_f32_16x16x32_bf16 v[8:11], v[136:139], v[72:75], v[8:11]
    ds_read_b128 v[56:59], v1 offset:49152
    v_mfma_f32_16x16x32_bf16 v[16:19], v[136:139], v[76:79], v[16:19]
    v_mfma_f32_16x16x32_bf16 v[20:23], v[140:143], v[76:79], v[20:23]
    buffer_load_dwordx4 v1, s[16:19], s42 offen offset:1024 sc1 lds
    v_mfma_f32_16x16x32_bf16 v[12:15], v[140:143], v[72:75], v[12:15]
    ds_read_b128 v[60:63], v1 offset:50176
    v_fmac_f32 v28, v115, v108
    v_mfma_f32_16x16x32_bf16 v[24:27], v[144:147], v[72:75], v[24:27]
    v_mfma_f32_16x16x32_bf16 v[28:31], v[144:147], v[76:79], v[28:31]
    s_waitcnt lgkmcnt(2)
    v_mfma_f32_16x16x32_bf16 v[8:11], v[148:151], v[80:83], v[8:11]
    ds_read_b128 v[64:67], v1 offset:51200
    v_mfma_f32_16x16x32_bf16 v[16:19], v[148:151], v[84:87], v[16:19]
    v_mfma_f32_16x16x32_bf16 v[20:23], v[152:155], v[84:87], v[20:23]
    buffer_load_dwordx4 v1, s[16:19], s42 offen offset:2048 sc1 lds
    v_mfma_f32_16x16x32_bf16 v[12:15], v[152:155], v[80:83], v[12:15]
    ds_read_b128 v[68:71], v1 offset:52224
    v_fmac_f32 v29, v115, v109
    v_mfma_f32_16x16x32_bf16 v[24:27], v[156:159], v[80:83], v[24:27]
    v_mfma_f32_16x16x32_bf16 v[28:31], v[156:159], v[84:87], v[28:31]
    s_waitcnt lgkmcnt(2)
    v_mfma_f32_16x16x32_bf16 v[8:11], v[160:163], v[56:59], v[8:11]
    ds_read_b128 v[72:75], v1 offset:53248
    v_mfma_f32_16x16x32_bf16 v[16:19], v[160:163], v[60:63], v[16:19]
    v_mfma_f32_16x16x32_bf16 v[20:23], v[164:167], v[60:63], v[20:23]
    buffer_load_dwordx4 v1, s[16:19], s42 offen offset:3072 sc1 lds
    v_mfma_f32_16x16x32_bf16 v[12:15], v[164:167], v[56:59], v[12:15]
    s_add_u32 m0, s52, 73728
    ds_read_b128 v[76:79], v1 offset:54272
    v_fmac_f32 v30, v115, v110
    v_mfma_f32_16x16x32_bf16 v[24:27], v[168:171], v[56:59], v[24:27]
    s_add_u32 s42, s46, s52
    v_mfma_f32_16x16x32_bf16 v[28:31], v[168:171], v[60:63], v[28:31]
    s_waitcnt lgkmcnt(2)
    v_mfma_f32_16x16x32_bf16 v[8:11], v[172:175], v[64:67], v[8:11]
    ds_read_b128 v[80:83], v1 offset:55296
    v_mfma_f32_16x16x32_bf16 v[16:19], v[172:175], v[68:71], v[16:19]
    buffer_load_dwordx4 v1, s[16:19], s42 offen sc1 lds
    v_mfma_f32_16x16x32_bf16 v[20:23], v[176:179], v[68:71], v[20:23]
    v_fmac_f32 v31, v115, v111
    v_mfma_f32_16x16x32_bf16 v[12:15], v[176:179], v[64:67], v[12:15]
    ds_read_b128 v[84:87], v1 offset:56320
    v_mfma_f32_16x16x32_bf16 v[24:27], v[180:183], v[64:67], v[24:27]
    v_mfma_f32_16x16x32_bf16 v[28:31], v[180:183], v[68:71], v[28:31]
    s_waitcnt lgkmcnt(2)
    v_mfma_f32_16x16x32_bf16 v[8:11], v[184:187], v[72:75], v[8:11]
    ds_read_b128 v[56:59], v1 offset:57344
    v_mfma_f32_16x16x32_bf16 v[16:19], v[184:187], v[76:79], v[16:19]
    v_mfma_f32_16x16x32_bf16 v[20:23], v[188:191], v[76:79], v[20:23]
    v_mfma_f32_16x16x32_bf16 v[12:15], v[188:191], v[72:75], v[12:15]
    ds_read_b128 v[60:63], v1 offset:58368
    v_mfma_f32_16x16x32_bf16 v[24:27], v[192:195], v[72:75], v[24:27]
    v_mfma_f32_16x16x32_bf16 v[28:31], v[192:195], v[76:79], v[28:31]
    s_waitcnt lgkmcnt(2)
    v_mfma_f32_16x16x32_bf16 v[8:11], v[196:199], v[80:83], v[8:11]
    ds_read_b128 v[64:67], v1 offset:59392
    v_mfma_f32_16x16x32_bf16 v[16:19], v[196:199], v[84:87], v[16:19]
    v_mfma_f32_16x16x32_bf16 v[20:23], v[200:203], v[84:87], v[20:23]
    v_mfma_f32_16x16x32_bf16 v[12:15], v[200:203], v[80:83], v[12:15]
    ds_read_b128 v[68:71], v1 offset:60416
    v_mfma_f32_16x16x32_bf16 v[24:27], v[204:207], v[80:83], v[24:27]
    v_mfma_f32_16x16x32_bf16 v[28:31], v[204:207], v[84:87], v[28:31]
    s_waitcnt lgkmcnt(2)
    v_mfma_f32_16x16x32_bf16 v[8:11], v[208:211], v[56:59], v[8:11]
    ds_read_b128 v[72:75], v1 offset:61440
    v_mfma_f32_16x16x32_bf16 v[16:19], v[208:211], v[60:63], v[16:19]
    v_mfma_f32_16x16x32_bf16 v[20:23], v[212:215], v[60:63], v[20:23]
    buffer_load_dword v7, v5, s[16:19], s45 offen sc1
    v_mfma_f32_16x16x32_bf16 v[12:15], v[212:215], v[56:59], v[12:15]
    ds_read_b128 v[76:79], v1 offset:62464
    v_mfma_f32_16x16x32_bf16 v[24:27], v[216:219], v[56:59], v[24:27]
    v_mfma_f32_16x16x32_bf16 v[28:31], v[216:219], v[60:63], v[28:31]
    s_waitcnt lgkmcnt(2)
    v_mfma_f32_16x16x32_bf16 v[8:11], v[220:223], v[64:67], v[8:11]
    ds_read_b128 v[80:83], v1 offset:63488
    v_mfma_f32_16x16x32_bf16 v[16:19], v[220:223], v[68:71], v[16:19]
    v_mfma_f32_16x16x32_bf16 v[20:23], v[224:227], v[68:71], v[20:23]
    v_mfma_f32_16x16x32_bf16 v[12:15], v[224:227], v[64:67], v[12:15]
    ds_read_b128 v[84:87], v1 offset:64512
    v_mfma_f32_16x16x32_bf16 v[24:27], v[228:231], v[64:67], v[24:27]
    v_mfma_f32_16x16x32_bf16 v[28:31], v[228:231], v[68:71], v[28:31]
    s_waitcnt lgkmcnt(2)
    v_mfma_f32_16x16x32_bf16 v[8:11], v[232:235], v[72:75], v[8:11]
    ds_read_b128 v[56:59], v2 offset:0
    v_mfma_f32_16x16x32_bf16 v[16:19], v[232:235], v[76:79], v[16:19]
    v_mfma_f32_16x16x32_bf16 v[20:23], v[236:239], v[76:79], v[20:23]
    v_mfma_f32_16x16x32_bf16 v[12:15], v[236:239], v[72:75], v[12:15]
    ds_read_b128 v[60:63], v2 offset:1024
    v_mfma_f32_16x16x32_bf16 v[24:27], v[240:243], v[72:75], v[24:27]
    v_mfma_f32_16x16x32_bf16 v[28:31], v[240:243], v[76:79], v[28:31]
    s_waitcnt lgkmcnt(2)
    v_mfma_f32_16x16x32_bf16 v[8:11], v[244:247], v[80:83], v[8:11]
    ds_read_b128 v[64:67], v2 offset:2048
    v_mfma_f32_16x16x32_bf16 v[16:19], v[244:247], v[84:87], v[16:19]
    v_mfma_f32_16x16x32_bf16 v[20:23], v[248:251], v[84:87], v[20:23]
    v_mfma_f32_16x16x32_bf16 v[12:15], v[248:251], v[80:83], v[12:15]
    ds_read_b128 v[68:71], v2 offset:3072
    v_mfma_f32_16x16x32_bf16 v[24:27], v[252:255], v[80:83], v[24:27]
    s_add_u32 s36, s36, 1
    v_mfma_f32_16x16x32_bf16 v[28:31], v[252:255], v[84:87], v[28:31]
    s_waitcnt lgkmcnt(2)
L_a_b1:
    v_mfma_f32_16x16x32_bf16 v[32:35], a[0:3], v[56:59], 0
    s_and_b32 s44, s90, 0xffffffff
    ds_read_b128 v[72:75], v2 offset:4096
    v_mul_f32 v120, v24, v116
    v_mfma_f32_16x16x32_bf16 v[40:43], a[0:3], v[60:63], 0
    s_cmp_lt_i32 s36, 1
    v_mul_f32 v121, v25, v116
    v_mul_f32 v120, v120, abs(v24)
    v_mfma_f32_16x16x32_bf16 v[44:47], a[4:7], v[60:63], 0
    s_cselect_b32 s44, 0x5e00000, s44
    v_mul_f32 v121, v121, abs(v25)
    v_cvt_pk_bf16_f32 v24, v120, v121
    v_mfma_f32_16x16x32_bf16 v[36:39], a[4:7], v[56:59], 0
    s_add_u32 s49, s44, s87
    ds_read_b128 v[76:79], v2 offset:5120
    v_pk_max_i16 v24, v24, 0
    v_mfma_f32_16x16x32_bf16 v[48:51], a[8:11], v[56:59], 0
    s_max_u32 s44, s44, s88
    v_mul_f32 v120, v26, v116
    v_mul_f32 v121, v27, v116
    v_mfma_f32_16x16x32_bf16 v[52:55], a[8:11], v[60:63], 0
    s_waitcnt lgkmcnt(2)
    v_mul_f32 v120, v120, abs(v26)
    v_mul_f32 v121, v121, abs(v27)
    v_mfma_f32_16x16x32_bf16 v[32:35], a[12:15], v[64:67], v[32:35]
    s_add_u32 s90, s90, 262144
    ds_read_b128 v[80:83], v2 offset:6144
    v_cvt_pk_bf16_f32 v25, v120, v121
    v_mfma_f32_16x16x32_bf16 v[40:43], a[12:15], v[68:71], v[40:43]
    s_add_u32 s98, s98, 65536
    v_pk_max_i16 v25, v25, 0
    s_min_i32 s98, s98, s96
    v_mfma_f32_16x16x32_bf16 v[44:47], a[16:19], v[68:71], v[44:47]
    s_and_b32 s41, s98, 0xffffffff
    ds_write_b64 v3, v[24:25] offset:0
    v_mfma_f32_16x16x32_bf16 v[36:39], a[16:19], v[64:67], v[36:39]
    ds_read_b128 v[84:87], v2 offset:7168
    v_mul_f32 v120, v28, v117
    v_mfma_f32_16x16x32_bf16 v[48:51], a[20:23], v[64:67], v[48:51]
    v_mul_f32 v121, v29, v117
    v_mul_f32 v120, v120, abs(v28)
    v_mfma_f32_16x16x32_bf16 v[52:55], a[20:23], v[68:71], v[52:55]
    s_waitcnt lgkmcnt(3)
    v_mul_f32 v121, v121, abs(v29)
    v_cvt_pk_bf16_f32 v28, v120, v121
    v_mfma_f32_16x16x32_bf16 v[32:35], a[24:27], v[72:75], v[32:35]
    ds_read_b128 v[56:59], v2 offset:8192
    v_pk_max_i16 v28, v28, 0
    v_mfma_f32_16x16x32_bf16 v[40:43], a[24:27], v[76:79], v[40:43]
    v_mul_f32 v120, v30, v117
    v_mul_f32 v121, v31, v117
    v_mfma_f32_16x16x32_bf16 v[44:47], a[28:31], v[76:79], v[44:47]
    v_mul_f32 v120, v120, abs(v30)
    v_mul_f32 v121, v121, abs(v31)
    v_mfma_f32_16x16x32_bf16 v[36:39], a[28:31], v[72:75], v[36:39]
    ds_read_b128 v[60:63], v2 offset:9216
    v_cvt_pk_bf16_f32 v29, v120, v121
    v_mfma_f32_16x16x32_bf16 v[48:51], a[32:35], v[72:75], v[48:51]
    v_pk_max_i16 v29, v29, 0
    v_mfma_f32_16x16x32_bf16 v[52:55], a[32:35], v[76:79], v[52:55]
    s_waitcnt lgkmcnt(2)
    ds_write_b64 v3, v[28:29] offset:1024
    v_mfma_f32_16x16x32_bf16 v[32:35], a[36:39], v[80:83], v[32:35]
    ds_read_b128 v[64:67], v2 offset:10240
    v_mul_f32 v120, v8, v116
    v_mfma_f32_16x16x32_bf16 v[40:43], a[36:39], v[84:87], v[40:43]
    v_mul_f32 v121, v9, v116
    v_mul_f32 v120, v120, abs(v8)
    v_mfma_f32_16x16x32_bf16 v[44:47], a[40:43], v[84:87], v[44:47]
    v_mul_f32 v121, v121, abs(v9)
    v_cvt_pk_bf16_f32 v8, v120, v121
    v_mfma_f32_16x16x32_bf16 v[36:39], a[40:43], v[80:83], v[36:39]
    ds_read_b128 v[68:71], v2 offset:11264
    v_pk_max_i16 v8, v8, 0
    v_mfma_f32_16x16x32_bf16 v[48:51], a[44:47], v[80:83], v[48:51]
    v_mul_f32 v120, v10, v116
    v_mul_f32 v121, v11, v116
    v_mfma_f32_16x16x32_bf16 v[52:55], a[44:47], v[84:87], v[52:55]
    s_waitcnt lgkmcnt(3)
    v_mul_f32 v120, v120, abs(v10)
    v_mul_f32 v121, v121, abs(v11)
    v_mfma_f32_16x16x32_bf16 v[32:35], a[48:51], v[56:59], v[32:35]
    ds_read_b128 v[72:75], v2 offset:12288
    v_cvt_pk_bf16_f32 v9, v120, v121
    v_mfma_f32_16x16x32_bf16 v[40:43], a[48:51], v[60:63], v[40:43]
    s_waitcnt vmcnt(0)
    v_cmp_ne_u32 vcc, 0, v7
    v_pk_max_i16 v9, v9, 0
    v_mfma_f32_16x16x32_bf16 v[44:47], a[52:55], v[60:63], v[44:47]
    v_mul_f32 v120, v12, v116
    v_mul_f32 v121, v13, v116
    v_mfma_f32_16x16x32_bf16 v[36:39], a[52:55], v[56:59], v[36:39]
    s_cbranch_vccnz L_spin18
L_back19:
    ds_read_b128 v[76:79], v2 offset:13312
    v_mul_f32 v120, v120, abs(v12)
    v_mfma_f32_16x16x32_bf16 v[48:51], a[56:59], v[56:59], v[48:51]
    s_waitcnt lgkmcnt(4)
    v_mul_f32 v121, v121, abs(v13)
    v_cvt_pk_bf16_f32 v10, v120, v121
    v_mfma_f32_16x16x32_bf16 v[52:55], a[56:59], v[60:63], v[52:55]
    s_waitcnt lgkmcnt(2)
    v_pk_max_i16 v10, v10, 0
    v_mul_f32 v120, v14, v116
    v_mfma_f32_16x16x32_bf16 v[32:35], a[60:63], v[64:67], v[32:35]
    s_barrier
    ds_read_b128 v[80:83], v2 offset:14336
    v_mul_f32 v121, v15, v116
    v_mfma_f32_16x16x32_bf16 v[40:43], a[60:63], v[68:71], v[40:43]
    s_add_u32 s45, s45, 65536
    ds_read_b128 v[24:27], v4 offset:0
    v_mul_f32 v120, v120, abs(v14)
    v_mfma_f32_16x16x32_bf16 v[44:47], a[64:67], v[68:71], v[44:47]
    v_mul_f32 v121, v121, abs(v15)
    v_cvt_pk_bf16_f32 v11, v120, v121
    v_mfma_f32_16x16x32_bf16 v[36:39], a[64:67], v[64:67], v[36:39]
    ds_read_b128 v[84:87], v2 offset:15360
    v_pk_max_i16 v11, v11, 0
    v_mfma_f32_16x16x32_bf16 v[48:51], a[68:71], v[64:67], v[48:51]
    buffer_store_dwordx4 v[8:11], v1, s[16:19], s44 offen offset:0 sc1
    v_mfma_f32_16x16x32_bf16 v[52:55], a[68:71], v[68:71], v[52:55]
    s_waitcnt lgkmcnt(3)
    v_mul_f32 v120, v16, v117
    v_mul_f32 v121, v17, v117
    v_mfma_f32_16x16x32_bf16 v[32:35], a[72:75], v[72:75], v[32:35]
    s_waitcnt lgkmcnt(1)
    ds_read_b128 v[56:59], v2 offset:16384
    v_mul_f32 v120, v120, abs(v16)
    v_mfma_f32_16x16x32_bf16 v[40:43], a[72:75], v[76:79], v[40:43]
    buffer_store_dwordx4 v[24:27], v1, s[16:19], s49 offen sc1
    v_mfma_f32_16x16x32_bf16 v[44:47], a[76:79], v[76:79], v[44:47]
    v_mul_f32 v121, v121, abs(v17)
    v_cvt_pk_bf16_f32 v16, v120, v121
    v_mfma_f32_16x16x32_bf16 v[36:39], a[76:79], v[72:75], v[36:39]
    ds_read_b128 v[60:63], v2 offset:17408
    v_pk_max_i16 v16, v16, 0
    v_mfma_f32_16x16x32_bf16 v[48:51], a[80:83], v[72:75], v[48:51]
    v_mul_f32 v120, v18, v117
    v_mul_f32 v121, v19, v117
    v_mfma_f32_16x16x32_bf16 v[52:55], a[80:83], v[76:79], v[52:55]
    s_waitcnt lgkmcnt(2)
    v_mul_f32 v120, v120, abs(v18)
    v_mul_f32 v121, v121, abs(v19)
    v_mfma_f32_16x16x32_bf16 v[32:35], a[84:87], v[80:83], v[32:35]
    ds_read_b128 v[64:67], v2 offset:18432
    v_cvt_pk_bf16_f32 v17, v120, v121
    v_mfma_f32_16x16x32_bf16 v[40:43], a[84:87], v[84:87], v[40:43]
    v_pk_max_i16 v17, v17, 0
    v_mul_f32 v120, v20, v117
    v_mfma_f32_16x16x32_bf16 v[44:47], a[88:91], v[84:87], v[44:47]
    v_mul_f32 v121, v21, v117
    v_mul_f32 v120, v120, abs(v20)
    v_mfma_f32_16x16x32_bf16 v[36:39], a[88:91], v[80:83], v[36:39]
    ds_read_b128 v[68:71], v2 offset:19456
    v_mul_f32 v121, v121, abs(v21)
    v_mfma_f32_16x16x32_bf16 v[48:51], a[92:95], v[80:83], v[48:51]
    v_cvt_pk_bf16_f32 v18, v120, v121
    v_pk_max_i16 v18, v18, 0
    v_mfma_f32_16x16x32_bf16 v[52:55], a[92:95], v[84:87], v[52:55]
    s_waitcnt lgkmcnt(2)
    v_mul_f32 v120, v22, v117
    v_mul_f32 v121, v23, v117
    v_mfma_f32_16x16x32_bf16 v[32:35], a[96:99], v[56:59], v[32:35]
    ds_read_b128 v[72:75], v2 offset:20480
    v_mul_f32 v120, v120, abs(v22)
    v_mfma_f32_16x16x32_bf16 v[40:43], a[96:99], v[60:63], v[40:43]
    v_mul_f32 v121, v121, abs(v23)
    v_cvt_pk_bf16_f32 v19, v120, v121
    v_mfma_f32_16x16x32_bf16 v[44:47], a[100:103], v[60:63], v[44:47]
    v_pk_max_i16 v19, v19, 0
    v_mfma_f32_16x16x32_bf16 v[36:39], a[100:103], v[56:59], v[36:39]
    ds_read_b128 v[76:79], v2 offset:21504
    v_mfma_f32_16x16x32_bf16 v[48:51], a[104:107], v[56:59], v[48:51]
    buffer_store_dwordx4 v[16:19], v1, s[16:19], s44 offen offset:1024 sc1
    v_mfma_f32_16x16x32_bf16 v[52:55], a[104:107], v[60:63], v[52:55]
    s_waitcnt lgkmcnt(2)
    ds_read_b64 v[12:13], v118 offset:0
    s_add_u32 m0, s43, 0
    v_mfma_f32_16x16x32_bf16 v[32:35], a[108:111], v[64:67], v[32:35]
    s_add_u32 s42, s41, 0
    ds_read_b128 v[80:83], v2 offset:22528
    v_mfma_f32_16x16x32_bf16 v[40:43], a[108:111], v[68:71], v[40:43]
    buffer_load_dwordx4 v1, s[16:19], s42 offen offset:0 sc1 lds
    v_mfma_f32_16x16x32_bf16 v[44:47], a[112:115], v[68:71], v[44:47]
    ds_read_b64 v[14:15], v118 offset:128
    v_mfma_f32_16x16x32_bf16 v[36:39], a[112:115], v[64:67], v[36:39]
    ds_read_b128 v[84:87], v2 offset:23552
    v_mfma_f32_16x16x32_bf16 v[48:51], a[116:119], v[64:67], v[48:51]
    ds_read_b64 v[16:17], v118 offset:256
    v_mfma_f32_16x16x32_bf16 v[52:55], a[116:119], v[68:71], v[52:55]
    s_waitcnt lgkmcnt(5)
    ds_read_b64 v[18:19], v118 offset:384
    v_mfma_f32_16x16x32_bf16 v[32:35], a[120:123], v[72:75], v[32:35]
    ds_read_b128 v[56:59], v2 offset:24576
    v_mfma_f32_16x16x32_bf16 v[40:43], a[120:123], v[76:79], v[40:43]
    buffer_load_dwordx4 v1, s[16:19], s42 offen offset:1024 sc1 lds
    v_mfma_f32_16x16x32_bf16 v[44:47], a[124:127], v[76:79], v[44:47]
    v_mfma_f32_16x16x32_bf16 v[36:39], a[124:127], v[72:75], v[36:39]
    ds_read_b128 v[60:63], v2 offset:25600
    v_mfma_f32_16x16x32_bf16 v[48:51], a[128:131], v[72:75], v[48:51]
    s_waitcnt lgkmcnt(2)
    v_max3_u32 v20, v12, v13, v14
    v_max3_u32 v21, v15, v16, v17
    v_mfma_f32_16x16x32_bf16 v[52:55], a[128:131], v[76:79], v[52:55]
    s_waitcnt lgkmcnt(4)
    v_max3_u32 v20, v20, v18, v19
    v_max_u32 v20, v20, v21
    v_mfma_f32_16x16x32_bf16 v[32:35], a[132:135], v[80:83], v[32:35]
    ds_read_b128 v[64:67], v2 offset:26624
    v_cmp_eq_u32 vcc, -1, v20
    v_mfma_f32_16x16x32_bf16 v[40:43], a[132:135], v[84:87], v[40:43]
    buffer_load_dwordx4 v1, s[16:19], s42 offen offset:2048 sc1 lds
    v_mfma_f32_16x16x32_bf16 v[44:47], a[136:139], v[84:87], v[44:47]
    s_cbranch_vccnz L_sspin20
L_sback21:
    v_add_f32 v20, v16, v18
    v_add_f32 v21, v17, v19
    v_mfma_f32_16x16x32_bf16 v[36:39], a[136:139], v[80:83], v[36:39]
    ds_read_b128 v[68:71], v2 offset:27648
    v_add_f32 v12, v12, v14
    v_mfma_f32_16x16x32_bf16 v[48:51], a[140:143], v[80:83], v[48:51]
    v_add_f32 v13, v13, v15
    v_add_f32 v12, v12, v20
    v_mfma_f32_16x16x32_bf16 v[52:55], a[140:143], v[84:87], v[52:55]
    s_waitcnt lgkmcnt(2)
    v_add_f32 v13, v13, v21
    v_mov_b32 v20, v12
    v_mfma_f32_16x16x32_bf16 v[32:35], a[144:147], v[56:59], v[32:35]
    ds_read_b128 v[72:75], v2 offset:28672
    v_mov_b32 v21, v13
    v_mfma_f32_16x16x32_bf16 v[40:43], a[144:147], v[60:63], v[40:43]
    buffer_load_dwordx4 v1, s[16:19], s42 offen offset:3072 sc1 lds
    v_mfma_f32_16x16x32_bf16 v[44:47], a[148:151], v[60:63], v[44:47]
    s_add_u32 m0, s43, 16384
    v_permlane32_swap_b32 v12, v20
    v_mfma_f32_16x16x32_bf16 v[36:39], a[148:151], v[56:59], v[36:39]
    s_add_u32 s42, s41, 16384
    ds_read_b128 v[76:79], v2 offset:29696
    v_mfma_f32_16x16x32_bf16 v[48:51], a[152:155], v[56:59], v[48:51]
    v_permlane32_swap_b32 v13, v21
    v_mfma_f32_16x16x32_bf16 v[52:55], a[152:155], v[60:63], v[52:55]
    s_waitcnt lgkmcnt(2)
    v_add_f32 v12, v12, v20
    v_add_f32 v13, v13, v21
    v_mfma_f32_16x16x32_bf16 v[32:35], a[156:159], v[64:67], v[32:35]
    ds_read_b128 v[80:83], v2 offset:30720
    v_mul_f32 v112, 0xba800000, v12
    v_mfma_f32_16x16x32_bf16 v[40:43], a[156:159], v[68:71], v[40:43]
    buffer_load_dwordx4 v1, s[16:19], s42 offen offset:0 sc1 lds
    v_mfma_f32_16x16x32_bf16 v[44:47], a[160:163], v[68:71], v[44:47]
    v_mul_f32 v13, 0x3a800000, v13
    v_fma_f32 v13, -v112, v112, v13
    v_mfma_f32_16x16x32_bf16 v[36:39], a[160:163], v[64:67], v[36:39]
    ds_read_b128 v[84:87], v2 offset:31744
    v_mov_b32 v113, v112
    v_mfma_f32_16x16x32_bf16 v[48:51], a[164:167], v[64:67], v[48:51]
    v_max_f32 v13, 0, v13
    v_add_f32 v13, 0x3727c5ac, v13
    v_mfma_f32_16x16x32_bf16 v[52:55], a[164:167], v[68:71], v[52:55]
    s_waitcnt lgkmcnt(2)
    v_rsq_f32 v116, v13
    v_mfma_f32_16x16x32_bf16 v[32:35], a[168:171], v[72:75], v[32:35]
    ds_read_b128 v[56:59], v2 offset:32768
    v_mfma_f32_16x16x32_bf16 v[40:43], a[168:171], v[76:79], v[40:43]
    buffer_load_dwordx4 v1, s[16:19], s42 offen offset:1024 sc1 lds
    v_mfma_f32_16x16x32_bf16 v[44:47], a[172:175], v[76:79], v[44:47]
    v_permlane16_swap_b32 v112, v113
    v_mfma_f32_16x16x32_bf16 v[36:39], a[172:175], v[72:75], v[36:39]
    s_nop 0
    ds_read_b128 v[60:63], v2 offset:33792
    v_mul_f32 v114, v13, v116
    v_mfma_f32_16x16x32_bf16 v[48:51], a[176:179], v[72:75], v[48:51]
    v_mul_f32 v116, v116, v116
    v_mov_b32 v115, v114
    v_mfma_f32_16x16x32_bf16 v[52:55], a[176:179], v[76:79], v[52:55]
    s_waitcnt lgkmcnt(2)
    v_mov_b32 v117, v116
    v_fmac_f32 v40, v113, v88
    v_mfma_f32_16x16x32_bf16 v[32:35], a[180:183], v[80:83], v[32:35]
    ds_read_b128 v[64:67], v2 offset:34816
    v_fmac_f32 v36, v112, v92
    v_mfma_f32_16x16x32_bf16 v[40:43], a[180:183], v[84:87], v[40:43]
    buffer_load_dwordx4 v1, s[16:19], s42 offen offset:2048 sc1 lds
    v_mfma_f32_16x16x32_bf16 v[44:47], a[184:187], v[84:87], v[44:47]
    v_permlane16_swap_b32 v114, v115
    v_mfma_f32_16x16x32_bf16 v[36:39], a[184:187], v[80:83], v[36:39]
    s_nop 0
    ds_read_b128 v[68:71], v2 offset:35840
    v_fmac_f32 v32, v112, v88
    v_mfma_f32_16x16x32_bf16 v[48:51], a[188:191], v[80:83], v[48:51]
    v_permlane16_swap_b32 v116, v117
    v_mfma_f32_16x16x32_bf16 v[52:55], a[188:191], v[84:87], v[52:55]
    s_waitcnt lgkmcnt(2)
    v_fmac_f32 v41, v113, v89
    v_fmac_f32 v42, v113, v90
    v_mfma_f32_16x16x32_bf16 v[32:35], a[192:195], v[56:59], v[32:35]
    s_add_u32 s46, s46, 2048
    ds_read_b128 v[72:75], v2 offset:36864
    v_fmac_f32 v37, v112, v93
    v_mfma_f32_16x16x32_bf16 v[40:43], a[192:195], v[60:63], v[40:43]
    buffer_load_dwordx4 v1, s[16:19], s42 offen offset:3072 sc1 lds
    v_mfma_f32_16x16x32_bf16 v[44:47], a[196:199], v[60:63], v[44:47]
    s_add_u32 m0, s43, 32768
    v_fmac_f32 v33, v112, v89
    v_fmac_f32 v34, v112, v90
    v_mfma_f32_16x16x32_bf16 v[36:39], a[196:199], v[56:59], v[36:39]
    s_add_u32 s42, s41, 32768
    ds_read_b128 v[76:79], v2 offset:37888
    v_fmac_f32 v35, v112, v91
    v_mfma_f32_16x16x32_bf16 v[48:51], a[200:203], v[56:59], v[48:51]
    s_min_u32 s46, s46, s55
    v_fmac_f32 v32, v114, v100
    v_fmac_f32 v33, v114, v101
    v_mfma_f32_16x16x32_bf16 v[52:55], a[200:203], v[60:63], v[52:55]
    s_waitcnt lgkmcnt(2)
    v_fmac_f32 v43, v113, v91
    v_fmac_f32 v40, v115, v100
    v_mfma_f32_16x16x32_bf16 v[32:35], a[204:207], v[64:67], v[32:35]
    ds_read_b128 v[80:83], v2 offset:38912
    v_fmac_f32 v38, v112, v94
    v_mfma_f32_16x16x32_bf16 v[40:43], a[204:207], v[68:71], v[40:43]
    buffer_load_dwordx4 v1, s[16:19], s42 offen offset:0 sc1 lds
    v_mfma_f32_16x16x32_bf16 v[44:47], a[208:211], v[68:71], v[44:47]
    v_fmac_f32 v48, v112, v96
    v_fmac_f32 v34, v114, v102
    v_mfma_f32_16x16x32_bf16 v[36:39], a[208:211], v[64:67], v[36:39]
    ds_read_b128 v[84:87], v2 offset:39936
    v_fmac_f32 v35, v114, v103
    v_mfma_f32_16x16x32_bf16 v[48:51], a[212:215], v[64:67], v[48:51]
    v_fmac_f32 v41, v115, v101
    v_fmac_f32 v42, v115, v102
    v_mfma_f32_16x16x32_bf16 v[52:55], a[212:215], v[68:71], v[52:55]
    s_waitcnt lgkmcnt(2)
    v_fmac_f32 v43, v115, v103
    v_fmac_f32 v39, v112, v95
    v_mfma_f32_16x16x32_bf16 v[32:35], a[216:219], v[72:75], v[32:35]
    ds_read_b128 v[56:59], v2 offset:40960
    v_fmac_f32 v36, v114, v104
    v_mfma_f32_16x16x32_bf16 v[40:43], a[216:219], v[76:79], v[40:43]
    buffer_load_dwordx4 v1, s[16:19], s42 offen offset:1024 sc1 lds
    v_mfma_f32_16x16x32_bf16 v[44:47], a[220:223], v[76:79], v[44:47]
    v_fmac_f32 v49, v112, v97
    v_fmac_f32 v50, v112, v98
    v_mfma_f32_16x16x32_bf16 v[36:39], a[220:223], v[72:75], v[36:39]
    ds_read_b128 v[60:63], v2 offset:41984
    v_fmac_f32 v52, v113, v96
    v_mfma_f32_16x16x32_bf16 v[48:51], a[224:227], v[72:75], v[48:51]
    v_fmac_f32 v44, v113, v92
    v_fmac_f32 v45, v113, v93
    v_mfma_f32_16x16x32_bf16 v[52:55], a[224:227], v[76:79], v[52:55]
    s_waitcnt lgkmcnt(2)
    v_fmac_f32 v37, v114, v105
    v_fmac_f32 v38, v114, v106
    v_mfma_f32_16x16x32_bf16 v[32:35], a[228:231], v[80:83], v[32:35]
    ds_read_b128 v[64:67], v2 offset:43008
    v_fmac_f32 v39, v114, v107
    v_mfma_f32_16x16x32_bf16 v[40:43], a[228:231], v[84:87], v[40:43]
    buffer_load_dwordx4 v1, s[16:19], s42 offen offset:2048 sc1 lds
    v_mfma_f32_16x16x32_bf16 v[44:47], a[232:235], v[84:87], v[44:47]
    v_fmac_f32 v51, v112, v99
    v_fmac_f32 v48, v114, v108
    v_mfma_f32_16x16x32_bf16 v[36:39], a[232:235], v[80:83], v[36:39]
    ds_read_b128 v[68:71], v2 offset:44032
    v_fmac_f32 v53, v113, v97
    v_mfma_f32_16x16x32_bf16 v[48:51], a[236:239], v[80:83], v[48:51]
    s_waitcnt vmcnt(7)
    v_fmac_f32 v46, v113, v94
    v_fmac_f32 v47, v113, v95
    v_mfma_f32_16x16x32_bf16 v[52:55], a[236:239], v[84:87], v[52:55]
    s_waitcnt lgkmcnt(2)
    v_fmac_f32 v44, v115, v104
    v_fmac_f32 v45, v115, v105
    v_mfma_f32_16x16x32_bf16 v[32:35], a[240:243], v[56:59], v[32:35]
    s_barrier
    ds_read_b128 v[72:75], v2 offset:45056
    v_fmac_f32 v46, v115, v106
    v_mfma_f32_16x16x32_bf16 v[40:43], a[240:243], v[60:63], v[40:43]
    buffer_store_dword v124, v124, s[16:19], s91 offen sc1
    v_mfma_f32_16x16x32_bf16 v[44:47], a[244:247], v[60:63], v[44:47]
    buffer_load_dwordx4 v1, s[16:19], s42 offen offset:3072 sc1 lds
    v_mfma_f32_16x16x32_bf16 v[36:39], a[244:247], v[56:59], v[36:39]
    s_add_u32 s91, s91, 65536
    ds_read_b128 v[76:79], v2 offset:46080
    v_fmac_f32 v54, v113, v98
    v_mfma_f32_16x16x32_bf16 v[48:51], a[248:251], v[56:59], v[48:51]
    s_add_u32 m0, s43, 49152
    v_fmac_f32 v47, v115, v107
    s_add_u32 s42, s41, 49152
    v_mfma_f32_16x16x32_bf16 v[52:55], a[248:251], v[60:63], v[52:55]
    s_waitcnt lgkmcnt(2)
    v_mfma_f32_16x16x32_bf16 v[32:35], a[252:255], v[64:67], v[32:35]
    ds_read_b128 v[80:83], v2 offset:47104
    v_fmac_f32 v49, v114, v109
    v_mfma_f32_16x16x32_bf16 v[40:43], a[252:255], v[68:71], v[40:43]
    v_fmac_f32 v50, v114, v110
    v_fmac_f32 v51, v114, v111
    v_mfma_f32_16x16x32_bf16 v[44:47], v[128:131], v[68:71], v[44:47]
    buffer_load_dwordx4 v1, s[16:19], s42 offen offset:0 sc1 lds
    v_mfma_f32_16x16x32_bf16 v[36:39], v[128:131], v[64:67], v[36:39]
    ds_read_b128 v[84:87], v2 offset:48128
    v_fmac_f32 v55, v113, v99
    v_mfma_f32_16x16x32_bf16 v[48:51], v[132:135], v[64:67], v[48:51]
    v_mfma_f32_16x16x32_bf16 v[52:55], v[132:135], v[68:71], v[52:55]
    s_waitcnt lgkmcnt(2)
    v_mfma_f32_16x16x32_bf16 v[32:35], v[136:139], v[72:75], v[32:35]
    ds_read_b128 v[56:59], v2 offset:49152
    v_mfma_f32_16x16x32_bf16 v[40:43], v[136:139], v[76:79], v[40:43]
    v_mfma_f32_16x16x32_bf16 v[44:47], v[140:143], v[76:79], v[44:47]
    buffer_load_dwordx4 v1, s[16:19], s42 offen offset:1024 sc1 lds
    v_mfma_f32_16x16x32_bf16 v[36:39], v[140:143], v[72:75], v[36:39]
    ds_read_b128 v[60:63], v2 offset:50176
    v_fmac_f32 v52, v115, v108
    v_mfma_f32_16x16x32_bf16 v[48:51], v[144:147], v[72:75], v[48:51]
    v_mfma_f32_16x16x32_bf16 v[52:55], v[144:147], v[76:79], v[52:55]
    s_waitcnt lgkmcnt(2)
    v_mfma_f32_16x16x32_bf16 v[32:35], v[148:151], v[80:83], v[32:35]
    ds_read_b128 v[64:67], v2 offset:51200
    v_mfma_f32_16x16x32_bf16 v[40:43], v[148:151], v[84:87], v[40:43]
    v_mfma_f32_16x16x32_bf16 v[44:47], v[152:155], v[84:87], v[44:47]
    buffer_load_dwordx4 v1, s[16:19], s42 offen offset:2048 sc1 lds
    v_mfma_f32_16x16x32_bf16 v[36:39], v[152:155], v[80:83], v[36:39]
    ds_read_b128 v[68:71], v2 offset:52224
    v_fmac_f32 v53, v115, v109
    v_mfma_f32_16x16x32_bf16 v[48:51], v[156:159], v[80:83], v[48:51]
    v_mfma_f32_16x16x32_bf16 v[52:55], v[156:159], v[84:87], v[52:55]
    s_waitcnt lgkmcnt(2)
    v_mfma_f32_16x16x32_bf16 v[32:35], v[160:163], v[56:59], v[32:35]
    ds_read_b128 v[72:75], v2 offset:53248
    v_mfma_f32_16x16x32_bf16 v[40:43], v[160:163], v[60:63], v[40:43]
    v_mfma_f32_16x16x32_bf16 v[44:47], v[164:167], v[60:63], v[44:47]
    buffer_load_dwordx4 v1, s[16:19], s42 offen offset:3072 sc1 lds
    v_mfma_f32_16x16x32_bf16 v[36:39], v[164:167], v[56:59], v[36:39]
    s_add_u32 m0, s52, 73728
    ds_read_b128 v[76:79], v2 offset:54272
    v_fmac_f32 v54, v115, v110
    v_mfma_f32_16x16x32_bf16 v[48:51], v[168:171], v[56:59], v[48:51]
    s_add_u32 s42, s46, s52
    v_mfma_f32_16x16x32_bf16 v[52:55], v[168:171], v[60:63], v[52:55]
    s_waitcnt lgkmcnt(2)
    v_mfma_f32_16x16x32_bf16 v[32:35], v[172:175], v[64:67], v[32:35]
    ds_read_b128 v[80:83], v2 offset:55296
    v_mfma_f32_16x16x32_bf16 v[40:43], v[172:175], v[68:71], v[40:43]
    buffer_load_dwordx4 v1, s[16:19], s42 offen sc1 lds
    v_mfma_f32_16x16x32_bf16 v[44:47], v[176:179], v[68:71], v[44:47]
    v_fmac_f32 v55, v115, v111
    v_mfma_f32_16x16x32_bf16 v[36:39], v[176:179], v[64:67], v[36:39]
    ds_read_b128 v[84:87], v2 offset:56320
    v_mfma_f32_16x16x32_bf16 v[48:51], v[180:183], v[64:67], v[48:51]
    v_mfma_f32_16x16x32_bf16 v[52:55], v[180:183], v[68:71], v[52:55]
    s_waitcnt lgkmcnt(2)
    v_mfma_f32_16x16x32_bf16 v[32:35], v[184:187], v[72:75], v[32:35]
    ds_read_b128 v[56:59], v2 offset:57344
    v_mfma_f32_16x16x32_bf16 v[40:43], v[184:187], v[76:79], v[40:43]
    v_mfma_f32_16x16x32_bf16 v[44:47], v[188:191], v[76:79], v[44:47]
    v_mfma_f32_16x16x32_bf16 v[36:39], v[188:191], v[72:75], v[36:39]
    ds_read_b128 v[60:63], v2 offset:58368
    v_mfma_f32_16x16x32_bf16 v[48:51], v[192:195], v[72:75], v[48:51]
    v_mfma_f32_16x16x32_bf16 v[52:55], v[192:195], v[76:79], v[52:55]
    s_waitcnt lgkmcnt(2)
    v_mfma_f32_16x16x32_bf16 v[32:35], v[196:199], v[80:83], v[32:35]
    ds_read_b128 v[64:67], v2 offset:59392
    v_mfma_f32_16x16x32_bf16 v[40:43], v[196:199], v[84:87], v[40:43]
    v_mfma_f32_16x16x32_bf16 v[44:47], v[200:203], v[84:87], v[44:47]
    v_mfma_f32_16x16x32_bf16 v[36:39], v[200:203], v[80:83], v[36:39]
    ds_read_b128 v[68:71], v2 offset:60416
    v_mfma_f32_16x16x32_bf16 v[48:51], v[204:207], v[80:83], v[48:51]
    v_mfma_f32_16x16x32_bf16 v[52:55], v[204:207], v[84:87], v[52:55]
    s_waitcnt lgkmcnt(2)
    v_mfma_f32_16x16x32_bf16 v[32:35], v[208:211], v[56:59], v[32:35]
    ds_read_b128 v[72:75], v2 offset:61440
    v_mfma_f32_16x16x32_bf16 v[40:43], v[208:211], v[60:63], v[40:43]
    v_mfma_f32_16x16x32_bf16 v[44:47], v[212:215], v[60:63], v[44:47]
    buffer_load_dword v7, v5, s[16:19], s45 offen sc1
    v_mfma_f32_16x16x32_bf16 v[36:39], v[212:215], v[56:59], v[36:39]
    ds_read_b128 v[76:79], v2 offset:62464
    v_mfma_f32_16x16x32_bf16 v[48:51], v[216:219], v[56:59], v[48:51]
    v_mfma_f32_16x16x32_bf16 v[52:55], v[216:219], v[60:63], v[52:55]
    s_waitcnt lgkmcnt(2)
    v_mfma_f32_16x16x32_bf16 v[32:35], v[220:223], v[64:67], v[32:35]
    ds_read_b128 v[80:83], v2 offset:63488
    v_mfma_f32_16x16x32_bf16 v[40:43], v[220:223], v[68:71], v[40:43]
    v_mfma_f32_16x16x32_bf16 v[44:47], v[224:227], v[68:71], v[44:47]
    v_mfma_f32_16x16x32_bf16 v[36:39], v[224:227], v[64:67], v[36:39]
    ds_read_b128 v[84:87], v2 offset:64512
    v_mfma_f32_16x16x32_bf16 v[48:51], v[228:231], v[64:67], v[48:51]
    v_mfma_f32_16x16x32_bf16 v[52:55], v[228:231], v[68:71], v[52:55]
    s_waitcnt lgkmcnt(2)
    v_mfma_f32_16x16x32_bf16 v[32:35], v[232:235], v[72:75], v[32:35]
    ds_read_b128 v[56:59], v1 offset:0
    v_mfma_f32_16x16x32_bf16 v[40:43], v[232:235], v[76:79], v[40:43]
    v_mfma_f32_16x16x32_bf16 v[44:47], v[236:239], v[76:79], v[44:47]
    v_mfma_f32_16x16x32_bf16 v[36:39], v[236:239], v[72:75], v[36:39]
    ds_read_b128 v[60:63], v1 offset:1024
    v_mfma_f32_16x16x32_bf16 v[48:51], v[240:243], v[72:75], v[48:51]
    v_mfma_f32_16x16x32_bf16 v[52:55], v[240:243], v[76:79], v[52:55]
    s_waitcnt lgkmcnt(2)
    v_mfma_f32_16x16x32_bf16 v[32:35], v[244:247], v[80:83], v[32:35]
    ds_read_b128 v[64:67], v1 offset:2048
    v_mfma_f32_16x16x32_bf16 v[40:43], v[244:247], v[84:87], v[40:43]
    v_mfma_f32_16x16x32_bf16 v[44:47], v[248:251], v[84:87], v[44:47]
    v_mfma_f32_16x16x32_bf16 v[36:39], v[248:251], v[80:83], v[36:39]
    ds_read_b128 v[68:71], v1 offset:3072
    v_mfma_f32_16x16x32_bf16 v[48:51], v[252:255], v[80:83], v[48:51]
    s_add_u32 s36, s36, 1
    v_mfma_f32_16x16x32_bf16 v[52:55], v[252:255], v[84:87], v[52:55]
    s_waitcnt lgkmcnt(2)
    s_cmp_lt_u32 s36, 32
    s_cbranch_scc1 L_a_b0
    s_nop 7
    s_and_b32 s44, s90, 0xffffffff
    s_cmp_lt_i32 s36, 1
    s_cselect_b32 s44, 0x5e00000, s44
    s_add_u32 s49, s44, s87
    s_max_u32 s44, s44, s88
    s_add_u32 s90, s90, 262144
    v_mul_f32 v120, v48, v116
    v_mul_f32 v121, v49, v116
    v_mul_f32 v120, v120, abs(v48)
    v_mul_f32 v121, v121, abs(v49)
    v_cvt_pk_bf16_f32 v48, v120, v121
    v_pk_max_i16 v48, v48, 0
    v_mul_f32 v120, v50, v116
    v_mul_f32 v121, v51, v116
    v_mul_f32 v120, v120, abs(v50)
    v_mul_f32 v121, v121, abs(v51)
    v_cvt_pk_bf16_f32 v49, v120, v121
    v_pk_max_i16 v49, v49, 0
    ds_write_b64 v3, v[48:49] offset:4096
    v_mul_f32 v120, v52, v117
    v_mul_f32 v121, v53, v117
    v_mul_f32 v120, v120, abs(v52)
    v_mul_f32 v121, v121, abs(v53)
    v_cvt_pk_bf16_f32 v52, v120, v121
    v_pk_max_i16 v52, v52, 0
    v_mul_f32 v120, v54, v117
    v_mul_f32 v121, v55, v117
    v_mul_f32 v120, v120, abs(v54)
    v_mul_f32 v121, v121, abs(v55)
    v_cvt_pk_bf16_f32 v53, v120, v121
    v_pk_max_i16 v53, v53, 0
    ds_write_b64 v3, v[52:53] offset:5120
    v_mul_f32 v120, v32, v116
    v_mul_f32 v121, v33, v116
    v_mul_f32 v120, v120, abs(v32)
    v_mul_f32 v121, v121, abs(v33)
    v_cvt_pk_bf16_f32 v32, v120, v121
    v_pk_max_i16 v32, v32, 0
    v_mul_f32 v120, v34, v116
    v_mul_f32 v121, v35, v116
    v_mul_f32 v120, v120, abs(v34)
    v_mul_f32 v121, v121, abs(v35)
    v_cvt_pk_bf16_f32 v33, v120, v121
    v_pk_max_i16 v33, v33, 0
    v_mul_f32 v120, v36, v116
    v_mul_f32 v121, v37, v116
    v_mul_f32 v120, v120, abs(v36)
    v_mul_f32 v121, v121, abs(v37)
    v_cvt_pk_bf16_f32 v34, v120, v121
    v_pk_max_i16 v34, v34, 0
    v_mul_f32 v120, v38, v116
    v_mul_f32 v121, v39, v116
    v_mul_f32 v120, v120, abs(v38)
    v_mul_f32 v121, v121, abs(v39)
    v_cvt_pk_bf16_f32 v35, v120, v121
    v_pk_max_i16 v35, v35, 0
    buffer_store_dwordx4 v[32:35], v1, s[16:19], s44 offen offset:0 sc1
    v_mul_f32 v120, v40, v117
    v_mul_f32 v121, v41, v117
    v_mul_f32 v120, v120, abs(v40)
    s_waitcnt lgkmcnt(0)
    s_barrier
    ds_read_b128 v[48:51], v4 offset:4096
    v_mul_f32 v121, v121, abs(v41)
    v_cvt_pk_bf16_f32 v40, v120, v121
    v_pk_max_i16 v40, v40, 0
    v_mul_f32 v120, v42, v117
    v_mul_f32 v121, v43, v117
    v_mul_f32 v120, v120, abs(v42)
    v_mul_f32 v121, v121, abs(v43)
    v_cvt_pk_bf16_f32 v41, v120, v121
    v_pk_max_i16 v41, v41, 0
    s_waitcnt lgkmcnt(0)
    buffer_store_dwordx4 v[48:51], v1, s[16:19], s49 offen sc1
    v_mul_f32 v120, v44, v117
    v_mul_f32 v121, v45, v117
    v_mul_f32 v120, v120, abs(v44)
    v_mul_f32 v121, v121, abs(v45)
    v_cvt_pk_bf16_f32 v42, v120, v121
    v_pk_max_i16 v42, v42, 0
    v_mul_f32 v120, v46, v117
    v_mul_f32 v121, v47, v117
    v_mul_f32 v120, v120, abs(v46)
    v_mul_f32 v121, v121, abs(v47)
    v_cvt_pk_bf16_f32 v43, v120, v121
    v_pk_max_i16 v43, v43, 0
    buffer_store_dwordx4 v[40:43], v1, s[16:19], s44 offen offset:1024 sc1
    s_waitcnt vmcnt(0)
    s_barrier
    buffer_store_dword v124, v124, s[16:19], s91 offen sc1
    s_add_u32 s91, s91, 65536
    s_waitcnt vmcnt(0)
    s_endpgm
L_spin10:
    s_mov_b32 s40, 0x20000
L_spin10_l:
    buffer_load_dword v56, v124, s[20:23], 0 offen sc1
    s_sub_u32 s40, s40, 1
    s_waitcnt vmcnt(0)
    v_cmp_eq_u32 vcc, v124, v56
    s_cbranch_scc1 L_back11
    s_cbranch_vccz L_back11
    s_sleep 8
    s_branch L_spin10_l
L_spin12:
    s_mov_b32 s40, 0x20000
L_spin12_l:
    buffer_load_dword v7, v5, s[16:19], s45 offen sc1
    s_sub_u32 s40, s40, 1
    s_waitcnt vmcnt(0)
    v_cmp_ne_u32 vcc, 0, v7
    s_cbranch_scc1 L_back13
    s_cbranch_vccz L_back13
    s_sleep 2
    s_branch L_spin12_l
L_spin14:
    s_mov_b32 s40, 0x20000
L_spin14_l:
    buffer_load_dword v7, v5, s[16:19], s45 offen sc1
    s_sub_u32 s40, s40, 1
    s_waitcnt vmcnt(0)
    v_cmp_ne_u32 vcc, 0, v7
    s_cbranch_scc1 L_back15
    s_cbranch_vccz L_back15
    s_sleep 2
    s_branch L_spin14_l
L_sspin16:
    s_mov_b32 s40, 0x20000
L_sspin16_l:
    buffer_load_dwordx2 v[36:37], v6, s[16:19], s46 offen offset:0 sc1
    buffer_load_dwordx2 v[38:39], v6, s[16:19], s46 offen offset:128 sc1
    buffer_load_dwordx2 v[40:41], v6, s[16:19], s46 offen offset:256 sc1
    buffer_load_dwordx2 v[42:43], v6, s[16:19], s46 offen offset:384 sc1
    s_sub_u32 s40, s40, 1
    s_waitcnt vmcnt(0)
    v_max3_u32 v44, v36, v37, v38
    v_max3_u32 v45, v39, v40, v41
    v_max3_u32 v44, v44, v42, v43
    v_max_u32 v44, v44, v45
    v_cmp_eq_u32 vcc, -1, v44
    s_cbranch_scc1 L_sback17
    s_cbranch_vccz L_sback17
    s_sleep 4
    s_branch L_sspin16_l
L_spin18:
    s_mov_b32 s40, 0x20000
L_spin18_l:
    buffer_load_dword v7, v5, s[16:19], s45 offen sc1
    s_sub_u32 s40, s40, 1
    s_waitcnt vmcnt(0)
    v_cmp_ne_u32 vcc, 0, v7
    s_cbranch_scc1 L_back19
    s_cbranch_vccz L_back19
    s_sleep 2
    s_branch L_spin18_l
L_sspin20:
    s_mov_b32 s40, 0x20000
L_sspin20_l:
    buffer_load_dwordx2 v[12:13], v6, s[16:19], s46 offen offset:0 sc1
    buffer_load_dwordx2 v[14:15], v6, s[16:19], s46 offen offset:128 sc1
    buffer_load_dwordx2 v[16:17], v6, s[16:19], s46 offen offset:256 sc1
    buffer_load_dwordx2 v[18:19], v6, s[16:19], s46 offen offset:384 sc1
    s_sub_u32 s40, s40, 1
    s_waitcnt vmcnt(0)
    v_max3_u32 v20, v12, v13, v14
    v_max3_u32 v21, v15, v16, v17
    v_max3_u32 v20, v20, v18, v19
    v_max_u32 v20, v20, v21
    v_cmp_eq_u32 vcc, -1, v20
    s_cbranch_scc1 L_sback21
    s_cbranch_vccz L_sback21
    s_sleep 4
    s_branch L_sspin20_l
L_odd:
    s_mov_b32 s33, s47
    s_lshl2_add_u32 s53, s48, s47
    s_cmp_lt_u32 s48, 8
    s_cselect_b32 s34, 16, 32
    s_add_u32 s34, s34, s48
    s_sub_u32 s37, s48, 8
    s_cmp_lt_u32 s37, 20
    s_cselect_b32 s44, -16, 0
    s_cmp_lt_u32 s37, 4
    s_cselect_b32 s44, 64, s44
    s_add_u32 s44, s44, s53
    s_lshl2_add_u32 s44, s44, s32
    s_lshl_b32 s44, s44, 13
    v_lshlrev_b32 v6, 7, v0
    s_waitcnt lgkmcnt(0)
    s_mov_b32 s12, s66
    s_mov_b32 s13, s67
    s_mov_b32 s14, 0x400000
    s_mov_b32 s15, 0x00020000
    s_mov_b32 s16, s84
    s_mov_b32 s17, s85
    s_mov_b32 s18, 0x5e00000
    s_mov_b32 s19, 0x00020000
    v_min_u32 v124, 1, v0
    v_lshlrev_b32 v124, 30, v124
    s_cmp_lt_u32 s48, 8
    s_cbranch_scc1 L_touch
    s_sub_u32 s37, s48, 12
    s_cmp_lt_u32 s37, 16
    s_cbranch_scc1 L_lines
    s_lshl_b32 s50, s33, 5
    s_or_b32 s37, s48, 16
    s_add_u32 s50, s50, s37
    s_lshl_b32 s46, s50, 15
    s_lshl_b32 s37, s32, 9
    s_add_u32 s46, s46, s37
    v_lshrrev_b32 v48, 3, v0
    v_and_b32 v49, 0x70, v1
    v_lshl_add_u32 v48, v48, 11, v49
    v_add_u32 v49, 16384, v48
    s_mov_b32 s8, s64
    s_mov_b32 s9, s65
    s_mov_b32 s10, 0x400000
    s_mov_b32 s11, 0x00020000
    buffer_load_dwordx4 v[16:19], v48, s[8:11], s46 offen offset:0
    buffer_load_dwordx4 v[20:23], v48, s[8:11], s46 offen offset:128
    buffer_load_dwordx4 v[24:27], v48, s[8:11], s46 offen offset:256
    buffer_load_dwordx4 v[28:31], v48, s[8:11], s46 offen offset:384
    buffer_load_dwordx4 v[32:35], v49, s[8:11], s46 offen offset:0
    buffer_load_dwordx4 v[36:39], v49, s[8:11], s46 offen offset:128
    buffer_load_dwordx4 v[40:43], v49, s[8:11], s46 offen offset:256
    buffer_load_dwordx4 v[44:47], v49, s[8:11], s46 offen offset:384
    s_mov_b32 s86, 0x3f803f80
    v_and_b32 v56, 1, v0
    v_lshlrev_b32 v56, 7, v56
    v_bfe_u32 v57, v0, 1, 1
    v_lshl_add_u32 v56, v57, 6, v56
    v_and_b32 v57, 0x38, v0
    v_add_u32 v56, v57, v56
    s_sub_u32 s46, 127, s50
    s_lshl_b32 s46, s46, 10
    s_lshl_b32 s37, s32, 8
    s_add_u32 s46, s46, s37
    s_add_u32 s46, s46, 0x5400000
    s_waitcnt vmcnt(0)
    v_dot2_f32_bf16 v48, v16, s86, 0
    v_dot2_f32_bf16 v49, v16, v16, 0
    v_dot2_f32_bf16 v50, v24, s86, 0
    v_dot2_f32_bf16 v51, v24, v24, 0
    v_dot2_f32_bf16 v52, v32, s86, 0
    v_dot2_f32_bf16 v53, v32, v32, 0
    v_dot2_f32_bf16 v54, v40, s86, 0
    v_dot2_f32_bf16 v55, v40, v40, 0
    v_dot2_f32_bf16 v48, v17, s86, v48
    v_dot2_f32_bf16 v49, v17, v17, v49
    v_dot2_f32_bf16 v50, v25, s86, v50
    v_dot2_f32_bf16 v51, v25, v25, v51
    v_dot2_f32_bf16 v52, v33, s86, v52
    v_dot2_f32_bf16 v53, v33, v33, v53
    v_dot2_f32_bf16 v54, v41, s86, v54
    v_dot2_f32_bf16 v55, v41, v41, v55
    v_dot2_f32_bf16 v48, v18, s86, v48
    v_dot2_f32_bf16 v49, v18, v18, v49
    v_dot2_f32_bf16 v50, v26, s86, v50
    v_dot2_f32_bf16 v51, v26, v26, v51
    v_dot2_f32_bf16 v52, v34, s86, v52
    v_dot2_f32_bf16 v53, v34, v34, v53
    v_dot2_f32_bf16 v54, v42, s86, v54
    v_dot2_f32_bf16 v55, v42, v42, v55
    v_dot2_f32_bf16 v48, v19, s86, v48
    v_dot2_f32_bf16 v49, v19, v19, v49
    v_dot2_f32_bf16 v50, v27, s86, v50
    v_dot2_f32_bf16 v51, v27, v27, v51
    v_dot2_f32_bf16 v52, v35, s86, v52
    v_dot2_f32_bf16 v53, v35, v35, v53
    v_dot2_f32_bf16 v54, v43, s86, v54
    v_dot2_f32_bf16 v55, v43, v43, v55
    v_dot2_f32_bf16 v48, v20, s86, v48
    v_dot2_f32_bf16 v49, v20, v20, v49
    v_dot2_f32_bf16 v50, v28, s86, v50
    v_dot2_f32_bf16 v51, v28, v28, v51
    v_dot2_f32_bf16 v52, v36, s86, v52
    v_dot2_f32_bf16 v53, v36, v36, v53
    v_dot2_f32_bf16 v54, v44, s86, v54
    v_dot2_f32_bf16 v55, v44, v44, v55
    v_dot2_f32_bf16 v48, v21, s86, v48
    v_dot2_f32_bf16 v49, v21, v21, v49
    v_dot2_f32_bf16 v50, v29, s86, v50
    v_dot2_f32_bf16 v51, v29, v29, v51
    v_dot2_f32_bf16 v52, v37, s86, v52
    v_dot2_f32_bf16 v53, v37, v37, v53
    v_dot2_f32_bf16 v54, v45, s86, v54
    v_dot2_f32_bf16 v55, v45, v45, v55
    v_dot2_f32_bf16 v48, v22, s86, v48
    v_dot2_f32_bf16 v49, v22, v22, v49
    v_dot2_f32_bf16 v50, v30, s86, v50
    v_dot2_f32_bf16 v51, v30, v30, v51
    v_dot2_f32_bf16 v52, v38, s86, v52
    v_dot2_f32_bf16 v53, v38, v38, v53
    v_dot2_f32_bf16 v54, v46, s86, v54
    v_dot2_f32_bf16 v55, v46, v46, v55
    v_dot2_f32_bf16 v48, v23, s86, v48
    v_dot2_f32_bf16 v49, v23, v23, v49
    v_dot2_f32_bf16 v50, v31, s86, v50
    v_dot2_f32_bf16 v51, v31, v31, v51
    v_dot2_f32_bf16 v52, v39, s86, v52
    v_dot2_f32_bf16 v53, v39, v39, v53
    v_dot2_f32_bf16 v54, v47, s86, v54
    v_dot2_f32_bf16 v55, v47, v47, v55
    v_add_f32_dpp v48, v48, v48 quad_perm:[1,0,3,2] row_mask:0xf bank_mask:0xf
    v_add_f32_dpp v49, v49, v49 quad_perm:[1,0,3,2] row_mask:0xf bank_mask:0xf
    v_add_f32_dpp v50, v50, v50 quad_perm:[1,0,3,2] row_mask:0xf bank_mask:0xf
    v_add_f32_dpp v51, v51, v51 quad_perm:[1,0,3,2] row_mask:0xf bank_mask:0xf
    v_add_f32_dpp v52, v52, v52 quad_perm:[1,0,3,2] row_mask:0xf bank_mask:0xf
    v_add_f32_dpp v53, v53, v53 quad_perm:[1,0,3,2] row_mask:0xf bank_mask:0xf
    v_add_f32_dpp v54, v54, v54 quad_perm:[1,0,3,2] row_mask:0xf bank_mask:0xf
    v_add_f32_dpp v55, v55, v55 quad_perm:[1,0,3,2] row_mask:0xf bank_mask:0xf
    v_add_f32_dpp v48, v48, v48 quad_perm:[2,3,0,1] row_mask:0xf bank_mask:0xf
    v_add_f32_dpp v49, v49, v49 quad_perm:[2,3,0,1] row_mask:0xf bank_mask:0xf
    v_add_f32_dpp v50, v50, v50 quad_perm:[2,3,0,1] row_mask:0xf bank_mask:0xf
    v_add_f32_dpp v51, v51, v51 quad_perm:[2,3,0,1] row_mask:0xf bank_mask:0xf
    v_add_f32_dpp v52, v52, v52 quad_perm:[2,3,0,1] row_mask:0xf bank_mask:0xf
    v_add_f32_dpp v53, v53, v53 quad_perm:[2,3,0,1] row_mask:0xf bank_mask:0xf
    v_add_f32_dpp v54, v54, v54 quad_perm:[2,3,0,1] row_mask:0xf bank_mask:0xf
    v_add_f32_dpp v55, v55, v55 quad_perm:[2,3,0,1] row_mask:0xf bank_mask:0xf
    v_add_f32_dpp v48, v48, v48 row_half_mirror row_mask:0xf bank_mask:0xf
    v_add_f32_dpp v49, v49, v49 row_half_mirror row_mask:0xf bank_mask:0xf
    v_add_f32_dpp v50, v50, v50 row_half_mirror row_mask:0xf bank_mask:0xf
    v_add_f32_dpp v51, v51, v51 row_half_mirror row_mask:0xf bank_mask:0xf
    v_add_f32_dpp v52, v52, v52 row_half_mirror row_mask:0xf bank_mask:0xf
    v_add_f32_dpp v53, v53, v53 row_half_mirror row_mask:0xf bank_mask:0xf
    v_add_f32_dpp v54, v54, v54 row_half_mirror row_mask:0xf bank_mask:0xf
    v_add_f32_dpp v55, v55, v55 row_half_mirror row_mask:0xf bank_mask:0xf
    s_mov_b32 exec_lo, 0x2020202
    s_mov_b32 exec_hi, 0x2020202
    v_mov_b32 v48, v50
    v_mov_b32 v49, v51
    s_mov_b32 exec_lo, 0x4040404
    s_mov_b32 exec_hi, 0x4040404
    v_mov_b32 v48, v52
    v_mov_b32 v49, v53
    s_mov_b32 exec_lo, 0x8080808
    s_mov_b32 exec_hi, 0x8080808
    v_mov_b32 v48, v54
    v_mov_b32 v49, v55
    s_mov_b32 exec_lo, 0x0f0f0f0f
    s_mov_b32 exec_hi, 0x0f0f0f0f
    buffer_store_dwordx2 v[48:49], v56, s[16:19], s46 offen sc1
    s_mov_b64 exec, -1
    s_branch L_job_end
L_lines:
    buffer_load_dword v248, v6, s[12:15], s44 offen
    s_mov_b32 s12, s68
    s_mov_b32 s13, s69
    s_mov_b32 s14, 0x200000
    s_mov_b32 s15, 0x00020000
    s_sub_u32 s39, 0x180, s12
    s_and_b32 s39, s39, 0x380
    s_lshl2_add_u32 s37, s37, s32
    s_lshl_b32 s37, s37, 15
    s_add_u32 s39, s39, s37
    v_and_b32 v7, 31, v0
    v_lshlrev_b32 v7, 10, v7
    buffer_load_dword v247, v7, s[12:15], s39 offen
    s_mov_b32 s14, 0
    s_sub_u32 s53, s53, 48
    s_and_b32 s37, s53, 7
    s_cmp_lt_u32 s37, 2
    s_cselect_b32 s87, 2, 3
    s_cselect_b32 s36, 34, 32
    s_cmp_ge_u32 s53, 32
    s_cselect_b32 s87, 2, s87
    s_cselect_b32 s36, 35, s36
    s_cselect_b32 s38, 5, 0
    s_cmp_lt_u32 s37, s38
    s_cselect_b32 s37, 0x5e00000, 0
    s_lshl_b32 s38, s53, 10
    s_add_u32 s37, s37, s38
    s_lshl_b32 s38, s32, 16
    s_add_u32 s37, s37, s38
    s_add_u32 s37, s37, 0x5500000
    s_sub_u32 s87, s32, s87
    s_cmp_lt_u32 s87, s36
    s_cselect_b32 s38, -1, 0
    v_mov_b32 v16, s38
    s_add_u32 s87, s87, 4
    buffer_store_dwordx4 v[16:19], v1, s[16:19], s37 offen sc1
    s_add_u32 s37, s37, 262144
    s_cmp_lt_u32 s87, s36
    s_cselect_b32 s38, -1, 0
    v_mov_b32 v20, s38
    s_add_u32 s87, s87, 4
    buffer_store_dwordx4 v[20:23], v1, s[16:19], s37 offen sc1
    s_add_u32 s37, s37, 262144
    s_cmp_lt_u32 s87, s36
    s_cselect_b32 s38, -1, 0
    v_mov_b32 v24, s38
    s_add_u32 s87, s87, 4
    buffer_store_dwordx4 v[24:27], v1, s[16:19], s37 offen sc1
    s_add_u32 s37, s37, 262144
    s_cmp_lt_u32 s87, s36
    s_cselect_b32 s38, -1, 0
    v_mov_b32 v28, s38
    s_add_u32 s87, s87, 4
    buffer_store_dwordx4 v[28:31], v1, s[16:19], s37 offen sc1
    s_add_u32 s37, s37, 262144
    s_cmp_lt_u32 s87, s36
    s_cselect_b32 s38, -1, 0
    v_mov_b32 v32, s38
    s_add_u32 s87, s87, 4
    buffer_store_dwordx4 v[32:35], v1, s[16:19], s37 offen sc1
    s_add_u32 s37, s37, 262144
    s_cmp_lt_u32 s87, s36
    s_cselect_b32 s38, -1, 0
    v_mov_b32 v36, s38
    s_add_u32 s87, s87, 4
    buffer_store_dwordx4 v[36:39], v1, s[16:19], s37 offen sc1
    s_add_u32 s37, s37, 262144
    s_cmp_lt_u32 s87, s36
    s_cselect_b32 s38, -1, 0
    v_mov_b32 v40, s38
    s_add_u32 s87, s87, 4
    buffer_store_dwordx4 v[40:43], v1, s[16:19], s37 offen sc1
    s_add_u32 s37, s37, 262144
    s_cmp_lt_u32 s87, s36
    s_cselect_b32 s38, -1, 0
    v_mov_b32 v44, s38
    s_add_u32 s87, s87, 4
    buffer_store_dwordx4 v[44:47], v1, s[16:19], s37 offen sc1
    s_add_u32 s37, s37, 262144
    s_cmp_lt_u32 s87, s36
    s_cselect_b32 s38, -1, 0
    v_mov_b32 v48, s38
    s_add_u32 s87, s87, 4
    buffer_store_dwordx4 v[48:51], v1, s[16:19], s37 offen sc1
    s_add_u32 s37, s37, 262144
    s_cmp_lt_u32 s87, s36
    s_cselect_b32 s38, -1, 0
    v_mov_b32 v52, s38
    s_add_u32 s87, s87, 4
    buffer_store_dwordx4 v[52:55], v1, s[16:19], s37 offen sc1
    s_add_u32 s37, s37, 262144
    v_mov_b32 v8, -1
    v_mov_b32 v9, -1
    v_mov_b32 v10, -1
    v_mov_b32 v11, -1
    s_lshl2_add_u32 s38, s53, s32
    s_lshl_b32 s38, s38, 10
    s_add_u32 s38, s38, 0x5440000
    buffer_store_dwordx4 v[8:11], v1, s[16:19], s38 offen sc1
L_job_end:
    s_mov_b32 s8, s82
    s_mov_b32 s9, s83
    s_mov_b32 s10, 0x100
    s_mov_b32 s11, 0x00020000
    v_mov_b32 v123, 1
    s_waitcnt vmcnt(0)
    s_barrier
    s_cmp_lg_u32 s32, 3
    s_cbranch_scc1 L_arr22
    buffer_atomic_add v123, v124, s[8:11], 0 offen sc0
    s_waitcnt vmcnt(0)
    v_readfirstlane_b32 s37, v123
    s_nop 0
    s_cmp_lg_u32 s37, 95
    s_cbranch_scc1 L_arr22
    buffer_store_dword v123, v124, s[8:11], 0 offen offset:128 sc1
L_arr22:
L_touch:
    buffer_load_dword v248, v6, s[12:15], s44 offen
    s_lshl_b32 s91, s33, 6
    s_add_u32 s91, s91, s34
    s_lshl_b32 s91, s91, 7
    s_add_u32 s91, s91, 0x5520000
    s_cmp_eq_u32 s32, 1
    s_cselect_b32 s91, s91, 0x5f00000
    s_cmp_ge_u32 s34, 60
    s_cbranch_scc1 L_role_60
    s_cmp_ge_u32 s34, 44
    s_cbranch_scc1 L_role_44
    s_cmp_ge_u32 s34, 40
    s_cbranch_scc1 L_role_40
L_role_16:
    s_sub_u32 s35, s34, 16
    s_lshl_b32 s54, s35, 8
    s_mov_b32 s12, s68
    s_mov_b32 s13, s69
    s_mov_b32 s14, 0x200000
    s_mov_b32 s15, 0x00020000
    s_mov_b32 s39, 2048
    v_lshrrev_b32 v52, 3, v0
    v_lshlrev_b32 v53, 2, v0
    v_and_b32 v53, 64, v53
    v_and_b32 v54, 0x70, v1
    v_xor_b32 v53, v53, v54
    v_mad_u32_u24 v44, v52, s39, v53
    v_add_u32 v45, 16384, v44
    v_add_u32 v46, 128, v44
    v_add_u32 v47, 16512, v44
    s_mul_i32 s38, s32, 32768
    s_add_u32 s54, s54, s38
    s_lshl_b32 s42, s32, 11
    s_add_u32 m0, s42, 0
    s_nop 0
    buffer_load_dwordx4 v44, s[12:15], s54 offen lds
    s_add_u32 m0, s42, 1024
    s_nop 0
    buffer_load_dwordx4 v45, s[12:15], s54 offen lds
    s_add_u32 m0, s42, 8192
    s_nop 0
    buffer_load_dwordx4 v46, s[12:15], s54 offen lds
    s_add_u32 m0, s42, 9216
    s_nop 0
    buffer_load_dwordx4 v47, s[12:15], s54 offen lds
    s_add_u32 s54, s54, 131072
    s_add_u32 m0, s42, 16384
    s_nop 0
    buffer_load_dwordx4 v44, s[12:15], s54 offen lds
    s_add_u32 m0, s42, 17408
    s_nop 0
    buffer_load_dwordx4 v45, s[12:15], s54 offen lds
    s_add_u32 m0, s42, 24576
    s_nop 0
    buffer_load_dwordx4 v46, s[12:15], s54 offen lds
    s_add_u32 m0, s42, 25600
    s_nop 0
    buffer_load_dwordx4 v47, s[12:15], s54 offen lds
    s_add_u32 s54, s54, 131072
    s_add_u32 m0, s42, 32768
    s_nop 0
    buffer_load_dwordx4 v44, s[12:15], s54 offen lds
    s_add_u32 m0, s42, 33792
    s_nop 0
    buffer_load_dwordx4 v45, s[12:15], s54 offen lds
    s_add_u32 m0, s42, 40960
    s_nop 0
    buffer_load_dwordx4 v46, s[12:15], s54 offen lds
    s_add_u32 m0, s42, 41984
    s_nop 0
    buffer_load_dwordx4 v47, s[12:15], s54 offen lds
    s_add_u32 s54, s54, 131072
    s_add_u32 m0, s42, 49152
    s_nop 0
    buffer_load_dwordx4 v44, s[12:15], s54 offen lds
    s_add_u32 m0, s42, 50176
    s_nop 0
    buffer_load_dwordx4 v45, s[12:15], s54 offen lds
    s_add_u32 m0, s42, 57344
    s_nop 0
    buffer_load_dwordx4 v46, s[12:15], s54 offen lds
    s_add_u32 m0, s42, 58368
    s_nop 0
    buffer_load_dwordx4 v47, s[12:15], s54 offen lds
    s_add_u32 s54, s54, 131072
    s_add_u32 m0, s42, 65536
    s_nop 0
    buffer_load_dwordx4 v44, s[12:15], s54 offen lds
    s_add_u32 m0, s42, 66560
    s_nop 0
    buffer_load_dwordx4 v45, s[12:15], s54 offen lds
    s_add_u32 m0, s42, 73728
    s_nop 0
    buffer_load_dwordx4 v46, s[12:15], s54 offen lds
    s_add_u32 m0, s42, 74752
    s_nop 0
    buffer_load_dwordx4 v47, s[12:15], s54 offen lds
    s_add_u32 s54, s54, 131072
    v_lshrrev_b32 v52, 4, v0
    v_bfe_u32 v53, v0, 2, 2
    v_lshl_add_u32 v52, v52, 3, v53
    v_lshlrev_b32 v52, 7, v52
    v_lshrrev_b32 v53, 1, v53
    v_lshl_add_u32 v52, v53, 6, v52
    v_and_b32 v53, 3, v0
    v_lshl_add_u32 v52, v53, 4, v52
    s_lshr_b32 s37, s32, 1
    s_lshl_b32 s37, s37, 13
    s_and_b32 s38, s32, 1
    s_lshl_b32 s38, s38, 6
    s_add_u32 s37, s37, s38
    s_add_u32 s37, s37, 0
    v_xor_b32 v48, s37, v52
    s_lshr_b32 s37, s32, 1
    s_lshl_b32 s37, s37, 13
    s_and_b32 s38, s32, 1
    s_lshl_b32 s38, s38, 6
    s_add_u32 s37, s37, s38
    s_add_u32 s37, s37, 8
    v_xor_b32 v49, s37, v52
    v_add_u32 v2, 98304, v1
    v_mov_b32 v108, 0
    v_mov_b32 v109, 0
    v_mov_b32 v110, 0
    v_mov_b32 v111, 0
    v_mov_b32 v112, 0
    v_mov_b32 v113, 0
    v_mov_b32 v114, 0
    v_mov_b32 v115, 0
    v_mov_b32 v13, 0x3f80
    v_and_b32 v12, 1, v0
    v_lshlrev_b32 v12, 4, v12
    v_lshlrev_b32 v12, v12, v13
    s_mov_b32 exec_lo, 0x300003
    s_mov_b32 exec_hi, 0x30000300
    v_mov_b32 v108, v12
    v_mov_b32 v114, v12
    s_mov_b32 exec_lo, 0xc0000c
    s_mov_b32 exec_hi, 0xc0000c00
    v_mov_b32 v109, v12
    v_mov_b32 v115, v12
    s_mov_b64 exec, -1
    s_lshl_b32 s37, s33, 6
    s_add_u32 s37, s37, 0
    s_lshl_b32 s37, s37, 7
    v_lshl_add_u32 v4, v0, 7, s37
    s_cmp_eq_u32 s32, 0
    s_cselect_b32 s37, 16, 0
    v_cmp_le_u32 vcc, s37, v0
    s_nop 1
    v_cndmask_b32 v4, v4, 2.0, vcc
    s_mov_b32 s86, 0x3f803f80
    s_lshl_b32 s43, s32, 12
    s_mul_i32 s41, s33, 2097152
    s_add_u32 s41, s41, 0x0
    s_add_u32 s41, s41, s43
    s_lshl_b32 s38, s35, 2
    s_add_u32 s38, s38, s32
    s_mul_i32 s90, s33, 2097152
    s_add_u32 s90, s90, 0x7f0000
    s_lshl_b32 s37, s38, 11
    s_add_u32 s90, s90, s37
    v_and_b32 v12, 15, v0
    v_and_b32 v13, 0x30, v0
    v_lshl_add_u32 v3, v12, 11, v13
    s_lshl_b32 s37, s38, 6
    v_add_u32 v3, s37, v3
    s_lshl_b32 s50, s33, 20
    s_add_u32 s50, s50, 983040
    s_add_u32 s88, s84, 0x5000000
    s_addc_u32 s89, s85, 0
    s_mov_b32 s8, s64
    s_mov_b32 s9, s65
    s_mov_b32 s10, 0x400000
    s_mov_b32 s11, 0x00020000
    v_bfe_u32 v13, v0, 4, 1
    v_lshl_add_u32 v12, v12, 1, v13
    s_lshl_b32 s37, s32, 2
    s_add_u32 s37, s37, 65536
    v_lshl_add_u32 v6, v12, 4, s37
    v_add_u32 v7, 65536, v1
    v_and_b32 v12, 31, v0
    v_lshrrev_b32 v13, 5, v0
    v_lshlrev_b32 v12, 2, v12
    v_lshl_add_u32 v8, v13, 10, v12
    s_mul_i32 s46, s33, 65536
    s_add_u32 s46, s46, 0x543f800
    s_lshl_b32 s37, s35, 7
    s_add_u32 s46, s46, s37
    s_cmp_eq_u32 s32, 2
    s_cselect_b32 s46, s46, 0x5f00000
    s_mov_b32 s36, -1
    v_add_u32 v50, 0, v48
    v_add_u32 v51, 0, v49
    s_waitcnt vmcnt(16)
    s_barrier
    ds_read_b64_tr_b16 a[0:1], v50 offset:0
    ds_read_b64_tr_b16 a[2:3], v50 offset:512
    ds_read_b64_tr_b16 a[4:5], v51 offset:0
    ds_read_b64_tr_b16 a[6:7], v51 offset:512
    ds_read_b64_tr_b16 a[8:9], v50 offset:4096
    ds_read_b64_tr_b16 a[10:11], v50 offset:4608
    ds_read_b64_tr_b16 a[12:13], v51 offset:4096
    ds_read_b64_tr_b16 a[14:15], v51 offset:4608
    s_add_u32 m0, s42, 81920
    s_nop 0
    buffer_load_dwordx4 v44, s[12:15], s54 offen lds
    s_add_u32 m0, s42, 82944
    s_nop 0
    buffer_load_dwordx4 v45, s[12:15], s54 offen lds
    s_add_u32 m0, s42, 90112
    s_nop 0
    buffer_load_dwordx4 v46, s[12:15], s54 offen lds
    s_add_u32 m0, s42, 91136
    s_nop 0
    buffer_load_dwordx4 v47, s[12:15], s54 offen lds
    s_add_u32 s54, s54, 131072
    s_waitcnt lgkmcnt(0)
    v_add_u32 v50, 16384, v48
    v_add_u32 v51, 16384, v49
    s_waitcnt vmcnt(16)
    s_barrier
    ds_read_b64_tr_b16 a[16:17], v50 offset:0
    ds_read_b64_tr_b16 a[18:19], v50 offset:512
    ds_read_b64_tr_b16 a[20:21], v51 offset:0
    ds_read_b64_tr_b16 a[22:23], v51 offset:512
    ds_read_b64_tr_b16 a[24:25], v50 offset:4096
    ds_read_b64_tr_b16 a[26:27], v50 offset:4608
    ds_read_b64_tr_b16 a[28:29], v51 offset:4096
    ds_read_b64_tr_b16 a[30:31], v51 offset:4608
    s_add_u32 m0, s42, 0
    s_nop 0
    buffer_load_dwordx4 v44, s[12:15], s54 offen lds
    s_add_u32 m0, s42, 1024
    s_nop 0
    buffer_load_dwordx4 v45, s[12:15], s54 offen lds
    s_add_u32 m0, s42, 8192
    s_nop 0
    buffer_load_dwordx4 v46, s[12:15], s54 offen lds
    s_add_u32 m0, s42, 9216
    s_nop 0
    buffer_load_dwordx4 v47, s[12:15], s54 offen lds
    s_add_u32 s54, s54, 131072
    s_waitcnt lgkmcnt(0)
    v_add_u32 v50, 32768, v48
    v_add_u32 v51, 32768, v49
    s_waitcnt vmcnt(16)
    s_barrier
    ds_read_b64_tr_b16 a[32:33], v50 offset:0
    ds_read_b64_tr_b16 a[34:35], v50 offset:512
    ds_read_b64_tr_b16 a[36:37], v51 offset:0
    ds_read_b64_tr_b16 a[38:39], v51 offset:512
    ds_read_b64_tr_b16 a[40:41], v50 offset:4096
    ds_read_b64_tr_b16 a[42:43], v50 offset:4608
    ds_read_b64_tr_b16 a[44:45], v51 offset:4096
    ds_read_b64_tr_b16 a[46:47], v51 offset:4608
    s_add_u32 m0, s42, 16384
    s_nop 0
    buffer_load_dwordx4 v44, s[12:15], s54 offen lds
    s_add_u32 m0, s42, 17408
    s_nop 0
    buffer_load_dwordx4 v45, s[12:15], s54 offen lds
    s_add_u32 m0, s42, 24576
    s_nop 0
    buffer_load_dwordx4 v46, s[12:15], s54 offen lds
    s_add_u32 m0, s42, 25600
    s_nop 0
    buffer_load_dwordx4 v47, s[12:15], s54 offen lds
    s_add_u32 s54, s54, 131072
    s_waitcnt lgkmcnt(0)
    v_add_u32 v50, 49152, v48
    v_add_u32 v51, 49152, v49
    s_waitcnt vmcnt(16)
    s_barrier
    ds_read_b64_tr_b16 a[48:49], v50 offset:0
    ds_read_b64_tr_b16 a[50:51], v50 offset:512
    ds_read_b64_tr_b16 a[52:53], v51 offset:0
    ds_read_b64_tr_b16 a[54:55], v51 offset:512
    ds_read_b64_tr_b16 a[56:57], v50 offset:4096
    ds_read_b64_tr_b16 a[58:59], v50 offset:4608
    ds_read_b64_tr_b16 a[60:61], v51 offset:4096
    ds_read_b64_tr_b16 a[62:63], v51 offset:4608
    s_add_u32 m0, s42, 32768
    s_nop 0
    buffer_load_dwordx4 v44, s[12:15], s54 offen lds
    s_add_u32 m0, s42, 33792
    s_nop 0
    buffer_load_dwordx4 v45, s[12:15], s54 offen lds
    s_add_u32 m0, s42, 40960
    s_nop 0
    buffer_load_dwordx4 v46, s[12:15], s54 offen lds
    s_add_u32 m0, s42, 41984
    s_nop 0
    buffer_load_dwordx4 v47, s[12:15], s54 offen lds
    s_add_u32 s54, s54, 131072
    s_waitcnt lgkmcnt(0)
    v_add_u32 v50, 65536, v48
    v_add_u32 v51, 65536, v49
    s_waitcnt vmcnt(16)
    s_barrier
    ds_read_b64_tr_b16 a[64:65], v50 offset:0
    ds_read_b64_tr_b16 a[66:67], v50 offset:512
    ds_read_b64_tr_b16 a[68:69], v51 offset:0
    ds_read_b64_tr_b16 a[70:71], v51 offset:512
    ds_read_b64_tr_b16 a[72:73], v50 offset:4096
    ds_read_b64_tr_b16 a[74:75], v50 offset:4608
    ds_read_b64_tr_b16 a[76:77], v51 offset:4096
    ds_read_b64_tr_b16 a[78:79], v51 offset:4608
    s_add_u32 m0, s42, 49152
    s_nop 0
    buffer_load_dwordx4 v44, s[12:15], s54 offen lds
    s_add_u32 m0, s42, 50176
    s_nop 0
    buffer_load_dwordx4 v45, s[12:15], s54 offen lds
    s_add_u32 m0, s42, 57344
    s_nop 0
    buffer_load_dwordx4 v46, s[12:15], s54 offen lds
    s_add_u32 m0, s42, 58368
    s_nop 0
    buffer_load_dwordx4 v47, s[12:15], s54 offen lds
    s_add_u32 s54, s54, 131072
    s_waitcnt lgkmcnt(0)
    v_add_u32 v50, 81920, v48
    v_add_u32 v51, 81920, v49
    s_waitcnt vmcnt(16)
    s_barrier
    ds_read_b64_tr_b16 a[80:81], v50 offset:0
    ds_read_b64_tr_b16 a[82:83], v50 offset:512
    ds_read_b64_tr_b16 a[84:85], v51 offset:0
    ds_read_b64_tr_b16 a[86:87], v51 offset:512
    ds_read_b64_tr_b16 a[88:89], v50 offset:4096
    ds_read_b64_tr_b16 a[90:91], v50 offset:4608
    ds_read_b64_tr_b16 a[92:93], v51 offset:4096
    ds_read_b64_tr_b16 a[94:95], v51 offset:4608
    s_add_u32 m0, s42, 65536
    s_nop 0
    buffer_load_dwordx4 v44, s[12:15], s54 offen lds
    s_add_u32 m0, s42, 66560
    s_nop 0
    buffer_load_dwordx4 v45, s[12:15], s54 offen lds
    s_add_u32 m0, s42, 73728
    s_nop 0
    buffer_load_dwordx4 v46, s[12:15], s54 offen lds
    s_add_u32 m0, s42, 74752
    s_nop 0
    buffer_load_dwordx4 v47, s[12:15], s54 offen lds
    s_add_u32 s54, s54, 131072
    s_waitcnt lgkmcnt(0)
    v_add_u32 v50, 0, v48
    v_add_u32 v51, 0, v49
    s_waitcnt vmcnt(16)
    s_barrier
    ds_read_b64_tr_b16 a[96:97], v50 offset:0
    ds_read_b64_tr_b16 a[98:99], v50 offset:512
    ds_read_b64_tr_b16 a[100:101], v51 offset:0
    ds_read_b64_tr_b16 a[102:103], v51 offset:512
    ds_read_b64_tr_b16 a[104:105], v50 offset:4096
    ds_read_b64_tr_b16 a[106:107], v50 offset:4608
    ds_read_b64_tr_b16 a[108:109], v51 offset:4096
    ds_read_b64_tr_b16 a[110:111], v51 offset:4608
    s_add_u32 m0, s42, 81920
    s_nop 0
    buffer_load_dwordx4 v44, s[12:15], s54 offen lds
    s_add_u32 m0, s42, 82944
    s_nop 0
    buffer_load_dwordx4 v45, s[12:15], s54 offen lds
    s_add_u32 m0, s42, 90112
    s_nop 0
    buffer_load_dwordx4 v46, s[12:15], s54 offen lds
    s_add_u32 m0, s42, 91136
    s_nop 0
    buffer_load_dwordx4 v47, s[12:15], s54 offen lds
    s_add_u32 s54, s54, 131072
    s_waitcnt lgkmcnt(0)
    v_add_u32 v50, 16384, v48
    v_add_u32 v51, 16384, v49
    s_waitcnt vmcnt(16)
    s_barrier
    ds_read_b64_tr_b16 a[112:113], v50 offset:0
    ds_read_b64_tr_b16 a[114:115], v50 offset:512
    ds_read_b64_tr_b16 a[116:117], v51 offset:0
    ds_read_b64_tr_b16 a[118:119], v51 offset:512
    ds_read_b64_tr_b16 a[120:121], v50 offset:4096
    ds_read_b64_tr_b16 a[122:123], v50 offset:4608
    ds_read_b64_tr_b16 a[124:125], v51 offset:4096
    ds_read_b64_tr_b16 a[126:127], v51 offset:4608
    s_add_u32 m0, s42, 0
    s_nop 0
    buffer_load_dwordx4 v44, s[12:15], s54 offen lds
    s_add_u32 m0, s42, 1024
    s_nop 0
    buffer_load_dwordx4 v45, s[12:15], s54 offen lds
    s_add_u32 m0, s42, 8192
    s_nop 0
    buffer_load_dwordx4 v46, s[12:15], s54 offen lds
    s_add_u32 m0, s42, 9216
    s_nop 0
    buffer_load_dwordx4 v47, s[12:15], s54 offen lds
    s_add_u32 s54, s54, 131072
    s_waitcnt lgkmcnt(0)
    v_add_u32 v50, 32768, v48
    v_add_u32 v51, 32768, v49
    s_waitcnt vmcnt(16)
    s_barrier
    ds_read_b64_tr_b16 a[128:129], v50 offset:0
    ds_read_b64_tr_b16 a[130:131], v50 offset:512
    ds_read_b64_tr_b16 a[132:133], v51 offset:0
    ds_read_b64_tr_b16 a[134:135], v51 offset:512
    ds_read_b64_tr_b16 a[136:137], v50 offset:4096
    ds_read_b64_tr_b16 a[138:139], v50 offset:4608
    ds_read_b64_tr_b16 a[140:141], v51 offset:4096
    ds_read_b64_tr_b16 a[142:143], v51 offset:4608
    s_add_u32 m0, s42, 16384
    s_nop 0
    buffer_load_dwordx4 v44, s[12:15], s54 offen lds
    s_add_u32 m0, s42, 17408
    s_nop 0
    buffer_load_dwordx4 v45, s[12:15], s54 offen lds
    s_add_u32 m0, s42, 24576
    s_nop 0
    buffer_load_dwordx4 v46, s[12:15], s54 offen lds
    s_add_u32 m0, s42, 25600
    s_nop 0
    buffer_load_dwordx4 v47, s[12:15], s54 offen lds
    s_add_u32 s54, s54, 131072
    s_waitcnt lgkmcnt(0)
    v_add_u32 v50, 49152, v48
    v_add_u32 v51, 49152, v49
    s_waitcnt vmcnt(16)
    s_barrier
    ds_read_b64_tr_b16 a[144:145], v50 offset:0
    ds_read_b64_tr_b16 a[146:147], v50 offset:512
    ds_read_b64_tr_b16 a[148:149], v51 offset:0
    ds_read_b64_tr_b16 a[150:151], v51 offset:512
    ds_read_b64_tr_b16 a[152:153], v50 offset:4096
    ds_read_b64_tr_b16 a[154:155], v50 offset:4608
    ds_read_b64_tr_b16 a[156:157], v51 offset:4096
    ds_read_b64_tr_b16 a[158:159], v51 offset:4608
    s_add_u32 m0, s42, 32768
    s_nop 0
    buffer_load_dwordx4 v44, s[12:15], s54 offen lds
    s_add_u32 m0, s42, 33792
    s_nop 0
    buffer_load_dwordx4 v45, s[12:15], s54 offen lds
    s_add_u32 m0, s42, 40960
    s_nop 0
    buffer_load_dwordx4 v46, s[12:15], s54 offen lds
    s_add_u32 m0, s42, 41984
    s_nop 0
    buffer_load_dwordx4 v47, s[12:15], s54 offen lds
    s_add_u32 s54, s54, 131072
    s_waitcnt lgkmcnt(0)
    v_add_u32 v50, 65536, v48
    v_add_u32 v51, 65536, v49
    s_waitcnt vmcnt(16)
    s_barrier
    ds_read_b64_tr_b16 a[160:161], v50 offset:0
    ds_read_b64_tr_b16 a[162:163], v50 offset:512
    ds_read_b64_tr_b16 a[164:165], v51 offset:0
    ds_read_b64_tr_b16 a[166:167], v51 offset:512
    ds_read_b64_tr_b16 a[168:169], v50 offset:4096
    ds_read_b64_tr_b16 a[170:171], v50 offset:4608
    ds_read_b64_tr_b16 a[172:173], v51 offset:4096
    ds_read_b64_tr_b16 a[174:175], v51 offset:4608
    s_add_u32 m0, s42, 49152
    s_nop 0
    buffer_load_dwordx4 v44, s[12:15], s54 offen lds
    s_add_u32 m0, s42, 50176
    s_nop 0
    buffer_load_dwordx4 v45, s[12:15], s54 offen lds
    s_add_u32 m0, s42, 57344
    s_nop 0
    buffer_load_dwordx4 v46, s[12:15], s54 offen lds
    s_add_u32 m0, s42, 58368
    s_nop 0
    buffer_load_dwordx4 v47, s[12:15], s54 offen lds
    s_add_u32 s54, s54, 131072
    s_waitcnt lgkmcnt(0)
    v_add_u32 v50, 81920, v48
    v_add_u32 v51, 81920, v49
    s_waitcnt vmcnt(16)
    s_barrier
    ds_read_b64_tr_b16 a[176:177], v50 offset:0
    ds_read_b64_tr_b16 a[178:179], v50 offset:512
    ds_read_b64_tr_b16 a[180:181], v51 offset:0
    ds_read_b64_tr_b16 a[182:183], v51 offset:512
    ds_read_b64_tr_b16 a[184:185], v50 offset:4096
    ds_read_b64_tr_b16 a[186:187], v50 offset:4608
    ds_read_b64_tr_b16 a[188:189], v51 offset:4096
    ds_read_b64_tr_b16 a[190:191], v51 offset:4608
    s_waitcnt lgkmcnt(0)
    v_add_u32 v50, 0, v48
    v_add_u32 v51, 0, v49
    s_waitcnt vmcnt(12)
    s_barrier
    ds_read_b64_tr_b16 a[192:193], v50 offset:0
    ds_read_b64_tr_b16 a[194:195], v50 offset:512
    ds_read_b64_tr_b16 a[196:197], v51 offset:0
    ds_read_b64_tr_b16 a[198:199], v51 offset:512
    ds_read_b64_tr_b16 a[200:201], v50 offset:4096
    ds_read_b64_tr_b16 a[202:203], v50 offset:4608
    ds_read_b64_tr_b16 a[204:205], v51 offset:4096
    ds_read_b64_tr_b16 a[206:207], v51 offset:4608
    s_waitcnt lgkmcnt(0)
    v_add_u32 v50, 16384, v48
    v_add_u32 v51, 16384, v49
    s_waitcnt vmcnt(8)
    s_barrier
    ds_read_b64_tr_b16 a[208:209], v50 offset:0
    ds_read_b64_tr_b16 a[210:211], v50 offset:512
    ds_read_b64_tr_b16 a[212:213], v51 offset:0
    ds_read_b64_tr_b16 a[214:215], v51 offset:512
    ds_read_b64_tr_b16 a[216:217], v50 offset:4096
    ds_read_b64_tr_b16 a[218:219], v50 offset:4608
    ds_read_b64_tr_b16 a[220:221], v51 offset:4096
    ds_read_b64_tr_b16 a[222:223], v51 offset:4608
    s_waitcnt lgkmcnt(0)
    v_add_u32 v50, 32768, v48
    v_add_u32 v51, 32768, v49
    s_waitcnt vmcnt(4)
    s_barrier
    ds_read_b64_tr_b16 a[224:225], v50 offset:0
    ds_read_b64_tr_b16 a[226:227], v50 offset:512
    ds_read_b64_tr_b16 a[228:229], v51 offset:0
    ds_read_b64_tr_b16 a[230:231], v51 offset:512
    ds_read_b64_tr_b16 a[232:233], v50 offset:4096
    ds_read_b64_tr_b16 a[234:235], v50 offset:4608
    ds_read_b64_tr_b16 a[236:237], v51 offset:4096
    ds_read_b64_tr_b16 a[238:239], v51 offset:4608
    s_waitcnt lgkmcnt(0)
    v_add_u32 v50, 49152, v48
    v_add_u32 v51, 49152, v49
    s_waitcnt vmcnt(0)
    s_barrier
    ds_read_b64_tr_b16 a[240:241], v50 offset:0
    ds_read_b64_tr_b16 a[242:243], v50 offset:512
    ds_read_b64_tr_b16 a[244:245], v51 offset:0
    ds_read_b64_tr_b16 a[246:247], v51 offset:512
    ds_read_b64_tr_b16 a[248:249], v50 offset:4096
    ds_read_b64_tr_b16 a[250:251], v50 offset:4608
    ds_read_b64_tr_b16 a[252:253], v51 offset:4096
    ds_read_b64_tr_b16 a[254:255], v51 offset:4608
    s_waitcnt lgkmcnt(0)
    s_barrier
    s_cmp_lg_u32 s32, 0
    s_cbranch_scc1 L_arv23
    s_add_u32 s20, s82, 0x80
    s_addc_u32 s21, s83, 0
    s_mov_b32 s22, 0x4
    s_mov_b32 s23, 0x00020000
    buffer_load_dword v12, v124, s[20:23], 0 offen sc1
    s_waitcnt vmcnt(0)
    v_cmp_eq_u32 vcc, v124, v12
    s_cbranch_vccnz L_spin24
L_back25:
L_arv23:
    s_add_u32 s96, s41, 2031616
    s_mov_b32 s98, s41
    s_mov_b32 s45, 0x5540000
    buffer_load_dword v136, v4, s[16:19], s45 offen sc1
    s_waitcnt vmcnt(0)
    v_cmp_ne_u32 vcc, 0, v136
    s_cbranch_vccnz L_spin26
L_back27:
    s_barrier
    s_add_u32 m0, s43, 0
    s_add_u32 s42, s41, 0
    buffer_load_dwordx4 v1, s[16:19], s42 offen offset:0 sc1 lds
    buffer_load_dwordx4 v1, s[16:19], s42 offen offset:1024 sc1 lds
    buffer_load_dwordx4 v1, s[16:19], s42 offen offset:2048 sc1 lds
    buffer_load_dwordx4 v1, s[16:19], s42 offen offset:3072 sc1 lds
    s_add_u32 m0, s43, 16384
    s_add_u32 s42, s41, 16384
    buffer_load_dwordx4 v1, s[16:19], s42 offen offset:0 sc1 lds
    buffer_load_dwordx4 v1, s[16:19], s42 offen offset:1024 sc1 lds
    buffer_load_dwordx4 v1, s[16:19], s42 offen offset:2048 sc1 lds
    buffer_load_dwordx4 v1, s[16:19], s42 offen offset:3072 sc1 lds
    s_add_u32 s45, s45, 65536
    s_add_u32 s47, s36, 1
    s_min_i32 s47, s47, 31
    s_max_i32 s47, s47, 0
    s_cmp_ge_u32 s47, 16
    s_cselect_b32 s8, s88, s64
    s_cselect_b32 s9, s89, s65
    s_and_b32 s47, s47, 15
    s_lshl_b32 s47, s47, 16
    s_sub_u32 s47, s50, s47
    s_add_u32 s48, s47, 32768
    buffer_load_dwordx4 v[128:131], v3, s[8:11], s48 offen sc1
    buffer_load_dwordx4 v[132:135], v3, s[8:11], s47 offen sc1
    s_waitcnt vmcnt(0) lgkmcnt(0)
    s_barrier
    v_mfma_f32_16x16x32_bf16 v[12:15], v[108:111], v[128:131], 0
    v_mfma_f32_16x16x32_bf16 v[16:19], v[112:115], v[128:131], 0
    v_mfma_f32_16x16x32_bf16 v[20:23], v[108:111], v[132:135], 0
    v_mfma_f32_16x16x32_bf16 v[24:27], v[112:115], v[132:135], 0
    ds_read_b128 v[44:47], v1 offset:0
    ds_read_b128 v[48:51], v1 offset:1024
    ds_read_b128 v[52:55], v1 offset:2048
    ds_read_b128 v[56:59], v1 offset:3072
    s_mov_b32 s36, 0
    s_waitcnt lgkmcnt(0)
    s_nop 7
L_o_b0:
    s_waitcnt lgkmcnt(2)
    v_mfma_f32_16x16x32_bf16 v[12:15], a[0:3], v[44:47], v[12:15]
    s_add_u32 m0, s43, 32768
    ds_read_b128 v[60:63], v1 offset:4096
    ds_read_b128 v[140:143], v7
    v_mfma_f32_16x16x32_bf16 v[20:23], a[0:3], v[48:51], v[20:23]
    s_cmp_eq_u32 s36, 0
    s_cselect_b32 s49, 0x5e00000, s46
    s_add_u32 s42, s41, 32768
    v_mfma_f32_16x16x32_bf16 v[24:27], a[4:7], v[48:51], v[24:27]
    ds_read_b128 v[64:67], v1 offset:5120
    buffer_load_dwordx4 v1, s[16:19], s42 offen offset:0 sc1 lds
    v_mfma_f32_16x16x32_bf16 v[16:19], a[4:7], v[44:47], v[16:19]
    s_waitcnt lgkmcnt(3)
    v_mfma_f32_16x16x32_bf16 v[12:15], a[8:11], v[52:55], v[12:15]
    s_waitcnt lgkmcnt(1)
    ds_read_b128 v[68:71], v1 offset:6144
    v_add_f32 v140, v140, v141
    v_mfma_f32_16x16x32_bf16 v[20:23], a[8:11], v[56:59], v[20:23]
    v_add_f32 v142, v142, v143
    v_add_f32 v140, v140, v142
    v_mfma_f32_16x16x32_bf16 v[24:27], a[12:15], v[56:59], v[24:27]
    ds_read_b128 v[72:75], v1 offset:7168
    v_min_u32 v140, -2, v140
    v_mfma_f32_16x16x32_bf16 v[16:19], a[12:15], v[52:55], v[16:19]
    s_waitcnt lgkmcnt(2)
    buffer_load_dwordx4 v1, s[16:19], s42 offen offset:1024 sc1 lds
    v_mfma_f32_16x16x32_bf16 v[12:15], a[16:19], v[60:63], v[12:15]
    ds_read_b128 v[44:47], v1 offset:8192
    v_mfma_f32_16x16x32_bf16 v[20:23], a[16:19], v[64:67], v[20:23]
    v_mfma_f32_16x16x32_bf16 v[24:27], a[20:23], v[64:67], v[24:27]
    ds_read_b128 v[48:51], v1 offset:9216
    buffer_load_dwordx4 v1, s[16:19], s42 offen offset:2048 sc1 lds
    v_mfma_f32_16x16x32_bf16 v[16:19], a[20:23], v[60:63], v[16:19]
    s_waitcnt lgkmcnt(2)
    v_mfma_f32_16x16x32_bf16 v[12:15], a[24:27], v[68:71], v[12:15]
    ds_read_b128 v[52:55], v1 offset:10240
    v_mfma_f32_16x16x32_bf16 v[20:23], a[24:27], v[72:75], v[20:23]
    buffer_load_dwordx4 v1, s[16:19], s42 offen offset:3072 sc1 lds
    v_mfma_f32_16x16x32_bf16 v[24:27], a[28:31], v[72:75], v[24:27]
    s_add_u32 m0, s43, 49152
    ds_read_b128 v[56:59], v1 offset:11264
    buffer_store_dword v140, v8, s[16:19], s49 offen sc1
    v_mfma_f32_16x16x32_bf16 v[16:19], a[28:31], v[68:71], v[16:19]
    s_waitcnt lgkmcnt(2)
    s_add_u32 s42, s41, 49152
    v_mfma_f32_16x16x32_bf16 v[12:15], a[32:35], v[44:47], v[12:15]
    ds_read_b128 v[60:63], v1 offset:12288
    buffer_load_dwordx4 v1, s[16:19], s42 offen offset:0 sc1 lds
    v_mfma_f32_16x16x32_bf16 v[20:23], a[32:35], v[48:51], v[20:23]
    v_mfma_f32_16x16x32_bf16 v[24:27], a[36:39], v[48:51], v[24:27]
    ds_read_b128 v[64:67], v1 offset:13312
    v_mfma_f32_16x16x32_bf16 v[16:19], a[36:39], v[44:47], v[16:19]
    s_waitcnt lgkmcnt(2)
    buffer_load_dwordx4 v1, s[16:19], s42 offen offset:1024 sc1 lds
    v_mfma_f32_16x16x32_bf16 v[12:15], a[40:43], v[52:55], v[12:15]
    s_waitcnt vmcnt(7)
    ds_read_b128 v[68:71], v1 offset:14336
    s_barrier
    v_mfma_f32_16x16x32_bf16 v[20:23], a[40:43], v[56:59], v[20:23]
    buffer_store_dword v124, v124, s[16:19], s91 offen sc1
    v_mfma_f32_16x16x32_bf16 v[24:27], a[44:47], v[56:59], v[24:27]
    s_add_u32 s91, s91, 65536
    ds_read_b128 v[72:75], v1 offset:15360
    buffer_load_dwordx4 v1, s[16:19], s42 offen offset:2048 sc1 lds
    v_mfma_f32_16x16x32_bf16 v[16:19], a[44:47], v[52:55], v[16:19]
    s_waitcnt lgkmcnt(2)
    v_mfma_f32_16x16x32_bf16 v[12:15], a[48:51], v[60:63], v[12:15]
    ds_read_b128 v[44:47], v1 offset:16384
    v_mfma_f32_16x16x32_bf16 v[20:23], a[48:51], v[64:67], v[20:23]
    buffer_load_dwordx4 v1, s[16:19], s42 offen offset:3072 sc1 lds
    v_mfma_f32_16x16x32_bf16 v[24:27], a[52:55], v[64:67], v[24:27]
    s_add_u32 s98, s98, 65536
    ds_read_b128 v[48:51], v1 offset:17408
    s_min_i32 s98, s98, s96
    v_mfma_f32_16x16x32_bf16 v[16:19], a[52:55], v[60:63], v[16:19]
    s_waitcnt lgkmcnt(2)
    s_and_b32 s41, s98, 0xffffffff
    s_add_u32 m0, s43, 98304
    v_mfma_f32_16x16x32_bf16 v[12:15], a[56:59], v[68:71], v[12:15]
    s_add_u32 s42, s41, 0
    ds_read_b128 v[52:55], v1 offset:18432
    s_add_u32 s47, s36, 1
    v_mfma_f32_16x16x32_bf16 v[20:23], a[56:59], v[72:75], v[20:23]
    s_min_i32 s47, s47, 31
    s_max_i32 s47, s47, 0
    s_cmp_ge_u32 s47, 16
    v_mfma_f32_16x16x32_bf16 v[24:27], a[60:63], v[72:75], v[24:27]
    s_cselect_b32 s8, s88, s64
    ds_read_b128 v[56:59], v1 offset:19456
    s_cselect_b32 s9, s89, s65
    v_mfma_f32_16x16x32_bf16 v[16:19], a[60:63], v[68:71], v[16:19]
    s_waitcnt lgkmcnt(2)
    s_and_b32 s47, s47, 15
    s_lshl_b32 s47, s47, 16
    v_mfma_f32_16x16x32_bf16 v[12:15], a[64:67], v[44:47], v[12:15]
    s_sub_u32 s47, s50, s47
    ds_read_b128 v[60:63], v1 offset:20480
    s_add_u32 s48, s47, 32768
    v_mfma_f32_16x16x32_bf16 v[20:23], a[64:67], v[48:51], v[20:23]
    buffer_load_dwordx4 v[128:131], v3, s[8:11], s48 offen sc1
    v_mfma_f32_16x16x32_bf16 v[24:27], a[68:71], v[48:51], v[24:27]
    ds_read_b128 v[64:67], v1 offset:21504
    buffer_load_dwordx4 v[132:135], v3, s[8:11], s47 offen sc1
    v_mfma_f32_16x16x32_bf16 v[16:19], a[68:71], v[44:47], v[16:19]
    s_waitcnt lgkmcnt(2)
    s_add_u32 s90, s90, 65536
    s_add_u32 s46, s46, 2048
    v_mfma_f32_16x16x32_bf16 v[12:15], a[72:75], v[52:55], v[12:15]
    s_and_b32 s44, s90, 0xffffffff
    ds_read_b128 v[68:71], v1 offset:22528
    v_mfma_f32_16x16x32_bf16 v[20:23], a[72:75], v[56:59], v[20:23]
    v_mfma_f32_16x16x32_bf16 v[24:27], a[76:79], v[56:59], v[24:27]
    ds_read_b128 v[72:75], v1 offset:23552
    v_mfma_f32_16x16x32_bf16 v[16:19], a[76:79], v[52:55], v[16:19]
    s_waitcnt lgkmcnt(2)
    v_mfma_f32_16x16x32_bf16 v[12:15], a[80:83], v[60:63], v[12:15]
    ds_read_b128 v[44:47], v1 offset:24576
    v_mfma_f32_16x16x32_bf16 v[20:23], a[80:83], v[64:67], v[20:23]
    v_mfma_f32_16x16x32_bf16 v[24:27], a[84:87], v[64:67], v[24:27]
    ds_read_b128 v[48:51], v1 offset:25600
    v_mfma_f32_16x16x32_bf16 v[16:19], a[84:87], v[60:63], v[16:19]
    s_waitcnt lgkmcnt(2)
    v_mfma_f32_16x16x32_bf16 v[12:15], a[88:91], v[68:71], v[12:15]
    ds_read_b128 v[52:55], v1 offset:26624
    v_mfma_f32_16x16x32_bf16 v[20:23], a[88:91], v[72:75], v[20:23]
    v_mfma_f32_16x16x32_bf16 v[24:27], a[92:95], v[72:75], v[24:27]
    ds_read_b128 v[56:59], v1 offset:27648
    v_mfma_f32_16x16x32_bf16 v[16:19], a[92:95], v[68:71], v[16:19]
    s_waitcnt lgkmcnt(2)
    v_mfma_f32_16x16x32_bf16 v[12:15], a[96:99], v[44:47], v[12:15]
    ds_read_b128 v[60:63], v1 offset:28672
    v_mfma_f32_16x16x32_bf16 v[20:23], a[96:99], v[48:51], v[20:23]
    v_mfma_f32_16x16x32_bf16 v[24:27], a[100:103], v[48:51], v[24:27]
    ds_read_b128 v[64:67], v1 offset:29696
    v_mfma_f32_16x16x32_bf16 v[16:19], a[100:103], v[44:47], v[16:19]
    s_waitcnt lgkmcnt(2)
    v_mfma_f32_16x16x32_bf16 v[12:15], a[104:107], v[52:55], v[12:15]
    ds_read_b128 v[68:71], v1 offset:30720
    v_mfma_f32_16x16x32_bf16 v[20:23], a[104:107], v[56:59], v[20:23]
    v_mfma_f32_16x16x32_bf16 v[24:27], a[108:111], v[56:59], v[24:27]
    ds_read_b128 v[72:75], v1 offset:31744
    v_mfma_f32_16x16x32_bf16 v[16:19], a[108:111], v[52:55], v[16:19]
    s_waitcnt vmcnt(8) lgkmcnt(2)
    s_barrier
    v_mfma_f32_16x16x32_bf16 v[12:15], a[112:115], v[60:63], v[12:15]
    ds_read_b128 v[44:47], v1 offset:32768
    v_mfma_f32_16x16x32_bf16 v[20:23], a[112:115], v[64:67], v[20:23]
    v_mfma_f32_16x16x32_bf16 v[24:27], a[116:119], v[64:67], v[24:27]
    ds_read_b128 v[48:51], v1 offset:33792
    v_mfma_f32_16x16x32_bf16 v[16:19], a[116:119], v[60:63], v[16:19]
    s_waitcnt lgkmcnt(2)
    v_mfma_f32_16x16x32_bf16 v[12:15], a[120:123], v[68:71], v[12:15]
    ds_read_b128 v[52:55], v1 offset:34816
    v_mfma_f32_16x16x32_bf16 v[20:23], a[120:123], v[72:75], v[20:23]
    v_mfma_f32_16x16x32_bf16 v[24:27], a[124:127], v[72:75], v[24:27]
    ds_read_b128 v[56:59], v1 offset:35840
    v_mfma_f32_16x16x32_bf16 v[16:19], a[124:127], v[68:71], v[16:19]
    s_waitcnt lgkmcnt(2)
    v_mfma_f32_16x16x32_bf16 v[12:15], a[128:131], v[44:47], v[12:15]
    ds_read_b128 v[60:63], v1 offset:36864
    v_mfma_f32_16x16x32_bf16 v[20:23], a[128:131], v[48:51], v[20:23]
    v_mfma_f32_16x16x32_bf16 v[24:27], a[132:135], v[48:51], v[24:27]
    ds_read_b128 v[64:67], v1 offset:37888
    v_mfma_f32_16x16x32_bf16 v[16:19], a[132:135], v[44:47], v[16:19]
    s_waitcnt lgkmcnt(2)
    v_mfma_f32_16x16x32_bf16 v[12:15], a[136:139], v[52:55], v[12:15]
    ds_read_b128 v[68:71], v1 offset:38912
    v_mfma_f32_16x16x32_bf16 v[20:23], a[136:139], v[56:59], v[20:23]
    v_mfma_f32_16x16x32_bf16 v[24:27], a[140:143], v[56:59], v[24:27]
    ds_read_b128 v[72:75], v1 offset:39936
    buffer_load_dword v136, v4, s[16:19], s45 offen sc1
    v_mfma_f32_16x16x32_bf16 v[16:19], a[140:143], v[52:55], v[16:19]
    s_waitcnt lgkmcnt(2)
    v_mfma_f32_16x16x32_bf16 v[12:15], a[144:147], v[60:63], v[12:15]
    ds_read_b128 v[44:47], v1 offset:40960
    v_mfma_f32_16x16x32_bf16 v[20:23], a[144:147], v[64:67], v[20:23]
    v_mfma_f32_16x16x32_bf16 v[24:27], a[148:151], v[64:67], v[24:27]
    ds_read_b128 v[48:51], v1 offset:41984
    v_mfma_f32_16x16x32_bf16 v[16:19], a[148:151], v[60:63], v[16:19]
    s_waitcnt lgkmcnt(2)
    v_mfma_f32_16x16x32_bf16 v[12:15], a[152:155], v[68:71], v[12:15]
    ds_read_b128 v[52:55], v1 offset:43008
    v_mfma_f32_16x16x32_bf16 v[20:23], a[152:155], v[72:75], v[20:23]
    v_mfma_f32_16x16x32_bf16 v[24:27], a[156:159], v[72:75], v[24:27]
    ds_read_b128 v[56:59], v1 offset:44032
    v_mfma_f32_16x16x32_bf16 v[16:19], a[156:159], v[68:71], v[16:19]
    s_waitcnt lgkmcnt(2)
    v_mfma_f32_16x16x32_bf16 v[12:15], a[160:163], v[44:47], v[12:15]
    ds_read_b128 v[60:63], v1 offset:45056
    v_mfma_f32_16x16x32_bf16 v[20:23], a[160:163], v[48:51], v[20:23]
    v_mfma_f32_16x16x32_bf16 v[24:27], a[164:167], v[48:51], v[24:27]
    ds_read_b128 v[64:67], v1 offset:46080
    v_mfma_f32_16x16x32_bf16 v[16:19], a[164:167], v[44:47], v[16:19]
    s_waitcnt lgkmcnt(2)
    v_mfma_f32_16x16x32_bf16 v[12:15], a[168:171], v[52:55], v[12:15]
    ds_read_b128 v[68:71], v1 offset:47104
    v_mfma_f32_16x16x32_bf16 v[20:23], a[168:171], v[56:59], v[20:23]
    v_mfma_f32_16x16x32_bf16 v[24:27], a[172:175], v[56:59], v[24:27]
    ds_read_b128 v[72:75], v1 offset:48128
    v_mfma_f32_16x16x32_bf16 v[16:19], a[172:175], v[52:55], v[16:19]
    s_waitcnt vmcnt(3) lgkmcnt(2)
    s_barrier
    v_mfma_f32_16x16x32_bf16 v[12:15], a[176:179], v[60:63], v[12:15]
    ds_read_b128 v[44:47], v1 offset:49152
    v_mfma_f32_16x16x32_bf16 v[20:23], a[176:179], v[64:67], v[20:23]
    v_mfma_f32_16x16x32_bf16 v[24:27], a[180:183], v[64:67], v[24:27]
    ds_read_b128 v[48:51], v1 offset:50176
    v_mfma_f32_16x16x32_bf16 v[16:19], a[180:183], v[60:63], v[16:19]
    s_waitcnt lgkmcnt(2)
    v_mfma_f32_16x16x32_bf16 v[12:15], a[184:187], v[68:71], v[12:15]
    ds_read_b128 v[52:55], v1 offset:51200
    v_mfma_f32_16x16x32_bf16 v[20:23], a[184:187], v[72:75], v[20:23]
    v_mfma_f32_16x16x32_bf16 v[24:27], a[188:191], v[72:75], v[24:27]
    ds_read_b128 v[56:59], v1 offset:52224
    v_mfma_f32_16x16x32_bf16 v[16:19], a[188:191], v[68:71], v[16:19]
    s_waitcnt lgkmcnt(2)
    v_mfma_f32_16x16x32_bf16 v[12:15], a[192:195], v[44:47], v[12:15]
    s_waitcnt vmcnt(1)
    ds_read_b128 v[60:63], v1 offset:53248
    v_mfma_f32_16x16x32_bf16 v[28:31], v[108:111], v[128:131], 0
    v_mfma_f32_16x16x32_bf16 v[32:35], v[112:115], v[128:131], 0
    v_mfma_f32_16x16x32_bf16 v[36:39], v[108:111], v[132:135], 0
    v_mfma_f32_16x16x32_bf16 v[40:43], v[112:115], v[132:135], 0
    v_mfma_f32_16x16x32_bf16 v[20:23], a[192:195], v[48:51], v[20:23]
    v_mfma_f32_16x16x32_bf16 v[24:27], a[196:199], v[48:51], v[24:27]
    ds_read_b128 v[64:67], v1 offset:54272
    v_mfma_f32_16x16x32_bf16 v[16:19], a[196:199], v[44:47], v[16:19]
    s_waitcnt lgkmcnt(2)
    v_mfma_f32_16x16x32_bf16 v[12:15], a[200:203], v[52:55], v[12:15]
    ds_read_b128 v[68:71], v1 offset:55296
    v_mfma_f32_16x16x32_bf16 v[20:23], a[200:203], v[56:59], v[20:23]
    v_mfma_f32_16x16x32_bf16 v[24:27], a[204:207], v[56:59], v[24:27]
    ds_read_b128 v[72:75], v1 offset:56320
    v_mfma_f32_16x16x32_bf16 v[16:19], a[204:207], v[52:55], v[16:19]
    s_waitcnt lgkmcnt(2)
    v_mfma_f32_16x16x32_bf16 v[12:15], a[208:211], v[60:63], v[12:15]
    ds_read_b128 v[44:47], v1 offset:57344
    v_mfma_f32_16x16x32_bf16 v[20:23], a[208:211], v[64:67], v[20:23]
    v_mfma_f32_16x16x32_bf16 v[24:27], a[212:215], v[64:67], v[24:27]
    ds_read_b128 v[48:51], v1 offset:58368
    v_mfma_f32_16x16x32_bf16 v[16:19], a[212:215], v[60:63], v[16:19]
    s_waitcnt lgkmcnt(2)
    v_mfma_f32_16x16x32_bf16 v[12:15], a[216:219], v[68:71], v[12:15]
    ds_read_b128 v[52:55], v1 offset:59392
    v_mfma_f32_16x16x32_bf16 v[20:23], a[216:219], v[72:75], v[20:23]
    v_mfma_f32_16x16x32_bf16 v[24:27], a[220:223], v[72:75], v[24:27]
    s_waitcnt vmcnt(0)
    ds_read_b128 v[56:59], v1 offset:60416
    v_cmp_ne_u32 vcc, 0, v136
    v_mfma_f32_16x16x32_bf16 v[16:19], a[220:223], v[68:71], v[16:19]
    s_waitcnt lgkmcnt(2)
    v_mfma_f32_16x16x32_bf16 v[12:15], a[224:227], v[44:47], v[12:15]
    s_cbranch_vccnz L_spin28
L_back29:
    ds_read_b128 v[60:63], v1 offset:61440
    s_barrier
    v_mfma_f32_16x16x32_bf16 v[20:23], a[224:227], v[48:51], v[20:23]
    s_add_u32 s45, s45, 65536
    buffer_load_dwordx4 v1, s[16:19], s42 offen offset:0 sc1 lds
    v_mfma_f32_16x16x32_bf16 v[24:27], a[228:231], v[48:51], v[24:27]
    ds_read_b128 v[64:67], v1 offset:62464
    v_mfma_f32_16x16x32_bf16 v[16:19], a[228:231], v[44:47], v[16:19]
    s_waitcnt lgkmcnt(2)
    v_mfma_f32_16x16x32_bf16 v[12:15], a[232:235], v[52:55], v[12:15]
    ds_read_b128 v[68:71], v1 offset:63488
    buffer_load_dwordx4 v1, s[16:19], s42 offen offset:1024 sc1 lds
    v_mfma_f32_16x16x32_bf16 v[20:23], a[232:235], v[56:59], v[20:23]
    v_mfma_f32_16x16x32_bf16 v[24:27], a[236:239], v[56:59], v[24:27]
    ds_read_b128 v[72:75], v1 offset:64512
    v_mfma_f32_16x16x32_bf16 v[16:19], a[236:239], v[52:55], v[16:19]
    s_waitcnt lgkmcnt(2)
    buffer_load_dwordx4 v1, s[16:19], s42 offen offset:2048 sc1 lds
    v_mfma_f32_16x16x32_bf16 v[12:15], a[240:243], v[60:63], v[12:15]
    v_mfma_f32_16x16x32_bf16 v[20:23], a[240:243], v[64:67], v[20:23]
    v_mfma_f32_16x16x32_bf16 v[24:27], a[244:247], v[64:67], v[24:27]
    buffer_load_dwordx4 v1, s[16:19], s42 offen offset:3072 sc1 lds
    v_mfma_f32_16x16x32_bf16 v[16:19], a[244:247], v[60:63], v[16:19]
    s_waitcnt lgkmcnt(0)
    v_mfma_f32_16x16x32_bf16 v[12:15], a[248:251], v[68:71], v[12:15]
    v_mfma_f32_16x16x32_bf16 v[20:23], a[248:251], v[72:75], v[20:23]
    v_mfma_f32_16x16x32_bf16 v[24:27], a[252:255], v[72:75], v[24:27]
    v_mfma_f32_16x16x32_bf16 v[16:19], a[252:255], v[68:71], v[16:19]
    s_nop 1
    v_cvt_pk_bf16_f32 v148, v12, v13
    v_cvt_pk_bf16_f32 v149, v14, v15
    s_nop 3
    v_cvt_pk_bf16_f32 v150, v16, v17
    v_cvt_pk_bf16_f32 v151, v18, v19
    buffer_store_dwordx4 v[148:151], v1, s[16:19], s44 offen offset:0 sc1
    v_cvt_pk_bf16_f32 v152, v20, v21
    v_cvt_pk_bf16_f32 v153, v22, v23
    v_cvt_pk_bf16_f32 v154, v24, v25
    v_cvt_pk_bf16_f32 v155, v26, v27
    buffer_store_dwordx4 v[152:155], v1, s[16:19], s44 offen offset:1024 sc1
    s_add_u32 m0, s43, 114688
    s_add_u32 s42, s41, 16384
    v_add_f32 v140, v12, v13
    v_add_f32 v144, v20, v21
    v_mul_f32 v141, v12, v12
    v_mul_f32 v145, v20, v20
    buffer_load_dwordx4 v1, s[16:19], s42 offen offset:0 sc1 lds
    v_fmac_f32 v141, v13, v13
    v_fmac_f32 v145, v21, v21
    v_add_f32 v140, v140, v14
    v_add_f32 v144, v144, v22
    v_fmac_f32 v141, v14, v14
    v_fmac_f32 v145, v22, v22
    v_add_f32 v140, v140, v15
    v_add_f32 v144, v144, v23
    buffer_load_dwordx4 v1, s[16:19], s42 offen offset:1024 sc1 lds
    v_fmac_f32 v141, v15, v15
    v_fmac_f32 v145, v23, v23
    v_add_f32 v140, v140, v16
    v_add_f32 v144, v144, v24
    v_fmac_f32 v141, v16, v16
    v_fmac_f32 v145, v24, v24
    v_add_f32 v140, v140, v17
    v_add_f32 v144, v144, v25
    buffer_load_dwordx4 v1, s[16:19], s42 offen offset:2048 sc1 lds
    v_fmac_f32 v141, v17, v17
    v_fmac_f32 v145, v25, v25
    v_add_f32 v140, v140, v18
    v_add_f32 v144, v144, v26
    v_fmac_f32 v141, v18, v18
    v_fmac_f32 v145, v26, v26
    v_add_f32 v140, v140, v19
    v_add_f32 v144, v144, v27
    buffer_load_dwordx4 v1, s[16:19], s42 offen offset:3072 sc1 lds
    v_fmac_f32 v141, v19, v19
    v_fmac_f32 v145, v27, v27
    s_nop 0
    v_permlane16_swap_b32 v140, v141
    v_permlane16_swap_b32 v144, v145
    v_add_f32 v140, v140, v141
    v_add_f32 v144, v144, v145
    v_mov_b32 v142, v140
    v_mov_b32 v146, v144
    s_nop 0
    v_permlane32_swap_b32 v140, v142
    v_permlane32_swap_b32 v144, v146
    v_add_f32 v140, v140, v142
    v_add_f32 v144, v144, v146
    ds_write_b32 v6, v140 offset:0
    ds_write_b32 v6, v144 offset:512
    s_waitcnt vmcnt(6) lgkmcnt(0)
    s_barrier
    ds_read_b128 v[44:47], v2 offset:0
    ds_read_b128 v[48:51], v2 offset:1024
    ds_read_b128 v[52:55], v2 offset:2048
    ds_read_b128 v[56:59], v2 offset:3072
    s_add_u32 s36, s36, 1
L_o_b1:
    s_waitcnt lgkmcnt(2)
    v_mfma_f32_16x16x32_bf16 v[28:31], a[0:3], v[44:47], v[28:31]
    s_add_u32 m0, s43, 131072
    ds_read_b128 v[60:63], v2 offset:4096
    ds_read_b128 v[140:143], v7
    v_mfma_f32_16x16x32_bf16 v[36:39], a[0:3], v[48:51], v[36:39]
    s_cmp_eq_u32 s36, 0
    s_cselect_b32 s49, 0x5e00000, s46
    s_add_u32 s42, s41, 32768
    v_mfma_f32_16x16x32_bf16 v[40:43], a[4:7], v[48:51], v[40:43]
    ds_read_b128 v[64:67], v2 offset:5120
    buffer_load_dwordx4 v1, s[16:19], s42 offen offset:0 sc1 lds
    v_mfma_f32_16x16x32_bf16 v[32:35], a[4:7], v[44:47], v[32:35]
    s_waitcnt lgkmcnt(3)
    v_mfma_f32_16x16x32_bf16 v[28:31], a[8:11], v[52:55], v[28:31]
    s_waitcnt lgkmcnt(1)
    ds_read_b128 v[68:71], v2 offset:6144
    v_add_f32 v140, v140, v141
    v_mfma_f32_16x16x32_bf16 v[36:39], a[8:11], v[56:59], v[36:39]
    v_add_f32 v142, v142, v143
    v_add_f32 v140, v140, v142
    v_mfma_f32_16x16x32_bf16 v[40:43], a[12:15], v[56:59], v[40:43]
    ds_read_b128 v[72:75], v2 offset:7168
    v_min_u32 v140, -2, v140
    v_mfma_f32_16x16x32_bf16 v[32:35], a[12:15], v[52:55], v[32:35]
    s_waitcnt lgkmcnt(2)
    buffer_load_dwordx4 v1, s[16:19], s42 offen offset:1024 sc1 lds
    v_mfma_f32_16x16x32_bf16 v[28:31], a[16:19], v[60:63], v[28:31]
    ds_read_b128 v[44:47], v2 offset:8192
    v_mfma_f32_16x16x32_bf16 v[36:39], a[16:19], v[64:67], v[36:39]
    v_mfma_f32_16x16x32_bf16 v[40:43], a[20:23], v[64:67], v[40:43]
    ds_read_b128 v[48:51], v2 offset:9216
    buffer_load_dwordx4 v1, s[16:19], s42 offen offset:2048 sc1 lds
    v_mfma_f32_16x16x32_bf16 v[32:35], a[20:23], v[60:63], v[32:35]
    s_waitcnt lgkmcnt(2)
    v_mfma_f32_16x16x32_bf16 v[28:31], a[24:27], v[68:71], v[28:31]
    ds_read_b128 v[52:55], v2 offset:10240
    v_mfma_f32_16x16x32_bf16 v[36:39], a[24:27], v[72:75], v[36:39]
    buffer_load_dwordx4 v1, s[16:19], s42 offen offset:3072 sc1 lds
    v_mfma_f32_16x16x32_bf16 v[40:43], a[28:31], v[72:75], v[40:43]
    s_add_u32 m0, s43, 147456
    ds_read_b128 v[56:59], v2 offset:11264
    buffer_store_dword v140, v8, s[16:19], s49 offen sc1
    v_mfma_f32_16x16x32_bf16 v[32:35], a[28:31], v[68:71], v[32:35]
    s_waitcnt lgkmcnt(2)
    s_add_u32 s42, s41, 49152
    v_mfma_f32_16x16x32_bf16 v[28:31], a[32:35], v[44:47], v[28:31]
    ds_read_b128 v[60:63], v2 offset:12288
    buffer_load_dwordx4 v1, s[16:19], s42 offen offset:0 sc1 lds
    v_mfma_f32_16x16x32_bf16 v[36:39], a[32:35], v[48:51], v[36:39]
    v_mfma_f32_16x16x32_bf16 v[40:43], a[36:39], v[48:51], v[40:43]
    ds_read_b128 v[64:67], v2 offset:13312
    v_mfma_f32_16x16x32_bf16 v[32:35], a[36:39], v[44:47], v[32:35]
    s_waitcnt lgkmcnt(2)
    buffer_load_dwordx4 v1, s[16:19], s42 offen offset:1024 sc1 lds
    v_mfma_f32_16x16x32_bf16 v[28:31], a[40:43], v[52:55], v[28:31]
    s_waitcnt vmcnt(7)
    ds_read_b128 v[68:71], v2 offset:14336
    s_barrier
    v_mfma_f32_16x16x32_bf16 v[36:39], a[40:43], v[56:59], v[36:39]
    buffer_store_dword v124, v124, s[16:19], s91 offen sc1
    v_mfma_f32_16x16x32_bf16 v[40:43], a[44:47], v[56:59], v[40:43]
    s_add_u32 s91, s91, 65536
    ds_read_b128 v[72:75], v2 offset:15360
    buffer_load_dwordx4 v1, s[16:19], s42 offen offset:2048 sc1 lds
    v_mfma_f32_16x16x32_bf16 v[32:35], a[44:47], v[52:55], v[32:35]
    s_waitcnt lgkmcnt(2)
    v_mfma_f32_16x16x32_bf16 v[28:31], a[48:51], v[60:63], v[28:31]
    ds_read_b128 v[44:47], v2 offset:16384
    v_mfma_f32_16x16x32_bf16 v[36:39], a[48:51], v[64:67], v[36:39]
    buffer_load_dwordx4 v1, s[16:19], s42 offen offset:3072 sc1 lds
    v_mfma_f32_16x16x32_bf16 v[40:43], a[52:55], v[64:67], v[40:43]
    s_add_u32 s98, s98, 65536
    ds_read_b128 v[48:51], v2 offset:17408
    s_min_i32 s98, s98, s96
    v_mfma_f32_16x16x32_bf16 v[32:35], a[52:55], v[60:63], v[32:35]
    s_waitcnt lgkmcnt(2)
    s_and_b32 s41, s98, 0xffffffff
    s_add_u32 m0, s43, 0
    v_mfma_f32_16x16x32_bf16 v[28:31], a[56:59], v[68:71], v[28:31]
    s_add_u32 s42, s41, 0
    ds_read_b128 v[52:55], v2 offset:18432
    s_add_u32 s47, s36, 1
    v_mfma_f32_16x16x32_bf16 v[36:39], a[56:59], v[72:75], v[36:39]
    s_min_i32 s47, s47, 31
    s_max_i32 s47, s47, 0
    s_cmp_ge_u32 s47, 16
    v_mfma_f32_16x16x32_bf16 v[40:43], a[60:63], v[72:75], v[40:43]
    s_cselect_b32 s8, s88, s64
    ds_read_b128 v[56:59], v2 offset:19456
    s_cselect_b32 s9, s89, s65
    v_mfma_f32_16x16x32_bf16 v[32:35], a[60:63], v[68:71], v[32:35]
    s_waitcnt lgkmcnt(2)
    s_and_b32 s47, s47, 15
    s_lshl_b32 s47, s47, 16
    v_mfma_f32_16x16x32_bf16 v[28:31], a[64:67], v[44:47], v[28:31]
    s_sub_u32 s47, s50, s47
    ds_read_b128 v[60:63], v2 offset:20480
    s_add_u32 s48, s47, 32768
    v_mfma_f32_16x16x32_bf16 v[36:39], a[64:67], v[48:51], v[36:39]
    buffer_load_dwordx4 v[128:131], v3, s[8:11], s48 offen sc1
    v_mfma_f32_16x16x32_bf16 v[40:43], a[68:71], v[48:51], v[40:43]
    ds_read_b128 v[64:67], v2 offset:21504
    buffer_load_dwordx4 v[132:135], v3, s[8:11], s47 offen sc1
    v_mfma_f32_16x16x32_bf16 v[32:35], a[68:71], v[44:47], v[32:35]
    s_waitcnt lgkmcnt(2)
    s_add_u32 s90, s90, 65536
    s_add_u32 s46, s46, 2048
    v_mfma_f32_16x16x32_bf16 v[28:31], a[72:75], v[52:55], v[28:31]
    s_and_b32 s44, s90, 0xffffffff
    ds_read_b128 v[68:71], v2 offset:22528
    v_mfma_f32_16x16x32_bf16 v[36:39], a[72:75], v[56:59], v[36:39]
    v_mfma_f32_16x16x32_bf16 v[40:43], a[76:79], v[56:59], v[40:43]
    ds_read_b128 v[72:75], v2 offset:23552
    v_mfma_f32_16x16x32_bf16 v[32:35], a[76:79], v[52:55], v[32:35]
    s_waitcnt lgkmcnt(2)
    v_mfma_f32_16x16x32_bf16 v[28:31], a[80:83], v[60:63], v[28:31]
    ds_read_b128 v[44:47], v2 offset:24576
    v_mfma_f32_16x16x32_bf16 v[36:39], a[80:83], v[64:67], v[36:39]
    v_mfma_f32_16x16x32_bf16 v[40:43], a[84:87], v[64:67], v[40:43]
    ds_read_b128 v[48:51], v2 offset:25600
    v_mfma_f32_16x16x32_bf16 v[32:35], a[84:87], v[60:63], v[32:35]
    s_waitcnt lgkmcnt(2)
    v_mfma_f32_16x16x32_bf16 v[28:31], a[88:91], v[68:71], v[28:31]
    ds_read_b128 v[52:55], v2 offset:26624
    v_mfma_f32_16x16x32_bf16 v[36:39], a[88:91], v[72:75], v[36:39]
    v_mfma_f32_16x16x32_bf16 v[40:43], a[92:95], v[72:75], v[40:43]
    ds_read_b128 v[56:59], v2 offset:27648
    v_mfma_f32_16x16x32_bf16 v[32:35], a[92:95], v[68:71], v[32:35]
    s_waitcnt lgkmcnt(2)
    v_mfma_f32_16x16x32_bf16 v[28:31], a[96:99], v[44:47], v[28:31]
    ds_read_b128 v[60:63], v2 offset:28672
    v_mfma_f32_16x16x32_bf16 v[36:39], a[96:99], v[48:51], v[36:39]
    v_mfma_f32_16x16x32_bf16 v[40:43], a[100:103], v[48:51], v[40:43]
    ds_read_b128 v[64:67], v2 offset:29696
    v_mfma_f32_16x16x32_bf16 v[32:35], a[100:103], v[44:47], v[32:35]
    s_waitcnt lgkmcnt(2)
    v_mfma_f32_16x16x32_bf16 v[28:31], a[104:107], v[52:55], v[28:31]
    ds_read_b128 v[68:71], v2 offset:30720
    v_mfma_f32_16x16x32_bf16 v[36:39], a[104:107], v[56:59], v[36:39]
    v_mfma_f32_16x16x32_bf16 v[40:43], a[108:111], v[56:59], v[40:43]
    ds_read_b128 v[72:75], v2 offset:31744
    v_mfma_f32_16x16x32_bf16 v[32:35], a[108:111], v[52:55], v[32:35]
    s_waitcnt vmcnt(8) lgkmcnt(2)
    s_barrier
    v_mfma_f32_16x16x32_bf16 v[28:31], a[112:115], v[60:63], v[28:31]
    ds_read_b128 v[44:47], v2 offset:32768
    v_mfma_f32_16x16x32_bf16 v[36:39], a[112:115], v[64:67], v[36:39]
    v_mfma_f32_16x16x32_bf16 v[40:43], a[116:119], v[64:67], v[40:43]
    ds_read_b128 v[48:51], v2 offset:33792
    v_mfma_f32_16x16x32_bf16 v[32:35], a[116:119], v[60:63], v[32:35]
    s_waitcnt lgkmcnt(2)
    v_mfma_f32_16x16x32_bf16 v[28:31], a[120:123], v[68:71], v[28:31]
    ds_read_b128 v[52:55], v2 offset:34816
    v_mfma_f32_16x16x32_bf16 v[36:39], a[120:123], v[72:75], v[36:39]
    v_mfma_f32_16x16x32_bf16 v[40:43], a[124:127], v[72:75], v[40:43]
    ds_read_b128 v[56:59], v2 offset:35840
    v_mfma_f32_16x16x32_bf16 v[32:35], a[124:127], v[68:71], v[32:35]
    s_waitcnt lgkmcnt(2)
    v_mfma_f32_16x16x32_bf16 v[28:31], a[128:131], v[44:47], v[28:31]
    ds_read_b128 v[60:63], v2 offset:36864
    v_mfma_f32_16x16x32_bf16 v[36:39], a[128:131], v[48:51], v[36:39]
    v_mfma_f32_16x16x32_bf16 v[40:43], a[132:135], v[48:51], v[40:43]
    ds_read_b128 v[64:67], v2 offset:37888
    v_mfma_f32_16x16x32_bf16 v[32:35], a[132:135], v[44:47], v[32:35]
    s_waitcnt lgkmcnt(2)
    v_mfma_f32_16x16x32_bf16 v[28:31], a[136:139], v[52:55], v[28:31]
    ds_read_b128 v[68:71], v2 offset:38912
    v_mfma_f32_16x16x32_bf16 v[36:39], a[136:139], v[56:59], v[36:39]
    v_mfma_f32_16x16x32_bf16 v[40:43], a[140:143], v[56:59], v[40:43]
    ds_read_b128 v[72:75], v2 offset:39936
    buffer_load_dword v136, v4, s[16:19], s45 offen sc1
    v_mfma_f32_16x16x32_bf16 v[32:35], a[140:143], v[52:55], v[32:35]
    s_waitcnt lgkmcnt(2)
    v_mfma_f32_16x16x32_bf16 v[28:31], a[144:147], v[60:63], v[28:31]
    ds_read_b128 v[44:47], v2 offset:40960
    v_mfma_f32_16x16x32_bf16 v[36:39], a[144:147], v[64:67], v[36:39]
    v_mfma_f32_16x16x32_bf16 v[40:43], a[148:151], v[64:67], v[40:43]
    ds_read_b128 v[48:51], v2 offset:41984
    v_mfma_f32_16x16x32_bf16 v[32:35], a[148:151], v[60:63], v[32:35]
    s_waitcnt lgkmcnt(2)
    v_mfma_f32_16x16x32_bf16 v[28:31], a[152:155], v[68:71], v[28:31]
    ds_read_b128 v[52:55], v2 offset:43008
    v_mfma_f32_16x16x32_bf16 v[36:39], a[152:155], v[72:75], v[36:39]
    v_mfma_f32_16x16x32_bf16 v[40:43], a[156:159], v[72:75], v[40:43]
    ds_read_b128 v[56:59], v2 offset:44032
    v_mfma_f32_16x16x32_bf16 v[32:35], a[156:159], v[68:71], v[32:35]
    s_waitcnt lgkmcnt(2)
    v_mfma_f32_16x16x32_bf16 v[28:31], a[160:163], v[44:47], v[28:31]
    ds_read_b128 v[60:63], v2 offset:45056
    v_mfma_f32_16x16x32_bf16 v[36:39], a[160:163], v[48:51], v[36:39]
    v_mfma_f32_16x16x32_bf16 v[40:43], a[164:167], v[48:51], v[40:43]
    ds_read_b128 v[64:67], v2 offset:46080
    v_mfma_f32_16x16x32_bf16 v[32:35], a[164:167], v[44:47], v[32:35]
    s_waitcnt lgkmcnt(2)
    v_mfma_f32_16x16x32_bf16 v[28:31], a[168:171], v[52:55], v[28:31]
    ds_read_b128 v[68:71], v2 offset:47104
    v_mfma_f32_16x16x32_bf16 v[36:39], a[168:171], v[56:59], v[36:39]
    v_mfma_f32_16x16x32_bf16 v[40:43], a[172:175], v[56:59], v[40:43]
    ds_read_b128 v[72:75], v2 offset:48128
    v_mfma_f32_16x16x32_bf16 v[32:35], a[172:175], v[52:55], v[32:35]
    s_waitcnt vmcnt(3) lgkmcnt(2)
    s_barrier
    v_mfma_f32_16x16x32_bf16 v[28:31], a[176:179], v[60:63], v[28:31]
    ds_read_b128 v[44:47], v2 offset:49152
    v_mfma_f32_16x16x32_bf16 v[36:39], a[176:179], v[64:67], v[36:39]
    v_mfma_f32_16x16x32_bf16 v[40:43], a[180:183], v[64:67], v[40:43]
    ds_read_b128 v[48:51], v2 offset:50176
    v_mfma_f32_16x16x32_bf16 v[32:35], a[180:183], v[60:63], v[32:35]
    s_waitcnt lgkmcnt(2)
    v_mfma_f32_16x16x32_bf16 v[28:31], a[184:187], v[68:71], v[28:31]
    ds_read_b128 v[52:55], v2 offset:51200
    v_mfma_f32_16x16x32_bf16 v[36:39], a[184:187], v[72:75], v[36:39]
    v_mfma_f32_16x16x32_bf16 v[40:43], a[188:191], v[72:75], v[40:43]
    ds_read_b128 v[56:59], v2 offset:52224
    v_mfma_f32_16x16x32_bf16 v[32:35], a[188:191], v[68:71], v[32:35]
    s_waitcnt lgkmcnt(2)
    v_mfma_f32_16x16x32_bf16 v[28:31], a[192:195], v[44:47], v[28:31]
    s_waitcnt vmcnt(1)
    ds_read_b128 v[60:63], v2 offset:53248
    v_mfma_f32_16x16x32_bf16 v[12:15], v[108:111], v[128:131], 0
    v_mfma_f32_16x16x32_bf16 v[16:19], v[112:115], v[128:131], 0
    v_mfma_f32_16x16x32_bf16 v[20:23], v[108:111], v[132:135], 0
    v_mfma_f32_16x16x32_bf16 v[24:27], v[112:115], v[132:135], 0
    v_mfma_f32_16x16x32_bf16 v[36:39], a[192:195], v[48:51], v[36:39]
    v_mfma_f32_16x16x32_bf16 v[40:43], a[196:199], v[48:51], v[40:43]
    ds_read_b128 v[64:67], v2 offset:54272
    v_mfma_f32_16x16x32_bf16 v[32:35], a[196:199], v[44:47], v[32:35]
    s_waitcnt lgkmcnt(2)
    v_mfma_f32_16x16x32_bf16 v[28:31], a[200:203], v[52:55], v[28:31]
    ds_read_b128 v[68:71], v2 offset:55296
    v_mfma_f32_16x16x32_bf16 v[36:39], a[200:203], v[56:59], v[36:39]
    v_mfma_f32_16x16x32_bf16 v[40:43], a[204:207], v[56:59], v[40:43]
    ds_read_b128 v[72:75], v2 offset:56320
    v_mfma_f32_16x16x32_bf16 v[32:35], a[204:207], v[52:55], v[32:35]
    s_waitcnt lgkmcnt(2)
    v_mfma_f32_16x16x32_bf16 v[28:31], a[208:211], v[60:63], v[28:31]
    ds_read_b128 v[44:47], v2 offset:57344
    v_mfma_f32_16x16x32_bf16 v[36:39], a[208:211], v[64:67], v[36:39]
    v_mfma_f32_16x16x32_bf16 v[40:43], a[212:215], v[64:67], v[40:43]
    ds_read_b128 v[48:51], v2 offset:58368
    v_mfma_f32_16x16x32_bf16 v[32:35], a[212:215], v[60:63], v[32:35]
    s_waitcnt lgkmcnt(2)
    v_mfma_f32_16x16x32_bf16 v[28:31], a[216:219], v[68:71], v[28:31]
    ds_read_b128 v[52:55], v2 offset:59392
    v_mfma_f32_16x16x32_bf16 v[36:39], a[216:219], v[72:75], v[36:39]
    v_mfma_f32_16x16x32_bf16 v[40:43], a[220:223], v[72:75], v[40:43]
    s_waitcnt vmcnt(0)
    ds_read_b128 v[56:59], v2 offset:60416
    v_cmp_ne_u32 vcc, 0, v136
    v_mfma_f32_16x16x32_bf16 v[32:35], a[220:223], v[68:71], v[32:35]
    s_waitcnt lgkmcnt(2)
    v_mfma_f32_16x16x32_bf16 v[28:31], a[224:227], v[44:47], v[28:31]
    s_cbranch_vccnz L_spin30
L_back31:
    ds_read_b128 v[60:63], v2 offset:61440
    s_barrier
    v_mfma_f32_16x16x32_bf16 v[36:39], a[224:227], v[48:51], v[36:39]
    s_add_u32 s45, s45, 65536
    buffer_load_dwordx4 v1, s[16:19], s42 offen offset:0 sc1 lds
    v_mfma_f32_16x16x32_bf16 v[40:43], a[228:231], v[48:51], v[40:43]
    ds_read_b128 v[64:67], v2 offset:62464
    v_mfma_f32_16x16x32_bf16 v[32:35], a[228:231], v[44:47], v[32:35]
    s_waitcnt lgkmcnt(2)
    v_mfma_f32_16x16x32_bf16 v[28:31], a[232:235], v[52:55], v[28:31]
    ds_read_b128 v[68:71], v2 offset:63488
    buffer_load_dwordx4 v1, s[16:19], s42 offen offset:1024 sc1 lds
    v_mfma_f32_16x16x32_bf16 v[36:39], a[232:235], v[56:59], v[36:39]
    v_mfma_f32_16x16x32_bf16 v[40:43], a[236:239], v[56:59], v[40:43]
    ds_read_b128 v[72:75], v2 offset:64512
    v_mfma_f32_16x16x32_bf16 v[32:35], a[236:239], v[52:55], v[32:35]
    s_waitcnt lgkmcnt(2)
    buffer_load_dwordx4 v1, s[16:19], s42 offen offset:2048 sc1 lds
    v_mfma_f32_16x16x32_bf16 v[28:31], a[240:243], v[60:63], v[28:31]
    v_mfma_f32_16x16x32_bf16 v[36:39], a[240:243], v[64:67], v[36:39]
    v_mfma_f32_16x16x32_bf16 v[40:43], a[244:247], v[64:67], v[40:43]
    buffer_load_dwordx4 v1, s[16:19], s42 offen offset:3072 sc1 lds
    v_mfma_f32_16x16x32_bf16 v[32:35], a[244:247], v[60:63], v[32:35]
    s_waitcnt lgkmcnt(0)
    v_mfma_f32_16x16x32_bf16 v[28:31], a[248:251], v[68:71], v[28:31]
    v_mfma_f32_16x16x32_bf16 v[36:39], a[248:251], v[72:75], v[36:39]
    v_mfma_f32_16x16x32_bf16 v[40:43], a[252:255], v[72:75], v[40:43]
    v_mfma_f32_16x16x32_bf16 v[32:35], a[252:255], v[68:71], v[32:35]
    s_nop 1
    v_cvt_pk_bf16_f32 v148, v28, v29
    v_cvt_pk_bf16_f32 v149, v30, v31
    s_nop 3
    v_cvt_pk_bf16_f32 v150, v32, v33
    v_cvt_pk_bf16_f32 v151, v34, v35
    buffer_store_dwordx4 v[148:151], v1, s[16:19], s44 offen offset:0 sc1
    v_cvt_pk_bf16_f32 v152, v36, v37
    v_cvt_pk_bf16_f32 v153, v38, v39
    v_cvt_pk_bf16_f32 v154, v40, v41
    v_cvt_pk_bf16_f32 v155, v42, v43
    buffer_store_dwordx4 v[152:155], v1, s[16:19], s44 offen offset:1024 sc1
    s_add_u32 m0, s43, 16384
    s_add_u32 s42, s41, 16384
    v_add_f32 v140, v28, v29
    v_add_f32 v144, v36, v37
    v_mul_f32 v141, v28, v28
    v_mul_f32 v145, v36, v36
    buffer_load_dwordx4 v1, s[16:19], s42 offen offset:0 sc1 lds
    v_fmac_f32 v141, v29, v29
    v_fmac_f32 v145, v37, v37
    v_add_f32 v140, v140, v30
    v_add_f32 v144, v144, v38
    v_fmac_f32 v141, v30, v30
    v_fmac_f32 v145, v38, v38
    v_add_f32 v140, v140, v31
    v_add_f32 v144, v144, v39
    buffer_load_dwordx4 v1, s[16:19], s42 offen offset:1024 sc1 lds
    v_fmac_f32 v141, v31, v31
    v_fmac_f32 v145, v39, v39
    v_add_f32 v140, v140, v32
    v_add_f32 v144, v144, v40
    v_fmac_f32 v141, v32, v32
    v_fmac_f32 v145, v40, v40
    v_add_f32 v140, v140, v33
    v_add_f32 v144, v144, v41
    buffer_load_dwordx4 v1, s[16:19], s42 offen offset:2048 sc1 lds
    v_fmac_f32 v141, v33, v33
    v_fmac_f32 v145, v41, v41
    v_add_f32 v140, v140, v34
    v_add_f32 v144, v144, v42
    v_fmac_f32 v141, v34, v34
    v_fmac_f32 v145, v42, v42
    v_add_f32 v140, v140, v35
    v_add_f32 v144, v144, v43
    buffer_load_dwordx4 v1, s[16:19], s42 offen offset:3072 sc1 lds
    v_fmac_f32 v141, v35, v35
    v_fmac_f32 v145, v43, v43
    s_nop 0
    v_permlane16_swap_b32 v140, v141
    v_permlane16_swap_b32 v144, v145
    v_add_f32 v140, v140, v141
    v_add_f32 v144, v144, v145
    v_mov_b32 v142, v140
    v_mov_b32 v146, v144
    s_nop 0
    v_permlane32_swap_b32 v140, v142
    v_permlane32_swap_b32 v144, v146
    v_add_f32 v140, v140, v142
    v_add_f32 v144, v144, v146
    ds_write_b32 v6, v140 offset:0
    ds_write_b32 v6, v144 offset:512
    s_waitcnt vmcnt(6) lgkmcnt(0)
    s_barrier
    ds_read_b128 v[44:47], v1 offset:0
    ds_read_b128 v[48:51], v1 offset:1024
    ds_read_b128 v[52:55], v1 offset:2048
    ds_read_b128 v[56:59], v1 offset:3072
    s_add_u32 s36, s36, 1
    s_cmp_lt_u32 s36, 32
    s_cbranch_scc1 L_o_b0
    s_nop 7
    ds_read_b128 v[140:143], v7
    s_cmp_eq_u32 s36, 0
    s_cselect_b32 s49, 0x5e00000, s46
    s_waitcnt lgkmcnt(0)
    v_add_f32 v140, v140, v141
    v_add_f32 v142, v142, v143
    v_add_f32 v140, v140, v142
    v_min_u32 v140, -2, v140
    buffer_store_dword v140, v8, s[16:19], s49 offen sc1
    s_waitcnt vmcnt(5)
    s_barrier
    buffer_store_dword v124, v124, s[16:19], s91 offen sc1
    s_add_u32 s91, s91, 65536
    s_waitcnt vmcnt(0)
    s_endpgm
L_spin24:
    s_mov_b32 s40, 0x20000
L_spin24_l:
    buffer_load_dword v12, v124, s[20:23], 0 offen sc1
    s_sub_u32 s40, s40, 1
    s_waitcnt vmcnt(0)
    v_cmp_eq_u32 vcc, v124, v12
    s_cbranch_scc1 L_back25
    s_cbranch_vccz L_back25
    s_sleep 8
    s_branch L_spin24_l
L_spin26:
    s_mov_b32 s40, 0x20000
L_spin26_l:
    buffer_load_dword v136, v4, s[16:19], s45 offen sc1
    s_sub_u32 s40, s40, 1
    s_waitcnt vmcnt(0)
    v_cmp_ne_u32 vcc, 0, v136
    s_cbranch_scc1 L_back27
    s_cbranch_vccz L_back27
    s_sleep 2
    s_branch L_spin26_l
L_spin28:
    s_mov_b32 s40, 0x20000
L_spin28_l:
    buffer_load_dword v136, v4, s[16:19], s45 offen sc1
    s_sub_u32 s40, s40, 1
    s_waitcnt vmcnt(0)
    v_cmp_ne_u32 vcc, 0, v136
    s_cbranch_scc1 L_back29
    s_cbranch_vccz L_back29
    s_sleep 2
    s_branch L_spin28_l
L_spin30:
    s_mov_b32 s40, 0x20000
L_spin30_l:
    buffer_load_dword v136, v4, s[16:19], s45 offen sc1
    s_sub_u32 s40, s40, 1
    s_waitcnt vmcnt(0)
    v_cmp_ne_u32 vcc, 0, v136
    s_cbranch_scc1 L_back31
    s_cbranch_vccz L_back31
    s_sleep 2
    s_branch L_spin30_l
L_role_40:
    s_sub_u32 s35, s34, 40
    s_lshl_b32 s51, s35, 2
    s_add_u32 s51, s51, 96
    s_lshl_b32 s54, s51, 6
    s_mov_b32 s12, s72
    s_mov_b32 s13, s73
    s_mov_b32 s14, 0x700000
    s_mov_b32 s15, 0x00020000
    s_mov_b32 s39, 7168
    v_lshrrev_b32 v64, 3, v0
    v_lshlrev_b32 v65, 2, v0
    v_and_b32 v65, 64, v65
    v_and_b32 v66, 0x70, v1
    v_xor_b32 v65, v65, v66
    v_mad_u32_u24 v56, v64, s39, v65
    v_add_u32 v57, 57344, v56
    v_add_u32 v58, 128, v56
    v_add_u32 v59, 57472, v56
    s_mul_i32 s38, s32, 114688
    s_add_u32 s54, s54, s38
    s_lshl_b32 s42, s32, 11
    s_add_u32 m0, s42, 0
    s_nop 0
    buffer_load_dwordx4 v56, s[12:15], s54 offen lds
    s_add_u32 m0, s42, 1024
    s_nop 0
    buffer_load_dwordx4 v57, s[12:15], s54 offen lds
    s_add_u32 m0, s42, 8192
    s_nop 0
    buffer_load_dwordx4 v58, s[12:15], s54 offen lds
    s_add_u32 m0, s42, 9216
    s_nop 0
    buffer_load_dwordx4 v59, s[12:15], s54 offen lds
    s_add_u32 s54, s54, 458752
    s_add_u32 m0, s42, 16384
    s_nop 0
    buffer_load_dwordx4 v56, s[12:15], s54 offen lds
    s_add_u32 m0, s42, 17408
    s_nop 0
    buffer_load_dwordx4 v57, s[12:15], s54 offen lds
    s_add_u32 m0, s42, 24576
    s_nop 0
    buffer_load_dwordx4 v58, s[12:15], s54 offen lds
    s_add_u32 m0, s42, 25600
    s_nop 0
    buffer_load_dwordx4 v59, s[12:15], s54 offen lds
    s_add_u32 s54, s54, 458752
    s_add_u32 m0, s42, 32768
    s_nop 0
    buffer_load_dwordx4 v56, s[12:15], s54 offen lds
    s_add_u32 m0, s42, 33792
    s_nop 0
    buffer_load_dwordx4 v57, s[12:15], s54 offen lds
    s_add_u32 m0, s42, 40960
    s_nop 0
    buffer_load_dwordx4 v58, s[12:15], s54 offen lds
    s_add_u32 m0, s42, 41984
    s_nop 0
    buffer_load_dwordx4 v59, s[12:15], s54 offen lds
    s_add_u32 s54, s54, 458752
    s_add_u32 m0, s42, 49152
    s_nop 0
    buffer_load_dwordx4 v56, s[12:15], s54 offen lds
    s_add_u32 m0, s42, 50176
    s_nop 0
    buffer_load_dwordx4 v57, s[12:15], s54 offen lds
    s_add_u32 m0, s42, 57344
    s_nop 0
    buffer_load_dwordx4 v58, s[12:15], s54 offen lds
    s_add_u32 m0, s42, 58368
    s_nop 0
    buffer_load_dwordx4 v59, s[12:15], s54 offen lds
    s_add_u32 s54, s54, 458752
    s_add_u32 m0, s42, 65536
    s_nop 0
    buffer_load_dwordx4 v56, s[12:15], s54 offen lds
    s_add_u32 m0, s42, 66560
    s_nop 0
    buffer_load_dwordx4 v57, s[12:15], s54 offen lds
    s_add_u32 m0, s42, 73728
    s_nop 0
    buffer_load_dwordx4 v58, s[12:15], s54 offen lds
    s_add_u32 m0, s42, 74752
    s_nop 0
    buffer_load_dwordx4 v59, s[12:15], s54 offen lds
    s_add_u32 s54, s54, 458752
    v_lshrrev_b32 v64, 4, v0
    v_bfe_u32 v65, v0, 2, 2
    v_lshl_add_u32 v64, v64, 3, v65
    v_lshlrev_b32 v64, 7, v64
    v_lshrrev_b32 v65, 1, v65
    v_lshl_add_u32 v64, v65, 6, v64
    v_and_b32 v65, 3, v0
    v_lshl_add_u32 v64, v65, 4, v64
    s_lshr_b32 s37, s32, 1
    s_lshl_b32 s37, s37, 13
    s_and_b32 s38, s32, 1
    s_lshl_b32 s38, s38, 6
    s_add_u32 s37, s37, s38
    s_add_u32 s37, s37, 0
    v_xor_b32 v60, s37, v64
    s_lshr_b32 s37, s32, 1
    s_lshl_b32 s37, s37, 13
    s_and_b32 s38, s32, 1
    s_lshl_b32 s38, s38, 6
    s_add_u32 s37, s37, s38
    s_add_u32 s37, s37, 8
    v_xor_b32 v61, s37, v64
    v_mov_b32 v64, 0x3f803f80
    v_mov_b32 v65, 0x3f803f80
    v_mov_b32 v66, 0x3f803f80
    v_mov_b32 v67, 0x3f803f80
    v_add_u32 v2, 98304, v1
    s_lshl_b32 s37, s33, 6
    s_add_u32 s37, s37, 16
    s_lshl_b32 s37, s37, 7
    v_lshl_add_u32 v5, v0, 7, s37
    s_cmp_eq_u32 s32, 0
    s_cselect_b32 s37, 8, 0
    v_cmp_le_u32 vcc, s37, v0
    s_nop 1
    v_cndmask_b32 v5, v5, 2.0, vcc
    s_lshl_b32 s43, s32, 12
    s_mul_i32 s41, s33, 2097152
    s_add_u32 s41, s41, 0x800000
    s_add_u32 s41, s41, s43
    s_mul_i32 s90, s33, 8388608
    s_add_u32 s90, s90, 0xfc0000
    s_add_u32 s37, s51, s32
    s_lshl_b32 s37, s37, 11
    s_add_u32 s90, s90, s37
    s_lshl_b32 s37, s32, 10
    s_sub_u32 s87, 8192, s37
    s_lshl_b32 s38, s35, 1
    s_lshr_b32 s39, s32, 1
    s_add_u32 s38, s38, s39
    s_cmp_eq_u32 s38, 36
    s_cselect_b32 s88, 0x5e00000, 0
    s_and_b32 s38, s32, 1
    s_lshl_b32 s38, s38, 3
    s_and_b32 s39, s32, 2
    s_lshl_b32 s39, s39, 10
    s_add_u32 s38, s38, s39
    s_add_u32 s38, s38, 65536
    v_add_u32 v3, s38, v1
    s_add_u32 s37, s37, 65536
    v_add_u32 v4, s37, v1
    v_and_b32 v6, 15, v0
    v_lshlrev_b32 v6, 3, v6
    v_lshrrev_b32 v8, 5, v0
    v_lshl_add_u32 v6, v8, 9, v6
    v_and_b32 v8, 16, v0
    v_lshl_add_u32 v6, v8, 6, v6
    v_add_u32 v118, 73728, v6
    s_mul_i32 s46, s33, 65536
    s_add_u32 s46, s46, 0x5440000
    s_add_u32 s55, s46, 63488
    s_and_b32 s52, s32, 1
    s_lshl_b32 s52, s52, 10
    s_mov_b32 s8, s74
    s_mov_b32 s9, s75
    s_mov_b32 s10, 0x1c00
    s_mov_b32 s11, 0x00020000
    v_and_b32 v8, 0x30, v0
    s_add_u32 s37, s51, s32
    s_lshl_b32 s37, s37, 6
    buffer_load_dwordx4 v[16:19], v8, s[8:11], s37 offen
    s_lshr_b32 s37, s32, 1
    s_add_u32 s37, s37, s51
    s_lshl_b32 s37, s37, 6
    s_and_b32 s38, s32, 1
    s_lshl_b32 s38, s38, 3
    s_add_u32 s37, s37, s38
    buffer_load_dwordx2 v[20:21], v8, s[8:11], s37 offen offset:256
    v_add_u32 v62, 0, v60
    v_add_u32 v63, 0, v61
    s_waitcnt vmcnt(18)
    s_barrier
    ds_read_b64_tr_b16 a[0:1], v62 offset:0
    ds_read_b64_tr_b16 a[2:3], v62 offset:512
    ds_read_b64_tr_b16 a[4:5], v63 offset:0
    ds_read_b64_tr_b16 a[6:7], v63 offset:512
    ds_read_b64_tr_b16 a[8:9], v62 offset:4096
    ds_read_b64_tr_b16 a[10:11], v62 offset:4608
    ds_read_b64_tr_b16 a[12:13], v63 offset:4096
    ds_read_b64_tr_b16 a[14:15], v63 offset:4608
    s_add_u32 m0, s42, 81920
    s_nop 0
    buffer_load_dwordx4 v56, s[12:15], s54 offen lds
    s_add_u32 m0, s42, 82944
    s_nop 0
    buffer_load_dwordx4 v57, s[12:15], s54 offen lds
    s_add_u32 m0, s42, 90112
    s_nop 0
    buffer_load_dwordx4 v58, s[12:15], s54 offen lds
    s_add_u32 m0, s42, 91136
    s_nop 0
    buffer_load_dwordx4 v59, s[12:15], s54 offen lds
    s_add_u32 s54, s54, 458752
    s_waitcnt lgkmcnt(0)
    v_mfma_f32_16x16x32_bf16 v[88:91], a[0:3], v[64:67], 0
    v_mfma_f32_16x16x32_bf16 v[92:95], a[4:7], v[64:67], 0
    v_mfma_f32_16x16x32_bf16 v[88:91], a[8:11], v[64:67], v[88:91]
    v_mfma_f32_16x16x32_bf16 v[92:95], a[12:15], v[64:67], v[92:95]
    v_add_u32 v62, 16384, v60
    v_add_u32 v63, 16384, v61
    s_waitcnt vmcnt(18)
    s_barrier
    ds_read_b64_tr_b16 a[16:17], v62 offset:0
    ds_read_b64_tr_b16 a[18:19], v62 offset:512
    ds_read_b64_tr_b16 a[20:21], v63 offset:0
    ds_read_b64_tr_b16 a[22:23], v63 offset:512
    ds_read_b64_tr_b16 a[24:25], v62 offset:4096
    ds_read_b64_tr_b16 a[26:27], v62 offset:4608
    ds_read_b64_tr_b16 a[28:29], v63 offset:4096
    ds_read_b64_tr_b16 a[30:31], v63 offset:4608
    s_add_u32 m0, s42, 0
    s_nop 0
    buffer_load_dwordx4 v56, s[12:15], s54 offen lds
    s_add_u32 m0, s42, 1024
    s_nop 0
    buffer_load_dwordx4 v57, s[12:15], s54 offen lds
    s_add_u32 m0, s42, 8192
    s_nop 0
    buffer_load_dwordx4 v58, s[12:15], s54 offen lds
    s_add_u32 m0, s42, 9216
    s_nop 0
    buffer_load_dwordx4 v59, s[12:15], s54 offen lds
    s_add_u32 s54, s54, 458752
    s_waitcnt lgkmcnt(0)
    v_mfma_f32_16x16x32_bf16 v[88:91], a[16:19], v[64:67], v[88:91]
    v_mfma_f32_16x16x32_bf16 v[92:95], a[20:23], v[64:67], v[92:95]
    v_mfma_f32_16x16x32_bf16 v[88:91], a[24:27], v[64:67], v[88:91]
    v_mfma_f32_16x16x32_bf16 v[92:95], a[28:31], v[64:67], v[92:95]
    v_add_u32 v62, 32768, v60
    v_add_u32 v63, 32768, v61
    s_waitcnt vmcnt(18)
    s_barrier
    ds_read_b64_tr_b16 a[32:33], v62 offset:0
    ds_read_b64_tr_b16 a[34:35], v62 offset:512
    ds_read_b64_tr_b16 a[36:37], v63 offset:0
    ds_read_b64_tr_b16 a[38:39], v63 offset:512
    ds_read_b64_tr_b16 a[40:41], v62 offset:4096
    ds_read_b64_tr_b16 a[42:43], v62 offset:4608
    ds_read_b64_tr_b16 a[44:45], v63 offset:4096
    ds_read_b64_tr_b16 a[46:47], v63 offset:4608
    s_add_u32 m0, s42, 16384
    s_nop 0
    buffer_load_dwordx4 v56, s[12:15], s54 offen lds
    s_add_u32 m0, s42, 17408
    s_nop 0
    buffer_load_dwordx4 v57, s[12:15], s54 offen lds
    s_add_u32 m0, s42, 24576
    s_nop 0
    buffer_load_dwordx4 v58, s[12:15], s54 offen lds
    s_add_u32 m0, s42, 25600
    s_nop 0
    buffer_load_dwordx4 v59, s[12:15], s54 offen lds
    s_add_u32 s54, s54, 458752
    s_waitcnt lgkmcnt(0)
    v_mfma_f32_16x16x32_bf16 v[88:91], a[32:35], v[64:67], v[88:91]
    v_mfma_f32_16x16x32_bf16 v[92:95], a[36:39], v[64:67], v[92:95]
    v_mfma_f32_16x16x32_bf16 v[88:91], a[40:43], v[64:67], v[88:91]
    v_mfma_f32_16x16x32_bf16 v[92:95], a[44:47], v[64:67], v[92:95]
    v_add_u32 v62, 49152, v60
    v_add_u32 v63, 49152, v61
    s_waitcnt vmcnt(18)
    s_barrier
    ds_read_b64_tr_b16 a[48:49], v62 offset:0
    ds_read_b64_tr_b16 a[50:51], v62 offset:512
    ds_read_b64_tr_b16 a[52:53], v63 offset:0
    ds_read_b64_tr_b16 a[54:55], v63 offset:512
    ds_read_b64_tr_b16 a[56:57], v62 offset:4096
    ds_read_b64_tr_b16 a[58:59], v62 offset:4608
    ds_read_b64_tr_b16 a[60:61], v63 offset:4096
    ds_read_b64_tr_b16 a[62:63], v63 offset:4608
    s_add_u32 m0, s42, 32768
    s_nop 0
    buffer_load_dwordx4 v56, s[12:15], s54 offen lds
    s_add_u32 m0, s42, 33792
    s_nop 0
    buffer_load_dwordx4 v57, s[12:15], s54 offen lds
    s_add_u32 m0, s42, 40960
    s_nop 0
    buffer_load_dwordx4 v58, s[12:15], s54 offen lds
    s_add_u32 m0, s42, 41984
    s_nop 0
    buffer_load_dwordx4 v59, s[12:15], s54 offen lds
    s_add_u32 s54, s54, 458752
    s_waitcnt lgkmcnt(0)
    v_mfma_f32_16x16x32_bf16 v[88:91], a[48:51], v[64:67], v[88:91]
    v_mfma_f32_16x16x32_bf16 v[92:95], a[52:55], v[64:67], v[92:95]
    v_mfma_f32_16x16x32_bf16 v[88:91], a[56:59], v[64:67], v[88:91]
    v_mfma_f32_16x16x32_bf16 v[92:95], a[60:63], v[64:67], v[92:95]
    v_add_u32 v62, 65536, v60
    v_add_u32 v63, 65536, v61
    s_waitcnt vmcnt(18)
    s_barrier
    ds_read_b64_tr_b16 a[64:65], v62 offset:0
    ds_read_b64_tr_b16 a[66:67], v62 offset:512
    ds_read_b64_tr_b16 a[68:69], v63 offset:0
    ds_read_b64_tr_b16 a[70:71], v63 offset:512
    ds_read_b64_tr_b16 a[72:73], v62 offset:4096
    ds_read_b64_tr_b16 a[74:75], v62 offset:4608
    ds_read_b64_tr_b16 a[76:77], v63 offset:4096
    ds_read_b64_tr_b16 a[78:79], v63 offset:4608
    s_add_u32 m0, s42, 49152
    s_nop 0
    buffer_load_dwordx4 v56, s[12:15], s54 offen lds
    s_add_u32 m0, s42, 50176
    s_nop 0
    buffer_load_dwordx4 v57, s[12:15], s54 offen lds
    s_add_u32 m0, s42, 57344
    s_nop 0
    buffer_load_dwordx4 v58, s[12:15], s54 offen lds
    s_add_u32 m0, s42, 58368
    s_nop 0
    buffer_load_dwordx4 v59, s[12:15], s54 offen lds
    s_add_u32 s54, s54, 458752
    s_waitcnt lgkmcnt(0)
    v_mfma_f32_16x16x32_bf16 v[88:91], a[64:67], v[64:67], v[88:91]
    v_mfma_f32_16x16x32_bf16 v[92:95], a[68:71], v[64:67], v[92:95]
    v_mfma_f32_16x16x32_bf16 v[88:91], a[72:75], v[64:67], v[88:91]
    v_mfma_f32_16x16x32_bf16 v[92:95], a[76:79], v[64:67], v[92:95]
    v_add_u32 v62, 81920, v60
    v_add_u32 v63, 81920, v61
    s_waitcnt vmcnt(16)
    s_barrier
    ds_read_b64_tr_b16 a[80:81], v62 offset:0
    ds_read_b64_tr_b16 a[82:83], v62 offset:512
    ds_read_b64_tr_b16 a[84:85], v63 offset:0
    ds_read_b64_tr_b16 a[86:87], v63 offset:512
    ds_read_b64_tr_b16 a[88:89], v62 offset:4096
    ds_read_b64_tr_b16 a[90:91], v62 offset:4608
    ds_read_b64_tr_b16 a[92:93], v63 offset:4096
    ds_read_b64_tr_b16 a[94:95], v63 offset:4608
    s_add_u32 m0, s42, 65536
    s_nop 0
    buffer_load_dwordx4 v56, s[12:15], s54 offen lds
    s_add_u32 m0, s42, 66560
    s_nop 0
    buffer_load_dwordx4 v57, s[12:15], s54 offen lds
    s_add_u32 m0, s42, 73728
    s_nop 0
    buffer_load_dwordx4 v58, s[12:15], s54 offen lds
    s_add_u32 m0, s42, 74752
    s_nop 0
    buffer_load_dwordx4 v59, s[12:15], s54 offen lds
    s_add_u32 s54, s54, 458752
    s_waitcnt lgkmcnt(0)
    v_mfma_f32_16x16x32_bf16 v[88:91], a[80:83], v[64:67], v[88:91]
    v_mfma_f32_16x16x32_bf16 v[92:95], a[84:87], v[64:67], v[92:95]
    v_mfma_f32_16x16x32_bf16 v[88:91], a[88:91], v[64:67], v[88:91]
    v_mfma_f32_16x16x32_bf16 v[92:95], a[92:95], v[64:67], v[92:95]
    v_add_u32 v62, 0, v60
    v_add_u32 v63, 0, v61
    s_waitcnt vmcnt(16)
    s_barrier
    ds_read_b64_tr_b16 a[96:97], v62 offset:0
    ds_read_b64_tr_b16 a[98:99], v62 offset:512
    ds_read_b64_tr_b16 a[100:101], v63 offset:0
    ds_read_b64_tr_b16 a[102:103], v63 offset:512
    ds_read_b64_tr_b16 a[104:105], v62 offset:4096
    ds_read_b64_tr_b16 a[106:107], v62 offset:4608
    ds_read_b64_tr_b16 a[108:109], v63 offset:4096
    ds_read_b64_tr_b16 a[110:111], v63 offset:4608
    s_add_u32 m0, s42, 81920
    s_nop 0
    buffer_load_dwordx4 v56, s[12:15], s54 offen lds
    s_add_u32 m0, s42, 82944
    s_nop 0
    buffer_load_dwordx4 v57, s[12:15], s54 offen lds
    s_add_u32 m0, s42, 90112
    s_nop 0
    buffer_load_dwordx4 v58, s[12:15], s54 offen lds
    s_add_u32 m0, s42, 91136
    s_nop 0
    buffer_load_dwordx4 v59, s[12:15], s54 offen lds
    s_add_u32 s54, s54, 458752
    s_waitcnt lgkmcnt(0)
    v_mfma_f32_16x16x32_bf16 v[88:91], a[96:99], v[64:67], v[88:91]
    v_mfma_f32_16x16x32_bf16 v[92:95], a[100:103], v[64:67], v[92:95]
    v_mfma_f32_16x16x32_bf16 v[88:91], a[104:107], v[64:67], v[88:91]
    v_mfma_f32_16x16x32_bf16 v[92:95], a[108:111], v[64:67], v[92:95]
    v_add_u32 v62, 16384, v60
    v_add_u32 v63, 16384, v61
    s_waitcnt vmcnt(16)
    s_barrier
    ds_read_b64_tr_b16 a[112:113], v62 offset:0
    ds_read_b64_tr_b16 a[114:115], v62 offset:512
    ds_read_b64_tr_b16 a[116:117], v63 offset:0
    ds_read_b64_tr_b16 a[118:119], v63 offset:512
    ds_read_b64_tr_b16 a[120:121], v62 offset:4096
    ds_read_b64_tr_b16 a[122:123], v62 offset:4608
    ds_read_b64_tr_b16 a[124:125], v63 offset:4096
    ds_read_b64_tr_b16 a[126:127], v63 offset:4608
    s_add_u32 m0, s42, 0
    s_nop 0
    buffer_load_dwordx4 v56, s[12:15], s54 offen lds
    s_add_u32 m0, s42, 1024
    s_nop 0
    buffer_load_dwordx4 v57, s[12:15], s54 offen lds
    s_add_u32 m0, s42, 8192
    s_nop 0
    buffer_load_dwordx4 v58, s[12:15], s54 offen lds
    s_add_u32 m0, s42, 9216
    s_nop 0
    buffer_load_dwordx4 v59, s[12:15], s54 offen lds
    s_add_u32 s54, s54, 458752
    s_waitcnt lgkmcnt(0)
    v_mfma_f32_16x16x32_bf16 v[88:91], a[112:115], v[64:67], v[88:91]
    v_mfma_f32_16x16x32_bf16 v[92:95], a[116:119], v[64:67], v[92:95]
    v_mfma_f32_16x16x32_bf16 v[88:91], a[120:123], v[64:67], v[88:91]
    v_mfma_f32_16x16x32_bf16 v[92:95], a[124:127], v[64:67], v[92:95]
    v_add_u32 v62, 32768, v60
    v_add_u32 v63, 32768, v61
    s_waitcnt vmcnt(16)
    s_barrier
    ds_read_b64_tr_b16 a[128:129], v62 offset:0
    ds_read_b64_tr_b16 a[130:131], v62 offset:512
    ds_read_b64_tr_b16 a[132:133], v63 offset:0
    ds_read_b64_tr_b16 a[134:135], v63 offset:512
    ds_read_b64_tr_b16 a[136:137], v62 offset:4096
    ds_read_b64_tr_b16 a[138:139], v62 offset:4608
    ds_read_b64_tr_b16 a[140:141], v63 offset:4096
    ds_read_b64_tr_b16 a[142:143], v63 offset:4608
    s_add_u32 m0, s42, 16384
    s_nop 0
    buffer_load_dwordx4 v56, s[12:15], s54 offen lds
    s_add_u32 m0, s42, 17408
    s_nop 0
    buffer_load_dwordx4 v57, s[12:15], s54 offen lds
    s_add_u32 m0, s42, 24576
    s_nop 0
    buffer_load_dwordx4 v58, s[12:15], s54 offen lds
    s_add_u32 m0, s42, 25600
    s_nop 0
    buffer_load_dwordx4 v59, s[12:15], s54 offen lds
    s_add_u32 s54, s54, 458752
    s_waitcnt lgkmcnt(0)
    v_mfma_f32_16x16x32_bf16 v[88:91], a[128:131], v[64:67], v[88:91]
    v_mfma_f32_16x16x32_bf16 v[92:95], a[132:135], v[64:67], v[92:95]
    v_mfma_f32_16x16x32_bf16 v[88:91], a[136:139], v[64:67], v[88:91]
    v_mfma_f32_16x16x32_bf16 v[92:95], a[140:143], v[64:67], v[92:95]
    v_add_u32 v62, 49152, v60
    v_add_u32 v63, 49152, v61
    s_waitcnt vmcnt(16)
    s_barrier
    ds_read_b64_tr_b16 a[144:145], v62 offset:0
    ds_read_b64_tr_b16 a[146:147], v62 offset:512
    ds_read_b64_tr_b16 a[148:149], v63 offset:0
    ds_read_b64_tr_b16 a[150:151], v63 offset:512
    ds_read_b64_tr_b16 a[152:153], v62 offset:4096
    ds_read_b64_tr_b16 a[154:155], v62 offset:4608
    ds_read_b64_tr_b16 a[156:157], v63 offset:4096
    ds_read_b64_tr_b16 a[158:159], v63 offset:4608
    s_add_u32 m0, s42, 32768
    s_nop 0
    buffer_load_dwordx4 v56, s[12:15], s54 offen lds
    s_add_u32 m0, s42, 33792
    s_nop 0
    buffer_load_dwordx4 v57, s[12:15], s54 offen lds
    s_add_u32 m0, s42, 40960
    s_nop 0
    buffer_load_dwordx4 v58, s[12:15], s54 offen lds
    s_add_u32 m0, s42, 41984
    s_nop 0
    buffer_load_dwordx4 v59, s[12:15], s54 offen lds
    s_add_u32 s54, s54, 458752
    s_waitcnt lgkmcnt(0)
    v_mfma_f32_16x16x32_bf16 v[88:91], a[144:147], v[64:67], v[88:91]
    v_mfma_f32_16x16x32_bf16 v[92:95], a[148:151], v[64:67], v[92:95]
    v_mfma_f32_16x16x32_bf16 v[88:91], a[152:155], v[64:67], v[88:91]
    v_mfma_f32_16x16x32_bf16 v[92:95], a[156:159], v[64:67], v[92:95]
    v_add_u32 v62, 65536, v60
    v_add_u32 v63, 65536, v61
    s_waitcnt vmcnt(16)
    s_barrier
    ds_read_b64_tr_b16 a[160:161], v62 offset:0
    ds_read_b64_tr_b16 a[162:163], v62 offset:512
    ds_read_b64_tr_b16 a[164:165], v63 offset:0
    ds_read_b64_tr_b16 a[166:167], v63 offset:512
    ds_read_b64_tr_b16 a[168:169], v62 offset:4096
    ds_read_b64_tr_b16 a[170:171], v62 offset:4608
    ds_read_b64_tr_b16 a[172:173], v63 offset:4096
    ds_read_b64_tr_b16 a[174:175], v63 offset:4608
    s_add_u32 m0, s42, 49152
    s_nop 0
    buffer_load_dwordx4 v56, s[12:15], s54 offen lds
    s_add_u32 m0, s42, 50176
    s_nop 0
    buffer_load_dwordx4 v57, s[12:15], s54 offen lds
    s_add_u32 m0, s42, 57344
    s_nop 0
    buffer_load_dwordx4 v58, s[12:15], s54 offen lds
    s_add_u32 m0, s42, 58368
    s_nop 0
    buffer_load_dwordx4 v59, s[12:15], s54 offen lds
    s_add_u32 s54, s54, 458752
    s_waitcnt lgkmcnt(0)
    v_mfma_f32_16x16x32_bf16 v[88:91], a[160:163], v[64:67], v[88:91]
    v_mfma_f32_16x16x32_bf16 v[92:95], a[164:167], v[64:67], v[92:95]
    v_mfma_f32_16x16x32_bf16 v[88:91], a[168:171], v[64:67], v[88:91]
    v_mfma_f32_16x16x32_bf16 v[92:95], a[172:175], v[64:67], v[92:95]
    v_add_u32 v62, 81920, v60
    v_add_u32 v63, 81920, v61
    s_waitcnt vmcnt(16)
    s_barrier
    ds_read_b64_tr_b16 a[176:177], v62 offset:0
    ds_read_b64_tr_b16 a[178:179], v62 offset:512
    ds_read_b64_tr_b16 a[180:181], v63 offset:0
    ds_read_b64_tr_b16 a[182:183], v63 offset:512
    ds_read_b64_tr_b16 a[184:185], v62 offset:4096
    ds_read_b64_tr_b16 a[186:187], v62 offset:4608
    ds_read_b64_tr_b16 a[188:189], v63 offset:4096
    ds_read_b64_tr_b16 a[190:191], v63 offset:4608
    s_waitcnt lgkmcnt(0)
    v_mfma_f32_16x16x32_bf16 v[88:91], a[176:179], v[64:67], v[88:91]
    v_mfma_f32_16x16x32_bf16 v[92:95], a[180:183], v[64:67], v[92:95]
    v_mfma_f32_16x16x32_bf16 v[88:91], a[184:187], v[64:67], v[88:91]
    v_mfma_f32_16x16x32_bf16 v[92:95], a[188:191], v[64:67], v[92:95]
    v_add_u32 v62, 0, v60
    v_add_u32 v63, 0, v61
    s_waitcnt vmcnt(12)
    s_barrier
    ds_read_b64_tr_b16 a[192:193], v62 offset:0
    ds_read_b64_tr_b16 a[194:195], v62 offset:512
    ds_read_b64_tr_b16 a[196:197], v63 offset:0
    ds_read_b64_tr_b16 a[198:199], v63 offset:512
    ds_read_b64_tr_b16 a[200:201], v62 offset:4096
    ds_read_b64_tr_b16 a[202:203], v62 offset:4608
    ds_read_b64_tr_b16 a[204:205], v63 offset:4096
    ds_read_b64_tr_b16 a[206:207], v63 offset:4608
    s_waitcnt lgkmcnt(0)
    v_mfma_f32_16x16x32_bf16 v[88:91], a[192:195], v[64:67], v[88:91]
    v_mfma_f32_16x16x32_bf16 v[92:95], a[196:199], v[64:67], v[92:95]
    v_mfma_f32_16x16x32_bf16 v[88:91], a[200:203], v[64:67], v[88:91]
    v_mfma_f32_16x16x32_bf16 v[92:95], a[204:207], v[64:67], v[92:95]
    v_add_u32 v62, 16384, v60
    v_add_u32 v63, 16384, v61
    s_waitcnt vmcnt(8)
    s_barrier
    ds_read_b64_tr_b16 a[208:209], v62 offset:0
    ds_read_b64_tr_b16 a[210:211], v62 offset:512
    ds_read_b64_tr_b16 a[212:213], v63 offset:0
    ds_read_b64_tr_b16 a[214:215], v63 offset:512
    ds_read_b64_tr_b16 a[216:217], v62 offset:4096
    ds_read_b64_tr_b16 a[218:219], v62 offset:4608
    ds_read_b64_tr_b16 a[220:221], v63 offset:4096
    ds_read_b64_tr_b16 a[222:223], v63 offset:4608
    s_waitcnt lgkmcnt(0)
    v_mfma_f32_16x16x32_bf16 v[88:91], a[208:211], v[64:67], v[88:91]
    v_mfma_f32_16x16x32_bf16 v[92:95], a[212:215], v[64:67], v[92:95]
    v_mfma_f32_16x16x32_bf16 v[88:91], a[216:219], v[64:67], v[88:91]
    v_mfma_f32_16x16x32_bf16 v[92:95], a[220:223], v[64:67], v[92:95]
    v_add_u32 v62, 32768, v60
    v_add_u32 v63, 32768, v61
    s_waitcnt vmcnt(4)
    s_barrier
    ds_read_b64_tr_b16 a[224:225], v62 offset:0
    ds_read_b64_tr_b16 a[226:227], v62 offset:512
    ds_read_b64_tr_b16 a[228:229], v63 offset:0
    ds_read_b64_tr_b16 a[230:231], v63 offset:512
    ds_read_b64_tr_b16 a[232:233], v62 offset:4096
    ds_read_b64_tr_b16 a[234:235], v62 offset:4608
    ds_read_b64_tr_b16 a[236:237], v63 offset:4096
    ds_read_b64_tr_b16 a[238:239], v63 offset:4608
    s_waitcnt lgkmcnt(0)
    v_mfma_f32_16x16x32_bf16 v[88:91], a[224:227], v[64:67], v[88:91]
    v_mfma_f32_16x16x32_bf16 v[92:95], a[228:231], v[64:67], v[92:95]
    v_mfma_f32_16x16x32_bf16 v[88:91], a[232:235], v[64:67], v[88:91]
    v_mfma_f32_16x16x32_bf16 v[92:95], a[236:239], v[64:67], v[92:95]
    v_add_u32 v62, 49152, v60
    v_add_u32 v63, 49152, v61
    s_waitcnt vmcnt(0)
    s_barrier
    ds_read_b64_tr_b16 a[240:241], v62 offset:0
    ds_read_b64_tr_b16 a[242:243], v62 offset:512
    ds_read_b64_tr_b16 a[244:245], v63 offset:0
    ds_read_b64_tr_b16 a[246:247], v63 offset:512
    ds_read_b64_tr_b16 a[248:249], v62 offset:4096
    ds_read_b64_tr_b16 a[250:251], v62 offset:4608
    ds_read_b64_tr_b16 a[252:253], v63 offset:4096
    ds_read_b64_tr_b16 a[254:255], v63 offset:4608
    s_waitcnt lgkmcnt(0)
    v_mfma_f32_16x16x32_bf16 v[88:91], a[240:243], v[64:67], v[88:91]
    v_mfma_f32_16x16x32_bf16 v[92:95], a[244:247], v[64:67], v[92:95]
    v_mfma_f32_16x16x32_bf16 v[88:91], a[248:251], v[64:67], v[88:91]
    v_mfma_f32_16x16x32_bf16 v[92:95], a[252:255], v[64:67], v[92:95]
    s_barrier
    s_mov_b32 s37, 0xffff0000
    v_lshlrev_b32 v100, 16, v16
    v_and_b32 v101, s37, v16
    v_lshlrev_b32 v102, 16, v17
    v_and_b32 v103, s37, v17
    v_lshlrev_b32 v104, 16, v18
    v_and_b32 v105, s37, v18
    v_lshlrev_b32 v106, 16, v19
    v_and_b32 v107, s37, v19
    v_lshlrev_b32 v108, 16, v20
    v_and_b32 v109, s37, v20
    v_lshlrev_b32 v110, 16, v21
    v_and_b32 v111, s37, v21
    s_cmp_lg_u32 s32, 0
    s_cbranch_scc1 L_arv32
    s_add_u32 s20, s82, 0x80
    s_addc_u32 s21, s83, 0
    s_mov_b32 s22, 0x4
    s_mov_b32 s23, 0x00020000
    buffer_load_dword v56, v124, s[20:23], 0 offen sc1
    s_waitcnt vmcnt(0)
    v_cmp_eq_u32 vcc, v124, v56
    s_cbranch_vccnz L_spin33
L_back34:
L_arv32:
    s_add_u32 s96, s41, 2031616
    s_mov_b32 s98, s41
    s_mov_b32 s45, 0x5530000
    buffer_load_dword v7, v5, s[16:19], s45 offen sc1
    s_waitcnt vmcnt(0)
    v_cmp_ne_u32 vcc, 0, v7
    s_cbranch_vccnz L_spin35
L_back36:
    s_barrier
    s_add_u32 m0, s43, 0
    s_add_u32 s42, s41, 0
    buffer_load_dwordx4 v1, s[16:19], s42 offen offset:0 sc1 lds
    buffer_load_dwordx4 v1, s[16:19], s42 offen offset:1024 sc1 lds
    buffer_load_dwordx4 v1, s[16:19], s42 offen offset:2048 sc1 lds
    buffer_load_dwordx4 v1, s[16:19], s42 offen offset:3072 sc1 lds
    s_add_u32 m0, s43, 16384
    s_add_u32 s42, s41, 16384
    buffer_load_dwordx4 v1, s[16:19], s42 offen offset:0 sc1 lds
    buffer_load_dwordx4 v1, s[16:19], s42 offen offset:1024 sc1 lds
    buffer_load_dwordx4 v1, s[16:19], s42 offen offset:2048 sc1 lds
    buffer_load_dwordx4 v1, s[16:19], s42 offen offset:3072 sc1 lds
    s_add_u32 s45, s45, 65536
    s_waitcnt vmcnt(0) lgkmcnt(0)
    s_barrier
    ds_read_b128 v[56:59], v1 offset:0
    ds_read_b128 v[60:63], v1 offset:1024
    ds_read_b128 v[64:67], v1 offset:2048
    ds_read_b128 v[68:71], v1 offset:3072
    s_mov_b32 s36, 0
    s_waitcnt lgkmcnt(0)
    s_nop 7
L_l_b0:
    s_waitcnt lgkmcnt(2)
    v_mfma_f32_16x16x32_bf16 v[8:11], a[0:3], v[56:59], 0
    s_add_u32 m0, s52, 73728
    ds_read_b128 v[72:75], v1 offset:4096
    s_add_u32 s42, s46, s52
    v_mfma_f32_16x16x32_bf16 v[16:19], a[0:3], v[60:63], 0
    buffer_load_dwordx4 v1, s[16:19], s42 offen sc1 lds
    v_mfma_f32_16x16x32_bf16 v[20:23], a[4:7], v[60:63], 0
    s_add_u32 m0, s43, 32768
    ds_read_b128 v[76:79], v1 offset:5120
    s_add_u32 s42, s41, 32768
    v_mfma_f32_16x16x32_bf16 v[12:15], a[4:7], v[56:59], 0
    s_waitcnt lgkmcnt(2)
    buffer_load_dwordx4 v1, s[16:19], s42 offen offset:0 sc1 lds
    v_mfma_f32_16x16x32_bf16 v[8:11], a[8:11], v[64:67], v[8:11]
    s_and_b32 s44, s90, 0xffffffff
    ds_read_b128 v[80:83], v1 offset:6144
    s_cmp_lt_i32 s36, 1
    v_mfma_f32_16x16x32_bf16 v[16:19], a[8:11], v[68:71], v[16:19]
    buffer_load_dwordx4 v1, s[16:19], s42 offen offset:1024 sc1 lds
    v_mfma_f32_16x16x32_bf16 v[20:23], a[12:15], v[68:71], v[20:23]
    s_cselect_b32 s44, 0x5e00000, s44
    ds_read_b128 v[84:87], v1 offset:7168
    s_add_u32 s90, s90, 262144
    v_mfma_f32_16x16x32_bf16 v[12:15], a[12:15], v[64:67], v[12:15]
    s_waitcnt lgkmcnt(2)
    buffer_load_dwordx4 v1, s[16:19], s42 offen offset:2048 sc1 lds
    v_mfma_f32_16x16x32_bf16 v[8:11], a[16:19], v[72:75], v[8:11]
    ds_read_b128 v[56:59], v1 offset:8192
    v_add_f32 v32, v32, v128
    v_mfma_f32_16x16x32_bf16 v[16:19], a[16:19], v[76:79], v[16:19]
    buffer_load_dwordx4 v1, s[16:19], s42 offen offset:3072 sc1 lds
    v_mfma_f32_16x16x32_bf16 v[20:23], a[20:23], v[76:79], v[20:23]
    s_add_u32 m0, s43, 49152
    ds_read_b128 v[60:63], v1 offset:9216
    v_add_f32 v33, v33, v129
    v_mfma_f32_16x16x32_bf16 v[12:15], a[20:23], v[72:75], v[12:15]
    s_waitcnt lgkmcnt(2)
    v_mul_f32 v120, v32, v116
    v_mul_f32 v121, v33, v116
    v_mfma_f32_16x16x32_bf16 v[8:11], a[24:27], v[80:83], v[8:11]
    s_add_u32 s42, s41, 49152
    ds_read_b128 v[64:67], v1 offset:10240
    buffer_load_dwordx4 v1, s[16:19], s42 offen offset:0 sc1 lds
    v_mfma_f32_16x16x32_bf16 v[16:19], a[24:27], v[84:87], v[16:19]
    v_mul_f32 v120, v120, abs(v32)
    v_mul_f32 v121, v121, abs(v33)
    v_mfma_f32_16x16x32_bf16 v[20:23], a[28:31], v[84:87], v[20:23]
    ds_read_b128 v[68:71], v1 offset:11264
    buffer_load_dwordx4 v1, s[16:19], s42 offen offset:1024 sc1 lds
    v_mfma_f32_16x16x32_bf16 v[12:15], a[28:31], v[80:83], v[12:15]
    s_waitcnt lgkmcnt(2)
    v_cvt_pk_bf16_f32 v32, v120, v121
    v_pk_max_i16 v32, v32, 0
    v_mfma_f32_16x16x32_bf16 v[8:11], a[32:35], v[56:59], v[8:11]
    ds_read_b128 v[72:75], v1 offset:12288
    buffer_load_dwordx4 v1, s[16:19], s42 offen offset:2048 sc1 lds
    v_mfma_f32_16x16x32_bf16 v[16:19], a[32:35], v[60:63], v[16:19]
    v_add_f32 v34, v34, v130
    v_add_f32 v35, v35, v131
    v_mfma_f32_16x16x32_bf16 v[20:23], a[36:39], v[60:63], v[20:23]
    ds_read_b128 v[76:79], v1 offset:13312
    buffer_load_dwordx4 v1, s[16:19], s42 offen offset:3072 sc1 lds
    v_mfma_f32_16x16x32_bf16 v[12:15], a[36:39], v[56:59], v[12:15]
    s_waitcnt lgkmcnt(2)
    v_mul_f32 v120, v34, v116
    v_mul_f32 v121, v35, v116
    v_mfma_f32_16x16x32_bf16 v[8:11], a[40:43], v[64:67], v[8:11]
    s_add_u32 s98, s98, 65536
    ds_read_b128 v[80:83], v1 offset:14336
    v_mul_f32 v120, v120, abs(v34)
    v_mfma_f32_16x16x32_bf16 v[16:19], a[40:43], v[68:71], v[16:19]
    s_min_i32 s98, s98, s96
    v_mul_f32 v121, v121, abs(v35)
    v_cvt_pk_bf16_f32 v33, v120, v121
    v_mfma_f32_16x16x32_bf16 v[20:23], a[44:47], v[68:71], v[20:23]
    s_and_b32 s41, s98, 0xffffffff
    ds_read_b128 v[84:87], v1 offset:15360
    v_pk_max_i16 v33, v33, 0
    v_mfma_f32_16x16x32_bf16 v[12:15], a[44:47], v[64:67], v[12:15]
    s_waitcnt vmcnt(9) lgkmcnt(2)
    s_barrier
    v_add_f32 v36, v36, v132
    v_mfma_f32_16x16x32_bf16 v[8:11], a[48:51], v[72:75], v[8:11]
    ds_read_b128 v[56:59], v1 offset:16384
    v_add_f32 v37, v37, v133
    v_mfma_f32_16x16x32_bf16 v[16:19], a[48:51], v[76:79], v[16:19]
    v_mul_f32 v120, v36, v116
    v_mul_f32 v121, v37, v116
    v_mfma_f32_16x16x32_bf16 v[20:23], a[52:55], v[76:79], v[20:23]
    ds_read_b128 v[60:63], v1 offset:17408
    v_mul_f32 v120, v120, abs(v36)
    v_mfma_f32_16x16x32_bf16 v[12:15], a[52:55], v[72:75], v[12:15]
    s_waitcnt lgkmcnt(2)
    v_mul_f32 v121, v121, abs(v37)
    v_cvt_pk_bf16_f32 v34, v120, v121
    v_mfma_f32_16x16x32_bf16 v[8:11], a[56:59], v[80:83], v[8:11]
    ds_read_b128 v[64:67], v1 offset:18432
    v_pk_max_i16 v34, v34, 0
    v_mfma_f32_16x16x32_bf16 v[16:19], a[56:59], v[84:87], v[16:19]
    v_add_f32 v38, v38, v134
    v_add_f32 v39, v39, v135
    v_mfma_f32_16x16x32_bf16 v[20:23], a[60:63], v[84:87], v[20:23]
    ds_read_b128 v[68:71], v1 offset:19456
    v_mul_f32 v120, v38, v116
    v_mfma_f32_16x16x32_bf16 v[12:15], a[60:63], v[80:83], v[12:15]
    s_waitcnt lgkmcnt(2)
    v_mul_f32 v121, v39, v116
    v_mul_f32 v120, v120, abs(v38)
    v_mfma_f32_16x16x32_bf16 v[8:11], a[64:67], v[56:59], v[8:11]
    ds_read_b128 v[72:75], v1 offset:20480
    v_mul_f32 v121, v121, abs(v39)
    v_mfma_f32_16x16x32_bf16 v[16:19], a[64:67], v[60:63], v[16:19]
    v_cvt_pk_bf16_f32 v35, v120, v121
    v_pk_max_i16 v35, v35, 0
    v_mfma_f32_16x16x32_bf16 v[20:23], a[68:71], v[60:63], v[20:23]
    ds_read_b128 v[76:79], v1 offset:21504
    buffer_store_dwordx4 v[32:35], v1, s[16:19], s44 offen offset:0 sc1
    v_mfma_f32_16x16x32_bf16 v[12:15], a[68:71], v[56:59], v[12:15]
    s_waitcnt lgkmcnt(2)
    v_add_f32 v40, v40, v136
    v_add_f32 v41, v41, v137
    v_mfma_f32_16x16x32_bf16 v[8:11], a[72:75], v[64:67], v[8:11]
    ds_read_b128 v[80:83], v1 offset:22528
    v_mul_f32 v120, v40, v117
    v_mfma_f32_16x16x32_bf16 v[16:19], a[72:75], v[68:71], v[16:19]
    v_mul_f32 v121, v41, v117
    v_mul_f32 v120, v120, abs(v40)
    v_mfma_f32_16x16x32_bf16 v[20:23], a[76:79], v[68:71], v[20:23]
    ds_read_b128 v[84:87], v1 offset:23552
    v_mul_f32 v121, v121, abs(v41)
    v_mfma_f32_16x16x32_bf16 v[12:15], a[76:79], v[64:67], v[12:15]
    s_waitcnt lgkmcnt(2)
    v_cvt_pk_bf16_f32 v40, v120, v121
    v_pk_max_i16 v40, v40, 0
    v_mfma_f32_16x16x32_bf16 v[8:11], a[80:83], v[72:75], v[8:11]
    ds_read_b128 v[56:59], v1 offset:24576
    v_add_f32 v42, v42, v138
    v_mfma_f32_16x16x32_bf16 v[16:19], a[80:83], v[76:79], v[16:19]
    v_add_f32 v43, v43, v139
    v_mul_f32 v120, v42, v117
    v_mfma_f32_16x16x32_bf16 v[20:23], a[84:87], v[76:79], v[20:23]
    ds_read_b128 v[60:63], v1 offset:25600
    v_mul_f32 v121, v43, v117
    v_mfma_f32_16x16x32_bf16 v[12:15], a[84:87], v[72:75], v[12:15]
    s_waitcnt lgkmcnt(2)
    v_mul_f32 v120, v120, abs(v42)
    v_mul_f32 v121, v121, abs(v43)
    v_mfma_f32_16x16x32_bf16 v[8:11], a[88:91], v[80:83], v[8:11]
    ds_read_b128 v[64:67], v1 offset:26624
    v_cvt_pk_bf16_f32 v41, v120, v121
    v_mfma_f32_16x16x32_bf16 v[16:19], a[88:91], v[84:87], v[16:19]
    v_pk_max_i16 v41, v41, 0
    v_add_f32 v44, v44, v140
    v_mfma_f32_16x16x32_bf16 v[20:23], a[92:95], v[84:87], v[20:23]
    ds_read_b128 v[68:71], v1 offset:27648
    v_add_f32 v45, v45, v141
    v_mfma_f32_16x16x32_bf16 v[12:15], a[92:95], v[80:83], v[12:15]
    s_waitcnt lgkmcnt(2)
    v_mul_f32 v120, v44, v117
    v_mul_f32 v121, v45, v117
    v_mfma_f32_16x16x32_bf16 v[8:11], a[96:99], v[56:59], v[8:11]
    ds_read_b128 v[72:75], v1 offset:28672
    v_mul_f32 v120, v120, abs(v44)
    v_mfma_f32_16x16x32_bf16 v[16:19], a[96:99], v[60:63], v[16:19]
    v_mul_f32 v121, v121, abs(v45)
    v_cvt_pk_bf16_f32 v42, v120, v121
    v_mfma_f32_16x16x32_bf16 v[20:23], a[100:103], v[60:63], v[20:23]
    ds_read_b128 v[76:79], v1 offset:29696
    buffer_load_dword v7, v5, s[16:19], s45 offen sc1
    v_mfma_f32_16x16x32_bf16 v[12:15], a[100:103], v[56:59], v[12:15]
    s_waitcnt lgkmcnt(2)
    v_pk_max_i16 v42, v42, 0
    v_add_f32 v46, v46, v142
    v_mfma_f32_16x16x32_bf16 v[8:11], a[104:107], v[64:67], v[8:11]
    ds_read_b128 v[80:83], v1 offset:30720
    v_add_f32 v47, v47, v143
    v_mfma_f32_16x16x32_bf16 v[16:19], a[104:107], v[68:71], v[16:19]
    v_mul_f32 v120, v46, v117
    v_mul_f32 v121, v47, v117
    v_mfma_f32_16x16x32_bf16 v[20:23], a[108:111], v[68:71], v[20:23]
    ds_read_b128 v[84:87], v1 offset:31744
    v_mul_f32 v120, v120, abs(v46)
    v_mfma_f32_16x16x32_bf16 v[12:15], a[108:111], v[64:67], v[12:15]
    s_waitcnt vmcnt(6) lgkmcnt(2)
    s_barrier
    v_mul_f32 v121, v121, abs(v47)
    v_mfma_f32_16x16x32_bf16 v[8:11], a[112:115], v[72:75], v[8:11]
    ds_read_b128 v[56:59], v1 offset:32768
    v_cvt_pk_bf16_f32 v43, v120, v121
    v_mfma_f32_16x16x32_bf16 v[16:19], a[112:115], v[76:79], v[16:19]
    v_pk_max_i16 v43, v43, 0
    buffer_store_dwordx4 v[40:43], v1, s[16:19], s44 offen offset:1024 sc1
    v_mfma_f32_16x16x32_bf16 v[20:23], a[116:119], v[76:79], v[20:23]
    s_add_u32 m0, s43, 98304
    ds_read_b128 v[60:63], v1 offset:33792
    ds_read_b64 v[144:145], v118 offset:0
    v_mfma_f32_16x16x32_bf16 v[12:15], a[116:119], v[72:75], v[12:15]
    s_waitcnt lgkmcnt(3)
    ds_read_b64 v[146:147], v118 offset:128
    ds_read_b64 v[148:149], v118 offset:256
    v_mfma_f32_16x16x32_bf16 v[8:11], a[120:123], v[80:83], v[8:11]
    s_add_u32 s42, s41, 0
    ds_read_b128 v[64:67], v1 offset:34816
    ds_read_b64 v[150:151], v118 offset:384
    v_mfma_f32_16x16x32_bf16 v[16:19], a[120:123], v[84:87], v[16:19]
    v_mfma_f32_16x16x32_bf16 v[20:23], a[124:127], v[84:87], v[20:23]
    ds_read_b128 v[68:71], v1 offset:35840
    v_mfma_f32_16x16x32_bf16 v[12:15], a[124:127], v[80:83], v[12:15]
    s_waitcnt lgkmcnt(6)
    v_mfma_f32_16x16x32_bf16 v[8:11], a[128:131], v[56:59], v[8:11]
    ds_read_b128 v[72:75], v1 offset:36864
    v_mfma_f32_16x16x32_bf16 v[16:19], a[128:131], v[60:63], v[16:19]
    s_waitcnt lgkmcnt(2)
    v_max3_u32 v152, v144, v145, v146
    v_max3_u32 v153, v147, v148, v149
    v_mfma_f32_16x16x32_bf16 v[20:23], a[132:135], v[60:63], v[20:23]
    ds_read_b128 v[76:79], v1 offset:37888
    v_max3_u32 v152, v152, v150, v151
    v_mfma_f32_16x16x32_bf16 v[12:15], a[132:135], v[56:59], v[12:15]
    s_waitcnt lgkmcnt(2)
    v_max_u32 v152, v152, v153
    v_cmp_eq_u32 vcc, -1, v152
    v_mfma_f32_16x16x32_bf16 v[8:11], a[136:139], v[64:67], v[8:11]
    ds_read_b128 v[80:83], v1 offset:38912
    v_mfma_f32_16x16x32_bf16 v[16:19], a[136:139], v[68:71], v[16:19]
    s_cbranch_vccnz L_sspin39
L_sback40:
    v_add_f32 v152, v148, v150
    v_add_f32 v153, v149, v151
    v_mfma_f32_16x16x32_bf16 v[20:23], a[140:143], v[68:71], v[20:23]
    ds_read_b128 v[84:87], v1 offset:39936
    v_add_f32 v144, v144, v146
    v_mfma_f32_16x16x32_bf16 v[12:15], a[140:143], v[64:67], v[12:15]
    s_waitcnt lgkmcnt(2)
    v_add_f32 v145, v145, v147
    v_add_f32 v144, v144, v152
    v_mfma_f32_16x16x32_bf16 v[8:11], a[144:147], v[72:75], v[8:11]
    ds_read_b128 v[56:59], v1 offset:40960
    v_add_f32 v145, v145, v153
    v_mfma_f32_16x16x32_bf16 v[16:19], a[144:147], v[76:79], v[16:19]
    v_mov_b32 v152, v144
    v_mov_b32 v153, v145
    v_mfma_f32_16x16x32_bf16 v[20:23], a[148:151], v[76:79], v[20:23]
    ds_read_b128 v[60:63], v1 offset:41984
    v_permlane32_swap_b32 v144, v152
    v_mfma_f32_16x16x32_bf16 v[12:15], a[148:151], v[72:75], v[12:15]
    s_waitcnt lgkmcnt(2)
    v_permlane32_swap_b32 v145, v153
    v_mfma_f32_16x16x32_bf16 v[8:11], a[152:155], v[80:83], v[8:11]
    ds_read_b128 v[64:67], v1 offset:43008
    v_add_f32 v144, v144, v152
    v_mfma_f32_16x16x32_bf16 v[16:19], a[152:155], v[84:87], v[16:19]
    v_add_f32 v145, v145, v153
    v_mul_f32 v112, 0xba800000, v144
    v_mfma_f32_16x16x32_bf16 v[20:23], a[156:159], v[84:87], v[20:23]
    ds_read_b128 v[68:71], v1 offset:44032
    v_mul_f32 v145, 0x3a800000, v145
    v_mfma_f32_16x16x32_bf16 v[12:15], a[156:159], v[80:83], v[12:15]
    s_waitcnt lgkmcnt(2)
    v_fma_f32 v145, -v112, v112, v145
    v_mov_b32 v113, v112
    v_mfma_f32_16x16x32_bf16 v[8:11], a[160:163], v[56:59], v[8:11]
    ds_read_b128 v[72:75], v1 offset:45056
    v_max_f32 v145, 0, v145
    v_mfma_f32_16x16x32_bf16 v[16:19], a[160:163], v[60:63], v[16:19]
    v_add_f32 v145, 0x3727c5ac, v145
    v_rsq_f32 v116, v145
    v_mfma_f32_16x16x32_bf16 v[20:23], a[164:167], v[60:63], v[20:23]
    ds_read_b128 v[76:79], v1 offset:46080
    v_permlane16_swap_b32 v112, v113
    v_mfma_f32_16x16x32_bf16 v[12:15], a[164:167], v[56:59], v[12:15]
    s_waitcnt lgkmcnt(2)
    v_mul_f32 v114, v145, v116
    v_mul_f32 v116, v116, v116
    v_mfma_f32_16x16x32_bf16 v[8:11], a[168:171], v[64:67], v[8:11]
    s_waitcnt vmcnt(0)
    ds_read_b128 v[80:83], v1 offset:47104
    v_mov_b32 v115, v114
    v_mfma_f32_16x16x32_bf16 v[16:19], a[168:171], v[68:71], v[16:19]
    s_barrier
    buffer_store_dword v124, v124, s[16:19], s91 offen sc1
    v_mfma_f32_16x16x32_bf16 v[20:23], a[172:175], v[68:71], v[20:23]
    s_add_u32 s91, s91, 65536
    ds_read_b128 v[84:87], v1 offset:48128
    v_cmp_ne_u32 vcc, 0, v7
    v_mfma_f32_16x16x32_bf16 v[12:15], a[172:175], v[64:67], v[12:15]
    s_waitcnt lgkmcnt(2)
    v_mov_b32 v117, v116
    v_permlane16_swap_b32 v114, v115
    v_mfma_f32_16x16x32_bf16 v[8:11], a[176:179], v[72:75], v[8:11]
    s_cbranch_vccnz L_spin37
L_back38:
    ds_read_b128 v[56:59], v1 offset:49152
    v_permlane16_swap_b32 v116, v117
    v_mfma_f32_16x16x32_bf16 v[16:19], a[176:179], v[76:79], v[16:19]
    s_barrier
    buffer_load_dwordx4 v1, s[16:19], s42 offen offset:0 sc1 lds
    v_mfma_f32_16x16x32_bf16 v[20:23], a[180:183], v[76:79], v[20:23]
    s_add_u32 s46, s46, 2048
    ds_read_b128 v[60:63], v1 offset:50176
    buffer_load_dwordx4 v1, s[16:19], s42 offen offset:1024 sc1 lds
    v_mfma_f32_16x16x32_bf16 v[12:15], a[180:183], v[72:75], v[12:15]
    s_waitcnt lgkmcnt(2)
    buffer_load_dwordx4 v1, s[16:19], s42 offen offset:2048 sc1 lds
    v_mfma_f32_16x16x32_bf16 v[8:11], a[184:187], v[80:83], v[8:11]
    ds_read_b128 v[64:67], v1 offset:51200
    buffer_load_dwordx4 v1, s[16:19], s42 offen offset:3072 sc1 lds
    v_mfma_f32_16x16x32_bf16 v[16:19], a[184:187], v[84:87], v[16:19]
    s_add_u32 m0, s43, 114688
    v_mul_f32 v128, v112, v88
    v_fmac_f32 v128, v114, v100
    v_mfma_f32_16x16x32_bf16 v[20:23], a[188:191], v[84:87], v[20:23]
    s_add_u32 s42, s41, 16384
    ds_read_b128 v[68:71], v1 offset:52224
    v_mul_f32 v129, v112, v89
    v_mfma_f32_16x16x32_bf16 v[12:15], a[188:191], v[80:83], v[12:15]
    s_waitcnt lgkmcnt(2)
    v_fmac_f32 v129, v114, v101
    v_mul_f32 v130, v112, v90
    v_mfma_f32_16x16x32_bf16 v[8:11], a[192:195], v[56:59], v[8:11]
    ds_read_b128 v[72:75], v1 offset:53248
    buffer_load_dwordx4 v1, s[16:19], s42 offen offset:0 sc1 lds
    v_mfma_f32_16x16x32_bf16 v[16:19], a[192:195], v[60:63], v[16:19]
    v_fmac_f32 v130, v114, v102
    v_mul_f32 v131, v112, v91
    v_mfma_f32_16x16x32_bf16 v[20:23], a[196:199], v[60:63], v[20:23]
    ds_read_b128 v[76:79], v1 offset:54272
    v_fmac_f32 v131, v114, v103
    v_mfma_f32_16x16x32_bf16 v[12:15], a[196:199], v[56:59], v[12:15]
    s_waitcnt lgkmcnt(2)
    v_mul_f32 v132, v112, v92
    v_fmac_f32 v132, v114, v104
    v_mfma_f32_16x16x32_bf16 v[8:11], a[200:203], v[64:67], v[8:11]
    ds_read_b128 v[80:83], v1 offset:55296
    buffer_load_dwordx4 v1, s[16:19], s42 offen offset:1024 sc1 lds
    v_mfma_f32_16x16x32_bf16 v[16:19], a[200:203], v[68:71], v[16:19]
    v_mul_f32 v133, v112, v93
    v_fmac_f32 v133, v114, v105
    v_mfma_f32_16x16x32_bf16 v[20:23], a[204:207], v[68:71], v[20:23]
    ds_read_b128 v[84:87], v1 offset:56320
    v_mul_f32 v134, v112, v94
    v_mfma_f32_16x16x32_bf16 v[12:15], a[204:207], v[64:67], v[12:15]
    s_waitcnt lgkmcnt(2)
    v_fmac_f32 v134, v114, v106
    v_mul_f32 v135, v112, v95
    v_mfma_f32_16x16x32_bf16 v[8:11], a[208:211], v[72:75], v[8:11]
    ds_read_b128 v[56:59], v1 offset:57344
    buffer_load_dwordx4 v1, s[16:19], s42 offen offset:2048 sc1 lds
    v_mfma_f32_16x16x32_bf16 v[16:19], a[208:211], v[76:79], v[16:19]
    v_fmac_f32 v135, v114, v107
    v_mul_f32 v136, v113, v88
    v_mfma_f32_16x16x32_bf16 v[20:23], a[212:215], v[76:79], v[20:23]
    ds_read_b128 v[60:63], v1 offset:58368
    v_fmac_f32 v136, v115, v100
    v_mfma_f32_16x16x32_bf16 v[12:15], a[212:215], v[72:75], v[12:15]
    s_waitcnt lgkmcnt(2)
    v_mul_f32 v137, v113, v89
    v_fmac_f32 v137, v115, v101
    v_mfma_f32_16x16x32_bf16 v[8:11], a[216:219], v[80:83], v[8:11]
    ds_read_b128 v[64:67], v1 offset:59392
    buffer_load_dwordx4 v1, s[16:19], s42 offen offset:3072 sc1 lds
    v_mfma_f32_16x16x32_bf16 v[16:19], a[216:219], v[84:87], v[16:19]
    s_add_u32 s45, s45, 65536
    v_mul_f32 v138, v113, v90
    v_fmac_f32 v138, v115, v102
    v_mfma_f32_16x16x32_bf16 v[20:23], a[220:223], v[84:87], v[20:23]
    ds_read_b128 v[68:71], v1 offset:60416
    v_mul_f32 v139, v113, v91
    v_mfma_f32_16x16x32_bf16 v[12:15], a[220:223], v[80:83], v[12:15]
    s_waitcnt lgkmcnt(2)
    v_fmac_f32 v139, v115, v103
    v_mul_f32 v140, v113, v92
    v_mfma_f32_16x16x32_bf16 v[8:11], a[224:227], v[56:59], v[8:11]
    ds_read_b128 v[72:75], v1 offset:61440
    v_fmac_f32 v140, v115, v104
    v_mfma_f32_16x16x32_bf16 v[16:19], a[224:227], v[60:63], v[16:19]
    v_mul_f32 v141, v113, v93
    v_fmac_f32 v141, v115, v105
    v_mfma_f32_16x16x32_bf16 v[20:23], a[228:231], v[60:63], v[20:23]
    ds_read_b128 v[76:79], v1 offset:62464
    v_mul_f32 v142, v113, v94
    v_mfma_f32_16x16x32_bf16 v[12:15], a[228:231], v[56:59], v[12:15]
    s_waitcnt lgkmcnt(2)
    v_fmac_f32 v142, v115, v106
    v_mul_f32 v143, v113, v95
    v_mfma_f32_16x16x32_bf16 v[8:11], a[232:235], v[64:67], v[8:11]
    ds_read_b128 v[80:83], v1 offset:63488
    v_fmac_f32 v143, v115, v107
    v_mfma_f32_16x16x32_bf16 v[16:19], a[232:235], v[68:71], v[16:19]
    v_mfma_f32_16x16x32_bf16 v[20:23], a[236:239], v[68:71], v[20:23]
    ds_read_b128 v[84:87], v1 offset:64512
    v_mfma_f32_16x16x32_bf16 v[12:15], a[236:239], v[64:67], v[12:15]
    s_waitcnt vmcnt(4) lgkmcnt(2)
    s_barrier
    v_mfma_f32_16x16x32_bf16 v[8:11], a[240:243], v[72:75], v[8:11]
    ds_read_b128 v[56:59], v2 offset:0
    v_mfma_f32_16x16x32_bf16 v[16:19], a[240:243], v[76:79], v[16:19]
    v_mfma_f32_16x16x32_bf16 v[20:23], a[244:247], v[76:79], v[20:23]
    ds_read_b128 v[60:63], v2 offset:1024
    v_mfma_f32_16x16x32_bf16 v[12:15], a[244:247], v[72:75], v[12:15]
    s_waitcnt lgkmcnt(2)
    v_mfma_f32_16x16x32_bf16 v[8:11], a[248:251], v[80:83], v[8:11]
    ds_read_b128 v[64:67], v2 offset:2048
    v_mfma_f32_16x16x32_bf16 v[16:19], a[248:251], v[84:87], v[16:19]
    v_mfma_f32_16x16x32_bf16 v[20:23], a[252:255], v[84:87], v[20:23]
    ds_read_b128 v[68:71], v2 offset:3072
    v_mfma_f32_16x16x32_bf16 v[12:15], a[252:255], v[80:83], v[12:15]
    s_add_u32 s36, s36, 1
L_l_b1:
    s_waitcnt lgkmcnt(2)
    v_mfma_f32_16x16x32_bf16 v[32:35], a[0:3], v[56:59], 0
    s_add_u32 m0, s52, 73728
    ds_read_b128 v[72:75], v2 offset:4096
    s_add_u32 s42, s46, s52
    v_mfma_f32_16x16x32_bf16 v[40:43], a[0:3], v[60:63], 0
    buffer_load_dwordx4 v1, s[16:19], s42 offen sc1 lds
    v_mfma_f32_16x16x32_bf16 v[44:47], a[4:7], v[60:63], 0
    s_add_u32 m0, s43, 131072
    ds_read_b128 v[76:79], v2 offset:5120
    s_add_u32 s42, s41, 32768
    v_mfma_f32_16x16x32_bf16 v[36:39], a[4:7], v[56:59], 0
    s_waitcnt lgkmcnt(2)
    buffer_load_dwordx4 v1, s[16:19], s42 offen offset:0 sc1 lds
    v_mfma_f32_16x16x32_bf16 v[32:35], a[8:11], v[64:67], v[32:35]
    s_and_b32 s44, s90, 0xffffffff
    ds_read_b128 v[80:83], v2 offset:6144
    s_cmp_lt_i32 s36, 1
    v_mfma_f32_16x16x32_bf16 v[40:43], a[8:11], v[68:71], v[40:43]
    buffer_load_dwordx4 v1, s[16:19], s42 offen offset:1024 sc1 lds
    v_mfma_f32_16x16x32_bf16 v[44:47], a[12:15], v[68:71], v[44:47]
    s_cselect_b32 s44, 0x5e00000, s44
    ds_read_b128 v[84:87], v2 offset:7168
    s_add_u32 s90, s90, 262144
    v_mfma_f32_16x16x32_bf16 v[36:39], a[12:15], v[64:67], v[36:39]
    s_waitcnt lgkmcnt(2)
    buffer_load_dwordx4 v1, s[16:19], s42 offen offset:2048 sc1 lds
    v_mfma_f32_16x16x32_bf16 v[32:35], a[16:19], v[72:75], v[32:35]
    ds_read_b128 v[56:59], v2 offset:8192
    v_add_f32 v8, v8, v128
    v_mfma_f32_16x16x32_bf16 v[40:43], a[16:19], v[76:79], v[40:43]
    buffer_load_dwordx4 v1, s[16:19], s42 offen offset:3072 sc1 lds
    v_mfma_f32_16x16x32_bf16 v[44:47], a[20:23], v[76:79], v[44:47]
    s_add_u32 m0, s43, 147456
    ds_read_b128 v[60:63], v2 offset:9216
    v_add_f32 v9, v9, v129
    v_mfma_f32_16x16x32_bf16 v[36:39], a[20:23], v[72:75], v[36:39]
    s_waitcnt lgkmcnt(2)
    v_mul_f32 v120, v8, v116
    v_mul_f32 v121, v9, v116
    v_mfma_f32_16x16x32_bf16 v[32:35], a[24:27], v[80:83], v[32:35]
    s_add_u32 s42, s41, 49152
    ds_read_b128 v[64:67], v2 offset:10240
    buffer_load_dwordx4 v1, s[16:19], s42 offen offset:0 sc1 lds
    v_mfma_f32_16x16x32_bf16 v[40:43], a[24:27], v[84:87], v[40:43]
    v_mul_f32 v120, v120, abs(v8)
    v_mul_f32 v121, v121, abs(v9)
    v_mfma_f32_16x16x32_bf16 v[44:47], a[28:31], v[84:87], v[44:47]
    ds_read_b128 v[68:71], v2 offset:11264
    buffer_load_dwordx4 v1, s[16:19], s42 offen offset:1024 sc1 lds
    v_mfma_f32_16x16x32_bf16 v[36:39], a[28:31], v[80:83], v[36:39]
    s_waitcnt lgkmcnt(2)
    v_cvt_pk_bf16_f32 v8, v120, v121
    v_pk_max_i16 v8, v8, 0
    v_mfma_f32_16x16x32_bf16 v[32:35], a[32:35], v[56:59], v[32:35]
    ds_read_b128 v[72:75], v2 offset:12288
    buffer_load_dwordx4 v1, s[16:19], s42 offen offset:2048 sc1 lds
    v_mfma_f32_16x16x32_bf16 v[40:43], a[32:35], v[60:63], v[40:43]
    v_add_f32 v10, v10, v130
    v_add_f32 v11, v11, v131
    v_mfma_f32_16x16x32_bf16 v[44:47], a[36:39], v[60:63], v[44:47]
    ds_read_b128 v[76:79], v2 offset:13312
    buffer_load_dwordx4 v1, s[16:19], s42 offen offset:3072 sc1 lds
    v_mfma_f32_16x16x32_bf16 v[36:39], a[36:39], v[56:59], v[36:39]
    s_waitcnt lgkmcnt(2)
    v_mul_f32 v120, v10, v116
    v_mul_f32 v121, v11, v116
    v_mfma_f32_16x16x32_bf16 v[32:35], a[40:43], v[64:67], v[32:35]
    s_add_u32 s98, s98, 65536
    ds_read_b128 v[80:83], v2 offset:14336
    v_mul_f32 v120, v120, abs(v10)
    v_mfma_f32_16x16x32_bf16 v[40:43], a[40:43], v[68:71], v[40:43]
    s_min_i32 s98, s98, s96
    v_mul_f32 v121, v121, abs(v11)
    v_cvt_pk_bf16_f32 v9, v120, v121
    v_mfma_f32_16x16x32_bf16 v[44:47], a[44:47], v[68:71], v[44:47]
    s_and_b32 s41, s98, 0xffffffff
    ds_read_b128 v[84:87], v2 offset:15360
    v_pk_max_i16 v9, v9, 0
    v_mfma_f32_16x16x32_bf16 v[36:39], a[44:47], v[64:67], v[36:39]
    s_waitcnt vmcnt(9) lgkmcnt(2)
    s_barrier
    v_add_f32 v12, v12, v132
    v_mfma_f32_16x16x32_bf16 v[32:35], a[48:51], v[72:75], v[32:35]
    ds_read_b128 v[56:59], v2 offset:16384
    v_add_f32 v13, v13, v133
    v_mfma_f32_16x16x32_bf16 v[40:43], a[48:51], v[76:79], v[40:43]
    v_mul_f32 v120, v12, v116
    v_mul_f32 v121, v13, v116
    v_mfma_f32_16x16x32_bf16 v[44:47], a[52:55], v[76:79], v[44:47]
    ds_read_b128 v[60:63], v2 offset:17408
    v_mul_f32 v120, v120, abs(v12)
    v_mfma_f32_16x16x32_bf16 v[36:39], a[52:55], v[72:75], v[36:39]
    s_waitcnt lgkmcnt(2)
    v_mul_f32 v121, v121, abs(v13)
    v_cvt_pk_bf16_f32 v10, v120, v121
    v_mfma_f32_16x16x32_bf16 v[32:35], a[56:59], v[80:83], v[32:35]
    ds_read_b128 v[64:67], v2 offset:18432
    v_pk_max_i16 v10, v10, 0
    v_mfma_f32_16x16x32_bf16 v[40:43], a[56:59], v[84:87], v[40:43]
    v_add_f32 v14, v14, v134
    v_add_f32 v15, v15, v135
    v_mfma_f32_16x16x32_bf16 v[44:47], a[60:63], v[84:87], v[44:47]
    ds_read_b128 v[68:71], v2 offset:19456
    v_mul_f32 v120, v14, v116
    v_mfma_f32_16x16x32_bf16 v[36:39], a[60:63], v[80:83], v[36:39]
    s_waitcnt lgkmcnt(2)
    v_mul_f32 v121, v15, v116
    v_mul_f32 v120, v120, abs(v14)
    v_mfma_f32_16x16x32_bf16 v[32:35], a[64:67], v[56:59], v[32:35]
    ds_read_b128 v[72:75], v2 offset:20480
    v_mul_f32 v121, v121, abs(v15)
    v_mfma_f32_16x16x32_bf16 v[40:43], a[64:67], v[60:63], v[40:43]
    v_cvt_pk_bf16_f32 v11, v120, v121
    v_pk_max_i16 v11, v11, 0
    v_mfma_f32_16x16x32_bf16 v[44:47], a[68:71], v[60:63], v[44:47]
    ds_read_b128 v[76:79], v2 offset:21504
    buffer_store_dwordx4 v[8:11], v1, s[16:19], s44 offen offset:0 sc1
    v_mfma_f32_16x16x32_bf16 v[36:39], a[68:71], v[56:59], v[36:39]
    s_waitcnt lgkmcnt(2)
    v_add_f32 v16, v16, v136
    v_add_f32 v17, v17, v137
    v_mfma_f32_16x16x32_bf16 v[32:35], a[72:75], v[64:67], v[32:35]
    ds_read_b128 v[80:83], v2 offset:22528
    v_mul_f32 v120, v16, v117
    v_mfma_f32_16x16x32_bf16 v[40:43], a[72:75], v[68:71], v[40:43]
    v_mul_f32 v121, v17, v117
    v_mul_f32 v120, v120, abs(v16)
    v_mfma_f32_16x16x32_bf16 v[44:47], a[76:79], v[68:71], v[44:47]
    ds_read_b128 v[84:87], v2 offset:23552
    v_mul_f32 v121, v121, abs(v17)
    v_mfma_f32_16x16x32_bf16 v[36:39], a[76:79], v[64:67], v[36:39]
    s_waitcnt lgkmcnt(2)
    v_cvt_pk_bf16_f32 v16, v120, v121
    v_pk_max_i16 v16, v16, 0
    v_mfma_f32_16x16x32_bf16 v[32:35], a[80:83], v[72:75], v[32:35]
    ds_read_b128 v[56:59], v2 offset:24576
    v_add_f32 v18, v18, v138
    v_mfma_f32_16x16x32_bf16 v[40:43], a[80:83], v[76:79], v[40:43]
    v_add_f32 v19, v19, v139
    v_mul_f32 v120, v18, v117
    v_mfma_f32_16x16x32_bf16 v[44:47], a[84:87], v[76:79], v[44:47]
    ds_read_b128 v[60:63], v2 offset:25600
    v_mul_f32 v121, v19, v117
    v_mfma_f32_16x16x32_bf16 v[36:39], a[84:87], v[72:75], v[36:39]
    s_waitcnt lgkmcnt(2)
    v_mul_f32 v120, v120, abs(v18)
    v_mul_f32 v121, v121, abs(v19)
    v_mfma_f32_16x16x32_bf16 v[32:35], a[88:91], v[80:83], v[32:35]
    ds_read_b128 v[64:67], v2 offset:26624
    v_cvt_pk_bf16_f32 v17, v120, v121
    v_mfma_f32_16x16x32_bf16 v[40:43], a[88:91], v[84:87], v[40:43]
    v_pk_max_i16 v17, v17, 0
    v_add_f32 v20, v20, v140
    v_mfma_f32_16x16x32_bf16 v[44:47], a[92:95], v[84:87], v[44:47]
    ds_read_b128 v[68:71], v2 offset:27648
    v_add_f32 v21, v21, v141
    v_mfma_f32_16x16x32_bf16 v[36:39], a[92:95], v[80:83], v[36:39]
    s_waitcnt lgkmcnt(2)
    v_mul_f32 v120, v20, v117
    v_mul_f32 v121, v21, v117
    v_mfma_f32_16x16x32_bf16 v[32:35], a[96:99], v[56:59], v[32:35]
    ds_read_b128 v[72:75], v2 offset:28672
    v_mul_f32 v120, v120, abs(v20)
    v_mfma_f32_16x16x32_bf16 v[40:43], a[96:99], v[60:63], v[40:43]
    v_mul_f32 v121, v121, abs(v21)
    v_cvt_pk_bf16_f32 v18, v120, v121
    v_mfma_f32_16x16x32_bf16 v[44:47], a[100:103], v[60:63], v[44:47]
    ds_read_b128 v[76:79], v2 offset:29696
    buffer_load_dword v7, v5, s[16:19], s45 offen sc1
    v_mfma_f32_16x16x32_bf16 v[36:39], a[100:103], v[56:59], v[36:39]
    s_waitcnt lgkmcnt(2)
    v_pk_max_i16 v18, v18, 0
    v_add_f32 v22, v22, v142
    v_mfma_f32_16x16x32_bf16 v[32:35], a[104:107], v[64:67], v[32:35]
    ds_read_b128 v[80:83], v2 offset:30720
    v_add_f32 v23, v23, v143
    v_mfma_f32_16x16x32_bf16 v[40:43], a[104:107], v[68:71], v[40:43]
    v_mul_f32 v120, v22, v117
    v_mul_f32 v121, v23, v117
    v_mfma_f32_16x16x32_bf16 v[44:47], a[108:111], v[68:71], v[44:47]
    ds_read_b128 v[84:87], v2 offset:31744
    v_mul_f32 v120, v120, abs(v22)
    v_mfma_f32_16x16x32_bf16 v[36:39], a[108:111], v[64:67], v[36:39]
    s_waitcnt vmcnt(6) lgkmcnt(2)
    s_barrier
    v_mul_f32 v121, v121, abs(v23)
    v_mfma_f32_16x16x32_bf16 v[32:35], a[112:115], v[72:75], v[32:35]
    ds_read_b128 v[56:59], v2 offset:32768
    v_cvt_pk_bf16_f32 v19, v120, v121
    v_mfma_f32_16x16x32_bf16 v[40:43], a[112:115], v[76:79], v[40:43]
    v_pk_max_i16 v19, v19, 0
    buffer_store_dwordx4 v[16:19], v1, s[16:19], s44 offen offset:1024 sc1
    v_mfma_f32_16x16x32_bf16 v[44:47], a[116:119], v[76:79], v[44:47]
    s_add_u32 m0, s43, 0
    ds_read_b128 v[60:63], v2 offset:33792
    ds_read_b64 v[144:145], v118 offset:0
    v_mfma_f32_16x16x32_bf16 v[36:39], a[116:119], v[72:75], v[36:39]
    s_waitcnt lgkmcnt(3)
    ds_read_b64 v[146:147], v118 offset:128
    ds_read_b64 v[148:149], v118 offset:256
    v_mfma_f32_16x16x32_bf16 v[32:35], a[120:123], v[80:83], v[32:35]
    s_add_u32 s42, s41, 0
    ds_read_b128 v[64:67], v2 offset:34816
    ds_read_b64 v[150:151], v118 offset:384
    v_mfma_f32_16x16x32_bf16 v[40:43], a[120:123], v[84:87], v[40:43]
    v_mfma_f32_16x16x32_bf16 v[44:47], a[124:127], v[84:87], v[44:47]
    ds_read_b128 v[68:71], v2 offset:35840
    v_mfma_f32_16x16x32_bf16 v[36:39], a[124:127], v[80:83], v[36:39]
    s_waitcnt lgkmcnt(6)
    v_mfma_f32_16x16x32_bf16 v[32:35], a[128:131], v[56:59], v[32:35]
    ds_read_b128 v[72:75], v2 offset:36864
    v_mfma_f32_16x16x32_bf16 v[40:43], a[128:131], v[60:63], v[40:43]
    s_waitcnt lgkmcnt(2)
    v_max3_u32 v152, v144, v145, v146
    v_max3_u32 v153, v147, v148, v149
    v_mfma_f32_16x16x32_bf16 v[44:47], a[132:135], v[60:63], v[44:47]
    ds_read_b128 v[76:79], v2 offset:37888
    v_max3_u32 v152, v152, v150, v151
    v_mfma_f32_16x16x32_bf16 v[36:39], a[132:135], v[56:59], v[36:39]
    s_waitcnt lgkmcnt(2)
    v_max_u32 v152, v152, v153
    v_cmp_eq_u32 vcc, -1, v152
    v_mfma_f32_16x16x32_bf16 v[32:35], a[136:139], v[64:67], v[32:35]
    ds_read_b128 v[80:83], v2 offset:38912
    v_mfma_f32_16x16x32_bf16 v[40:43], a[136:139], v[68:71], v[40:43]
    s_cbranch_vccnz L_sspin43
L_sback44:
    v_add_f32 v152, v148, v150
    v_add_f32 v153, v149, v151
    v_mfma_f32_16x16x32_bf16 v[44:47], a[140:143], v[68:71], v[44:47]
    ds_read_b128 v[84:87], v2 offset:39936
    v_add_f32 v144, v144, v146
    v_mfma_f32_16x16x32_bf16 v[36:39], a[140:143], v[64:67], v[36:39]
    s_waitcnt lgkmcnt(2)
    v_add_f32 v145, v145, v147
    v_add_f32 v144, v144, v152
    v_mfma_f32_16x16x32_bf16 v[32:35], a[144:147], v[72:75], v[32:35]
    ds_read_b128 v[56:59], v2 offset:40960
    v_add_f32 v145, v145, v153
    v_mfma_f32_16x16x32_bf16 v[40:43], a[144:147], v[76:79], v[40:43]
    v_mov_b32 v152, v144
    v_mov_b32 v153, v145
    v_mfma_f32_16x16x32_bf16 v[44:47], a[148:151], v[76:79], v[44:47]
    ds_read_b128 v[60:63], v2 offset:41984
    v_permlane32_swap_b32 v144, v152
    v_mfma_f32_16x16x32_bf16 v[36:39], a[148:151], v[72:75], v[36:39]
    s_waitcnt lgkmcnt(2)
    v_permlane32_swap_b32 v145, v153
    v_mfma_f32_16x16x32_bf16 v[32:35], a[152:155], v[80:83], v[32:35]
    ds_read_b128 v[64:67], v2 offset:43008
    v_add_f32 v144, v144, v152
    v_mfma_f32_16x16x32_bf16 v[40:43], a[152:155], v[84:87], v[40:43]
    v_add_f32 v145, v145, v153
    v_mul_f32 v112, 0xba800000, v144
    v_mfma_f32_16x16x32_bf16 v[44:47], a[156:159], v[84:87], v[44:47]
    ds_read_b128 v[68:71], v2 offset:44032
    v_mul_f32 v145, 0x3a800000, v145
    v_mfma_f32_16x16x32_bf16 v[36:39], a[156:159], v[80:83], v[36:39]
    s_waitcnt lgkmcnt(2)
    v_fma_f32 v145, -v112, v112, v145
    v_mov_b32 v113, v112
    v_mfma_f32_16x16x32_bf16 v[32:35], a[160:163], v[56:59], v[32:35]
    ds_read_b128 v[72:75], v2 offset:45056
    v_max_f32 v145, 0, v145
    v_mfma_f32_16x16x32_bf16 v[40:43], a[160:163], v[60:63], v[40:43]
    v_add_f32 v145, 0x3727c5ac, v145
    v_rsq_f32 v116, v145
    v_mfma_f32_16x16x32_bf16 v[44:47], a[164:167], v[60:63], v[44:47]
    ds_read_b128 v[76:79], v2 offset:46080
    v_permlane16_swap_b32 v112, v113
    v_mfma_f32_16x16x32_bf16 v[36:39], a[164:167], v[56:59], v[36:39]
    s_waitcnt lgkmcnt(2)
    v_mul_f32 v114, v145, v116
    v_mul_f32 v116, v116, v116
    v_mfma_f32_16x16x32_bf16 v[32:35], a[168:171], v[64:67], v[32:35]
    s_waitcnt vmcnt(0)
    ds_read_b128 v[80:83], v2 offset:47104
    v_mov_b32 v115, v114
    v_mfma_f32_16x16x32_bf16 v[40:43], a[168:171], v[68:71], v[40:43]
    s_barrier
    buffer_store_dword v124, v124, s[16:19], s91 offen sc1
    v_mfma_f32_16x16x32_bf16 v[44:47], a[172:175], v[68:71], v[44:47]
    s_add_u32 s91, s91, 65536
    ds_read_b128 v[84:87], v2 offset:48128
    v_cmp_ne_u32 vcc, 0, v7
    v_mfma_f32_16x16x32_bf16 v[36:39], a[172:175], v[64:67], v[36:39]
    s_waitcnt lgkmcnt(2)
    v_mov_b32 v117, v116
    v_permlane16_swap_b32 v114, v115
    v_mfma_f32_16x16x32_bf16 v[32:35], a[176:179], v[72:75], v[32:35]
    s_cbranch_vccnz L_spin41
L_back42:
    ds_read_b128 v[56:59], v2 offset:49152
    v_permlane16_swap_b32 v116, v117
    v_mfma_f32_16x16x32_bf16 v[40:43], a[176:179], v[76:79], v[40:43]
    s_barrier
    buffer_load_dwordx4 v1, s[16:19], s42 offen offset:0 sc1 lds
    v_mfma_f32_16x16x32_bf16 v[44:47], a[180:183], v[76:79], v[44:47]
    s_add_u32 s46, s46, 2048
    ds_read_b128 v[60:63], v2 offset:50176
    buffer_load_dwordx4 v1, s[16:19], s42 offen offset:1024 sc1 lds
    v_mfma_f32_16x16x32_bf16 v[36:39], a[180:183], v[72:75], v[36:39]
    s_waitcnt lgkmcnt(2)
    buffer_load_dwordx4 v1, s[16:19], s42 offen offset:2048 sc1 lds
    v_mfma_f32_16x16x32_bf16 v[32:35], a[184:187], v[80:83], v[32:35]
    ds_read_b128 v[64:67], v2 offset:51200
    buffer_load_dwordx4 v1, s[16:19], s42 offen offset:3072 sc1 lds
    v_mfma_f32_16x16x32_bf16 v[40:43], a[184:187], v[84:87], v[40:43]
    s_add_u32 m0, s43, 16384
    v_mul_f32 v128, v112, v88
    v_fmac_f32 v128, v114, v100
    v_mfma_f32_16x16x32_bf16 v[44:47], a[188:191], v[84:87], v[44:47]
    s_add_u32 s42, s41, 16384
    ds_read_b128 v[68:71], v2 offset:52224
    v_mul_f32 v129, v112, v89
    v_mfma_f32_16x16x32_bf16 v[36:39], a[188:191], v[80:83], v[36:39]
    s_waitcnt lgkmcnt(2)
    v_fmac_f32 v129, v114, v101
    v_mul_f32 v130, v112, v90
    v_mfma_f32_16x16x32_bf16 v[32:35], a[192:195], v[56:59], v[32:35]
    ds_read_b128 v[72:75], v2 offset:53248
    buffer_load_dwordx4 v1, s[16:19], s42 offen offset:0 sc1 lds
    v_mfma_f32_16x16x32_bf16 v[40:43], a[192:195], v[60:63], v[40:43]
    v_fmac_f32 v130, v114, v102
    v_mul_f32 v131, v112, v91
    v_mfma_f32_16x16x32_bf16 v[44:47], a[196:199], v[60:63], v[44:47]
    ds_read_b128 v[76:79], v2 offset:54272
    v_fmac_f32 v131, v114, v103
    v_mfma_f32_16x16x32_bf16 v[36:39], a[196:199], v[56:59], v[36:39]
    s_waitcnt lgkmcnt(2)
    v_mul_f32 v132, v112, v92
    v_fmac_f32 v132, v114, v104
    v_mfma_f32_16x16x32_bf16 v[32:35], a[200:203], v[64:67], v[32:35]
    ds_read_b128 v[80:83], v2 offset:55296
    buffer_load_dwordx4 v1, s[16:19], s42 offen offset:1024 sc1 lds
    v_mfma_f32_16x16x32_bf16 v[40:43], a[200:203], v[68:71], v[40:43]
    v_mul_f32 v133, v112, v93
    v_fmac_f32 v133, v114, v105
    v_mfma_f32_16x16x32_bf16 v[44:47], a[204:207], v[68:71], v[44:47]
    ds_read_b128 v[84:87], v2 offset:56320
    v_mul_f32 v134, v112, v94
    v_mfma_f32_16x16x32_bf16 v[36:39], a[204:207], v[64:67], v[36:39]
    s_waitcnt lgkmcnt(2)
    v_fmac_f32 v134, v114, v106
    v_mul_f32 v135, v112, v95
    v_mfma_f32_16x16x32_bf16 v[32:35], a[208:211], v[72:75], v[32:35]
    ds_read_b128 v[56:59], v2 offset:57344
    buffer_load_dwordx4 v1, s[16:19], s42 offen offset:2048 sc1 lds
    v_mfma_f32_16x16x32_bf16 v[40:43], a[208:211], v[76:79], v[40:43]
    v_fmac_f32 v135, v114, v107
    v_mul_f32 v136, v113, v88
    v_mfma_f32_16x16x32_bf16 v[44:47], a[212:215], v[76:79], v[44:47]
    ds_read_b128 v[60:63], v2 offset:58368
    v_fmac_f32 v136, v115, v100
    v_mfma_f32_16x16x32_bf16 v[36:39], a[212:215], v[72:75], v[36:39]
    s_waitcnt lgkmcnt(2)
    v_mul_f32 v137, v113, v89
    v_fmac_f32 v137, v115, v101
    v_mfma_f32_16x16x32_bf16 v[32:35], a[216:219], v[80:83], v[32:35]
    ds_read_b128 v[64:67], v2 offset:59392
    buffer_load_dwordx4 v1, s[16:19], s42 offen offset:3072 sc1 lds
    v_mfma_f32_16x16x32_bf16 v[40:43], a[216:219], v[84:87], v[40:43]
    s_add_u32 s45, s45, 65536
    v_mul_f32 v138, v113, v90
    v_fmac_f32 v138, v115, v102
    v_mfma_f32_16x16x32_bf16 v[44:47], a[220:223], v[84:87], v[44:47]
    ds_read_b128 v[68:71], v2 offset:60416
    v_mul_f32 v139, v113, v91
    v_mfma_f32_16x16x32_bf16 v[36:39], a[220:223], v[80:83], v[36:39]
    s_waitcnt lgkmcnt(2)
    v_fmac_f32 v139, v115, v103
    v_mul_f32 v140, v113, v92
    v_mfma_f32_16x16x32_bf16 v[32:35], a[224:227], v[56:59], v[32:35]
    ds_read_b128 v[72:75], v2 offset:61440
    v_fmac_f32 v140, v115, v104
    v_mfma_f32_16x16x32_bf16 v[40:43], a[224:227], v[60:63], v[40:43]
    v_mul_f32 v141, v113, v93
    v_fmac_f32 v141, v115, v105
    v_mfma_f32_16x16x32_bf16 v[44:47], a[228:231], v[60:63], v[44:47]
    ds_read_b128 v[76:79], v2 offset:62464
    v_mul_f32 v142, v113, v94
    v_mfma_f32_16x16x32_bf16 v[36:39], a[228:231], v[56:59], v[36:39]
    s_waitcnt lgkmcnt(2)
    v_fmac_f32 v142, v115, v106
    v_mul_f32 v143, v113, v95
    v_mfma_f32_16x16x32_bf16 v[32:35], a[232:235], v[64:67], v[32:35]
    ds_read_b128 v[80:83], v2 offset:63488
    v_fmac_f32 v143, v115, v107
    v_mfma_f32_16x16x32_bf16 v[40:43], a[232:235], v[68:71], v[40:43]
    v_mfma_f32_16x16x32_bf16 v[44:47], a[236:239], v[68:71], v[44:47]
    ds_read_b128 v[84:87], v2 offset:64512
    v_mfma_f32_16x16x32_bf16 v[36:39], a[236:239], v[64:67], v[36:39]
    s_waitcnt vmcnt(4) lgkmcnt(2)
    s_barrier
    v_mfma_f32_16x16x32_bf16 v[32:35], a[240:243], v[72:75], v[32:35]
    ds_read_b128 v[56:59], v1 offset:0
    v_mfma_f32_16x16x32_bf16 v[40:43], a[240:243], v[76:79], v[40:43]
    v_mfma_f32_16x16x32_bf16 v[44:47], a[244:247], v[76:79], v[44:47]
    ds_read_b128 v[60:63], v1 offset:1024
    v_mfma_f32_16x16x32_bf16 v[36:39], a[244:247], v[72:75], v[36:39]
    s_waitcnt lgkmcnt(2)
    v_mfma_f32_16x16x32_bf16 v[32:35], a[248:251], v[80:83], v[32:35]
    ds_read_b128 v[64:67], v1 offset:2048
    v_mfma_f32_16x16x32_bf16 v[40:43], a[248:251], v[84:87], v[40:43]
    v_mfma_f32_16x16x32_bf16 v[44:47], a[252:255], v[84:87], v[44:47]
    ds_read_b128 v[68:71], v1 offset:3072
    v_mfma_f32_16x16x32_bf16 v[36:39], a[252:255], v[80:83], v[36:39]
    s_add_u32 s36, s36, 1
    s_cmp_lt_u32 s36, 32
    s_cbranch_scc1 L_l_b0
    s_nop 7
    s_and_b32 s44, s90, 0xffffffff
    s_cmp_lt_i32 s36, 1
    s_cselect_b32 s44, 0x5e00000, s44
    s_add_u32 s90, s90, 262144
    v_add_f32 v32, v32, v128
    v_add_f32 v33, v33, v129
    v_mul_f32 v120, v32, v116
    v_mul_f32 v121, v33, v116
    v_mul_f32 v120, v120, abs(v32)
    v_mul_f32 v121, v121, abs(v33)
    v_cvt_pk_bf16_f32 v32, v120, v121
    v_pk_max_i16 v32, v32, 0
    v_add_f32 v34, v34, v130
    v_add_f32 v35, v35, v131
    v_mul_f32 v120, v34, v116
    v_mul_f32 v121, v35, v116
    v_mul_f32 v120, v120, abs(v34)
    v_mul_f32 v121, v121, abs(v35)
    v_cvt_pk_bf16_f32 v33, v120, v121
    v_pk_max_i16 v33, v33, 0
    v_add_f32 v36, v36, v132
    v_add_f32 v37, v37, v133
    v_mul_f32 v120, v36, v116
    v_mul_f32 v121, v37, v116
    v_mul_f32 v120, v120, abs(v36)
    v_mul_f32 v121, v121, abs(v37)
    v_cvt_pk_bf16_f32 v34, v120, v121
    v_pk_max_i16 v34, v34, 0
    v_add_f32 v38, v38, v134
    v_add_f32 v39, v39, v135
    v_mul_f32 v120, v38, v116
    v_mul_f32 v121, v39, v116
    v_mul_f32 v120, v120, abs(v38)
    v_mul_f32 v121, v121, abs(v39)
    v_cvt_pk_bf16_f32 v35, v120, v121
    v_pk_max_i16 v35, v35, 0
    buffer_store_dwordx4 v[32:35], v1, s[16:19], s44 offen offset:0 sc1
    v_add_f32 v40, v40, v136
    v_add_f32 v41, v41, v137
    v_mul_f32 v120, v40, v117
    v_mul_f32 v121, v41, v117
    v_mul_f32 v120, v120, abs(v40)
    v_mul_f32 v121, v121, abs(v41)
    v_cvt_pk_bf16_f32 v40, v120, v121
    v_pk_max_i16 v40, v40, 0
    v_add_f32 v42, v42, v138
    v_add_f32 v43, v43, v139
    v_mul_f32 v120, v42, v117
    v_mul_f32 v121, v43, v117
    v_mul_f32 v120, v120, abs(v42)
    v_mul_f32 v121, v121, abs(v43)
    v_cvt_pk_bf16_f32 v41, v120, v121
    v_pk_max_i16 v41, v41, 0
    v_add_f32 v44, v44, v140
    v_add_f32 v45, v45, v141
    v_mul_f32 v120, v44, v117
    v_mul_f32 v121, v45, v117
    v_mul_f32 v120, v120, abs(v44)
    v_mul_f32 v121, v121, abs(v45)
    v_cvt_pk_bf16_f32 v42, v120, v121
    v_pk_max_i16 v42, v42, 0
    v_add_f32 v46, v46, v142
    v_add_f32 v47, v47, v143
    v_mul_f32 v120, v46, v117
    v_mul_f32 v121, v47, v117
    v_mul_f32 v120, v120, abs(v46)
    v_mul_f32 v121, v121, abs(v47)
    v_cvt_pk_bf16_f32 v43, v120, v121
    v_pk_max_i16 v43, v43, 0
    buffer_store_dwordx4 v[40:43], v1, s[16:19], s44 offen offset:1024 sc1
    s_waitcnt vmcnt(0)
    s_barrier
    buffer_store_dword v124, v124, s[16:19], s91 offen sc1
    s_add_u32 s91, s91, 65536
    s_waitcnt vmcnt(0)
    s_endpgm
L_spin33:
    s_mov_b32 s40, 0x20000
L_spin33_l:
    buffer_load_dword v56, v124, s[20:23], 0 offen sc1
    s_sub_u32 s40, s40, 1
    s_waitcnt vmcnt(0)
    v_cmp_eq_u32 vcc, v124, v56
    s_cbranch_scc1 L_back34
    s_cbranch_vccz L_back34
    s_sleep 8
    s_branch L_spin33_l
L_spin35:
    s_mov_b32 s40, 0x20000
L_spin35_l:
    buffer_load_dword v7, v5, s[16:19], s45 offen sc1
    s_sub_u32 s40, s40, 1
    s_waitcnt vmcnt(0)
    v_cmp_ne_u32 vcc, 0, v7
    s_cbranch_scc1 L_back36
    s_cbranch_vccz L_back36
    s_sleep 2
    s_branch L_spin35_l
L_spin37:
    s_mov_b32 s40, 0x20000
L_spin37_l:
    buffer_load_dword v7, v5, s[16:19], s45 offen sc1
    s_sub_u32 s40, s40, 1
    s_waitcnt vmcnt(0)
    v_cmp_ne_u32 vcc, 0, v7
    s_cbranch_scc1 L_back38
    s_cbranch_vccz L_back38
    s_sleep 2
    s_branch L_spin37_l
L_sspin39:
    s_mov_b32 s40, 0x20000
L_sspin39_l:
    buffer_load_dwordx2 v[144:145], v6, s[16:19], s46 offen offset:0 sc1
    buffer_load_dwordx2 v[146:147], v6, s[16:19], s46 offen offset:128 sc1
    buffer_load_dwordx2 v[148:149], v6, s[16:19], s46 offen offset:256 sc1
    buffer_load_dwordx2 v[150:151], v6, s[16:19], s46 offen offset:384 sc1
    s_sub_u32 s40, s40, 1
    s_waitcnt vmcnt(0)
    v_max3_u32 v152, v144, v145, v146
    v_max3_u32 v153, v147, v148, v149
    v_max3_u32 v152, v152, v150, v151
    v_max_u32 v152, v152, v153
    v_cmp_eq_u32 vcc, -1, v152
    s_cbranch_scc1 L_sback40
    s_cbranch_vccz L_sback40
    s_sleep 4
    s_branch L_sspin39_l
L_spin41:
    s_mov_b32 s40, 0x20000
L_spin41_l:
    buffer_load_dword v7, v5, s[16:19], s45 offen sc1
    s_sub_u32 s40, s40, 1
    s_waitcnt vmcnt(0)
    v_cmp_ne_u32 vcc, 0, v7
    s_cbranch_scc1 L_back42
    s_cbranch_vccz L_back42
    s_sleep 2
    s_branch L_spin41_l
L_sspin43:
    s_mov_b32 s40, 0x20000
L_sspin43_l:
    buffer_load_dwordx2 v[144:145], v6, s[16:19], s46 offen offset:0 sc1
    buffer_load_dwordx2 v[146:147], v6, s[16:19], s46 offen offset:128 sc1
    buffer_load_dwordx2 v[148:149], v6, s[16:19], s46 offen offset:256 sc1
    buffer_load_dwordx2 v[150:151], v6, s[16:19], s46 offen offset:384 sc1
    s_sub_u32 s40, s40, 1
    s_waitcnt vmcnt(0)
    v_max3_u32 v152, v144, v145, v146
    v_max3_u32 v153, v147, v148, v149
    v_max3_u32 v152, v152, v150, v151
    v_max_u32 v152, v152, v153
    v_cmp_eq_u32 vcc, -1, v152
    s_cbranch_scc1 L_sback44
    s_cbranch_vccz L_sback44
    s_sleep 4
    s_branch L_sspin43_l
L_role_44:
    s_sub_u32 s35, s34, 44
    s_cmp_ge_u32 s35, 12
    s_cbranch_scc1 L_bf_nost
    s_lshl_b32 s50, s33, 4
    s_add_u32 s50, s50, s35
    s_lshl_b32 s50, s50, 1
    s_lshl_b32 s46, s50, 15
    s_lshl_b32 s37, s32, 9
    s_add_u32 s46, s46, s37
    v_lshrrev_b32 v48, 3, v0
    v_and_b32 v49, 0x70, v1
    v_lshl_add_u32 v48, v48, 11, v49
    v_add_u32 v49, 16384, v48
    s_mov_b32 s8, s64
    s_mov_b32 s9, s65
    s_mov_b32 s10, 0x400000
    s_mov_b32 s11, 0x00020000
    buffer_load_dwordx4 v[16:19], v48, s[8:11], s46 offen offset:0
    buffer_load_dwordx4 v[20:23], v48, s[8:11], s46 offen offset:128
    buffer_load_dwordx4 v[24:27], v48, s[8:11], s46 offen offset:256
    buffer_load_dwordx4 v[28:31], v48, s[8:11], s46 offen offset:384
    buffer_load_dwordx4 v[32:35], v49, s[8:11], s46 offen offset:0
    buffer_load_dwordx4 v[36:39], v49, s[8:11], s46 offen offset:128
    buffer_load_dwordx4 v[40:43], v49, s[8:11], s46 offen offset:256
    buffer_load_dwordx4 v[44:47], v49, s[8:11], s46 offen offset:384
    s_xor_b32 s50, s50, 1
    s_lshl_b32 s46, s50, 15
    s_lshl_b32 s37, s32, 9
    s_add_u32 s46, s46, s37
    v_lshrrev_b32 v96, 3, v0
    v_and_b32 v97, 0x70, v1
    v_lshl_add_u32 v96, v96, 11, v97
    v_add_u32 v97, 16384, v96
    s_mov_b32 s8, s64
    s_mov_b32 s9, s65
    s_mov_b32 s10, 0x400000
    s_mov_b32 s11, 0x00020000
    buffer_load_dwordx4 v[64:67], v96, s[8:11], s46 offen offset:0
    buffer_load_dwordx4 v[68:71], v96, s[8:11], s46 offen offset:128
    buffer_load_dwordx4 v[72:75], v96, s[8:11], s46 offen offset:256
    buffer_load_dwordx4 v[76:79], v96, s[8:11], s46 offen offset:384
    buffer_load_dwordx4 v[80:83], v97, s[8:11], s46 offen offset:0
    buffer_load_dwordx4 v[84:87], v97, s[8:11], s46 offen offset:128
    buffer_load_dwordx4 v[88:91], v97, s[8:11], s46 offen offset:256
    buffer_load_dwordx4 v[92:95], v97, s[8:11], s46 offen offset:384
    s_xor_b32 s50, s50, 1
    s_mov_b32 s86, 0x3f803f80
    v_and_b32 v56, 1, v0
    v_lshlrev_b32 v56, 7, v56
    v_bfe_u32 v57, v0, 1, 1
    v_lshl_add_u32 v56, v57, 6, v56
    v_and_b32 v57, 0x38, v0
    v_add_u32 v56, v57, v56
    s_sub_u32 s46, 127, s50
    s_lshl_b32 s46, s46, 10
    s_lshl_b32 s37, s32, 8
    s_add_u32 s46, s46, s37
    s_add_u32 s46, s46, 0x5400000
    s_waitcnt vmcnt(8)
    v_dot2_f32_bf16 v48, v16, s86, 0
    v_dot2_f32_bf16 v49, v16, v16, 0
    v_dot2_f32_bf16 v50, v24, s86, 0
    v_dot2_f32_bf16 v51, v24, v24, 0
    v_dot2_f32_bf16 v52, v32, s86, 0
    v_dot2_f32_bf16 v53, v32, v32, 0
    v_dot2_f32_bf16 v54, v40, s86, 0
    v_dot2_f32_bf16 v55, v40, v40, 0
    v_dot2_f32_bf16 v48, v17, s86, v48
    v_dot2_f32_bf16 v49, v17, v17, v49
    v_dot2_f32_bf16 v50, v25, s86, v50
    v_dot2_f32_bf16 v51, v25, v25, v51
    v_dot2_f32_bf16 v52, v33, s86, v52
    v_dot2_f32_bf16 v53, v33, v33, v53
    v_dot2_f32_bf16 v54, v41, s86, v54
    v_dot2_f32_bf16 v55, v41, v41, v55
    v_dot2_f32_bf16 v48, v18, s86, v48
    v_dot2_f32_bf16 v49, v18, v18, v49
    v_dot2_f32_bf16 v50, v26, s86, v50
    v_dot2_f32_bf16 v51, v26, v26, v51
    v_dot2_f32_bf16 v52, v34, s86, v52
    v_dot2_f32_bf16 v53, v34, v34, v53
    v_dot2_f32_bf16 v54, v42, s86, v54
    v_dot2_f32_bf16 v55, v42, v42, v55
    v_dot2_f32_bf16 v48, v19, s86, v48
    v_dot2_f32_bf16 v49, v19, v19, v49
    v_dot2_f32_bf16 v50, v27, s86, v50
    v_dot2_f32_bf16 v51, v27, v27, v51
    v_dot2_f32_bf16 v52, v35, s86, v52
    v_dot2_f32_bf16 v53, v35, v35, v53
    v_dot2_f32_bf16 v54, v43, s86, v54
    v_dot2_f32_bf16 v55, v43, v43, v55
    v_dot2_f32_bf16 v48, v20, s86, v48
    v_dot2_f32_bf16 v49, v20, v20, v49
    v_dot2_f32_bf16 v50, v28, s86, v50
    v_dot2_f32_bf16 v51, v28, v28, v51
    v_dot2_f32_bf16 v52, v36, s86, v52
    v_dot2_f32_bf16 v53, v36, v36, v53
    v_dot2_f32_bf16 v54, v44, s86, v54
    v_dot2_f32_bf16 v55, v44, v44, v55
    v_dot2_f32_bf16 v48, v21, s86, v48
    v_dot2_f32_bf16 v49, v21, v21, v49
    v_dot2_f32_bf16 v50, v29, s86, v50
    v_dot2_f32_bf16 v51, v29, v29, v51
    v_dot2_f32_bf16 v52, v37, s86, v52
    v_dot2_f32_bf16 v53, v37, v37, v53
    v_dot2_f32_bf16 v54, v45, s86, v54
    v_dot2_f32_bf16 v55, v45, v45, v55
    v_dot2_f32_bf16 v48, v22, s86, v48
    v_dot2_f32_bf16 v49, v22, v22, v49
    v_dot2_f32_bf16 v50, v30, s86, v50
    v_dot2_f32_bf16 v51, v30, v30, v51
    v_dot2_f32_bf16 v52, v38, s86, v52
    v_dot2_f32_bf16 v53, v38, v38, v53
    v_dot2_f32_bf16 v54, v46, s86, v54
    v_dot2_f32_bf16 v55, v46, v46, v55
    v_dot2_f32_bf16 v48, v23, s86, v48
    v_dot2_f32_bf16 v49, v23, v23, v49
    v_dot2_f32_bf16 v50, v31, s86, v50
    v_dot2_f32_bf16 v51, v31, v31, v51
    v_dot2_f32_bf16 v52, v39, s86, v52
    v_dot2_f32_bf16 v53, v39, v39, v53
    v_dot2_f32_bf16 v54, v47, s86, v54
    v_dot2_f32_bf16 v55, v47, v47, v55
    v_add_f32_dpp v48, v48, v48 quad_perm:[1,0,3,2] row_mask:0xf bank_mask:0xf
    v_add_f32_dpp v49, v49, v49 quad_perm:[1,0,3,2] row_mask:0xf bank_mask:0xf
    v_add_f32_dpp v50, v50, v50 quad_perm:[1,0,3,2] row_mask:0xf bank_mask:0xf
    v_add_f32_dpp v51, v51, v51 quad_perm:[1,0,3,2] row_mask:0xf bank_mask:0xf
    v_add_f32_dpp v52, v52, v52 quad_perm:[1,0,3,2] row_mask:0xf bank_mask:0xf
    v_add_f32_dpp v53, v53, v53 quad_perm:[1,0,3,2] row_mask:0xf bank_mask:0xf
    v_add_f32_dpp v54, v54, v54 quad_perm:[1,0,3,2] row_mask:0xf bank_mask:0xf
    v_add_f32_dpp v55, v55, v55 quad_perm:[1,0,3,2] row_mask:0xf bank_mask:0xf
    v_add_f32_dpp v48, v48, v48 quad_perm:[2,3,0,1] row_mask:0xf bank_mask:0xf
    v_add_f32_dpp v49, v49, v49 quad_perm:[2,3,0,1] row_mask:0xf bank_mask:0xf
    v_add_f32_dpp v50, v50, v50 quad_perm:[2,3,0,1] row_mask:0xf bank_mask:0xf
    v_add_f32_dpp v51, v51, v51 quad_perm:[2,3,0,1] row_mask:0xf bank_mask:0xf
    v_add_f32_dpp v52, v52, v52 quad_perm:[2,3,0,1] row_mask:0xf bank_mask:0xf
    v_add_f32_dpp v53, v53, v53 quad_perm:[2,3,0,1] row_mask:0xf bank_mask:0xf
    v_add_f32_dpp v54, v54, v54 quad_perm:[2,3,0,1] row_mask:0xf bank_mask:0xf
    v_add_f32_dpp v55, v55, v55 quad_perm:[2,3,0,1] row_mask:0xf bank_mask:0xf
    v_add_f32_dpp v48, v48, v48 row_half_mirror row_mask:0xf bank_mask:0xf
    v_add_f32_dpp v49, v49, v49 row_half_mirror row_mask:0xf bank_mask:0xf
    v_add_f32_dpp v50, v50, v50 row_half_mirror row_mask:0xf bank_mask:0xf
    v_add_f32_dpp v51, v51, v51 row_half_mirror row_mask:0xf bank_mask:0xf
    v_add_f32_dpp v52, v52, v52 row_half_mirror row_mask:0xf bank_mask:0xf
    v_add_f32_dpp v53, v53, v53 row_half_mirror row_mask:0xf bank_mask:0xf
    v_add_f32_dpp v54, v54, v54 row_half_mirror row_mask:0xf bank_mask:0xf
    v_add_f32_dpp v55, v55, v55 row_half_mirror row_mask:0xf bank_mask:0xf
    s_mov_b32 exec_lo, 0x2020202
    s_mov_b32 exec_hi, 0x2020202
    v_mov_b32 v48, v50
    v_mov_b32 v49, v51
    s_mov_b32 exec_lo, 0x4040404
    s_mov_b32 exec_hi, 0x4040404
    v_mov_b32 v48, v52
    v_mov_b32 v49, v53
    s_mov_b32 exec_lo, 0x8080808
    s_mov_b32 exec_hi, 0x8080808
    v_mov_b32 v48, v54
    v_mov_b32 v49, v55
    s_mov_b32 exec_lo, 0x0f0f0f0f
    s_mov_b32 exec_hi, 0x0f0f0f0f
    buffer_store_dwordx2 v[48:49], v56, s[16:19], s46 offen sc1
    s_mov_b64 exec, -1
    s_xor_b32 s50, s50, 1
    s_mov_b32 s86, 0x3f803f80
    v_and_b32 v104, 1, v0
    v_lshlrev_b32 v104, 7, v104
    v_bfe_u32 v105, v0, 1, 1
    v_lshl_add_u32 v104, v105, 6, v104
    v_and_b32 v105, 0x38, v0
    v_add_u32 v104, v105, v104
    s_sub_u32 s46, 127, s50
    s_lshl_b32 s46, s46, 10
    s_lshl_b32 s37, s32, 8
    s_add_u32 s46, s46, s37
    s_add_u32 s46, s46, 0x5400000
    s_waitcnt vmcnt(1)
    v_dot2_f32_bf16 v96, v64, s86, 0
    v_dot2_f32_bf16 v97, v64, v64, 0
    v_dot2_f32_bf16 v98, v72, s86, 0
    v_dot2_f32_bf16 v99, v72, v72, 0
    v_dot2_f32_bf16 v100, v80, s86, 0
    v_dot2_f32_bf16 v101, v80, v80, 0
    v_dot2_f32_bf16 v102, v88, s86, 0
    v_dot2_f32_bf16 v103, v88, v88, 0
    v_dot2_f32_bf16 v96, v65, s86, v96
    v_dot2_f32_bf16 v97, v65, v65, v97
    v_dot2_f32_bf16 v98, v73, s86, v98
    v_dot2_f32_bf16 v99, v73, v73, v99
    v_dot2_f32_bf16 v100, v81, s86, v100
    v_dot2_f32_bf16 v101, v81, v81, v101
    v_dot2_f32_bf16 v102, v89, s86, v102
    v_dot2_f32_bf16 v103, v89, v89, v103
    v_dot2_f32_bf16 v96, v66, s86, v96
    v_dot2_f32_bf16 v97, v66, v66, v97
    v_dot2_f32_bf16 v98, v74, s86, v98
    v_dot2_f32_bf16 v99, v74, v74, v99
    v_dot2_f32_bf16 v100, v82, s86, v100
    v_dot2_f32_bf16 v101, v82, v82, v101
    v_dot2_f32_bf16 v102, v90, s86, v102
    v_dot2_f32_bf16 v103, v90, v90, v103
    v_dot2_f32_bf16 v96, v67, s86, v96
    v_dot2_f32_bf16 v97, v67, v67, v97
    v_dot2_f32_bf16 v98, v75, s86, v98
    v_dot2_f32_bf16 v99, v75, v75, v99
    v_dot2_f32_bf16 v100, v83, s86, v100
    v_dot2_f32_bf16 v101, v83, v83, v101
    v_dot2_f32_bf16 v102, v91, s86, v102
    v_dot2_f32_bf16 v103, v91, v91, v103
    v_dot2_f32_bf16 v96, v68, s86, v96
    v_dot2_f32_bf16 v97, v68, v68, v97
    v_dot2_f32_bf16 v98, v76, s86, v98
    v_dot2_f32_bf16 v99, v76, v76, v99
    v_dot2_f32_bf16 v100, v84, s86, v100
    v_dot2_f32_bf16 v101, v84, v84, v101
    v_dot2_f32_bf16 v102, v92, s86, v102
    v_dot2_f32_bf16 v103, v92, v92, v103
    v_dot2_f32_bf16 v96, v69, s86, v96
    v_dot2_f32_bf16 v97, v69, v69, v97
    v_dot2_f32_bf16 v98, v77, s86, v98
    v_dot2_f32_bf16 v99, v77, v77, v99
    v_dot2_f32_bf16 v100, v85, s86, v100
    v_dot2_f32_bf16 v101, v85, v85, v101
    v_dot2_f32_bf16 v102, v93, s86, v102
    v_dot2_f32_bf16 v103, v93, v93, v103
    v_dot2_f32_bf16 v96, v70, s86, v96
    v_dot2_f32_bf16 v97, v70, v70, v97
    v_dot2_f32_bf16 v98, v78, s86, v98
    v_dot2_f32_bf16 v99, v78, v78, v99
    v_dot2_f32_bf16 v100, v86, s86, v100
    v_dot2_f32_bf16 v101, v86, v86, v101
    v_dot2_f32_bf16 v102, v94, s86, v102
    v_dot2_f32_bf16 v103, v94, v94, v103
    v_dot2_f32_bf16 v96, v71, s86, v96
    v_dot2_f32_bf16 v97, v71, v71, v97
    v_dot2_f32_bf16 v98, v79, s86, v98
    v_dot2_f32_bf16 v99, v79, v79, v99
    v_dot2_f32_bf16 v100, v87, s86, v100
    v_dot2_f32_bf16 v101, v87, v87, v101
    v_dot2_f32_bf16 v102, v95, s86, v102
    v_dot2_f32_bf16 v103, v95, v95, v103
    v_add_f32_dpp v96, v96, v96 quad_perm:[1,0,3,2] row_mask:0xf bank_mask:0xf
    v_add_f32_dpp v97, v97, v97 quad_perm:[1,0,3,2] row_mask:0xf bank_mask:0xf
    v_add_f32_dpp v98, v98, v98 quad_perm:[1,0,3,2] row_mask:0xf bank_mask:0xf
    v_add_f32_dpp v99, v99, v99 quad_perm:[1,0,3,2] row_mask:0xf bank_mask:0xf
    v_add_f32_dpp v100, v100, v100 quad_perm:[1,0,3,2] row_mask:0xf bank_mask:0xf
    v_add_f32_dpp v101, v101, v101 quad_perm:[1,0,3,2] row_mask:0xf bank_mask:0xf
    v_add_f32_dpp v102, v102, v102 quad_perm:[1,0,3,2] row_mask:0xf bank_mask:0xf
    v_add_f32_dpp v103, v103, v103 quad_perm:[1,0,3,2] row_mask:0xf bank_mask:0xf
    v_add_f32_dpp v96, v96, v96 quad_perm:[2,3,0,1] row_mask:0xf bank_mask:0xf
    v_add_f32_dpp v97, v97, v97 quad_perm:[2,3,0,1] row_mask:0xf bank_mask:0xf
    v_add_f32_dpp v98, v98, v98 quad_perm:[2,3,0,1] row_mask:0xf bank_mask:0xf
    v_add_f32_dpp v99, v99, v99 quad_perm:[2,3,0,1] row_mask:0xf bank_mask:0xf
    v_add_f32_dpp v100, v100, v100 quad_perm:[2,3,0,1] row_mask:0xf bank_mask:0xf
    v_add_f32_dpp v101, v101, v101 quad_perm:[2,3,0,1] row_mask:0xf bank_mask:0xf
    v_add_f32_dpp v102, v102, v102 quad_perm:[2,3,0,1] row_mask:0xf bank_mask:0xf
    v_add_f32_dpp v103, v103, v103 quad_perm:[2,3,0,1] row_mask:0xf bank_mask:0xf
    v_add_f32_dpp v96, v96, v96 row_half_mirror row_mask:0xf bank_mask:0xf
    v_add_f32_dpp v97, v97, v97 row_half_mirror row_mask:0xf bank_mask:0xf
    v_add_f32_dpp v98, v98, v98 row_half_mirror row_mask:0xf bank_mask:0xf
    v_add_f32_dpp v99, v99, v99 row_half_mirror row_mask:0xf bank_mask:0xf
    v_add_f32_dpp v100, v100, v100 row_half_mirror row_mask:0xf bank_mask:0xf
    v_add_f32_dpp v101, v101, v101 row_half_mirror row_mask:0xf bank_mask:0xf
    v_add_f32_dpp v102, v102, v102 row_half_mirror row_mask:0xf bank_mask:0xf
    v_add_f32_dpp v103, v103, v103 row_half_mirror row_mask:0xf bank_mask:0xf
    s_mov_b32 exec_lo, 0x2020202
    s_mov_b32 exec_hi, 0x2020202
    v_mov_b32 v96, v98
    v_mov_b32 v97, v99
    s_mov_b32 exec_lo, 0x4040404
    s_mov_b32 exec_hi, 0x4040404
    v_mov_b32 v96, v100
    v_mov_b32 v97, v101
    s_mov_b32 exec_lo, 0x8080808
    s_mov_b32 exec_hi, 0x8080808
    v_mov_b32 v96, v102
    v_mov_b32 v97, v103
    s_mov_b32 exec_lo, 0x0f0f0f0f
    s_mov_b32 exec_hi, 0x0f0f0f0f
    buffer_store_dwordx2 v[96:97], v104, s[16:19], s46 offen sc1
    s_mov_b64 exec, -1
    s_xor_b32 s50, s50, 1
L_bf_nost:
    s_cmp_lg_u32 s32, 0
    s_cbranch_scc1 L_arv45
    s_add_u32 s20, s82, 0x80
    s_addc_u32 s21, s83, 0
    s_mov_b32 s22, 0x4
    s_mov_b32 s23, 0x00020000
    buffer_load_dword v8, v124, s[20:23], 0 offen sc1
    s_waitcnt vmcnt(0)
    v_cmp_eq_u32 vcc, v124, v8
    s_cbranch_vccnz L_spin46
L_back47:
L_arv45:
    s_waitcnt vmcnt(0)
    s_barrier
    s_add_u32 s39, s91, 32768
    buffer_store_dword v124, v124, s[16:19], s39 offen sc1
    s_cmp_lt_u32 s35, 12
    s_cbranch_scc1 L_bf_nopf
    s_add_u32 s12, s72, 0x400000
    s_addc_u32 s13, s73, 0
    s_mov_b32 s14, 0x300000
    s_mov_b32 s15, 0x00020000
    s_sub_u32 s37, s35, 12
    s_lshl2_add_u32 s37, s37, s33
    s_lshl2_add_u32 s37, s37, s32
    s_lshl_b32 s37, s37, 13
    v_lshlrev_b32 v6, 7, v0
    buffer_load_dword v240, v6, s[12:15], s37 offen
    s_add_u32 s37, s37, 1048576
    buffer_load_dword v241, v6, s[12:15], s37 offen
    s_add_u32 s37, s37, 1048576
    buffer_load_dword v242, v6, s[12:15], s37 offen
    s_add_u32 s37, s37, 1048576
L_bf_nopf:
    s_lshr_b32 s51, s35, 2
    s_and_b32 s87, s35, 3
    s_mul_i32 s54, s51, 1441792
    s_lshl_b32 s37, s87, 9
    s_add_u32 s54, s54, s37
    s_mov_b32 s12, s76
    s_mov_b32 s13, s77
    s_mov_b32 s14, 0x700000
    s_mov_b32 s15, 0x00020000
    s_mov_b32 s39, 2048
    s_cmp_lg_u32 s32, 0
    s_cbranch_scc1 L_arv48
    s_add_u32 s20, s82, 0x80
    s_addc_u32 s21, s83, 0
    s_mov_b32 s22, 0x4
    s_mov_b32 s23, 0x00020000
    buffer_load_dword v48, v124, s[20:23], 0 offen sc1
    s_waitcnt vmcnt(0)
    v_cmp_eq_u32 vcc, v124, v48
    s_cbranch_vccnz L_spin49
L_back50:
L_arv48:
    s_and_b32 s38, s34, 15
    s_lshl_b32 s37, s33, 6
    s_add_u32 s37, s37, s38
    s_lshl_b32 s37, s37, 7
    v_lshl_add_u32 v48, v0, 7, s37
    s_cmp_eq_u32 s32, 0
    s_cselect_b32 s37, 1, 0
    v_cmp_le_u32 vcc, s37, v0
    s_nop 1
    v_cndmask_b32 v48, v48, 2.0, vcc
    s_mov_b32 s38, 0x5520000
    buffer_load_dword v49, v48, s[16:19], s38 offen sc1
    s_waitcnt vmcnt(0)
    v_cmp_ne_u32 vcc, 0, v49
    s_cbranch_vccnz L_spin51
L_back52:
    s_barrier
    v_lshrrev_b32 v64, 3, v0
    v_lshlrev_b32 v65, 2, v0
    v_and_b32 v65, 64, v65
    v_and_b32 v66, 0x70, v1
    v_xor_b32 v65, v65, v66
    v_mad_u32_u24 v48, v64, s39, v65
    v_add_u32 v49, 16384, v48
    v_add_u32 v50, 128, v48
    v_add_u32 v51, 16512, v48
    v_add_u32 v52, 256, v48
    v_add_u32 v53, 16640, v48
    v_add_u32 v54, 384, v48
    v_add_u32 v55, 16768, v48
    s_mul_i32 s38, s32, 32768
    s_add_u32 s54, s54, s38
    s_lshl_b32 s42, s32, 11
    s_add_u32 m0, s42, 0
    s_nop 0
    buffer_load_dwordx4 v48, s[12:15], s54 offen lds
    s_add_u32 m0, s42, 1024
    s_nop 0
    buffer_load_dwordx4 v49, s[12:15], s54 offen lds
    s_add_u32 m0, s42, 8192
    s_nop 0
    buffer_load_dwordx4 v50, s[12:15], s54 offen lds
    s_add_u32 m0, s42, 9216
    s_nop 0
    buffer_load_dwordx4 v51, s[12:15], s54 offen lds
    s_add_u32 m0, s42, 16384
    s_nop 0
    buffer_load_dwordx4 v52, s[12:15], s54 offen lds
    s_add_u32 m0, s42, 17408
    s_nop 0
    buffer_load_dwordx4 v53, s[12:15], s54 offen lds
    s_add_u32 m0, s42, 24576
    s_nop 0
    buffer_load_dwordx4 v54, s[12:15], s54 offen lds
    s_add_u32 m0, s42, 25600
    s_nop 0
    buffer_load_dwordx4 v55, s[12:15], s54 offen lds
    s_add_u32 s54, s54, 131072
    s_add_u32 m0, s42, 32768
    s_nop 0
    buffer_load_dwordx4 v48, s[12:15], s54 offen lds
    s_add_u32 m0, s42, 33792
    s_nop 0
    buffer_load_dwordx4 v49, s[12:15], s54 offen lds
    s_add_u32 m0, s42, 40960
    s_nop 0
    buffer_load_dwordx4 v50, s[12:15], s54 offen lds
    s_add_u32 m0, s42, 41984
    s_nop 0
    buffer_load_dwordx4 v51, s[12:15], s54 offen lds
    s_add_u32 m0, s42, 49152
    s_nop 0
    buffer_load_dwordx4 v52, s[12:15], s54 offen lds
    s_add_u32 m0, s42, 50176
    s_nop 0
    buffer_load_dwordx4 v53, s[12:15], s54 offen lds
    s_add_u32 m0, s42, 57344
    s_nop 0
    buffer_load_dwordx4 v54, s[12:15], s54 offen lds
    s_add_u32 m0, s42, 58368
    s_nop 0
    buffer_load_dwordx4 v55, s[12:15], s54 offen lds
    s_add_u32 s54, s54, 131072
    s_add_u32 m0, s42, 65536
    s_nop 0
    buffer_load_dwordx4 v48, s[12:15], s54 offen lds
    s_add_u32 m0, s42, 66560
    s_nop 0
    buffer_load_dwordx4 v49, s[12:15], s54 offen lds
    s_add_u32 m0, s42, 73728
    s_nop 0
    buffer_load_dwordx4 v50, s[12:15], s54 offen lds
    s_add_u32 m0, s42, 74752
    s_nop 0
    buffer_load_dwordx4 v51, s[12:15], s54 offen lds
    s_add_u32 m0, s42, 81920
    s_nop 0
    buffer_load_dwordx4 v52, s[12:15], s54 offen lds
    s_add_u32 m0, s42, 82944
    s_nop 0
    buffer_load_dwordx4 v53, s[12:15], s54 offen lds
    s_add_u32 m0, s42, 90112
    s_nop 0
    buffer_load_dwordx4 v54, s[12:15], s54 offen lds
    s_add_u32 m0, s42, 91136
    s_nop 0
    buffer_load_dwordx4 v55, s[12:15], s54 offen lds
    s_add_u32 s54, s54, 131072
    s_add_u32 m0, s42, 98304
    s_nop 0
    buffer_load_dwordx4 v48, s[12:15], s54 offen lds
    s_add_u32 m0, s42, 99328
    s_nop 0
    buffer_load_dwordx4 v49, s[12:15], s54 offen lds
    s_add_u32 m0, s42, 106496
    s_nop 0
    buffer_load_dwordx4 v50, s[12:15], s54 offen lds
    s_add_u32 m0, s42, 107520
    s_nop 0
    buffer_load_dwordx4 v51, s[12:15], s54 offen lds
    s_add_u32 m0, s42, 114688
    s_nop 0
    buffer_load_dwordx4 v52, s[12:15], s54 offen lds
    s_add_u32 m0, s42, 115712
    s_nop 0
    buffer_load_dwordx4 v53, s[12:15], s54 offen lds
    s_add_u32 m0, s42, 122880
    s_nop 0
    buffer_load_dwordx4 v54, s[12:15], s54 offen lds
    s_add_u32 m0, s42, 123904
    s_nop 0
    buffer_load_dwordx4 v55, s[12:15], s54 offen lds
    s_add_u32 s54, s54, 131072
    v_lshrrev_b32 v64, 4, v0
    v_bfe_u32 v65, v0, 2, 2
    v_lshl_add_u32 v64, v64, 3, v65
    v_lshlrev_b32 v64, 7, v64
    v_lshrrev_b32 v65, 1, v65
    v_lshl_add_u32 v64, v65, 6, v64
    v_and_b32 v65, 3, v0
    v_lshl_add_u32 v64, v65, 4, v64
    s_lshl_b32 s37, s32, 13
    s_and_b32 s38, s51, 2
    s_lshl_b32 s38, s38, 5
    s_xor_b32 s38, s38, 0
    s_add_u32 s37, s37, s38
    v_xor_b32 v56, s37, v64
    s_lshl_b32 s37, s32, 13
    s_and_b32 s38, s51, 2
    s_lshl_b32 s38, s38, 5
    s_xor_b32 s38, s38, 8
    s_add_u32 s37, s37, s38
    v_xor_b32 v57, s37, v64
    s_lshl_b32 s37, s32, 13
    s_and_b32 s38, s51, 2
    s_lshl_b32 s38, s38, 5
    s_xor_b32 s38, s38, 64
    s_add_u32 s37, s37, s38
    v_xor_b32 v58, s37, v64
    s_lshl_b32 s37, s32, 13
    s_and_b32 s38, s51, 2
    s_lshl_b32 s38, s38, 5
    s_xor_b32 s38, s38, 72
    s_add_u32 s37, s37, s38
    v_xor_b32 v59, s37, v64
    s_and_b32 s39, s51, 1
    s_lshl_b32 s37, s39, 10
    v_add_u32 v2, s37, v1
    v_xor_b32 v3, 1024, v2
    v_add_u32 v4, 98304, v2
    v_add_u32 v5, 98304, v3
    s_mul_i32 s38, s51, 11*43
    s_lshr_b32 s38, s38, 7
    s_add_u32 s38, s38, 24
    s_lshl_b32 s37, s33, 6
    s_add_u32 s37, s37, s38
    s_lshl_b32 s37, s37, 7
    v_lshl_add_u32 v6, v0, 7, s37
    s_cmp_eq_u32 s32, 0
    s_cselect_b32 s37, 5, 0
    v_cmp_le_u32 vcc, s37, v0
    s_nop 1
    v_cndmask_b32 v6, v6, 2.0, vcc
    s_mul_i32 s43, s32, 3072
    s_lshl_b32 s88, s32, 11
    s_sub_u32 s89, s88, s43
    s_mul_i32 s41, s33, 8388608
    s_add_u32 s41, s41, 0x1000000
    s_mul_i32 s37, s51, 45056
    s_add_u32 s41, s41, s37
    s_add_u32 s41, s41, s43
    s_mul_i32 s90, s33, 8388608
    s_add_u32 s90, s90, 0x2fc0000
    s_lshl_b32 s37, s87, 16
    s_add_u32 s90, s90, s37
    s_lshl_b32 s37, s32, 12
    s_add_u32 s90, s90, s37
    s_and_b32 s37, s51, 3
    s_lshl_b32 s37, s37, 14
    s_add_u32 s90, s90, s37
    v_mov_b32 v104, 0
    v_mov_b32 v105, 0
    v_mov_b32 v106, 0
    v_mov_b32 v107, 0
    v_mov_b32 v108, 0
    v_mov_b32 v109, 0
    v_mov_b32 v110, 0
    v_mov_b32 v111, 0
    v_mov_b32 v17, 0x3f80
    v_and_b32 v16, 1, v0
    v_lshlrev_b32 v16, 4, v16
    v_lshlrev_b32 v16, v16, v17
    s_mov_b32 exec_lo, 0x300003
    s_mov_b32 exec_hi, 0x30000300
    v_mov_b32 v104, v16
    v_mov_b32 v110, v16
    s_mov_b32 exec_lo, 0xc0000c
    s_mov_b32 exec_hi, 0xc0000c00
    v_mov_b32 v105, v16
    v_mov_b32 v111, v16
    s_mov_b64 exec, -1
    s_add_u32 s38, s87, 44
    s_lshl_b32 s37, s33, 6
    s_add_u32 s37, s37, s38
    s_lshl_b32 s37, s37, 7
    v_lshl_add_u32 v8, v0, 9, s37
    s_cmp_eq_u32 s32, 0
    s_cselect_b32 s37, 5, 0
    v_cmp_le_u32 vcc, s37, v0
    s_nop 1
    v_cndmask_b32 v8, v8, 2.0, vcc
    s_lshl_b32 s38, s87, 2
    s_add_u32 s38, s38, s32
    s_lshl_b32 s38, s38, 1
    s_lshr_b32 s37, s51, 1
    s_add_u32 s38, s38, s37
    s_mul_i32 s53, s33, 2097152
    s_add_u32 s53, s53, 0x7f0000
    s_lshl_b32 s37, s38, 11
    s_add_u32 s53, s53, s37
    s_lshl_b32 s37, s39, 10
    s_add_u32 s53, s53, s37
    v_and_b32 v16, 15, v0
    v_and_b32 v17, 0x30, v0
    s_lshl_b32 s38, s38, 6
    s_mov_b32 s8, s78
    s_mov_b32 s9, s79
    s_mov_b32 s10, 0x800
    s_mov_b32 s11, 0x00020000
    buffer_load_dwordx4 v[24:27], v17, s[8:11], s38 offen
    v_lshl_add_u32 v9, v16, 11, v17
    v_add_u32 v9, s38, v9
    s_lshl_b32 s50, s33, 5
    s_add_u32 s50, s50, 31
    s_sub_u32 s50, s50, s39
    v_bfe_u32 v17, v0, 4, 1
    v_lshl_add_u32 v16, v16, 1, v17
    s_lshl_b32 s37, s32, 2
    s_add_u32 s37, s37, 65536
    v_lshl_add_u32 v10, v16, 4, s37
    v_and_b32 v16, 31, v0
    v_lshrrev_b32 v12, 5, v0
    v_lshlrev_b32 v12, 30, v12
    v_lshl_add_u32 v12, v16, 2, v12
    v_lshlrev_b32 v16, 4, v16
    v_add_u32 v11, 65536, v16
    s_lshl_b32 s37, s87, 1
    s_lshr_b32 s38, s51, 1
    s_add_u32 s37, s37, s38
    s_lshl_b32 s37, s37, 7
    s_add_u32 s55, s37, 0x543fc00
    s_cmp_eq_u32 s32, 2
    s_cselect_b32 s55, s55, 0x5f00000
    v_add_u32 v60, 0, v56
    v_add_u32 v61, 0, v57
    v_add_u32 v62, 0, v58
    v_add_u32 v63, 0, v59
    s_waitcnt vmcnt(25)
    s_barrier
    ds_read_b64_tr_b16 a[0:1], v60 offset:0
    ds_read_b64_tr_b16 a[2:3], v60 offset:512
    ds_read_b64_tr_b16 a[4:5], v61 offset:0
    ds_read_b64_tr_b16 a[6:7], v61 offset:512
    ds_read_b64_tr_b16 a[8:9], v62 offset:0
    ds_read_b64_tr_b16 a[10:11], v62 offset:512
    ds_read_b64_tr_b16 a[12:13], v63 offset:0
    ds_read_b64_tr_b16 a[14:15], v63 offset:512
    ds_read_b64_tr_b16 a[16:17], v60 offset:4096
    ds_read_b64_tr_b16 a[18:19], v60 offset:4608
    ds_read_b64_tr_b16 a[20:21], v61 offset:4096
    ds_read_b64_tr_b16 a[22:23], v61 offset:4608
    ds_read_b64_tr_b16 a[24:25], v62 offset:4096
    ds_read_b64_tr_b16 a[26:27], v62 offset:4608
    ds_read_b64_tr_b16 a[28:29], v63 offset:4096
    ds_read_b64_tr_b16 a[30:31], v63 offset:4608
    s_add_u32 m0, s42, 131072
    s_nop 0
    buffer_load_dwordx4 v48, s[12:15], s54 offen lds
    s_add_u32 m0, s42, 132096
    s_nop 0
    buffer_load_dwordx4 v49, s[12:15], s54 offen lds
    s_add_u32 m0, s42, 139264
    s_nop 0
    buffer_load_dwordx4 v50, s[12:15], s54 offen lds
    s_add_u32 m0, s42, 140288
    s_nop 0
    buffer_load_dwordx4 v51, s[12:15], s54 offen lds
    s_add_u32 m0, s42, 147456
    s_nop 0
    buffer_load_dwordx4 v52, s[12:15], s54 offen lds
    s_add_u32 m0, s42, 148480
    s_nop 0
    buffer_load_dwordx4 v53, s[12:15], s54 offen lds
    s_add_u32 m0, s42, 155648
    s_nop 0
    buffer_load_dwordx4 v54, s[12:15], s54 offen lds
    s_add_u32 m0, s42, 156672
    s_nop 0
    buffer_load_dwordx4 v55, s[12:15], s54 offen lds
    s_add_u32 s54, s54, 131072
    s_waitcnt lgkmcnt(0)
    v_add_u32 v60, 32768, v56
    v_add_u32 v61, 32768, v57
    v_add_u32 v62, 32768, v58
    v_add_u32 v63, 32768, v59
    s_waitcnt vmcnt(25)
    s_barrier
    ds_read_b64_tr_b16 a[32:33], v60 offset:0
    ds_read_b64_tr_b16 a[34:35], v60 offset:512
    ds_read_b64_tr_b16 a[36:37], v61 offset:0
    ds_read_b64_tr_b16 a[38:39], v61 offset:512
    ds_read_b64_tr_b16 a[40:41], v62 offset:0
    ds_read_b64_tr_b16 a[42:43], v62 offset:512
    ds_read_b64_tr_b16 a[44:45], v63 offset:0
    ds_read_b64_tr_b16 a[46:47], v63 offset:512
    ds_read_b64_tr_b16 a[48:49], v60 offset:4096
    ds_read_b64_tr_b16 a[50:51], v60 offset:4608
    ds_read_b64_tr_b16 a[52:53], v61 offset:4096
    ds_read_b64_tr_b16 a[54:55], v61 offset:4608
    ds_read_b64_tr_b16 a[56:57], v62 offset:4096
    ds_read_b64_tr_b16 a[58:59], v62 offset:4608
    ds_read_b64_tr_b16 a[60:61], v63 offset:4096
    ds_read_b64_tr_b16 a[62:63], v63 offset:4608
    s_add_u32 m0, s42, 0
    s_nop 0
    buffer_load_dwordx4 v48, s[12:15], s54 offen lds
    s_add_u32 m0, s42, 1024
    s_nop 0
    buffer_load_dwordx4 v49, s[12:15], s54 offen lds
    s_add_u32 m0, s42, 8192
    s_nop 0
    buffer_load_dwordx4 v50, s[12:15], s54 offen lds
    s_add_u32 m0, s42, 9216
    s_nop 0
    buffer_load_dwordx4 v51, s[12:15], s54 offen lds
    s_add_u32 m0, s42, 16384
    s_nop 0
    buffer_load_dwordx4 v52, s[12:15], s54 offen lds
    s_add_u32 m0, s42, 17408
    s_nop 0
    buffer_load_dwordx4 v53, s[12:15], s54 offen lds
    s_add_u32 m0, s42, 24576
    s_nop 0
    buffer_load_dwordx4 v54, s[12:15], s54 offen lds
    s_add_u32 m0, s42, 25600
    s_nop 0
    buffer_load_dwordx4 v55, s[12:15], s54 offen lds
    s_add_u32 s54, s54, 131072
    s_waitcnt lgkmcnt(0)
    v_add_u32 v60, 65536, v56
    v_add_u32 v61, 65536, v57
    v_add_u32 v62, 65536, v58
    v_add_u32 v63, 65536, v59
    s_waitcnt vmcnt(25)
    s_barrier
    ds_read_b64_tr_b16 a[64:65], v60 offset:0
    ds_read_b64_tr_b16 a[66:67], v60 offset:512
    ds_read_b64_tr_b16 a[68:69], v61 offset:0
    ds_read_b64_tr_b16 a[70:71], v61 offset:512
    ds_read_b64_tr_b16 a[72:73], v62 offset:0
    ds_read_b64_tr_b16 a[74:75], v62 offset:512
    ds_read_b64_tr_b16 a[76:77], v63 offset:0
    ds_read_b64_tr_b16 a[78:79], v63 offset:512
    ds_read_b64_tr_b16 a[80:81], v60 offset:4096
    ds_read_b64_tr_b16 a[82:83], v60 offset:4608
    ds_read_b64_tr_b16 a[84:85], v61 offset:4096
    ds_read_b64_tr_b16 a[86:87], v61 offset:4608
    ds_read_b64_tr_b16 a[88:89], v62 offset:4096
    ds_read_b64_tr_b16 a[90:91], v62 offset:4608
    ds_read_b64_tr_b16 a[92:93], v63 offset:4096
    ds_read_b64_tr_b16 a[94:95], v63 offset:4608
    s_add_u32 m0, s42, 32768
    s_nop 0
    buffer_load_dwordx4 v48, s[12:15], s54 offen lds
    s_add_u32 m0, s42, 33792
    s_nop 0
    buffer_load_dwordx4 v49, s[12:15], s54 offen lds
    s_add_u32 m0, s42, 40960
    s_nop 0
    buffer_load_dwordx4 v50, s[12:15], s54 offen lds
    s_add_u32 m0, s42, 41984
    s_nop 0
    buffer_load_dwordx4 v51, s[12:15], s54 offen lds
    s_add_u32 m0, s42, 49152
    s_nop 0
    buffer_load_dwordx4 v52, s[12:15], s54 offen lds
    s_add_u32 m0, s42, 50176
    s_nop 0
    buffer_load_dwordx4 v53, s[12:15], s54 offen lds
    s_add_u32 m0, s42, 57344
    s_nop 0
    buffer_load_dwordx4 v54, s[12:15], s54 offen lds
    s_add_u32 m0, s42, 58368
    s_nop 0
    buffer_load_dwordx4 v55, s[12:15], s54 offen lds
    s_add_u32 s54, s54, 131072
    s_waitcnt lgkmcnt(0)
    v_add_u32 v60, 98304, v56
    v_add_u32 v61, 98304, v57
    v_add_u32 v62, 98304, v58
    v_add_u32 v63, 98304, v59
    s_waitcnt vmcnt(25)
    s_barrier
    ds_read_b64_tr_b16 a[96:97], v60 offset:0
    ds_read_b64_tr_b16 a[98:99], v60 offset:512
    ds_read_b64_tr_b16 a[100:101], v61 offset:0
    ds_read_b64_tr_b16 a[102:103], v61 offset:512
    ds_read_b64_tr_b16 a[104:105], v62 offset:0
    ds_read_b64_tr_b16 a[106:107], v62 offset:512
    ds_read_b64_tr_b16 a[108:109], v63 offset:0
    ds_read_b64_tr_b16 a[110:111], v63 offset:512
    ds_read_b64_tr_b16 a[112:113], v60 offset:4096
    ds_read_b64_tr_b16 a[114:115], v60 offset:4608
    ds_read_b64_tr_b16 a[116:117], v61 offset:4096
    ds_read_b64_tr_b16 a[118:119], v61 offset:4608
    ds_read_b64_tr_b16 a[120:121], v62 offset:4096
    ds_read_b64_tr_b16 a[122:123], v62 offset:4608
    ds_read_b64_tr_b16 a[124:125], v63 offset:4096
    ds_read_b64_tr_b16 a[126:127], v63 offset:4608
    s_add_u32 m0, s42, 65536
    s_nop 0
    buffer_load_dwordx4 v48, s[12:15], s54 offen lds
    s_add_u32 m0, s42, 66560
    s_nop 0
    buffer_load_dwordx4 v49, s[12:15], s54 offen lds
    s_add_u32 m0, s42, 73728
    s_nop 0
    buffer_load_dwordx4 v50, s[12:15], s54 offen lds
    s_add_u32 m0, s42, 74752
    s_nop 0
    buffer_load_dwordx4 v51, s[12:15], s54 offen lds
    s_add_u32 m0, s42, 81920
    s_nop 0
    buffer_load_dwordx4 v52, s[12:15], s54 offen lds
    s_add_u32 m0, s42, 82944
    s_nop 0
    buffer_load_dwordx4 v53, s[12:15], s54 offen lds
    s_add_u32 m0, s42, 90112
    s_nop 0
    buffer_load_dwordx4 v54, s[12:15], s54 offen lds
    s_add_u32 m0, s42, 91136
    s_nop 0
    buffer_load_dwordx4 v55, s[12:15], s54 offen lds
    s_add_u32 s54, s54, 131072
    s_waitcnt lgkmcnt(0)
    v_add_u32 v60, 131072, v56
    v_add_u32 v61, 131072, v57
    v_add_u32 v62, 131072, v58
    v_add_u32 v63, 131072, v59
    s_waitcnt vmcnt(24)
    s_barrier
    ds_read_b64_tr_b16 a[128:129], v60 offset:0
    ds_read_b64_tr_b16 a[130:131], v60 offset:512
    ds_read_b64_tr_b16 a[132:133], v61 offset:0
    ds_read_b64_tr_b16 a[134:135], v61 offset:512
    ds_read_b64_tr_b16 a[136:137], v62 offset:0
    ds_read_b64_tr_b16 a[138:139], v62 offset:512
    ds_read_b64_tr_b16 a[140:141], v63 offset:0
    ds_read_b64_tr_b16 a[142:143], v63 offset:512
    ds_read_b64_tr_b16 a[144:145], v60 offset:4096
    ds_read_b64_tr_b16 a[146:147], v60 offset:4608
    ds_read_b64_tr_b16 a[148:149], v61 offset:4096
    ds_read_b64_tr_b16 a[150:151], v61 offset:4608
    ds_read_b64_tr_b16 a[152:153], v62 offset:4096
    ds_read_b64_tr_b16 a[154:155], v62 offset:4608
    ds_read_b64_tr_b16 a[156:157], v63 offset:4096
    ds_read_b64_tr_b16 a[158:159], v63 offset:4608
    s_add_u32 m0, s42, 98304
    s_nop 0
    buffer_load_dwordx4 v48, s[12:15], s54 offen lds
    s_add_u32 m0, s42, 99328
    s_nop 0
    buffer_load_dwordx4 v49, s[12:15], s54 offen lds
    s_add_u32 m0, s42, 106496
    s_nop 0
    buffer_load_dwordx4 v50, s[12:15], s54 offen lds
    s_add_u32 m0, s42, 107520
    s_nop 0
    buffer_load_dwordx4 v51, s[12:15], s54 offen lds
    s_add_u32 m0, s42, 114688
    s_nop 0
    buffer_load_dwordx4 v52, s[12:15], s54 offen lds
    s_add_u32 m0, s42, 115712
    s_nop 0
    buffer_load_dwordx4 v53, s[12:15], s54 offen lds
    s_add_u32 m0, s42, 122880
    s_nop 0
    buffer_load_dwordx4 v54, s[12:15], s54 offen lds
    s_add_u32 m0, s42, 123904
    s_nop 0
    buffer_load_dwordx4 v55, s[12:15], s54 offen lds
    s_add_u32 s54, s54, 131072
    s_waitcnt lgkmcnt(0)
    v_add_u32 v60, 0, v56
    v_add_u32 v61, 0, v57
    v_add_u32 v62, 0, v58
    v_add_u32 v63, 0, v59
    s_waitcnt vmcnt(24)
    s_barrier
    ds_read_b64_tr_b16 a[160:161], v60 offset:0
    ds_read_b64_tr_b16 a[162:163], v60 offset:512
    ds_read_b64_tr_b16 a[164:165], v61 offset:0
    ds_read_b64_tr_b16 a[166:167], v61 offset:512
    ds_read_b64_tr_b16 a[168:169], v62 offset:0
    ds_read_b64_tr_b16 a[170:171], v62 offset:512
    ds_read_b64_tr_b16 a[172:173], v63 offset:0
    ds_read_b64_tr_b16 a[174:175], v63 offset:512
    ds_read_b64_tr_b16 a[176:177], v60 offset:4096
    ds_read_b64_tr_b16 a[178:179], v60 offset:4608
    ds_read_b64_tr_b16 a[180:181], v61 offset:4096
    ds_read_b64_tr_b16 a[182:183], v61 offset:4608
    ds_read_b64_tr_b16 a[184:185], v62 offset:4096
    ds_read_b64_tr_b16 a[186:187], v62 offset:4608
    ds_read_b64_tr_b16 a[188:189], v63 offset:4096
    ds_read_b64_tr_b16 a[190:191], v63 offset:4608
    s_add_u32 m0, s42, 131072
    s_nop 0
    buffer_load_dwordx4 v48, s[12:15], s54 offen lds
    s_add_u32 m0, s42, 132096
    s_nop 0
    buffer_load_dwordx4 v49, s[12:15], s54 offen lds
    s_add_u32 m0, s42, 139264
    s_nop 0
    buffer_load_dwordx4 v50, s[12:15], s54 offen lds
    s_add_u32 m0, s42, 140288
    s_nop 0
    buffer_load_dwordx4 v51, s[12:15], s54 offen lds
    s_add_u32 m0, s42, 147456
    s_nop 0
    buffer_load_dwordx4 v52, s[12:15], s54 offen lds
    s_add_u32 m0, s42, 148480
    s_nop 0
    buffer_load_dwordx4 v53, s[12:15], s54 offen lds
    s_add_u32 m0, s42, 155648
    s_nop 0
    buffer_load_dwordx4 v54, s[12:15], s54 offen lds
    s_add_u32 m0, s42, 156672
    s_nop 0
    buffer_load_dwordx4 v55, s[12:15], s54 offen lds
    s_add_u32 s54, s54, 131072
    s_waitcnt lgkmcnt(0)
    v_add_u32 v60, 32768, v56
    v_add_u32 v61, 32768, v57
    v_add_u32 v62, 32768, v58
    v_add_u32 v63, 32768, v59
    s_waitcnt vmcnt(24)
    s_barrier
    ds_read_b64_tr_b16 a[192:193], v60 offset:0
    ds_read_b64_tr_b16 a[194:195], v60 offset:512
    ds_read_b64_tr_b16 a[196:197], v61 offset:0
    ds_read_b64_tr_b16 a[198:199], v61 offset:512
    ds_read_b64_tr_b16 a[200:201], v62 offset:0
    ds_read_b64_tr_b16 a[202:203], v62 offset:512
    ds_read_b64_tr_b16 a[204:205], v63 offset:0
    ds_read_b64_tr_b16 a[206:207], v63 offset:512
    ds_read_b64_tr_b16 a[208:209], v60 offset:4096
    ds_read_b64_tr_b16 a[210:211], v60 offset:4608
    ds_read_b64_tr_b16 a[212:213], v61 offset:4096
    ds_read_b64_tr_b16 a[214:215], v61 offset:4608
    ds_read_b64_tr_b16 a[216:217], v62 offset:4096
    ds_read_b64_tr_b16 a[218:219], v62 offset:4608
    ds_read_b64_tr_b16 a[220:221], v63 offset:4096
    ds_read_b64_tr_b16 a[222:223], v63 offset:4608
    s_add_u32 m0, s42, 0
    s_nop 0
    buffer_load_dwordx4 v48, s[12:15], s54 offen lds
    s_add_u32 m0, s42, 1024
    s_nop 0
    buffer_load_dwordx4 v49, s[12:15], s54 offen lds
    s_add_u32 m0, s42, 8192
    s_nop 0
    buffer_load_dwordx4 v50, s[12:15], s54 offen lds
    s_add_u32 m0, s42, 9216
    s_nop 0
    buffer_load_dwordx4 v51, s[12:15], s54 offen lds
    s_add_u32 m0, s42, 16384
    s_nop 0
    buffer_load_dwordx4 v52, s[12:15], s54 offen lds
    s_add_u32 m0, s42, 17408
    s_nop 0
    buffer_load_dwordx4 v53, s[12:15], s54 offen lds
    s_add_u32 m0, s42, 24576
    s_nop 0
    buffer_load_dwordx4 v54, s[12:15], s54 offen lds
    s_add_u32 m0, s42, 25600
    s_nop 0
    buffer_load_dwordx4 v55, s[12:15], s54 offen lds
    s_add_u32 s54, s54, 131072
    s_waitcnt lgkmcnt(0)
    v_add_u32 v60, 65536, v56
    v_add_u32 v61, 65536, v57
    v_add_u32 v62, 65536, v58
    v_add_u32 v63, 65536, v59
    s_waitcnt vmcnt(24)
    s_barrier
    ds_read_b64_tr_b16 a[224:225], v60 offset:0
    ds_read_b64_tr_b16 a[226:227], v60 offset:512
    ds_read_b64_tr_b16 a[228:229], v61 offset:0
    ds_read_b64_tr_b16 a[230:231], v61 offset:512
    ds_read_b64_tr_b16 a[232:233], v62 offset:0
    ds_read_b64_tr_b16 a[234:235], v62 offset:512
    ds_read_b64_tr_b16 a[236:237], v63 offset:0
    ds_read_b64_tr_b16 a[238:239], v63 offset:512
    ds_read_b64_tr_b16 a[240:241], v60 offset:4096
    ds_read_b64_tr_b16 a[242:243], v60 offset:4608
    ds_read_b64_tr_b16 a[244:245], v61 offset:4096
    ds_read_b64_tr_b16 a[246:247], v61 offset:4608
    ds_read_b64_tr_b16 a[248:249], v62 offset:4096
    ds_read_b64_tr_b16 a[250:251], v62 offset:4608
    ds_read_b64_tr_b16 a[252:253], v63 offset:4096
    ds_read_b64_tr_b16 a[254:255], v63 offset:4608
    s_waitcnt lgkmcnt(0)
    v_add_u32 v60, 98304, v56
    v_add_u32 v61, 98304, v57
    v_add_u32 v62, 98304, v58
    v_add_u32 v63, 98304, v59
    s_waitcnt vmcnt(16)
    s_barrier
    ds_read_b64_tr_b16 v[160:161], v60 offset:0
    ds_read_b64_tr_b16 v[162:163], v60 offset:512
    ds_read_b64_tr_b16 v[164:165], v61 offset:0
    ds_read_b64_tr_b16 v[166:167], v61 offset:512
    ds_read_b64_tr_b16 v[168:169], v62 offset:0
    ds_read_b64_tr_b16 v[170:171], v62 offset:512
    ds_read_b64_tr_b16 v[172:173], v63 offset:0
    ds_read_b64_tr_b16 v[174:175], v63 offset:512
    ds_read_b64_tr_b16 v[176:177], v60 offset:4096
    ds_read_b64_tr_b16 v[178:179], v60 offset:4608
    ds_read_b64_tr_b16 v[180:181], v61 offset:4096
    ds_read_b64_tr_b16 v[182:183], v61 offset:4608
    ds_read_b64_tr_b16 v[184:185], v62 offset:4096
    ds_read_b64_tr_b16 v[186:187], v62 offset:4608
    ds_read_b64_tr_b16 v[188:189], v63 offset:4096
    ds_read_b64_tr_b16 v[190:191], v63 offset:4608
    s_waitcnt lgkmcnt(0)
    v_add_u32 v60, 131072, v56
    v_add_u32 v61, 131072, v57
    v_add_u32 v62, 131072, v58
    v_add_u32 v63, 131072, v59
    s_waitcnt vmcnt(8)
    s_barrier
    ds_read_b64_tr_b16 v[192:193], v60 offset:0
    ds_read_b64_tr_b16 v[194:195], v60 offset:512
    ds_read_b64_tr_b16 v[196:197], v61 offset:0
    ds_read_b64_tr_b16 v[198:199], v61 offset:512
    ds_read_b64_tr_b16 v[200:201], v62 offset:0
    ds_read_b64_tr_b16 v[202:203], v62 offset:512
    ds_read_b64_tr_b16 v[204:205], v63 offset:0
    ds_read_b64_tr_b16 v[206:207], v63 offset:512
    ds_read_b64_tr_b16 v[208:209], v60 offset:4096
    ds_read_b64_tr_b16 v[210:211], v60 offset:4608
    ds_read_b64_tr_b16 v[212:213], v61 offset:4096
    ds_read_b64_tr_b16 v[214:215], v61 offset:4608
    ds_read_b64_tr_b16 v[216:217], v62 offset:4096
    ds_read_b64_tr_b16 v[218:219], v62 offset:4608
    ds_read_b64_tr_b16 v[220:221], v63 offset:4096
    ds_read_b64_tr_b16 v[222:223], v63 offset:4608
    s_waitcnt lgkmcnt(0)
    v_add_u32 v60, 0, v56
    v_add_u32 v61, 0, v57
    v_add_u32 v62, 0, v58
    v_add_u32 v63, 0, v59
    s_waitcnt vmcnt(0)
    s_barrier
    ds_read_b64_tr_b16 v[224:225], v60 offset:0
    ds_read_b64_tr_b16 v[226:227], v60 offset:512
    ds_read_b64_tr_b16 v[228:229], v61 offset:0
    ds_read_b64_tr_b16 v[230:231], v61 offset:512
    ds_read_b64_tr_b16 v[232:233], v62 offset:0
    ds_read_b64_tr_b16 v[234:235], v62 offset:512
    ds_read_b64_tr_b16 v[236:237], v63 offset:0
    ds_read_b64_tr_b16 v[238:239], v63 offset:512
    ds_read_b64_tr_b16 v[240:241], v60 offset:4096
    ds_read_b64_tr_b16 v[242:243], v60 offset:4608
    ds_read_b64_tr_b16 v[244:245], v61 offset:4096
    ds_read_b64_tr_b16 v[246:247], v61 offset:4608
    ds_read_b64_tr_b16 v[248:249], v62 offset:4096
    ds_read_b64_tr_b16 v[250:251], v62 offset:4608
    ds_read_b64_tr_b16 v[252:253], v63 offset:4096
    ds_read_b64_tr_b16 v[254:255], v63 offset:4608
    s_waitcnt lgkmcnt(0)
    s_barrier
    s_mov_b32 s37, 0xffff0000
    v_lshlrev_b32 v112, 16, v24
    v_and_b32 v113, s37, v24
    v_lshlrev_b32 v114, 16, v25
    v_and_b32 v115, s37, v25
    v_lshlrev_b32 v116, 16, v26
    v_and_b32 v117, s37, v26
    v_lshlrev_b32 v118, 16, v27
    v_and_b32 v119, s37, v27
    s_cmp_lg_u32 s32, 0
    s_cbranch_scc1 L_arv53
    s_add_u32 s20, s82, 0x80
    s_addc_u32 s21, s83, 0
    s_mov_b32 s22, 0x4
    s_mov_b32 s23, 0x00020000
    buffer_load_dword v80, v124, s[20:23], 0 offen sc1
    s_waitcnt vmcnt(0)
    v_cmp_eq_u32 vcc, v124, v80
    s_cbranch_vccnz L_spin54
L_back55:
L_arv53:
    s_add_u32 s96, s41, 8126464
    s_mov_b32 s98, s41
    s_mov_b32 s45, 0x5530000
    buffer_load_dword v96, v6, s[16:19], s45 offen sc1
    s_waitcnt vmcnt(0)
    v_cmp_ne_u32 vcc, 0, v96
    s_cbranch_vccnz L_spin56
L_back57:
    s_barrier
    s_add_u32 m0, s43, 0
    s_add_u32 s42, s41, 0
    buffer_load_dwordx4 v1, s[16:19], s42 offen offset:0 sc1 lds
    buffer_load_dwordx4 v1, s[16:19], s42 offen offset:1024 sc1 lds
    buffer_load_dwordx4 v1, s[16:19], s42 offen offset:2048 sc1 lds
    s_add_u32 m0, s43, 12288
    s_add_u32 s42, s41, 12288
    buffer_load_dwordx4 v1, s[16:19], s42 offen offset:0 sc1 lds
    buffer_load_dwordx4 v1, s[16:19], s42 offen offset:1024 sc1 lds
    buffer_load_dwordx4 v1, s[16:19], s42 offen offset:2048 sc1 lds
    s_add_u32 m0, s43, 24576
    s_add_u32 s42, s41, 24576
    buffer_load_dwordx4 v1, s[16:19], s42 offen offset:0 sc1 lds
    buffer_load_dwordx4 v1, s[16:19], s42 offen offset:1024 sc1 lds
    buffer_load_dwordx4 v1, s[16:19], s42 offen offset:2048 sc1 lds
    s_add_u32 s45, s45, 65536
    s_waitcnt vmcnt(0) lgkmcnt(0)
    s_barrier
    s_mov_b32 s52, 0x5e00000
    s_mov_b32 s46, 0x5e00000
    s_add_u32 s20, s84, 0x5e00000
    s_addc_u32 s21, s85, 0
    s_mov_b32 s22, 0x400000
    s_mov_b32 s23, 0x00020000
    ds_read_b128 v[80:83], v2 offset:0
    ds_read_b128 v[84:87], v3 offset:0
    s_mov_b32 s36, 0
    s_waitcnt lgkmcnt(0)
    s_nop 7
L_bf_b0:
    v_mfma_f32_16x16x32_bf16 v[16:19], a[0:3], v[80:83], v[112:115]
    s_sub_u32 s47, s45, 196608
    ds_read_b128 v[88:91], v2 offset:2048
    s_max_u32 s47, s47, 0x5500000
    v_mfma_f32_16x16x32_bf16 v[24:27], a[0:3], v[84:87], 0
    buffer_load_dword v13, v8, s[16:19], s47 offen sc1
    v_mfma_f32_16x16x32_bf16 v[28:31], a[4:7], v[84:87], 0
    s_and_b32 s38, s53, 0xffffffff
    ds_read_b128 v[92:95], v3 offset:2048
    s_cmp_lt_i32 s36, 1
    v_mfma_f32_16x16x32_bf16 v[20:23], a[4:7], v[80:83], v[116:119]
    s_cselect_b32 s38, 0x5e00000, s38
    v_mfma_f32_16x16x32_bf16 v[32:35], a[8:11], v[80:83], 0
    buffer_load_dwordx4 v[136:139], v1, s[16:19], s38 offen sc1
    v_mfma_f32_16x16x32_bf16 v[40:43], a[8:11], v[84:87], 0
    s_add_u32 s53, s53, 65536
    ds_read_b128 v[144:147], v11 offset:0
    s_and_b32 s44, s90, 0xffffffff
    v_mfma_f32_16x16x32_bf16 v[44:47], a[12:15], v[84:87], 0
    s_cmp_lt_i32 s36, 1
    s_cselect_b32 s44, 0x5e00000, s44
    s_xor_b32 s49, s44, 16384
    v_mfma_f32_16x16x32_bf16 v[36:39], a[12:15], v[80:83], 0
    s_waitcnt lgkmcnt(1)
    v_cvt_pk_bf16_f32 v56, v56, v57
    v_cvt_pk_bf16_f32 v57, v58, v59
    v_mfma_f32_16x16x32_bf16 v[16:19], a[16:19], v[88:91], v[16:19]
    ds_read_b128 v[80:83], v2 offset:4096
    v_cvt_pk_bf16_f32 v58, v60, v61
    v_mfma_f32_16x16x32_bf16 v[24:27], a[16:19], v[92:95], v[24:27]
    v_cvt_pk_bf16_f32 v59, v62, v63
    v_mfma_f32_16x16x32_bf16 v[28:31], a[20:23], v[92:95], v[28:31]
    s_waitcnt lgkmcnt(1)
    ds_read_b128 v[84:87], v3 offset:4096
    v_add_f32 v144, v144, v145
    v_mfma_f32_16x16x32_bf16 v[20:23], a[20:23], v[88:91], v[20:23]
    buffer_store_dwordx4 v[56:59], v1, s[16:19], s49 offen offset:0 sc1
    v_mfma_f32_16x16x32_bf16 v[32:35], a[24:27], v[88:91], v[32:35]
    s_xor_b32 s49, s44, 32768
    v_cvt_pk_bf16_f32 v64, v64, v65
    v_cvt_pk_bf16_f32 v65, v66, v67
    v_mfma_f32_16x16x32_bf16 v[40:43], a[24:27], v[92:95], v[40:43]
    v_cvt_pk_bf16_f32 v66, v68, v69
    v_cvt_pk_bf16_f32 v67, v70, v71
    v_mfma_f32_16x16x32_bf16 v[44:47], a[28:31], v[92:95], v[44:47]
    buffer_store_dwordx4 v[64:67], v1, s[16:19], s49 offen offset:1024 sc1
    v_mfma_f32_16x16x32_bf16 v[36:39], a[28:31], v[88:91], v[36:39]
    s_waitcnt lgkmcnt(0)
    v_add_f32 v146, v146, v147
    v_add_f32 v144, v144, v146
    v_mfma_f32_16x16x32_bf16 v[16:19], a[32:35], v[80:83], v[16:19]
    s_xor_b32 s49, s44, 49152
    ds_read_b128 v[88:91], v2 offset:6144
    v_cvt_pk_bf16_f32 v72, v72, v73
    v_mfma_f32_16x16x32_bf16 v[24:27], a[32:35], v[84:87], v[24:27]
    s_add_u32 m0, s88, 36864
    v_cvt_pk_bf16_f32 v73, v74, v75
    v_cvt_pk_bf16_f32 v74, v76, v77
    v_mfma_f32_16x16x32_bf16 v[28:31], a[36:39], v[84:87], v[28:31]
    s_add_u32 s42, s41, 36864
    ds_read_b128 v[92:95], v3 offset:6144
    v_cvt_pk_bf16_f32 v75, v78, v79
    v_mfma_f32_16x16x32_bf16 v[20:23], a[36:39], v[80:83], v[20:23]
    buffer_store_dwordx4 v[72:75], v1, s[16:19], s49 offen offset:2048 sc1
    v_mfma_f32_16x16x32_bf16 v[32:35], a[40:43], v[80:83], v[32:35]
    s_add_u32 s42, s42, s89
    s_add_u32 s90, s90, 262144
    v_mfma_f32_16x16x32_bf16 v[40:43], a[40:43], v[84:87], v[40:43]
    v_mfma_f32_16x16x32_bf16 v[44:47], a[44:47], v[84:87], v[44:47]
    buffer_load_dwordx4 v1, s[16:19], s42 offen offset:0 sc1 lds
    v_mfma_f32_16x16x32_bf16 v[36:39], a[44:47], v[80:83], v[36:39]
    s_waitcnt lgkmcnt(0)
    v_mfma_f32_16x16x32_bf16 v[16:19], a[48:51], v[88:91], v[16:19]
    ds_read_b128 v[80:83], v2 offset:8192
    v_mfma_f32_16x16x32_bf16 v[24:27], a[48:51], v[92:95], v[24:27]
    buffer_store_dword v144, v12, s[16:19], s46 offen sc1
    v_mfma_f32_16x16x32_bf16 v[28:31], a[52:55], v[92:95], v[28:31]
    ds_read_b128 v[84:87], v3 offset:8192
    v_mfma_f32_16x16x32_bf16 v[20:23], a[52:55], v[88:91], v[20:23]
    v_mfma_f32_16x16x32_bf16 v[32:35], a[56:59], v[88:91], v[32:35]
    buffer_load_dwordx4 v1, s[16:19], s42 offen offset:1024 sc1 lds
    v_mfma_f32_16x16x32_bf16 v[40:43], a[56:59], v[92:95], v[40:43]
    s_add_u32 s98, s98, 262144
    s_min_i32 s98, s98, s96
    s_and_b32 s41, s98, 0xffffffff
    v_mfma_f32_16x16x32_bf16 v[44:47], a[60:63], v[92:95], v[44:47]
    v_mfma_f32_16x16x32_bf16 v[36:39], a[60:63], v[88:91], v[36:39]
    s_waitcnt lgkmcnt(0)
    v_mfma_f32_16x16x32_bf16 v[16:19], a[64:67], v[80:83], v[16:19]
    ds_read_b128 v[88:91], v2 offset:10240
    v_mfma_f32_16x16x32_bf16 v[24:27], a[64:67], v[84:87], v[24:27]
    v_mfma_f32_16x16x32_bf16 v[28:31], a[68:71], v[84:87], v[28:31]
    ds_read_b128 v[92:95], v3 offset:10240
    v_mfma_f32_16x16x32_bf16 v[20:23], a[68:71], v[80:83], v[20:23]
    s_waitcnt vmcnt(7)
    v_cmp_ne_u32 vcc, 0, v13
    v_mfma_f32_16x16x32_bf16 v[32:35], a[72:75], v[80:83], v[32:35]
    v_mfma_f32_16x16x32_bf16 v[40:43], a[72:75], v[84:87], v[40:43]
    s_cbranch_vccnz L_spin58
L_back59:
    v_mfma_f32_16x16x32_bf16 v[44:47], a[76:79], v[84:87], v[44:47]
    v_mfma_f32_16x16x32_bf16 v[36:39], a[76:79], v[80:83], v[36:39]
    s_waitcnt vmcnt(8) lgkmcnt(0)
    s_barrier
    v_mfma_f32_16x16x32_bf16 v[16:19], a[80:83], v[88:91], v[16:19]
    s_sub_u32 s48, s90, 524288
    ds_read_b128 v[80:83], v2 offset:12288
    s_and_b32 s48, s48, 0xffffffff
    v_mfma_f32_16x16x32_bf16 v[24:27], a[80:83], v[92:95], v[24:27]
    s_cmp_lt_i32 s36, 2
    s_cselect_b32 s48, s52, s48
    v_mfma_f32_16x16x32_bf16 v[28:31], a[84:87], v[92:95], v[28:31]
    ds_read_b128 v[84:87], v3 offset:12288
    v_mfma_f32_16x16x32_bf16 v[20:23], a[84:87], v[88:91], v[20:23]
    buffer_load_dwordx4 v[140:143], v1, s[16:19], s48 offen offset:0 sc1
    v_mfma_f32_16x16x32_bf16 v[32:35], a[88:91], v[88:91], v[32:35]
    v_mfma_f32_16x16x32_bf16 v[40:43], a[88:91], v[92:95], v[40:43]
    v_mfma_f32_16x16x32_bf16 v[44:47], a[92:95], v[92:95], v[44:47]
    buffer_load_dwordx4 v[144:147], v1, s[16:19], s48 offen offset:1024 sc1
    v_mfma_f32_16x16x32_bf16 v[36:39], a[92:95], v[88:91], v[36:39]
    s_waitcnt lgkmcnt(0)
    v_mfma_f32_16x16x32_bf16 v[16:19], a[96:99], v[80:83], v[16:19]
    ds_read_b128 v[88:91], v2 offset:14336
    v_mfma_f32_16x16x32_bf16 v[24:27], a[96:99], v[84:87], v[24:27]
    buffer_load_dwordx4 v[148:151], v1, s[16:19], s48 offen offset:2048 sc1
    v_mfma_f32_16x16x32_bf16 v[28:31], a[100:103], v[84:87], v[28:31]
    ds_read_b128 v[92:95], v3 offset:14336
    v_mfma_f32_16x16x32_bf16 v[20:23], a[100:103], v[80:83], v[20:23]
    v_mfma_f32_16x16x32_bf16 v[32:35], a[104:107], v[80:83], v[32:35]
    buffer_load_dwordx4 v[152:155], v1, s[16:19], s48 offen offset:3072 sc1
    v_mfma_f32_16x16x32_bf16 v[40:43], a[104:107], v[84:87], v[40:43]
    s_sub_u32 s47, s36, 2
    s_cmp_lt_u32 s47, 16
    s_cselect_b32 s48, 0x5000000, s52
    v_mfma_f32_16x16x32_bf16 v[44:47], a[108:111], v[84:87], v[44:47]
    s_add_u32 s20, s84, s48
    s_addc_u32 s21, s85, 0
    s_cmp_ge_i32 s47, 16
    v_mfma_f32_16x16x32_bf16 v[36:39], a[108:111], v[80:83], v[36:39]
    s_waitcnt lgkmcnt(0)
    s_cselect_b32 s20, s80, s20
    s_cselect_b32 s21, s81, s21
    v_mfma_f32_16x16x32_bf16 v[16:19], a[112:115], v[88:91], v[16:19]
    s_and_b32 s48, s47, 15
    ds_read_b128 v[80:83], v2 offset:16384
    s_lshl_b32 s48, s48, 1
    v_mfma_f32_16x16x32_bf16 v[24:27], a[112:115], v[92:95], v[24:27]
    s_sub_u32 s48, s50, s48
    s_lshl_b32 s46, s48, 10
    s_sub_u32 s46, s55, s46
    v_mfma_f32_16x16x32_bf16 v[28:31], a[116:119], v[92:95], v[28:31]
    s_cmp_lt_u32 s47, 16
    ds_read_b128 v[84:87], v3 offset:16384
    s_cselect_b32 s46, s46, s52
    v_mfma_f32_16x16x32_bf16 v[20:23], a[116:119], v[88:91], v[20:23]
    buffer_load_dword v96, v6, s[16:19], s45 offen sc1
    v_mfma_f32_16x16x32_bf16 v[32:35], a[120:123], v[88:91], v[32:35]
    s_add_u32 m0, s43, 98304
    s_add_u32 s42, s41, 0
    s_lshl_b32 s48, s48, 15
    v_mfma_f32_16x16x32_bf16 v[40:43], a[120:123], v[92:95], v[40:43]
    v_mfma_f32_16x16x32_bf16 v[44:47], a[124:127], v[92:95], v[44:47]
    v_mfma_f32_16x16x32_bf16 v[36:39], a[124:127], v[88:91], v[36:39]
    s_waitcnt lgkmcnt(0)
    v_mfma_f32_16x16x32_bf16 v[16:19], a[128:131], v[80:83], v[16:19]
    ds_read_b128 v[88:91], v2 offset:18432
    v_mfma_f32_16x16x32_bf16 v[24:27], a[128:131], v[84:87], v[24:27]
    v_mfma_f32_16x16x32_bf16 v[28:31], a[132:135], v[84:87], v[28:31]
    ds_read_b128 v[92:95], v3 offset:18432
    v_mfma_f32_16x16x32_bf16 v[20:23], a[132:135], v[80:83], v[20:23]
    v_mfma_f32_16x16x32_bf16 v[32:35], a[136:139], v[80:83], v[32:35]
    v_mfma_f32_16x16x32_bf16 v[40:43], a[136:139], v[84:87], v[40:43]
    v_mfma_f32_16x16x32_bf16 v[44:47], a[140:143], v[84:87], v[44:47]
    v_mfma_f32_16x16x32_bf16 v[36:39], a[140:143], v[80:83], v[36:39]
    s_waitcnt lgkmcnt(0)
    v_mfma_f32_16x16x32_bf16 v[16:19], a[144:147], v[88:91], v[16:19]
    ds_read_b128 v[80:83], v2 offset:20480
    v_mfma_f32_16x16x32_bf16 v[24:27], a[144:147], v[92:95], v[24:27]
    v_mfma_f32_16x16x32_bf16 v[28:31], a[148:151], v[92:95], v[28:31]
    ds_read_b128 v[84:87], v3 offset:20480
    v_mfma_f32_16x16x32_bf16 v[20:23], a[148:151], v[88:91], v[20:23]
    v_mfma_f32_16x16x32_bf16 v[32:35], a[152:155], v[88:91], v[32:35]
    v_mfma_f32_16x16x32_bf16 v[40:43], a[152:155], v[92:95], v[40:43]
    v_mfma_f32_16x16x32_bf16 v[44:47], a[156:159], v[92:95], v[44:47]
    v_mfma_f32_16x16x32_bf16 v[36:39], a[156:159], v[88:91], v[36:39]
    s_waitcnt lgkmcnt(0)
    v_mfma_f32_16x16x32_bf16 v[16:19], a[160:163], v[80:83], v[16:19]
    ds_read_b128 v[88:91], v2 offset:22528
    v_mfma_f32_16x16x32_bf16 v[24:27], a[160:163], v[84:87], v[24:27]
    v_mfma_f32_16x16x32_bf16 v[28:31], a[164:167], v[84:87], v[28:31]
    ds_read_b128 v[92:95], v3 offset:22528
    v_mfma_f32_16x16x32_bf16 v[20:23], a[164:167], v[80:83], v[20:23]
    v_mfma_f32_16x16x32_bf16 v[32:35], a[168:171], v[80:83], v[32:35]
    v_mfma_f32_16x16x32_bf16 v[40:43], a[168:171], v[84:87], v[40:43]
    v_mfma_f32_16x16x32_bf16 v[44:47], a[172:175], v[84:87], v[44:47]
    v_mfma_f32_16x16x32_bf16 v[36:39], a[172:175], v[80:83], v[36:39]
    s_waitcnt lgkmcnt(0)
    v_mfma_f32_16x16x32_bf16 v[16:19], a[176:179], v[88:91], v[16:19]
    ds_read_b128 v[80:83], v2 offset:24576
    v_mfma_f32_16x16x32_bf16 v[24:27], a[176:179], v[92:95], v[24:27]
    v_mfma_f32_16x16x32_bf16 v[28:31], a[180:183], v[92:95], v[28:31]
    ds_read_b128 v[84:87], v3 offset:24576
    v_mfma_f32_16x16x32_bf16 v[20:23], a[180:183], v[88:91], v[20:23]
    v_mfma_f32_16x16x32_bf16 v[32:35], a[184:187], v[88:91], v[32:35]
    v_mfma_f32_16x16x32_bf16 v[40:43], a[184:187], v[92:95], v[40:43]
    v_mfma_f32_16x16x32_bf16 v[44:47], a[188:191], v[92:95], v[44:47]
    v_mfma_f32_16x16x32_bf16 v[36:39], a[188:191], v[88:91], v[36:39]
    s_waitcnt lgkmcnt(0)
    v_mfma_f32_16x16x32_bf16 v[16:19], a[192:195], v[80:83], v[16:19]
    ds_read_b128 v[88:91], v2 offset:26624
    v_mfma_f32_16x16x32_bf16 v[24:27], a[192:195], v[84:87], v[24:27]
    v_mfma_f32_16x16x32_bf16 v[28:31], a[196:199], v[84:87], v[28:31]
    ds_read_b128 v[92:95], v3 offset:26624
    v_mfma_f32_16x16x32_bf16 v[20:23], a[196:199], v[80:83], v[20:23]
    v_mfma_f32_16x16x32_bf16 v[32:35], a[200:203], v[80:83], v[32:35]
    v_mfma_f32_16x16x32_bf16 v[40:43], a[200:203], v[84:87], v[40:43]
    v_mfma_f32_16x16x32_bf16 v[44:47], a[204:207], v[84:87], v[44:47]
    v_mfma_f32_16x16x32_bf16 v[36:39], a[204:207], v[80:83], v[36:39]
    s_waitcnt lgkmcnt(0)
    v_mfma_f32_16x16x32_bf16 v[16:19], a[208:211], v[88:91], v[16:19]
    s_waitcnt vmcnt(0)
    ds_read_b128 v[80:83], v2 offset:28672
    v_cmp_ne_u32 vcc, 0, v96
    v_mfma_f32_16x16x32_bf16 v[24:27], a[208:211], v[92:95], v[24:27]
    v_mfma_f32_16x16x32_bf16 v[28:31], a[212:215], v[92:95], v[28:31]
    s_cbranch_vccnz L_spin60
L_back61:
    ds_read_b128 v[84:87], v3 offset:28672
    s_barrier
    v_mfma_f32_16x16x32_bf16 v[20:23], a[212:215], v[88:91], v[20:23]
    buffer_load_dwordx4 v1, s[16:19], s42 offen offset:0 sc1 lds
    v_mfma_f32_16x16x32_bf16 v[32:35], a[216:219], v[88:91], v[32:35]
    v_mfma_f32_16x16x32_bf16 v[40:43], a[216:219], v[92:95], v[40:43]
    v_mfma_f32_16x16x32_bf16 v[44:47], a[220:223], v[92:95], v[44:47]
    buffer_load_dwordx4 v1, s[16:19], s42 offen offset:1024 sc1 lds
    v_mfma_f32_16x16x32_bf16 v[36:39], a[220:223], v[88:91], v[36:39]
    s_waitcnt lgkmcnt(0)
    v_mfma_f32_16x16x32_bf16 v[16:19], a[224:227], v[80:83], v[16:19]
    ds_read_b128 v[88:91], v2 offset:30720
    v_mfma_f32_16x16x32_bf16 v[24:27], a[224:227], v[84:87], v[24:27]
    buffer_load_dwordx4 v1, s[16:19], s42 offen offset:2048 sc1 lds
    v_mfma_f32_16x16x32_bf16 v[28:31], a[228:231], v[84:87], v[28:31]
    ds_read_b128 v[92:95], v3 offset:30720
    v_mfma_f32_16x16x32_bf16 v[20:23], a[228:231], v[80:83], v[20:23]
    v_mfma_f32_16x16x32_bf16 v[32:35], a[232:235], v[80:83], v[32:35]
    buffer_store_dword v124, v124, s[16:19], s91 offen sc1
    v_mfma_f32_16x16x32_bf16 v[40:43], a[232:235], v[84:87], v[40:43]
    s_add_u32 s91, s91, 65536
    s_add_u32 s39, s91, -163840
    s_add_u32 m0, s43, 110592
    v_mfma_f32_16x16x32_bf16 v[44:47], a[236:239], v[84:87], v[44:47]
    s_add_u32 s42, s41, 12288
    s_waitcnt vmcnt(5)
    v_mfma_f32_16x16x32_bf16 v[128:131], v[104:107], v[140:143], v[128:131]
    v_mfma_f32_16x16x32_bf16 v[132:135], v[108:111], v[140:143], v[132:135]
    v_mfma_f32_16x16x32_bf16 v[128:131], v[104:107], v[144:147], v[128:131]
    v_mfma_f32_16x16x32_bf16 v[132:135], v[108:111], v[144:147], v[132:135]
    v_mfma_f32_16x16x32_bf16 v[128:131], v[104:107], v[148:151], v[128:131]
    v_mfma_f32_16x16x32_bf16 v[132:135], v[108:111], v[148:151], v[132:135]
    v_mfma_f32_16x16x32_bf16 v[128:131], v[104:107], v[152:155], v[128:131]
    v_mfma_f32_16x16x32_bf16 v[132:135], v[108:111], v[152:155], v[132:135]
    v_mfma_f32_16x16x32_bf16 v[36:39], a[236:239], v[80:83], v[36:39]
    s_waitcnt lgkmcnt(0)
    v_mfma_f32_16x16x32_bf16 v[16:19], a[240:243], v[88:91], v[16:19]
    ds_read_b128 v[80:83], v2 offset:32768
    v_cvt_pk_bf16_f32 v140, v128, v129
    v_mfma_f32_16x16x32_bf16 v[24:27], a[240:243], v[92:95], v[24:27]
    buffer_store_dword v124, v124, s[16:19], s39 offen sc1
    v_mfma_f32_16x16x32_bf16 v[28:31], a[244:247], v[92:95], v[28:31]
    ds_read_b128 v[84:87], v3 offset:32768
    v_cvt_pk_bf16_f32 v141, v130, v131
    v_mfma_f32_16x16x32_bf16 v[20:23], a[244:247], v[88:91], v[20:23]
    v_cvt_pk_bf16_f32 v142, v132, v133
    v_cvt_pk_bf16_f32 v143, v134, v135
    v_mfma_f32_16x16x32_bf16 v[32:35], a[248:251], v[88:91], v[32:35]
    buffer_load_dwordx4 v1, s[16:19], s42 offen offset:0 sc1 lds
    v_mfma_f32_16x16x32_bf16 v[40:43], a[248:251], v[92:95], v[40:43]
    v_mfma_f32_16x16x32_bf16 v[44:47], a[252:255], v[92:95], v[44:47]
    v_mfma_f32_16x16x32_bf16 v[36:39], a[252:255], v[88:91], v[36:39]
    s_waitcnt lgkmcnt(0)
    v_mfma_f32_16x16x32_bf16 v[16:19], v[160:163], v[80:83], v[16:19]
    ds_read_b128 v[88:91], v2 offset:34816
    v_mfma_f32_16x16x32_bf16 v[24:27], v[160:163], v[84:87], v[24:27]
    buffer_load_dwordx4 v1, s[16:19], s42 offen offset:1024 sc1 lds
    v_mfma_f32_16x16x32_bf16 v[28:31], v[164:167], v[84:87], v[28:31]
    ds_read_b128 v[92:95], v3 offset:34816
    v_mfma_f32_16x16x32_bf16 v[20:23], v[164:167], v[80:83], v[20:23]
    v_mfma_f32_16x16x32_bf16 v[32:35], v[168:171], v[80:83], v[32:35]
    buffer_store_dwordx4 v[140:143], v9, s[20:23], s48 offen sc1
    v_mfma_f32_16x16x32_bf16 v[40:43], v[168:171], v[84:87], v[40:43]
    v_add_f32 v100, v128, v129
    v_mul_f32 v101, v128, v128
    v_mfma_f32_16x16x32_bf16 v[44:47], v[172:175], v[84:87], v[44:47]
    v_fmac_f32 v101, v129, v129
    v_add_f32 v100, v100, v130
    v_mfma_f32_16x16x32_bf16 v[36:39], v[172:175], v[80:83], v[36:39]
    s_waitcnt lgkmcnt(0)
    v_fmac_f32 v101, v130, v130
    v_add_f32 v100, v100, v131
    v_mfma_f32_16x16x32_bf16 v[16:19], v[176:179], v[88:91], v[16:19]
    ds_read_b128 v[80:83], v2 offset:36864
    v_fmac_f32 v101, v131, v131
    v_mfma_f32_16x16x32_bf16 v[24:27], v[176:179], v[92:95], v[24:27]
    buffer_load_dwordx4 v1, s[16:19], s42 offen offset:2048 sc1 lds
    v_mfma_f32_16x16x32_bf16 v[28:31], v[180:183], v[92:95], v[28:31]
    s_add_u32 m0, s43, 122880
    ds_read_b128 v[84:87], v3 offset:36864
    v_add_f32 v100, v100, v132
    v_mfma_f32_16x16x32_bf16 v[20:23], v[180:183], v[88:91], v[20:23]
    s_add_u32 s42, s41, 24576
    v_fmac_f32 v101, v132, v132
    v_add_f32 v100, v100, v133
    v_mfma_f32_16x16x32_bf16 v[32:35], v[184:187], v[88:91], v[32:35]
    v_fmac_f32 v101, v133, v133
    v_add_f32 v100, v100, v134
    v_mfma_f32_16x16x32_bf16 v[40:43], v[184:187], v[92:95], v[40:43]
    v_fmac_f32 v101, v134, v134
    v_add_f32 v100, v100, v135
    v_mfma_f32_16x16x32_bf16 v[44:47], v[188:191], v[92:95], v[44:47]
    buffer_load_dwordx4 v1, s[16:19], s42 offen offset:0 sc1 lds
    v_mfma_f32_16x16x32_bf16 v[36:39], v[188:191], v[88:91], v[36:39]
    s_waitcnt lgkmcnt(0)
    v_fmac_f32 v101, v135, v135
    v_mfma_f32_16x16x32_bf16 v[16:19], v[192:195], v[80:83], v[16:19]
    ds_read_b128 v[88:91], v2 offset:38912
    v_mfma_f32_16x16x32_bf16 v[24:27], v[192:195], v[84:87], v[24:27]
    v_permlane16_swap_b32 v100, v101
    v_mfma_f32_16x16x32_bf16 v[28:31], v[196:199], v[84:87], v[28:31]
    ds_read_b128 v[92:95], v3 offset:38912
    v_add_f32 v100, v100, v101
    v_mfma_f32_16x16x32_bf16 v[20:23], v[196:199], v[80:83], v[20:23]
    buffer_load_dwordx4 v1, s[16:19], s42 offen offset:1024 sc1 lds
    v_mfma_f32_16x16x32_bf16 v[32:35], v[200:203], v[80:83], v[32:35]
    v_mov_b32 v102, v100
    v_mfma_f32_16x16x32_bf16 v[40:43], v[200:203], v[84:87], v[40:43]
    v_permlane32_swap_b32 v100, v102
    v_mfma_f32_16x16x32_bf16 v[44:47], v[204:207], v[84:87], v[44:47]
    v_add_f32 v100, v100, v102
    v_mfma_f32_16x16x32_bf16 v[36:39], v[204:207], v[80:83], v[36:39]
    s_waitcnt lgkmcnt(0)
    ds_write_b32 v10, v100 offset:512
    v_mfma_f32_16x16x32_bf16 v[16:19], v[208:211], v[88:91], v[16:19]
    s_waitcnt vmcnt(22)
    ds_read_b128 v[80:83], v2 offset:40960
    v_mfma_f32_16x16x32_bf16 v[128:131], v[104:107], v[136:139], v[48:51]
    buffer_load_dwordx4 v1, s[16:19], s42 offen offset:2048 sc1 lds
    v_mfma_f32_16x16x32_bf16 v[24:27], v[208:211], v[92:95], v[24:27]
    v_mfma_f32_16x16x32_bf16 v[132:135], v[108:111], v[136:139], v[52:55]
    s_add_u32 s45, s45, 65536
    v_mfma_f32_16x16x32_bf16 v[28:31], v[212:215], v[92:95], v[28:31]
    ds_read_b128 v[84:87], v3 offset:40960
    v_mfma_f32_16x16x32_bf16 v[20:23], v[212:215], v[88:91], v[20:23]
    v_mfma_f32_16x16x32_bf16 v[32:35], v[216:219], v[88:91], v[32:35]
    v_mfma_f32_16x16x32_bf16 v[40:43], v[216:219], v[92:95], v[40:43]
    v_mfma_f32_16x16x32_bf16 v[44:47], v[220:223], v[92:95], v[44:47]
    v_mfma_f32_16x16x32_bf16 v[36:39], v[220:223], v[88:91], v[36:39]
    s_waitcnt lgkmcnt(0)
    v_mfma_f32_16x16x32_bf16 v[16:19], v[224:227], v[80:83], v[16:19]
    ds_read_b128 v[88:91], v2 offset:43008
    v_mfma_f32_16x16x32_bf16 v[24:27], v[224:227], v[84:87], v[24:27]
    v_mfma_f32_16x16x32_bf16 v[28:31], v[228:231], v[84:87], v[28:31]
    ds_read_b128 v[92:95], v3 offset:43008
    v_mfma_f32_16x16x32_bf16 v[20:23], v[228:231], v[80:83], v[20:23]
    v_mfma_f32_16x16x32_bf16 v[32:35], v[232:235], v[80:83], v[32:35]
    v_mfma_f32_16x16x32_bf16 v[40:43], v[232:235], v[84:87], v[40:43]
    v_mfma_f32_16x16x32_bf16 v[44:47], v[236:239], v[84:87], v[44:47]
    v_mfma_f32_16x16x32_bf16 v[36:39], v[236:239], v[80:83], v[36:39]
    s_waitcnt vmcnt(9) lgkmcnt(0)
    s_barrier
    v_mfma_f32_16x16x32_bf16 v[16:19], v[240:243], v[88:91], v[16:19]
    ds_read_b128 v[80:83], v4 offset:0
    v_mfma_f32_16x16x32_bf16 v[24:27], v[240:243], v[92:95], v[24:27]
    v_mfma_f32_16x16x32_bf16 v[28:31], v[244:247], v[92:95], v[28:31]
    ds_read_b128 v[84:87], v5 offset:0
    v_mfma_f32_16x16x32_bf16 v[20:23], v[244:247], v[88:91], v[20:23]
    v_mfma_f32_16x16x32_bf16 v[32:35], v[248:251], v[88:91], v[32:35]
    v_mfma_f32_16x16x32_bf16 v[40:43], v[248:251], v[92:95], v[40:43]
    v_mfma_f32_16x16x32_bf16 v[44:47], v[252:255], v[92:95], v[44:47]
    s_add_u32 s36, s36, 1
    v_mfma_f32_16x16x32_bf16 v[36:39], v[252:255], v[88:91], v[36:39]
    s_waitcnt lgkmcnt(0)
L_bf_b1:
    v_mfma_f32_16x16x32_bf16 v[48:51], a[0:3], v[80:83], v[112:115]
    s_sub_u32 s47, s45, 196608
    ds_read_b128 v[88:91], v4 offset:2048
    s_max_u32 s47, s47, 0x5500000
    v_mfma_f32_16x16x32_bf16 v[56:59], a[0:3], v[84:87], 0
    buffer_load_dword v13, v8, s[16:19], s47 offen sc1
    v_mfma_f32_16x16x32_bf16 v[60:63], a[4:7], v[84:87], 0
    s_and_b32 s38, s53, 0xffffffff
    ds_read_b128 v[92:95], v5 offset:2048
    s_cmp_lt_i32 s36, 1
    v_mfma_f32_16x16x32_bf16 v[52:55], a[4:7], v[80:83], v[116:119]
    s_cselect_b32 s38, 0x5e00000, s38
    v_mfma_f32_16x16x32_bf16 v[64:67], a[8:11], v[80:83], 0
    buffer_load_dwordx4 v[136:139], v1, s[16:19], s38 offen sc1
    v_mfma_f32_16x16x32_bf16 v[72:75], a[8:11], v[84:87], 0
    s_add_u32 s53, s53, 65536
    ds_read_b128 v[144:147], v11 offset:512
    s_and_b32 s44, s90, 0xffffffff
    v_mfma_f32_16x16x32_bf16 v[76:79], a[12:15], v[84:87], 0
    s_cmp_lt_i32 s36, 1
    s_cselect_b32 s44, 0x5e00000, s44
    s_xor_b32 s49, s44, 16384
    v_mfma_f32_16x16x32_bf16 v[68:71], a[12:15], v[80:83], 0
    s_waitcnt lgkmcnt(1)
    v_cvt_pk_bf16_f32 v24, v24, v25
    v_cvt_pk_bf16_f32 v25, v26, v27
    v_mfma_f32_16x16x32_bf16 v[48:51], a[16:19], v[88:91], v[48:51]
    ds_read_b128 v[80:83], v4 offset:4096
    v_cvt_pk_bf16_f32 v26, v28, v29
    v_mfma_f32_16x16x32_bf16 v[56:59], a[16:19], v[92:95], v[56:59]
    v_cvt_pk_bf16_f32 v27, v30, v31
    v_mfma_f32_16x16x32_bf16 v[60:63], a[20:23], v[92:95], v[60:63]
    s_waitcnt lgkmcnt(1)
    ds_read_b128 v[84:87], v5 offset:4096
    v_add_f32 v144, v144, v145
    v_mfma_f32_16x16x32_bf16 v[52:55], a[20:23], v[88:91], v[52:55]
    buffer_store_dwordx4 v[24:27], v1, s[16:19], s49 offen offset:0 sc1
    v_mfma_f32_16x16x32_bf16 v[64:67], a[24:27], v[88:91], v[64:67]
    s_xor_b32 s49, s44, 32768
    v_cvt_pk_bf16_f32 v32, v32, v33
    v_cvt_pk_bf16_f32 v33, v34, v35
    v_mfma_f32_16x16x32_bf16 v[72:75], a[24:27], v[92:95], v[72:75]
    v_cvt_pk_bf16_f32 v34, v36, v37
    v_cvt_pk_bf16_f32 v35, v38, v39
    v_mfma_f32_16x16x32_bf16 v[76:79], a[28:31], v[92:95], v[76:79]
    buffer_store_dwordx4 v[32:35], v1, s[16:19], s49 offen offset:1024 sc1
    v_mfma_f32_16x16x32_bf16 v[68:71], a[28:31], v[88:91], v[68:71]
    s_waitcnt lgkmcnt(0)
    v_add_f32 v146, v146, v147
    v_add_f32 v144, v144, v146
    v_mfma_f32_16x16x32_bf16 v[48:51], a[32:35], v[80:83], v[48:51]
    s_xor_b32 s49, s44, 49152
    ds_read_b128 v[88:91], v4 offset:6144
    v_cvt_pk_bf16_f32 v40, v40, v41
    v_mfma_f32_16x16x32_bf16 v[56:59], a[32:35], v[84:87], v[56:59]
    s_add_u32 m0, s88, 135168
    v_cvt_pk_bf16_f32 v41, v42, v43
    v_cvt_pk_bf16_f32 v42, v44, v45
    v_mfma_f32_16x16x32_bf16 v[60:63], a[36:39], v[84:87], v[60:63]
    s_add_u32 s42, s41, 36864
    ds_read_b128 v[92:95], v5 offset:6144
    v_cvt_pk_bf16_f32 v43, v46, v47
    v_mfma_f32_16x16x32_bf16 v[52:55], a[36:39], v[80:83], v[52:55]
    buffer_store_dwordx4 v[40:43], v1, s[16:19], s49 offen offset:2048 sc1
    v_mfma_f32_16x16x32_bf16 v[64:67], a[40:43], v[80:83], v[64:67]
    s_add_u32 s42, s42, s89
    s_add_u32 s90, s90, 262144
    v_mfma_f32_16x16x32_bf16 v[72:75], a[40:43], v[84:87], v[72:75]
    v_mfma_f32_16x16x32_bf16 v[76:79], a[44:47], v[84:87], v[76:79]
    buffer_load_dwordx4 v1, s[16:19], s42 offen offset:0 sc1 lds
    v_mfma_f32_16x16x32_bf16 v[68:71], a[44:47], v[80:83], v[68:71]
    s_waitcnt lgkmcnt(0)
    v_mfma_f32_16x16x32_bf16 v[48:51], a[48:51], v[88:91], v[48:51]
    ds_read_b128 v[80:83], v4 offset:8192
    v_mfma_f32_16x16x32_bf16 v[56:59], a[48:51], v[92:95], v[56:59]
    buffer_store_dword v144, v12, s[16:19], s46 offen sc1
    v_mfma_f32_16x16x32_bf16 v[60:63], a[52:55], v[92:95], v[60:63]
    ds_read_b128 v[84:87], v5 offset:8192
    v_mfma_f32_16x16x32_bf16 v[52:55], a[52:55], v[88:91], v[52:55]
    v_mfma_f32_16x16x32_bf16 v[64:67], a[56:59], v[88:91], v[64:67]
    buffer_load_dwordx4 v1, s[16:19], s42 offen offset:1024 sc1 lds
    v_mfma_f32_16x16x32_bf16 v[72:75], a[56:59], v[92:95], v[72:75]
    s_add_u32 s98, s98, 262144
    s_min_i32 s98, s98, s96
    s_and_b32 s41, s98, 0xffffffff
    v_mfma_f32_16x16x32_bf16 v[76:79], a[60:63], v[92:95], v[76:79]
    v_mfma_f32_16x16x32_bf16 v[68:71], a[60:63], v[88:91], v[68:71]
    s_waitcnt lgkmcnt(0)
    v_mfma_f32_16x16x32_bf16 v[48:51], a[64:67], v[80:83], v[48:51]
    ds_read_b128 v[88:91], v4 offset:10240
    v_mfma_f32_16x16x32_bf16 v[56:59], a[64:67], v[84:87], v[56:59]
    v_mfma_f32_16x16x32_bf16 v[60:63], a[68:71], v[84:87], v[60:63]
    ds_read_b128 v[92:95], v5 offset:10240
    v_mfma_f32_16x16x32_bf16 v[52:55], a[68:71], v[80:83], v[52:55]
    s_waitcnt vmcnt(7)
    v_cmp_ne_u32 vcc, 0, v13
    v_mfma_f32_16x16x32_bf16 v[64:67], a[72:75], v[80:83], v[64:67]
    v_mfma_f32_16x16x32_bf16 v[72:75], a[72:75], v[84:87], v[72:75]
    s_cbranch_vccnz L_spin62
L_back63:
    v_mfma_f32_16x16x32_bf16 v[76:79], a[76:79], v[84:87], v[76:79]
    v_mfma_f32_16x16x32_bf16 v[68:71], a[76:79], v[80:83], v[68:71]
    s_waitcnt vmcnt(8) lgkmcnt(0)
    s_barrier
    v_mfma_f32_16x16x32_bf16 v[48:51], a[80:83], v[88:91], v[48:51]
    s_sub_u32 s48, s90, 524288
    ds_read_b128 v[80:83], v4 offset:12288
    s_and_b32 s48, s48, 0xffffffff
    v_mfma_f32_16x16x32_bf16 v[56:59], a[80:83], v[92:95], v[56:59]
    s_cmp_lt_i32 s36, 2
    s_cselect_b32 s48, s52, s48
    v_mfma_f32_16x16x32_bf16 v[60:63], a[84:87], v[92:95], v[60:63]
    ds_read_b128 v[84:87], v5 offset:12288
    v_mfma_f32_16x16x32_bf16 v[52:55], a[84:87], v[88:91], v[52:55]
    buffer_load_dwordx4 v[140:143], v1, s[16:19], s48 offen offset:0 sc1
    v_mfma_f32_16x16x32_bf16 v[64:67], a[88:91], v[88:91], v[64:67]
    v_mfma_f32_16x16x32_bf16 v[72:75], a[88:91], v[92:95], v[72:75]
    v_mfma_f32_16x16x32_bf16 v[76:79], a[92:95], v[92:95], v[76:79]
    buffer_load_dwordx4 v[144:147], v1, s[16:19], s48 offen offset:1024 sc1
    v_mfma_f32_16x16x32_bf16 v[68:71], a[92:95], v[88:91], v[68:71]
    s_waitcnt lgkmcnt(0)
    v_mfma_f32_16x16x32_bf16 v[48:51], a[96:99], v[80:83], v[48:51]
    ds_read_b128 v[88:91], v4 offset:14336
    v_mfma_f32_16x16x32_bf16 v[56:59], a[96:99], v[84:87], v[56:59]
    buffer_load_dwordx4 v[148:151], v1, s[16:19], s48 offen offset:2048 sc1
    v_mfma_f32_16x16x32_bf16 v[60:63], a[100:103], v[84:87], v[60:63]
    ds_read_b128 v[92:95], v5 offset:14336
    v_mfma_f32_16x16x32_bf16 v[52:55], a[100:103], v[80:83], v[52:55]
    v_mfma_f32_16x16x32_bf16 v[64:67], a[104:107], v[80:83], v[64:67]
    buffer_load_dwordx4 v[152:155], v1, s[16:19], s48 offen offset:3072 sc1
    v_mfma_f32_16x16x32_bf16 v[72:75], a[104:107], v[84:87], v[72:75]
    s_sub_u32 s47, s36, 2
    s_cmp_lt_u32 s47, 16
    s_cselect_b32 s48, 0x5000000, s52
    v_mfma_f32_16x16x32_bf16 v[76:79], a[108:111], v[84:87], v[76:79]
    s_add_u32 s20, s84, s48
    s_addc_u32 s21, s85, 0
    s_cmp_ge_i32 s47, 16
    v_mfma_f32_16x16x32_bf16 v[68:71], a[108:111], v[80:83], v[68:71]
    s_waitcnt lgkmcnt(0)
    s_cselect_b32 s20, s80, s20
    s_cselect_b32 s21, s81, s21
    v_mfma_f32_16x16x32_bf16 v[48:51], a[112:115], v[88:91], v[48:51]
    s_and_b32 s48, s47, 15
    ds_read_b128 v[80:83], v4 offset:16384
    s_lshl_b32 s48, s48, 1
    v_mfma_f32_16x16x32_bf16 v[56:59], a[112:115], v[92:95], v[56:59]
    s_sub_u32 s48, s50, s48
    s_lshl_b32 s46, s48, 10
    s_sub_u32 s46, s55, s46
    v_mfma_f32_16x16x32_bf16 v[60:63], a[116:119], v[92:95], v[60:63]
    s_cmp_lt_u32 s47, 16
    ds_read_b128 v[84:87], v5 offset:16384
    s_cselect_b32 s46, s46, s52
    v_mfma_f32_16x16x32_bf16 v[52:55], a[116:119], v[88:91], v[52:55]
    buffer_load_dword v96, v6, s[16:19], s45 offen sc1
    v_mfma_f32_16x16x32_bf16 v[64:67], a[120:123], v[88:91], v[64:67]
    s_add_u32 m0, s43, 0
    s_add_u32 s42, s41, 0
    s_lshl_b32 s48, s48, 15
    v_mfma_f32_16x16x32_bf16 v[72:75], a[120:123], v[92:95], v[72:75]
    v_mfma_f32_16x16x32_bf16 v[76:79], a[124:127], v[92:95], v[76:79]
    v_mfma_f32_16x16x32_bf16 v[68:71], a[124:127], v[88:91], v[68:71]
    s_waitcnt lgkmcnt(0)
    v_mfma_f32_16x16x32_bf16 v[48:51], a[128:131], v[80:83], v[48:51]
    ds_read_b128 v[88:91], v4 offset:18432
    v_mfma_f32_16x16x32_bf16 v[56:59], a[128:131], v[84:87], v[56:59]
    v_mfma_f32_16x16x32_bf16 v[60:63], a[132:135], v[84:87], v[60:63]
    ds_read_b128 v[92:95], v5 offset:18432
    v_mfma_f32_16x16x32_bf16 v[52:55], a[132:135], v[80:83], v[52:55]
    v_mfma_f32_16x16x32_bf16 v[64:67], a[136:139], v[80:83], v[64:67]
    v_mfma_f32_16x16x32_bf16 v[72:75], a[136:139], v[84:87], v[72:75]
    v_mfma_f32_16x16x32_bf16 v[76:79], a[140:143], v[84:87], v[76:79]
    v_mfma_f32_16x16x32_bf16 v[68:71], a[140:143], v[80:83], v[68:71]
    s_waitcnt lgkmcnt(0)
    v_mfma_f32_16x16x32_bf16 v[48:51], a[144:147], v[88:91], v[48:51]
    ds_read_b128 v[80:83], v4 offset:20480
    v_mfma_f32_16x16x32_bf16 v[56:59], a[144:147], v[92:95], v[56:59]
    v_mfma_f32_16x16x32_bf16 v[60:63], a[148:151], v[92:95], v[60:63]
    ds_read_b128 v[84:87], v5 offset:20480
    v_mfma_f32_16x16x32_bf16 v[52:55], a[148:151], v[88:91], v[52:55]
    v_mfma_f32_16x16x32_bf16 v[64:67], a[152:155], v[88:91], v[64:67]
    v_mfma_f32_16x16x32_bf16 v[72:75], a[152:155], v[92:95], v[72:75]
    v_mfma_f32_16x16x32_bf16 v[76:79], a[156:159], v[92:95], v[76:79]
    v_mfma_f32_16x16x32_bf16 v[68:71], a[156:159], v[88:91], v[68:71]
    s_waitcnt lgkmcnt(0)
    v_mfma_f32_16x16x32_bf16 v[48:51], a[160:163], v[80:83], v[48:51]
    ds_read_b128 v[88:91], v4 offset:22528
    v_mfma_f32_16x16x32_bf16 v[56:59], a[160:163], v[84:87], v[56:59]
    v_mfma_f32_16x16x32_bf16 v[60:63], a[164:167], v[84:87], v[60:63]
    ds_read_b128 v[92:95], v5 offset:22528
    v_mfma_f32_16x16x32_bf16 v[52:55], a[164:167], v[80:83], v[52:55]
    v_mfma_f32_16x16x32_bf16 v[64:67], a[168:171], v[80:83], v[64:67]
    v_mfma_f32_16x16x32_bf16 v[72:75], a[168:171], v[84:87], v[72:75]
    v_mfma_f32_16x16x32_bf16 v[76:79], a[172:175], v[84:87], v[76:79]
    v_mfma_f32_16x16x32_bf16 v[68:71], a[172:175], v[80:83], v[68:71]
    s_waitcnt lgkmcnt(0)
    v_mfma_f32_16x16x32_bf16 v[48:51], a[176:179], v[88:91], v[48:51]
    ds_read_b128 v[80:83], v4 offset:24576
    v_mfma_f32_16x16x32_bf16 v[56:59], a[176:179], v[92:95], v[56:59]
    v_mfma_f32_16x16x32_bf16 v[60:63], a[180:183], v[92:95], v[60:63]
    ds_read_b128 v[84:87], v5 offset:24576
    v_mfma_f32_16x16x32_bf16 v[52:55], a[180:183], v[88:91], v[52:55]
    v_mfma_f32_16x16x32_bf16 v[64:67], a[184:187], v[88:91], v[64:67]
    v_mfma_f32_16x16x32_bf16 v[72:75], a[184:187], v[92:95], v[72:75]
    v_mfma_f32_16x16x32_bf16 v[76:79], a[188:191], v[92:95], v[76:79]
    v_mfma_f32_16x16x32_bf16 v[68:71], a[188:191], v[88:91], v[68:71]
    s_waitcnt lgkmcnt(0)
    v_mfma_f32_16x16x32_bf16 v[48:51], a[192:195], v[80:83], v[48:51]
    ds_read_b128 v[88:91], v4 offset:26624
    v_mfma_f32_16x16x32_bf16 v[56:59], a[192:195], v[84:87], v[56:59]
    v_mfma_f32_16x16x32_bf16 v[60:63], a[196:199], v[84:87], v[60:63]
    ds_read_b128 v[92:95], v5 offset:26624
    v_mfma_f32_16x16x32_bf16 v[52:55], a[196:199], v[80:83], v[52:55]
    v_mfma_f32_16x16x32_bf16 v[64:67], a[200:203], v[80:83], v[64:67]
    v_mfma_f32_16x16x32_bf16 v[72:75], a[200:203], v[84:87], v[72:75]
    v_mfma_f32_16x16x32_bf16 v[76:79], a[204:207], v[84:87], v[76:79]
    v_mfma_f32_16x16x32_bf16 v[68:71], a[204:207], v[80:83], v[68:71]
    s_waitcnt lgkmcnt(0)
    v_mfma_f32_16x16x32_bf16 v[48:51], a[208:211], v[88:91], v[48:51]
    s_waitcnt vmcnt(0)
    ds_read_b128 v[80:83], v4 offset:28672
    v_cmp_ne_u32 vcc, 0, v96
    v_mfma_f32_16x16x32_bf16 v[56:59], a[208:211], v[92:95], v[56:59]
    v_mfma_f32_16x16x32_bf16 v[60:63], a[212:215], v[92:95], v[60:63]
    s_cbranch_vccnz L_spin64
L_back65:
    ds_read_b128 v[84:87], v5 offset:28672
    s_barrier
    v_mfma_f32_16x16x32_bf16 v[52:55], a[212:215], v[88:91], v[52:55]
    buffer_load_dwordx4 v1, s[16:19], s42 offen offset:0 sc1 lds
    v_mfma_f32_16x16x32_bf16 v[64:67], a[216:219], v[88:91], v[64:67]
    v_mfma_f32_16x16x32_bf16 v[72:75], a[216:219], v[92:95], v[72:75]
    v_mfma_f32_16x16x32_bf16 v[76:79], a[220:223], v[92:95], v[76:79]
    buffer_load_dwordx4 v1, s[16:19], s42 offen offset:1024 sc1 lds
    v_mfma_f32_16x16x32_bf16 v[68:71], a[220:223], v[88:91], v[68:71]
    s_waitcnt lgkmcnt(0)
    v_mfma_f32_16x16x32_bf16 v[48:51], a[224:227], v[80:83], v[48:51]
    ds_read_b128 v[88:91], v4 offset:30720
    v_mfma_f32_16x16x32_bf16 v[56:59], a[224:227], v[84:87], v[56:59]
    buffer_load_dwordx4 v1, s[16:19], s42 offen offset:2048 sc1 lds
    v_mfma_f32_16x16x32_bf16 v[60:63], a[228:231], v[84:87], v[60:63]
    ds_read_b128 v[92:95], v5 offset:30720
    v_mfma_f32_16x16x32_bf16 v[52:55], a[228:231], v[80:83], v[52:55]
    v_mfma_f32_16x16x32_bf16 v[64:67], a[232:235], v[80:83], v[64:67]
    buffer_store_dword v124, v124, s[16:19], s91 offen sc1
    v_mfma_f32_16x16x32_bf16 v[72:75], a[232:235], v[84:87], v[72:75]
    s_add_u32 s91, s91, 65536
    s_add_u32 s39, s91, -163840
    s_add_u32 m0, s43, 12288
    v_mfma_f32_16x16x32_bf16 v[76:79], a[236:239], v[84:87], v[76:79]
    s_add_u32 s42, s41, 12288
    s_waitcnt vmcnt(5)
    v_mfma_f32_16x16x32_bf16 v[128:131], v[104:107], v[140:143], v[128:131]
    v_mfma_f32_16x16x32_bf16 v[132:135], v[108:111], v[140:143], v[132:135]
    v_mfma_f32_16x16x32_bf16 v[128:131], v[104:107], v[144:147], v[128:131]
    v_mfma_f32_16x16x32_bf16 v[132:135], v[108:111], v[144:147], v[132:135]
    v_mfma_f32_16x16x32_bf16 v[128:131], v[104:107], v[148:151], v[128:131]
    v_mfma_f32_16x16x32_bf16 v[132:135], v[108:111], v[148:151], v[132:135]
    v_mfma_f32_16x16x32_bf16 v[128:131], v[104:107], v[152:155], v[128:131]
    v_mfma_f32_16x16x32_bf16 v[132:135], v[108:111], v[152:155], v[132:135]
    v_mfma_f32_16x16x32_bf16 v[68:71], a[236:239], v[80:83], v[68:71]
    s_waitcnt lgkmcnt(0)
    v_mfma_f32_16x16x32_bf16 v[48:51], a[240:243], v[88:91], v[48:51]
    ds_read_b128 v[80:83], v4 offset:32768
    v_cvt_pk_bf16_f32 v140, v128, v129
    v_mfma_f32_16x16x32_bf16 v[56:59], a[240:243], v[92:95], v[56:59]
    buffer_store_dword v124, v124, s[16:19], s39 offen sc1
    v_mfma_f32_16x16x32_bf16 v[60:63], a[244:247], v[92:95], v[60:63]
    ds_read_b128 v[84:87], v5 offset:32768
    v_cvt_pk_bf16_f32 v141, v130, v131
    v_mfma_f32_16x16x32_bf16 v[52:55], a[244:247], v[88:91], v[52:55]
    v_cvt_pk_bf16_f32 v142, v132, v133
    v_cvt_pk_bf16_f32 v143, v134, v135
    v_mfma_f32_16x16x32_bf16 v[64:67], a[248:251], v[88:91], v[64:67]
    buffer_load_dwordx4 v1, s[16:19], s42 offen offset:0 sc1 lds
    v_mfma_f32_16x16x32_bf16 v[72:75], a[248:251], v[92:95], v[72:75]
    v_mfma_f32_16x16x32_bf16 v[76:79], a[252:255], v[92:95], v[76:79]
    v_mfma_f32_16x16x32_bf16 v[68:71], a[252:255], v[88:91], v[68:71]
    s_waitcnt lgkmcnt(0)
    v_mfma_f32_16x16x32_bf16 v[48:51], v[160:163], v[80:83], v[48:51]
    ds_read_b128 v[88:91], v4 offset:34816
    v_mfma_f32_16x16x32_bf16 v[56:59], v[160:163], v[84:87], v[56:59]
    buffer_load_dwordx4 v1, s[16:19], s42 offen offset:1024 sc1 lds
    v_mfma_f32_16x16x32_bf16 v[60:63], v[164:167], v[84:87], v[60:63]
    ds_read_b128 v[92:95], v5 offset:34816
    v_mfma_f32_16x16x32_bf16 v[52:55], v[164:167], v[80:83], v[52:55]
    v_mfma_f32_16x16x32_bf16 v[64:67], v[168:171], v[80:83], v[64:67]
    buffer_store_dwordx4 v[140:143], v9, s[20:23], s48 offen sc1
    v_mfma_f32_16x16x32_bf16 v[72:75], v[168:171], v[84:87], v[72:75]
    v_add_f32 v100, v128, v129
    v_mul_f32 v101, v128, v128
    v_mfma_f32_16x16x32_bf16 v[76:79], v[172:175], v[84:87], v[76:79]
    v_fmac_f32 v101, v129, v129
    v_add_f32 v100, v100, v130
    v_mfma_f32_16x16x32_bf16 v[68:71], v[172:175], v[80:83], v[68:71]
    s_waitcnt lgkmcnt(0)
    v_fmac_f32 v101, v130, v130
    v_add_f32 v100, v100, v131
    v_mfma_f32_16x16x32_bf16 v[48:51], v[176:179], v[88:91], v[48:51]
    ds_read_b128 v[80:83], v4 offset:36864
    v_fmac_f32 v101, v131, v131
    v_mfma_f32_16x16x32_bf16 v[56:59], v[176:179], v[92:95], v[56:59]
    buffer_load_dwordx4 v1, s[16:19], s42 offen offset:2048 sc1 lds
    v_mfma_f32_16x16x32_bf16 v[60:63], v[180:183], v[92:95], v[60:63]
    s_add_u32 m0, s43, 24576
    ds_read_b128 v[84:87], v5 offset:36864
    v_add_f32 v100, v100, v132
    v_mfma_f32_16x16x32_bf16 v[52:55], v[180:183], v[88:91], v[52:55]
    s_add_u32 s42, s41, 24576
    v_fmac_f32 v101, v132, v132
    v_add_f32 v100, v100, v133
    v_mfma_f32_16x16x32_bf16 v[64:67], v[184:187], v[88:91], v[64:67]
    v_fmac_f32 v101, v133, v133
    v_add_f32 v100, v100, v134
    v_mfma_f32_16x16x32_bf16 v[72:75], v[184:187], v[92:95], v[72:75]
    v_fmac_f32 v101, v134, v134
    v_add_f32 v100, v100, v135
    v_mfma_f32_16x16x32_bf16 v[76:79], v[188:191], v[92:95], v[76:79]
    buffer_load_dwordx4 v1, s[16:19], s42 offen offset:0 sc1 lds
    v_mfma_f32_16x16x32_bf16 v[68:71], v[188:191], v[88:91], v[68:71]
    s_waitcnt lgkmcnt(0)
    v_fmac_f32 v101, v135, v135
    v_mfma_f32_16x16x32_bf16 v[48:51], v[192:195], v[80:83], v[48:51]
    ds_read_b128 v[88:91], v4 offset:38912
    v_mfma_f32_16x16x32_bf16 v[56:59], v[192:195], v[84:87], v[56:59]
    v_permlane16_swap_b32 v100, v101
    v_mfma_f32_16x16x32_bf16 v[60:63], v[196:199], v[84:87], v[60:63]
    ds_read_b128 v[92:95], v5 offset:38912
    v_add_f32 v100, v100, v101
    v_mfma_f32_16x16x32_bf16 v[52:55], v[196:199], v[80:83], v[52:55]
    buffer_load_dwordx4 v1, s[16:19], s42 offen offset:1024 sc1 lds
    v_mfma_f32_16x16x32_bf16 v[64:67], v[200:203], v[80:83], v[64:67]
    v_mov_b32 v102, v100
    v_mfma_f32_16x16x32_bf16 v[72:75], v[200:203], v[84:87], v[72:75]
    v_permlane32_swap_b32 v100, v102
    v_mfma_f32_16x16x32_bf16 v[76:79], v[204:207], v[84:87], v[76:79]
    v_add_f32 v100, v100, v102
    v_mfma_f32_16x16x32_bf16 v[68:71], v[204:207], v[80:83], v[68:71]
    s_waitcnt lgkmcnt(0)
    ds_write_b32 v10, v100 offset:0
    v_mfma_f32_16x16x32_bf16 v[48:51], v[208:211], v[88:91], v[48:51]
    s_waitcnt vmcnt(22)
    ds_read_b128 v[80:83], v4 offset:40960
    v_mfma_f32_16x16x32_bf16 v[128:131], v[104:107], v[136:139], v[16:19]
    buffer_load_dwordx4 v1, s[16:19], s42 offen offset:2048 sc1 lds
    v_mfma_f32_16x16x32_bf16 v[56:59], v[208:211], v[92:95], v[56:59]
    v_mfma_f32_16x16x32_bf16 v[132:135], v[108:111], v[136:139], v[20:23]
    s_add_u32 s45, s45, 65536
    v_mfma_f32_16x16x32_bf16 v[60:63], v[212:215], v[92:95], v[60:63]
    ds_read_b128 v[84:87], v5 offset:40960
    v_mfma_f32_16x16x32_bf16 v[52:55], v[212:215], v[88:91], v[52:55]
    v_mfma_f32_16x16x32_bf16 v[64:67], v[216:219], v[88:91], v[64:67]
    v_mfma_f32_16x16x32_bf16 v[72:75], v[216:219], v[92:95], v[72:75]
    v_mfma_f32_16x16x32_bf16 v[76:79], v[220:223], v[92:95], v[76:79]
    v_mfma_f32_16x16x32_bf16 v[68:71], v[220:223], v[88:91], v[68:71]
    s_waitcnt lgkmcnt(0)
    v_mfma_f32_16x16x32_bf16 v[48:51], v[224:227], v[80:83], v[48:51]
    ds_read_b128 v[88:91], v4 offset:43008
    v_mfma_f32_16x16x32_bf16 v[56:59], v[224:227], v[84:87], v[56:59]
    v_mfma_f32_16x16x32_bf16 v[60:63], v[228:231], v[84:87], v[60:63]
    ds_read_b128 v[92:95], v5 offset:43008
    v_mfma_f32_16x16x32_bf16 v[52:55], v[228:231], v[80:83], v[52:55]
    v_mfma_f32_16x16x32_bf16 v[64:67], v[232:235], v[80:83], v[64:67]
    v_mfma_f32_16x16x32_bf16 v[72:75], v[232:235], v[84:87], v[72:75]
    v_mfma_f32_16x16x32_bf16 v[76:79], v[236:239], v[84:87], v[76:79]
    v_mfma_f32_16x16x32_bf16 v[68:71], v[236:239], v[80:83], v[68:71]
    s_waitcnt vmcnt(9) lgkmcnt(0)
    s_barrier
    v_mfma_f32_16x16x32_bf16 v[48:51], v[240:243], v[88:91], v[48:51]
    ds_read_b128 v[80:83], v2 offset:0
    v_mfma_f32_16x16x32_bf16 v[56:59], v[240:243], v[92:95], v[56:59]
    v_mfma_f32_16x16x32_bf16 v[60:63], v[244:247], v[92:95], v[60:63]
    ds_read_b128 v[84:87], v3 offset:0
    v_mfma_f32_16x16x32_bf16 v[52:55], v[244:247], v[88:91], v[52:55]
    v_mfma_f32_16x16x32_bf16 v[64:67], v[248:251], v[88:91], v[64:67]
    v_mfma_f32_16x16x32_bf16 v[72:75], v[248:251], v[92:95], v[72:75]
    v_mfma_f32_16x16x32_bf16 v[76:79], v[252:255], v[92:95], v[76:79]
    s_add_u32 s36, s36, 1
    v_mfma_f32_16x16x32_bf16 v[68:71], v[252:255], v[88:91], v[68:71]
    s_waitcnt lgkmcnt(0)
    s_cmp_lt_u32 s36, 32
    s_cbranch_scc1 L_bf_b0
    s_nop 7
    s_sub_u32 s47, s45, 196608
    s_max_u32 s47, s47, 0x5500000
    buffer_load_dword v13, v8, s[16:19], s47 offen sc1
    s_and_b32 s38, s53, 0xffffffff
    s_cmp_lt_i32 s36, 1
    s_cselect_b32 s38, 0x5e00000, s38
    buffer_load_dwordx4 v[136:139], v1, s[16:19], s38 offen sc1
    s_add_u32 s53, s53, 65536
    s_and_b32 s44, s90, 0xffffffff
    s_cmp_lt_i32 s36, 1
    s_cselect_b32 s44, 0x5e00000, s44
    s_xor_b32 s49, s44, 16384
    v_cvt_pk_bf16_f32 v56, v56, v57
    v_cvt_pk_bf16_f32 v57, v58, v59
    v_cvt_pk_bf16_f32 v58, v60, v61
    v_cvt_pk_bf16_f32 v59, v62, v63
    buffer_store_dwordx4 v[56:59], v1, s[16:19], s49 offen offset:0 sc1
    s_xor_b32 s49, s44, 32768
    v_cvt_pk_bf16_f32 v64, v64, v65
    v_cvt_pk_bf16_f32 v65, v66, v67
    v_cvt_pk_bf16_f32 v66, v68, v69
    v_cvt_pk_bf16_f32 v67, v70, v71
    buffer_store_dwordx4 v[64:67], v1, s[16:19], s49 offen offset:1024 sc1
    s_xor_b32 s49, s44, 49152
    v_cvt_pk_bf16_f32 v72, v72, v73
    v_cvt_pk_bf16_f32 v73, v74, v75
    v_cvt_pk_bf16_f32 v74, v76, v77
    v_cvt_pk_bf16_f32 v75, v78, v79
    buffer_store_dwordx4 v[72:75], v1, s[16:19], s49 offen offset:2048 sc1
    s_add_u32 s90, s90, 262144
    s_waitcnt vmcnt(4)
    v_cmp_ne_u32 vcc, 0, v13
    s_cbranch_vccnz L_spin66
L_back67:
    s_barrier
    s_sub_u32 s48, s90, 524288
    s_and_b32 s48, s48, 0xffffffff
    s_cmp_lt_i32 s36, 2
    s_cselect_b32 s48, s52, s48
    buffer_load_dwordx4 v[140:143], v1, s[16:19], s48 offen offset:0 sc1
    buffer_load_dwordx4 v[144:147], v1, s[16:19], s48 offen offset:1024 sc1
    buffer_load_dwordx4 v[148:151], v1, s[16:19], s48 offen offset:2048 sc1
    buffer_load_dwordx4 v[152:155], v1, s[16:19], s48 offen offset:3072 sc1
    s_sub_u32 s47, s36, 2
    s_cmp_lt_u32 s47, 16
    s_cselect_b32 s48, 0x5000000, s52
    s_add_u32 s20, s84, s48
    s_addc_u32 s21, s85, 0
    s_cmp_ge_i32 s47, 16
    s_cselect_b32 s20, s80, s20
    s_cselect_b32 s21, s81, s21
    s_and_b32 s48, s47, 15
    s_lshl_b32 s48, s48, 1
    s_sub_u32 s48, s50, s48
    s_lshl_b32 s46, s48, 10
    s_sub_u32 s46, s55, s46
    s_cmp_lt_u32 s47, 16
    s_cselect_b32 s46, s46, s52
    s_lshl_b32 s48, s48, 15
    s_waitcnt vmcnt(4)
    s_barrier
    buffer_store_dword v124, v124, s[16:19], s91 offen sc1
    s_add_u32 s91, s91, 65536
    s_waitcnt vmcnt(1)
    v_mfma_f32_16x16x32_bf16 v[128:131], v[104:107], v[140:143], v[128:131]
    v_mfma_f32_16x16x32_bf16 v[132:135], v[108:111], v[140:143], v[132:135]
    v_mfma_f32_16x16x32_bf16 v[128:131], v[104:107], v[144:147], v[128:131]
    v_mfma_f32_16x16x32_bf16 v[132:135], v[108:111], v[144:147], v[132:135]
    v_mfma_f32_16x16x32_bf16 v[128:131], v[104:107], v[148:151], v[128:131]
    v_mfma_f32_16x16x32_bf16 v[132:135], v[108:111], v[148:151], v[132:135]
    v_mfma_f32_16x16x32_bf16 v[128:131], v[104:107], v[152:155], v[128:131]
    v_mfma_f32_16x16x32_bf16 v[132:135], v[108:111], v[152:155], v[132:135]
    s_nop 5
    v_cvt_pk_bf16_f32 v140, v128, v129
    v_cvt_pk_bf16_f32 v141, v130, v131
    v_cvt_pk_bf16_f32 v142, v132, v133
    v_cvt_pk_bf16_f32 v143, v134, v135
    buffer_store_dwordx4 v[140:143], v9, s[20:23], s48 offen sc1
    s_waitcnt vmcnt(9)
    v_mfma_f32_16x16x32_bf16 v[128:131], v[104:107], v[136:139], v[48:51]
    v_mfma_f32_16x16x32_bf16 v[132:135], v[108:111], v[136:139], v[52:55]
    s_sub_u32 s47, s45, 131072
    s_max_u32 s47, s47, 0x5500000
    buffer_load_dword v13, v8, s[16:19], s47 offen sc1
    s_waitcnt vmcnt(0)
    v_cmp_ne_u32 vcc, 0, v13
    s_cbranch_vccnz L_spin68
L_back69:
    s_barrier
    s_sub_u32 s48, s90, 262144
    s_and_b32 s48, s48, 0xffffffff
    s_cmp_lt_i32 s36, 1
    s_cselect_b32 s48, s52, s48
    buffer_load_dwordx4 v[140:143], v1, s[16:19], s48 offen offset:0 sc1
    buffer_load_dwordx4 v[144:147], v1, s[16:19], s48 offen offset:1024 sc1
    buffer_load_dwordx4 v[148:151], v1, s[16:19], s48 offen offset:2048 sc1
    buffer_load_dwordx4 v[152:155], v1, s[16:19], s48 offen offset:3072 sc1
    s_sub_u32 s47, s36, 1
    s_cmp_lt_u32 s47, 16
    s_cselect_b32 s48, 0x5000000, s52
    s_add_u32 s20, s84, s48
    s_addc_u32 s21, s85, 0
    s_cmp_ge_i32 s47, 16
    s_cselect_b32 s20, s80, s20
    s_cselect_b32 s21, s81, s21
    s_and_b32 s48, s47, 15
    s_lshl_b32 s48, s48, 1
    s_sub_u32 s48, s50, s48
    s_lshl_b32 s46, s48, 10
    s_sub_u32 s46, s55, s46
    s_cmp_lt_u32 s47, 16
    s_cselect_b32 s46, s46, s52
    s_lshl_b32 s48, s48, 15
    s_waitcnt vmcnt(0)
    v_mfma_f32_16x16x32_bf16 v[128:131], v[104:107], v[140:143], v[128:131]
    v_mfma_f32_16x16x32_bf16 v[132:135], v[108:111], v[140:143], v[132:135]
    v_mfma_f32_16x16x32_bf16 v[128:131], v[104:107], v[144:147], v[128:131]
    v_mfma_f32_16x16x32_bf16 v[132:135], v[108:111], v[144:147], v[132:135]
    v_mfma_f32_16x16x32_bf16 v[128:131], v[104:107], v[148:151], v[128:131]
    v_mfma_f32_16x16x32_bf16 v[132:135], v[108:111], v[148:151], v[132:135]
    v_mfma_f32_16x16x32_bf16 v[128:131], v[104:107], v[152:155], v[128:131]
    v_mfma_f32_16x16x32_bf16 v[132:135], v[108:111], v[152:155], v[132:135]
    s_nop 5
    v_cvt_pk_bf16_f32 v140, v128, v129
    v_cvt_pk_bf16_f32 v141, v130, v131
    v_cvt_pk_bf16_f32 v142, v132, v133
    v_cvt_pk_bf16_f32 v143, v134, v135
    buffer_store_dwordx4 v[140:143], v9, s[20:23], s48 offen sc1
    s_waitcnt vmcnt(0)
    s_endpgm
L_spin46:
    s_mov_b32 s40, 0x20000
L_spin46_l:
    buffer_load_dword v8, v124, s[20:23], 0 offen sc1
    s_sub_u32 s40, s40, 1
    s_waitcnt vmcnt(0)
    v_cmp_eq_u32 vcc, v124, v8
    s_cbranch_scc1 L_back47
    s_cbranch_vccz L_back47
    s_sleep 8
    s_branch L_spin46_l
L_spin49:
    s_mov_b32 s40, 0x20000
L_spin49_l:
    buffer_load_dword v48, v124, s[20:23], 0 offen sc1
    s_sub_u32 s40, s40, 1
    s_waitcnt vmcnt(0)
    v_cmp_eq_u32 vcc, v124, v48
    s_cbranch_scc1 L_back50
    s_cbranch_vccz L_back50
    s_sleep 8
    s_branch L_spin49_l
L_spin51:
    s_mov_b32 s40, 0x20000
L_spin51_l:
    buffer_load_dword v49, v48, s[16:19], s38 offen sc1
    s_sub_u32 s40, s40, 1
    s_waitcnt vmcnt(0)
    v_cmp_ne_u32 vcc, 0, v49
    s_cbranch_scc1 L_back52
    s_cbranch_vccz L_back52
    s_sleep 8
    s_branch L_spin51_l
L_spin54:
    s_mov_b32 s40, 0x20000
L_spin54_l:
    buffer_load_dword v80, v124, s[20:23], 0 offen sc1
    s_sub_u32 s40, s40, 1
    s_waitcnt vmcnt(0)
    v_cmp_eq_u32 vcc, v124, v80
    s_cbranch_scc1 L_back55
    s_cbranch_vccz L_back55
    s_sleep 8
    s_branch L_spin54_l
L_spin56:
    s_mov_b32 s40, 0x20000
L_spin56_l:
    buffer_load_dword v96, v6, s[16:19], s45 offen sc1
    s_sub_u32 s40, s40, 1
    s_waitcnt vmcnt(0)
    v_cmp_ne_u32 vcc, 0, v96
    s_cbranch_scc1 L_back57
    s_cbranch_vccz L_back57
    s_sleep 2
    s_branch L_spin56_l
L_spin58:
    s_mov_b32 s40, 0x20000
L_spin58_l:
    buffer_load_dword v13, v8, s[16:19], s47 offen sc1
    s_sub_u32 s40, s40, 1
    s_waitcnt vmcnt(0)
    v_cmp_ne_u32 vcc, 0, v13
    s_cbranch_scc1 L_back59
    s_cbranch_vccz L_back59
    s_sleep 2
    s_branch L_spin58_l
L_spin60:
    s_mov_b32 s40, 0x20000
L_spin60_l:
    buffer_load_dword v96, v6, s[16:19], s45 offen sc1
    s_sub_u32 s40, s40, 1
    s_waitcnt vmcnt(0)
    v_cmp_ne_u32 vcc, 0, v96
    s_cbranch_scc1 L_back61
    s_cbranch_vccz L_back61
    s_sleep 2
    s_branch L_spin60_l
L_spin62:
    s_mov_b32 s40, 0x20000
L_spin62_l:
    buffer_load_dword v13, v8, s[16:19], s47 offen sc1
    s_sub_u32 s40, s40, 1
    s_waitcnt vmcnt(0)
    v_cmp_ne_u32 vcc, 0, v13
    s_cbranch_scc1 L_back63
    s_cbranch_vccz L_back63
    s_sleep 2
    s_branch L_spin62_l
L_spin64:
    s_mov_b32 s40, 0x20000
L_spin64_l:
    buffer_load_dword v96, v6, s[16:19], s45 offen sc1
    s_sub_u32 s40, s40, 1
    s_waitcnt vmcnt(0)
    v_cmp_ne_u32 vcc, 0, v96
    s_cbranch_scc1 L_back65
    s_cbranch_vccz L_back65
    s_sleep 2
    s_branch L_spin64_l
L_spin66:
    s_mov_b32 s40, 0x20000
L_spin66_l:
    buffer_load_dword v13, v8, s[16:19], s47 offen sc1
    s_sub_u32 s40, s40, 1
    s_waitcnt vmcnt(0)
    v_cmp_ne_u32 vcc, 0, v13
    s_cbranch_scc1 L_back67
    s_cbranch_vccz L_back67
    s_sleep 2
    s_branch L_spin66_l
L_spin68:
    s_mov_b32 s40, 0x20000
L_spin68_l:
    buffer_load_dword v13, v8, s[16:19], s47 offen sc1
    s_sub_u32 s40, s40, 1
    s_waitcnt vmcnt(0)
    v_cmp_ne_u32 vcc, 0, v13
    s_cbranch_scc1 L_back69
    s_cbranch_vccz L_back69
    s_sleep 2
    s_branch L_spin68_l
L_role_60:
    s_sub_u32 s35, s34, 44
    s_barrier
    s_add_u32 s12, s72, 0x400000
    s_addc_u32 s13, s73, 0
    s_mov_b32 s14, 0x300000
    s_mov_b32 s15, 0x00020000
    s_sub_u32 s37, s35, 12
    s_lshl2_add_u32 s37, s37, s33
    s_lshl2_add_u32 s37, s37, s32
    s_lshl_b32 s37, s37, 13
    v_lshlrev_b32 v6, 7, v0
    buffer_load_dword v240, v6, s[12:15], s37 offen
    s_add_u32 s37, s37, 1048576
    buffer_load_dword v241, v6, s[12:15], s37 offen
    s_add_u32 s37, s37, 1048576
    buffer_load_dword v242, v6, s[12:15], s37 offen
    s_add_u32 s37, s37, 1048576
    s_lshr_b32 s51, s35, 2
    s_and_b32 s87, s35, 3
    s_mul_i32 s54, s51, 1441792
    s_lshl_b32 s37, s87, 9
    s_add_u32 s54, s54, s37
    s_mov_b32 s12, s76
    s_mov_b32 s13, s77
    s_mov_b32 s14, 0x700000
    s_mov_b32 s15, 0x00020000
    s_mov_b32 s39, 2048
    s_cmp_lg_u32 s32, 0
    s_cbranch_scc1 L_arv70
    s_add_u32 s20, s82, 0x80
    s_addc_u32 s21, s83, 0
    s_mov_b32 s22, 0x4
    s_mov_b32 s23, 0x00020000
    buffer_load_dword v48, v124, s[20:23], 0 offen sc1
    s_waitcnt vmcnt(0)
    v_cmp_eq_u32 vcc, v124, v48
    s_cbranch_vccnz L_spin71
L_back72:
L_arv70:
    s_and_b32 s38, s34, 15
    s_lshl_b32 s37, s33, 6
    s_add_u32 s37, s37, s38
    s_lshl_b32 s37, s37, 7
    v_lshl_add_u32 v48, v0, 7, s37
    s_cmp_eq_u32 s32, 0
    s_cselect_b32 s37, 1, 0
    v_cmp_le_u32 vcc, s37, v0
    s_nop 1
    v_cndmask_b32 v48, v48, 2.0, vcc
    s_mov_b32 s38, 0x5520000
    buffer_load_dword v49, v48, s[16:19], s38 offen sc1
    s_waitcnt vmcnt(0)
    v_cmp_ne_u32 vcc, 0, v49
    s_cbranch_vccnz L_spin73
L_back74:
    s_barrier
    v_lshrrev_b32 v64, 3, v0
    v_lshlrev_b32 v65, 2, v0
    v_and_b32 v65, 64, v65
    v_and_b32 v66, 0x70, v1
    v_xor_b32 v65, v65, v66
    v_mad_u32_u24 v48, v64, s39, v65
    v_add_u32 v49, 16384, v48
    v_add_u32 v50, 128, v48
    v_add_u32 v51, 16512, v48
    v_add_u32 v52, 256, v48
    v_add_u32 v53, 16640, v48
    v_add_u32 v54, 384, v48
    v_add_u32 v55, 16768, v48
    s_mul_i32 s38, s32, 32768
    s_add_u32 s54, s54, s38
    s_lshl_b32 s42, s32, 11
    s_add_u32 m0, s42, 0
    s_nop 0
    buffer_load_dwordx4 v48, s[12:15], s54 offen lds
    s_add_u32 m0, s42, 1024
    s_nop 0
    buffer_load_dwordx4 v49, s[12:15], s54 offen lds
    s_add_u32 m0, s42, 8192
    s_nop 0
    buffer_load_dwordx4 v50, s[12:15], s54 offen lds
    s_add_u32 m0, s42, 9216
    s_nop 0
    buffer_load_dwordx4 v51, s[12:15], s54 offen lds
    s_add_u32 m0, s42, 16384
    s_nop 0
    buffer_load_dwordx4 v52, s[12:15], s54 offen lds
    s_add_u32 m0, s42, 17408
    s_nop 0
    buffer_load_dwordx4 v53, s[12:15], s54 offen lds
    s_add_u32 m0, s42, 24576
    s_nop 0
    buffer_load_dwordx4 v54, s[12:15], s54 offen lds
    s_add_u32 m0, s42, 25600
    s_nop 0
    buffer_load_dwordx4 v55, s[12:15], s54 offen lds
    s_add_u32 s54, s54, 131072
    s_add_u32 m0, s42, 32768
    s_nop 0
    buffer_load_dwordx4 v48, s[12:15], s54 offen lds
    s_add_u32 m0, s42, 33792
    s_nop 0
    buffer_load_dwordx4 v49, s[12:15], s54 offen lds
    s_add_u32 m0, s42, 40960
    s_nop 0
    buffer_load_dwordx4 v50, s[12:15], s54 offen lds
    s_add_u32 m0, s42, 41984
    s_nop 0
    buffer_load_dwordx4 v51, s[12:15], s54 offen lds
    s_add_u32 m0, s42, 49152
    s_nop 0
    buffer_load_dwordx4 v52, s[12:15], s54 offen lds
    s_add_u32 m0, s42, 50176
    s_nop 0
    buffer_load_dwordx4 v53, s[12:15], s54 offen lds
    s_add_u32 m0, s42, 57344
    s_nop 0
    buffer_load_dwordx4 v54, s[12:15], s54 offen lds
    s_add_u32 m0, s42, 58368
    s_nop 0
    buffer_load_dwordx4 v55, s[12:15], s54 offen lds
    s_add_u32 s54, s54, 131072
    s_add_u32 m0, s42, 65536
    s_nop 0
    buffer_load_dwordx4 v48, s[12:15], s54 offen lds
    s_add_u32 m0, s42, 66560
    s_nop 0
    buffer_load_dwordx4 v49, s[12:15], s54 offen lds
    s_add_u32 m0, s42, 73728
    s_nop 0
    buffer_load_dwordx4 v50, s[12:15], s54 offen lds
    s_add_u32 m0, s42, 74752
    s_nop 0
    buffer_load_dwordx4 v51, s[12:15], s54 offen lds
    s_add_u32 m0, s42, 81920
    s_nop 0
    buffer_load_dwordx4 v52, s[12:15], s54 offen lds
    s_add_u32 m0, s42, 82944
    s_nop 0
    buffer_load_dwordx4 v53, s[12:15], s54 offen lds
    s_add_u32 m0, s42, 90112
    s_nop 0
    buffer_load_dwordx4 v54, s[12:15], s54 offen lds
    s_add_u32 m0, s42, 91136
    s_nop 0
    buffer_load_dwordx4 v55, s[12:15], s54 offen lds
    s_add_u32 s54, s54, 131072
    s_add_u32 m0, s42, 98304
    s_nop 0
    buffer_load_dwordx4 v48, s[12:15], s54 offen lds
    s_add_u32 m0, s42, 99328
    s_nop 0
    buffer_load_dwordx4 v49, s[12:15], s54 offen lds
    s_add_u32 m0, s42, 106496
    s_nop 0
    buffer_load_dwordx4 v50, s[12:15], s54 offen lds
    s_add_u32 m0, s42, 107520
    s_nop 0
    buffer_load_dwordx4 v51, s[12:15], s54 offen lds
    s_add_u32 m0, s42, 114688
    s_nop 0
    buffer_load_dwordx4 v52, s[12:15], s54 offen lds
    s_add_u32 m0, s42, 115712
    s_nop 0
    buffer_load_dwordx4 v53, s[12:15], s54 offen lds
    s_add_u32 m0, s42, 122880
    s_nop 0
    buffer_load_dwordx4 v54, s[12:15], s54 offen lds
    s_add_u32 m0, s42, 123904
    s_nop 0
    buffer_load_dwordx4 v55, s[12:15], s54 offen lds
    s_add_u32 s54, s54, 131072
    v_lshrrev_b32 v64, 4, v0
    v_bfe_u32 v65, v0, 2, 2
    v_lshl_add_u32 v64, v64, 3, v65
    v_lshlrev_b32 v64, 7, v64
    v_lshrrev_b32 v65, 1, v65
    v_lshl_add_u32 v64, v65, 6, v64
    v_and_b32 v65, 3, v0
    v_lshl_add_u32 v64, v65, 4, v64
    s_lshl_b32 s37, s32, 13
    s_and_b32 s38, s51, 2
    s_lshl_b32 s38, s38, 5
    s_xor_b32 s38, s38, 0
    s_add_u32 s37, s37, s38
    v_xor_b32 v56, s37, v64
    s_lshl_b32 s37, s32, 13
    s_and_b32 s38, s51, 2
    s_lshl_b32 s38, s38, 5
    s_xor_b32 s38, s38, 8
    s_add_u32 s37, s37, s38
    v_xor_b32 v57, s37, v64
    s_lshl_b32 s37, s32, 13
    s_and_b32 s38, s51, 2
    s_lshl_b32 s38, s38, 5
    s_xor_b32 s38, s38, 64
    s_add_u32 s37, s37, s38
    v_xor_b32 v58, s37, v64
    s_lshl_b32 s37, s32, 13
    s_and_b32 s38, s51, 2
    s_lshl_b32 s38, s38, 5
    s_xor_b32 s38, s38, 72
    s_add_u32 s37, s37, s38
    v_xor_b32 v59, s37, v64
    s_and_b32 s39, s51, 1
    s_lshl_b32 s37, s39, 10
    v_add_u32 v2, s37, v1
    v_xor_b32 v3, 1024, v2
    v_add_u32 v4, 98304, v2
    v_add_u32 v5, 98304, v3
    s_mul_i32 s38, s51, 11*43
    s_lshr_b32 s38, s38, 7
    s_add_u32 s38, s38, 24
    s_lshl_b32 s37, s33, 6
    s_add_u32 s37, s37, s38
    s_lshl_b32 s37, s37, 7
    v_lshl_add_u32 v6, v0, 7, s37
    s_cmp_eq_u32 s32, 0
    s_cselect_b32 s37, 6, 0
    v_cmp_le_u32 vcc, s37, v0
    s_nop 1
    v_cndmask_b32 v6, v6, 2.0, vcc
    s_mul_i32 s43, s32, 3072
    s_lshl_b32 s88, s32, 11
    s_sub_u32 s89, s88, s43
    s_mul_i32 s41, s33, 8388608
    s_add_u32 s41, s41, 0x1000000
    s_mul_i32 s37, s51, 45056
    s_add_u32 s41, s41, s37
    s_add_u32 s41, s41, s43
    s_mul_i32 s90, s33, 8388608
    s_add_u32 s90, s90, 0x2fc0000
    s_lshl_b32 s37, s87, 16
    s_add_u32 s90, s90, s37
    s_lshl_b32 s37, s32, 12
    s_add_u32 s90, s90, s37
    s_and_b32 s37, s51, 3
    s_lshl_b32 s37, s37, 14
    s_add_u32 s90, s90, s37
    v_add_u32 v60, 0, v56
    v_add_u32 v61, 0, v57
    v_add_u32 v62, 0, v58
    v_add_u32 v63, 0, v59
    s_waitcnt vmcnt(24)
    s_barrier
    ds_read_b64_tr_b16 a[0:1], v60 offset:0
    ds_read_b64_tr_b16 a[2:3], v60 offset:512
    ds_read_b64_tr_b16 a[4:5], v61 offset:0
    ds_read_b64_tr_b16 a[6:7], v61 offset:512
    ds_read_b64_tr_b16 a[8:9], v62 offset:0
    ds_read_b64_tr_b16 a[10:11], v62 offset:512
    ds_read_b64_tr_b16 a[12:13], v63 offset:0
    ds_read_b64_tr_b16 a[14:15], v63 offset:512
    ds_read_b64_tr_b16 a[16:17], v60 offset:4096
    ds_read_b64_tr_b16 a[18:19], v60 offset:4608
    ds_read_b64_tr_b16 a[20:21], v61 offset:4096
    ds_read_b64_tr_b16 a[22:23], v61 offset:4608
    ds_read_b64_tr_b16 a[24:25], v62 offset:4096
    ds_read_b64_tr_b16 a[26:27], v62 offset:4608
    ds_read_b64_tr_b16 a[28:29], v63 offset:4096
    ds_read_b64_tr_b16 a[30:31], v63 offset:4608
    s_add_u32 m0, s42, 131072
    s_nop 0
    buffer_load_dwordx4 v48, s[12:15], s54 offen lds
    s_add_u32 m0, s42, 132096
    s_nop 0
    buffer_load_dwordx4 v49, s[12:15], s54 offen lds
    s_add_u32 m0, s42, 139264
    s_nop 0
    buffer_load_dwordx4 v50, s[12:15], s54 offen lds
    s_add_u32 m0, s42, 140288
    s_nop 0
    buffer_load_dwordx4 v51, s[12:15], s54 offen lds
    s_add_u32 m0, s42, 147456
    s_nop 0
    buffer_load_dwordx4 v52, s[12:15], s54 offen lds
    s_add_u32 m0, s42, 148480
    s_nop 0
    buffer_load_dwordx4 v53, s[12:15], s54 offen lds
    s_add_u32 m0, s42, 155648
    s_nop 0
    buffer_load_dwordx4 v54, s[12:15], s54 offen lds
    s_add_u32 m0, s42, 156672
    s_nop 0
    buffer_load_dwordx4 v55, s[12:15], s54 offen lds
    s_add_u32 s54, s54, 131072
    s_waitcnt lgkmcnt(0)
    v_add_u32 v60, 32768, v56
    v_add_u32 v61, 32768, v57
    v_add_u32 v62, 32768, v58
    v_add_u32 v63, 32768, v59
    s_waitcnt vmcnt(24)
    s_barrier
    ds_read_b64_tr_b16 a[32:33], v60 offset:0
    ds_read_b64_tr_b16 a[34:35], v60 offset:512
    ds_read_b64_tr_b16 a[36:37], v61 offset:0
    ds_read_b64_tr_b16 a[38:39], v61 offset:512
    ds_read_b64_tr_b16 a[40:41], v62 offset:0
    ds_read_b64_tr_b16 a[42:43], v62 offset:512
    ds_read_b64_tr_b16 a[44:45], v63 offset:0
    ds_read_b64_tr_b16 a[46:47], v63 offset:512
    ds_read_b64_tr_b16 a[48:49], v60 offset:4096
    ds_read_b64_tr_b16 a[50:51], v60 offset:4608
    ds_read_b64_tr_b16 a[52:53], v61 offset:4096
    ds_read_b64_tr_b16 a[54:55], v61 offset:4608
    ds_read_b64_tr_b16 a[56:57], v62 offset:4096
    ds_read_b64_tr_b16 a[58:59], v62 offset:4608
    ds_read_b64_tr_b16 a[60:61], v63 offset:4096
    ds_read_b64_tr_b16 a[62:63], v63 offset:4608
    s_add_u32 m0, s42, 0
    s_nop 0
    buffer_load_dwordx4 v48, s[12:15], s54 offen lds
    s_add_u32 m0, s42, 1024
    s_nop 0
    buffer_load_dwordx4 v49, s[12:15], s54 offen lds
    s_add_u32 m0, s42, 8192
    s_nop 0
    buffer_load_dwordx4 v50, s[12:15], s54 offen lds
    s_add_u32 m0, s42, 9216
    s_nop 0
    buffer_load_dwordx4 v51, s[12:15], s54 offen lds
    s_add_u32 m0, s42, 16384
    s_nop 0
    buffer_load_dwordx4 v52, s[12:15], s54 offen lds
    s_add_u32 m0, s42, 17408
    s_nop 0
    buffer_load_dwordx4 v53, s[12:15], s54 offen lds
    s_add_u32 m0, s42, 24576
    s_nop 0
    buffer_load_dwordx4 v54, s[12:15], s54 offen lds
    s_add_u32 m0, s42, 25600
    s_nop 0
    buffer_load_dwordx4 v55, s[12:15], s54 offen lds
    s_add_u32 s54, s54, 131072
    s_waitcnt lgkmcnt(0)
    v_add_u32 v60, 65536, v56
    v_add_u32 v61, 65536, v57
    v_add_u32 v62, 65536, v58
    v_add_u32 v63, 65536, v59
    s_waitcnt vmcnt(24)
    s_barrier
    ds_read_b64_tr_b16 a[64:65], v60 offset:0
    ds_read_b64_tr_b16 a[66:67], v60 offset:512
    ds_read_b64_tr_b16 a[68:69], v61 offset:0
    ds_read_b64_tr_b16 a[70:71], v61 offset:512
    ds_read_b64_tr_b16 a[72:73], v62 offset:0
    ds_read_b64_tr_b16 a[74:75], v62 offset:512
    ds_read_b64_tr_b16 a[76:77], v63 offset:0
    ds_read_b64_tr_b16 a[78:79], v63 offset:512
    ds_read_b64_tr_b16 a[80:81], v60 offset:4096
    ds_read_b64_tr_b16 a[82:83], v60 offset:4608
    ds_read_b64_tr_b16 a[84:85], v61 offset:4096
    ds_read_b64_tr_b16 a[86:87], v61 offset:4608
    ds_read_b64_tr_b16 a[88:89], v62 offset:4096
    ds_read_b64_tr_b16 a[90:91], v62 offset:4608
    ds_read_b64_tr_b16 a[92:93], v63 offset:4096
    ds_read_b64_tr_b16 a[94:95], v63 offset:4608
    s_add_u32 m0, s42, 32768
    s_nop 0
    buffer_load_dwordx4 v48, s[12:15], s54 offen lds
    s_add_u32 m0, s42, 33792
    s_nop 0
    buffer_load_dwordx4 v49, s[12:15], s54 offen lds
    s_add_u32 m0, s42, 40960
    s_nop 0
    buffer_load_dwordx4 v50, s[12:15], s54 offen lds
    s_add_u32 m0, s42, 41984
    s_nop 0
    buffer_load_dwordx4 v51, s[12:15], s54 offen lds
    s_add_u32 m0, s42, 49152
    s_nop 0
    buffer_load_dwordx4 v52, s[12:15], s54 offen lds
    s_add_u32 m0, s42, 50176
    s_nop 0
    buffer_load_dwordx4 v53, s[12:15], s54 offen lds
    s_add_u32 m0, s42, 57344
    s_nop 0
    buffer_load_dwordx4 v54, s[12:15], s54 offen lds
    s_add_u32 m0, s42, 58368
    s_nop 0
    buffer_load_dwordx4 v55, s[12:15], s54 offen lds
    s_add_u32 s54, s54, 131072
    s_waitcnt lgkmcnt(0)
    v_add_u32 v60, 98304, v56
    v_add_u32 v61, 98304, v57
    v_add_u32 v62, 98304, v58
    v_add_u32 v63, 98304, v59
    s_waitcnt vmcnt(24)
    s_barrier
    ds_read_b64_tr_b16 a[96:97], v60 offset:0
    ds_read_b64_tr_b16 a[98:99], v60 offset:512
    ds_read_b64_tr_b16 a[100:101], v61 offset:0
    ds_read_b64_tr_b16 a[102:103], v61 offset:512
    ds_read_b64_tr_b16 a[104:105], v62 offset:0
    ds_read_b64_tr_b16 a[106:107], v62 offset:512
    ds_read_b64_tr_b16 a[108:109], v63 offset:0
    ds_read_b64_tr_b16 a[110:111], v63 offset:512
    ds_read_b64_tr_b16 a[112:113], v60 offset:4096
    ds_read_b64_tr_b16 a[114:115], v60 offset:4608
    ds_read_b64_tr_b16 a[116:117], v61 offset:4096
    ds_read_b64_tr_b16 a[118:119], v61 offset:4608
    ds_read_b64_tr_b16 a[120:121], v62 offset:4096
    ds_read_b64_tr_b16 a[122:123], v62 offset:4608
    ds_read_b64_tr_b16 a[124:125], v63 offset:4096
    ds_read_b64_tr_b16 a[126:127], v63 offset:4608
    s_add_u32 m0, s42, 65536
    s_nop 0
    buffer_load_dwordx4 v48, s[12:15], s54 offen lds
    s_add_u32 m0, s42, 66560
    s_nop 0
    buffer_load_dwordx4 v49, s[12:15], s54 offen lds
    s_add_u32 m0, s42, 73728
    s_nop 0
    buffer_load_dwordx4 v50, s[12:15], s54 offen lds
    s_add_u32 m0, s42, 74752
    s_nop 0
    buffer_load_dwordx4 v51, s[12:15], s54 offen lds
    s_add_u32 m0, s42, 81920
    s_nop 0
    buffer_load_dwordx4 v52, s[12:15], s54 offen lds
    s_add_u32 m0, s42, 82944
    s_nop 0
    buffer_load_dwordx4 v53, s[12:15], s54 offen lds
    s_add_u32 m0, s42, 90112
    s_nop 0
    buffer_load_dwordx4 v54, s[12:15], s54 offen lds
    s_add_u32 m0, s42, 91136
    s_nop 0
    buffer_load_dwordx4 v55, s[12:15], s54 offen lds
    s_add_u32 s54, s54, 131072
    s_waitcnt lgkmcnt(0)
    v_add_u32 v60, 131072, v56
    v_add_u32 v61, 131072, v57
    v_add_u32 v62, 131072, v58
    v_add_u32 v63, 131072, v59
    s_waitcnt vmcnt(24)
    s_barrier
    ds_read_b64_tr_b16 a[128:129], v60 offset:0
    ds_read_b64_tr_b16 a[130:131], v60 offset:512
    ds_read_b64_tr_b16 a[132:133], v61 offset:0
    ds_read_b64_tr_b16 a[134:135], v61 offset:512
    ds_read_b64_tr_b16 a[136:137], v62 offset:0
    ds_read_b64_tr_b16 a[138:139], v62 offset:512
    ds_read_b64_tr_b16 a[140:141], v63 offset:0
    ds_read_b64_tr_b16 a[142:143], v63 offset:512
    ds_read_b64_tr_b16 a[144:145], v60 offset:4096
    ds_read_b64_tr_b16 a[146:147], v60 offset:4608
    ds_read_b64_tr_b16 a[148:149], v61 offset:4096
    ds_read_b64_tr_b16 a[150:151], v61 offset:4608
    ds_read_b64_tr_b16 a[152:153], v62 offset:4096
    ds_read_b64_tr_b16 a[154:155], v62 offset:4608
    ds_read_b64_tr_b16 a[156:157], v63 offset:4096
    ds_read_b64_tr_b16 a[158:159], v63 offset:4608
    s_add_u32 m0, s42, 98304
    s_nop 0
    buffer_load_dwordx4 v48, s[12:15], s54 offen lds
    s_add_u32 m0, s42, 99328
    s_nop 0
    buffer_load_dwordx4 v49, s[12:15], s54 offen lds
    s_add_u32 m0, s42, 106496
    s_nop 0
    buffer_load_dwordx4 v50, s[12:15], s54 offen lds
    s_add_u32 m0, s42, 107520
    s_nop 0
    buffer_load_dwordx4 v51, s[12:15], s54 offen lds
    s_add_u32 m0, s42, 114688
    s_nop 0
    buffer_load_dwordx4 v52, s[12:15], s54 offen lds
    s_add_u32 m0, s42, 115712
    s_nop 0
    buffer_load_dwordx4 v53, s[12:15], s54 offen lds
    s_add_u32 m0, s42, 122880
    s_nop 0
    buffer_load_dwordx4 v54, s[12:15], s54 offen lds
    s_add_u32 m0, s42, 123904
    s_nop 0
    buffer_load_dwordx4 v55, s[12:15], s54 offen lds
    s_add_u32 s54, s54, 131072
    s_waitcnt lgkmcnt(0)
    v_add_u32 v60, 0, v56
    v_add_u32 v61, 0, v57
    v_add_u32 v62, 0, v58
    v_add_u32 v63, 0, v59
    s_waitcnt vmcnt(24)
    s_barrier
    ds_read_b64_tr_b16 a[160:161], v60 offset:0
    ds_read_b64_tr_b16 a[162:163], v60 offset:512
    ds_read_b64_tr_b16 a[164:165], v61 offset:0
    ds_read_b64_tr_b16 a[166:167], v61 offset:512
    ds_read_b64_tr_b16 a[168:169], v62 offset:0
    ds_read_b64_tr_b16 a[170:171], v62 offset:512
    ds_read_b64_tr_b16 a[172:173], v63 offset:0
    ds_read_b64_tr_b16 a[174:175], v63 offset:512
    ds_read_b64_tr_b16 a[176:177], v60 offset:4096
    ds_read_b64_tr_b16 a[178:179], v60 offset:4608
    ds_read_b64_tr_b16 a[180:181], v61 offset:4096
    ds_read_b64_tr_b16 a[182:183], v61 offset:4608
    ds_read_b64_tr_b16 a[184:185], v62 offset:4096
    ds_read_b64_tr_b16 a[186:187], v62 offset:4608
    ds_read_b64_tr_b16 a[188:189], v63 offset:4096
    ds_read_b64_tr_b16 a[190:191], v63 offset:4608
    s_add_u32 m0, s42, 131072
    s_nop 0
    buffer_load_dwordx4 v48, s[12:15], s54 offen lds
    s_add_u32 m0, s42, 132096
    s_nop 0
    buffer_load_dwordx4 v49, s[12:15], s54 offen lds
    s_add_u32 m0, s42, 139264
    s_nop 0
    buffer_load_dwordx4 v50, s[12:15], s54 offen lds
    s_add_u32 m0, s42, 140288
    s_nop 0
    buffer_load_dwordx4 v51, s[12:15], s54 offen lds
    s_add_u32 m0, s42, 147456
    s_nop 0
    buffer_load_dwordx4 v52, s[12:15], s54 offen lds
    s_add_u32 m0, s42, 148480
    s_nop 0
    buffer_load_dwordx4 v53, s[12:15], s54 offen lds
    s_add_u32 m0, s42, 155648
    s_nop 0
    buffer_load_dwordx4 v54, s[12:15], s54 offen lds
    s_add_u32 m0, s42, 156672
    s_nop 0
    buffer_load_dwordx4 v55, s[12:15], s54 offen lds
    s_add_u32 s54, s54, 131072
    s_waitcnt lgkmcnt(0)
    v_add_u32 v60, 32768, v56
    v_add_u32 v61, 32768, v57
    v_add_u32 v62, 32768, v58
    v_add_u32 v63, 32768, v59
    s_waitcnt vmcnt(24)
    s_barrier
    ds_read_b64_tr_b16 a[192:193], v60 offset:0
    ds_read_b64_tr_b16 a[194:195], v60 offset:512
    ds_read_b64_tr_b16 a[196:197], v61 offset:0
    ds_read_b64_tr_b16 a[198:199], v61 offset:512
    ds_read_b64_tr_b16 a[200:201], v62 offset:0
    ds_read_b64_tr_b16 a[202:203], v62 offset:512
    ds_read_b64_tr_b16 a[204:205], v63 offset:0
    ds_read_b64_tr_b16 a[206:207], v63 offset:512
    ds_read_b64_tr_b16 a[208:209], v60 offset:4096
    ds_read_b64_tr_b16 a[210:211], v60 offset:4608
    ds_read_b64_tr_b16 a[212:213], v61 offset:4096
    ds_read_b64_tr_b16 a[214:215], v61 offset:4608
    ds_read_b64_tr_b16 a[216:217], v62 offset:4096
    ds_read_b64_tr_b16 a[218:219], v62 offset:4608
    ds_read_b64_tr_b16 a[220:221], v63 offset:4096
    ds_read_b64_tr_b16 a[222:223], v63 offset:4608
    s_add_u32 m0, s42, 0
    s_nop 0
    buffer_load_dwordx4 v48, s[12:15], s54 offen lds
    s_add_u32 m0, s42, 1024
    s_nop 0
    buffer_load_dwordx4 v49, s[12:15], s54 offen lds
    s_add_u32 m0, s42, 8192
    s_nop 0
    buffer_load_dwordx4 v50, s[12:15], s54 offen lds
    s_add_u32 m0, s42, 9216
    s_nop 0
    buffer_load_dwordx4 v51, s[12:15], s54 offen lds
    s_add_u32 m0, s42, 16384
    s_nop 0
    buffer_load_dwordx4 v52, s[12:15], s54 offen lds
    s_add_u32 m0, s42, 17408
    s_nop 0
    buffer_load_dwordx4 v53, s[12:15], s54 offen lds
    s_add_u32 m0, s42, 24576
    s_nop 0
    buffer_load_dwordx4 v54, s[12:15], s54 offen lds
    s_add_u32 m0, s42, 25600
    s_nop 0
    buffer_load_dwordx4 v55, s[12:15], s54 offen lds
    s_add_u32 s54, s54, 131072
    s_waitcnt lgkmcnt(0)
    v_add_u32 v60, 65536, v56
    v_add_u32 v61, 65536, v57
    v_add_u32 v62, 65536, v58
    v_add_u32 v63, 65536, v59
    s_waitcnt vmcnt(24)
    s_barrier
    ds_read_b64_tr_b16 a[224:225], v60 offset:0
    ds_read_b64_tr_b16 a[226:227], v60 offset:512
    ds_read_b64_tr_b16 a[228:229], v61 offset:0
    ds_read_b64_tr_b16 a[230:231], v61 offset:512
    ds_read_b64_tr_b16 a[232:233], v62 offset:0
    ds_read_b64_tr_b16 a[234:235], v62 offset:512
    ds_read_b64_tr_b16 a[236:237], v63 offset:0
    ds_read_b64_tr_b16 a[238:239], v63 offset:512
    ds_read_b64_tr_b16 a[240:241], v60 offset:4096
    ds_read_b64_tr_b16 a[242:243], v60 offset:4608
    ds_read_b64_tr_b16 a[244:245], v61 offset:4096
    ds_read_b64_tr_b16 a[246:247], v61 offset:4608
    ds_read_b64_tr_b16 a[248:249], v62 offset:4096
    ds_read_b64_tr_b16 a[250:251], v62 offset:4608
    ds_read_b64_tr_b16 a[252:253], v63 offset:4096
    ds_read_b64_tr_b16 a[254:255], v63 offset:4608
    s_add_u32 m0, s42, 32768
    s_nop 0
    buffer_load_dwordx4 v48, s[12:15], s54 offen lds
    s_add_u32 m0, s42, 33792
    s_nop 0
    buffer_load_dwordx4 v49, s[12:15], s54 offen lds
    s_add_u32 m0, s42, 40960
    s_nop 0
    buffer_load_dwordx4 v50, s[12:15], s54 offen lds
    s_add_u32 m0, s42, 41984
    s_nop 0
    buffer_load_dwordx4 v51, s[12:15], s54 offen lds
    s_add_u32 m0, s42, 49152
    s_nop 0
    buffer_load_dwordx4 v52, s[12:15], s54 offen lds
    s_add_u32 m0, s42, 50176
    s_nop 0
    buffer_load_dwordx4 v53, s[12:15], s54 offen lds
    s_add_u32 m0, s42, 57344
    s_nop 0
    buffer_load_dwordx4 v54, s[12:15], s54 offen lds
    s_add_u32 m0, s42, 58368
    s_nop 0
    buffer_load_dwordx4 v55, s[12:15], s54 offen lds
    s_add_u32 s54, s54, 131072
    s_waitcnt lgkmcnt(0)
    v_add_u32 v60, 98304, v56
    v_add_u32 v61, 98304, v57
    v_add_u32 v62, 98304, v58
    v_add_u32 v63, 98304, v59
    s_waitcnt vmcnt(24)
    s_barrier
    ds_read_b64_tr_b16 v[128:129], v60 offset:0
    ds_read_b64_tr_b16 v[130:131], v60 offset:512
    ds_read_b64_tr_b16 v[132:133], v61 offset:0
    ds_read_b64_tr_b16 v[134:135], v61 offset:512
    ds_read_b64_tr_b16 v[136:137], v62 offset:0
    ds_read_b64_tr_b16 v[138:139], v62 offset:512
    ds_read_b64_tr_b16 v[140:141], v63 offset:0
    ds_read_b64_tr_b16 v[142:143], v63 offset:512
    ds_read_b64_tr_b16 v[144:145], v60 offset:4096
    ds_read_b64_tr_b16 v[146:147], v60 offset:4608
    ds_read_b64_tr_b16 v[148:149], v61 offset:4096
    ds_read_b64_tr_b16 v[150:151], v61 offset:4608
    ds_read_b64_tr_b16 v[152:153], v62 offset:4096
    ds_read_b64_tr_b16 v[154:155], v62 offset:4608
    ds_read_b64_tr_b16 v[156:157], v63 offset:4096
    ds_read_b64_tr_b16 v[158:159], v63 offset:4608
    s_waitcnt lgkmcnt(0)
    v_add_u32 v60, 131072, v56
    v_add_u32 v61, 131072, v57
    v_add_u32 v62, 131072, v58
    v_add_u32 v63, 131072, v59
    s_waitcnt vmcnt(16)
    s_barrier
    ds_read_b64_tr_b16 v[160:161], v60 offset:0
    ds_read_b64_tr_b16 v[162:163], v60 offset:512
    ds_read_b64_tr_b16 v[164:165], v61 offset:0
    ds_read_b64_tr_b16 v[166:167], v61 offset:512
    ds_read_b64_tr_b16 v[168:169], v62 offset:0
    ds_read_b64_tr_b16 v[170:171], v62 offset:512
    ds_read_b64_tr_b16 v[172:173], v63 offset:0
    ds_read_b64_tr_b16 v[174:175], v63 offset:512
    ds_read_b64_tr_b16 v[176:177], v60 offset:4096
    ds_read_b64_tr_b16 v[178:179], v60 offset:4608
    ds_read_b64_tr_b16 v[180:181], v61 offset:4096
    ds_read_b64_tr_b16 v[182:183], v61 offset:4608
    ds_read_b64_tr_b16 v[184:185], v62 offset:4096
    ds_read_b64_tr_b16 v[186:187], v62 offset:4608
    ds_read_b64_tr_b16 v[188:189], v63 offset:4096
    ds_read_b64_tr_b16 v[190:191], v63 offset:4608
    s_waitcnt lgkmcnt(0)
    v_add_u32 v60, 0, v56
    v_add_u32 v61, 0, v57
    v_add_u32 v62, 0, v58
    v_add_u32 v63, 0, v59
    s_waitcnt vmcnt(8)
    s_barrier
    ds_read_b64_tr_b16 v[192:193], v60 offset:0
    ds_read_b64_tr_b16 v[194:195], v60 offset:512
    ds_read_b64_tr_b16 v[196:197], v61 offset:0
    ds_read_b64_tr_b16 v[198:199], v61 offset:512
    ds_read_b64_tr_b16 v[200:201], v62 offset:0
    ds_read_b64_tr_b16 v[202:203], v62 offset:512
    ds_read_b64_tr_b16 v[204:205], v63 offset:0
    ds_read_b64_tr_b16 v[206:207], v63 offset:512
    ds_read_b64_tr_b16 v[208:209], v60 offset:4096
    ds_read_b64_tr_b16 v[210:211], v60 offset:4608
    ds_read_b64_tr_b16 v[212:213], v61 offset:4096
    ds_read_b64_tr_b16 v[214:215], v61 offset:4608
    ds_read_b64_tr_b16 v[216:217], v62 offset:4096
    ds_read_b64_tr_b16 v[218:219], v62 offset:4608
    ds_read_b64_tr_b16 v[220:221], v63 offset:4096
    ds_read_b64_tr_b16 v[222:223], v63 offset:4608
    s_waitcnt lgkmcnt(0)
    v_add_u32 v60, 32768, v56
    v_add_u32 v61, 32768, v57
    v_add_u32 v62, 32768, v58
    v_add_u32 v63, 32768, v59
    s_waitcnt vmcnt(0)
    s_barrier
    ds_read_b64_tr_b16 v[224:225], v60 offset:0
    ds_read_b64_tr_b16 v[226:227], v60 offset:512
    ds_read_b64_tr_b16 v[228:229], v61 offset:0
    ds_read_b64_tr_b16 v[230:231], v61 offset:512
    ds_read_b64_tr_b16 v[232:233], v62 offset:0
    ds_read_b64_tr_b16 v[234:235], v62 offset:512
    ds_read_b64_tr_b16 v[236:237], v63 offset:0
    ds_read_b64_tr_b16 v[238:239], v63 offset:512
    ds_read_b64_tr_b16 v[240:241], v60 offset:4096
    ds_read_b64_tr_b16 v[242:243], v60 offset:4608
    ds_read_b64_tr_b16 v[244:245], v61 offset:4096
    ds_read_b64_tr_b16 v[246:247], v61 offset:4608
    ds_read_b64_tr_b16 v[248:249], v62 offset:4096
    ds_read_b64_tr_b16 v[250:251], v62 offset:4608
    ds_read_b64_tr_b16 v[252:253], v63 offset:4096
    ds_read_b64_tr_b16 v[254:255], v63 offset:4608
    s_waitcnt lgkmcnt(0)
    s_barrier
    s_cmp_lg_u32 s32, 0
    s_cbranch_scc1 L_arv75
    s_add_u32 s20, s82, 0x80
    s_addc_u32 s21, s83, 0
    s_mov_b32 s22, 0x4
    s_mov_b32 s23, 0x00020000
    buffer_load_dword v80, v124, s[20:23], 0 offen sc1
    s_waitcnt vmcnt(0)
    v_cmp_eq_u32 vcc, v124, v80
    s_cbranch_vccnz L_spin76
L_back77:
L_arv75:
    s_add_u32 s96, s41, 8126464
    s_mov_b32 s98, s41
    s_mov_b32 s45, 0x5530000
    buffer_load_dword v96, v6, s[16:19], s45 offen sc1
    s_waitcnt vmcnt(0)
    v_cmp_ne_u32 vcc, 0, v96
    s_cbranch_vccnz L_spin78
L_back79:
    s_barrier
    s_add_u32 m0, s43, 0
    s_add_u32 s42, s41, 0
    buffer_load_dwordx4 v1, s[16:19], s42 offen offset:0 sc1 lds
    buffer_load_dwordx4 v1, s[16:19], s42 offen offset:1024 sc1 lds
    buffer_load_dwordx4 v1, s[16:19], s42 offen offset:2048 sc1 lds
    s_add_u32 m0, s43, 12288
    s_add_u32 s42, s41, 12288
    buffer_load_dwordx4 v1, s[16:19], s42 offen offset:0 sc1 lds
    buffer_load_dwordx4 v1, s[16:19], s42 offen offset:1024 sc1 lds
    buffer_load_dwordx4 v1, s[16:19], s42 offen offset:2048 sc1 lds
    s_add_u32 m0, s43, 24576
    s_add_u32 s42, s41, 24576
    buffer_load_dwordx4 v1, s[16:19], s42 offen offset:0 sc1 lds
    buffer_load_dwordx4 v1, s[16:19], s42 offen offset:1024 sc1 lds
    buffer_load_dwordx4 v1, s[16:19], s42 offen offset:2048 sc1 lds
    s_add_u32 s45, s45, 65536
    s_waitcnt vmcnt(0) lgkmcnt(0)
    s_barrier
    s_mov_b32 s52, 0x5e00000
    s_mov_b32 s46, 0x5e00000
    s_add_u32 s20, s84, 0x5e00000
    s_addc_u32 s21, s85, 0
    s_mov_b32 s22, 0x400000
    s_mov_b32 s23, 0x00020000
    ds_read_b128 v[80:83], v2 offset:0
    ds_read_b128 v[84:87], v3 offset:0
    s_mov_b32 s36, 0
    s_waitcnt lgkmcnt(0)
    s_nop 7
L_bs_b0:
    v_mfma_f32_16x16x32_bf16 v[16:19], a[0:3], v[80:83], 0
    s_and_b32 s44, s90, 0xffffffff
    ds_read_b128 v[88:91], v2 offset:2048
    s_cmp_lt_i32 s36, 1
    v_mfma_f32_16x16x32_bf16 v[24:27], a[0:3], v[84:87], 0
    s_cselect_b32 s44, 0x5e00000, s44
    s_xor_b32 s49, s44, 0
    v_cvt_pk_bf16_f32 v48, v48, v49
    v_mfma_f32_16x16x32_bf16 v[28:31], a[4:7], v[84:87], 0
    ds_read_b128 v[92:95], v3 offset:2048
    v_cvt_pk_bf16_f32 v49, v50, v51
    v_mfma_f32_16x16x32_bf16 v[20:23], a[4:7], v[80:83], 0
    v_cvt_pk_bf16_f32 v50, v52, v53
    v_cvt_pk_bf16_f32 v51, v54, v55
    v_mfma_f32_16x16x32_bf16 v[32:35], a[8:11], v[80:83], 0
    buffer_store_dwordx4 v[48:51], v1, s[16:19], s49 offen offset:3072 sc1
    v_mfma_f32_16x16x32_bf16 v[40:43], a[8:11], v[84:87], 0
    s_xor_b32 s49, s44, 16384
    v_cvt_pk_bf16_f32 v56, v56, v57
    v_cvt_pk_bf16_f32 v57, v58, v59
    v_mfma_f32_16x16x32_bf16 v[44:47], a[12:15], v[84:87], 0
    v_cvt_pk_bf16_f32 v58, v60, v61
    v_cvt_pk_bf16_f32 v59, v62, v63
    v_mfma_f32_16x16x32_bf16 v[36:39], a[12:15], v[80:83], 0
    s_waitcnt lgkmcnt(0)
    v_mfma_f32_16x16x32_bf16 v[16:19], a[16:19], v[88:91], v[16:19]
    ds_read_b128 v[80:83], v2 offset:4096
    v_mfma_f32_16x16x32_bf16 v[24:27], a[16:19], v[92:95], v[24:27]
    buffer_store_dwordx4 v[56:59], v1, s[16:19], s49 offen offset:3072 sc1
    v_mfma_f32_16x16x32_bf16 v[28:31], a[20:23], v[92:95], v[28:31]
    s_xor_b32 s49, s44, 32768
    ds_read_b128 v[84:87], v3 offset:4096
    v_cvt_pk_bf16_f32 v64, v64, v65
    v_mfma_f32_16x16x32_bf16 v[20:23], a[20:23], v[88:91], v[20:23]
    v_cvt_pk_bf16_f32 v65, v66, v67
    v_cvt_pk_bf16_f32 v66, v68, v69
    v_mfma_f32_16x16x32_bf16 v[32:35], a[24:27], v[88:91], v[32:35]
    v_cvt_pk_bf16_f32 v67, v70, v71
    v_mfma_f32_16x16x32_bf16 v[40:43], a[24:27], v[92:95], v[40:43]
    buffer_store_dwordx4 v[64:67], v1, s[16:19], s49 offen offset:3072 sc1
    v_mfma_f32_16x16x32_bf16 v[44:47], a[28:31], v[92:95], v[44:47]
    s_xor_b32 s49, s44, 49152
    v_cvt_pk_bf16_f32 v72, v72, v73
    v_cvt_pk_bf16_f32 v73, v74, v75
    v_mfma_f32_16x16x32_bf16 v[36:39], a[28:31], v[88:91], v[36:39]
    s_waitcnt lgkmcnt(0)
    v_cvt_pk_bf16_f32 v74, v76, v77
    v_cvt_pk_bf16_f32 v75, v78, v79
    v_mfma_f32_16x16x32_bf16 v[16:19], a[32:35], v[80:83], v[16:19]
    s_add_u32 m0, s43, 36864
    ds_read_b128 v[88:91], v2 offset:6144
    s_add_u32 s42, s41, 36864
    v_mfma_f32_16x16x32_bf16 v[24:27], a[32:35], v[84:87], v[24:27]
    buffer_store_dwordx4 v[72:75], v1, s[16:19], s49 offen offset:3072 sc1
    v_mfma_f32_16x16x32_bf16 v[28:31], a[36:39], v[84:87], v[28:31]
    s_add_u32 s90, s90, 262144
    ds_read_b128 v[92:95], v3 offset:6144
    v_mfma_f32_16x16x32_bf16 v[20:23], a[36:39], v[80:83], v[20:23]
    v_mfma_f32_16x16x32_bf16 v[32:35], a[40:43], v[80:83], v[32:35]
    buffer_load_dwordx4 v1, s[16:19], s42 offen offset:0 sc1 lds
    v_mfma_f32_16x16x32_bf16 v[40:43], a[40:43], v[84:87], v[40:43]
    v_mfma_f32_16x16x32_bf16 v[44:47], a[44:47], v[84:87], v[44:47]
    v_mfma_f32_16x16x32_bf16 v[36:39], a[44:47], v[80:83], v[36:39]
    s_waitcnt lgkmcnt(0)
    v_mfma_f32_16x16x32_bf16 v[16:19], a[48:51], v[88:91], v[16:19]
    ds_read_b128 v[80:83], v2 offset:8192
    v_mfma_f32_16x16x32_bf16 v[24:27], a[48:51], v[92:95], v[24:27]
    v_mfma_f32_16x16x32_bf16 v[28:31], a[52:55], v[92:95], v[28:31]
    ds_read_b128 v[84:87], v3 offset:8192
    v_mfma_f32_16x16x32_bf16 v[20:23], a[52:55], v[88:91], v[20:23]
    buffer_load_dwordx4 v1, s[16:19], s42 offen offset:1024 sc1 lds
    v_mfma_f32_16x16x32_bf16 v[32:35], a[56:59], v[88:91], v[32:35]
    v_mfma_f32_16x16x32_bf16 v[40:43], a[56:59], v[92:95], v[40:43]
    v_mfma_f32_16x16x32_bf16 v[44:47], a[60:63], v[92:95], v[44:47]
    v_mfma_f32_16x16x32_bf16 v[36:39], a[60:63], v[88:91], v[36:39]
    s_waitcnt lgkmcnt(0)
    v_mfma_f32_16x16x32_bf16 v[16:19], a[64:67], v[80:83], v[16:19]
    ds_read_b128 v[88:91], v2 offset:10240
    v_mfma_f32_16x16x32_bf16 v[24:27], a[64:67], v[84:87], v[24:27]
    buffer_load_dwordx4 v1, s[16:19], s42 offen offset:2048 sc1 lds
    v_mfma_f32_16x16x32_bf16 v[28:31], a[68:71], v[84:87], v[28:31]
    s_add_u32 s98, s98, 262144
    ds_read_b128 v[92:95], v3 offset:10240
    s_min_i32 s98, s98, s96
    v_mfma_f32_16x16x32_bf16 v[20:23], a[68:71], v[80:83], v[20:23]
    s_and_b32 s41, s98, 0xffffffff
    v_mfma_f32_16x16x32_bf16 v[32:35], a[72:75], v[80:83], v[32:35]
    v_mfma_f32_16x16x32_bf16 v[40:43], a[72:75], v[84:87], v[40:43]
    v_mfma_f32_16x16x32_bf16 v[44:47], a[76:79], v[84:87], v[44:47]
    v_mfma_f32_16x16x32_bf16 v[36:39], a[76:79], v[80:83], v[36:39]
    s_waitcnt vmcnt(7) lgkmcnt(0)
    s_barrier
    v_mfma_f32_16x16x32_bf16 v[16:19], a[80:83], v[88:91], v[16:19]
    ds_read_b128 v[80:83], v2 offset:12288
    v_mfma_f32_16x16x32_bf16 v[24:27], a[80:83], v[92:95], v[24:27]
    v_mfma_f32_16x16x32_bf16 v[28:31], a[84:87], v[92:95], v[28:31]
    ds_read_b128 v[84:87], v3 offset:12288
    v_mfma_f32_16x16x32_bf16 v[20:23], a[84:87], v[88:91], v[20:23]
    v_mfma_f32_16x16x32_bf16 v[32:35], a[88:91], v[88:91], v[32:35]
    v_mfma_f32_16x16x32_bf16 v[40:43], a[88:91], v[92:95], v[40:43]
    v_mfma_f32_16x16x32_bf16 v[44:47], a[92:95], v[92:95], v[44:47]
    v_mfma_f32_16x16x32_bf16 v[36:39], a[92:95], v[88:91], v[36:39]
    s_waitcnt lgkmcnt(0)
    v_mfma_f32_16x16x32_bf16 v[16:19], a[96:99], v[80:83], v[16:19]
    ds_read_b128 v[88:91], v2 offset:14336
    v_mfma_f32_16x16x32_bf16 v[24:27], a[96:99], v[84:87], v[24:27]
    v_mfma_f32_16x16x32_bf16 v[28:31], a[100:103], v[84:87], v[28:31]
    ds_read_b128 v[92:95], v3 offset:14336
    v_mfma_f32_16x16x32_bf16 v[20:23], a[100:103], v[80:83], v[20:23]
    v_mfma_f32_16x16x32_bf16 v[32:35], a[104:107], v[80:83], v[32:35]
    v_mfma_f32_16x16x32_bf16 v[40:43], a[104:107], v[84:87], v[40:43]
    v_mfma_f32_16x16x32_bf16 v[44:47], a[108:111], v[84:87], v[44:47]
    v_mfma_f32_16x16x32_bf16 v[36:39], a[108:111], v[80:83], v[36:39]
    s_waitcnt lgkmcnt(0)
    v_mfma_f32_16x16x32_bf16 v[16:19], a[112:115], v[88:91], v[16:19]
    ds_read_b128 v[80:83], v2 offset:16384
    v_mfma_f32_16x16x32_bf16 v[24:27], a[112:115], v[92:95], v[24:27]
    v_mfma_f32_16x16x32_bf16 v[28:31], a[116:119], v[92:95], v[28:31]
    ds_read_b128 v[84:87], v3 offset:16384
    v_mfma_f32_16x16x32_bf16 v[20:23], a[116:119], v[88:91], v[20:23]
    v_mfma_f32_16x16x32_bf16 v[32:35], a[120:123], v[88:91], v[32:35]
    v_mfma_f32_16x16x32_bf16 v[40:43], a[120:123], v[92:95], v[40:43]
    v_mfma_f32_16x16x32_bf16 v[44:47], a[124:127], v[92:95], v[44:47]
    v_mfma_f32_16x16x32_bf16 v[36:39], a[124:127], v[88:91], v[36:39]
    s_waitcnt lgkmcnt(0)
    v_mfma_f32_16x16x32_bf16 v[16:19], a[128:131], v[80:83], v[16:19]
    ds_read_b128 v[88:91], v2 offset:18432
    v_mfma_f32_16x16x32_bf16 v[24:27], a[128:131], v[84:87], v[24:27]
    v_mfma_f32_16x16x32_bf16 v[28:31], a[132:135], v[84:87], v[28:31]
    ds_read_b128 v[92:95], v3 offset:18432
    v_mfma_f32_16x16x32_bf16 v[20:23], a[132:135], v[80:83], v[20:23]
    v_mfma_f32_16x16x32_bf16 v[32:35], a[136:139], v[80:83], v[32:35]
    v_mfma_f32_16x16x32_bf16 v[40:43], a[136:139], v[84:87], v[40:43]
    v_mfma_f32_16x16x32_bf16 v[44:47], a[140:143], v[84:87], v[44:47]
    v_mfma_f32_16x16x32_bf16 v[36:39], a[140:143], v[80:83], v[36:39]
    s_waitcnt lgkmcnt(0)
    v_mfma_f32_16x16x32_bf16 v[16:19], a[144:147], v[88:91], v[16:19]
    ds_read_b128 v[80:83], v2 offset:20480
    v_mfma_f32_16x16x32_bf16 v[24:27], a[144:147], v[92:95], v[24:27]
    v_mfma_f32_16x16x32_bf16 v[28:31], a[148:151], v[92:95], v[28:31]
    ds_read_b128 v[84:87], v3 offset:20480
    v_mfma_f32_16x16x32_bf16 v[20:23], a[148:151], v[88:91], v[20:23]
    buffer_load_dword v96, v6, s[16:19], s45 offen sc1
    v_mfma_f32_16x16x32_bf16 v[32:35], a[152:155], v[88:91], v[32:35]
    s_add_u32 m0, s43, 98304
    s_add_u32 s42, s41, 0
    v_mfma_f32_16x16x32_bf16 v[40:43], a[152:155], v[92:95], v[40:43]
    v_mfma_f32_16x16x32_bf16 v[44:47], a[156:159], v[92:95], v[44:47]
    v_mfma_f32_16x16x32_bf16 v[36:39], a[156:159], v[88:91], v[36:39]
    s_waitcnt lgkmcnt(0)
    v_mfma_f32_16x16x32_bf16 v[16:19], a[160:163], v[80:83], v[16:19]
    ds_read_b128 v[88:91], v2 offset:22528
    v_mfma_f32_16x16x32_bf16 v[24:27], a[160:163], v[84:87], v[24:27]
    v_mfma_f32_16x16x32_bf16 v[28:31], a[164:167], v[84:87], v[28:31]
    ds_read_b128 v[92:95], v3 offset:22528
    v_mfma_f32_16x16x32_bf16 v[20:23], a[164:167], v[80:83], v[20:23]
    v_mfma_f32_16x16x32_bf16 v[32:35], a[168:171], v[80:83], v[32:35]
    v_mfma_f32_16x16x32_bf16 v[40:43], a[168:171], v[84:87], v[40:43]
    v_mfma_f32_16x16x32_bf16 v[44:47], a[172:175], v[84:87], v[44:47]
    v_mfma_f32_16x16x32_bf16 v[36:39], a[172:175], v[80:83], v[36:39]
    s_waitcnt lgkmcnt(0)
    v_mfma_f32_16x16x32_bf16 v[16:19], a[176:179], v[88:91], v[16:19]
    ds_read_b128 v[80:83], v2 offset:24576
    v_mfma_f32_16x16x32_bf16 v[24:27], a[176:179], v[92:95], v[24:27]
    v_mfma_f32_16x16x32_bf16 v[28:31], a[180:183], v[92:95], v[28:31]
    ds_read_b128 v[84:87], v3 offset:24576
    v_mfma_f32_16x16x32_bf16 v[20:23], a[180:183], v[88:91], v[20:23]
    v_mfma_f32_16x16x32_bf16 v[32:35], a[184:187], v[88:91], v[32:35]
    v_mfma_f32_16x16x32_bf16 v[40:43], a[184:187], v[92:95], v[40:43]
    v_mfma_f32_16x16x32_bf16 v[44:47], a[188:191], v[92:95], v[44:47]
    v_mfma_f32_16x16x32_bf16 v[36:39], a[188:191], v[88:91], v[36:39]
    s_waitcnt lgkmcnt(0)
    v_mfma_f32_16x16x32_bf16 v[16:19], a[192:195], v[80:83], v[16:19]
    ds_read_b128 v[88:91], v2 offset:26624
    v_mfma_f32_16x16x32_bf16 v[24:27], a[192:195], v[84:87], v[24:27]
    v_mfma_f32_16x16x32_bf16 v[28:31], a[196:199], v[84:87], v[28:31]
    ds_read_b128 v[92:95], v3 offset:26624
    v_mfma_f32_16x16x32_bf16 v[20:23], a[196:199], v[80:83], v[20:23]
    v_mfma_f32_16x16x32_bf16 v[32:35], a[200:203], v[80:83], v[32:35]
    v_mfma_f32_16x16x32_bf16 v[40:43], a[200:203], v[84:87], v[40:43]
    v_mfma_f32_16x16x32_bf16 v[44:47], a[204:207], v[84:87], v[44:47]
    v_mfma_f32_16x16x32_bf16 v[36:39], a[204:207], v[80:83], v[36:39]
    s_waitcnt lgkmcnt(0)
    v_mfma_f32_16x16x32_bf16 v[16:19], a[208:211], v[88:91], v[16:19]
    ds_read_b128 v[80:83], v2 offset:28672
    v_mfma_f32_16x16x32_bf16 v[24:27], a[208:211], v[92:95], v[24:27]
    v_mfma_f32_16x16x32_bf16 v[28:31], a[212:215], v[92:95], v[28:31]
    ds_read_b128 v[84:87], v3 offset:28672
    v_mfma_f32_16x16x32_bf16 v[20:23], a[212:215], v[88:91], v[20:23]
    v_mfma_f32_16x16x32_bf16 v[32:35], a[216:219], v[88:91], v[32:35]
    v_mfma_f32_16x16x32_bf16 v[40:43], a[216:219], v[92:95], v[40:43]
    v_mfma_f32_16x16x32_bf16 v[44:47], a[220:223], v[92:95], v[44:47]
    v_mfma_f32_16x16x32_bf16 v[36:39], a[220:223], v[88:91], v[36:39]
    s_waitcnt lgkmcnt(0)
    v_mfma_f32_16x16x32_bf16 v[16:19], a[224:227], v[80:83], v[16:19]
    ds_read_b128 v[88:91], v2 offset:30720
    v_mfma_f32_16x16x32_bf16 v[24:27], a[224:227], v[84:87], v[24:27]
    v_mfma_f32_16x16x32_bf16 v[28:31], a[228:231], v[84:87], v[28:31]
    ds_read_b128 v[92:95], v3 offset:30720
    v_mfma_f32_16x16x32_bf16 v[20:23], a[228:231], v[80:83], v[20:23]
    v_mfma_f32_16x16x32_bf16 v[32:35], a[232:235], v[80:83], v[32:35]
    v_mfma_f32_16x16x32_bf16 v[40:43], a[232:235], v[84:87], v[40:43]
    v_mfma_f32_16x16x32_bf16 v[44:47], a[236:239], v[84:87], v[44:47]
    v_mfma_f32_16x16x32_bf16 v[36:39], a[236:239], v[80:83], v[36:39]
    s_waitcnt lgkmcnt(0)
    v_mfma_f32_16x16x32_bf16 v[16:19], a[240:243], v[88:91], v[16:19]
    s_waitcnt vmcnt(0)
    ds_read_b128 v[80:83], v2 offset:32768
    v_cmp_ne_u32 vcc, 0, v96
    v_mfma_f32_16x16x32_bf16 v[24:27], a[240:243], v[92:95], v[24:27]
    v_mfma_f32_16x16x32_bf16 v[28:31], a[244:247], v[92:95], v[28:31]
    s_cbranch_vccnz L_spin80
L_back81:
    ds_read_b128 v[84:87], v3 offset:32768
    s_barrier
    v_mfma_f32_16x16x32_bf16 v[20:23], a[244:247], v[88:91], v[20:23]
    buffer_load_dwordx4 v1, s[16:19], s42 offen offset:0 sc1 lds
    v_mfma_f32_16x16x32_bf16 v[32:35], a[248:251], v[88:91], v[32:35]
    v_mfma_f32_16x16x32_bf16 v[40:43], a[248:251], v[92:95], v[40:43]
    v_mfma_f32_16x16x32_bf16 v[44:47], a[252:255], v[92:95], v[44:47]
    buffer_load_dwordx4 v1, s[16:19], s42 offen offset:1024 sc1 lds
    v_mfma_f32_16x16x32_bf16 v[36:39], a[252:255], v[88:91], v[36:39]
    s_waitcnt lgkmcnt(0)
    v_mfma_f32_16x16x32_bf16 v[16:19], v[128:131], v[80:83], v[16:19]
    ds_read_b128 v[88:91], v2 offset:34816
    v_mfma_f32_16x16x32_bf16 v[24:27], v[128:131], v[84:87], v[24:27]
    buffer_load_dwordx4 v1, s[16:19], s42 offen offset:2048 sc1 lds
    v_mfma_f32_16x16x32_bf16 v[28:31], v[132:135], v[84:87], v[28:31]
    ds_read_b128 v[92:95], v3 offset:34816
    v_mfma_f32_16x16x32_bf16 v[20:23], v[132:135], v[80:83], v[20:23]
    v_mfma_f32_16x16x32_bf16 v[32:35], v[136:139], v[80:83], v[32:35]
    buffer_store_dword v124, v124, s[16:19], s91 offen sc1
    v_mfma_f32_16x16x32_bf16 v[40:43], v[136:139], v[84:87], v[40:43]
    s_add_u32 s91, s91, 65536
    s_add_u32 m0, s43, 110592
    s_add_u32 s42, s41, 12288
    v_mfma_f32_16x16x32_bf16 v[44:47], v[140:143], v[84:87], v[44:47]
    v_mfma_f32_16x16x32_bf16 v[36:39], v[140:143], v[80:83], v[36:39]
    s_waitcnt lgkmcnt(0)
    v_mfma_f32_16x16x32_bf16 v[16:19], v[144:147], v[88:91], v[16:19]
    ds_read_b128 v[80:83], v2 offset:36864
    v_mfma_f32_16x16x32_bf16 v[24:27], v[144:147], v[92:95], v[24:27]
    v_mfma_f32_16x16x32_bf16 v[28:31], v[148:151], v[92:95], v[28:31]
    ds_read_b128 v[84:87], v3 offset:36864
    v_mfma_f32_16x16x32_bf16 v[20:23], v[148:151], v[88:91], v[20:23]
    buffer_load_dwordx4 v1, s[16:19], s42 offen offset:0 sc1 lds
    v_mfma_f32_16x16x32_bf16 v[32:35], v[152:155], v[88:91], v[32:35]
    v_mfma_f32_16x16x32_bf16 v[40:43], v[152:155], v[92:95], v[40:43]
    v_mfma_f32_16x16x32_bf16 v[44:47], v[156:159], v[92:95], v[44:47]
    v_mfma_f32_16x16x32_bf16 v[36:39], v[156:159], v[88:91], v[36:39]
    s_waitcnt lgkmcnt(0)
    v_mfma_f32_16x16x32_bf16 v[16:19], v[160:163], v[80:83], v[16:19]
    ds_read_b128 v[88:91], v2 offset:38912
    v_mfma_f32_16x16x32_bf16 v[24:27], v[160:163], v[84:87], v[24:27]
    buffer_load_dwordx4 v1, s[16:19], s42 offen offset:1024 sc1 lds
    v_mfma_f32_16x16x32_bf16 v[28:31], v[164:167], v[84:87], v[28:31]
    ds_read_b128 v[92:95], v3 offset:38912
    v_mfma_f32_16x16x32_bf16 v[20:23], v[164:167], v[80:83], v[20:23]
    v_mfma_f32_16x16x32_bf16 v[32:35], v[168:171], v[80:83], v[32:35]
    v_mfma_f32_16x16x32_bf16 v[40:43], v[168:171], v[84:87], v[40:43]
    v_mfma_f32_16x16x32_bf16 v[44:47], v[172:175], v[84:87], v[44:47]
    buffer_load_dwordx4 v1, s[16:19], s42 offen offset:2048 sc1 lds
    v_mfma_f32_16x16x32_bf16 v[36:39], v[172:175], v[80:83], v[36:39]
    s_waitcnt lgkmcnt(0)
    s_add_u32 m0, s43, 122880
    s_add_u32 s42, s41, 24576
    v_mfma_f32_16x16x32_bf16 v[16:19], v[176:179], v[88:91], v[16:19]
    ds_read_b128 v[80:83], v2 offset:40960
    v_mfma_f32_16x16x32_bf16 v[24:27], v[176:179], v[92:95], v[24:27]
    v_mfma_f32_16x16x32_bf16 v[28:31], v[180:183], v[92:95], v[28:31]
    ds_read_b128 v[84:87], v3 offset:40960
    v_mfma_f32_16x16x32_bf16 v[20:23], v[180:183], v[88:91], v[20:23]
    buffer_load_dwordx4 v1, s[16:19], s42 offen offset:0 sc1 lds
    v_mfma_f32_16x16x32_bf16 v[32:35], v[184:187], v[88:91], v[32:35]
    v_mfma_f32_16x16x32_bf16 v[40:43], v[184:187], v[92:95], v[40:43]
    v_mfma_f32_16x16x32_bf16 v[44:47], v[188:191], v[92:95], v[44:47]
    v_mfma_f32_16x16x32_bf16 v[36:39], v[188:191], v[88:91], v[36:39]
    s_waitcnt lgkmcnt(0)
    v_mfma_f32_16x16x32_bf16 v[16:19], v[192:195], v[80:83], v[16:19]
    ds_read_b128 v[88:91], v2 offset:43008
    v_mfma_f32_16x16x32_bf16 v[24:27], v[192:195], v[84:87], v[24:27]
    buffer_load_dwordx4 v1, s[16:19], s42 offen offset:1024 sc1 lds
    v_mfma_f32_16x16x32_bf16 v[28:31], v[196:199], v[84:87], v[28:31]
    ds_read_b128 v[92:95], v3 offset:43008
    v_mfma_f32_16x16x32_bf16 v[20:23], v[196:199], v[80:83], v[20:23]
    v_mfma_f32_16x16x32_bf16 v[32:35], v[200:203], v[80:83], v[32:35]
    v_mfma_f32_16x16x32_bf16 v[40:43], v[200:203], v[84:87], v[40:43]
    v_mfma_f32_16x16x32_bf16 v[44:47], v[204:207], v[84:87], v[44:47]
    buffer_load_dwordx4 v1, s[16:19], s42 offen offset:2048 sc1 lds
    v_mfma_f32_16x16x32_bf16 v[36:39], v[204:207], v[80:83], v[36:39]
    s_waitcnt lgkmcnt(0)
    s_add_u32 s45, s45, 65536
    v_mfma_f32_16x16x32_bf16 v[16:19], v[208:211], v[88:91], v[16:19]
    ds_read_b128 v[80:83], v2 offset:45056
    v_mfma_f32_16x16x32_bf16 v[24:27], v[208:211], v[92:95], v[24:27]
    v_mfma_f32_16x16x32_bf16 v[28:31], v[212:215], v[92:95], v[28:31]
    ds_read_b128 v[84:87], v3 offset:45056
    v_mfma_f32_16x16x32_bf16 v[20:23], v[212:215], v[88:91], v[20:23]
    v_mfma_f32_16x16x32_bf16 v[32:35], v[216:219], v[88:91], v[32:35]
    v_mfma_f32_16x16x32_bf16 v[40:43], v[216:219], v[92:95], v[40:43]
    v_mfma_f32_16x16x32_bf16 v[44:47], v[220:223], v[92:95], v[44:47]
    v_mfma_f32_16x16x32_bf16 v[36:39], v[220:223], v[88:91], v[36:39]
    s_waitcnt lgkmcnt(0)
    v_mfma_f32_16x16x32_bf16 v[16:19], v[224:227], v[80:83], v[16:19]
    ds_read_b128 v[88:91], v2 offset:47104
    v_mfma_f32_16x16x32_bf16 v[24:27], v[224:227], v[84:87], v[24:27]
    v_mfma_f32_16x16x32_bf16 v[28:31], v[228:231], v[84:87], v[28:31]
    ds_read_b128 v[92:95], v3 offset:47104
    v_mfma_f32_16x16x32_bf16 v[20:23], v[228:231], v[80:83], v[20:23]
    v_mfma_f32_16x16x32_bf16 v[32:35], v[232:235], v[80:83], v[32:35]
    v_mfma_f32_16x16x32_bf16 v[40:43], v[232:235], v[84:87], v[40:43]
    v_mfma_f32_16x16x32_bf16 v[44:47], v[236:239], v[84:87], v[44:47]
    v_mfma_f32_16x16x32_bf16 v[36:39], v[236:239], v[80:83], v[36:39]
    s_waitcnt vmcnt(7) lgkmcnt(0)
    s_barrier
    v_mfma_f32_16x16x32_bf16 v[16:19], v[240:243], v[88:91], v[16:19]
    ds_read_b128 v[80:83], v4 offset:0
    v_mfma_f32_16x16x32_bf16 v[24:27], v[240:243], v[92:95], v[24:27]
    v_mfma_f32_16x16x32_bf16 v[28:31], v[244:247], v[92:95], v[28:31]
    ds_read_b128 v[84:87], v5 offset:0
    v_mfma_f32_16x16x32_bf16 v[20:23], v[244:247], v[88:91], v[20:23]
    v_mfma_f32_16x16x32_bf16 v[32:35], v[248:251], v[88:91], v[32:35]
    v_mfma_f32_16x16x32_bf16 v[40:43], v[248:251], v[92:95], v[40:43]
    v_mfma_f32_16x16x32_bf16 v[44:47], v[252:255], v[92:95], v[44:47]
    s_add_u32 s36, s36, 1
    v_mfma_f32_16x16x32_bf16 v[36:39], v[252:255], v[88:91], v[36:39]
    s_waitcnt lgkmcnt(0)
L_bs_b1:
    v_mfma_f32_16x16x32_bf16 v[48:51], a[0:3], v[80:83], 0
    s_and_b32 s44, s90, 0xffffffff
    ds_read_b128 v[88:91], v4 offset:2048
    s_cmp_lt_i32 s36, 1
    v_mfma_f32_16x16x32_bf16 v[56:59], a[0:3], v[84:87], 0
    s_cselect_b32 s44, 0x5e00000, s44
    s_xor_b32 s49, s44, 0
    v_cvt_pk_bf16_f32 v16, v16, v17
    v_mfma_f32_16x16x32_bf16 v[60:63], a[4:7], v[84:87], 0
    ds_read_b128 v[92:95], v5 offset:2048
    v_cvt_pk_bf16_f32 v17, v18, v19
    v_mfma_f32_16x16x32_bf16 v[52:55], a[4:7], v[80:83], 0
    v_cvt_pk_bf16_f32 v18, v20, v21
    v_cvt_pk_bf16_f32 v19, v22, v23
    v_mfma_f32_16x16x32_bf16 v[64:67], a[8:11], v[80:83], 0
    buffer_store_dwordx4 v[16:19], v1, s[16:19], s49 offen offset:3072 sc1
    v_mfma_f32_16x16x32_bf16 v[72:75], a[8:11], v[84:87], 0
    s_xor_b32 s49, s44, 16384
    v_cvt_pk_bf16_f32 v24, v24, v25
    v_cvt_pk_bf16_f32 v25, v26, v27
    v_mfma_f32_16x16x32_bf16 v[76:79], a[12:15], v[84:87], 0
    v_cvt_pk_bf16_f32 v26, v28, v29
    v_cvt_pk_bf16_f32 v27, v30, v31
    v_mfma_f32_16x16x32_bf16 v[68:71], a[12:15], v[80:83], 0
    s_waitcnt lgkmcnt(0)
    v_mfma_f32_16x16x32_bf16 v[48:51], a[16:19], v[88:91], v[48:51]
    ds_read_b128 v[80:83], v4 offset:4096
    v_mfma_f32_16x16x32_bf16 v[56:59], a[16:19], v[92:95], v[56:59]
    buffer_store_dwordx4 v[24:27], v1, s[16:19], s49 offen offset:3072 sc1
    v_mfma_f32_16x16x32_bf16 v[60:63], a[20:23], v[92:95], v[60:63]
    s_xor_b32 s49, s44, 32768
    ds_read_b128 v[84:87], v5 offset:4096
    v_cvt_pk_bf16_f32 v32, v32, v33
    v_mfma_f32_16x16x32_bf16 v[52:55], a[20:23], v[88:91], v[52:55]
    v_cvt_pk_bf16_f32 v33, v34, v35
    v_cvt_pk_bf16_f32 v34, v36, v37
    v_mfma_f32_16x16x32_bf16 v[64:67], a[24:27], v[88:91], v[64:67]
    v_cvt_pk_bf16_f32 v35, v38, v39
    v_mfma_f32_16x16x32_bf16 v[72:75], a[24:27], v[92:95], v[72:75]
    buffer_store_dwordx4 v[32:35], v1, s[16:19], s49 offen offset:3072 sc1
    v_mfma_f32_16x16x32_bf16 v[76:79], a[28:31], v[92:95], v[76:79]
    s_xor_b32 s49, s44, 49152
    v_cvt_pk_bf16_f32 v40, v40, v41
    v_cvt_pk_bf16_f32 v41, v42, v43
    v_mfma_f32_16x16x32_bf16 v[68:71], a[28:31], v[88:91], v[68:71]
    s_waitcnt lgkmcnt(0)
    v_cvt_pk_bf16_f32 v42, v44, v45
    v_cvt_pk_bf16_f32 v43, v46, v47
    v_mfma_f32_16x16x32_bf16 v[48:51], a[32:35], v[80:83], v[48:51]
    s_add_u32 m0, s43, 135168
    ds_read_b128 v[88:91], v4 offset:6144
    s_add_u32 s42, s41, 36864
    v_mfma_f32_16x16x32_bf16 v[56:59], a[32:35], v[84:87], v[56:59]
    buffer_store_dwordx4 v[40:43], v1, s[16:19], s49 offen offset:3072 sc1
    v_mfma_f32_16x16x32_bf16 v[60:63], a[36:39], v[84:87], v[60:63]
    s_add_u32 s90, s90, 262144
    ds_read_b128 v[92:95], v5 offset:6144
    v_mfma_f32_16x16x32_bf16 v[52:55], a[36:39], v[80:83], v[52:55]
    v_mfma_f32_16x16x32_bf16 v[64:67], a[40:43], v[80:83], v[64:67]
    buffer_load_dwordx4 v1, s[16:19], s42 offen offset:0 sc1 lds
    v_mfma_f32_16x16x32_bf16 v[72:75], a[40:43], v[84:87], v[72:75]
    v_mfma_f32_16x16x32_bf16 v[76:79], a[44:47], v[84:87], v[76:79]
    v_mfma_f32_16x16x32_bf16 v[68:71], a[44:47], v[80:83], v[68:71]
    s_waitcnt lgkmcnt(0)
    v_mfma_f32_16x16x32_bf16 v[48:51], a[48:51], v[88:91], v[48:51]
    ds_read_b128 v[80:83], v4 offset:8192
    v_mfma_f32_16x16x32_bf16 v[56:59], a[48:51], v[92:95], v[56:59]
    v_mfma_f32_16x16x32_bf16 v[60:63], a[52:55], v[92:95], v[60:63]
    ds_read_b128 v[84:87], v5 offset:8192
    v_mfma_f32_16x16x32_bf16 v[52:55], a[52:55], v[88:91], v[52:55]
    buffer_load_dwordx4 v1, s[16:19], s42 offen offset:1024 sc1 lds
    v_mfma_f32_16x16x32_bf16 v[64:67], a[56:59], v[88:91], v[64:67]
    v_mfma_f32_16x16x32_bf16 v[72:75], a[56:59], v[92:95], v[72:75]
    v_mfma_f32_16x16x32_bf16 v[76:79], a[60:63], v[92:95], v[76:79]
    v_mfma_f32_16x16x32_bf16 v[68:71], a[60:63], v[88:91], v[68:71]
    s_waitcnt lgkmcnt(0)
    v_mfma_f32_16x16x32_bf16 v[48:51], a[64:67], v[80:83], v[48:51]
    ds_read_b128 v[88:91], v4 offset:10240
    v_mfma_f32_16x16x32_bf16 v[56:59], a[64:67], v[84:87], v[56:59]
    buffer_load_dwordx4 v1, s[16:19], s42 offen offset:2048 sc1 lds
    v_mfma_f32_16x16x32_bf16 v[60:63], a[68:71], v[84:87], v[60:63]
    s_add_u32 s98, s98, 262144
    ds_read_b128 v[92:95], v5 offset:10240
    s_min_i32 s98, s98, s96
    v_mfma_f32_16x16x32_bf16 v[52:55], a[68:71], v[80:83], v[52:55]
    s_and_b32 s41, s98, 0xffffffff
    v_mfma_f32_16x16x32_bf16 v[64:67], a[72:75], v[80:83], v[64:67]
    v_mfma_f32_16x16x32_bf16 v[72:75], a[72:75], v[84:87], v[72:75]
    v_mfma_f32_16x16x32_bf16 v[76:79], a[76:79], v[84:87], v[76:79]
    v_mfma_f32_16x16x32_bf16 v[68:71], a[76:79], v[80:83], v[68:71]
    s_waitcnt vmcnt(7) lgkmcnt(0)
    s_barrier
    v_mfma_f32_16x16x32_bf16 v[48:51], a[80:83], v[88:91], v[48:51]
    ds_read_b128 v[80:83], v4 offset:12288
    v_mfma_f32_16x16x32_bf16 v[56:59], a[80:83], v[92:95], v[56:59]
    v_mfma_f32_16x16x32_bf16 v[60:63], a[84:87], v[92:95], v[60:63]
    ds_read_b128 v[84:87], v5 offset:12288
    v_mfma_f32_16x16x32_bf16 v[52:55], a[84:87], v[88:91], v[52:55]
    v_mfma_f32_16x16x32_bf16 v[64:67], a[88:91], v[88:91], v[64:67]
    v_mfma_f32_16x16x32_bf16 v[72:75], a[88:91], v[92:95], v[72:75]
    v_mfma_f32_16x16x32_bf16 v[76:79], a[92:95], v[92:95], v[76:79]
    v_mfma_f32_16x16x32_bf16 v[68:71], a[92:95], v[88:91], v[68:71]
    s_waitcnt lgkmcnt(0)
    v_mfma_f32_16x16x32_bf16 v[48:51], a[96:99], v[80:83], v[48:51]
    ds_read_b128 v[88:91], v4 offset:14336
    v_mfma_f32_16x16x32_bf16 v[56:59], a[96:99], v[84:87], v[56:59]
    v_mfma_f32_16x16x32_bf16 v[60:63], a[100:103], v[84:87], v[60:63]
    ds_read_b128 v[92:95], v5 offset:14336
    v_mfma_f32_16x16x32_bf16 v[52:55], a[100:103], v[80:83], v[52:55]
    v_mfma_f32_16x16x32_bf16 v[64:67], a[104:107], v[80:83], v[64:67]
    v_mfma_f32_16x16x32_bf16 v[72:75], a[104:107], v[84:87], v[72:75]
    v_mfma_f32_16x16x32_bf16 v[76:79], a[108:111], v[84:87], v[76:79]
    v_mfma_f32_16x16x32_bf16 v[68:71], a[108:111], v[80:83], v[68:71]
    s_waitcnt lgkmcnt(0)
    v_mfma_f32_16x16x32_bf16 v[48:51], a[112:115], v[88:91], v[48:51]
    ds_read_b128 v[80:83], v4 offset:16384
    v_mfma_f32_16x16x32_bf16 v[56:59], a[112:115], v[92:95], v[56:59]
    v_mfma_f32_16x16x32_bf16 v[60:63], a[116:119], v[92:95], v[60:63]
    ds_read_b128 v[84:87], v5 offset:16384
    v_mfma_f32_16x16x32_bf16 v[52:55], a[116:119], v[88:91], v[52:55]
    v_mfma_f32_16x16x32_bf16 v[64:67], a[120:123], v[88:91], v[64:67]
    v_mfma_f32_16x16x32_bf16 v[72:75], a[120:123], v[92:95], v[72:75]
    v_mfma_f32_16x16x32_bf16 v[76:79], a[124:127], v[92:95], v[76:79]
    v_mfma_f32_16x16x32_bf16 v[68:71], a[124:127], v[88:91], v[68:71]
    s_waitcnt lgkmcnt(0)
    v_mfma_f32_16x16x32_bf16 v[48:51], a[128:131], v[80:83], v[48:51]
    ds_read_b128 v[88:91], v4 offset:18432
    v_mfma_f32_16x16x32_bf16 v[56:59], a[128:131], v[84:87], v[56:59]
    v_mfma_f32_16x16x32_bf16 v[60:63], a[132:135], v[84:87], v[60:63]
    ds_read_b128 v[92:95], v5 offset:18432
    v_mfma_f32_16x16x32_bf16 v[52:55], a[132:135], v[80:83], v[52:55]
    v_mfma_f32_16x16x32_bf16 v[64:67], a[136:139], v[80:83], v[64:67]
    v_mfma_f32_16x16x32_bf16 v[72:75], a[136:139], v[84:87], v[72:75]
    v_mfma_f32_16x16x32_bf16 v[76:79], a[140:143], v[84:87], v[76:79]
    v_mfma_f32_16x16x32_bf16 v[68:71], a[140:143], v[80:83], v[68:71]
    s_waitcnt lgkmcnt(0)
    v_mfma_f32_16x16x32_bf16 v[48:51], a[144:147], v[88:91], v[48:51]
    ds_read_b128 v[80:83], v4 offset:20480
    v_mfma_f32_16x16x32_bf16 v[56:59], a[144:147], v[92:95], v[56:59]
    v_mfma_f32_16x16x32_bf16 v[60:63], a[148:151], v[92:95], v[60:63]
    ds_read_b128 v[84:87], v5 offset:20480
    v_mfma_f32_16x16x32_bf16 v[52:55], a[148:151], v[88:91], v[52:55]
    buffer_load_dword v96, v6, s[16:19], s45 offen sc1
    v_mfma_f32_16x16x32_bf16 v[64:67], a[152:155], v[88:91], v[64:67]
    s_add_u32 m0, s43, 0
    s_add_u32 s42, s41, 0
    v_mfma_f32_16x16x32_bf16 v[72:75], a[152:155], v[92:95], v[72:75]
    v_mfma_f32_16x16x32_bf16 v[76:79], a[156:159], v[92:95], v[76:79]
    v_mfma_f32_16x16x32_bf16 v[68:71], a[156:159], v[88:91], v[68:71]
    s_waitcnt lgkmcnt(0)
    v_mfma_f32_16x16x32_bf16 v[48:51], a[160:163], v[80:83], v[48:51]
    ds_read_b128 v[88:91], v4 offset:22528
    v_mfma_f32_16x16x32_bf16 v[56:59], a[160:163], v[84:87], v[56:59]
    v_mfma_f32_16x16x32_bf16 v[60:63], a[164:167], v[84:87], v[60:63]
    ds_read_b128 v[92:95], v5 offset:22528
    v_mfma_f32_16x16x32_bf16 v[52:55], a[164:167], v[80:83], v[52:55]
    v_mfma_f32_16x16x32_bf16 v[64:67], a[168:171], v[80:83], v[64:67]
    v_mfma_f32_16x16x32_bf16 v[72:75], a[168:171], v[84:87], v[72:75]
    v_mfma_f32_16x16x32_bf16 v[76:79], a[172:175], v[84:87], v[76:79]
    v_mfma_f32_16x16x32_bf16 v[68:71], a[172:175], v[80:83], v[68:71]
    s_waitcnt lgkmcnt(0)
    v_mfma_f32_16x16x32_bf16 v[48:51], a[176:179], v[88:91], v[48:51]
    ds_read_b128 v[80:83], v4 offset:24576
    v_mfma_f32_16x16x32_bf16 v[56:59], a[176:179], v[92:95], v[56:59]
    v_mfma_f32_16x16x32_bf16 v[60:63], a[180:183], v[92:95], v[60:63]
    ds_read_b128 v[84:87], v5 offset:24576
    v_mfma_f32_16x16x32_bf16 v[52:55], a[180:183], v[88:91], v[52:55]
    v_mfma_f32_16x16x32_bf16 v[64:67], a[184:187], v[88:91], v[64:67]
    v_mfma_f32_16x16x32_bf16 v[72:75], a[184:187], v[92:95], v[72:75]
    v_mfma_f32_16x16x32_bf16 v[76:79], a[188:191], v[92:95], v[76:79]
    v_mfma_f32_16x16x32_bf16 v[68:71], a[188:191], v[88:91], v[68:71]
    s_waitcnt lgkmcnt(0)
    v_mfma_f32_16x16x32_bf16 v[48:51], a[192:195], v[80:83], v[48:51]
    ds_read_b128 v[88:91], v4 offset:26624
    v_mfma_f32_16x16x32_bf16 v[56:59], a[192:195], v[84:87], v[56:59]
    v_mfma_f32_16x16x32_bf16 v[60:63], a[196:199], v[84:87], v[60:63]
    ds_read_b128 v[92:95], v5 offset:26624
    v_mfma_f32_16x16x32_bf16 v[52:55], a[196:199], v[80:83], v[52:55]
    v_mfma_f32_16x16x32_bf16 v[64:67], a[200:203], v[80:83], v[64:67]
    v_mfma_f32_16x16x32_bf16 v[72:75], a[200:203], v[84:87], v[72:75]
    v_mfma_f32_16x16x32_bf16 v[76:79], a[204:207], v[84:87], v[76:79]
    v_mfma_f32_16x16x32_bf16 v[68:71], a[204:207], v[80:83], v[68:71]
    s_waitcnt lgkmcnt(0)
    v_mfma_f32_16x16x32_bf16 v[48:51], a[208:211], v[88:91], v[48:51]
    ds_read_b128 v[80:83], v4 offset:28672
    v_mfma_f32_16x16x32_bf16 v[56:59], a[208:211], v[92:95], v[56:59]
    v_mfma_f32_16x16x32_bf16 v[60:63], a[212:215], v[92:95], v[60:63]
    ds_read_b128 v[84:87], v5 offset:28672
    v_mfma_f32_16x16x32_bf16 v[52:55], a[212:215], v[88:91], v[52:55]
    v_mfma_f32_16x16x32_bf16 v[64:67], a[216:219], v[88:91], v[64:67]
    v_mfma_f32_16x16x32_bf16 v[72:75], a[216:219], v[92:95], v[72:75]
    v_mfma_f32_16x16x32_bf16 v[76:79], a[220:223], v[92:95], v[76:79]
    v_mfma_f32_16x16x32_bf16 v[68:71], a[220:223], v[88:91], v[68:71]
    s_waitcnt lgkmcnt(0)
    v_mfma_f32_16x16x32_bf16 v[48:51], a[224:227], v[80:83], v[48:51]
    ds_read_b128 v[88:91], v4 offset:30720
    v_mfma_f32_16x16x32_bf16 v[56:59], a[224:227], v[84:87], v[56:59]
    v_mfma_f32_16x16x32_bf16 v[60:63], a[228:231], v[84:87], v[60:63]
    ds_read_b128 v[92:95], v5 offset:30720
    v_mfma_f32_16x16x32_bf16 v[52:55], a[228:231], v[80:83], v[52:55]
    v_mfma_f32_16x16x32_bf16 v[64:67], a[232:235], v[80:83], v[64:67]
    v_mfma_f32_16x16x32_bf16 v[72:75], a[232:235], v[84:87], v[72:75]
    v_mfma_f32_16x16x32_bf16 v[76:79], a[236:239], v[84:87], v[76:79]
    v_mfma_f32_16x16x32_bf16 v[68:71], a[236:239], v[80:83], v[68:71]
    s_waitcnt lgkmcnt(0)
    v_mfma_f32_16x16x32_bf16 v[48:51], a[240:243], v[88:91], v[48:51]
    s_waitcnt vmcnt(0)
    ds_read_b128 v[80:83], v4 offset:32768
    v_cmp_ne_u32 vcc, 0, v96
    v_mfma_f32_16x16x32_bf16 v[56:59], a[240:243], v[92:95], v[56:59]
    v_mfma_f32_16x16x32_bf16 v[60:63], a[244:247], v[92:95], v[60:63]
    s_cbranch_vccnz L_spin82
L_back83:
    ds_read_b128 v[84:87], v5 offset:32768
    s_barrier
    v_mfma_f32_16x16x32_bf16 v[52:55], a[244:247], v[88:91], v[52:55]
    buffer_load_dwordx4 v1, s[16:19], s42 offen offset:0 sc1 lds
    v_mfma_f32_16x16x32_bf16 v[64:67], a[248:251], v[88:91], v[64:67]
    v_mfma_f32_16x16x32_bf16 v[72:75], a[248:251], v[92:95], v[72:75]
    v_mfma_f32_16x16x32_bf16 v[76:79], a[252:255], v[92:95], v[76:79]
    buffer_load_dwordx4 v1, s[16:19], s42 offen offset:1024 sc1 lds
    v_mfma_f32_16x16x32_bf16 v[68:71], a[252:255], v[88:91], v[68:71]
    s_waitcnt lgkmcnt(0)
    v_mfma_f32_16x16x32_bf16 v[48:51], v[128:131], v[80:83], v[48:51]
    ds_read_b128 v[88:91], v4 offset:34816
    v_mfma_f32_16x16x32_bf16 v[56:59], v[128:131], v[84:87], v[56:59]
    buffer_load_dwordx4 v1, s[16:19], s42 offen offset:2048 sc1 lds
    v_mfma_f32_16x16x32_bf16 v[60:63], v[132:135], v[84:87], v[60:63]
    ds_read_b128 v[92:95], v5 offset:34816
    v_mfma_f32_16x16x32_bf16 v[52:55], v[132:135], v[80:83], v[52:55]
    v_mfma_f32_16x16x32_bf16 v[64:67], v[136:139], v[80:83], v[64:67]
    buffer_store_dword v124, v124, s[16:19], s91 offen sc1
    v_mfma_f32_16x16x32_bf16 v[72:75], v[136:139], v[84:87], v[72:75]
    s_add_u32 s91, s91, 65536
    s_add_u32 m0, s43, 12288
    s_add_u32 s42, s41, 12288
    v_mfma_f32_16x16x32_bf16 v[76:79], v[140:143], v[84:87], v[76:79]
    v_mfma_f32_16x16x32_bf16 v[68:71], v[140:143], v[80:83], v[68:71]
    s_waitcnt lgkmcnt(0)
    v_mfma_f32_16x16x32_bf16 v[48:51], v[144:147], v[88:91], v[48:51]
    ds_read_b128 v[80:83], v4 offset:36864
    v_mfma_f32_16x16x32_bf16 v[56:59], v[144:147], v[92:95], v[56:59]
    v_mfma_f32_16x16x32_bf16 v[60:63], v[148:151], v[92:95], v[60:63]
    ds_read_b128 v[84:87], v5 offset:36864
    v_mfma_f32_16x16x32_bf16 v[52:55], v[148:151], v[88:91], v[52:55]
    buffer_load_dwordx4 v1, s[16:19], s42 offen offset:0 sc1 lds
    v_mfma_f32_16x16x32_bf16 v[64:67], v[152:155], v[88:91], v[64:67]
    v_mfma_f32_16x16x32_bf16 v[72:75], v[152:155], v[92:95], v[72:75]
    v_mfma_f32_16x16x32_bf16 v[76:79], v[156:159], v[92:95], v[76:79]
    v_mfma_f32_16x16x32_bf16 v[68:71], v[156:159], v[88:91], v[68:71]
    s_waitcnt lgkmcnt(0)
    v_mfma_f32_16x16x32_bf16 v[48:51], v[160:163], v[80:83], v[48:51]
    ds_read_b128 v[88:91], v4 offset:38912
    v_mfma_f32_16x16x32_bf16 v[56:59], v[160:163], v[84:87], v[56:59]
    buffer_load_dwordx4 v1, s[16:19], s42 offen offset:1024 sc1 lds
    v_mfma_f32_16x16x32_bf16 v[60:63], v[164:167], v[84:87], v[60:63]
    ds_read_b128 v[92:95], v5 offset:38912
    v_mfma_f32_16x16x32_bf16 v[52:55], v[164:167], v[80:83], v[52:55]
    v_mfma_f32_16x16x32_bf16 v[64:67], v[168:171], v[80:83], v[64:67]
    v_mfma_f32_16x16x32_bf16 v[72:75], v[168:171], v[84:87], v[72:75]
    v_mfma_f32_16x16x32_bf16 v[76:79], v[172:175], v[84:87], v[76:79]
    buffer_load_dwordx4 v1, s[16:19], s42 offen offset:2048 sc1 lds
    v_mfma_f32_16x16x32_bf16 v[68:71], v[172:175], v[80:83], v[68:71]
    s_waitcnt lgkmcnt(0)
    s_add_u32 m0, s43, 24576
    s_add_u32 s42, s41, 24576
    v_mfma_f32_16x16x32_bf16 v[48:51], v[176:179], v[88:91], v[48:51]
    ds_read_b128 v[80:83], v4 offset:40960
    v_mfma_f32_16x16x32_bf16 v[56:59], v[176:179], v[92:95], v[56:59]
    v_mfma_f32_16x16x32_bf16 v[60:63], v[180:183], v[92:95], v[60:63]
    ds_read_b128 v[84:87], v5 offset:40960
    v_mfma_f32_16x16x32_bf16 v[52:55], v[180:183], v[88:91], v[52:55]
    buffer_load_dwordx4 v1, s[16:19], s42 offen offset:0 sc1 lds
    v_mfma_f32_16x16x32_bf16 v[64:67], v[184:187], v[88:91], v[64:67]
    v_mfma_f32_16x16x32_bf16 v[72:75], v[184:187], v[92:95], v[72:75]
    v_mfma_f32_16x16x32_bf16 v[76:79], v[188:191], v[92:95], v[76:79]
    v_mfma_f32_16x16x32_bf16 v[68:71], v[188:191], v[88:91], v[68:71]
    s_waitcnt lgkmcnt(0)
    v_mfma_f32_16x16x32_bf16 v[48:51], v[192:195], v[80:83], v[48:51]
    ds_read_b128 v[88:91], v4 offset:43008
    v_mfma_f32_16x16x32_bf16 v[56:59], v[192:195], v[84:87], v[56:59]
    buffer_load_dwordx4 v1, s[16:19], s42 offen offset:1024 sc1 lds
    v_mfma_f32_16x16x32_bf16 v[60:63], v[196:199], v[84:87], v[60:63]
    ds_read_b128 v[92:95], v5 offset:43008
    v_mfma_f32_16x16x32_bf16 v[52:55], v[196:199], v[80:83], v[52:55]
    v_mfma_f32_16x16x32_bf16 v[64:67], v[200:203], v[80:83], v[64:67]
    v_mfma_f32_16x16x32_bf16 v[72:75], v[200:203], v[84:87], v[72:75]
    v_mfma_f32_16x16x32_bf16 v[76:79], v[204:207], v[84:87], v[76:79]
    buffer_load_dwordx4 v1, s[16:19], s42 offen offset:2048 sc1 lds
    v_mfma_f32_16x16x32_bf16 v[68:71], v[204:207], v[80:83], v[68:71]
    s_waitcnt lgkmcnt(0)
    s_add_u32 s45, s45, 65536
    v_mfma_f32_16x16x32_bf16 v[48:51], v[208:211], v[88:91], v[48:51]
    ds_read_b128 v[80:83], v4 offset:45056
    v_mfma_f32_16x16x32_bf16 v[56:59], v[208:211], v[92:95], v[56:59]
    v_mfma_f32_16x16x32_bf16 v[60:63], v[212:215], v[92:95], v[60:63]
    ds_read_b128 v[84:87], v5 offset:45056
    v_mfma_f32_16x16x32_bf16 v[52:55], v[212:215], v[88:91], v[52:55]
    v_mfma_f32_16x16x32_bf16 v[64:67], v[216:219], v[88:91], v[64:67]
    v_mfma_f32_16x16x32_bf16 v[72:75], v[216:219], v[92:95], v[72:75]
    v_mfma_f32_16x16x32_bf16 v[76:79], v[220:223], v[92:95], v[76:79]
    v_mfma_f32_16x16x32_bf16 v[68:71], v[220:223], v[88:91], v[68:71]
    s_waitcnt lgkmcnt(0)
    v_mfma_f32_16x16x32_bf16 v[48:51], v[224:227], v[80:83], v[48:51]
    ds_read_b128 v[88:91], v4 offset:47104
    v_mfma_f32_16x16x32_bf16 v[56:59], v[224:227], v[84:87], v[56:59]
    v_mfma_f32_16x16x32_bf16 v[60:63], v[228:231], v[84:87], v[60:63]
    ds_read_b128 v[92:95], v5 offset:47104
    v_mfma_f32_16x16x32_bf16 v[52:55], v[228:231], v[80:83], v[52:55]
    v_mfma_f32_16x16x32_bf16 v[64:67], v[232:235], v[80:83], v[64:67]
    v_mfma_f32_16x16x32_bf16 v[72:75], v[232:235], v[84:87], v[72:75]
    v_mfma_f32_16x16x32_bf16 v[76:79], v[236:239], v[84:87], v[76:79]
    v_mfma_f32_16x16x32_bf16 v[68:71], v[236:239], v[80:83], v[68:71]
    s_waitcnt vmcnt(7) lgkmcnt(0)
    s_barrier
    v_mfma_f32_16x16x32_bf16 v[48:51], v[240:243], v[88:91], v[48:51]
    ds_read_b128 v[80:83], v2 offset:0
    v_mfma_f32_16x16x32_bf16 v[56:59], v[240:243], v[92:95], v[56:59]
    v_mfma_f32_16x16x32_bf16 v[60:63], v[244:247], v[92:95], v[60:63]
    ds_read_b128 v[84:87], v3 offset:0
    v_mfma_f32_16x16x32_bf16 v[52:55], v[244:247], v[88:91], v[52:55]
    v_mfma_f32_16x16x32_bf16 v[64:67], v[248:251], v[88:91], v[64:67]
    v_mfma_f32_16x16x32_bf16 v[72:75], v[248:251], v[92:95], v[72:75]
    v_mfma_f32_16x16x32_bf16 v[76:79], v[252:255], v[92:95], v[76:79]
    s_add_u32 s36, s36, 1
    v_mfma_f32_16x16x32_bf16 v[68:71], v[252:255], v[88:91], v[68:71]
    s_waitcnt lgkmcnt(0)
    s_cmp_lt_u32 s36, 32
    s_cbranch_scc1 L_bs_b0
    s_nop 7
    s_and_b32 s44, s90, 0xffffffff
    s_cmp_lt_i32 s36, 1
    s_cselect_b32 s44, 0x5e00000, s44
    s_xor_b32 s49, s44, 0
    v_cvt_pk_bf16_f32 v48, v48, v49
    v_cvt_pk_bf16_f32 v49, v50, v51
    v_cvt_pk_bf16_f32 v50, v52, v53
    v_cvt_pk_bf16_f32 v51, v54, v55
    buffer_store_dwordx4 v[48:51], v1, s[16:19], s49 offen offset:3072 sc1
    s_xor_b32 s49, s44, 16384
    v_cvt_pk_bf16_f32 v56, v56, v57
    v_cvt_pk_bf16_f32 v57, v58, v59
    v_cvt_pk_bf16_f32 v58, v60, v61
    v_cvt_pk_bf16_f32 v59, v62, v63
    buffer_store_dwordx4 v[56:59], v1, s[16:19], s49 offen offset:3072 sc1
    s_xor_b32 s49, s44, 32768
    v_cvt_pk_bf16_f32 v64, v64, v65
    v_cvt_pk_bf16_f32 v65, v66, v67
    v_cvt_pk_bf16_f32 v66, v68, v69
    v_cvt_pk_bf16_f32 v67, v70, v71
    buffer_store_dwordx4 v[64:67], v1, s[16:19], s49 offen offset:3072 sc1
    s_xor_b32 s49, s44, 49152
    v_cvt_pk_bf16_f32 v72, v72, v73
    v_cvt_pk_bf16_f32 v73, v74, v75
    v_cvt_pk_bf16_f32 v74, v76, v77
    v_cvt_pk_bf16_f32 v75, v78, v79
    buffer_store_dwordx4 v[72:75], v1, s[16:19], s49 offen offset:3072 sc1
    s_add_u32 s90, s90, 262144
    s_waitcnt vmcnt(0)
    s_barrier
    buffer_store_dword v124, v124, s[16:19], s91 offen sc1
    s_add_u32 s91, s91, 65536
    s_waitcnt vmcnt(0)
    s_endpgm
L_spin71:
    s_mov_b32 s40, 0x20000
L_spin71_l:
    buffer_load_dword v48, v124, s[20:23], 0 offen sc1
    s_sub_u32 s40, s40, 1
    s_waitcnt vmcnt(0)
    v_cmp_eq_u32 vcc, v124, v48
    s_cbranch_scc1 L_back72
    s_cbranch_vccz L_back72
    s_sleep 8
    s_branch L_spin71_l
L_spin73:
    s_mov_b32 s40, 0x20000
L_spin73_l:
    buffer_load_dword v49, v48, s[16:19], s38 offen sc1
    s_sub_u32 s40, s40, 1
    s_waitcnt vmcnt(0)
    v_cmp_ne_u32 vcc, 0, v49
    s_cbranch_scc1 L_back74
    s_cbranch_vccz L_back74
    s_sleep 8
    s_branch L_spin73_l
L_spin76:
    s_mov_b32 s40, 0x20000
L_spin76_l:
    buffer_load_dword v80, v124, s[20:23], 0 offen sc1
    s_sub_u32 s40, s40, 1
    s_waitcnt vmcnt(0)
    v_cmp_eq_u32 vcc, v124, v80
    s_cbranch_scc1 L_back77
    s_cbranch_vccz L_back77
    s_sleep 8
    s_branch L_spin76_l
L_spin78:
    s_mov_b32 s40, 0x20000
L_spin78_l:
    buffer_load_dword v96, v6, s[16:19], s45 offen sc1
    s_sub_u32 s40, s40, 1
    s_waitcnt vmcnt(0)
    v_cmp_ne_u32 vcc, 0, v96
    s_cbranch_scc1 L_back79
    s_cbranch_vccz L_back79
    s_sleep 2
    s_branch L_spin78_l
L_spin80:
    s_mov_b32 s40, 0x20000
L_spin80_l:
    buffer_load_dword v96, v6, s[16:19], s45 offen sc1
    s_sub_u32 s40, s40, 1
    s_waitcnt vmcnt(0)
    v_cmp_ne_u32 vcc, 0, v96
    s_cbranch_scc1 L_back81
    s_cbranch_vccz L_back81
    s_sleep 2
    s_branch L_spin80_l
L_spin82:
    s_mov_b32 s40, 0x20000
L_spin82_l:
    buffer_load_dword v96, v6, s[16:19], s45 offen sc1
    s_sub_u32 s40, s40, 1
    s_waitcnt vmcnt(0)
    v_cmp_ne_u32 vcc, 0, v96
    s_cbranch_scc1 L_back83
    s_cbranch_vccz L_back83
    s_sleep 2
    s_branch L_spin82_l
L_code_end:
    s_endpgm
.section .rodata,"a"
.p2align 6
.amdhsa_kernel interleave_layers__sliding_local_dilated__dense_activation_squared_relu__prompt_kernel
  .amdhsa_next_free_vgpr 512
  .amdhsa_next_free_sgpr 102
  .amdhsa_accum_offset 256
  .amdhsa_group_segment_fixed_size 0
  .amdhsa_kernarg_size 88
  .amdhsa_user_sgpr_count 2
  .amdhsa_user_sgpr_kernarg_segment_ptr 1
  .amdhsa_system_sgpr_workgroup_id_x 1
.end_amdhsa_kernel
```

```asm
; @launch grid=(256,1,1) block=(256,1,1) lds=163840
.amdgcn_target "amdgcn-amd-amdhsa--gfx950"
.text
.globl interleave_layers__sliding_local_dilated__dense_activation_squared_relu__prompt_kernel
.p2align 8
.type interleave_layers__sliding_local_dilated__dense_activation_squared_relu__prompt_kernel,@function
interleave_layers__sliding_local_dilated__dense_activation_squared_relu__prompt_kernel:
    s_load_dwordx16 s[64:79], s[0:1], 0x0
    s_load_dwordx4 s[80:83], s[0:1], 0x40
    s_load_dwordx2 s[84:85], s[0:1], 0x50
    v_lshrrev_b32 v1, 6, v0
    s_cmp_ge_u32 s2, 256
    s_cbranch_scc1 L_code_end
    s_getpc_b64 s[20:21]
L_pc:
    s_mov_b32 s22, L_code_end-L_pc
    s_mov_b32 s23, 0x00020000
    v_lshlrev_b32 v7, 12, v0
    s_lshl_b32 s37, s2, 4
    buffer_load_dword v252, v7, s[20:23], s37 offen
    v_readfirstlane_b32 s32, v1
    v_and_b32 v0, 63, v0
    v_lshlrev_b32 v1, 4, v0
    s_bfe_u32 s47, s2, 0x20001
    s_and_b32 s37, s2, 0x81
    s_cmp_lg_u32 s37, 0
    s_cbranch_scc1 L_other
    s_bfe_u32 s33, s2, 0x20003
    s_lshr_b32 s34, s2, 5
    s_lshl2_add_u32 s34, s47, s34
    s_mov_b32 s35, s34
    s_movk_i32 s39, 6144
    s_lshl_b32 s54, s35, 7
    v_lshrrev_b32 v32, 3, v0
    v_lshlrev_b32 v33, 2, v0
    v_and_b32 v33, 64, v33
    v_and_b32 v34, 0x70, v1
    v_xor_b32 v33, v33, v34
    v_mad_u32_u24 v20, v32, s39, v33
    v_add_u32 v21, 49152, v20
    v_add_u32 v22, 2048, v20
    v_add_u32 v23, 51200, v20
    v_add_u32 v24, 4096, v20
    v_add_u32 v25, 53248, v20
    s_mul_i32 s38, s32, 98304
    s_add_u32 s54, s54, s38
    s_lshl_b32 s42, s32, 11
    s_lshr_b32 s51, s32, 1
    s_lshl_b32 s50, s33, 5
    s_add_u32 s53, s50, 31
    s_lshl_b32 s53, s53, 8
    s_add_u32 s53, s53, s51
    s_lshl_b32 s53, s53, 7
    s_add_u32 s50, s50, 30
    s_sub_u32 s50, s50, s51
    s_lshl_b32 s41, s50, 15
    s_lshl_b32 s43, s32, 10
    v_lshlrev_b32 v37, 1, v0
    v_and_b32 v37, 0x60, v37
    v_xor_b32 v37, v37, v34
    s_and_b32 s37, s32, 1
    s_lshl_b32 s37, s37, 14
    v_lshl_add_u32 v6, v32, 11, v37
    v_add_u32 v6, s37, v6
    s_waitcnt lgkmcnt(0)
    s_mov_b32 s12, s66
    s_mov_b32 s13, s67
    s_mov_b32 s14, 0x600000
    s_mov_b32 s15, 0x00020000
    s_mov_b32 s8, s64
    s_mov_b32 s9, s65
    s_mov_b32 s10, 0x400000
    s_mov_b32 s11, 0x00020000
    s_add_u32 m0, s43, 131072
    s_nop 0
    buffer_load_dwordx4 v6, s[8:11], s53 offen offset:0 sc1 lds
    s_add_u32 m0, s43, 98304
    s_nop 0
    buffer_load_dwordx4 v6, s[8:11], s41 offen offset:0 sc1 lds
    s_add_u32 m0, s42, 73728
    s_nop 0
    buffer_load_dwordx4 v20, s[12:15], s54 offen lds
    s_add_u32 m0, s42, 74752
    s_nop 0
    buffer_load_dwordx4 v21, s[12:15], s54 offen lds
    s_add_u32 m0, s42, 81920
    s_nop 0
    buffer_load_dwordx4 v22, s[12:15], s54 offen lds
    s_add_u32 m0, s42, 82944
    s_nop 0
    buffer_load_dwordx4 v23, s[12:15], s54 offen lds
    s_add_u32 m0, s42, 90112
    s_nop 0
    buffer_load_dwordx4 v24, s[12:15], s54 offen lds
    s_add_u32 m0, s42, 91136
    s_nop 0
    buffer_load_dwordx4 v25, s[12:15], s54 offen lds
    s_add_u32 s54, s54, 393216
    v_lshrrev_b32 v32, 4, v0
    v_bfe_u32 v33, v0, 2, 2
    v_lshl_add_u32 v32, v32, 3, v33
    v_lshlrev_b32 v32, 7, v32
    v_lshrrev_b32 v33, 1, v33
    v_lshl_add_u32 v32, v33, 6, v32
    v_and_b32 v33, 3, v0
    v_lshl_add_u32 v32, v33, 4, v32
    s_lshl_b32 s37, s51, 6
    s_and_b32 s38, s32, 1
    s_lshl_b32 s38, s38, 3
    s_add_u32 s37, s37, s38
    s_add_u32 s37, s37, 0
    v_xor_b32 v26, s37, v32
    s_lshl_b32 s37, s51, 6
    s_and_b32 s38, s32, 1
    s_lshl_b32 s38, s38, 3
    s_add_u32 s37, s37, s38
    s_add_u32 s37, s37, 8192
    v_xor_b32 v27, s37, v32
    s_lshl_b32 s37, s51, 6
    s_and_b32 s38, s32, 1
    s_lshl_b32 s38, s38, 3
    s_add_u32 s37, s37, s38
    s_add_u32 s37, s37, 16384
    v_xor_b32 v28, s37, v32
    v_mov_b32 v32, 0x3f803f80
    v_mov_b32 v33, 0x3f803f80
    v_mov_b32 v34, 0x3f803f80
    v_mov_b32 v35, 0x3f803f80
    v_and_b32 v36, 15, v0
    v_lshrrev_b32 v37, 4, v0
    v_and_b32 v38, 6, v36
    v_xor_b32 v38, v37, v38
    v_lshlrev_b32 v38, 4, v38
    v_lshl_add_u32 v2, v36, 7, v38
    v_xor_b32 v3, 64, v2
    v_add_u32 v4, 98304, v2
    v_add_u32 v5, 98304, v3
    s_add_u32 m0, s43, 102272
    s_nop 0
    buffer_load_dwordx4 v6, s[8:11], s41 offen offset:128 sc1 lds
    s_add_u32 m0, s42, 0
    s_nop 0
    buffer_load_dwordx4 v20, s[12:15], s54 offen lds
    s_add_u32 m0, s42, 1024
    s_nop 0
    buffer_load_dwordx4 v21, s[12:15], s54 offen lds
    s_add_u32 m0, s42, 8192
    s_nop 0
    buffer_load_dwordx4 v22, s[12:15], s54 offen lds
    s_add_u32 m0, s42, 9216
    s_nop 0
    buffer_load_dwordx4 v23, s[12:15], s54 offen lds
    s_add_u32 m0, s42, 16384
    s_nop 0
    buffer_load_dwordx4 v24, s[12:15], s54 offen lds
    s_add_u32 m0, s42, 17408
    s_nop 0
    buffer_load_dwordx4 v25, s[12:15], s54 offen lds
    s_add_u32 s54, s54, 393216
    s_add_u32 m0, s43, 134912
    s_nop 0
    buffer_load_dwordx4 v6, s[8:11], s53 offen offset:256 sc1 lds
    s_add_u32 m0, s43, 106240
    s_nop 0
    buffer_load_dwordx4 v6, s[8:11], s41 offen offset:256 sc1 lds
    s_add_u32 m0, s42, 24576
    s_nop 0
    buffer_load_dwordx4 v20, s[12:15], s54 offen lds
    s_add_u32 m0, s42, 25600
    s_nop 0
    buffer_load_dwordx4 v21, s[12:15], s54 offen lds
    s_add_u32 m0, s42, 32768
    s_nop 0
    buffer_load_dwordx4 v22, s[12:15], s54 offen lds
    s_add_u32 m0, s42, 33792
    s_nop 0
    buffer_load_dwordx4 v23, s[12:15], s54 offen lds
    s_add_u32 m0, s42, 40960
    s_nop 0
    buffer_load_dwordx4 v24, s[12:15], s54 offen lds
    s_add_u32 m0, s42, 41984
    s_nop 0
    buffer_load_dwordx4 v25, s[12:15], s54 offen lds
    s_add_u32 s54, s54, 393216
    s_mov_b32 s36, -1
    v_add_u32 v29, 73728, v26
    v_add_u32 v30, 73728, v27
    v_add_u32 v31, 73728, v28
    s_waitcnt vmcnt(15) lgkmcnt(0)
    s_barrier
    ds_read_b128 v[68:71], v4 offset:0
    s_add_u32 m0, s43, 110208
    ds_read_b128 v[72:75], v4 offset:2048
    buffer_load_dwordx4 v6, s[8:11], s41 offen offset:384 sc1 lds
    ds_read_b128 v[76:79], v4 offset:32768
    s_add_u32 m0, s42, 49152
    ds_read_b64_tr_b16 a[0:1], v29 offset:0
    buffer_load_dwordx4 v20, s[12:15], s54 offen lds
    ds_read_b64_tr_b16 a[2:3], v29 offset:512
    s_add_u32 m0, s42, 50176
    ds_read_b64_tr_b16 a[4:5], v30 offset:0
    buffer_load_dwordx4 v21, s[12:15], s54 offen lds
    ds_read_b64_tr_b16 a[6:7], v30 offset:512
    s_add_u32 m0, s42, 57344
    ds_read_b64_tr_b16 a[8:9], v31 offset:0
    buffer_load_dwordx4 v22, s[12:15], s54 offen lds
    ds_read_b64_tr_b16 a[10:11], v31 offset:512
    s_waitcnt lgkmcnt(0)
    v_mfma_f32_16x16x32_bf16 v[44:47], a[0:3], v[68:71], 0
    ds_read_b128 v[80:83], v5 offset:0
    s_add_u32 m0, s42, 58368
    v_mfma_f32_16x16x32_bf16 v[48:51], a[0:3], v[72:75], 0
    ds_read_b128 v[84:87], v5 offset:2048
    buffer_load_dwordx4 v23, s[12:15], s54 offen lds
    v_mfma_f32_16x16x32_bf16 v[92:95], a[0:3], v[76:79], 0
    ds_read_b128 v[88:91], v5 offset:32768
    s_add_u32 m0, s42, 65536
    v_mfma_f32_16x16x32_bf16 v[52:55], a[4:7], v[68:71], 0
    ds_read_b64_tr_b16 a[12:13], v29 offset:4096
    buffer_load_dwordx4 v24, s[12:15], s54 offen lds
    v_mfma_f32_16x16x32_bf16 v[56:59], a[4:7], v[72:75], 0
    ds_read_b64_tr_b16 a[14:15], v29 offset:4608
    s_add_u32 m0, s42, 66560
    v_mfma_f32_16x16x32_bf16 v[96:99], a[4:7], v[76:79], 0
    ds_read_b64_tr_b16 a[16:17], v30 offset:4096
    buffer_load_dwordx4 v25, s[12:15], s54 offen lds
    v_mfma_f32_16x16x32_bf16 v[60:63], a[8:11], v[68:71], 0
    ds_read_b64_tr_b16 a[18:19], v30 offset:4608
    s_add_u32 s54, s54, 393216
    v_mfma_f32_16x16x32_bf16 v[64:67], a[8:11], v[72:75], 0
    ds_read_b64_tr_b16 a[20:21], v31 offset:4096
    v_mfma_f32_16x16x32_bf16 v[118:121], a[8:11], v[76:79], 0
    ds_read_b64_tr_b16 a[22:23], v31 offset:4608
    v_mfma_f32_16x16x32_bf16 v[100:103], a[0:3], v[32:35], 0
    v_mfma_f32_16x16x32_bf16 v[104:107], a[4:7], v[32:35], 0
    v_mfma_f32_16x16x32_bf16 v[108:111], a[8:11], v[32:35], 0
    s_mov_b32 s16, s84
    s_mov_b32 s17, s85
    s_mov_b32 s18, 0x5e00000
    s_mov_b32 s19, 0x00020000
    v_min_u32 v124, 1, v0
    v_lshlrev_b32 v124, 30, v124
    s_lshl_b32 s91, s33, 6
    s_add_u32 s91, s91, s34
    s_lshl_b32 s91, s91, 7
    s_add_u32 s91, s91, 0x5520000
    s_cmp_eq_u32 s32, 1
    s_cselect_b32 s91, s91, 0x5f00000
    v_add_u32 v29, 0, v26
    v_add_u32 v30, 0, v27
    v_add_u32 v31, 0, v28
    s_waitcnt vmcnt(15) lgkmcnt(0)
    s_barrier
    v_mfma_f32_16x16x32_bf16 v[44:47], a[12:15], v[80:83], v[44:47]
    ds_read_b128 v[68:71], v4 offset:4096
    s_add_u32 m0, s43, 138752
    v_mfma_f32_16x16x32_bf16 v[48:51], a[12:15], v[84:87], v[48:51]
    ds_read_b128 v[72:75], v4 offset:6144
    buffer_load_dwordx4 v6, s[8:11], s53 offen offset:512 sc1 lds
    v_mfma_f32_16x16x32_bf16 v[92:95], a[12:15], v[88:91], v[92:95]
    ds_read_b128 v[76:79], v4 offset:34816
    s_add_u32 m0, s43, 114176
    v_mfma_f32_16x16x32_bf16 v[52:55], a[16:19], v[80:83], v[52:55]
    ds_read_b64_tr_b16 a[24:25], v29 offset:0
    buffer_load_dwordx4 v6, s[8:11], s41 offen offset:512 sc1 lds
    v_mfma_f32_16x16x32_bf16 v[56:59], a[16:19], v[84:87], v[56:59]
    ds_read_b64_tr_b16 a[26:27], v29 offset:512
    s_add_u32 m0, s42, 73728
    v_mfma_f32_16x16x32_bf16 v[96:99], a[16:19], v[88:91], v[96:99]
    ds_read_b64_tr_b16 a[28:29], v30 offset:0
    buffer_load_dwordx4 v20, s[12:15], s54 offen lds
    v_mfma_f32_16x16x32_bf16 v[60:63], a[20:23], v[80:83], v[60:63]
    ds_read_b64_tr_b16 a[30:31], v30 offset:512
    s_add_u32 m0, s42, 74752
    v_mfma_f32_16x16x32_bf16 v[64:67], a[20:23], v[84:87], v[64:67]
    ds_read_b64_tr_b16 a[32:33], v31 offset:0
    buffer_load_dwordx4 v21, s[12:15], s54 offen lds
    v_mfma_f32_16x16x32_bf16 v[118:121], a[20:23], v[88:91], v[118:121]
    ds_read_b64_tr_b16 a[34:35], v31 offset:512
    v_mfma_f32_16x16x32_bf16 v[100:103], a[12:15], v[32:35], v[100:103]
    v_mfma_f32_16x16x32_bf16 v[104:107], a[16:19], v[32:35], v[104:107]
    v_mfma_f32_16x16x32_bf16 v[108:111], a[20:23], v[32:35], v[108:111]
    s_waitcnt lgkmcnt(0)
    v_mfma_f32_16x16x32_bf16 v[44:47], a[24:27], v[68:71], v[44:47]
    ds_read_b128 v[80:83], v5 offset:4096
    s_add_u32 m0, s42, 81920
    v_mfma_f32_16x16x32_bf16 v[48:51], a[24:27], v[72:75], v[48:51]
    ds_read_b128 v[84:87], v5 offset:6144
    buffer_load_dwordx4 v22, s[12:15], s54 offen lds
    v_mfma_f32_16x16x32_bf16 v[92:95], a[24:27], v[76:79], v[92:95]
    ds_read_b128 v[88:91], v5 offset:34816
    s_add_u32 m0, s42, 82944
    v_mfma_f32_16x16x32_bf16 v[52:55], a[28:31], v[68:71], v[52:55]
    ds_read_b64_tr_b16 a[36:37], v29 offset:4096
    buffer_load_dwordx4 v23, s[12:15], s54 offen lds
    v_mfma_f32_16x16x32_bf16 v[56:59], a[28:31], v[72:75], v[56:59]
    ds_read_b64_tr_b16 a[38:39], v29 offset:4608
    s_add_u32 m0, s42, 90112
    v_mfma_f32_16x16x32_bf16 v[96:99], a[28:31], v[76:79], v[96:99]
    ds_read_b64_tr_b16 a[40:41], v30 offset:4096
    buffer_load_dwordx4 v24, s[12:15], s54 offen lds
    v_mfma_f32_16x16x32_bf16 v[60:63], a[32:35], v[68:71], v[60:63]
    ds_read_b64_tr_b16 a[42:43], v30 offset:4608
    s_add_u32 m0, s42, 91136
    v_mfma_f32_16x16x32_bf16 v[64:67], a[32:35], v[72:75], v[64:67]
    ds_read_b64_tr_b16 a[44:45], v31 offset:4096
    buffer_load_dwordx4 v25, s[12:15], s54 offen lds
    v_mfma_f32_16x16x32_bf16 v[118:121], a[32:35], v[76:79], v[118:121]
    ds_read_b64_tr_b16 a[46:47], v31 offset:4608
    s_add_u32 s54, s54, 393216
    v_mfma_f32_16x16x32_bf16 v[100:103], a[24:27], v[32:35], v[100:103]
    v_mfma_f32_16x16x32_bf16 v[104:107], a[28:31], v[32:35], v[104:107]
    v_mfma_f32_16x16x32_bf16 v[108:111], a[32:35], v[32:35], v[108:111]
    s_add_u32 s88, s84, 0x5000000
    s_addc_u32 s89, s85, 0
    s_mov_b32 s97, 14
    s_and_b32 s38, s32, 1
    v_lshlrev_b32 v40, 1, v0
    v_and_b32 v40, 0x30, v40
    v_xor_b32 v40, v40, v1
    s_mul_i32 s37, s51, 3072
    s_add_u32 s37, s37, 65536
    s_lshl_b32 s39, s38, 3
    s_add_u32 s39, s39, s37
    v_add_u32 v29, 24576, v26
    v_add_u32 v30, 24576, v27
    v_add_u32 v31, 24576, v28
    s_waitcnt vmcnt(15) lgkmcnt(0)
    s_barrier
    v_mfma_f32_16x16x32_bf16 v[44:47], a[36:39], v[80:83], v[44:47]
    ds_read_b128 v[68:71], v4 offset:8192
    s_add_u32 m0, s43, 118144
    v_mfma_f32_16x16x32_bf16 v[48:51], a[36:39], v[84:87], v[48:51]
    ds_read_b128 v[72:75], v4 offset:10240
    buffer_load_dwordx4 v6, s[8:11], s41 offen offset:640 sc1 lds
    v_mfma_f32_16x16x32_bf16 v[92:95], a[36:39], v[88:91], v[92:95]
    ds_read_b128 v[76:79], v4 offset:36864
    s_add_u32 m0, s42, 0
    v_mfma_f32_16x16x32_bf16 v[52:55], a[40:43], v[80:83], v[52:55]
    ds_read_b64_tr_b16 a[48:49], v29 offset:0
    buffer_load_dwordx4 v20, s[12:15], s54 offen lds
    v_mfma_f32_16x16x32_bf16 v[56:59], a[40:43], v[84:87], v[56:59]
    ds_read_b64_tr_b16 a[50:51], v29 offset:512
    s_add_u32 m0, s42, 1024
    v_mfma_f32_16x16x32_bf16 v[96:99], a[40:43], v[88:91], v[96:99]
    ds_read_b64_tr_b16 a[52:53], v30 offset:0
    buffer_load_dwordx4 v21, s[12:15], s54 offen lds
    v_mfma_f32_16x16x32_bf16 v[60:63], a[44:47], v[80:83], v[60:63]
    ds_read_b64_tr_b16 a[54:55], v30 offset:512
    s_add_u32 m0, s42, 8192
    v_mfma_f32_16x16x32_bf16 v[64:67], a[44:47], v[84:87], v[64:67]
    ds_read_b64_tr_b16 a[56:57], v31 offset:0
    buffer_load_dwordx4 v22, s[12:15], s54 offen lds
    v_mfma_f32_16x16x32_bf16 v[118:121], a[44:47], v[88:91], v[118:121]
    ds_read_b64_tr_b16 a[58:59], v31 offset:512
    v_mfma_f32_16x16x32_bf16 v[100:103], a[36:39], v[32:35], v[100:103]
    v_mfma_f32_16x16x32_bf16 v[104:107], a[40:43], v[32:35], v[104:107]
    v_mfma_f32_16x16x32_bf16 v[108:111], a[44:47], v[32:35], v[108:111]
    s_waitcnt lgkmcnt(0)
    v_mfma_f32_16x16x32_bf16 v[44:47], a[48:51], v[68:71], v[44:47]
    ds_read_b128 v[80:83], v5 offset:8192
    s_add_u32 m0, s42, 9216
    v_mfma_f32_16x16x32_bf16 v[48:51], a[48:51], v[72:75], v[48:51]
    ds_read_b128 v[84:87], v5 offset:10240
    buffer_load_dwordx4 v23, s[12:15], s54 offen lds
    v_mfma_f32_16x16x32_bf16 v[92:95], a[48:51], v[76:79], v[92:95]
    ds_read_b128 v[88:91], v5 offset:36864
    s_add_u32 m0, s42, 16384
    v_mfma_f32_16x16x32_bf16 v[52:55], a[52:55], v[68:71], v[52:55]
    ds_read_b64_tr_b16 a[60:61], v29 offset:4096
    buffer_load_dwordx4 v24, s[12:15], s54 offen lds
    v_mfma_f32_16x16x32_bf16 v[56:59], a[52:55], v[72:75], v[56:59]
    ds_read_b64_tr_b16 a[62:63], v29 offset:4608
    s_add_u32 m0, s42, 17408
    v_mfma_f32_16x16x32_bf16 v[96:99], a[52:55], v[76:79], v[96:99]
    ds_read_b64_tr_b16 a[64:65], v30 offset:4096
    buffer_load_dwordx4 v25, s[12:15], s54 offen lds
    v_mfma_f32_16x16x32_bf16 v[60:63], a[56:59], v[68:71], v[60:63]
    ds_read_b64_tr_b16 a[66:67], v30 offset:4608
    s_add_u32 s54, s54, 393216
    v_mfma_f32_16x16x32_bf16 v[64:67], a[56:59], v[72:75], v[64:67]
    ds_read_b64_tr_b16 a[68:69], v31 offset:4096
    v_mfma_f32_16x16x32_bf16 v[118:121], a[56:59], v[76:79], v[118:121]
    ds_read_b64_tr_b16 a[70:71], v31 offset:4608
    v_mfma_f32_16x16x32_bf16 v[100:103], a[48:51], v[32:35], v[100:103]
    v_mfma_f32_16x16x32_bf16 v[104:107], a[52:55], v[32:35], v[104:107]
    v_mfma_f32_16x16x32_bf16 v[108:111], a[56:59], v[32:35], v[108:111]
    v_add_u32 v7, s39, v40
    v_bfe_u32 v38, v0, 1, 2
    v_xor_b32 v38, v38, v37
    v_lshlrev_b32 v38, 4, v38
    v_lshl_add_u32 v38, v36, 6, v38
    v_add_u32 v8, s39, v38
    s_mul_i32 s39, s38, 6144
    s_add_u32 s39, s39, s37
    v_add_u32 v9, s39, v40
    s_cmp_eq_u32 s38, 0
    s_cselect_b32 s39, 18432, 0
    v_add_u32 v29, 49152, v26
    v_add_u32 v30, 49152, v27
    v_add_u32 v31, 49152, v28
    s_waitcnt vmcnt(15) lgkmcnt(0)
    s_barrier
    v_mfma_f32_16x16x32_bf16 v[44:47], a[60:63], v[80:83], v[44:47]
    ds_read_b128 v[68:71], v4 offset:12288
    s_add_u32 m0, s43, 142592
    v_mfma_f32_16x16x32_bf16 v[48:51], a[60:63], v[84:87], v[48:51]
    ds_read_b128 v[72:75], v4 offset:14336
    buffer_load_dwordx4 v6, s[8:11], s53 offen offset:768 sc1 lds
    v_mfma_f32_16x16x32_bf16 v[92:95], a[60:63], v[88:91], v[92:95]
    ds_read_b128 v[76:79], v4 offset:38912
    s_add_u32 m0, s43, 122112
    v_mfma_f32_16x16x32_bf16 v[52:55], a[64:67], v[80:83], v[52:55]
    ds_read_b64_tr_b16 a[72:73], v29 offset:0
    buffer_load_dwordx4 v6, s[8:11], s41 offen offset:768 sc1 lds
    v_mfma_f32_16x16x32_bf16 v[56:59], a[64:67], v[84:87], v[56:59]
    ds_read_b64_tr_b16 a[74:75], v29 offset:512
    s_add_u32 m0, s42, 24576
    v_mfma_f32_16x16x32_bf16 v[96:99], a[64:67], v[88:91], v[96:99]
    ds_read_b64_tr_b16 a[76:77], v30 offset:0
    buffer_load_dwordx4 v20, s[12:15], s54 offen lds
    v_mfma_f32_16x16x32_bf16 v[60:63], a[68:71], v[80:83], v[60:63]
    ds_read_b64_tr_b16 a[78:79], v30 offset:512
    s_add_u32 m0, s42, 25600
    v_mfma_f32_16x16x32_bf16 v[64:67], a[68:71], v[84:87], v[64:67]
    ds_read_b64_tr_b16 a[80:81], v31 offset:0
    buffer_load_dwordx4 v21, s[12:15], s54 offen lds
    v_mfma_f32_16x16x32_bf16 v[118:121], a[68:71], v[88:91], v[118:121]
    ds_read_b64_tr_b16 a[82:83], v31 offset:512
    v_mfma_f32_16x16x32_bf16 v[100:103], a[60:63], v[32:35], v[100:103]
    v_mfma_f32_16x16x32_bf16 v[104:107], a[64:67], v[32:35], v[104:107]
    v_mfma_f32_16x16x32_bf16 v[108:111], a[68:71], v[32:35], v[108:111]
    s_waitcnt lgkmcnt(0)
    v_mfma_f32_16x16x32_bf16 v[44:47], a[72:75], v[68:71], v[44:47]
    ds_read_b128 v[80:83], v5 offset:12288
    s_add_u32 m0, s42, 32768
    v_mfma_f32_16x16x32_bf16 v[48:51], a[72:75], v[72:75], v[48:51]
    ds_read_b128 v[84:87], v5 offset:14336
    buffer_load_dwordx4 v22, s[12:15], s54 offen lds
    v_mfma_f32_16x16x32_bf16 v[92:95], a[72:75], v[76:79], v[92:95]
    ds_read_b128 v[88:91], v5 offset:38912
    s_add_u32 m0, s42, 33792
    v_mfma_f32_16x16x32_bf16 v[52:55], a[76:79], v[68:71], v[52:55]
    ds_read_b64_tr_b16 a[84:85], v29 offset:4096
    buffer_load_dwordx4 v23, s[12:15], s54 offen lds
    v_mfma_f32_16x16x32_bf16 v[56:59], a[76:79], v[72:75], v[56:59]
    ds_read_b64_tr_b16 a[86:87], v29 offset:4608
    s_add_u32 m0, s42, 40960
    v_mfma_f32_16x16x32_bf16 v[96:99], a[76:79], v[76:79], v[96:99]
    ds_read_b64_tr_b16 a[88:89], v30 offset:4096
    buffer_load_dwordx4 v24, s[12:15], s54 offen lds
    v_mfma_f32_16x16x32_bf16 v[60:63], a[80:83], v[68:71], v[60:63]
    ds_read_b64_tr_b16 a[90:91], v30 offset:4608
    s_add_u32 m0, s42, 41984
    v_mfma_f32_16x16x32_bf16 v[64:67], a[80:83], v[72:75], v[64:67]
    ds_read_b64_tr_b16 a[92:93], v31 offset:4096
    buffer_load_dwordx4 v25, s[12:15], s54 offen lds
    v_mfma_f32_16x16x32_bf16 v[118:121], a[80:83], v[76:79], v[118:121]
    ds_read_b64_tr_b16 a[94:95], v31 offset:4608
    s_add_u32 s54, s54, 393216
    v_mfma_f32_16x16x32_bf16 v[100:103], a[72:75], v[32:35], v[100:103]
    v_mfma_f32_16x16x32_bf16 v[104:107], a[76:79], v[32:35], v[104:107]
    v_mfma_f32_16x16x32_bf16 v[108:111], a[80:83], v[32:35], v[108:111]
    s_add_u32 s39, s39, s37
    v_add_u32 v10, s39, v40
    s_sub_u32 s39, s33, 1
    s_max_i32 s39, s39, 0
    v_mov_b32 v38, s33
    v_mov_b32 v39, s39
    v_mov_b32 v12, 1048576
    v_mov_b32 v41, 131072
    v_cmp_lt_u32 vcc, 15, v0
    s_nop 1
    v_cndmask_b32 v38, v38, v39, vcc
    v_cndmask_b32 v12, v12, v41, vcc
    v_add_u32 v29, 73728, v26
    v_add_u32 v30, 73728, v27
    v_add_u32 v31, 73728, v28
    s_waitcnt vmcnt(15) lgkmcnt(0)
    s_barrier
    v_mfma_f32_16x16x32_bf16 v[44:47], a[84:87], v[80:83], v[44:47]
    ds_read_b128 v[68:71], v4 offset:16384
    s_add_u32 m0, s43, 126080
    v_mfma_f32_16x16x32_bf16 v[48:51], a[84:87], v[84:87], v[48:51]
    ds_read_b128 v[72:75], v4 offset:18432
    buffer_load_dwordx4 v6, s[8:11], s41 offen offset:896 sc1 lds
    v_mfma_f32_16x16x32_bf16 v[92:95], a[84:87], v[88:91], v[92:95]
    ds_read_b128 v[76:79], v4 offset:40960
    s_add_u32 m0, s42, 49152
    v_mfma_f32_16x16x32_bf16 v[52:55], a[88:91], v[80:83], v[52:55]
    ds_read_b64_tr_b16 a[96:97], v29 offset:0
    buffer_load_dwordx4 v20, s[12:15], s54 offen lds
    v_mfma_f32_16x16x32_bf16 v[56:59], a[88:91], v[84:87], v[56:59]
    ds_read_b64_tr_b16 a[98:99], v29 offset:512
    s_add_u32 m0, s42, 50176
    v_mfma_f32_16x16x32_bf16 v[96:99], a[88:91], v[88:91], v[96:99]
    ds_read_b64_tr_b16 a[100:101], v30 offset:0
    buffer_load_dwordx4 v21, s[12:15], s54 offen lds
    v_mfma_f32_16x16x32_bf16 v[60:63], a[92:95], v[80:83], v[60:63]
    ds_read_b64_tr_b16 a[102:103], v30 offset:512
    s_add_u32 m0, s42, 57344
    v_mfma_f32_16x16x32_bf16 v[64:67], a[92:95], v[84:87], v[64:67]
    ds_read_b64_tr_b16 a[104:105], v31 offset:0
    buffer_load_dwordx4 v22, s[12:15], s54 offen lds
    v_mfma_f32_16x16x32_bf16 v[118:121], a[92:95], v[88:91], v[118:121]
    ds_read_b64_tr_b16 a[106:107], v31 offset:512
    v_mfma_f32_16x16x32_bf16 v[100:103], a[84:87], v[32:35], v[100:103]
    v_mfma_f32_16x16x32_bf16 v[104:107], a[88:91], v[32:35], v[104:107]
    v_mfma_f32_16x16x32_bf16 v[108:111], a[92:95], v[32:35], v[108:111]
    s_waitcnt lgkmcnt(0)
    v_mfma_f32_16x16x32_bf16 v[44:47], a[96:99], v[68:71], v[44:47]
    ds_read_b128 v[80:83], v5 offset:16384
    s_add_u32 m0, s42, 58368
    v_mfma_f32_16x16x32_bf16 v[48:51], a[96:99], v[72:75], v[48:51]
    ds_read_b128 v[84:87], v5 offset:18432
    buffer_load_dwordx4 v23, s[12:15], s54 offen lds
    v_mfma_f32_16x16x32_bf16 v[92:95], a[96:99], v[76:79], v[92:95]
    ds_read_b128 v[88:91], v5 offset:40960
    s_add_u32 m0, s42, 65536
    v_mfma_f32_16x16x32_bf16 v[52:55], a[100:103], v[68:71], v[52:55]
    ds_read_b64_tr_b16 a[108:109], v29 offset:4096
    buffer_load_dwordx4 v24, s[12:15], s54 offen lds
    v_mfma_f32_16x16x32_bf16 v[56:59], a[100:103], v[72:75], v[56:59]
    ds_read_b64_tr_b16 a[110:111], v29 offset:4608
    s_add_u32 m0, s42, 66560
    v_mfma_f32_16x16x32_bf16 v[96:99], a[100:103], v[76:79], v[96:99]
    ds_read_b64_tr_b16 a[112:113], v30 offset:4096
    buffer_load_dwordx4 v25, s[12:15], s54 offen lds
    v_mfma_f32_16x16x32_bf16 v[60:63], a[104:107], v[68:71], v[60:63]
    ds_read_b64_tr_b16 a[114:115], v30 offset:4608
    s_add_u32 s54, s54, 393216
    v_mfma_f32_16x16x32_bf16 v[64:67], a[104:107], v[72:75], v[64:67]
    ds_read_b64_tr_b16 a[116:117], v31 offset:4096
    v_mfma_f32_16x16x32_bf16 v[118:121], a[104:107], v[76:79], v[118:121]
    ds_read_b64_tr_b16 a[118:119], v31 offset:4608
    v_mfma_f32_16x16x32_bf16 v[100:103], a[96:99], v[32:35], v[100:103]
    v_mfma_f32_16x16x32_bf16 v[104:107], a[100:103], v[32:35], v[104:107]
    v_mfma_f32_16x16x32_bf16 v[108:111], a[104:107], v[32:35], v[108:111]
    v_lshl_add_u32 v38, v38, 6, v36
    v_add_u32 v38, 697644, v38
    v_lshlrev_b32 v11, 7, v38
    s_cmp_eq_u32 s32, 0
    s_cselect_b32 s37, 32, 0
    v_cmp_le_u32 vcc, s37, v0
    s_nop 1
    v_cndmask_b32 v11, v11, 2.0, vcc
    v_mov_b32 v116, 0
    v_mov_b32 v117, v11
    s_mov_b32 s45, -786432
    v_and_b32 v13, 15, v0
    v_add_u32 v29, 0, v26
    v_add_u32 v30, 0, v27
    v_add_u32 v31, 0, v28
    s_waitcnt vmcnt(15) lgkmcnt(0)
    s_barrier
    v_mfma_f32_16x16x32_bf16 v[44:47], a[108:111], v[80:83], v[44:47]
    ds_read_b128 v[68:71], v4 offset:20480
    s_add_u32 m0, s43, 146432
    v_mfma_f32_16x16x32_bf16 v[48:51], a[108:111], v[84:87], v[48:51]
    ds_read_b128 v[72:75], v4 offset:22528
    buffer_load_dwordx4 v6, s[8:11], s53 offen offset:1024 sc1 lds
    v_mfma_f32_16x16x32_bf16 v[92:95], a[108:111], v[88:91], v[92:95]
    ds_read_b128 v[76:79], v4 offset:43008
    s_add_u32 m0, s43, 97280
    v_mfma_f32_16x16x32_bf16 v[52:55], a[112:115], v[80:83], v[52:55]
    ds_read_b64_tr_b16 a[120:121], v29 offset:0
    buffer_load_dwordx4 v6, s[8:11], s41 offen offset:1024 sc1 lds
    v_mfma_f32_16x16x32_bf16 v[56:59], a[112:115], v[84:87], v[56:59]
    ds_read_b64_tr_b16 a[122:123], v29 offset:512
    s_add_u32 m0, s42, 73728
    v_mfma_f32_16x16x32_bf16 v[96:99], a[112:115], v[88:91], v[96:99]
    ds_read_b64_tr_b16 a[124:125], v30 offset:0
    buffer_load_dwordx4 v20, s[12:15], s54 offen lds
    v_mfma_f32_16x16x32_bf16 v[60:63], a[116:119], v[80:83], v[60:63]
    ds_read_b64_tr_b16 a[126:127], v30 offset:512
    s_add_u32 m0, s42, 74752
    v_mfma_f32_16x16x32_bf16 v[64:67], a[116:119], v[84:87], v[64:67]
    ds_read_b64_tr_b16 a[128:129], v31 offset:0
    buffer_load_dwordx4 v21, s[12:15], s54 offen lds
    v_mfma_f32_16x16x32_bf16 v[118:121], a[116:119], v[88:91], v[118:121]
    ds_read_b64_tr_b16 a[130:131], v31 offset:512
    v_mfma_f32_16x16x32_bf16 v[100:103], a[108:111], v[32:35], v[100:103]
    v_mfma_f32_16x16x32_bf16 v[104:107], a[112:115], v[32:35], v[104:107]
    v_mfma_f32_16x16x32_bf16 v[108:111], a[116:119], v[32:35], v[108:111]
    s_waitcnt lgkmcnt(0)
    v_mfma_f32_16x16x32_bf16 v[44:47], a[120:123], v[68:71], v[44:47]
    ds_read_b128 v[80:83], v5 offset:20480
    s_add_u32 m0, s42, 81920
    v_mfma_f32_16x16x32_bf16 v[48:51], a[120:123], v[72:75], v[48:51]
    ds_read_b128 v[84:87], v5 offset:22528
    buffer_load_dwordx4 v22, s[12:15], s54 offen lds
    v_mfma_f32_16x16x32_bf16 v[92:95], a[120:123], v[76:79], v[92:95]
    ds_read_b128 v[88:91], v5 offset:43008
    s_add_u32 m0, s42, 82944
    v_mfma_f32_16x16x32_bf16 v[52:55], a[124:127], v[68:71], v[52:55]
    ds_read_b64_tr_b16 a[132:133], v29 offset:4096
    buffer_load_dwordx4 v23, s[12:15], s54 offen lds
    v_mfma_f32_16x16x32_bf16 v[56:59], a[124:127], v[72:75], v[56:59]
    ds_read_b64_tr_b16 a[134:135], v29 offset:4608
    s_add_u32 m0, s42, 90112
    v_mfma_f32_16x16x32_bf16 v[96:99], a[124:127], v[76:79], v[96:99]
    ds_read_b64_tr_b16 a[136:137], v30 offset:4096
    buffer_load_dwordx4 v24, s[12:15], s54 offen lds
    v_mfma_f32_16x16x32_bf16 v[60:63], a[128:131], v[68:71], v[60:63]
    ds_read_b64_tr_b16 a[138:139], v30 offset:4608
    s_add_u32 m0, s42, 91136
    v_mfma_f32_16x16x32_bf16 v[64:67], a[128:131], v[72:75], v[64:67]
    ds_read_b64_tr_b16 a[140:141], v31 offset:4096
    buffer_load_dwordx4 v25, s[12:15], s54 offen lds
    v_mfma_f32_16x16x32_bf16 v[118:121], a[128:131], v[76:79], v[118:121]
    ds_read_b64_tr_b16 a[142:143], v31 offset:4608
    s_add_u32 s54, s54, 393216
    v_mfma_f32_16x16x32_bf16 v[100:103], a[120:123], v[32:35], v[100:103]
    v_mfma_f32_16x16x32_bf16 v[104:107], a[124:127], v[32:35], v[104:107]
    v_mfma_f32_16x16x32_bf16 v[108:111], a[128:131], v[32:35], v[108:111]
    v_lshlrev_b32 v13, 3, v13
    v_lshrrev_b32 v38, 5, v0
    v_lshl_add_u32 v13, v38, 9, v13
    v_and_b32 v38, 16, v0
    v_lshl_add_u32 v13, v38, 6, v13
    v_add_u32 v13, 90112, v13
    s_lshl_b32 s52, s51, 10
    s_or_b32 s96, s50, 31
    s_mov_b32 s55, 0x541fc00
    s_lshl_b32 s46, s50, 10
    s_sub_u32 s46, s55, s46
    v_add_u32 v29, 24576, v26
    v_add_u32 v30, 24576, v27
    v_add_u32 v31, 24576, v28
    s_waitcnt vmcnt(15) lgkmcnt(0)
    s_barrier
    v_mfma_f32_16x16x32_bf16 v[44:47], a[132:135], v[80:83], v[44:47]
    ds_read_b128 v[68:71], v4 offset:24576
    s_add_u32 m0, s43, 101248
    v_mfma_f32_16x16x32_bf16 v[48:51], a[132:135], v[84:87], v[48:51]
    ds_read_b128 v[72:75], v4 offset:26624
    buffer_load_dwordx4 v6, s[8:11], s41 offen offset:1152 sc1 lds
    v_mfma_f32_16x16x32_bf16 v[92:95], a[132:135], v[88:91], v[92:95]
    ds_read_b128 v[76:79], v4 offset:45056
    s_add_u32 m0, s42, 0
    v_mfma_f32_16x16x32_bf16 v[52:55], a[136:139], v[80:83], v[52:55]
    ds_read_b64_tr_b16 a[144:145], v29 offset:0
    buffer_load_dwordx4 v20, s[12:15], s54 offen lds
    v_mfma_f32_16x16x32_bf16 v[56:59], a[136:139], v[84:87], v[56:59]
    ds_read_b64_tr_b16 a[146:147], v29 offset:512
    s_add_u32 m0, s42, 1024
    v_mfma_f32_16x16x32_bf16 v[96:99], a[136:139], v[88:91], v[96:99]
    ds_read_b64_tr_b16 a[148:149], v30 offset:0
    buffer_load_dwordx4 v21, s[12:15], s54 offen lds
    v_mfma_f32_16x16x32_bf16 v[60:63], a[140:143], v[80:83], v[60:63]
    ds_read_b64_tr_b16 a[150:151], v30 offset:512
    s_add_u32 m0, s42, 8192
    v_mfma_f32_16x16x32_bf16 v[64:67], a[140:143], v[84:87], v[64:67]
    ds_read_b64_tr_b16 a[152:153], v31 offset:0
    buffer_load_dwordx4 v22, s[12:15], s54 offen lds
    v_mfma_f32_16x16x32_bf16 v[118:121], a[140:143], v[88:91], v[118:121]
    ds_read_b64_tr_b16 a[154:155], v31 offset:512
    v_mfma_f32_16x16x32_bf16 v[100:103], a[132:135], v[32:35], v[100:103]
    v_mfma_f32_16x16x32_bf16 v[104:107], a[136:139], v[32:35], v[104:107]
    v_mfma_f32_16x16x32_bf16 v[108:111], a[140:143], v[32:35], v[108:111]
    s_waitcnt lgkmcnt(0)
    v_mfma_f32_16x16x32_bf16 v[44:47], a[144:147], v[68:71], v[44:47]
    ds_read_b128 v[80:83], v5 offset:24576
    s_add_u32 m0, s42, 9216
    v_mfma_f32_16x16x32_bf16 v[48:51], a[144:147], v[72:75], v[48:51]
    ds_read_b128 v[84:87], v5 offset:26624
    buffer_load_dwordx4 v23, s[12:15], s54 offen lds
    v_mfma_f32_16x16x32_bf16 v[92:95], a[144:147], v[76:79], v[92:95]
    ds_read_b128 v[88:91], v5 offset:45056
    s_add_u32 m0, s42, 16384
    v_mfma_f32_16x16x32_bf16 v[52:55], a[148:151], v[68:71], v[52:55]
    ds_read_b64_tr_b16 a[156:157], v29 offset:4096
    buffer_load_dwordx4 v24, s[12:15], s54 offen lds
    v_mfma_f32_16x16x32_bf16 v[56:59], a[148:151], v[72:75], v[56:59]
    ds_read_b64_tr_b16 a[158:159], v29 offset:4608
    s_add_u32 m0, s42, 17408
    v_mfma_f32_16x16x32_bf16 v[96:99], a[148:151], v[76:79], v[96:99]
    ds_read_b64_tr_b16 a[160:161], v30 offset:4096
    buffer_load_dwordx4 v25, s[12:15], s54 offen lds
    v_mfma_f32_16x16x32_bf16 v[60:63], a[152:155], v[68:71], v[60:63]
    ds_read_b64_tr_b16 a[162:163], v30 offset:4608
    s_add_u32 s54, s54, 393216
    v_mfma_f32_16x16x32_bf16 v[64:67], a[152:155], v[72:75], v[64:67]
    ds_read_b64_tr_b16 a[164:165], v31 offset:4096
    v_mfma_f32_16x16x32_bf16 v[118:121], a[152:155], v[76:79], v[118:121]
    ds_read_b64_tr_b16 a[166:167], v31 offset:4608
    v_mfma_f32_16x16x32_bf16 v[100:103], a[144:147], v[32:35], v[100:103]
    v_mfma_f32_16x16x32_bf16 v[104:107], a[148:151], v[32:35], v[104:107]
    v_mfma_f32_16x16x32_bf16 v[108:111], a[152:155], v[32:35], v[108:111]
    s_mov_b32 s56, 0xaaaaaaaa
    s_mov_b32 s57, 0xaaaaaaaa
    s_mov_b32 s58, 0xfff0ffff
    s_mov_b32 s59, 0xf000ff00
    s_mov_b32 s60, 0xffc0fffc
    s_mov_b32 s61, 0xc000fc00
    s_mov_b32 s86, 0x3e8293ee
    v_mov_b32 v38, 0x0c0c0c0c
    v_mov_b32 v36, 0xc0c0100
    v_mov_b32 v37, 0x1000c0c
    v_cndmask_b32 v36, v36, v37, s[56:57]
    v_add_u32 v29, 49152, v26
    v_add_u32 v30, 49152, v27
    v_add_u32 v31, 49152, v28
    s_waitcnt vmcnt(15) lgkmcnt(0)
    s_barrier
    v_mfma_f32_16x16x32_bf16 v[44:47], a[156:159], v[80:83], v[44:47]
    ds_read_b128 v[68:71], v4 offset:28672
    s_add_u32 m0, s43, 150272
    v_mfma_f32_16x16x32_bf16 v[48:51], a[156:159], v[84:87], v[48:51]
    ds_read_b128 v[72:75], v4 offset:30720
    buffer_load_dwordx4 v6, s[8:11], s53 offen offset:1280 sc1 lds
    v_mfma_f32_16x16x32_bf16 v[92:95], a[156:159], v[88:91], v[92:95]
    ds_read_b128 v[76:79], v4 offset:47104
    s_add_u32 m0, s43, 105216
    v_mfma_f32_16x16x32_bf16 v[52:55], a[160:163], v[80:83], v[52:55]
    ds_read_b64_tr_b16 a[168:169], v29 offset:0
    buffer_load_dwordx4 v6, s[8:11], s41 offen offset:1280 sc1 lds
    v_mfma_f32_16x16x32_bf16 v[56:59], a[160:163], v[84:87], v[56:59]
    ds_read_b64_tr_b16 a[170:171], v29 offset:512
    s_add_u32 m0, s42, 24576
    v_mfma_f32_16x16x32_bf16 v[96:99], a[160:163], v[88:91], v[96:99]
    ds_read_b64_tr_b16 a[172:173], v30 offset:0
    buffer_load_dwordx4 v20, s[12:15], s54 offen lds
    v_mfma_f32_16x16x32_bf16 v[60:63], a[164:167], v[80:83], v[60:63]
    ds_read_b64_tr_b16 a[174:175], v30 offset:512
    s_add_u32 m0, s42, 25600
    v_mfma_f32_16x16x32_bf16 v[64:67], a[164:167], v[84:87], v[64:67]
    ds_read_b64_tr_b16 a[176:177], v31 offset:0
    buffer_load_dwordx4 v21, s[12:15], s54 offen lds
    v_mfma_f32_16x16x32_bf16 v[118:121], a[164:167], v[88:91], v[118:121]
    ds_read_b64_tr_b16 a[178:179], v31 offset:512
    v_mfma_f32_16x16x32_bf16 v[100:103], a[156:159], v[32:35], v[100:103]
    v_mfma_f32_16x16x32_bf16 v[104:107], a[160:163], v[32:35], v[104:107]
    v_mfma_f32_16x16x32_bf16 v[108:111], a[164:167], v[32:35], v[108:111]
    s_waitcnt lgkmcnt(0)
    v_mfma_f32_16x16x32_bf16 v[44:47], a[168:171], v[68:71], v[44:47]
    ds_read_b128 v[80:83], v5 offset:28672
    s_add_u32 m0, s42, 32768
    v_mfma_f32_16x16x32_bf16 v[48:51], a[168:171], v[72:75], v[48:51]
    ds_read_b128 v[84:87], v5 offset:30720
    buffer_load_dwordx4 v22, s[12:15], s54 offen lds
    v_mfma_f32_16x16x32_bf16 v[92:95], a[168:171], v[76:79], v[92:95]
    ds_read_b128 v[88:91], v5 offset:47104
    s_add_u32 m0, s42, 33792
    v_mfma_f32_16x16x32_bf16 v[52:55], a[172:175], v[68:71], v[52:55]
    ds_read_b64_tr_b16 a[180:181], v29 offset:4096
    buffer_load_dwordx4 v23, s[12:15], s54 offen lds
    v_mfma_f32_16x16x32_bf16 v[56:59], a[172:175], v[72:75], v[56:59]
    ds_read_b64_tr_b16 a[182:183], v29 offset:4608
    s_add_u32 m0, s42, 40960
    v_mfma_f32_16x16x32_bf16 v[96:99], a[172:175], v[76:79], v[96:99]
    ds_read_b64_tr_b16 a[184:185], v30 offset:4096
    buffer_load_dwordx4 v24, s[12:15], s54 offen lds
    v_mfma_f32_16x16x32_bf16 v[60:63], a[176:179], v[68:71], v[60:63]
    ds_read_b64_tr_b16 a[186:187], v30 offset:4608
    s_add_u32 m0, s42, 41984
    v_mfma_f32_16x16x32_bf16 v[64:67], a[176:179], v[72:75], v[64:67]
    ds_read_b64_tr_b16 a[188:189], v31 offset:4096
    buffer_load_dwordx4 v25, s[12:15], s54 offen lds
    v_mfma_f32_16x16x32_bf16 v[118:121], a[176:179], v[76:79], v[118:121]
    ds_read_b64_tr_b16 a[190:191], v31 offset:4608
    s_add_u32 s54, s54, 393216
    v_mfma_f32_16x16x32_bf16 v[100:103], a[168:171], v[32:35], v[100:103]
    v_mfma_f32_16x16x32_bf16 v[104:107], a[172:175], v[32:35], v[104:107]
    v_mfma_f32_16x16x32_bf16 v[108:111], a[176:179], v[32:35], v[108:111]
    v_cndmask_b32 v14, v36, v38, s[58:59]
    v_cndmask_b32 v16, v38, v36, s[58:59]
    v_mov_b32 v36, 0xc0c0302
    v_mov_b32 v37, 0x3020c0c
    v_cndmask_b32 v36, v36, v37, s[56:57]
    v_cndmask_b32 v15, v36, v38, s[60:61]
    v_cndmask_b32 v17, v38, v36, s[60:61]
    v_mov_b32 v18, 0xff800000
    s_mul_i32 s90, s33, 2097152
    s_add_u32 s90, s90, 0xffff0000
    s_lshl_b32 s37, s35, 1
    v_add_u32 v29, 73728, v26
    v_add_u32 v30, 73728, v27
    v_add_u32 v31, 73728, v28
    s_waitcnt vmcnt(15) lgkmcnt(0)
    s_barrier
    v_mfma_f32_16x16x32_bf16 v[44:47], a[180:183], v[80:83], v[44:47]
    ds_read_b128 v[68:71], v4 offset:0
    s_add_u32 m0, s43, 109184
    v_mfma_f32_16x16x32_bf16 v[48:51], a[180:183], v[84:87], v[48:51]
    ds_read_b128 v[72:75], v4 offset:2048
    buffer_load_dwordx4 v6, s[8:11], s41 offen offset:1408 sc1 lds
    v_mfma_f32_16x16x32_bf16 v[92:95], a[180:183], v[88:91], v[92:95]
    ds_read_b128 v[76:79], v4 offset:49152
    s_add_u32 m0, s42, 49152
    v_mfma_f32_16x16x32_bf16 v[52:55], a[184:187], v[80:83], v[52:55]
    ds_read_b64_tr_b16 a[192:193], v29 offset:0
    buffer_load_dwordx4 v20, s[12:15], s54 offen lds
    v_mfma_f32_16x16x32_bf16 v[56:59], a[184:187], v[84:87], v[56:59]
    ds_read_b64_tr_b16 a[194:195], v29 offset:512
    s_add_u32 m0, s42, 50176
    v_mfma_f32_16x16x32_bf16 v[96:99], a[184:187], v[88:91], v[96:99]
    ds_read_b64_tr_b16 a[196:197], v30 offset:0
    buffer_load_dwordx4 v21, s[12:15], s54 offen lds
    v_mfma_f32_16x16x32_bf16 v[60:63], a[188:191], v[80:83], v[60:63]
    ds_read_b64_tr_b16 a[198:199], v30 offset:512
    s_add_u32 m0, s42, 57344
    v_mfma_f32_16x16x32_bf16 v[64:67], a[188:191], v[84:87], v[64:67]
    ds_read_b64_tr_b16 a[200:201], v31 offset:0
    buffer_load_dwordx4 v22, s[12:15], s54 offen lds
    v_mfma_f32_16x16x32_bf16 v[118:121], a[188:191], v[88:91], v[118:121]
    ds_read_b64_tr_b16 a[202:203], v31 offset:512
    v_mfma_f32_16x16x32_bf16 v[100:103], a[180:183], v[32:35], v[100:103]
    v_mfma_f32_16x16x32_bf16 v[104:107], a[184:187], v[32:35], v[104:107]
    v_mfma_f32_16x16x32_bf16 v[108:111], a[188:191], v[32:35], v[108:111]
    s_waitcnt lgkmcnt(0)
    v_mfma_f32_16x16x32_bf16 v[44:47], a[192:195], v[68:71], v[44:47]
    ds_read_b128 v[80:83], v5 offset:0
    s_add_u32 m0, s42, 58368
    v_mfma_f32_16x16x32_bf16 v[48:51], a[192:195], v[72:75], v[48:51]
    ds_read_b128 v[84:87], v5 offset:2048
    buffer_load_dwordx4 v23, s[12:15], s54 offen lds
    v_mfma_f32_16x16x32_bf16 v[92:95], a[192:195], v[76:79], v[92:95]
    ds_read_b128 v[88:91], v5 offset:49152
    s_add_u32 m0, s42, 65536
    v_mfma_f32_16x16x32_bf16 v[52:55], a[196:199], v[68:71], v[52:55]
    ds_read_b64_tr_b16 a[204:205], v29 offset:4096
    buffer_load_dwordx4 v24, s[12:15], s54 offen lds
    v_mfma_f32_16x16x32_bf16 v[56:59], a[196:199], v[72:75], v[56:59]
    ds_read_b64_tr_b16 a[206:207], v29 offset:4608
    s_add_u32 m0, s42, 66560
    v_mfma_f32_16x16x32_bf16 v[96:99], a[196:199], v[76:79], v[96:99]
    ds_read_b64_tr_b16 a[208:209], v30 offset:4096
    buffer_load_dwordx4 v25, s[12:15], s54 offen lds
    v_mfma_f32_16x16x32_bf16 v[60:63], a[200:203], v[68:71], v[60:63]
    ds_read_b64_tr_b16 a[210:211], v30 offset:4608
    s_add_u32 s54, s54, 393216
    v_mfma_f32_16x16x32_bf16 v[64:67], a[200:203], v[72:75], v[64:67]
    ds_read_b64_tr_b16 a[212:213], v31 offset:4096
    v_mfma_f32_16x16x32_bf16 v[118:121], a[200:203], v[76:79], v[118:121]
    ds_read_b64_tr_b16 a[214:215], v31 offset:4608
    v_mfma_f32_16x16x32_bf16 v[100:103], a[192:195], v[32:35], v[100:103]
    v_mfma_f32_16x16x32_bf16 v[104:107], a[196:199], v[32:35], v[104:107]
    v_mfma_f32_16x16x32_bf16 v[108:111], a[200:203], v[32:35], v[108:111]
    s_add_u32 s37, s37, s51
    s_lshl_b32 s37, s37, 11
    s_add_u32 s90, s90, s37
    s_mul_i32 s37, s38, 1024
    s_add_u32 s90, s90, s37
    s_mov_b32 s87, -1024
    s_mov_b32 s24, 0xfffeffff
    s_mov_b32 s25, -1
    s_lshl_b32 s26, s38, 15
    s_mov_b32 s27, s38
    s_add_u32 s87, s87, 1024
    s_cmp_eq_u32 s33, 0
    s_cselect_b64 s[26:27], s[26:27], 0
    s_add_u32 s20, s82, 0x80
    s_addc_u32 s21, s83, 0
    s_mov_b32 s22, 0x4
    s_mov_b32 s23, 0x00020000
    v_lshl_add_u32 v36, s32, 4, v124
    v_add_u32 v29, 0, v26
    v_add_u32 v30, 0, v27
    v_add_u32 v31, 0, v28
    s_waitcnt vmcnt(15) lgkmcnt(0)
    s_barrier
    v_mfma_f32_16x16x32_bf16 v[44:47], a[204:207], v[80:83], v[44:47]
    ds_read_b128 v[68:71], v4 offset:4096
    s_add_u32 m0, s43, 154112
    v_mfma_f32_16x16x32_bf16 v[48:51], a[204:207], v[84:87], v[48:51]
    ds_read_b128 v[72:75], v4 offset:6144
    buffer_load_dwordx4 v6, s[8:11], s53 offen offset:1536 sc1 lds
    v_mfma_f32_16x16x32_bf16 v[92:95], a[204:207], v[88:91], v[92:95]
    ds_read_b128 v[76:79], v4 offset:51200
    s_add_u32 m0, s43, 113152
    v_mfma_f32_16x16x32_bf16 v[52:55], a[208:211], v[80:83], v[52:55]
    ds_read_b64_tr_b16 a[216:217], v29 offset:0
    buffer_load_dwordx4 v6, s[8:11], s41 offen offset:1536 sc1 lds
    v_mfma_f32_16x16x32_bf16 v[56:59], a[208:211], v[84:87], v[56:59]
    ds_read_b64_tr_b16 a[218:219], v29 offset:512
    s_add_u32 m0, s42, 73728
    v_mfma_f32_16x16x32_bf16 v[96:99], a[208:211], v[88:91], v[96:99]
    ds_read_b64_tr_b16 a[220:221], v30 offset:0
    buffer_load_dwordx4 v20, s[12:15], s54 offen lds
    v_mfma_f32_16x16x32_bf16 v[60:63], a[212:215], v[80:83], v[60:63]
    ds_read_b64_tr_b16 a[222:223], v30 offset:512
    s_add_u32 m0, s42, 74752
    v_mfma_f32_16x16x32_bf16 v[64:67], a[212:215], v[84:87], v[64:67]
    ds_read_b64_tr_b16 a[224:225], v31 offset:0
    buffer_load_dwordx4 v21, s[12:15], s54 offen lds
    v_mfma_f32_16x16x32_bf16 v[118:121], a[212:215], v[88:91], v[118:121]
    ds_read_b64_tr_b16 a[226:227], v31 offset:512
    v_mfma_f32_16x16x32_bf16 v[100:103], a[204:207], v[32:35], v[100:103]
    v_mfma_f32_16x16x32_bf16 v[104:107], a[208:211], v[32:35], v[104:107]
    v_mfma_f32_16x16x32_bf16 v[108:111], a[212:215], v[32:35], v[108:111]
    s_waitcnt lgkmcnt(0)
    v_mfma_f32_16x16x32_bf16 v[44:47], a[216:219], v[68:71], v[44:47]
    ds_read_b128 v[80:83], v5 offset:4096
    s_add_u32 m0, s42, 81920
    v_mfma_f32_16x16x32_bf16 v[48:51], a[216:219], v[72:75], v[48:51]
    ds_read_b128 v[84:87], v5 offset:6144
    buffer_load_dwordx4 v22, s[12:15], s54 offen lds
    v_mfma_f32_16x16x32_bf16 v[92:95], a[216:219], v[76:79], v[92:95]
    ds_read_b128 v[88:91], v5 offset:51200
    s_add_u32 m0, s42, 82944
    v_mfma_f32_16x16x32_bf16 v[52:55], a[220:223], v[68:71], v[52:55]
    ds_read_b64_tr_b16 a[228:229], v29 offset:4096
    buffer_load_dwordx4 v23, s[12:15], s54 offen lds
    v_mfma_f32_16x16x32_bf16 v[56:59], a[220:223], v[72:75], v[56:59]
    ds_read_b64_tr_b16 a[230:231], v29 offset:4608
    s_add_u32 m0, s42, 90112
    v_mfma_f32_16x16x32_bf16 v[96:99], a[220:223], v[76:79], v[96:99]
    ds_read_b64_tr_b16 a[232:233], v30 offset:4096
    buffer_load_dwordx4 v24, s[12:15], s54 offen lds
    v_mfma_f32_16x16x32_bf16 v[60:63], a[224:227], v[68:71], v[60:63]
    ds_read_b64_tr_b16 a[234:235], v30 offset:4608
    s_add_u32 m0, s42, 91136
    v_mfma_f32_16x16x32_bf16 v[64:67], a[224:227], v[72:75], v[64:67]
    ds_read_b64_tr_b16 a[236:237], v31 offset:4096
    buffer_load_dwordx4 v25, s[12:15], s54 offen lds
    v_mfma_f32_16x16x32_bf16 v[118:121], a[224:227], v[76:79], v[118:121]
    ds_read_b64_tr_b16 a[238:239], v31 offset:4608
    s_add_u32 s54, s54, 393216
    v_mfma_f32_16x16x32_bf16 v[100:103], a[216:219], v[32:35], v[100:103]
    v_mfma_f32_16x16x32_bf16 v[104:107], a[220:223], v[32:35], v[104:107]
    v_mfma_f32_16x16x32_bf16 v[108:111], a[224:227], v[32:35], v[108:111]
    v_add_u32 v29, 24576, v26
    v_add_u32 v30, 24576, v27
    v_add_u32 v31, 24576, v28
    s_waitcnt vmcnt(15) lgkmcnt(0)
    s_barrier
    v_mfma_f32_16x16x32_bf16 v[44:47], a[228:231], v[80:83], v[44:47]
    ds_read_b128 v[68:71], v4 offset:8192
    s_add_u32 m0, s43, 117120
    v_mfma_f32_16x16x32_bf16 v[48:51], a[228:231], v[84:87], v[48:51]
    ds_read_b128 v[72:75], v4 offset:10240
    buffer_load_dwordx4 v6, s[8:11], s41 offen offset:1664 sc1 lds
    v_mfma_f32_16x16x32_bf16 v[92:95], a[228:231], v[88:91], v[92:95]
    ds_read_b128 v[76:79], v4 offset:53248
    s_add_u32 m0, s42, 0
    v_mfma_f32_16x16x32_bf16 v[52:55], a[232:235], v[80:83], v[52:55]
    ds_read_b64_tr_b16 a[240:241], v29 offset:0
    buffer_load_dwordx4 v20, s[12:15], s54 offen lds
    v_mfma_f32_16x16x32_bf16 v[56:59], a[232:235], v[84:87], v[56:59]
    ds_read_b64_tr_b16 a[242:243], v29 offset:512
    s_add_u32 m0, s42, 1024
    v_mfma_f32_16x16x32_bf16 v[96:99], a[232:235], v[88:91], v[96:99]
    ds_read_b64_tr_b16 a[244:245], v30 offset:0
    buffer_load_dwordx4 v21, s[12:15], s54 offen lds
    v_mfma_f32_16x16x32_bf16 v[60:63], a[236:239], v[80:83], v[60:63]
    ds_read_b64_tr_b16 a[246:247], v30 offset:512
    s_add_u32 m0, s42, 8192
    v_mfma_f32_16x16x32_bf16 v[64:67], a[236:239], v[84:87], v[64:67]
    ds_read_b64_tr_b16 a[248:249], v31 offset:0
    buffer_load_dwordx4 v22, s[12:15], s54 offen lds
    v_mfma_f32_16x16x32_bf16 v[118:121], a[236:239], v[88:91], v[118:121]
    ds_read_b64_tr_b16 a[250:251], v31 offset:512
    v_mfma_f32_16x16x32_bf16 v[100:103], a[228:231], v[32:35], v[100:103]
    v_mfma_f32_16x16x32_bf16 v[104:107], a[232:235], v[32:35], v[104:107]
    v_mfma_f32_16x16x32_bf16 v[108:111], a[236:239], v[32:35], v[108:111]
    s_waitcnt lgkmcnt(0)
    v_mfma_f32_16x16x32_bf16 v[44:47], a[240:243], v[68:71], v[44:47]
    ds_read_b128 v[80:83], v5 offset:8192
    s_add_u32 m0, s42, 9216
    v_mfma_f32_16x16x32_bf16 v[48:51], a[240:243], v[72:75], v[48:51]
    ds_read_b128 v[84:87], v5 offset:10240
    buffer_load_dwordx4 v23, s[12:15], s54 offen lds
    v_mfma_f32_16x16x32_bf16 v[92:95], a[240:243], v[76:79], v[92:95]
    ds_read_b128 v[88:91], v5 offset:53248
    s_add_u32 m0, s42, 16384
    v_mfma_f32_16x16x32_bf16 v[52:55], a[244:247], v[68:71], v[52:55]
    ds_read_b64_tr_b16 a[252:253], v29 offset:4096
    buffer_load_dwordx4 v24, s[12:15], s54 offen lds
    v_mfma_f32_16x16x32_bf16 v[56:59], a[244:247], v[72:75], v[56:59]
    ds_read_b64_tr_b16 a[254:255], v29 offset:4608
    s_add_u32 m0, s42, 17408
    v_mfma_f32_16x16x32_bf16 v[96:99], a[244:247], v[76:79], v[96:99]
    ds_read_b64_tr_b16 v[128:129], v30 offset:4096
    buffer_load_dwordx4 v25, s[12:15], s54 offen lds
    v_mfma_f32_16x16x32_bf16 v[60:63], a[248:251], v[68:71], v[60:63]
    ds_read_b64_tr_b16 v[130:131], v30 offset:4608
    s_add_u32 s54, s54, 393216
    v_mfma_f32_16x16x32_bf16 v[64:67], a[248:251], v[72:75], v[64:67]
    ds_read_b64_tr_b16 v[132:133], v31 offset:4096
    v_mfma_f32_16x16x32_bf16 v[118:121], a[248:251], v[76:79], v[118:121]
    ds_read_b64_tr_b16 v[134:135], v31 offset:4608
    v_mfma_f32_16x16x32_bf16 v[100:103], a[240:243], v[32:35], v[100:103]
    v_mfma_f32_16x16x32_bf16 v[104:107], a[244:247], v[32:35], v[104:107]
    v_mfma_f32_16x16x32_bf16 v[108:111], a[248:251], v[32:35], v[108:111]
    v_add_u32 v29, 49152, v26
    v_add_u32 v30, 49152, v27
    v_add_u32 v31, 49152, v28
    s_waitcnt vmcnt(15) lgkmcnt(0)
    s_barrier
    v_mfma_f32_16x16x32_bf16 v[44:47], a[252:255], v[80:83], v[44:47]
    ds_read_b128 v[68:71], v4 offset:12288
    buffer_load_dword v37, v36, s[20:23], 0 offen sc1
    v_mfma_f32_16x16x32_bf16 v[48:51], a[252:255], v[84:87], v[48:51]
    ds_read_b128 v[72:75], v4 offset:14336
    s_add_u32 m0, s43, 157952
    v_mfma_f32_16x16x32_bf16 v[92:95], a[252:255], v[88:91], v[92:95]
    ds_read_b128 v[76:79], v4 offset:55296
    buffer_load_dwordx4 v6, s[8:11], s53 offen offset:1792 sc1 lds
    v_mfma_f32_16x16x32_bf16 v[52:55], v[128:131], v[80:83], v[52:55]
    ds_read_b64_tr_b16 v[136:137], v29 offset:0
    s_add_u32 m0, s43, 121088
    v_mfma_f32_16x16x32_bf16 v[56:59], v[128:131], v[84:87], v[56:59]
    ds_read_b64_tr_b16 v[138:139], v29 offset:512
    buffer_load_dwordx4 v6, s[8:11], s41 offen offset:1792 sc1 lds
    v_mfma_f32_16x16x32_bf16 v[96:99], v[128:131], v[88:91], v[96:99]
    ds_read_b64_tr_b16 v[140:141], v30 offset:0
    s_add_u32 m0, s42, 24576
    v_mfma_f32_16x16x32_bf16 v[60:63], v[132:135], v[80:83], v[60:63]
    ds_read_b64_tr_b16 v[142:143], v30 offset:512
    buffer_load_dwordx4 v20, s[12:15], s54 offen lds
    v_mfma_f32_16x16x32_bf16 v[64:67], v[132:135], v[84:87], v[64:67]
    ds_read_b64_tr_b16 v[144:145], v31 offset:0
    s_add_u32 m0, s42, 25600
    v_mfma_f32_16x16x32_bf16 v[118:121], v[132:135], v[88:91], v[118:121]
    ds_read_b64_tr_b16 v[146:147], v31 offset:512
    buffer_load_dwordx4 v21, s[12:15], s54 offen lds
    v_mfma_f32_16x16x32_bf16 v[100:103], a[252:255], v[32:35], v[100:103]
    s_add_u32 m0, s42, 32768
    v_mfma_f32_16x16x32_bf16 v[104:107], v[128:131], v[32:35], v[104:107]
    v_mfma_f32_16x16x32_bf16 v[108:111], v[132:135], v[32:35], v[108:111]
    s_waitcnt lgkmcnt(0)
    v_mfma_f32_16x16x32_bf16 v[44:47], v[136:139], v[68:71], v[44:47]
    ds_read_b128 v[80:83], v5 offset:12288
    buffer_load_dwordx4 v22, s[12:15], s54 offen lds
    v_mfma_f32_16x16x32_bf16 v[48:51], v[136:139], v[72:75], v[48:51]
    ds_read_b128 v[84:87], v5 offset:14336
    s_add_u32 m0, s42, 33792
    v_mfma_f32_16x16x32_bf16 v[92:95], v[136:139], v[76:79], v[92:95]
    ds_read_b128 v[88:91], v5 offset:55296
    buffer_load_dwordx4 v23, s[12:15], s54 offen lds
    v_mfma_f32_16x16x32_bf16 v[52:55], v[140:143], v[68:71], v[52:55]
    ds_read_b64_tr_b16 v[148:149], v29 offset:4096
    s_add_u32 m0, s42, 40960
    v_mfma_f32_16x16x32_bf16 v[56:59], v[140:143], v[72:75], v[56:59]
    ds_read_b64_tr_b16 v[150:151], v29 offset:4608
    buffer_load_dwordx4 v24, s[12:15], s54 offen lds
    v_mfma_f32_16x16x32_bf16 v[96:99], v[140:143], v[76:79], v[96:99]
    ds_read_b64_tr_b16 v[152:153], v30 offset:4096
    s_add_u32 m0, s42, 41984
    v_mfma_f32_16x16x32_bf16 v[60:63], v[144:147], v[68:71], v[60:63]
    ds_read_b64_tr_b16 v[154:155], v30 offset:4608
    buffer_load_dwordx4 v25, s[12:15], s54 offen lds
    v_mfma_f32_16x16x32_bf16 v[64:67], v[144:147], v[72:75], v[64:67]
    ds_read_b64_tr_b16 v[156:157], v31 offset:4096
    s_add_u32 s54, s54, 393216
    v_mfma_f32_16x16x32_bf16 v[118:121], v[144:147], v[76:79], v[118:121]
    ds_read_b64_tr_b16 v[158:159], v31 offset:4608
    v_mfma_f32_16x16x32_bf16 v[100:103], v[136:139], v[32:35], v[100:103]
    v_mfma_f32_16x16x32_bf16 v[104:107], v[140:143], v[32:35], v[104:107]
    v_mfma_f32_16x16x32_bf16 v[108:111], v[144:147], v[32:35], v[108:111]
    v_add_u32 v29, 73728, v26
    v_add_u32 v30, 73728, v27
    v_add_u32 v31, 73728, v28
    s_waitcnt vmcnt(16) lgkmcnt(0)
    s_barrier
    v_mfma_f32_16x16x32_bf16 v[44:47], v[148:151], v[80:83], v[44:47]
    ds_read_b128 v[68:71], v4 offset:16384
    s_add_u32 m0, s43, 125056
    v_mfma_f32_16x16x32_bf16 v[48:51], v[148:151], v[84:87], v[48:51]
    ds_read_b128 v[72:75], v4 offset:18432
    buffer_load_dwordx4 v6, s[8:11], s41 offen offset:1920 sc1 lds
    v_mfma_f32_16x16x32_bf16 v[92:95], v[148:151], v[88:91], v[92:95]
    ds_read_b128 v[76:79], v4 offset:57344
    s_add_u32 m0, s42, 49152
    v_mfma_f32_16x16x32_bf16 v[52:55], v[152:155], v[80:83], v[52:55]
    ds_read_b64_tr_b16 v[160:161], v29 offset:0
    buffer_load_dwordx4 v20, s[12:15], s54 offen lds
    v_mfma_f32_16x16x32_bf16 v[56:59], v[152:155], v[84:87], v[56:59]
    ds_read_b64_tr_b16 v[162:163], v29 offset:512
    s_add_u32 m0, s42, 50176
    v_mfma_f32_16x16x32_bf16 v[96:99], v[152:155], v[88:91], v[96:99]
    ds_read_b64_tr_b16 v[164:165], v30 offset:0
    buffer_load_dwordx4 v21, s[12:15], s54 offen lds
    v_mfma_f32_16x16x32_bf16 v[60:63], v[156:159], v[80:83], v[60:63]
    ds_read_b64_tr_b16 v[166:167], v30 offset:512
    s_add_u32 m0, s42, 57344
    v_mfma_f32_16x16x32_bf16 v[64:67], v[156:159], v[84:87], v[64:67]
    ds_read_b64_tr_b16 v[168:169], v31 offset:0
    buffer_load_dwordx4 v22, s[12:15], s54 offen lds
    v_mfma_f32_16x16x32_bf16 v[118:121], v[156:159], v[88:91], v[118:121]
    ds_read_b64_tr_b16 v[170:171], v31 offset:512
    v_mfma_f32_16x16x32_bf16 v[100:103], v[148:151], v[32:35], v[100:103]
    v_mfma_f32_16x16x32_bf16 v[104:107], v[152:155], v[32:35], v[104:107]
    v_mfma_f32_16x16x32_bf16 v[108:111], v[156:159], v[32:35], v[108:111]
    s_waitcnt lgkmcnt(0)
    v_mfma_f32_16x16x32_bf16 v[44:47], v[160:163], v[68:71], v[44:47]
    ds_read_b128 v[80:83], v5 offset:16384
    s_add_u32 m0, s42, 58368
    v_mfma_f32_16x16x32_bf16 v[48:51], v[160:163], v[72:75], v[48:51]
    ds_read_b128 v[84:87], v5 offset:18432
    buffer_load_dwordx4 v23, s[12:15], s54 offen lds
    v_mfma_f32_16x16x32_bf16 v[92:95], v[160:163], v[76:79], v[92:95]
    ds_read_b128 v[88:91], v5 offset:57344
    s_add_u32 m0, s42, 65536
    v_mfma_f32_16x16x32_bf16 v[52:55], v[164:167], v[68:71], v[52:55]
    ds_read_b64_tr_b16 v[172:173], v29 offset:4096
    buffer_load_dwordx4 v24, s[12:15], s54 offen lds
    v_mfma_f32_16x16x32_bf16 v[56:59], v[164:167], v[72:75], v[56:59]
    ds_read_b64_tr_b16 v[174:175], v29 offset:4608
    s_add_u32 m0, s42, 66560
    v_mfma_f32_16x16x32_bf16 v[96:99], v[164:167], v[76:79], v[96:99]
    ds_read_b64_tr_b16 v[176:177], v30 offset:4096
    buffer_load_dwordx4 v25, s[12:15], s54 offen lds
    v_mfma_f32_16x16x32_bf16 v[60:63], v[168:171], v[68:71], v[60:63]
    ds_read_b64_tr_b16 v[178:179], v30 offset:4608
    s_add_u32 s54, s54, 393216
    v_mfma_f32_16x16x32_bf16 v[64:67], v[168:171], v[72:75], v[64:67]
    ds_read_b64_tr_b16 v[180:181], v31 offset:4096
    v_mfma_f32_16x16x32_bf16 v[118:121], v[168:171], v[76:79], v[118:121]
    ds_read_b64_tr_b16 v[182:183], v31 offset:4608
    v_mfma_f32_16x16x32_bf16 v[100:103], v[160:163], v[32:35], v[100:103]
    v_mfma_f32_16x16x32_bf16 v[104:107], v[164:167], v[32:35], v[104:107]
    v_mfma_f32_16x16x32_bf16 v[108:111], v[168:171], v[32:35], v[108:111]
    v_add_u32 v29, 0, v26
    v_add_u32 v30, 0, v27
    v_add_u32 v31, 0, v28
    s_waitcnt vmcnt(15) lgkmcnt(0)
    v_cmp_eq_u32 vcc, v36, v37
    s_cbranch_vccnz L_spin1
L_back2:
    s_barrier
    v_mfma_f32_16x16x32_bf16 v[44:47], v[172:175], v[80:83], v[44:47]
    ds_read_b128 v[68:71], v4 offset:20480
    s_lshl_b32 s53, s33, 15
    v_mfma_f32_16x16x32_bf16 v[48:51], v[172:175], v[84:87], v[48:51]
    ds_read_b128 v[72:75], v4 offset:22528
    s_sub_u32 s53, 0x5418000, s53
    v_mfma_f32_16x16x32_bf16 v[92:95], v[172:175], v[88:91], v[92:95]
    ds_read_b128 v[76:79], v4 offset:59392
    s_add_u32 m0, s52, 94208
    v_mfma_f32_16x16x32_bf16 v[52:55], v[176:179], v[80:83], v[52:55]
    ds_read_b64_tr_b16 v[184:185], v29 offset:0
    buffer_load_dwordx4 v1, s[16:19], s53 offen sc1 lds
    v_mfma_f32_16x16x32_bf16 v[56:59], v[176:179], v[84:87], v[56:59]
    ds_read_b64_tr_b16 v[186:187], v29 offset:512
    s_add_u32 m0, s52, 92160
    v_mfma_f32_16x16x32_bf16 v[96:99], v[176:179], v[88:91], v[96:99]
    ds_read_b64_tr_b16 v[188:189], v30 offset:0
    buffer_load_dwordx4 v1, s[16:19], s46 offen sc1 lds
    v_mfma_f32_16x16x32_bf16 v[60:63], v[180:183], v[80:83], v[60:63]
    ds_read_b64_tr_b16 v[190:191], v30 offset:512
    s_cmp_eq_u32 s36, s97
    s_cselect_b32 s47, 32, -2
    s_cselect_b64 s[8:9], s[88:89], s[8:9]
    s_cselect_b32 s55, 0x543fc00, s55
    v_mfma_f32_16x16x32_bf16 v[64:67], v[180:183], v[84:87], v[64:67]
    ds_read_b64_tr_b16 v[192:193], v31 offset:0
    s_add_u32 s50, s50, s47
    v_mfma_f32_16x16x32_bf16 v[118:121], v[180:183], v[88:91], v[118:121]
    ds_read_b64_tr_b16 v[194:195], v31 offset:512
    v_mfma_f32_16x16x32_bf16 v[100:103], v[172:175], v[32:35], v[100:103]
    v_mfma_f32_16x16x32_bf16 v[104:107], v[176:179], v[32:35], v[104:107]
    v_mfma_f32_16x16x32_bf16 v[108:111], v[180:183], v[32:35], v[108:111]
    s_waitcnt lgkmcnt(0)
    v_mfma_f32_16x16x32_bf16 v[44:47], v[184:187], v[68:71], v[44:47]
    ds_read_b128 v[80:83], v5 offset:20480
    s_max_i32 s47, s50, 0
    v_mfma_f32_16x16x32_bf16 v[48:51], v[184:187], v[72:75], v[48:51]
    ds_read_b128 v[84:87], v5 offset:22528
    s_min_i32 s47, s47, s96
    v_mfma_f32_16x16x32_bf16 v[92:95], v[184:187], v[76:79], v[92:95]
    ds_read_b128 v[88:91], v5 offset:59392
    s_lshl_b32 s41, s47, 15
    v_mfma_f32_16x16x32_bf16 v[52:55], v[188:191], v[68:71], v[52:55]
    ds_read_b64_tr_b16 v[196:197], v29 offset:4096
    s_lshl_b32 s46, s47, 10
    v_mfma_f32_16x16x32_bf16 v[56:59], v[188:191], v[72:75], v[56:59]
    ds_read_b64_tr_b16 v[198:199], v29 offset:4608
    s_sub_u32 s46, s55, s46
    v_mfma_f32_16x16x32_bf16 v[96:99], v[188:191], v[76:79], v[96:99]
    ds_read_b64_tr_b16 v[200:201], v30 offset:4096
    s_add_u32 m0, s52, 90112
    v_mfma_f32_16x16x32_bf16 v[60:63], v[192:195], v[68:71], v[60:63]
    ds_read_b64_tr_b16 v[202:203], v30 offset:4608
    buffer_load_dwordx4 v1, s[16:19], s46 offen sc1 lds
    v_mfma_f32_16x16x32_bf16 v[64:67], v[192:195], v[72:75], v[64:67]
    ds_read_b64_tr_b16 v[204:205], v31 offset:4096
    s_add_u32 s91, s91, 65536
    v_mfma_f32_16x16x32_bf16 v[118:121], v[192:195], v[76:79], v[118:121]
    ds_read_b64_tr_b16 v[206:207], v31 offset:4608
    v_mfma_f32_16x16x32_bf16 v[100:103], v[184:187], v[32:35], v[100:103]
    v_mfma_f32_16x16x32_bf16 v[104:107], v[188:191], v[32:35], v[104:107]
    v_mfma_f32_16x16x32_bf16 v[108:111], v[192:195], v[32:35], v[108:111]
    v_add_u32 v29, 24576, v26
    v_add_u32 v30, 24576, v27
    v_add_u32 v31, 24576, v28
    s_waitcnt vmcnt(10) lgkmcnt(0)
    s_barrier
    v_mfma_f32_16x16x32_bf16 v[44:47], v[196:199], v[80:83], v[44:47]
    ds_read_b128 v[68:71], v4 offset:24576
    s_add_u32 m0, s43, 0
    v_mfma_f32_16x16x32_bf16 v[48:51], v[196:199], v[84:87], v[48:51]
    ds_read_b128 v[72:75], v4 offset:26624
    buffer_load_dwordx4 v6, s[8:11], s41 offen offset:0 sc1 lds
    v_mfma_f32_16x16x32_bf16 v[92:95], v[196:199], v[88:91], v[92:95]
    ds_read_b128 v[76:79], v4 offset:61440
    s_add_u32 m0, s43, 3968
    v_mfma_f32_16x16x32_bf16 v[52:55], v[200:203], v[80:83], v[52:55]
    ds_read_b64_tr_b16 v[208:209], v29 offset:0
    buffer_load_dwordx4 v6, s[8:11], s41 offen offset:128 sc1 lds
    v_mfma_f32_16x16x32_bf16 v[56:59], v[200:203], v[84:87], v[56:59]
    ds_read_b64_tr_b16 v[210:211], v29 offset:512
    s_add_u32 m0, s43, 7936
    v_mfma_f32_16x16x32_bf16 v[96:99], v[200:203], v[88:91], v[96:99]
    ds_read_b64_tr_b16 v[212:213], v30 offset:0
    buffer_load_dwordx4 v6, s[8:11], s41 offen offset:256 sc1 lds
    v_mfma_f32_16x16x32_bf16 v[60:63], v[204:207], v[80:83], v[60:63]
    ds_read_b64_tr_b16 v[214:215], v30 offset:512
    v_mfma_f32_16x16x32_bf16 v[64:67], v[204:207], v[84:87], v[64:67]
    ds_read_b64_tr_b16 v[216:217], v31 offset:0
    v_mfma_f32_16x16x32_bf16 v[118:121], v[204:207], v[88:91], v[118:121]
    ds_read_b64_tr_b16 v[218:219], v31 offset:512
    v_mfma_f32_16x16x32_bf16 v[100:103], v[196:199], v[32:35], v[100:103]
    v_mfma_f32_16x16x32_bf16 v[104:107], v[200:203], v[32:35], v[104:107]
    v_mfma_f32_16x16x32_bf16 v[108:111], v[204:207], v[32:35], v[108:111]
    s_waitcnt lgkmcnt(0)
    v_mfma_f32_16x16x32_bf16 v[44:47], v[208:211], v[68:71], v[44:47]
    ds_read_b128 v[80:83], v5 offset:24576
    s_add_u32 m0, s43, 11904
    v_mfma_f32_16x16x32_bf16 v[48:51], v[208:211], v[72:75], v[48:51]
    ds_read_b128 v[84:87], v5 offset:26624
    buffer_load_dwordx4 v6, s[8:11], s41 offen offset:384 sc1 lds
    v_mfma_f32_16x16x32_bf16 v[92:95], v[208:211], v[76:79], v[92:95]
    ds_read_b128 v[88:91], v5 offset:61440
    s_add_u32 m0, s43, 15872
    v_mfma_f32_16x16x32_bf16 v[52:55], v[212:215], v[68:71], v[52:55]
    ds_read_b64_tr_b16 v[220:221], v29 offset:4096
    buffer_load_dwordx4 v6, s[8:11], s41 offen offset:512 sc1 lds
    v_mfma_f32_16x16x32_bf16 v[56:59], v[212:215], v[72:75], v[56:59]
    ds_read_b64_tr_b16 v[222:223], v29 offset:4608
    s_add_u32 m0, s43, 19840
    v_mfma_f32_16x16x32_bf16 v[96:99], v[212:215], v[76:79], v[96:99]
    ds_read_b64_tr_b16 v[224:225], v30 offset:4096
    buffer_load_dwordx4 v6, s[8:11], s41 offen offset:640 sc1 lds
    v_mfma_f32_16x16x32_bf16 v[60:63], v[216:219], v[68:71], v[60:63]
    ds_read_b64_tr_b16 v[226:227], v30 offset:4608
    v_mfma_f32_16x16x32_bf16 v[64:67], v[216:219], v[72:75], v[64:67]
    ds_read_b64_tr_b16 v[228:229], v31 offset:4096
    v_mfma_f32_16x16x32_bf16 v[118:121], v[216:219], v[76:79], v[118:121]
    ds_read_b64_tr_b16 v[230:231], v31 offset:4608
    v_mfma_f32_16x16x32_bf16 v[100:103], v[208:211], v[32:35], v[100:103]
    v_mfma_f32_16x16x32_bf16 v[104:107], v[212:215], v[32:35], v[104:107]
    v_mfma_f32_16x16x32_bf16 v[108:111], v[216:219], v[32:35], v[108:111]
    v_add_u32 v29, 49152, v26
    v_add_u32 v30, 49152, v27
    v_add_u32 v31, 49152, v28
    s_waitcnt vmcnt(7) lgkmcnt(0)
    s_barrier
    v_mfma_f32_16x16x32_bf16 v[44:47], v[220:223], v[80:83], v[44:47]
    ds_read_b64 v[20:21], v13 offset:4096
    s_add_u32 m0, s43, 23808
    v_mfma_f32_16x16x32_bf16 v[48:51], v[220:223], v[84:87], v[48:51]
    ds_read_b64 v[22:23], v13 offset:4224
    buffer_load_dwordx4 v6, s[8:11], s41 offen offset:768 sc1 lds
    v_mfma_f32_16x16x32_bf16 v[92:95], v[220:223], v[88:91], v[92:95]
    ds_read_b64 v[24:25], v13 offset:4352
    s_add_u32 m0, s43, 27776
    v_mfma_f32_16x16x32_bf16 v[52:55], v[224:227], v[80:83], v[52:55]
    ds_read_b64 v[36:37], v13 offset:4480
    buffer_load_dwordx4 v6, s[8:11], s41 offen offset:896 sc1 lds
    v_mfma_f32_16x16x32_bf16 v[56:59], v[224:227], v[84:87], v[56:59]
    ds_read_b128 v[68:71], v4 offset:28672
    s_add_u32 m0, s43, 31744
    v_mfma_f32_16x16x32_bf16 v[96:99], v[224:227], v[88:91], v[96:99]
    ds_read_b128 v[72:75], v4 offset:30720
    buffer_load_dwordx4 v6, s[8:11], s41 offen offset:1024 sc1 lds
    v_mfma_f32_16x16x32_bf16 v[60:63], v[228:231], v[80:83], v[60:63]
    ds_read_b128 v[76:79], v4 offset:63488
    v_mfma_f32_16x16x32_bf16 v[64:67], v[228:231], v[84:87], v[64:67]
    ds_read_b64_tr_b16 v[232:233], v29 offset:0
    v_mfma_f32_16x16x32_bf16 v[118:121], v[228:231], v[88:91], v[118:121]
    ds_read_b64_tr_b16 v[234:235], v29 offset:512
    v_mfma_f32_16x16x32_bf16 v[100:103], v[220:223], v[32:35], v[100:103]
    ds_read_b64_tr_b16 v[236:237], v30 offset:0
    v_mfma_f32_16x16x32_bf16 v[104:107], v[224:227], v[32:35], v[104:107]
    ds_read_b64_tr_b16 v[238:239], v30 offset:512
    v_mfma_f32_16x16x32_bf16 v[108:111], v[228:231], v[32:35], v[108:111]
    ds_read_b64_tr_b16 v[240:241], v31 offset:0
    ds_read_b64_tr_b16 v[242:243], v31 offset:512
    s_waitcnt lgkmcnt(0)
    v_mfma_f32_16x16x32_bf16 v[44:47], v[232:235], v[68:71], v[44:47]
    ds_read_b64 v[26:27], v13 offset:2048
    s_add_u32 m0, s43, 35712
    v_add_f32 v42, v24, v36
    v_add_f32 v43, v25, v37
    v_mfma_f32_16x16x32_bf16 v[48:51], v[232:235], v[72:75], v[48:51]
    ds_read_b64 v[112:113], v13 offset:2176
    buffer_load_dwordx4 v6, s[8:11], s41 offen offset:1152 sc1 lds
    v_add_f32 v20, v20, v22
    v_add_f32 v21, v21, v23
    v_mfma_f32_16x16x32_bf16 v[92:95], v[232:235], v[76:79], v[92:95]
    ds_read_b64 v[114:115], v13 offset:2304
    s_add_u32 m0, s43, 39680
    v_add_f32 v20, v20, v42
    v_add_f32 v21, v21, v43
    v_mfma_f32_16x16x32_bf16 v[52:55], v[236:239], v[68:71], v[52:55]
    ds_read_b64 v[122:123], v13 offset:2432
    buffer_load_dwordx4 v6, s[8:11], s41 offen offset:1280 sc1 lds
    v_mov_b32 v42, v20
    v_mov_b32 v43, v21
    v_mfma_f32_16x16x32_bf16 v[56:59], v[236:239], v[72:75], v[56:59]
    ds_read_b128 v[80:83], v5 offset:28672
    s_add_u32 m0, s43, 43648
    v_permlane32_swap_b32 v20, v42
    v_permlane32_swap_b32 v21, v43
    v_mfma_f32_16x16x32_bf16 v[96:99], v[236:239], v[76:79], v[96:99]
    ds_read_b128 v[84:87], v5 offset:30720
    buffer_load_dwordx4 v6, s[8:11], s41 offen offset:1408 sc1 lds
    v_add_f32 v20, v20, v42
    v_add_f32 v21, v21, v43
    v_mfma_f32_16x16x32_bf16 v[60:63], v[240:243], v[68:71], v[60:63]
    ds_read_b128 v[88:91], v5 offset:63488
    v_mul_f32 v38, 0xba800000, v20
    v_mul_f32 v21, 0x3a800000, v21
    v_mfma_f32_16x16x32_bf16 v[64:67], v[240:243], v[72:75], v[64:67]
    ds_read_b64_tr_b16 v[244:245], v29 offset:4096
    v_fma_f32 v21, -v38, v38, v21
    v_mov_b32 v39, v38
    v_mfma_f32_16x16x32_bf16 v[118:121], v[240:243], v[76:79], v[118:121]
    ds_read_b64_tr_b16 v[246:247], v29 offset:4608
    v_max_f32 v21, 0, v21
    v_add_f32 v21, 0x3727c5ac, v21
    v_mfma_f32_16x16x32_bf16 v[100:103], v[232:235], v[32:35], v[100:103]
    ds_read_b64_tr_b16 v[248:249], v30 offset:4096
    v_rsq_f32 v40, v21
    v_permlane16_swap_b32 v38, v39
    v_mfma_f32_16x16x32_bf16 v[104:107], v[236:239], v[32:35], v[104:107]
    ds_read_b64_tr_b16 v[250:251], v30 offset:4608
    v_mov_b32 v41, v40
    s_nop 1
    v_permlane16_swap_b32 v40, v41
    v_mfma_f32_16x16x32_bf16 v[108:111], v[240:243], v[32:35], v[108:111]
    ds_read_b64_tr_b16 v[252:253], v31 offset:4096
    ds_read_b64_tr_b16 v[254:255], v31 offset:4608
    s_waitcnt vmcnt(13) lgkmcnt(0)
    s_barrier
    v_mfma_f32_16x16x32_bf16 v[44:47], v[244:247], v[80:83], v[44:47]
    s_add_u32 m0, s43, 47616
    v_add_f32 v28, v114, v122
    v_add_f32 v19, v115, v123
    v_mfma_f32_16x16x32_bf16 v[48:51], v[244:247], v[84:87], v[48:51]
    buffer_load_dwordx4 v6, s[8:11], s41 offen offset:1536 sc1 lds
    v_add_f32 v26, v26, v112
    v_add_f32 v27, v27, v113
    v_mfma_f32_16x16x32_bf16 v[92:95], v[244:247], v[88:91], v[92:95]
    s_add_u32 m0, s43, 51584
    v_add_f32 v26, v26, v28
    v_add_f32 v27, v27, v19
    v_mfma_f32_16x16x32_bf16 v[52:55], v[248:251], v[80:83], v[52:55]
    buffer_load_dwordx4 v6, s[8:11], s41 offen offset:1664 sc1 lds
    v_mov_b32 v28, v26
    v_mov_b32 v19, v27
    v_mfma_f32_16x16x32_bf16 v[56:59], v[248:251], v[84:87], v[56:59]
    s_add_u32 m0, s43, 55552
    v_permlane32_swap_b32 v26, v28
    v_permlane32_swap_b32 v27, v19
    v_mfma_f32_16x16x32_bf16 v[96:99], v[248:251], v[88:91], v[96:99]
    buffer_load_dwordx4 v6, s[8:11], s41 offen offset:1792 sc1 lds
    v_add_f32 v26, v26, v28
    v_add_f32 v27, v27, v19
    v_mfma_f32_16x16x32_bf16 v[60:63], v[252:255], v[80:83], v[60:63]
    s_add_u32 m0, s43, 59520
    v_mul_f32 v112, 0xba800000, v26
    v_mul_f32 v27, 0x3a800000, v27
    v_mfma_f32_16x16x32_bf16 v[64:67], v[252:255], v[84:87], v[64:67]
    buffer_load_dwordx4 v6, s[8:11], s41 offen offset:1920 sc1 lds
    v_fma_f32 v27, -v112, v112, v27
    v_mov_b32 v113, v112
    v_mfma_f32_16x16x32_bf16 v[118:121], v[252:255], v[88:91], v[118:121]
    s_sub_u32 s53, s91, 65536
    v_max_f32 v27, 0, v27
    v_add_f32 v27, 0x3727c5ac, v27
    v_mfma_f32_16x16x32_bf16 v[100:103], v[244:247], v[32:35], v[100:103]
    buffer_store_dword v124, v124, s[16:19], s53 offen sc1
    v_rsq_f32 v114, v27
    v_permlane16_swap_b32 v112, v113
    v_mfma_f32_16x16x32_bf16 v[104:107], v[248:251], v[32:35], v[104:107]
    s_add_u32 s91, s91, 65536
    v_mov_b32 v115, v114
    s_nop 1
    v_permlane16_swap_b32 v114, v115
    v_mfma_f32_16x16x32_bf16 v[108:111], v[252:255], v[32:35], v[108:111]
    s_mov_b32 s36, 0
    s_cmp_eq_u32 s36, s97
    s_cselect_b32 s47, 32, -2
    s_cselect_b64 s[8:9], s[88:89], s[8:9]
    s_cselect_b32 s55, 0x543fc00, s55
    s_add_u32 s50, s50, s47
    s_max_i32 s47, s50, 0
    s_min_i32 s47, s47, s96
    s_lshl_b32 s41, s47, 15
    s_lshl_b32 s46, s47, 10
    s_sub_u32 s46, s55, s46
    s_cmp_eq_u32 s36, 17
    s_cselect_b32 s49, s87, 0x10000
    s_add_u32 s90, s90, s49
    s_and_b32 s49, s90, 0xffffffff
    s_bitcmp1_b64 s[24:25], s36
    s_cselect_b32 s44, s49, 0x5e00000
    s_bitcmp1_b64 s[26:27], s36
    s_cselect_b64 s[62:63], 0, -1
    v_fmac_f32 v92, v38, v100
    v_fmac_f32 v93, v38, v101
    v_fmac_f32 v94, v38, v102
    v_fmac_f32 v95, v38, v103
    v_mul_f32 v92, v92, v40
    v_mul_f32 v93, v93, v40
    v_mul_f32 v94, v94, v40
    v_mul_f32 v95, v95, v40
    v_cvt_pk_bf16_f32 v92, v92, v93
    v_cvt_pk_bf16_f32 v93, v94, v95
    ds_write_b64 v7, v[92:93] offset:6144
    v_fmac_f32 v96, v38, v104
    v_fmac_f32 v97, v38, v105
    v_fmac_f32 v98, v38, v106
    v_fmac_f32 v99, v38, v107
    v_mul_f32 v96, v96, v40
    v_mul_f32 v97, v97, v40
    v_mul_f32 v98, v98, v40
    v_mul_f32 v99, v99, v40
    v_cvt_pk_bf16_f32 v96, v96, v97
    v_cvt_pk_bf16_f32 v97, v98, v99
    ds_write_b64 v7, v[96:97] offset:7168
    v_fmac_f32 v118, v38, v108
    v_fmac_f32 v119, v38, v109
    v_fmac_f32 v120, v38, v110
    v_fmac_f32 v121, v38, v111
    v_mul_f32 v118, v118, v40
    v_mul_f32 v119, v119, v40
    v_mul_f32 v120, v120, v40
    v_mul_f32 v121, v121, v40
    v_cvt_pk_bf16_f32 v118, v118, v119
    v_cvt_pk_bf16_f32 v119, v120, v121
    ds_write_b64 v8, v[118:119] offset:8192
    v_fmac_f32 v44, v112, v100
    v_fmac_f32 v45, v112, v101
    v_fmac_f32 v46, v112, v102
    v_fmac_f32 v47, v112, v103
    v_fmac_f32 v48, v113, v100
    v_fmac_f32 v49, v113, v101
    v_fmac_f32 v50, v113, v102
    v_fmac_f32 v51, v113, v103
    v_fmac_f32 v52, v112, v104
    v_fmac_f32 v53, v112, v105
    v_fmac_f32 v54, v112, v106
    v_fmac_f32 v55, v112, v107
    v_fmac_f32 v56, v113, v104
    v_fmac_f32 v57, v113, v105
    v_fmac_f32 v58, v113, v106
    v_fmac_f32 v59, v113, v107
    v_fmac_f32 v60, v112, v108
    v_fmac_f32 v61, v112, v109
    v_fmac_f32 v62, v112, v110
    v_fmac_f32 v63, v112, v111
    v_fmac_f32 v64, v113, v108
    v_fmac_f32 v65, v113, v109
    v_fmac_f32 v66, v113, v110
    v_fmac_f32 v67, v113, v111
    s_waitcnt vmcnt(5) lgkmcnt(0)
    s_barrier
    ds_read_b128 v[68:71], v2 offset:0
    ds_read_b128 v[72:75], v2 offset:2048
    ds_read_b128 v[76:79], v3 offset:0
    ds_read_b128 v[80:83], v3 offset:2048
    s_mov_b32 s36, 1
    s_waitcnt lgkmcnt(0)
    s_nop 7
L_q_b0:
    v_mfma_f32_16x16x32_bf16 v[20:23], a[0:3], v[68:71], 0
    ds_read_b128 v[84:87], v2 offset:4096
    v_mul_f32 v44, v44, v114
    v_mfma_f32_16x16x32_bf16 v[24:27], a[0:3], v[72:75], 0
    v_mul_f32 v45, v45, v114
    v_mul_f32 v46, v46, v114
    v_mfma_f32_16x16x32_bf16 v[32:35], a[4:7], v[72:75], 0
    v_mul_f32 v47, v47, v114
    v_cvt_pk_bf16_f32 v44, v44, v45
    v_mfma_f32_16x16x32_bf16 v[28:31], a[4:7], v[68:71], 0
    ds_read_b128 v[88:91], v2 offset:6144
    v_cvt_pk_bf16_f32 v45, v46, v47
    v_mfma_f32_16x16x32_bf16 v[36:39], a[8:11], v[68:71], 0
    ds_write_b64 v7, v[44:45] offset:12288
    v_mfma_f32_16x16x32_bf16 v[40:43], a[8:11], v[72:75], 0
    s_waitcnt lgkmcnt(3)
    v_mul_f32 v48, v48, v115
    v_mul_f32 v49, v49, v115
    v_mfma_f32_16x16x32_bf16 v[20:23], a[12:15], v[76:79], v[20:23]
    ds_read_b128 v[92:95], v3 offset:4096
    v_mul_f32 v50, v50, v115
    v_mfma_f32_16x16x32_bf16 v[24:27], a[12:15], v[80:83], v[24:27]
    v_mul_f32 v51, v51, v115
    v_cvt_pk_bf16_f32 v48, v48, v49
    v_mfma_f32_16x16x32_bf16 v[32:35], a[16:19], v[80:83], v[32:35]
    v_cvt_pk_bf16_f32 v49, v50, v51
    v_mfma_f32_16x16x32_bf16 v[28:31], a[16:19], v[76:79], v[28:31]
    ds_read_b128 v[96:99], v3 offset:6144
    v_mfma_f32_16x16x32_bf16 v[36:39], a[20:23], v[76:79], v[36:39]
    ds_write_b64 v7, v[48:49] offset:18432
    v_mfma_f32_16x16x32_bf16 v[40:43], a[20:23], v[80:83], v[40:43]
    s_waitcnt lgkmcnt(4)
    v_mul_f32 v52, v52, v114
    v_mul_f32 v53, v53, v114
    v_mfma_f32_16x16x32_bf16 v[20:23], a[24:27], v[84:87], v[20:23]
    ds_read_b128 v[68:71], v2 offset:8192
    v_mul_f32 v54, v54, v114
    v_mfma_f32_16x16x32_bf16 v[24:27], a[24:27], v[88:91], v[24:27]
    v_mul_f32 v55, v55, v114
    v_cvt_pk_bf16_f32 v52, v52, v53
    v_mfma_f32_16x16x32_bf16 v[32:35], a[28:31], v[88:91], v[32:35]
    v_cvt_pk_bf16_f32 v53, v54, v55
    v_mfma_f32_16x16x32_bf16 v[28:31], a[28:31], v[84:87], v[28:31]
    ds_read_b128 v[72:75], v2 offset:10240
    v_mfma_f32_16x16x32_bf16 v[36:39], a[32:35], v[84:87], v[36:39]
    ds_write_b64 v7, v[52:53] offset:13312
    v_mfma_f32_16x16x32_bf16 v[40:43], a[32:35], v[88:91], v[40:43]
    s_waitcnt lgkmcnt(4)
    v_mul_f32 v56, v56, v115
    v_mul_f32 v57, v57, v115
    v_mfma_f32_16x16x32_bf16 v[20:23], a[36:39], v[92:95], v[20:23]
    ds_read_b128 v[76:79], v3 offset:8192
    v_mul_f32 v58, v58, v115
    v_mfma_f32_16x16x32_bf16 v[24:27], a[36:39], v[96:99], v[24:27]
    v_mul_f32 v59, v59, v115
    v_cvt_pk_bf16_f32 v56, v56, v57
    v_mfma_f32_16x16x32_bf16 v[32:35], a[40:43], v[96:99], v[32:35]
    v_cvt_pk_bf16_f32 v57, v58, v59
    v_mfma_f32_16x16x32_bf16 v[28:31], a[40:43], v[92:95], v[28:31]
    ds_read_b128 v[80:83], v3 offset:10240
    v_mfma_f32_16x16x32_bf16 v[36:39], a[44:47], v[92:95], v[36:39]
    ds_write_b64 v7, v[56:57] offset:19456
    v_mfma_f32_16x16x32_bf16 v[40:43], a[44:47], v[96:99], v[40:43]
    s_waitcnt lgkmcnt(4)
    v_mul_f32 v60, v60, v114
    v_mul_f32 v61, v61, v114
    v_mfma_f32_16x16x32_bf16 v[20:23], a[48:51], v[68:71], v[20:23]
    s_waitcnt vmcnt(1)
    ds_read_b128 v[84:87], v2 offset:12288
    v_cmp_ne_u32 vcc, 0, v116
    v_mfma_f32_16x16x32_bf16 v[24:27], a[48:51], v[72:75], v[24:27]
    v_mul_f32 v62, v62, v114
    v_mul_f32 v63, v63, v114
    v_mfma_f32_16x16x32_bf16 v[32:35], a[52:55], v[72:75], v[32:35]
    s_cbranch_vccnz L_spin3
L_back4:
    v_cvt_pk_bf16_f32 v60, v60, v61
    v_cvt_pk_bf16_f32 v61, v62, v63
    v_mfma_f32_16x16x32_bf16 v[28:31], a[52:55], v[68:71], v[28:31]
    ds_read_b128 v[88:91], v2 offset:14336
    v_mfma_f32_16x16x32_bf16 v[36:39], a[56:59], v[68:71], v[36:39]
    ds_write_b64 v8, v[60:61] offset:14336
    v_mfma_f32_16x16x32_bf16 v[40:43], a[56:59], v[72:75], v[40:43]
    s_waitcnt lgkmcnt(4)
    v_mul_f32 v64, v64, v115
    v_mul_f32 v65, v65, v115
    v_mfma_f32_16x16x32_bf16 v[20:23], a[60:63], v[76:79], v[20:23]
    ds_read_b128 v[92:95], v3 offset:12288
    v_mul_f32 v66, v66, v115
    v_mfma_f32_16x16x32_bf16 v[24:27], a[60:63], v[80:83], v[24:27]
    v_mul_f32 v67, v67, v115
    v_cvt_pk_bf16_f32 v64, v64, v65
    v_mfma_f32_16x16x32_bf16 v[32:35], a[64:67], v[80:83], v[32:35]
    v_cvt_pk_bf16_f32 v65, v66, v67
    v_mfma_f32_16x16x32_bf16 v[28:31], a[64:67], v[76:79], v[28:31]
    ds_read_b128 v[96:99], v3 offset:14336
    v_mfma_f32_16x16x32_bf16 v[36:39], a[68:71], v[76:79], v[36:39]
    ds_write_b64 v8, v[64:65] offset:20480
    v_mfma_f32_16x16x32_bf16 v[40:43], a[68:71], v[80:83], v[40:43]
    s_waitcnt lgkmcnt(4)
    v_mfma_f32_16x16x32_bf16 v[20:23], a[72:75], v[84:87], v[20:23]
    ds_read_b128 v[68:71], v2 offset:16384
    v_mfma_f32_16x16x32_bf16 v[24:27], a[72:75], v[88:91], v[24:27]
    v_mfma_f32_16x16x32_bf16 v[32:35], a[76:79], v[88:91], v[32:35]
    s_waitcnt lgkmcnt(1)
    s_barrier
    v_mfma_f32_16x16x32_bf16 v[28:31], a[76:79], v[84:87], v[28:31]
    ds_read_b128 v[72:75], v2 offset:18432
    v_mfma_f32_16x16x32_bf16 v[36:39], a[80:83], v[84:87], v[36:39]
    ds_read_b128 v[44:47], v9 offset:6144
    v_mfma_f32_16x16x32_bf16 v[40:43], a[80:83], v[88:91], v[40:43]
    s_waitcnt lgkmcnt(4)
    ds_read_b128 v[48:51], v9 offset:13312
    v_mfma_f32_16x16x32_bf16 v[20:23], a[84:87], v[92:95], v[20:23]
    ds_read_b128 v[76:79], v3 offset:16384
    v_mfma_f32_16x16x32_bf16 v[24:27], a[84:87], v[96:99], v[24:27]
    ds_read_b128 v[52:55], v9 offset:7168
    s_add_u32 m0, s43, 98304
    v_mfma_f32_16x16x32_bf16 v[32:35], a[88:91], v[96:99], v[32:35]
    buffer_load_dwordx4 v6, s[8:11], s41 offen offset:0 sc1 lds
    v_mfma_f32_16x16x32_bf16 v[28:31], a[88:91], v[92:95], v[28:31]
    s_add_u32 m0, s43, 102272
    ds_read_b128 v[80:83], v3 offset:18432
    v_mfma_f32_16x16x32_bf16 v[36:39], a[92:95], v[92:95], v[36:39]
    ds_read_b64_tr_b16 v[56:57], v9 offset:14336
    v_mfma_f32_16x16x32_bf16 v[40:43], a[92:95], v[96:99], v[40:43]
    s_waitcnt lgkmcnt(6)
    ds_read_b64_tr_b16 v[58:59], v9 offset:8192
    s_waitcnt lgkmcnt(3)
    v_mfma_f32_16x16x32_bf16 v[20:23], a[96:99], v[68:71], v[20:23]
    ds_read_b128 v[84:87], v2 offset:20480
    v_mfma_f32_16x16x32_bf16 v[64:67], v[48:51], v[44:47], 0
    ds_read_b64_tr_b16 v[60:61], v9 offset:14344
    v_mfma_f32_16x16x32_bf16 v[118:121], v[52:55], v[44:47], 0
    ds_read_b64_tr_b16 v[62:63], v9 offset:8200
    v_mfma_f32_16x16x32_bf16 v[24:27], a[96:99], v[72:75], v[24:27]
    v_mfma_f32_16x16x32_bf16 v[32:35], a[100:103], v[72:75], v[32:35]
    buffer_load_dwordx4 v6, s[8:11], s41 offen offset:128 sc1 lds
    v_mfma_f32_16x16x32_bf16 v[28:31], a[100:103], v[68:71], v[28:31]
    s_add_u32 m0, s43, 106240
    ds_read_b128 v[88:91], v2 offset:22528
    v_cndmask_b32 v64, v64, v65, s[56:57]
    v_mfma_f32_16x16x32_bf16 v[36:39], a[104:107], v[68:71], v[36:39]
    v_cndmask_b32 v66, v66, v67, s[56:57]
    v_cndmask_b32 v118, v118, v119, s[56:57]
    v_mfma_f32_16x16x32_bf16 v[40:43], a[104:107], v[72:75], v[40:43]
    s_waitcnt lgkmcnt(6)
    v_cndmask_b32 v120, v120, v121, s[56:57]
    v_cndmask_b32 v64, v18, v64, s[62:63]
    v_mfma_f32_16x16x32_bf16 v[20:23], a[108:111], v[76:79], v[20:23]
    ds_read_b128 v[92:95], v3 offset:20480
    v_cndmask_b32 v66, v18, v66, s[62:63]
    v_mfma_f32_16x16x32_bf16 v[24:27], a[108:111], v[80:83], v[24:27]
    v_cndmask_b32 v46, v64, v118, s[58:59]
    v_cndmask_b32 v47, v66, v120, s[60:61]
    v_mfma_f32_16x16x32_bf16 v[32:35], a[112:115], v[80:83], v[32:35]
    buffer_load_dwordx4 v6, s[8:11], s41 offen offset:256 sc1 lds
    v_mfma_f32_16x16x32_bf16 v[28:31], a[112:115], v[76:79], v[28:31]
    s_add_u32 m0, s43, 110208
    ds_read_b128 v[96:99], v3 offset:22528
    v_max_f32 v44, v46, v47
    v_mfma_f32_16x16x32_bf16 v[36:39], a[116:119], v[76:79], v[36:39]
    v_mov_b32 v45, v44
    v_mfma_f32_16x16x32_bf16 v[40:43], a[116:119], v[80:83], v[40:43]
    s_waitcnt lgkmcnt(2)
    v_permlane16_swap_b32 v44, v45
    v_mfma_f32_16x16x32_bf16 v[20:23], a[120:123], v[84:87], v[20:23]
    ds_read_b128 v[68:71], v2 offset:24576
    v_max_f32 v44, v44, v45
    v_mfma_f32_16x16x32_bf16 v[24:27], a[120:123], v[88:91], v[24:27]
    v_mov_b32 v45, v44
    v_mfma_f32_16x16x32_bf16 v[32:35], a[124:127], v[88:91], v[32:35]
    buffer_load_dwordx4 v6, s[8:11], s41 offen offset:384 sc1 lds
    v_mfma_f32_16x16x32_bf16 v[28:31], a[124:127], v[84:87], v[28:31]
    s_add_u32 m0, s43, 114176
    ds_read_b128 v[72:75], v2 offset:26624
    v_mfma_f32_16x16x32_bf16 v[36:39], a[128:131], v[84:87], v[36:39]
    v_permlane32_swap_b32 v44, v45
    v_mfma_f32_16x16x32_bf16 v[40:43], a[128:131], v[88:91], v[40:43]
    s_waitcnt lgkmcnt(2)
    v_max_f32 v44, v44, v45
    v_mul_f32 v44, s86, v44
    v_mfma_f32_16x16x32_bf16 v[20:23], a[132:135], v[92:95], v[20:23]
    ds_read_b128 v[76:79], v3 offset:24576
    v_fma_f32 v46, v46, s86, -v44
    v_mfma_f32_16x16x32_bf16 v[24:27], a[132:135], v[96:99], v[24:27]
    v_fma_f32 v47, v47, s86, -v44
    v_mfma_f32_16x16x32_bf16 v[32:35], a[136:139], v[96:99], v[32:35]
    buffer_load_dwordx4 v6, s[8:11], s41 offen offset:512 sc1 lds
    v_mfma_f32_16x16x32_bf16 v[28:31], a[136:139], v[92:95], v[28:31]
    s_add_u32 m0, s43, 118144
    ds_read_b128 v[80:83], v3 offset:26624
    v_mfma_f32_16x16x32_bf16 v[36:39], a[140:143], v[92:95], v[36:39]
    v_exp_f32 v46, v46
    v_mfma_f32_16x16x32_bf16 v[40:43], a[140:143], v[96:99], v[40:43]
    s_waitcnt lgkmcnt(2)
    v_exp_f32 v47, v47
    v_mfma_f32_16x16x32_bf16 v[20:23], a[144:147], v[68:71], v[20:23]
    ds_read_b128 v[84:87], v2 offset:28672
    v_cvt_pk_bf16_f32 v52, v46, v47
    v_mfma_f32_16x16x32_bf16 v[24:27], a[144:147], v[72:75], v[24:27]
    v_perm_b32 v48, v52, v52, v14
    v_perm_b32 v49, v52, v52, v15
    v_mfma_f32_16x16x32_bf16 v[32:35], a[148:151], v[72:75], v[32:35]
    buffer_load_dwordx4 v6, s[8:11], s41 offen offset:640 sc1 lds
    v_mfma_f32_16x16x32_bf16 v[28:31], a[148:151], v[68:71], v[28:31]
    s_add_u32 m0, s43, 122112
    ds_read_b128 v[88:91], v2 offset:30720
    v_perm_b32 v50, v52, v52, v16
    v_mfma_f32_16x16x32_bf16 v[36:39], a[152:155], v[68:71], v[36:39]
    v_perm_b32 v51, v52, v52, v17
    v_add_f32 v44, v46, v47
    v_mfma_f32_16x16x32_bf16 v[40:43], a[152:155], v[72:75], v[40:43]
    s_waitcnt lgkmcnt(2)
    v_mov_b32 v45, v44
    s_waitcnt lgkmcnt(9)
    v_mfma_f32_16x16x32_bf16 v[20:23], a[156:159], v[76:79], v[20:23]
    ds_read_b128 v[92:95], v3 offset:28672
    v_mfma_f32_16x16x32_bf16 v[64:67], v[56:59], v[48:51], 0
    v_mfma_f32_16x16x32_bf16 v[118:121], v[60:63], v[48:51], 0
    v_permlane16_swap_b32 v44, v45
    v_mfma_f32_16x16x32_bf16 v[24:27], a[156:159], v[80:83], v[24:27]
    v_add_f32 v44, v44, v45
    v_mov_b32 v45, v44
    v_mfma_f32_16x16x32_bf16 v[32:35], a[160:163], v[80:83], v[32:35]
    buffer_load_dwordx4 v6, s[8:11], s41 offen offset:768 sc1 lds
    v_mfma_f32_16x16x32_bf16 v[28:31], a[160:163], v[76:79], v[28:31]
    s_add_u32 m0, s43, 126080
    ds_read_b128 v[96:99], v3 offset:30720
    v_mfma_f32_16x16x32_bf16 v[36:39], a[164:167], v[76:79], v[36:39]
    v_permlane32_swap_b32 v44, v45
    v_mfma_f32_16x16x32_bf16 v[40:43], a[164:167], v[80:83], v[40:43]
    s_waitcnt lgkmcnt(2)
    v_add_f32 v44, v44, v45
    v_mfma_f32_16x16x32_bf16 v[20:23], a[168:171], v[84:87], v[20:23]
    ds_read_b128 v[68:71], v2 offset:32768
    v_mfma_f32_16x16x32_bf16 v[24:27], a[168:171], v[88:91], v[24:27]
    v_rcp_f32 v44, v44
    v_mfma_f32_16x16x32_bf16 v[32:35], a[172:175], v[88:91], v[32:35]
    buffer_load_dwordx4 v6, s[8:11], s41 offen offset:896 sc1 lds
    v_mfma_f32_16x16x32_bf16 v[28:31], a[172:175], v[84:87], v[28:31]
    s_add_u32 m0, s43, 130048
    ds_read_b128 v[72:75], v2 offset:34816
    v_mul_f32 v64, v64, v44
    v_mfma_f32_16x16x32_bf16 v[36:39], a[176:179], v[84:87], v[36:39]
    v_mul_f32 v65, v65, v44
    v_mul_f32 v66, v66, v44
    v_mfma_f32_16x16x32_bf16 v[40:43], a[176:179], v[88:91], v[40:43]
    s_waitcnt lgkmcnt(2)
    v_mul_f32 v67, v67, v44
    v_cvt_pk_bf16_f32 v52, v64, v65
    v_mfma_f32_16x16x32_bf16 v[20:23], a[180:183], v[92:95], v[20:23]
    ds_read_b128 v[76:79], v3 offset:32768
    v_cvt_pk_bf16_f32 v53, v66, v67
    v_mfma_f32_16x16x32_bf16 v[24:27], a[180:183], v[96:99], v[24:27]
    v_mul_f32 v118, v118, v44
    v_mul_f32 v119, v119, v44
    v_mfma_f32_16x16x32_bf16 v[32:35], a[184:187], v[96:99], v[32:35]
    buffer_load_dwordx4 v6, s[8:11], s41 offen offset:1024 sc1 lds
    v_mfma_f32_16x16x32_bf16 v[28:31], a[184:187], v[92:95], v[28:31]
    s_add_u32 m0, s43, 134016
    ds_read_b128 v[80:83], v3 offset:34816
    v_mul_f32 v120, v120, v44
    v_mfma_f32_16x16x32_bf16 v[36:39], a[188:191], v[92:95], v[36:39]
    v_mul_f32 v121, v121, v44
    v_cvt_pk_bf16_f32 v54, v118, v119
    v_mfma_f32_16x16x32_bf16 v[40:43], a[188:191], v[96:99], v[40:43]
    s_waitcnt lgkmcnt(2)
    v_cvt_pk_bf16_f32 v55, v120, v121
    v_mfma_f32_16x16x32_bf16 v[20:23], a[192:195], v[68:71], v[20:23]
    ds_read_b128 v[84:87], v2 offset:36864
    v_mfma_f32_16x16x32_bf16 v[24:27], a[192:195], v[72:75], v[24:27]
    buffer_store_dwordx4 v[52:55], v1, s[16:19], s44 offen sc1
    v_mfma_f32_16x16x32_bf16 v[32:35], a[196:199], v[72:75], v[32:35]
    buffer_load_dwordx4 v6, s[8:11], s41 offen offset:1152 sc1 lds
    v_mfma_f32_16x16x32_bf16 v[28:31], a[196:199], v[68:71], v[28:31]
    s_add_u32 m0, s43, 137984
    ds_read_b128 v[88:91], v2 offset:38912
    s_cmp_eq_u32 s36, 17
    v_mfma_f32_16x16x32_bf16 v[36:39], a[200:203], v[68:71], v[36:39]
    s_cselect_b32 s49, s87, 0x10000
    ds_read_b64 v[56:57], v13 offset:0
    s_add_u32 s90, s90, s49
    v_mfma_f32_16x16x32_bf16 v[40:43], a[200:203], v[72:75], v[40:43]
    s_waitcnt lgkmcnt(3)
    ds_read_b64 v[58:59], v13 offset:128
    s_and_b32 s49, s90, 0xffffffff
    v_mfma_f32_16x16x32_bf16 v[20:23], a[204:207], v[76:79], v[20:23]
    s_bitcmp1_b64 s[24:25], s36
    ds_read_b128 v[92:95], v3 offset:36864
    s_cselect_b32 s44, s49, 0x5e00000
    v_mfma_f32_16x16x32_bf16 v[24:27], a[204:207], v[80:83], v[24:27]
    s_bitcmp1_b64 s[26:27], s36
    ds_read_b64 v[60:61], v13 offset:256
    s_cselect_b64 s[62:63], 0, -1
    v_mfma_f32_16x16x32_bf16 v[32:35], a[208:211], v[80:83], v[32:35]
    buffer_load_dwordx4 v6, s[8:11], s41 offen offset:1280 sc1 lds
    v_mfma_f32_16x16x32_bf16 v[28:31], a[208:211], v[76:79], v[28:31]
    s_add_u32 m0, s43, 141952
    ds_read_b128 v[96:99], v3 offset:38912
    v_mfma_f32_16x16x32_bf16 v[36:39], a[212:215], v[76:79], v[36:39]
    ds_read_b64 v[62:63], v13 offset:384
    v_mfma_f32_16x16x32_bf16 v[40:43], a[212:215], v[80:83], v[40:43]
    s_waitcnt lgkmcnt(6)
    v_mfma_f32_16x16x32_bf16 v[20:23], a[216:219], v[84:87], v[20:23]
    ds_read_b128 v[68:71], v2 offset:40960
    v_mfma_f32_16x16x32_bf16 v[24:27], a[216:219], v[88:91], v[24:27]
    v_mfma_f32_16x16x32_bf16 v[32:35], a[220:223], v[88:91], v[32:35]
    buffer_load_dwordx4 v6, s[8:11], s41 offen offset:1408 sc1 lds
    v_mfma_f32_16x16x32_bf16 v[28:31], a[220:223], v[84:87], v[28:31]
    s_add_u32 m0, s43, 145920
    ds_read_b128 v[72:75], v2 offset:43008
    s_waitcnt lgkmcnt(2)
    v_mfma_f32_16x16x32_bf16 v[36:39], a[224:227], v[84:87], v[36:39]
    v_add_f32 v64, v60, v62
    v_add_f32 v65, v61, v63
    v_mfma_f32_16x16x32_bf16 v[40:43], a[224:227], v[88:91], v[40:43]
    s_waitcnt lgkmcnt(3)
    v_add_f32 v56, v56, v58
    v_add_f32 v57, v57, v59
    v_mfma_f32_16x16x32_bf16 v[20:23], a[228:231], v[92:95], v[20:23]
    ds_read_b128 v[76:79], v3 offset:40960
    v_add_f32 v56, v56, v64
    v_mfma_f32_16x16x32_bf16 v[24:27], a[228:231], v[96:99], v[24:27]
    v_add_f32 v57, v57, v65
    v_mov_b32 v64, v56
    v_mfma_f32_16x16x32_bf16 v[32:35], a[232:235], v[96:99], v[32:35]
    buffer_load_dwordx4 v6, s[8:11], s41 offen offset:1536 sc1 lds
    v_mfma_f32_16x16x32_bf16 v[28:31], a[232:235], v[92:95], v[28:31]
    s_add_u32 m0, s43, 149888
    ds_read_b128 v[80:83], v3 offset:43008
    v_mov_b32 v65, v57
    v_mfma_f32_16x16x32_bf16 v[36:39], a[236:239], v[92:95], v[36:39]
    v_permlane32_swap_b32 v56, v64
    v_mfma_f32_16x16x32_bf16 v[40:43], a[236:239], v[96:99], v[40:43]
    s_waitcnt lgkmcnt(2)
    v_permlane32_swap_b32 v57, v65
    v_mfma_f32_16x16x32_bf16 v[20:23], a[240:243], v[68:71], v[20:23]
    ds_read_b128 v[84:87], v2 offset:45056
    v_add_f32 v56, v56, v64
    v_mfma_f32_16x16x32_bf16 v[24:27], a[240:243], v[72:75], v[24:27]
    v_add_f32 v57, v57, v65
    v_mul_f32 v112, 0xba800000, v56
    v_mfma_f32_16x16x32_bf16 v[32:35], a[244:247], v[72:75], v[32:35]
    buffer_load_dwordx4 v6, s[8:11], s41 offen offset:1664 sc1 lds
    v_mfma_f32_16x16x32_bf16 v[28:31], a[244:247], v[68:71], v[28:31]
    s_add_u32 m0, s43, 153856
    ds_read_b128 v[88:91], v2 offset:47104
    v_mul_f32 v57, 0x3a800000, v57
    v_mfma_f32_16x16x32_bf16 v[36:39], a[248:251], v[68:71], v[36:39]
    v_fma_f32 v57, -v112, v112, v57
    v_mov_b32 v113, v112
    v_mfma_f32_16x16x32_bf16 v[40:43], a[248:251], v[72:75], v[40:43]
    s_waitcnt lgkmcnt(2)
    v_max_f32 v57, 0, v57
    v_add_f32 v57, 0x3727c5ac, v57
    v_mfma_f32_16x16x32_bf16 v[20:23], a[252:255], v[76:79], v[20:23]
    ds_read_b128 v[92:95], v3 offset:45056
    v_mfma_f32_16x16x32_bf16 v[24:27], a[252:255], v[80:83], v[24:27]
    v_rsq_f32 v114, v57
    v_mfma_f32_16x16x32_bf16 v[32:35], v[128:131], v[80:83], v[32:35]
    buffer_load_dwordx4 v6, s[8:11], s41 offen offset:1792 sc1 lds
    v_mfma_f32_16x16x32_bf16 v[28:31], v[128:131], v[76:79], v[28:31]
    s_add_u32 m0, s43, 157824
    ds_read_b128 v[96:99], v3 offset:47104
    v_mfma_f32_16x16x32_bf16 v[36:39], v[132:135], v[76:79], v[36:39]
    v_permlane16_swap_b32 v112, v113
    v_mfma_f32_16x16x32_bf16 v[40:43], v[132:135], v[80:83], v[40:43]
    s_waitcnt lgkmcnt(2)
    v_mov_b32 v115, v114
    v_fmac_f32 v24, v113, v100
    v_mfma_f32_16x16x32_bf16 v[20:23], v[136:139], v[84:87], v[20:23]
    ds_read_b128 v[68:71], v2 offset:49152
    v_fmac_f32 v28, v112, v104
    v_mfma_f32_16x16x32_bf16 v[24:27], v[136:139], v[88:91], v[24:27]
    v_permlane16_swap_b32 v114, v115
    v_mfma_f32_16x16x32_bf16 v[32:35], v[140:143], v[88:91], v[32:35]
    buffer_load_dwordx4 v6, s[8:11], s41 offen offset:1920 sc1 lds
    v_mfma_f32_16x16x32_bf16 v[28:31], v[140:143], v[84:87], v[28:31]
    s_add_u32 m0, s52, 92160
    ds_read_b128 v[72:75], v2 offset:51200
    v_fmac_f32 v20, v112, v100
    v_mfma_f32_16x16x32_bf16 v[36:39], v[144:147], v[84:87], v[36:39]
    v_fmac_f32 v21, v112, v101
    v_fmac_f32 v22, v112, v102
    v_mfma_f32_16x16x32_bf16 v[40:43], v[144:147], v[88:91], v[40:43]
    s_waitcnt lgkmcnt(2)
    v_fmac_f32 v25, v113, v101
    v_fmac_f32 v26, v113, v102
    v_mfma_f32_16x16x32_bf16 v[20:23], v[148:151], v[92:95], v[20:23]
    ds_read_b128 v[76:79], v3 offset:49152
    v_fmac_f32 v29, v112, v105
    v_mfma_f32_16x16x32_bf16 v[24:27], v[148:151], v[96:99], v[24:27]
    v_fmac_f32 v30, v112, v106
    v_fmac_f32 v31, v112, v107
    v_mfma_f32_16x16x32_bf16 v[32:35], v[152:155], v[96:99], v[32:35]
    buffer_load_dwordx4 v1, s[16:19], s46 offen sc1 lds
    v_mfma_f32_16x16x32_bf16 v[28:31], v[152:155], v[92:95], v[28:31]
    s_cmp_eq_u32 s36, s97
    ds_read_b128 v[80:83], v3 offset:51200
    v_med3_i32 v117, s45, 0, v12
    v_mfma_f32_16x16x32_bf16 v[36:39], v[156:159], v[92:95], v[36:39]
    s_cselect_b32 s47, 32, -2
    v_add_u32 v117, v117, v11
    v_fmac_f32 v23, v112, v103
    v_mfma_f32_16x16x32_bf16 v[40:43], v[156:159], v[96:99], v[40:43]
    s_waitcnt lgkmcnt(2)
    v_fmac_f32 v27, v113, v103
    v_fmac_f32 v32, v113, v104
    v_mfma_f32_16x16x32_bf16 v[20:23], v[160:163], v[68:71], v[20:23]
    s_cselect_b64 s[8:9], s[88:89], s[8:9]
    ds_read_b128 v[84:87], v2 offset:53248
    v_fmac_f32 v33, v113, v105
    v_mfma_f32_16x16x32_bf16 v[24:27], v[160:163], v[72:75], v[24:27]
    s_cselect_b32 s55, 0x543fc00, s55
    v_fmac_f32 v36, v112, v108
    v_fmac_f32 v37, v112, v109
    v_mfma_f32_16x16x32_bf16 v[32:35], v[164:167], v[72:75], v[32:35]
    s_add_u32 s45, s45, 65536
    v_fmac_f32 v38, v112, v110
    v_fmac_f32 v39, v112, v111
    v_mfma_f32_16x16x32_bf16 v[28:31], v[164:167], v[68:71], v[28:31]
    s_add_u32 s50, s50, s47
    ds_read_b128 v[88:91], v2 offset:55296
    v_fmac_f32 v40, v113, v108
    v_mfma_f32_16x16x32_bf16 v[36:39], v[168:171], v[68:71], v[36:39]
    buffer_load_dword v116, v117, s[16:19], 0 offen sc1
    v_mfma_f32_16x16x32_bf16 v[40:43], v[168:171], v[72:75], v[40:43]
    s_waitcnt lgkmcnt(2)
    v_fmac_f32 v34, v113, v106
    v_fmac_f32 v35, v113, v107
    v_mfma_f32_16x16x32_bf16 v[20:23], v[172:175], v[76:79], v[20:23]
    s_max_i32 s47, s50, 0
    ds_read_b128 v[92:95], v3 offset:53248
    s_min_i32 s47, s47, s96
    v_mfma_f32_16x16x32_bf16 v[24:27], v[172:175], v[80:83], v[24:27]
    s_lshl_b32 s41, s47, 15
    v_fmac_f32 v41, v113, v109
    v_fmac_f32 v42, v113, v110
    v_mfma_f32_16x16x32_bf16 v[32:35], v[176:179], v[80:83], v[32:35]
    s_lshl_b32 s46, s47, 10
    v_fmac_f32 v43, v113, v111
    s_sub_u32 s46, s55, s46
    v_mfma_f32_16x16x32_bf16 v[28:31], v[176:179], v[76:79], v[28:31]
    ds_read_b128 v[96:99], v3 offset:55296
    v_mfma_f32_16x16x32_bf16 v[36:39], v[180:183], v[76:79], v[36:39]
    v_mfma_f32_16x16x32_bf16 v[40:43], v[180:183], v[80:83], v[40:43]
    s_waitcnt lgkmcnt(2)
    v_mfma_f32_16x16x32_bf16 v[20:23], v[184:187], v[84:87], v[20:23]
    ds_read_b128 v[68:71], v2 offset:57344
    v_mfma_f32_16x16x32_bf16 v[24:27], v[184:187], v[88:91], v[24:27]
    v_mfma_f32_16x16x32_bf16 v[32:35], v[188:191], v[88:91], v[32:35]
    v_mfma_f32_16x16x32_bf16 v[28:31], v[188:191], v[84:87], v[28:31]
    ds_read_b128 v[72:75], v2 offset:59392
    v_mfma_f32_16x16x32_bf16 v[36:39], v[192:195], v[84:87], v[36:39]
    s_waitcnt vmcnt(9)
    s_barrier
    v_mfma_f32_16x16x32_bf16 v[40:43], v[192:195], v[88:91], v[40:43]
    s_waitcnt lgkmcnt(2)
    v_mfma_f32_16x16x32_bf16 v[20:23], v[196:199], v[92:95], v[20:23]
    ds_read_b128 v[76:79], v3 offset:57344
    v_mfma_f32_16x16x32_bf16 v[24:27], v[196:199], v[96:99], v[24:27]
    buffer_store_dword v124, v124, s[16:19], s91 offen sc1
    v_mfma_f32_16x16x32_bf16 v[32:35], v[200:203], v[96:99], v[32:35]
    s_add_u32 s91, s91, 65536
    v_mfma_f32_16x16x32_bf16 v[28:31], v[200:203], v[92:95], v[28:31]
    ds_read_b128 v[80:83], v3 offset:59392
    v_mfma_f32_16x16x32_bf16 v[36:39], v[204:207], v[92:95], v[36:39]
    v_mfma_f32_16x16x32_bf16 v[40:43], v[204:207], v[96:99], v[40:43]
    s_waitcnt lgkmcnt(2)
    v_mfma_f32_16x16x32_bf16 v[20:23], v[208:211], v[68:71], v[20:23]
    ds_read_b128 v[84:87], v2 offset:61440
    v_mfma_f32_16x16x32_bf16 v[24:27], v[208:211], v[72:75], v[24:27]
    v_mfma_f32_16x16x32_bf16 v[32:35], v[212:215], v[72:75], v[32:35]
    v_mfma_f32_16x16x32_bf16 v[28:31], v[212:215], v[68:71], v[28:31]
    ds_read_b128 v[88:91], v2 offset:63488
    v_mfma_f32_16x16x32_bf16 v[36:39], v[216:219], v[68:71], v[36:39]
    v_mfma_f32_16x16x32_bf16 v[40:43], v[216:219], v[72:75], v[40:43]
    s_waitcnt lgkmcnt(2)
    v_mfma_f32_16x16x32_bf16 v[20:23], v[220:223], v[76:79], v[20:23]
    ds_read_b128 v[92:95], v3 offset:61440
    v_mfma_f32_16x16x32_bf16 v[24:27], v[220:223], v[80:83], v[24:27]
    v_mfma_f32_16x16x32_bf16 v[32:35], v[224:227], v[80:83], v[32:35]
    v_mfma_f32_16x16x32_bf16 v[28:31], v[224:227], v[76:79], v[28:31]
    ds_read_b128 v[96:99], v3 offset:63488
    v_mfma_f32_16x16x32_bf16 v[36:39], v[228:231], v[76:79], v[36:39]
    v_mfma_f32_16x16x32_bf16 v[40:43], v[228:231], v[80:83], v[40:43]
    s_waitcnt lgkmcnt(2)
    v_mfma_f32_16x16x32_bf16 v[20:23], v[232:235], v[84:87], v[20:23]
    ds_read_b128 v[68:71], v4 offset:0
    v_mfma_f32_16x16x32_bf16 v[24:27], v[232:235], v[88:91], v[24:27]
    v_mfma_f32_16x16x32_bf16 v[32:35], v[236:239], v[88:91], v[32:35]
    v_mfma_f32_16x16x32_bf16 v[28:31], v[236:239], v[84:87], v[28:31]
    ds_read_b128 v[72:75], v4 offset:2048
    v_mfma_f32_16x16x32_bf16 v[36:39], v[240:243], v[84:87], v[36:39]
    v_mfma_f32_16x16x32_bf16 v[40:43], v[240:243], v[88:91], v[40:43]
    s_waitcnt lgkmcnt(2)
    v_mfma_f32_16x16x32_bf16 v[20:23], v[244:247], v[92:95], v[20:23]
    ds_read_b128 v[76:79], v5 offset:0
    v_mfma_f32_16x16x32_bf16 v[24:27], v[244:247], v[96:99], v[24:27]
    v_mfma_f32_16x16x32_bf16 v[32:35], v[248:251], v[96:99], v[32:35]
    v_mfma_f32_16x16x32_bf16 v[28:31], v[248:251], v[92:95], v[28:31]
    ds_read_b128 v[80:83], v5 offset:2048
    v_mfma_f32_16x16x32_bf16 v[36:39], v[252:255], v[92:95], v[36:39]
    s_add_u32 s36, s36, 1
    v_mfma_f32_16x16x32_bf16 v[40:43], v[252:255], v[96:99], v[40:43]
    s_waitcnt lgkmcnt(2)
    s_cmp_eq_u32 s36, 16
    s_cbranch_scc1 L_q_short
L_q_b1:
    v_mfma_f32_16x16x32_bf16 v[44:47], a[0:3], v[68:71], 0
    ds_read_b128 v[84:87], v4 offset:4096
    v_mul_f32 v20, v20, v114
    v_mfma_f32_16x16x32_bf16 v[48:51], a[0:3], v[72:75], 0
    v_mul_f32 v21, v21, v114
    v_mul_f32 v22, v22, v114
    v_mfma_f32_16x16x32_bf16 v[56:59], a[4:7], v[72:75], 0
    v_mul_f32 v23, v23, v114
    v_cvt_pk_bf16_f32 v20, v20, v21
    v_mfma_f32_16x16x32_bf16 v[52:55], a[4:7], v[68:71], 0
    ds_read_b128 v[88:91], v4 offset:6144
    v_cvt_pk_bf16_f32 v21, v22, v23
    v_mfma_f32_16x16x32_bf16 v[60:63], a[8:11], v[68:71], 0
    ds_write_b64 v7, v[20:21] offset:0
    v_mfma_f32_16x16x32_bf16 v[64:67], a[8:11], v[72:75], 0
    s_waitcnt lgkmcnt(3)
    v_mul_f32 v24, v24, v115
    v_mul_f32 v25, v25, v115
    v_mfma_f32_16x16x32_bf16 v[44:47], a[12:15], v[76:79], v[44:47]
    ds_read_b128 v[92:95], v5 offset:4096
    v_mul_f32 v26, v26, v115
    v_mfma_f32_16x16x32_bf16 v[48:51], a[12:15], v[80:83], v[48:51]
    v_mul_f32 v27, v27, v115
    v_cvt_pk_bf16_f32 v24, v24, v25
    v_mfma_f32_16x16x32_bf16 v[56:59], a[16:19], v[80:83], v[56:59]
    v_cvt_pk_bf16_f32 v25, v26, v27
    v_mfma_f32_16x16x32_bf16 v[52:55], a[16:19], v[76:79], v[52:55]
    ds_read_b128 v[96:99], v5 offset:6144
    v_mfma_f32_16x16x32_bf16 v[60:63], a[20:23], v[76:79], v[60:63]
    ds_write_b64 v7, v[24:25] offset:6144
    v_mfma_f32_16x16x32_bf16 v[64:67], a[20:23], v[80:83], v[64:67]
    s_waitcnt lgkmcnt(4)
    v_mul_f32 v28, v28, v114
    v_mul_f32 v29, v29, v114
    v_mfma_f32_16x16x32_bf16 v[44:47], a[24:27], v[84:87], v[44:47]
    ds_read_b128 v[68:71], v4 offset:8192
    v_mul_f32 v30, v30, v114
    v_mfma_f32_16x16x32_bf16 v[48:51], a[24:27], v[88:91], v[48:51]
    v_mul_f32 v31, v31, v114
    v_cvt_pk_bf16_f32 v28, v28, v29
    v_mfma_f32_16x16x32_bf16 v[56:59], a[28:31], v[88:91], v[56:59]
    v_cvt_pk_bf16_f32 v29, v30, v31
    v_mfma_f32_16x16x32_bf16 v[52:55], a[28:31], v[84:87], v[52:55]
    ds_read_b128 v[72:75], v4 offset:10240
    v_mfma_f32_16x16x32_bf16 v[60:63], a[32:35], v[84:87], v[60:63]
    ds_write_b64 v7, v[28:29] offset:1024
    v_mfma_f32_16x16x32_bf16 v[64:67], a[32:35], v[88:91], v[64:67]
    s_waitcnt lgkmcnt(4)
    v_mul_f32 v32, v32, v115
    v_mul_f32 v33, v33, v115
    v_mfma_f32_16x16x32_bf16 v[44:47], a[36:39], v[92:95], v[44:47]
    ds_read_b128 v[76:79], v5 offset:8192
    v_mul_f32 v34, v34, v115
    v_mfma_f32_16x16x32_bf16 v[48:51], a[36:39], v[96:99], v[48:51]
    v_mul_f32 v35, v35, v115
    v_cvt_pk_bf16_f32 v32, v32, v33
    v_mfma_f32_16x16x32_bf16 v[56:59], a[40:43], v[96:99], v[56:59]
    v_cvt_pk_bf16_f32 v33, v34, v35
    v_mfma_f32_16x16x32_bf16 v[52:55], a[40:43], v[92:95], v[52:55]
    ds_read_b128 v[80:83], v5 offset:10240
    v_mfma_f32_16x16x32_bf16 v[60:63], a[44:47], v[92:95], v[60:63]
    ds_write_b64 v7, v[32:33] offset:7168
    v_mfma_f32_16x16x32_bf16 v[64:67], a[44:47], v[96:99], v[64:67]
    s_waitcnt lgkmcnt(4)
    v_mul_f32 v36, v36, v114
    v_mul_f32 v37, v37, v114
    v_mfma_f32_16x16x32_bf16 v[44:47], a[48:51], v[68:71], v[44:47]
    s_waitcnt vmcnt(1)
    ds_read_b128 v[84:87], v4 offset:12288
    v_cmp_ne_u32 vcc, 0, v116
    v_mfma_f32_16x16x32_bf16 v[48:51], a[48:51], v[72:75], v[48:51]
    v_mul_f32 v38, v38, v114
    v_mul_f32 v39, v39, v114
    v_mfma_f32_16x16x32_bf16 v[56:59], a[52:55], v[72:75], v[56:59]
    s_cbranch_vccnz L_spin5
L_back6:
    v_cvt_pk_bf16_f32 v36, v36, v37
    v_cvt_pk_bf16_f32 v37, v38, v39
    v_mfma_f32_16x16x32_bf16 v[52:55], a[52:55], v[68:71], v[52:55]
    ds_read_b128 v[88:91], v4 offset:14336
    v_mfma_f32_16x16x32_bf16 v[60:63], a[56:59], v[68:71], v[60:63]
    ds_write_b64 v8, v[36:37] offset:2048
    v_mfma_f32_16x16x32_bf16 v[64:67], a[56:59], v[72:75], v[64:67]
    s_waitcnt lgkmcnt(4)
    v_mul_f32 v40, v40, v115
    v_mul_f32 v41, v41, v115
    v_mfma_f32_16x16x32_bf16 v[44:47], a[60:63], v[76:79], v[44:47]
    ds_read_b128 v[92:95], v5 offset:12288
    v_mul_f32 v42, v42, v115
    v_mfma_f32_16x16x32_bf16 v[48:51], a[60:63], v[80:83], v[48:51]
    v_mul_f32 v43, v43, v115
    v_cvt_pk_bf16_f32 v40, v40, v41
    v_mfma_f32_16x16x32_bf16 v[56:59], a[64:67], v[80:83], v[56:59]
    v_cvt_pk_bf16_f32 v41, v42, v43
    v_mfma_f32_16x16x32_bf16 v[52:55], a[64:67], v[76:79], v[52:55]
    ds_read_b128 v[96:99], v5 offset:14336
    v_mfma_f32_16x16x32_bf16 v[60:63], a[68:71], v[76:79], v[60:63]
    ds_write_b64 v8, v[40:41] offset:8192
    v_mfma_f32_16x16x32_bf16 v[64:67], a[68:71], v[80:83], v[64:67]
    s_waitcnt lgkmcnt(4)
    v_mfma_f32_16x16x32_bf16 v[44:47], a[72:75], v[84:87], v[44:47]
    ds_read_b128 v[68:71], v4 offset:16384
    v_mfma_f32_16x16x32_bf16 v[48:51], a[72:75], v[88:91], v[48:51]
    v_mfma_f32_16x16x32_bf16 v[56:59], a[76:79], v[88:91], v[56:59]
    s_waitcnt lgkmcnt(1)
    s_barrier
    v_mfma_f32_16x16x32_bf16 v[52:55], a[76:79], v[84:87], v[52:55]
    ds_read_b128 v[72:75], v4 offset:18432
    v_mfma_f32_16x16x32_bf16 v[60:63], a[80:83], v[84:87], v[60:63]
    ds_read_b128 v[20:23], v10 offset:0
    v_mfma_f32_16x16x32_bf16 v[64:67], a[80:83], v[88:91], v[64:67]
    s_waitcnt lgkmcnt(4)
    ds_read_b128 v[24:27], v9 offset:1024
    v_mfma_f32_16x16x32_bf16 v[44:47], a[84:87], v[92:95], v[44:47]
    ds_read_b128 v[76:79], v5 offset:16384
    v_mfma_f32_16x16x32_bf16 v[48:51], a[84:87], v[96:99], v[48:51]
    ds_read_b128 v[28:31], v10 offset:1024
    s_add_u32 m0, s43, 0
    v_mfma_f32_16x16x32_bf16 v[56:59], a[88:91], v[96:99], v[56:59]
    buffer_load_dwordx4 v6, s[8:11], s41 offen offset:0 sc1 lds
    v_mfma_f32_16x16x32_bf16 v[52:55], a[88:91], v[92:95], v[52:55]
    s_add_u32 m0, s43, 3968
    ds_read_b128 v[80:83], v5 offset:18432
    v_mfma_f32_16x16x32_bf16 v[60:63], a[92:95], v[92:95], v[60:63]
    ds_read_b64_tr_b16 v[32:33], v9 offset:2048
    v_mfma_f32_16x16x32_bf16 v[64:67], a[92:95], v[96:99], v[64:67]
    s_waitcnt lgkmcnt(6)
    ds_read_b64_tr_b16 v[34:35], v10 offset:2048
    s_waitcnt lgkmcnt(3)
    v_mfma_f32_16x16x32_bf16 v[44:47], a[96:99], v[68:71], v[44:47]
    ds_read_b128 v[84:87], v4 offset:20480
    v_mfma_f32_16x16x32_bf16 v[40:43], v[24:27], v[20:23], 0
    ds_read_b64_tr_b16 v[36:37], v9 offset:2056
    v_mfma_f32_16x16x32_bf16 v[118:121], v[28:31], v[20:23], 0
    ds_read_b64_tr_b16 v[38:39], v10 offset:2056
    v_mfma_f32_16x16x32_bf16 v[48:51], a[96:99], v[72:75], v[48:51]
    v_mfma_f32_16x16x32_bf16 v[56:59], a[100:103], v[72:75], v[56:59]
    buffer_load_dwordx4 v6, s[8:11], s41 offen offset:128 sc1 lds
    v_mfma_f32_16x16x32_bf16 v[52:55], a[100:103], v[68:71], v[52:55]
    s_add_u32 m0, s43, 7936
    ds_read_b128 v[88:91], v4 offset:22528
    v_cndmask_b32 v40, v40, v41, s[56:57]
    v_mfma_f32_16x16x32_bf16 v[60:63], a[104:107], v[68:71], v[60:63]
    v_cndmask_b32 v42, v42, v43, s[56:57]
    v_cndmask_b32 v118, v118, v119, s[56:57]
    v_mfma_f32_16x16x32_bf16 v[64:67], a[104:107], v[72:75], v[64:67]
    s_waitcnt lgkmcnt(6)
    v_cndmask_b32 v120, v120, v121, s[56:57]
    v_cndmask_b32 v40, v18, v40, s[62:63]
    v_mfma_f32_16x16x32_bf16 v[44:47], a[108:111], v[76:79], v[44:47]
    ds_read_b128 v[92:95], v5 offset:20480
    v_cndmask_b32 v42, v18, v42, s[62:63]
    v_mfma_f32_16x16x32_bf16 v[48:51], a[108:111], v[80:83], v[48:51]
    v_cndmask_b32 v22, v40, v118, s[58:59]
    v_cndmask_b32 v23, v42, v120, s[60:61]
    v_mfma_f32_16x16x32_bf16 v[56:59], a[112:115], v[80:83], v[56:59]
    buffer_load_dwordx4 v6, s[8:11], s41 offen offset:256 sc1 lds
    v_mfma_f32_16x16x32_bf16 v[52:55], a[112:115], v[76:79], v[52:55]
    s_add_u32 m0, s43, 11904
    ds_read_b128 v[96:99], v5 offset:22528
    v_max_f32 v20, v22, v23
    v_mfma_f32_16x16x32_bf16 v[60:63], a[116:119], v[76:79], v[60:63]
    v_mov_b32 v21, v20
    v_mfma_f32_16x16x32_bf16 v[64:67], a[116:119], v[80:83], v[64:67]
    s_waitcnt lgkmcnt(2)
    v_permlane16_swap_b32 v20, v21
    v_mfma_f32_16x16x32_bf16 v[44:47], a[120:123], v[84:87], v[44:47]
    ds_read_b128 v[68:71], v4 offset:24576
    v_max_f32 v20, v20, v21
    v_mfma_f32_16x16x32_bf16 v[48:51], a[120:123], v[88:91], v[48:51]
    v_mov_b32 v21, v20
    v_mfma_f32_16x16x32_bf16 v[56:59], a[124:127], v[88:91], v[56:59]
    buffer_load_dwordx4 v6, s[8:11], s41 offen offset:384 sc1 lds
    v_mfma_f32_16x16x32_bf16 v[52:55], a[124:127], v[84:87], v[52:55]
    s_add_u32 m0, s43, 15872
    ds_read_b128 v[72:75], v4 offset:26624
    v_mfma_f32_16x16x32_bf16 v[60:63], a[128:131], v[84:87], v[60:63]
    v_permlane32_swap_b32 v20, v21
    v_mfma_f32_16x16x32_bf16 v[64:67], a[128:131], v[88:91], v[64:67]
    s_waitcnt lgkmcnt(2)
    v_max_f32 v20, v20, v21
    v_mul_f32 v20, s86, v20
    v_mfma_f32_16x16x32_bf16 v[44:47], a[132:135], v[92:95], v[44:47]
    ds_read_b128 v[76:79], v5 offset:24576
    v_fma_f32 v22, v22, s86, -v20
    v_mfma_f32_16x16x32_bf16 v[48:51], a[132:135], v[96:99], v[48:51]
    v_fma_f32 v23, v23, s86, -v20
    v_mfma_f32_16x16x32_bf16 v[56:59], a[136:139], v[96:99], v[56:59]
    buffer_load_dwordx4 v6, s[8:11], s41 offen offset:512 sc1 lds
    v_mfma_f32_16x16x32_bf16 v[52:55], a[136:139], v[92:95], v[52:55]
    s_add_u32 m0, s43, 19840
    ds_read_b128 v[80:83], v5 offset:26624
    v_mfma_f32_16x16x32_bf16 v[60:63], a[140:143], v[92:95], v[60:63]
    v_exp_f32 v22, v22
    v_mfma_f32_16x16x32_bf16 v[64:67], a[140:143], v[96:99], v[64:67]
    s_waitcnt lgkmcnt(2)
    v_exp_f32 v23, v23
    v_mfma_f32_16x16x32_bf16 v[44:47], a[144:147], v[68:71], v[44:47]
    ds_read_b128 v[84:87], v4 offset:28672
    v_cvt_pk_bf16_f32 v28, v22, v23
    v_mfma_f32_16x16x32_bf16 v[48:51], a[144:147], v[72:75], v[48:51]
    v_perm_b32 v24, v28, v28, v14
    v_perm_b32 v25, v28, v28, v15
    v_mfma_f32_16x16x32_bf16 v[56:59], a[148:151], v[72:75], v[56:59]
    buffer_load_dwordx4 v6, s[8:11], s41 offen offset:640 sc1 lds
    v_mfma_f32_16x16x32_bf16 v[52:55], a[148:151], v[68:71], v[52:55]
    s_add_u32 m0, s43, 23808
    ds_read_b128 v[88:91], v4 offset:30720
    v_perm_b32 v26, v28, v28, v16
    v_mfma_f32_16x16x32_bf16 v[60:63], a[152:155], v[68:71], v[60:63]
    v_perm_b32 v27, v28, v28, v17
    v_add_f32 v20, v22, v23
    v_mfma_f32_16x16x32_bf16 v[64:67], a[152:155], v[72:75], v[64:67]
    s_waitcnt lgkmcnt(2)
    v_mov_b32 v21, v20
    s_waitcnt lgkmcnt(9)
    v_mfma_f32_16x16x32_bf16 v[44:47], a[156:159], v[76:79], v[44:47]
    ds_read_b128 v[92:95], v5 offset:28672
    v_mfma_f32_16x16x32_bf16 v[40:43], v[32:35], v[24:27], 0
    v_mfma_f32_16x16x32_bf16 v[118:121], v[36:39], v[24:27], 0
    v_permlane16_swap_b32 v20, v21
    v_mfma_f32_16x16x32_bf16 v[48:51], a[156:159], v[80:83], v[48:51]
    v_add_f32 v20, v20, v21
    v_mov_b32 v21, v20
    v_mfma_f32_16x16x32_bf16 v[56:59], a[160:163], v[80:83], v[56:59]
    buffer_load_dwordx4 v6, s[8:11], s41 offen offset:768 sc1 lds
    v_mfma_f32_16x16x32_bf16 v[52:55], a[160:163], v[76:79], v[52:55]
    s_add_u32 m0, s43, 27776
    ds_read_b128 v[96:99], v5 offset:30720
    v_mfma_f32_16x16x32_bf16 v[60:63], a[164:167], v[76:79], v[60:63]
    v_permlane32_swap_b32 v20, v21
    v_mfma_f32_16x16x32_bf16 v[64:67], a[164:167], v[80:83], v[64:67]
    s_waitcnt lgkmcnt(2)
    v_add_f32 v20, v20, v21
    v_mfma_f32_16x16x32_bf16 v[44:47], a[168:171], v[84:87], v[44:47]
    ds_read_b128 v[68:71], v4 offset:32768
    v_mfma_f32_16x16x32_bf16 v[48:51], a[168:171], v[88:91], v[48:51]
    v_rcp_f32 v20, v20
    v_mfma_f32_16x16x32_bf16 v[56:59], a[172:175], v[88:91], v[56:59]
    buffer_load_dwordx4 v6, s[8:11], s41 offen offset:896 sc1 lds
    v_mfma_f32_16x16x32_bf16 v[52:55], a[172:175], v[84:87], v[52:55]
    s_add_u32 m0, s43, 31744
    ds_read_b128 v[72:75], v4 offset:34816
    v_mul_f32 v40, v40, v20
    v_mfma_f32_16x16x32_bf16 v[60:63], a[176:179], v[84:87], v[60:63]
    v_mul_f32 v41, v41, v20
    v_mul_f32 v42, v42, v20
    v_mfma_f32_16x16x32_bf16 v[64:67], a[176:179], v[88:91], v[64:67]
    s_waitcnt lgkmcnt(2)
    v_mul_f32 v43, v43, v20
    v_cvt_pk_bf16_f32 v28, v40, v41
    v_mfma_f32_16x16x32_bf16 v[44:47], a[180:183], v[92:95], v[44:47]
    ds_read_b128 v[76:79], v5 offset:32768
    v_cvt_pk_bf16_f32 v29, v42, v43
    v_mfma_f32_16x16x32_bf16 v[48:51], a[180:183], v[96:99], v[48:51]
    v_mul_f32 v118, v118, v20
    v_mul_f32 v119, v119, v20
    v_mfma_f32_16x16x32_bf16 v[56:59], a[184:187], v[96:99], v[56:59]
    buffer_load_dwordx4 v6, s[8:11], s41 offen offset:1024 sc1 lds
    v_mfma_f32_16x16x32_bf16 v[52:55], a[184:187], v[92:95], v[52:55]
    s_add_u32 m0, s43, 35712
    ds_read_b128 v[80:83], v5 offset:34816
    v_mul_f32 v120, v120, v20
    v_mfma_f32_16x16x32_bf16 v[60:63], a[188:191], v[92:95], v[60:63]
    v_mul_f32 v121, v121, v20
    v_cvt_pk_bf16_f32 v30, v118, v119
    v_mfma_f32_16x16x32_bf16 v[64:67], a[188:191], v[96:99], v[64:67]
    s_waitcnt lgkmcnt(2)
    v_cvt_pk_bf16_f32 v31, v120, v121
    v_mfma_f32_16x16x32_bf16 v[44:47], a[192:195], v[68:71], v[44:47]
    ds_read_b128 v[84:87], v4 offset:36864
    v_mfma_f32_16x16x32_bf16 v[48:51], a[192:195], v[72:75], v[48:51]
    buffer_store_dwordx4 v[28:31], v1, s[16:19], s44 offen sc1
    v_mfma_f32_16x16x32_bf16 v[56:59], a[196:199], v[72:75], v[56:59]
    buffer_load_dwordx4 v6, s[8:11], s41 offen offset:1152 sc1 lds
    v_mfma_f32_16x16x32_bf16 v[52:55], a[196:199], v[68:71], v[52:55]
    s_add_u32 m0, s43, 39680
    ds_read_b128 v[88:91], v4 offset:38912
    s_cmp_eq_u32 s36, 17
    v_mfma_f32_16x16x32_bf16 v[60:63], a[200:203], v[68:71], v[60:63]
    s_cselect_b32 s49, s87, 0x10000
    ds_read_b64 v[32:33], v13 offset:2048
    s_add_u32 s90, s90, s49
    v_mfma_f32_16x16x32_bf16 v[64:67], a[200:203], v[72:75], v[64:67]
    s_waitcnt lgkmcnt(3)
    ds_read_b64 v[34:35], v13 offset:2176
    s_and_b32 s49, s90, 0xffffffff
    v_mfma_f32_16x16x32_bf16 v[44:47], a[204:207], v[76:79], v[44:47]
    s_bitcmp1_b64 s[24:25], s36
    ds_read_b128 v[92:95], v5 offset:36864
    s_cselect_b32 s44, s49, 0x5e00000
    v_mfma_f32_16x16x32_bf16 v[48:51], a[204:207], v[80:83], v[48:51]
    s_bitcmp1_b64 s[26:27], s36
    ds_read_b64 v[36:37], v13 offset:2304
    s_cselect_b64 s[62:63], 0, -1
    v_mfma_f32_16x16x32_bf16 v[56:59], a[208:211], v[80:83], v[56:59]
    buffer_load_dwordx4 v6, s[8:11], s41 offen offset:1280 sc1 lds
    v_mfma_f32_16x16x32_bf16 v[52:55], a[208:211], v[76:79], v[52:55]
    s_add_u32 m0, s43, 43648
    ds_read_b128 v[96:99], v5 offset:38912
    v_mfma_f32_16x16x32_bf16 v[60:63], a[212:215], v[76:79], v[60:63]
    ds_read_b64 v[38:39], v13 offset:2432
    v_mfma_f32_16x16x32_bf16 v[64:67], a[212:215], v[80:83], v[64:67]
    s_waitcnt lgkmcnt(6)
    v_mfma_f32_16x16x32_bf16 v[44:47], a[216:219], v[84:87], v[44:47]
    ds_read_b128 v[68:71], v4 offset:40960
    v_mfma_f32_16x16x32_bf16 v[48:51], a[216:219], v[88:91], v[48:51]
    v_mfma_f32_16x16x32_bf16 v[56:59], a[220:223], v[88:91], v[56:59]
    buffer_load_dwordx4 v6, s[8:11], s41 offen offset:1408 sc1 lds
    v_mfma_f32_16x16x32_bf16 v[52:55], a[220:223], v[84:87], v[52:55]
    s_add_u32 m0, s43, 47616
    ds_read_b128 v[72:75], v4 offset:43008
    s_waitcnt lgkmcnt(2)
    v_mfma_f32_16x16x32_bf16 v[60:63], a[224:227], v[84:87], v[60:63]
    v_add_f32 v40, v36, v38
    v_add_f32 v41, v37, v39
    v_mfma_f32_16x16x32_bf16 v[64:67], a[224:227], v[88:91], v[64:67]
    s_waitcnt lgkmcnt(3)
    v_add_f32 v32, v32, v34
    v_add_f32 v33, v33, v35
    v_mfma_f32_16x16x32_bf16 v[44:47], a[228:231], v[92:95], v[44:47]
    ds_read_b128 v[76:79], v5 offset:40960
    v_add_f32 v32, v32, v40
    v_mfma_f32_16x16x32_bf16 v[48:51], a[228:231], v[96:99], v[48:51]
    v_add_f32 v33, v33, v41
    v_mov_b32 v40, v32
    v_mfma_f32_16x16x32_bf16 v[56:59], a[232:235], v[96:99], v[56:59]
    buffer_load_dwordx4 v6, s[8:11], s41 offen offset:1536 sc1 lds
    v_mfma_f32_16x16x32_bf16 v[52:55], a[232:235], v[92:95], v[52:55]
    s_add_u32 m0, s43, 51584
    ds_read_b128 v[80:83], v5 offset:43008
    v_mov_b32 v41, v33
    v_mfma_f32_16x16x32_bf16 v[60:63], a[236:239], v[92:95], v[60:63]
    v_permlane32_swap_b32 v32, v40
    v_mfma_f32_16x16x32_bf16 v[64:67], a[236:239], v[96:99], v[64:67]
    s_waitcnt lgkmcnt(2)
    v_permlane32_swap_b32 v33, v41
    v_mfma_f32_16x16x32_bf16 v[44:47], a[240:243], v[68:71], v[44:47]
    ds_read_b128 v[84:87], v4 offset:45056
    v_add_f32 v32, v32, v40
    v_mfma_f32_16x16x32_bf16 v[48:51], a[240:243], v[72:75], v[48:51]
    v_add_f32 v33, v33, v41
    v_mul_f32 v112, 0xba800000, v32
    v_mfma_f32_16x16x32_bf16 v[56:59], a[244:247], v[72:75], v[56:59]
    buffer_load_dwordx4 v6, s[8:11], s41 offen offset:1664 sc1 lds
    v_mfma_f32_16x16x32_bf16 v[52:55], a[244:247], v[68:71], v[52:55]
    s_add_u32 m0, s43, 55552
    ds_read_b128 v[88:91], v4 offset:47104
    v_mul_f32 v33, 0x3a800000, v33
    v_mfma_f32_16x16x32_bf16 v[60:63], a[248:251], v[68:71], v[60:63]
    v_fma_f32 v33, -v112, v112, v33
    v_mov_b32 v113, v112
    v_mfma_f32_16x16x32_bf16 v[64:67], a[248:251], v[72:75], v[64:67]
    s_waitcnt lgkmcnt(2)
    v_max_f32 v33, 0, v33
    v_add_f32 v33, 0x3727c5ac, v33
    v_mfma_f32_16x16x32_bf16 v[44:47], a[252:255], v[76:79], v[44:47]
    ds_read_b128 v[92:95], v5 offset:45056
    v_mfma_f32_16x16x32_bf16 v[48:51], a[252:255], v[80:83], v[48:51]
    v_rsq_f32 v114, v33
    v_mfma_f32_16x16x32_bf16 v[56:59], v[128:131], v[80:83], v[56:59]
    buffer_load_dwordx4 v6, s[8:11], s41 offen offset:1792 sc1 lds
    v_mfma_f32_16x16x32_bf16 v[52:55], v[128:131], v[76:79], v[52:55]
    s_add_u32 m0, s43, 59520
    ds_read_b128 v[96:99], v5 offset:47104
    v_mfma_f32_16x16x32_bf16 v[60:63], v[132:135], v[76:79], v[60:63]
    v_permlane16_swap_b32 v112, v113
    v_mfma_f32_16x16x32_bf16 v[64:67], v[132:135], v[80:83], v[64:67]
    s_waitcnt lgkmcnt(2)
    v_mov_b32 v115, v114
    v_fmac_f32 v48, v113, v100
    v_mfma_f32_16x16x32_bf16 v[44:47], v[136:139], v[84:87], v[44:47]
    ds_read_b128 v[68:71], v4 offset:49152
    v_fmac_f32 v52, v112, v104
    v_mfma_f32_16x16x32_bf16 v[48:51], v[136:139], v[88:91], v[48:51]
    v_permlane16_swap_b32 v114, v115
    v_mfma_f32_16x16x32_bf16 v[56:59], v[140:143], v[88:91], v[56:59]
    buffer_load_dwordx4 v6, s[8:11], s41 offen offset:1920 sc1 lds
    v_mfma_f32_16x16x32_bf16 v[52:55], v[140:143], v[84:87], v[52:55]
    s_add_u32 m0, s52, 90112
    ds_read_b128 v[72:75], v4 offset:51200
    v_fmac_f32 v44, v112, v100
    v_mfma_f32_16x16x32_bf16 v[60:63], v[144:147], v[84:87], v[60:63]
    v_fmac_f32 v45, v112, v101
    v_fmac_f32 v46, v112, v102
    v_mfma_f32_16x16x32_bf16 v[64:67], v[144:147], v[88:91], v[64:67]
    s_waitcnt lgkmcnt(2)
    v_fmac_f32 v49, v113, v101
    v_fmac_f32 v50, v113, v102
    v_mfma_f32_16x16x32_bf16 v[44:47], v[148:151], v[92:95], v[44:47]
    ds_read_b128 v[76:79], v5 offset:49152
    v_fmac_f32 v53, v112, v105
    v_mfma_f32_16x16x32_bf16 v[48:51], v[148:151], v[96:99], v[48:51]
    v_fmac_f32 v54, v112, v106
    v_fmac_f32 v55, v112, v107
    v_mfma_f32_16x16x32_bf16 v[56:59], v[152:155], v[96:99], v[56:59]
    buffer_load_dwordx4 v1, s[16:19], s46 offen sc1 lds
    v_mfma_f32_16x16x32_bf16 v[52:55], v[152:155], v[92:95], v[52:55]
    s_cmp_eq_u32 s36, s97
    ds_read_b128 v[80:83], v5 offset:51200
    v_med3_i32 v117, s45, 0, v12
    v_mfma_f32_16x16x32_bf16 v[60:63], v[156:159], v[92:95], v[60:63]
    s_cselect_b32 s47, 32, -2
    v_add_u32 v117, v117, v11
    v_fmac_f32 v47, v112, v103
    v_mfma_f32_16x16x32_bf16 v[64:67], v[156:159], v[96:99], v[64:67]
    s_waitcnt lgkmcnt(2)
    v_fmac_f32 v51, v113, v103
    v_fmac_f32 v56, v113, v104
    v_mfma_f32_16x16x32_bf16 v[44:47], v[160:163], v[68:71], v[44:47]
    s_cselect_b64 s[8:9], s[88:89], s[8:9]
    ds_read_b128 v[84:87], v4 offset:53248
    v_fmac_f32 v57, v113, v105
    v_mfma_f32_16x16x32_bf16 v[48:51], v[160:163], v[72:75], v[48:51]
    s_cselect_b32 s55, 0x543fc00, s55
    v_fmac_f32 v60, v112, v108
    v_fmac_f32 v61, v112, v109
    v_mfma_f32_16x16x32_bf16 v[56:59], v[164:167], v[72:75], v[56:59]
    s_add_u32 s45, s45, 65536
    v_fmac_f32 v62, v112, v110
    v_fmac_f32 v63, v112, v111
    v_mfma_f32_16x16x32_bf16 v[52:55], v[164:167], v[68:71], v[52:55]
    s_add_u32 s50, s50, s47
    ds_read_b128 v[88:91], v4 offset:55296
    v_fmac_f32 v64, v113, v108
    v_mfma_f32_16x16x32_bf16 v[60:63], v[168:171], v[68:71], v[60:63]
    buffer_load_dword v116, v117, s[16:19], 0 offen sc1
    v_mfma_f32_16x16x32_bf16 v[64:67], v[168:171], v[72:75], v[64:67]
    s_waitcnt lgkmcnt(2)
    v_fmac_f32 v58, v113, v106
    v_fmac_f32 v59, v113, v107
    v_mfma_f32_16x16x32_bf16 v[44:47], v[172:175], v[76:79], v[44:47]
    s_max_i32 s47, s50, 0
    ds_read_b128 v[92:95], v5 offset:53248
    s_min_i32 s47, s47, s96
    v_mfma_f32_16x16x32_bf16 v[48:51], v[172:175], v[80:83], v[48:51]
    s_lshl_b32 s41, s47, 15
    v_fmac_f32 v65, v113, v109
    v_fmac_f32 v66, v113, v110
    v_mfma_f32_16x16x32_bf16 v[56:59], v[176:179], v[80:83], v[56:59]
    s_lshl_b32 s46, s47, 10
    v_fmac_f32 v67, v113, v111
    s_sub_u32 s46, s55, s46
    v_mfma_f32_16x16x32_bf16 v[52:55], v[176:179], v[76:79], v[52:55]
    ds_read_b128 v[96:99], v5 offset:55296
    v_mfma_f32_16x16x32_bf16 v[60:63], v[180:183], v[76:79], v[60:63]
    v_mfma_f32_16x16x32_bf16 v[64:67], v[180:183], v[80:83], v[64:67]
    s_waitcnt lgkmcnt(2)
    v_mfma_f32_16x16x32_bf16 v[44:47], v[184:187], v[84:87], v[44:47]
    ds_read_b128 v[68:71], v4 offset:57344
    v_mfma_f32_16x16x32_bf16 v[48:51], v[184:187], v[88:91], v[48:51]
    v_mfma_f32_16x16x32_bf16 v[56:59], v[188:191], v[88:91], v[56:59]
    v_mfma_f32_16x16x32_bf16 v[52:55], v[188:191], v[84:87], v[52:55]
    ds_read_b128 v[72:75], v4 offset:59392
    v_mfma_f32_16x16x32_bf16 v[60:63], v[192:195], v[84:87], v[60:63]
    s_waitcnt vmcnt(9)
    s_barrier
    v_mfma_f32_16x16x32_bf16 v[64:67], v[192:195], v[88:91], v[64:67]
    s_waitcnt lgkmcnt(2)
    v_mfma_f32_16x16x32_bf16 v[44:47], v[196:199], v[92:95], v[44:47]
    ds_read_b128 v[76:79], v5 offset:57344
    v_mfma_f32_16x16x32_bf16 v[48:51], v[196:199], v[96:99], v[48:51]
    buffer_store_dword v124, v124, s[16:19], s91 offen sc1
    v_mfma_f32_16x16x32_bf16 v[56:59], v[200:203], v[96:99], v[56:59]
    s_add_u32 s91, s91, 65536
    v_mfma_f32_16x16x32_bf16 v[52:55], v[200:203], v[92:95], v[52:55]
    ds_read_b128 v[80:83], v5 offset:59392
    v_mfma_f32_16x16x32_bf16 v[60:63], v[204:207], v[92:95], v[60:63]
    v_mfma_f32_16x16x32_bf16 v[64:67], v[204:207], v[96:99], v[64:67]
    s_waitcnt lgkmcnt(2)
    v_mfma_f32_16x16x32_bf16 v[44:47], v[208:211], v[68:71], v[44:47]
    ds_read_b128 v[84:87], v4 offset:61440
    v_mfma_f32_16x16x32_bf16 v[48:51], v[208:211], v[72:75], v[48:51]
    v_mfma_f32_16x16x32_bf16 v[56:59], v[212:215], v[72:75], v[56:59]
    v_mfma_f32_16x16x32_bf16 v[52:55], v[212:215], v[68:71], v[52:55]
    ds_read_b128 v[88:91], v4 offset:63488
    v_mfma_f32_16x16x32_bf16 v[60:63], v[216:219], v[68:71], v[60:63]
    v_mfma_f32_16x16x32_bf16 v[64:67], v[216:219], v[72:75], v[64:67]
    s_waitcnt lgkmcnt(2)
    v_mfma_f32_16x16x32_bf16 v[44:47], v[220:223], v[76:79], v[44:47]
    ds_read_b128 v[92:95], v5 offset:61440
    v_mfma_f32_16x16x32_bf16 v[48:51], v[220:223], v[80:83], v[48:51]
    v_mfma_f32_16x16x32_bf16 v[56:59], v[224:227], v[80:83], v[56:59]
    v_mfma_f32_16x16x32_bf16 v[52:55], v[224:227], v[76:79], v[52:55]
    ds_read_b128 v[96:99], v5 offset:63488
    v_mfma_f32_16x16x32_bf16 v[60:63], v[228:231], v[76:79], v[60:63]
    v_mfma_f32_16x16x32_bf16 v[64:67], v[228:231], v[80:83], v[64:67]
    s_waitcnt lgkmcnt(2)
    v_mfma_f32_16x16x32_bf16 v[44:47], v[232:235], v[84:87], v[44:47]
    ds_read_b128 v[68:71], v2 offset:0
    v_mfma_f32_16x16x32_bf16 v[48:51], v[232:235], v[88:91], v[48:51]
    v_mfma_f32_16x16x32_bf16 v[56:59], v[236:239], v[88:91], v[56:59]
    v_mfma_f32_16x16x32_bf16 v[52:55], v[236:239], v[84:87], v[52:55]
    ds_read_b128 v[72:75], v2 offset:2048
    v_mfma_f32_16x16x32_bf16 v[60:63], v[240:243], v[84:87], v[60:63]
    v_mfma_f32_16x16x32_bf16 v[64:67], v[240:243], v[88:91], v[64:67]
    s_waitcnt lgkmcnt(2)
    v_mfma_f32_16x16x32_bf16 v[44:47], v[244:247], v[92:95], v[44:47]
    ds_read_b128 v[76:79], v3 offset:0
    v_mfma_f32_16x16x32_bf16 v[48:51], v[244:247], v[96:99], v[48:51]
    v_mfma_f32_16x16x32_bf16 v[56:59], v[248:251], v[96:99], v[56:59]
    v_mfma_f32_16x16x32_bf16 v[52:55], v[248:251], v[92:95], v[52:55]
    ds_read_b128 v[80:83], v3 offset:2048
    v_mfma_f32_16x16x32_bf16 v[60:63], v[252:255], v[92:95], v[60:63]
    s_add_u32 s36, s36, 1
    v_mfma_f32_16x16x32_bf16 v[64:67], v[252:255], v[96:99], v[64:67]
    s_waitcnt lgkmcnt(2)
    s_cmp_lt_u32 s36, 33
    s_cbranch_scc1 L_q_b0
    s_nop 7
    v_mul_f32 v44, v44, v114
    v_mul_f32 v45, v45, v114
    v_mul_f32 v46, v46, v114
    v_mul_f32 v47, v47, v114
    v_cvt_pk_bf16_f32 v44, v44, v45
    v_cvt_pk_bf16_f32 v45, v46, v47
    ds_write_b64 v7, v[44:45] offset:12288
    v_mul_f32 v48, v48, v115
    v_mul_f32 v49, v49, v115
    v_mul_f32 v50, v50, v115
    v_mul_f32 v51, v51, v115
    v_cvt_pk_bf16_f32 v48, v48, v49
    v_cvt_pk_bf16_f32 v49, v50, v51
    ds_write_b64 v7, v[48:49] offset:18432
    v_mul_f32 v52, v52, v114
    v_mul_f32 v53, v53, v114
    v_mul_f32 v54, v54, v114
    v_mul_f32 v55, v55, v114
    v_cvt_pk_bf16_f32 v52, v52, v53
    v_cvt_pk_bf16_f32 v53, v54, v55
    ds_write_b64 v7, v[52:53] offset:13312
    v_mul_f32 v56, v56, v115
    v_mul_f32 v57, v57, v115
    v_mul_f32 v58, v58, v115
    v_mul_f32 v59, v59, v115
    v_cvt_pk_bf16_f32 v56, v56, v57
    v_cvt_pk_bf16_f32 v57, v58, v59
    ds_write_b64 v7, v[56:57] offset:19456
    v_mul_f32 v60, v60, v114
    v_mul_f32 v61, v61, v114
    v_mul_f32 v62, v62, v114
    v_mul_f32 v63, v63, v114
    v_cvt_pk_bf16_f32 v60, v60, v61
    v_cvt_pk_bf16_f32 v61, v62, v63
    ds_write_b64 v8, v[60:61] offset:14336
    v_mul_f32 v64, v64, v115
    v_mul_f32 v65, v65, v115
    v_mul_f32 v66, v66, v115
    v_mul_f32 v67, v67, v115
    v_cvt_pk_bf16_f32 v64, v64, v65
    v_cvt_pk_bf16_f32 v65, v66, v67
    ds_write_b64 v8, v[64:65] offset:20480
    s_waitcnt lgkmcnt(0)
    s_barrier
    ds_read_b128 v[44:47], v9 offset:6144
    ds_read_b128 v[48:51], v9 offset:13312
    ds_read_b128 v[52:55], v9 offset:7168
    ds_read_b64_tr_b16 v[56:57], v9 offset:14336
    ds_read_b64_tr_b16 v[58:59], v9 offset:8192
    ds_read_b64_tr_b16 v[60:61], v9 offset:14344
    ds_read_b64_tr_b16 v[62:63], v9 offset:8200
    s_waitcnt lgkmcnt(4)
    v_mfma_f32_16x16x32_bf16 v[64:67], v[48:51], v[44:47], 0
    v_mfma_f32_16x16x32_bf16 v[118:121], v[52:55], v[44:47], 0
    s_nop 5
    v_cndmask_b32 v64, v64, v65, s[56:57]
    v_cndmask_b32 v66, v66, v67, s[56:57]
    v_cndmask_b32 v118, v118, v119, s[56:57]
    v_cndmask_b32 v120, v120, v121, s[56:57]
    v_cndmask_b32 v64, v18, v64, s[62:63]
    v_cndmask_b32 v66, v18, v66, s[62:63]
    v_cndmask_b32 v46, v64, v118, s[58:59]
    v_cndmask_b32 v47, v66, v120, s[60:61]
    v_max_f32 v44, v46, v47
    v_mov_b32 v45, v44
    s_nop 1
    v_permlane16_swap_b32 v44, v45
    v_max_f32 v44, v44, v45
    v_mov_b32 v45, v44
    s_nop 1
    v_permlane32_swap_b32 v44, v45
    v_max_f32 v44, v44, v45
    v_mul_f32 v44, s86, v44
    v_fma_f32 v46, v46, s86, -v44
    v_fma_f32 v47, v47, s86, -v44
    v_exp_f32 v46, v46
    v_exp_f32 v47, v47
    s_nop 0
    v_cvt_pk_bf16_f32 v52, v46, v47
    v_perm_b32 v48, v52, v52, v14
    v_perm_b32 v49, v52, v52, v15
    v_perm_b32 v50, v52, v52, v16
    v_perm_b32 v51, v52, v52, v17
    s_waitcnt lgkmcnt(0)
    v_add_f32 v44, v46, v47
    v_mfma_f32_16x16x32_bf16 v[64:67], v[56:59], v[48:51], 0
    v_mfma_f32_16x16x32_bf16 v[118:121], v[60:63], v[48:51], 0
    v_mov_b32 v45, v44
    s_nop 1
    v_permlane16_swap_b32 v44, v45
    v_add_f32 v44, v44, v45
    v_mov_b32 v45, v44
    s_nop 1
    v_permlane32_swap_b32 v44, v45
    v_add_f32 v44, v44, v45
    v_rcp_f32 v44, v44
    s_nop 0
    v_mul_f32 v64, v64, v44
    v_mul_f32 v65, v65, v44
    v_mul_f32 v66, v66, v44
    v_mul_f32 v67, v67, v44
    v_cvt_pk_bf16_f32 v52, v64, v65
    v_cvt_pk_bf16_f32 v53, v66, v67
    v_mul_f32 v118, v118, v44
    v_mul_f32 v119, v119, v44
    v_mul_f32 v120, v120, v44
    v_mul_f32 v121, v121, v44
    v_cvt_pk_bf16_f32 v54, v118, v119
    v_cvt_pk_bf16_f32 v55, v120, v121
    buffer_store_dwordx4 v[52:55], v1, s[16:19], s44 offen sc1
    s_waitcnt vmcnt(0)
    s_barrier
    buffer_store_dword v124, v124, s[16:19], s91 offen sc1
    s_add_u32 s91, s91, 65536
    s_waitcnt vmcnt(0)
    s_endpgm
L_q_short:
    s_nop 5
    s_waitcnt lgkmcnt(2)
    v_mfma_f32_16x16x32_bf16 v[48:51], a[0:3], v[72:75], 0
    s_mov_b32 s39, 0x5e00000
    ds_read_b128 v[96:99], v5 offset:6144
    v_mul_f32 v20, v20, v114
    v_mfma_f32_16x16x32_bf16 v[56:59], a[4:7], v[72:75], 0
    ds_read_b128 v[88:91], v4 offset:6144
    v_mul_f32 v21, v21, v114
    v_mfma_f32_16x16x32_bf16 v[64:67], a[8:11], v[72:75], 0
    s_waitcnt lgkmcnt(2)
    v_mul_f32 v22, v22, v114
    v_mul_f32 v23, v23, v114
    v_mfma_f32_16x16x32_bf16 v[48:51], a[12:15], v[80:83], v[48:51]
    ds_read_b128 v[72:75], v4 offset:10240
    v_cvt_pk_bf16_f32 v20, v20, v21
    v_mfma_f32_16x16x32_bf16 v[56:59], a[16:19], v[80:83], v[56:59]
    v_cvt_pk_bf16_f32 v21, v22, v23
    ds_write_b64 v7, v[20:21] offset:0
    v_mfma_f32_16x16x32_bf16 v[64:67], a[20:23], v[80:83], v[64:67]
    s_waitcnt lgkmcnt(2)
    v_mul_f32 v24, v24, v115
    v_mul_f32 v25, v25, v115
    v_mfma_f32_16x16x32_bf16 v[48:51], a[24:27], v[88:91], v[48:51]
    ds_read_b128 v[80:83], v5 offset:10240
    v_mul_f32 v26, v26, v115
    v_mfma_f32_16x16x32_bf16 v[56:59], a[28:31], v[88:91], v[56:59]
    v_mul_f32 v27, v27, v115
    v_cvt_pk_bf16_f32 v24, v24, v25
    v_mfma_f32_16x16x32_bf16 v[64:67], a[32:35], v[88:91], v[64:67]
    s_waitcnt lgkmcnt(4)
    v_cvt_pk_bf16_f32 v25, v26, v27
    ds_write_b64 v7, v[24:25] offset:6144
    v_mfma_f32_16x16x32_bf16 v[48:51], a[36:39], v[96:99], v[48:51]
    ds_read_b128 v[88:91], v4 offset:14336
    v_mul_f32 v28, v28, v114
    v_mfma_f32_16x16x32_bf16 v[56:59], a[40:43], v[96:99], v[56:59]
    v_mul_f32 v29, v29, v114
    v_mul_f32 v30, v30, v114
    v_mfma_f32_16x16x32_bf16 v[64:67], a[44:47], v[96:99], v[64:67]
    s_waitcnt lgkmcnt(4)
    v_mul_f32 v31, v31, v114
    v_cvt_pk_bf16_f32 v28, v28, v29
    v_mfma_f32_16x16x32_bf16 v[48:51], a[48:51], v[72:75], v[48:51]
    ds_read_b128 v[96:99], v5 offset:14336
    v_cvt_pk_bf16_f32 v29, v30, v31
    v_mfma_f32_16x16x32_bf16 v[56:59], a[52:55], v[72:75], v[56:59]
    ds_write_b64 v7, v[28:29] offset:1024
    v_mfma_f32_16x16x32_bf16 v[64:67], a[56:59], v[72:75], v[64:67]
    s_waitcnt lgkmcnt(4)
    v_mul_f32 v32, v32, v115
    v_mul_f32 v33, v33, v115
    v_mfma_f32_16x16x32_bf16 v[48:51], a[60:63], v[80:83], v[48:51]
    ds_read_b128 v[72:75], v4 offset:18432
    v_mul_f32 v34, v34, v115
    v_mfma_f32_16x16x32_bf16 v[56:59], a[64:67], v[80:83], v[56:59]
    v_mul_f32 v35, v35, v115
    v_cvt_pk_bf16_f32 v32, v32, v33
    v_mfma_f32_16x16x32_bf16 v[64:67], a[68:71], v[80:83], v[64:67]
    s_waitcnt lgkmcnt(3)
    v_cvt_pk_bf16_f32 v33, v34, v35
    ds_write_b64 v7, v[32:33] offset:7168
    v_mfma_f32_16x16x32_bf16 v[48:51], a[72:75], v[88:91], v[48:51]
    ds_read_b128 v[80:83], v5 offset:18432
    v_mul_f32 v36, v36, v114
    v_mfma_f32_16x16x32_bf16 v[56:59], a[76:79], v[88:91], v[56:59]
    v_mul_f32 v37, v37, v114
    v_mul_f32 v38, v38, v114
    v_mfma_f32_16x16x32_bf16 v[64:67], a[80:83], v[88:91], v[64:67]
    s_waitcnt lgkmcnt(4)
    v_mul_f32 v39, v39, v114
    v_cvt_pk_bf16_f32 v36, v36, v37
    v_mfma_f32_16x16x32_bf16 v[48:51], a[84:87], v[96:99], v[48:51]
    s_waitcnt vmcnt(1)
    ds_read_b128 v[88:91], v4 offset:22528
    v_cmp_ne_u32 vcc, 0, v116
    v_mfma_f32_16x16x32_bf16 v[56:59], a[88:91], v[96:99], v[56:59]
    v_cvt_pk_bf16_f32 v37, v38, v39
    ds_write_b64 v8, v[36:37] offset:2048
    v_mfma_f32_16x16x32_bf16 v[64:67], a[92:95], v[96:99], v[64:67]
    s_waitcnt lgkmcnt(4)
    v_mul_f32 v40, v40, v115
    v_mul_f32 v41, v41, v115
    v_mfma_f32_16x16x32_bf16 v[48:51], a[96:99], v[72:75], v[48:51]
    s_cbranch_vccnz L_spin7
L_back8:
    ds_read_b128 v[96:99], v5 offset:22528
    v_mul_f32 v42, v42, v115
    v_mfma_f32_16x16x32_bf16 v[56:59], a[100:103], v[72:75], v[56:59]
    v_mul_f32 v43, v43, v115
    v_cvt_pk_bf16_f32 v40, v40, v41
    v_mfma_f32_16x16x32_bf16 v[64:67], a[104:107], v[72:75], v[64:67]
    s_waitcnt lgkmcnt(3)
    v_cvt_pk_bf16_f32 v41, v42, v43
    ds_write_b64 v8, v[40:41] offset:8192
    v_mfma_f32_16x16x32_bf16 v[48:51], a[108:111], v[80:83], v[48:51]
    ds_read_b128 v[72:75], v4 offset:26624
    v_mfma_f32_16x16x32_bf16 v[56:59], a[112:115], v[80:83], v[56:59]
    v_mfma_f32_16x16x32_bf16 v[64:67], a[116:119], v[80:83], v[64:67]
    s_waitcnt lgkmcnt(4)
    s_waitcnt lgkmcnt(1)
    s_barrier
    v_mfma_f32_16x16x32_bf16 v[48:51], a[120:123], v[88:91], v[48:51]
    s_add_u32 m0, s43, 0
    ds_read_b128 v[80:83], v5 offset:26624
    buffer_load_dwordx4 v6, s[8:11], s41 offen offset:0 sc1 lds
    v_mfma_f32_16x16x32_bf16 v[56:59], a[124:127], v[88:91], v[56:59]
    s_add_u32 m0, s43, 3968
    ds_read_b128 v[20:23], v10 offset:0
    ds_read_b128 v[24:27], v9 offset:1024
    v_mfma_f32_16x16x32_bf16 v[64:67], a[128:131], v[88:91], v[64:67]
    s_waitcnt lgkmcnt(5)
    ds_read_b128 v[28:31], v10 offset:1024
    ds_read_b64_tr_b16 v[32:33], v9 offset:2048
    v_mfma_f32_16x16x32_bf16 v[48:51], a[132:135], v[96:99], v[48:51]
    ds_read_b128 v[88:91], v4 offset:30720
    buffer_load_dwordx4 v6, s[8:11], s41 offen offset:128 sc1 lds
    v_mfma_f32_16x16x32_bf16 v[56:59], a[136:139], v[96:99], v[56:59]
    s_add_u32 m0, s43, 7936
    ds_read_b64_tr_b16 v[34:35], v10 offset:2048
    ds_read_b64_tr_b16 v[36:37], v9 offset:2056
    v_mfma_f32_16x16x32_bf16 v[64:67], a[140:143], v[96:99], v[64:67]
    s_waitcnt lgkmcnt(8)
    ds_read_b64_tr_b16 v[38:39], v10 offset:2056
    ds_read_b64 v[44:45], v13 offset:2048
    v_mfma_f32_16x16x32_bf16 v[48:51], a[144:147], v[72:75], v[48:51]
    s_waitcnt lgkmcnt(6)
    ds_read_b128 v[96:99], v5 offset:30720
    buffer_load_dwordx4 v6, s[8:11], s41 offen offset:256 sc1 lds
    v_mfma_f32_16x16x32_bf16 v[56:59], a[148:151], v[72:75], v[56:59]
    v_mfma_f32_16x16x32_bf16 v[40:43], v[24:27], v[20:23], 0
    v_mfma_f32_16x16x32_bf16 v[118:121], v[28:31], v[20:23], 0
    s_add_u32 m0, s43, 11904
    ds_read_b64 v[46:47], v13 offset:2176
    ds_read_b64 v[52:53], v13 offset:2304
    v_mfma_f32_16x16x32_bf16 v[64:67], a[152:155], v[72:75], v[64:67]
    s_waitcnt lgkmcnt(12)
    v_cndmask_b32 v40, v40, v41, s[56:57]
    v_cndmask_b32 v42, v42, v43, s[56:57]
    v_mfma_f32_16x16x32_bf16 v[48:51], a[156:159], v[80:83], v[48:51]
    ds_read_b128 v[72:75], v4 offset:34816
    buffer_load_dwordx4 v6, s[8:11], s41 offen offset:384 sc1 lds
    v_mfma_f32_16x16x32_bf16 v[56:59], a[160:163], v[80:83], v[56:59]
    s_add_u32 m0, s43, 15872
    v_cndmask_b32 v118, v118, v119, s[56:57]
    v_cndmask_b32 v120, v120, v121, s[56:57]
    v_mfma_f32_16x16x32_bf16 v[64:67], a[164:167], v[80:83], v[64:67]
    s_waitcnt lgkmcnt(8)
    v_cndmask_b32 v40, v18, v40, s[62:63]
    v_cndmask_b32 v42, v18, v42, s[62:63]
    v_mfma_f32_16x16x32_bf16 v[48:51], a[168:171], v[88:91], v[48:51]
    ds_read_b128 v[80:83], v5 offset:34816
    buffer_load_dwordx4 v6, s[8:11], s41 offen offset:512 sc1 lds
    v_mfma_f32_16x16x32_bf16 v[56:59], a[172:175], v[88:91], v[56:59]
    s_add_u32 m0, s43, 19840
    v_cndmask_b32 v22, v40, v118, s[58:59]
    v_cndmask_b32 v23, v42, v120, s[60:61]
    v_mfma_f32_16x16x32_bf16 v[64:67], a[176:179], v[88:91], v[64:67]
    s_waitcnt lgkmcnt(4)
    v_max_f32 v20, v22, v23
    v_mov_b32 v21, v20
    v_mfma_f32_16x16x32_bf16 v[48:51], a[180:183], v[96:99], v[48:51]
    ds_read_b128 v[88:91], v4 offset:38912
    buffer_load_dwordx4 v6, s[8:11], s41 offen offset:640 sc1 lds
    v_mfma_f32_16x16x32_bf16 v[56:59], a[184:187], v[96:99], v[56:59]
    s_add_u32 m0, s43, 23808
    v_permlane16_swap_b32 v20, v21
    v_mfma_f32_16x16x32_bf16 v[64:67], a[188:191], v[96:99], v[64:67]
    s_waitcnt lgkmcnt(2)
    v_max_f32 v20, v20, v21
    v_mov_b32 v21, v20
    v_mfma_f32_16x16x32_bf16 v[48:51], a[192:195], v[72:75], v[48:51]
    ds_read_b128 v[96:99], v5 offset:38912
    buffer_load_dwordx4 v6, s[8:11], s41 offen offset:768 sc1 lds
    v_mfma_f32_16x16x32_bf16 v[56:59], a[196:199], v[72:75], v[56:59]
    s_add_u32 m0, s43, 27776
    v_permlane32_swap_b32 v20, v21
    v_mfma_f32_16x16x32_bf16 v[64:67], a[200:203], v[72:75], v[64:67]
    s_waitcnt lgkmcnt(2)
    v_max_f32 v20, v20, v21
    v_mul_f32 v20, s86, v20
    v_mfma_f32_16x16x32_bf16 v[48:51], a[204:207], v[80:83], v[48:51]
    ds_read_b128 v[72:75], v4 offset:43008
    buffer_load_dwordx4 v6, s[8:11], s41 offen offset:896 sc1 lds
    v_mfma_f32_16x16x32_bf16 v[56:59], a[208:211], v[80:83], v[56:59]
    s_add_u32 m0, s43, 31744
    v_fma_f32 v22, v22, s86, -v20
    v_fma_f32 v23, v23, s86, -v20
    v_mfma_f32_16x16x32_bf16 v[64:67], a[212:215], v[80:83], v[64:67]
    s_waitcnt lgkmcnt(2)
    v_exp_f32 v22, v22
    v_mfma_f32_16x16x32_bf16 v[48:51], a[216:219], v[88:91], v[48:51]
    ds_read_b128 v[80:83], v5 offset:43008
    buffer_load_dwordx4 v6, s[8:11], s41 offen offset:1024 sc1 lds
    v_mfma_f32_16x16x32_bf16 v[56:59], a[220:223], v[88:91], v[56:59]
    s_add_u32 m0, s43, 35712
    v_exp_f32 v23, v23
    v_mfma_f32_16x16x32_bf16 v[64:67], a[224:227], v[88:91], v[64:67]
    s_waitcnt lgkmcnt(2)
    v_cvt_pk_bf16_f32 v28, v22, v23
    v_perm_b32 v24, v28, v28, v14
    v_mfma_f32_16x16x32_bf16 v[48:51], a[228:231], v[96:99], v[48:51]
    ds_read_b128 v[88:91], v4 offset:47104
    buffer_load_dwordx4 v6, s[8:11], s41 offen offset:1152 sc1 lds
    v_mfma_f32_16x16x32_bf16 v[56:59], a[232:235], v[96:99], v[56:59]
    s_add_u32 m0, s43, 39680
    v_perm_b32 v25, v28, v28, v15
    v_perm_b32 v26, v28, v28, v16
    v_mfma_f32_16x16x32_bf16 v[64:67], a[236:239], v[96:99], v[64:67]
    s_waitcnt lgkmcnt(2)
    v_perm_b32 v27, v28, v28, v17
    v_add_f32 v20, v22, v23
    v_mfma_f32_16x16x32_bf16 v[48:51], a[240:243], v[72:75], v[48:51]
    s_waitcnt lgkmcnt(11)
    ds_read_b128 v[96:99], v5 offset:47104
    buffer_load_dwordx4 v6, s[8:11], s41 offen offset:1280 sc1 lds
    v_mfma_f32_16x16x32_bf16 v[56:59], a[244:247], v[72:75], v[56:59]
    v_mfma_f32_16x16x32_bf16 v[40:43], v[32:35], v[24:27], 0
    v_mfma_f32_16x16x32_bf16 v[118:121], v[36:39], v[24:27], 0
    s_add_u32 m0, s43, 43648
    v_mov_b32 v21, v20
    ds_read_b64 v[54:55], v13 offset:2432
    v_mfma_f32_16x16x32_bf16 v[64:67], a[248:251], v[72:75], v[64:67]
    s_waitcnt lgkmcnt(3)
    v_permlane16_swap_b32 v20, v21
    v_mfma_f32_16x16x32_bf16 v[48:51], a[252:255], v[80:83], v[48:51]
    ds_read_b128 v[72:75], v4 offset:51200
    buffer_load_dwordx4 v6, s[8:11], s41 offen offset:1408 sc1 lds
    v_mfma_f32_16x16x32_bf16 v[56:59], v[128:131], v[80:83], v[56:59]
    s_add_u32 m0, s43, 47616
    v_add_f32 v20, v20, v21
    v_mov_b32 v21, v20
    v_mfma_f32_16x16x32_bf16 v[64:67], v[132:135], v[80:83], v[64:67]
    s_waitcnt lgkmcnt(3)
    v_permlane32_swap_b32 v20, v21
    v_mfma_f32_16x16x32_bf16 v[48:51], v[136:139], v[88:91], v[48:51]
    s_waitcnt lgkmcnt(1)
    ds_read_b128 v[80:83], v5 offset:51200
    buffer_load_dwordx4 v6, s[8:11], s41 offen offset:1536 sc1 lds
    v_mfma_f32_16x16x32_bf16 v[56:59], v[140:143], v[88:91], v[56:59]
    s_add_u32 m0, s43, 51584
    v_add_f32 v20, v20, v21
    v_rcp_f32 v20, v20
    v_mfma_f32_16x16x32_bf16 v[64:67], v[144:147], v[88:91], v[64:67]
    s_waitcnt lgkmcnt(3)
    v_mul_f32 v40, v40, v20
    v_mul_f32 v41, v41, v20
    v_mfma_f32_16x16x32_bf16 v[48:51], v[148:151], v[96:99], v[48:51]
    ds_read_b128 v[88:91], v4 offset:55296
    buffer_load_dwordx4 v6, s[8:11], s41 offen offset:1664 sc1 lds
    v_mfma_f32_16x16x32_bf16 v[56:59], v[152:155], v[96:99], v[56:59]
    s_add_u32 m0, s43, 55552
    v_mul_f32 v42, v42, v20
    v_mul_f32 v43, v43, v20
    v_mfma_f32_16x16x32_bf16 v[64:67], v[156:159], v[96:99], v[64:67]
    s_waitcnt lgkmcnt(2)
    v_cvt_pk_bf16_f32 v28, v40, v41
    v_cvt_pk_bf16_f32 v29, v42, v43
    v_mfma_f32_16x16x32_bf16 v[48:51], v[160:163], v[72:75], v[48:51]
    ds_read_b128 v[96:99], v5 offset:55296
    buffer_load_dwordx4 v6, s[8:11], s41 offen offset:1792 sc1 lds
    v_mfma_f32_16x16x32_bf16 v[56:59], v[164:167], v[72:75], v[56:59]
    s_add_u32 m0, s43, 59520
    v_mul_f32 v118, v118, v20
    v_mul_f32 v119, v119, v20
    v_mfma_f32_16x16x32_bf16 v[64:67], v[168:171], v[72:75], v[64:67]
    s_waitcnt lgkmcnt(2)
    v_mul_f32 v120, v120, v20
    v_mul_f32 v121, v121, v20
    v_mfma_f32_16x16x32_bf16 v[48:51], v[172:175], v[80:83], v[48:51]
    ds_read_b128 v[72:75], v4 offset:59392
    buffer_load_dwordx4 v6, s[8:11], s41 offen offset:1920 sc1 lds
    v_mfma_f32_16x16x32_bf16 v[56:59], v[176:179], v[80:83], v[56:59]
    s_add_u32 m0, s52, 90112
    v_cvt_pk_bf16_f32 v30, v118, v119
    v_cvt_pk_bf16_f32 v31, v120, v121
    v_mfma_f32_16x16x32_bf16 v[64:67], v[180:183], v[80:83], v[64:67]
    s_waitcnt lgkmcnt(2)
    buffer_store_dwordx4 v[28:31], v1, s[16:19], s44 offen sc1
    v_mfma_f32_16x16x32_bf16 v[48:51], v[184:187], v[88:91], v[48:51]
    s_cmp_eq_u32 s36, 17
    ds_read_b128 v[80:83], v5 offset:59392
    buffer_load_dwordx4 v1, s[16:19], s46 offen sc1 lds
    v_mfma_f32_16x16x32_bf16 v[56:59], v[188:191], v[88:91], v[56:59]
    s_cselect_b32 s49, s87, 0x10000
    v_med3_i32 v117, s45, 0, v12
    v_add_u32 v117, v117, v11
    v_mfma_f32_16x16x32_bf16 v[64:67], v[192:195], v[88:91], v[64:67]
    s_waitcnt lgkmcnt(2)
    v_add_f32 v60, v52, v54
    v_add_f32 v61, v53, v55
    v_mfma_f32_16x16x32_bf16 v[48:51], v[196:199], v[96:99], v[48:51]
    s_add_u32 s45, s45, 65536
    ds_read_b128 v[88:91], v4 offset:63488
    buffer_load_dword v116, v117, s[16:19], 0 offen sc1
    v_mfma_f32_16x16x32_bf16 v[56:59], v[200:203], v[96:99], v[56:59]
    buffer_store_dword v124, v124, s[16:19], s39 offen sc1
    v_mfma_f32_16x16x32_bf16 v[64:67], v[204:207], v[96:99], v[64:67]
    s_waitcnt lgkmcnt(2)
    v_add_f32 v44, v44, v46
    v_add_f32 v45, v45, v47
    v_mfma_f32_16x16x32_bf16 v[48:51], v[208:211], v[72:75], v[48:51]
    s_add_u32 s90, s90, s49
    ds_read_b128 v[96:99], v5 offset:63488
    v_add_f32 v44, v44, v60
    v_mfma_f32_16x16x32_bf16 v[56:59], v[212:215], v[72:75], v[56:59]
    s_and_b32 s49, s90, 0xffffffff
    v_add_f32 v45, v45, v61
    v_mov_b32 v60, v44
    v_mfma_f32_16x16x32_bf16 v[64:67], v[216:219], v[72:75], v[64:67]
    s_waitcnt lgkmcnt(2)
    v_mov_b32 v61, v45
    v_permlane32_swap_b32 v44, v60
    v_mfma_f32_16x16x32_bf16 v[48:51], v[220:223], v[80:83], v[48:51]
    s_bitcmp1_b64 s[24:25], s36
    v_permlane32_swap_b32 v45, v61
    v_mfma_f32_16x16x32_bf16 v[56:59], v[224:227], v[80:83], v[56:59]
    s_cselect_b32 s44, s49, 0x5e00000
    v_add_f32 v44, v44, v60
    v_add_f32 v45, v45, v61
    v_mfma_f32_16x16x32_bf16 v[64:67], v[228:231], v[80:83], v[64:67]
    s_waitcnt lgkmcnt(1)
    v_mul_f32 v112, 0xba800000, v44
    v_mul_f32 v45, 0x3a800000, v45
    v_mfma_f32_16x16x32_bf16 v[48:51], v[232:235], v[88:91], v[48:51]
    s_bitcmp1_b64 s[26:27], s36
    v_fma_f32 v45, -v112, v112, v45
    v_mov_b32 v113, v112
    v_mfma_f32_16x16x32_bf16 v[56:59], v[236:239], v[88:91], v[56:59]
    s_cselect_b64 s[62:63], 0, -1
    v_max_f32 v45, 0, v45
    v_add_f32 v45, 0x3727c5ac, v45
    v_mfma_f32_16x16x32_bf16 v[64:67], v[240:243], v[88:91], v[64:67]
    s_waitcnt lgkmcnt(0)
    v_rsq_f32 v114, v45
    v_mfma_f32_16x16x32_bf16 v[48:51], v[244:247], v[96:99], v[48:51]
    s_cmp_eq_u32 s36, s97
    v_permlane16_swap_b32 v112, v113
    v_mfma_f32_16x16x32_bf16 v[56:59], v[248:251], v[96:99], v[56:59]
    s_cselect_b32 s47, 32, -2
    v_mov_b32 v115, v114
    s_cselect_b64 s[8:9], s[88:89], s[8:9]
    v_mfma_f32_16x16x32_bf16 v[64:67], v[252:255], v[96:99], v[64:67]
    s_cselect_b32 s55, 0x543fc00, s55
    v_permlane16_swap_b32 v114, v115
    s_add_u32 s50, s50, s47
    s_max_i32 s47, s50, 0
    s_min_i32 s47, s47, s96
    s_lshl_b32 s41, s47, 15
    s_lshl_b32 s46, s47, 10
    s_sub_u32 s46, s55, s46
    v_fmac_f32 v48, v113, v100
    v_fmac_f32 v49, v113, v101
    v_fmac_f32 v50, v113, v102
    v_fmac_f32 v51, v113, v103
    v_fmac_f32 v56, v113, v104
    v_fmac_f32 v57, v113, v105
    v_fmac_f32 v58, v113, v106
    v_fmac_f32 v59, v113, v107
    v_fmac_f32 v64, v113, v108
    v_fmac_f32 v65, v113, v109
    v_fmac_f32 v66, v113, v110
    v_fmac_f32 v67, v113, v111
    s_waitcnt vmcnt(12)
    s_barrier
    ds_read_b128 v[68:71], v2 offset:0
    ds_read_b128 v[72:75], v2 offset:2048
    ds_read_b128 v[76:79], v3 offset:0
    ds_read_b128 v[80:83], v3 offset:2048
    s_waitcnt lgkmcnt(0)
    s_add_u32 s36, s36, 1
    s_branch L_q_b0
L_spin1:
    s_mov_b32 s40, 0x20000
L_spin1_l:
    buffer_load_dword v37, v36, s[20:23], 0 offen sc1
    s_sub_u32 s40, s40, 1
    s_waitcnt vmcnt(0)
    v_cmp_eq_u32 vcc, v36, v37
    s_cbranch_scc1 L_back2
    s_cbranch_vccz L_back2
    s_sleep 8
    s_branch L_spin1_l
L_spin3:
    s_mov_b32 s40, 0x20000
L_spin3_l:
    buffer_load_dword v116, v117, s[16:19], 0 offen sc1
    s_sub_u32 s40, s40, 1
    s_waitcnt vmcnt(0)
    v_cmp_ne_u32 vcc, 0, v116
    s_cbranch_scc1 L_back4
    s_cbranch_vccz L_back4
    s_sleep 2
    s_branch L_spin3_l
L_spin5:
    s_mov_b32 s40, 0x20000
L_spin5_l:
    buffer_load_dword v116, v117, s[16:19], 0 offen sc1
    s_sub_u32 s40, s40, 1
    s_waitcnt vmcnt(0)
    v_cmp_ne_u32 vcc, 0, v116
    s_cbranch_scc1 L_back6
    s_cbranch_vccz L_back6
    s_sleep 2
    s_branch L_spin5_l
L_spin7:
    s_mov_b32 s40, 0x20000
L_spin7_l:
    buffer_load_dword v116, v117, s[16:19], 0 offen sc1
    s_sub_u32 s40, s40, 1
    s_waitcnt vmcnt(0)
    v_cmp_ne_u32 vcc, 0, v116
    s_cbranch_scc1 L_back8
    s_cbranch_vccz L_back8
    s_sleep 2
    s_branch L_spin7_l
L_other:
    s_lshr_b32 s48, s2, 3
    s_bitcmp1_b32 s2, 0
    s_cbranch_scc1 L_odd
    v_lshrrev_b32 v6, 2, v0
    v_and_b32 v7, 3, v0
    v_lshlrev_b32 v7, 7, v7
    v_lshl_add_u32 v6, v6, 11, v7
    s_and_b32 s48, s48, 15
    s_lshl2_add_u32 s39, s48, s32
    s_lshl_b32 s39, s39, 15
    s_lshl_b32 s37, s47, 9
    s_add_u32 s39, s39, s37
    s_lshr_b32 s37, s48, 2
    s_lshl_b32 s37, s37, 20
    s_and_b32 s38, s48, 3
    s_lshl2_add_u32 s38, s38, s32
    s_lshl_b32 s38, s38, 13
    s_add_u32 s37, s37, s38
    v_lshlrev_b32 v5, 7, v0
    s_waitcnt lgkmcnt(0)
    s_add_u32 s8, s64, 0xe0000
    s_addc_u32 s9, s65, 0
    s_mov_b32 s10, 0x320000
    s_mov_b32 s11, 0x00020000
    buffer_load_dword v251, v5, s[8:11], s37 offen
    s_mov_b32 s12, s66
    s_mov_b32 s13, s67
    s_mov_b32 s14, 0x600000
    s_mov_b32 s15, 0x00020000
    buffer_load_dword v248, v6, s[12:15], s39 offen
    s_add_u32 s39, s39, 2097152
    buffer_load_dword v249, v6, s[12:15], s39 offen
    s_add_u32 s39, s39, 2097152
    buffer_load_dword v250, v6, s[12:15], s39 offen
    s_add_u32 s39, s39, 2097152
    s_mov_b32 s16, s84
    s_mov_b32 s17, s85
    s_mov_b32 s18, 0x5e00000
    s_mov_b32 s19, 0x00020000
    v_min_u32 v124, 1, v0
    v_lshlrev_b32 v124, 30, v124
    s_lshr_b32 s33, s47, 1
    s_lshl_b32 s33, s33, 1
    s_and_b32 s37, s48, 1
    s_add_u32 s33, s33, s37
    s_and_b32 s35, s47, 1
    s_lshl_b32 s35, s35, 3
    s_lshr_b32 s37, s48, 1
    s_add_u32 s35, s35, s37
    s_add_u32 s34, s35, 24
    s_lshl_b32 s91, s33, 6
    s_add_u32 s91, s91, s34
    s_lshl_b32 s91, s91, 7
    s_add_u32 s91, s91, 0x5520000
    s_cmp_eq_u32 s32, 1
    s_cselect_b32 s91, s91, 0x5f00000
    s_mul_i32 s51, s35, 6
    s_min_u32 s51, s51, 106
    s_lshl_b32 s54, s51, 6
    s_mov_b32 s12, s72
    s_mov_b32 s13, s73
    s_mov_b32 s14, 0x700000
    s_mov_b32 s15, 0x00020000
    s_mov_b32 s39, 7168
    v_lshrrev_b32 v68, 3, v0
    v_lshlrev_b32 v69, 2, v0
    v_and_b32 v69, 64, v69
    v_and_b32 v70, 0x70, v1
    v_xor_b32 v69, v69, v70
    v_mad_u32_u24 v56, v68, s39, v69
    v_add_u32 v57, 57344, v56
    v_add_u32 v58, 128, v56
    v_add_u32 v59, 57472, v56
    v_add_u32 v60, 256, v56
    v_add_u32 v61, 57600, v56
    s_mul_i32 s38, s32, 114688
    s_add_u32 s54, s54, s38
    s_lshl_b32 s42, s32, 11
    s_add_u32 m0, s42, 0
    s_nop 0
    buffer_load_dwordx4 v56, s[12:15], s54 offen lds
    s_add_u32 m0, s42, 1024
    s_nop 0
    buffer_load_dwordx4 v57, s[12:15], s54 offen lds
    s_add_u32 m0, s42, 8192
    s_nop 0
    buffer_load_dwordx4 v58, s[12:15], s54 offen lds
    s_add_u32 m0, s42, 9216
    s_nop 0
    buffer_load_dwordx4 v59, s[12:15], s54 offen lds
    s_add_u32 m0, s42, 16384
    s_nop 0
    buffer_load_dwordx4 v60, s[12:15], s54 offen lds
    s_add_u32 m0, s42, 17408
    s_nop 0
    buffer_load_dwordx4 v61, s[12:15], s54 offen lds
    s_add_u32 s54, s54, 458752
    s_add_u32 m0, s42, 24576
    s_nop 0
    buffer_load_dwordx4 v56, s[12:15], s54 offen lds
    s_add_u32 m0, s42, 25600
    s_nop 0
    buffer_load_dwordx4 v57, s[12:15], s54 offen lds
    s_add_u32 m0, s42, 32768
    s_nop 0
    buffer_load_dwordx4 v58, s[12:15], s54 offen lds
    s_add_u32 m0, s42, 33792
    s_nop 0
    buffer_load_dwordx4 v59, s[12:15], s54 offen lds
    s_add_u32 m0, s42, 40960
    s_nop 0
    buffer_load_dwordx4 v60, s[12:15], s54 offen lds
    s_add_u32 m0, s42, 41984
    s_nop 0
    buffer_load_dwordx4 v61, s[12:15], s54 offen lds
    s_add_u32 s54, s54, 458752
    s_add_u32 m0, s42, 49152
    s_nop 0
    buffer_load_dwordx4 v56, s[12:15], s54 offen lds
    s_add_u32 m0, s42, 50176
    s_nop 0
    buffer_load_dwordx4 v57, s[12:15], s54 offen lds
    s_add_u32 m0, s42, 57344
    s_nop 0
    buffer_load_dwordx4 v58, s[12:15], s54 offen lds
    s_add_u32 m0, s42, 58368
    s_nop 0
    buffer_load_dwordx4 v59, s[12:15], s54 offen lds
    s_add_u32 m0, s42, 65536
    s_nop 0
    buffer_load_dwordx4 v60, s[12:15], s54 offen lds
    s_add_u32 m0, s42, 66560
    s_nop 0
    buffer_load_dwordx4 v61, s[12:15], s54 offen lds
    s_add_u32 s54, s54, 458752
    s_add_u32 m0, s42, 73728
    s_nop 0
    buffer_load_dwordx4 v56, s[12:15], s54 offen lds
    s_add_u32 m0, s42, 74752
    s_nop 0
    buffer_load_dwordx4 v57, s[12:15], s54 offen lds
    s_add_u32 m0, s42, 81920
    s_nop 0
    buffer_load_dwordx4 v58, s[12:15], s54 offen lds
    s_add_u32 m0, s42, 82944
    s_nop 0
    buffer_load_dwordx4 v59, s[12:15], s54 offen lds
    s_add_u32 m0, s42, 90112
    s_nop 0
    buffer_load_dwordx4 v60, s[12:15], s54 offen lds
    s_add_u32 m0, s42, 91136
    s_nop 0
    buffer_load_dwordx4 v61, s[12:15], s54 offen lds
    s_add_u32 s54, s54, 458752
    s_add_u32 m0, s42, 98304
    s_nop 0
    buffer_load_dwordx4 v56, s[12:15], s54 offen lds
    s_add_u32 m0, s42, 99328
    s_nop 0
    buffer_load_dwordx4 v57, s[12:15], s54 offen lds
    s_add_u32 m0, s42, 106496
    s_nop 0
    buffer_load_dwordx4 v58, s[12:15], s54 offen lds
    s_add_u32 m0, s42, 107520
    s_nop 0
    buffer_load_dwordx4 v59, s[12:15], s54 offen lds
    s_add_u32 m0, s42, 114688
    s_nop 0
    buffer_load_dwordx4 v60, s[12:15], s54 offen lds
    s_add_u32 m0, s42, 115712
    s_nop 0
    buffer_load_dwordx4 v61, s[12:15], s54 offen lds
    s_add_u32 s54, s54, 458752
    v_lshrrev_b32 v68, 4, v0
    v_bfe_u32 v69, v0, 2, 2
    v_lshl_add_u32 v68, v68, 3, v69
    v_lshlrev_b32 v68, 7, v68
    v_lshrrev_b32 v69, 1, v69
    v_lshl_add_u32 v68, v69, 6, v68
    v_and_b32 v69, 3, v0
    v_lshl_add_u32 v68, v69, 4, v68
    s_lshr_b32 s37, s32, 1
    s_lshl_b32 s37, s37, 13
    s_and_b32 s38, s32, 1
    s_lshl_b32 s38, s38, 6
    s_add_u32 s37, s37, s38
    s_add_u32 s37, s37, 0
    v_xor_b32 v62, s37, v68
    s_lshr_b32 s37, s32, 1
    s_lshl_b32 s37, s37, 13
    s_and_b32 s38, s32, 1
    s_lshl_b32 s38, s38, 6
    s_add_u32 s37, s37, s38
    s_add_u32 s37, s37, 8
    v_xor_b32 v63, s37, v68
    s_lshr_b32 s37, s32, 1
    s_lshl_b32 s37, s37, 6
    s_and_b32 s38, s32, 1
    s_lshl_b32 s38, s38, 3
    s_add_u32 s37, s37, s38
    s_add_u32 s37, s37, 16384
    v_xor_b32 v64, s37, v68
    v_mov_b32 v68, 0x3f803f80
    v_mov_b32 v69, 0x3f803f80
    v_mov_b32 v70, 0x3f803f80
    v_mov_b32 v71, 0x3f803f80
    v_add_u32 v2, 98304, v1
    s_lshl_b32 s37, s33, 6
    s_add_u32 s37, s37, 16
    s_lshl_b32 s37, s37, 7
    v_lshl_add_u32 v5, v0, 7, s37
    s_cmp_eq_u32 s32, 0
    s_cselect_b32 s37, 8, 0
    v_cmp_le_u32 vcc, s37, v0
    s_nop 1
    v_cndmask_b32 v5, v5, 2.0, vcc
    s_lshl_b32 s43, s32, 12
    s_mul_i32 s41, s33, 2097152
    s_add_u32 s41, s41, 0x800000
    s_add_u32 s41, s41, s43
    s_mul_i32 s90, s33, 8388608
    s_add_u32 s90, s90, 0xfc0000
    s_add_u32 s37, s51, s32
    s_lshl_b32 s37, s37, 11
    s_add_u32 s90, s90, s37
    s_lshl_b32 s37, s32, 10
    s_sub_u32 s87, 8192, s37
    s_lshl_b32 s38, s35, 1
    s_lshr_b32 s39, s32, 1
    s_add_u32 s38, s38, s39
    s_cmp_eq_u32 s38, 36
    s_cselect_b32 s88, 0x5e00000, 0
    s_and_b32 s38, s32, 1
    s_lshl_b32 s38, s38, 3
    s_and_b32 s39, s32, 2
    s_lshl_b32 s39, s39, 10
    s_add_u32 s38, s38, s39
    s_add_u32 s38, s38, 65536
    v_add_u32 v3, s38, v1
    s_add_u32 s37, s37, 65536
    v_add_u32 v4, s37, v1
    v_and_b32 v6, 15, v0
    v_lshlrev_b32 v6, 3, v6
    v_lshrrev_b32 v8, 5, v0
    v_lshl_add_u32 v6, v8, 9, v6
    v_and_b32 v8, 16, v0
    v_lshl_add_u32 v6, v8, 6, v6
    v_add_u32 v118, 73728, v6
    s_mul_i32 s46, s33, 65536
    s_add_u32 s46, s46, 0x5440000
    s_add_u32 s55, s46, 63488
    s_and_b32 s52, s32, 1
    s_lshl_b32 s52, s52, 10
    s_mov_b32 s8, s74
    s_mov_b32 s9, s75
    s_mov_b32 s10, 0x1c00
    s_mov_b32 s11, 0x00020000
    v_and_b32 v8, 0x30, v0
    s_add_u32 s37, s51, s32
    s_lshl_b32 s37, s37, 6
    buffer_load_dwordx4 v[16:19], v8, s[8:11], s37 offen
    s_lshr_b32 s37, s32, 1
    s_add_u32 s37, s37, s51
    s_lshl_b32 s37, s37, 6
    s_and_b32 s38, s32, 1
    s_lshl_b32 s38, s38, 3
    s_add_u32 s37, s37, s38
    buffer_load_dwordx2 v[20:21], v8, s[8:11], s37 offen offset:256
    v_add_u32 v65, 0, v62
    v_add_u32 v66, 0, v63
    v_add_u32 v67, 0, v64
    s_waitcnt vmcnt(26)
    s_barrier
    ds_read_b64_tr_b16 a[0:1], v65 offset:0
    ds_read_b64_tr_b16 a[2:3], v65 offset:512
    ds_read_b64_tr_b16 a[4:5], v66 offset:0
    ds_read_b64_tr_b16 a[6:7], v66 offset:512
    ds_read_b64_tr_b16 a[8:9], v67 offset:0
    ds_read_b64_tr_b16 a[10:11], v67 offset:512
    ds_read_b64_tr_b16 a[12:13], v65 offset:4096
    ds_read_b64_tr_b16 a[14:15], v65 offset:4608
    ds_read_b64_tr_b16 a[16:17], v66 offset:4096
    ds_read_b64_tr_b16 a[18:19], v66 offset:4608
    ds_read_b64_tr_b16 a[20:21], v67 offset:4096
    ds_read_b64_tr_b16 a[22:23], v67 offset:4608
    s_add_u32 m0, s42, 122880
    s_nop 0
    buffer_load_dwordx4 v56, s[12:15], s54 offen lds
    s_add_u32 m0, s42, 123904
    s_nop 0
    buffer_load_dwordx4 v57, s[12:15], s54 offen lds
    s_add_u32 m0, s42, 131072
    s_nop 0
    buffer_load_dwordx4 v58, s[12:15], s54 offen lds
    s_add_u32 m0, s42, 132096
    s_nop 0
    buffer_load_dwordx4 v59, s[12:15], s54 offen lds
    s_add_u32 m0, s42, 139264
    s_nop 0
    buffer_load_dwordx4 v60, s[12:15], s54 offen lds
    s_add_u32 m0, s42, 140288
    s_nop 0
    buffer_load_dwordx4 v61, s[12:15], s54 offen lds
    s_add_u32 s54, s54, 458752
    s_waitcnt lgkmcnt(0)
    v_mfma_f32_16x16x32_bf16 v[88:91], a[0:3], v[68:71], 0
    v_mfma_f32_16x16x32_bf16 v[92:95], a[4:7], v[68:71], 0
    v_mfma_f32_16x16x32_bf16 v[96:99], a[8:11], v[68:71], 0
    v_mfma_f32_16x16x32_bf16 v[88:91], a[12:15], v[68:71], v[88:91]
    v_mfma_f32_16x16x32_bf16 v[92:95], a[16:19], v[68:71], v[92:95]
    v_mfma_f32_16x16x32_bf16 v[96:99], a[20:23], v[68:71], v[96:99]
    v_add_u32 v65, 24576, v62
    v_add_u32 v66, 24576, v63
    v_add_u32 v67, 24576, v64
    s_waitcnt vmcnt(26)
    s_barrier
    ds_read_b64_tr_b16 a[24:25], v65 offset:0
    ds_read_b64_tr_b16 a[26:27], v65 offset:512
    ds_read_b64_tr_b16 a[28:29], v66 offset:0
    ds_read_b64_tr_b16 a[30:31], v66 offset:512
    ds_read_b64_tr_b16 a[32:33], v67 offset:0
    ds_read_b64_tr_b16 a[34:35], v67 offset:512
    ds_read_b64_tr_b16 a[36:37], v65 offset:4096
    ds_read_b64_tr_b16 a[38:39], v65 offset:4608
    ds_read_b64_tr_b16 a[40:41], v66 offset:4096
    ds_read_b64_tr_b16 a[42:43], v66 offset:4608
    ds_read_b64_tr_b16 a[44:45], v67 offset:4096
    ds_read_b64_tr_b16 a[46:47], v67 offset:4608
    s_add_u32 m0, s42, 0
    s_nop 0
    buffer_load_dwordx4 v56, s[12:15], s54 offen lds
    s_add_u32 m0, s42, 1024
    s_nop 0
    buffer_load_dwordx4 v57, s[12:15], s54 offen lds
    s_add_u32 m0, s42, 8192
    s_nop 0
    buffer_load_dwordx4 v58, s[12:15], s54 offen lds
    s_add_u32 m0, s42, 9216
    s_nop 0
    buffer_load_dwordx4 v59, s[12:15], s54 offen lds
    s_add_u32 m0, s42, 16384
    s_nop 0
    buffer_load_dwordx4 v60, s[12:15], s54 offen lds
    s_add_u32 m0, s42, 17408
    s_nop 0
    buffer_load_dwordx4 v61, s[12:15], s54 offen lds
    s_add_u32 s54, s54, 458752
    s_waitcnt lgkmcnt(0)
    v_mfma_f32_16x16x32_bf16 v[88:91], a[24:27], v[68:71], v[88:91]
    v_mfma_f32_16x16x32_bf16 v[92:95], a[28:31], v[68:71], v[92:95]
    v_mfma_f32_16x16x32_bf16 v[96:99], a[32:35], v[68:71], v[96:99]
    v_mfma_f32_16x16x32_bf16 v[88:91], a[36:39], v[68:71], v[88:91]
    v_mfma_f32_16x16x32_bf16 v[92:95], a[40:43], v[68:71], v[92:95]
    v_mfma_f32_16x16x32_bf16 v[96:99], a[44:47], v[68:71], v[96:99]
    v_add_u32 v65, 49152, v62
    v_add_u32 v66, 49152, v63
    v_add_u32 v67, 49152, v64
    s_waitcnt vmcnt(26)
    s_barrier
    ds_read_b64_tr_b16 a[48:49], v65 offset:0
    ds_read_b64_tr_b16 a[50:51], v65 offset:512
    ds_read_b64_tr_b16 a[52:53], v66 offset:0
    ds_read_b64_tr_b16 a[54:55], v66 offset:512
    ds_read_b64_tr_b16 a[56:57], v67 offset:0
    ds_read_b64_tr_b16 a[58:59], v67 offset:512
    ds_read_b64_tr_b16 a[60:61], v65 offset:4096
    ds_read_b64_tr_b16 a[62:63], v65 offset:4608
    ds_read_b64_tr_b16 a[64:65], v66 offset:4096
    ds_read_b64_tr_b16 a[66:67], v66 offset:4608
    ds_read_b64_tr_b16 a[68:69], v67 offset:4096
    ds_read_b64_tr_b16 a[70:71], v67 offset:4608
    s_add_u32 m0, s42, 24576
    s_nop 0
    buffer_load_dwordx4 v56, s[12:15], s54 offen lds
    s_add_u32 m0, s42, 25600
    s_nop 0
    buffer_load_dwordx4 v57, s[12:15], s54 offen lds
    s_add_u32 m0, s42, 32768
    s_nop 0
    buffer_load_dwordx4 v58, s[12:15], s54 offen lds
    s_add_u32 m0, s42, 33792
    s_nop 0
    buffer_load_dwordx4 v59, s[12:15], s54 offen lds
    s_add_u32 m0, s42, 40960
    s_nop 0
    buffer_load_dwordx4 v60, s[12:15], s54 offen lds
    s_add_u32 m0, s42, 41984
    s_nop 0
    buffer_load_dwordx4 v61, s[12:15], s54 offen lds
    s_add_u32 s54, s54, 458752
    s_waitcnt lgkmcnt(0)
    v_mfma_f32_16x16x32_bf16 v[88:91], a[48:51], v[68:71], v[88:91]
    v_mfma_f32_16x16x32_bf16 v[92:95], a[52:55], v[68:71], v[92:95]
    v_mfma_f32_16x16x32_bf16 v[96:99], a[56:59], v[68:71], v[96:99]
    v_mfma_f32_16x16x32_bf16 v[88:91], a[60:63], v[68:71], v[88:91]
    v_mfma_f32_16x16x32_bf16 v[92:95], a[64:67], v[68:71], v[92:95]
    v_mfma_f32_16x16x32_bf16 v[96:99], a[68:71], v[68:71], v[96:99]
    v_add_u32 v65, 73728, v62
    v_add_u32 v66, 73728, v63
    v_add_u32 v67, 73728, v64
    s_waitcnt vmcnt(26)
    s_barrier
    ds_read_b64_tr_b16 a[72:73], v65 offset:0
    ds_read_b64_tr_b16 a[74:75], v65 offset:512
    ds_read_b64_tr_b16 a[76:77], v66 offset:0
    ds_read_b64_tr_b16 a[78:79], v66 offset:512
    ds_read_b64_tr_b16 a[80:81], v67 offset:0
    ds_read_b64_tr_b16 a[82:83], v67 offset:512
    ds_read_b64_tr_b16 a[84:85], v65 offset:4096
    ds_read_b64_tr_b16 a[86:87], v65 offset:4608
    ds_read_b64_tr_b16 a[88:89], v66 offset:4096
    ds_read_b64_tr_b16 a[90:91], v66 offset:4608
    ds_read_b64_tr_b16 a[92:93], v67 offset:4096
    ds_read_b64_tr_b16 a[94:95], v67 offset:4608
    s_add_u32 m0, s42, 49152
    s_nop 0
    buffer_load_dwordx4 v56, s[12:15], s54 offen lds
    s_add_u32 m0, s42, 50176
    s_nop 0
    buffer_load_dwordx4 v57, s[12:15], s54 offen lds
    s_add_u32 m0, s42, 57344
    s_nop 0
    buffer_load_dwordx4 v58, s[12:15], s54 offen lds
    s_add_u32 m0, s42, 58368
    s_nop 0
    buffer_load_dwordx4 v59, s[12:15], s54 offen lds
    s_add_u32 m0, s42, 65536
    s_nop 0
    buffer_load_dwordx4 v60, s[12:15], s54 offen lds
    s_add_u32 m0, s42, 66560
    s_nop 0
    buffer_load_dwordx4 v61, s[12:15], s54 offen lds
    s_add_u32 s54, s54, 458752
    s_waitcnt lgkmcnt(0)
    v_mfma_f32_16x16x32_bf16 v[88:91], a[72:75], v[68:71], v[88:91]
    v_mfma_f32_16x16x32_bf16 v[92:95], a[76:79], v[68:71], v[92:95]
    v_mfma_f32_16x16x32_bf16 v[96:99], a[80:83], v[68:71], v[96:99]
    v_mfma_f32_16x16x32_bf16 v[88:91], a[84:87], v[68:71], v[88:91]
    v_mfma_f32_16x16x32_bf16 v[92:95], a[88:91], v[68:71], v[92:95]
    v_mfma_f32_16x16x32_bf16 v[96:99], a[92:95], v[68:71], v[96:99]
    v_add_u32 v65, 98304, v62
    v_add_u32 v66, 98304, v63
    v_add_u32 v67, 98304, v64
    s_waitcnt vmcnt(26)
    s_barrier
    ds_read_b64_tr_b16 a[96:97], v65 offset:0
    ds_read_b64_tr_b16 a[98:99], v65 offset:512
    ds_read_b64_tr_b16 a[100:101], v66 offset:0
    ds_read_b64_tr_b16 a[102:103], v66 offset:512
    ds_read_b64_tr_b16 a[104:105], v67 offset:0
    ds_read_b64_tr_b16 a[106:107], v67 offset:512
    ds_read_b64_tr_b16 a[108:109], v65 offset:4096
    ds_read_b64_tr_b16 a[110:111], v65 offset:4608
    ds_read_b64_tr_b16 a[112:113], v66 offset:4096
    ds_read_b64_tr_b16 a[114:115], v66 offset:4608
    ds_read_b64_tr_b16 a[116:117], v67 offset:4096
    ds_read_b64_tr_b16 a[118:119], v67 offset:4608
    s_add_u32 m0, s42, 73728
    s_nop 0
    buffer_load_dwordx4 v56, s[12:15], s54 offen lds
    s_add_u32 m0, s42, 74752
    s_nop 0
    buffer_load_dwordx4 v57, s[12:15], s54 offen lds
    s_add_u32 m0, s42, 81920
    s_nop 0
    buffer_load_dwordx4 v58, s[12:15], s54 offen lds
    s_add_u32 m0, s42, 82944
    s_nop 0
    buffer_load_dwordx4 v59, s[12:15], s54 offen lds
    s_add_u32 m0, s42, 90112
    s_nop 0
    buffer_load_dwordx4 v60, s[12:15], s54 offen lds
    s_add_u32 m0, s42, 91136
    s_nop 0
    buffer_load_dwordx4 v61, s[12:15], s54 offen lds
    s_add_u32 s54, s54, 458752
    s_waitcnt lgkmcnt(0)
    v_mfma_f32_16x16x32_bf16 v[88:91], a[96:99], v[68:71], v[88:91]
    v_mfma_f32_16x16x32_bf16 v[92:95], a[100:103], v[68:71], v[92:95]
    v_mfma_f32_16x16x32_bf16 v[96:99], a[104:107], v[68:71], v[96:99]
    v_mfma_f32_16x16x32_bf16 v[88:91], a[108:111], v[68:71], v[88:91]
    v_mfma_f32_16x16x32_bf16 v[92:95], a[112:115], v[68:71], v[92:95]
    v_mfma_f32_16x16x32_bf16 v[96:99], a[116:119], v[68:71], v[96:99]
    v_add_u32 v65, 122880, v62
    v_add_u32 v66, 122880, v63
    v_add_u32 v67, 122880, v64
    s_waitcnt vmcnt(24)
    s_barrier
    ds_read_b64_tr_b16 a[120:121], v65 offset:0
    ds_read_b64_tr_b16 a[122:123], v65 offset:512
    ds_read_b64_tr_b16 a[124:125], v66 offset:0
    ds_read_b64_tr_b16 a[126:127], v66 offset:512
    ds_read_b64_tr_b16 a[128:129], v67 offset:0
    ds_read_b64_tr_b16 a[130:131], v67 offset:512
    ds_read_b64_tr_b16 a[132:133], v65 offset:4096
    ds_read_b64_tr_b16 a[134:135], v65 offset:4608
    ds_read_b64_tr_b16 a[136:137], v66 offset:4096
    ds_read_b64_tr_b16 a[138:139], v66 offset:4608
    ds_read_b64_tr_b16 a[140:141], v67 offset:4096
    ds_read_b64_tr_b16 a[142:143], v67 offset:4608
    s_add_u32 m0, s42, 98304
    s_nop 0
    buffer_load_dwordx4 v56, s[12:15], s54 offen lds
    s_add_u32 m0, s42, 99328
    s_nop 0
    buffer_load_dwordx4 v57, s[12:15], s54 offen lds
    s_add_u32 m0, s42, 106496
    s_nop 0
    buffer_load_dwordx4 v58, s[12:15], s54 offen lds
    s_add_u32 m0, s42, 107520
    s_nop 0
    buffer_load_dwordx4 v59, s[12:15], s54 offen lds
    s_add_u32 m0, s42, 114688
    s_nop 0
    buffer_load_dwordx4 v60, s[12:15], s54 offen lds
    s_add_u32 m0, s42, 115712
    s_nop 0
    buffer_load_dwordx4 v61, s[12:15], s54 offen lds
    s_add_u32 s54, s54, 458752
    s_waitcnt lgkmcnt(0)
    v_mfma_f32_16x16x32_bf16 v[88:91], a[120:123], v[68:71], v[88:91]
    v_mfma_f32_16x16x32_bf16 v[92:95], a[124:127], v[68:71], v[92:95]
    v_mfma_f32_16x16x32_bf16 v[96:99], a[128:131], v[68:71], v[96:99]
    v_mfma_f32_16x16x32_bf16 v[88:91], a[132:135], v[68:71], v[88:91]
    v_mfma_f32_16x16x32_bf16 v[92:95], a[136:139], v[68:71], v[92:95]
    v_mfma_f32_16x16x32_bf16 v[96:99], a[140:143], v[68:71], v[96:99]
    v_add_u32 v65, 0, v62
    v_add_u32 v66, 0, v63
    v_add_u32 v67, 0, v64
    s_waitcnt vmcnt(24)
    s_barrier
    ds_read_b64_tr_b16 a[144:145], v65 offset:0
    ds_read_b64_tr_b16 a[146:147], v65 offset:512
    ds_read_b64_tr_b16 a[148:149], v66 offset:0
    ds_read_b64_tr_b16 a[150:151], v66 offset:512
    ds_read_b64_tr_b16 a[152:153], v67 offset:0
    ds_read_b64_tr_b16 a[154:155], v67 offset:512
    ds_read_b64_tr_b16 a[156:157], v65 offset:4096
    ds_read_b64_tr_b16 a[158:159], v65 offset:4608
    ds_read_b64_tr_b16 a[160:161], v66 offset:4096
    ds_read_b64_tr_b16 a[162:163], v66 offset:4608
    ds_read_b64_tr_b16 a[164:165], v67 offset:4096
    ds_read_b64_tr_b16 a[166:167], v67 offset:4608
    s_add_u32 m0, s42, 122880
    s_nop 0
    buffer_load_dwordx4 v56, s[12:15], s54 offen lds
    s_add_u32 m0, s42, 123904
    s_nop 0
    buffer_load_dwordx4 v57, s[12:15], s54 offen lds
    s_add_u32 m0, s42, 131072
    s_nop 0
    buffer_load_dwordx4 v58, s[12:15], s54 offen lds
    s_add_u32 m0, s42, 132096
    s_nop 0
    buffer_load_dwordx4 v59, s[12:15], s54 offen lds
    s_add_u32 m0, s42, 139264
    s_nop 0
    buffer_load_dwordx4 v60, s[12:15], s54 offen lds
    s_add_u32 m0, s42, 140288
    s_nop 0
    buffer_load_dwordx4 v61, s[12:15], s54 offen lds
    s_add_u32 s54, s54, 458752
    s_waitcnt lgkmcnt(0)
    v_mfma_f32_16x16x32_bf16 v[88:91], a[144:147], v[68:71], v[88:91]
    v_mfma_f32_16x16x32_bf16 v[92:95], a[148:151], v[68:71], v[92:95]
    v_mfma_f32_16x16x32_bf16 v[96:99], a[152:155], v[68:71], v[96:99]
    v_mfma_f32_16x16x32_bf16 v[88:91], a[156:159], v[68:71], v[88:91]
    v_mfma_f32_16x16x32_bf16 v[92:95], a[160:163], v[68:71], v[92:95]
    v_mfma_f32_16x16x32_bf16 v[96:99], a[164:167], v[68:71], v[96:99]
    v_add_u32 v65, 24576, v62
    v_add_u32 v66, 24576, v63
    v_add_u32 v67, 24576, v64
    s_waitcnt vmcnt(24)
    s_barrier
    ds_read_b64_tr_b16 a[168:169], v65 offset:0
    ds_read_b64_tr_b16 a[170:171], v65 offset:512
    ds_read_b64_tr_b16 a[172:173], v66 offset:0
    ds_read_b64_tr_b16 a[174:175], v66 offset:512
    ds_read_b64_tr_b16 a[176:177], v67 offset:0
    ds_read_b64_tr_b16 a[178:179], v67 offset:512
    ds_read_b64_tr_b16 a[180:181], v65 offset:4096
    ds_read_b64_tr_b16 a[182:183], v65 offset:4608
    ds_read_b64_tr_b16 a[184:185], v66 offset:4096
    ds_read_b64_tr_b16 a[186:187], v66 offset:4608
    ds_read_b64_tr_b16 a[188:189], v67 offset:4096
    ds_read_b64_tr_b16 a[190:191], v67 offset:4608
    s_add_u32 m0, s42, 0
    s_nop 0
    buffer_load_dwordx4 v56, s[12:15], s54 offen lds
    s_add_u32 m0, s42, 1024
    s_nop 0
    buffer_load_dwordx4 v57, s[12:15], s54 offen lds
    s_add_u32 m0, s42, 8192
    s_nop 0
    buffer_load_dwordx4 v58, s[12:15], s54 offen lds
    s_add_u32 m0, s42, 9216
    s_nop 0
    buffer_load_dwordx4 v59, s[12:15], s54 offen lds
    s_add_u32 m0, s42, 16384
    s_nop 0
    buffer_load_dwordx4 v60, s[12:15], s54 offen lds
    s_add_u32 m0, s42, 17408
    s_nop 0
    buffer_load_dwordx4 v61, s[12:15], s54 offen lds
    s_add_u32 s54, s54, 458752
    s_waitcnt lgkmcnt(0)
    v_mfma_f32_16x16x32_bf16 v[88:91], a[168:171], v[68:71], v[88:91]
    v_mfma_f32_16x16x32_bf16 v[92:95], a[172:175], v[68:71], v[92:95]
    v_mfma_f32_16x16x32_bf16 v[96:99], a[176:179], v[68:71], v[96:99]
    v_mfma_f32_16x16x32_bf16 v[88:91], a[180:183], v[68:71], v[88:91]
    v_mfma_f32_16x16x32_bf16 v[92:95], a[184:187], v[68:71], v[92:95]
    v_mfma_f32_16x16x32_bf16 v[96:99], a[188:191], v[68:71], v[96:99]
    v_add_u32 v65, 49152, v62
    v_add_u32 v66, 49152, v63
    v_add_u32 v67, 49152, v64
    s_waitcnt vmcnt(24)
    s_barrier
    ds_read_b64_tr_b16 a[192:193], v65 offset:0
    ds_read_b64_tr_b16 a[194:195], v65 offset:512
    ds_read_b64_tr_b16 a[196:197], v66 offset:0
    ds_read_b64_tr_b16 a[198:199], v66 offset:512
    ds_read_b64_tr_b16 a[200:201], v67 offset:0
    ds_read_b64_tr_b16 a[202:203], v67 offset:512
    ds_read_b64_tr_b16 a[204:205], v65 offset:4096
    ds_read_b64_tr_b16 a[206:207], v65 offset:4608
    ds_read_b64_tr_b16 a[208:209], v66 offset:4096
    ds_read_b64_tr_b16 a[210:211], v66 offset:4608
    ds_read_b64_tr_b16 a[212:213], v67 offset:4096
    ds_read_b64_tr_b16 a[214:215], v67 offset:4608
    s_add_u32 m0, s42, 24576
    s_nop 0
    buffer_load_dwordx4 v56, s[12:15], s54 offen lds
    s_add_u32 m0, s42, 25600
    s_nop 0
    buffer_load_dwordx4 v57, s[12:15], s54 offen lds
    s_add_u32 m0, s42, 32768
    s_nop 0
    buffer_load_dwordx4 v58, s[12:15], s54 offen lds
    s_add_u32 m0, s42, 33792
    s_nop 0
    buffer_load_dwordx4 v59, s[12:15], s54 offen lds
    s_add_u32 m0, s42, 40960
    s_nop 0
    buffer_load_dwordx4 v60, s[12:15], s54 offen lds
    s_add_u32 m0, s42, 41984
    s_nop 0
    buffer_load_dwordx4 v61, s[12:15], s54 offen lds
    s_add_u32 s54, s54, 458752
    s_waitcnt lgkmcnt(0)
    v_mfma_f32_16x16x32_bf16 v[88:91], a[192:195], v[68:71], v[88:91]
    v_mfma_f32_16x16x32_bf16 v[92:95], a[196:199], v[68:71], v[92:95]
    v_mfma_f32_16x16x32_bf16 v[96:99], a[200:203], v[68:71], v[96:99]
    v_mfma_f32_16x16x32_bf16 v[88:91], a[204:207], v[68:71], v[88:91]
    v_mfma_f32_16x16x32_bf16 v[92:95], a[208:211], v[68:71], v[92:95]
    v_mfma_f32_16x16x32_bf16 v[96:99], a[212:215], v[68:71], v[96:99]
    v_add_u32 v65, 73728, v62
    v_add_u32 v66, 73728, v63
    v_add_u32 v67, 73728, v64
    s_waitcnt vmcnt(24)
    s_barrier
    ds_read_b64_tr_b16 a[216:217], v65 offset:0
    ds_read_b64_tr_b16 a[218:219], v65 offset:512
    ds_read_b64_tr_b16 a[220:221], v66 offset:0
    ds_read_b64_tr_b16 a[222:223], v66 offset:512
    ds_read_b64_tr_b16 a[224:225], v67 offset:0
    ds_read_b64_tr_b16 a[226:227], v67 offset:512
    ds_read_b64_tr_b16 a[228:229], v65 offset:4096
    ds_read_b64_tr_b16 a[230:231], v65 offset:4608
    ds_read_b64_tr_b16 a[232:233], v66 offset:4096
    ds_read_b64_tr_b16 a[234:235], v66 offset:4608
    ds_read_b64_tr_b16 a[236:237], v67 offset:4096
    ds_read_b64_tr_b16 a[238:239], v67 offset:4608
    s_add_u32 m0, s42, 49152
    s_nop 0
    buffer_load_dwordx4 v56, s[12:15], s54 offen lds
    s_add_u32 m0, s42, 50176
    s_nop 0
    buffer_load_dwordx4 v57, s[12:15], s54 offen lds
    s_add_u32 m0, s42, 57344
    s_nop 0
    buffer_load_dwordx4 v58, s[12:15], s54 offen lds
    s_add_u32 m0, s42, 58368
    s_nop 0
    buffer_load_dwordx4 v59, s[12:15], s54 offen lds
    s_add_u32 m0, s42, 65536
    s_nop 0
    buffer_load_dwordx4 v60, s[12:15], s54 offen lds
    s_add_u32 m0, s42, 66560
    s_nop 0
    buffer_load_dwordx4 v61, s[12:15], s54 offen lds
    s_add_u32 s54, s54, 458752
    s_waitcnt lgkmcnt(0)
    v_mfma_f32_16x16x32_bf16 v[88:91], a[216:219], v[68:71], v[88:91]
    v_mfma_f32_16x16x32_bf16 v[92:95], a[220:223], v[68:71], v[92:95]
    v_mfma_f32_16x16x32_bf16 v[96:99], a[224:227], v[68:71], v[96:99]
    v_mfma_f32_16x16x32_bf16 v[88:91], a[228:231], v[68:71], v[88:91]
    v_mfma_f32_16x16x32_bf16 v[92:95], a[232:235], v[68:71], v[92:95]
    v_mfma_f32_16x16x32_bf16 v[96:99], a[236:239], v[68:71], v[96:99]
    v_add_u32 v65, 98304, v62
    v_add_u32 v66, 98304, v63
    v_add_u32 v67, 98304, v64
    s_waitcnt vmcnt(24)
    s_barrier
    ds_read_b64_tr_b16 a[240:241], v65 offset:0
    ds_read_b64_tr_b16 a[242:243], v65 offset:512
    ds_read_b64_tr_b16 a[244:245], v66 offset:0
    ds_read_b64_tr_b16 a[246:247], v66 offset:512
    ds_read_b64_tr_b16 a[248:249], v67 offset:0
    ds_read_b64_tr_b16 a[250:251], v67 offset:512
    ds_read_b64_tr_b16 a[252:253], v65 offset:4096
    ds_read_b64_tr_b16 a[254:255], v65 offset:4608
    ds_read_b64_tr_b16 v[128:129], v66 offset:4096
    ds_read_b64_tr_b16 v[130:131], v66 offset:4608
    ds_read_b64_tr_b16 v[132:133], v67 offset:4096
    ds_read_b64_tr_b16 v[134:135], v67 offset:4608
    s_add_u32 m0, s42, 73728
    s_nop 0
    buffer_load_dwordx4 v56, s[12:15], s54 offen lds
    s_add_u32 m0, s42, 74752
    s_nop 0
    buffer_load_dwordx4 v57, s[12:15], s54 offen lds
    s_add_u32 m0, s42, 81920
    s_nop 0
    buffer_load_dwordx4 v58, s[12:15], s54 offen lds
    s_add_u32 m0, s42, 82944
    s_nop 0
    buffer_load_dwordx4 v59, s[12:15], s54 offen lds
    s_add_u32 m0, s42, 90112
    s_nop 0
    buffer_load_dwordx4 v60, s[12:15], s54 offen lds
    s_add_u32 m0, s42, 91136
    s_nop 0
    buffer_load_dwordx4 v61, s[12:15], s54 offen lds
    s_add_u32 s54, s54, 458752
    s_waitcnt lgkmcnt(0)
    v_mfma_f32_16x16x32_bf16 v[88:91], a[240:243], v[68:71], v[88:91]
    v_mfma_f32_16x16x32_bf16 v[92:95], a[244:247], v[68:71], v[92:95]
    v_mfma_f32_16x16x32_bf16 v[96:99], a[248:251], v[68:71], v[96:99]
    v_mfma_f32_16x16x32_bf16 v[88:91], a[252:255], v[68:71], v[88:91]
    v_mfma_f32_16x16x32_bf16 v[92:95], v[128:131], v[68:71], v[92:95]
    v_mfma_f32_16x16x32_bf16 v[96:99], v[132:135], v[68:71], v[96:99]
    v_add_u32 v65, 122880, v62
    v_add_u32 v66, 122880, v63
    v_add_u32 v67, 122880, v64
    s_waitcnt vmcnt(24)
    s_barrier
    ds_read_b64_tr_b16 v[136:137], v65 offset:0
    ds_read_b64_tr_b16 v[138:139], v65 offset:512
    ds_read_b64_tr_b16 v[140:141], v66 offset:0
    ds_read_b64_tr_b16 v[142:143], v66 offset:512
    ds_read_b64_tr_b16 v[144:145], v67 offset:0
    ds_read_b64_tr_b16 v[146:147], v67 offset:512
    ds_read_b64_tr_b16 v[148:149], v65 offset:4096
    ds_read_b64_tr_b16 v[150:151], v65 offset:4608
    ds_read_b64_tr_b16 v[152:153], v66 offset:4096
    ds_read_b64_tr_b16 v[154:155], v66 offset:4608
    ds_read_b64_tr_b16 v[156:157], v67 offset:4096
    ds_read_b64_tr_b16 v[158:159], v67 offset:4608
    s_waitcnt lgkmcnt(0)
    v_mfma_f32_16x16x32_bf16 v[88:91], v[136:139], v[68:71], v[88:91]
    v_mfma_f32_16x16x32_bf16 v[92:95], v[140:143], v[68:71], v[92:95]
    v_mfma_f32_16x16x32_bf16 v[96:99], v[144:147], v[68:71], v[96:99]
    v_mfma_f32_16x16x32_bf16 v[88:91], v[148:151], v[68:71], v[88:91]
    v_mfma_f32_16x16x32_bf16 v[92:95], v[152:155], v[68:71], v[92:95]
    v_mfma_f32_16x16x32_bf16 v[96:99], v[156:159], v[68:71], v[96:99]
    v_add_u32 v65, 0, v62
    v_add_u32 v66, 0, v63
    v_add_u32 v67, 0, v64
    s_waitcnt vmcnt(18)
    s_barrier
    ds_read_b64_tr_b16 v[160:161], v65 offset:0
    ds_read_b64_tr_b16 v[162:163], v65 offset:512
    ds_read_b64_tr_b16 v[164:165], v66 offset:0
    ds_read_b64_tr_b16 v[166:167], v66 offset:512
    ds_read_b64_tr_b16 v[168:169], v67 offset:0
    ds_read_b64_tr_b16 v[170:171], v67 offset:512
    ds_read_b64_tr_b16 v[172:173], v65 offset:4096
    ds_read_b64_tr_b16 v[174:175], v65 offset:4608
    ds_read_b64_tr_b16 v[176:177], v66 offset:4096
    ds_read_b64_tr_b16 v[178:179], v66 offset:4608
    ds_read_b64_tr_b16 v[180:181], v67 offset:4096
    ds_read_b64_tr_b16 v[182:183], v67 offset:4608
    s_waitcnt lgkmcnt(0)
    v_mfma_f32_16x16x32_bf16 v[88:91], v[160:163], v[68:71], v[88:91]
    v_mfma_f32_16x16x32_bf16 v[92:95], v[164:167], v[68:71], v[92:95]
    v_mfma_f32_16x16x32_bf16 v[96:99], v[168:171], v[68:71], v[96:99]
    v_mfma_f32_16x16x32_bf16 v[88:91], v[172:175], v[68:71], v[88:91]
    v_mfma_f32_16x16x32_bf16 v[92:95], v[176:179], v[68:71], v[92:95]
    v_mfma_f32_16x16x32_bf16 v[96:99], v[180:183], v[68:71], v[96:99]
    v_add_u32 v65, 24576, v62
    v_add_u32 v66, 24576, v63
    v_add_u32 v67, 24576, v64
    s_waitcnt vmcnt(12)
    s_barrier
    ds_read_b64_tr_b16 v[184:185], v65 offset:0
    ds_read_b64_tr_b16 v[186:187], v65 offset:512
    ds_read_b64_tr_b16 v[188:189], v66 offset:0
    ds_read_b64_tr_b16 v[190:191], v66 offset:512
    ds_read_b64_tr_b16 v[192:193], v67 offset:0
    ds_read_b64_tr_b16 v[194:195], v67 offset:512
    ds_read_b64_tr_b16 v[196:197], v65 offset:4096
    ds_read_b64_tr_b16 v[198:199], v65 offset:4608
    ds_read_b64_tr_b16 v[200:201], v66 offset:4096
    ds_read_b64_tr_b16 v[202:203], v66 offset:4608
    ds_read_b64_tr_b16 v[204:205], v67 offset:4096
    ds_read_b64_tr_b16 v[206:207], v67 offset:4608
    s_waitcnt lgkmcnt(0)
    v_mfma_f32_16x16x32_bf16 v[88:91], v[184:187], v[68:71], v[88:91]
    v_mfma_f32_16x16x32_bf16 v[92:95], v[188:191], v[68:71], v[92:95]
    v_mfma_f32_16x16x32_bf16 v[96:99], v[192:195], v[68:71], v[96:99]
    v_mfma_f32_16x16x32_bf16 v[88:91], v[196:199], v[68:71], v[88:91]
    v_mfma_f32_16x16x32_bf16 v[92:95], v[200:203], v[68:71], v[92:95]
    v_mfma_f32_16x16x32_bf16 v[96:99], v[204:207], v[68:71], v[96:99]
    v_add_u32 v65, 49152, v62
    v_add_u32 v66, 49152, v63
    v_add_u32 v67, 49152, v64
    s_waitcnt vmcnt(6)
    s_barrier
    ds_read_b64_tr_b16 v[208:209], v65 offset:0
    ds_read_b64_tr_b16 v[210:211], v65 offset:512
    ds_read_b64_tr_b16 v[212:213], v66 offset:0
    ds_read_b64_tr_b16 v[214:215], v66 offset:512
    ds_read_b64_tr_b16 v[216:217], v67 offset:0
    ds_read_b64_tr_b16 v[218:219], v67 offset:512
    ds_read_b64_tr_b16 v[220:221], v65 offset:4096
    ds_read_b64_tr_b16 v[222:223], v65 offset:4608
    ds_read_b64_tr_b16 v[224:225], v66 offset:4096
    ds_read_b64_tr_b16 v[226:227], v66 offset:4608
    ds_read_b64_tr_b16 v[228:229], v67 offset:4096
    ds_read_b64_tr_b16 v[230:231], v67 offset:4608
    s_waitcnt lgkmcnt(0)
    v_mfma_f32_16x16x32_bf16 v[88:91], v[208:211], v[68:71], v[88:91]
    v_mfma_f32_16x16x32_bf16 v[92:95], v[212:215], v[68:71], v[92:95]
    v_mfma_f32_16x16x32_bf16 v[96:99], v[216:219], v[68:71], v[96:99]
    v_mfma_f32_16x16x32_bf16 v[88:91], v[220:223], v[68:71], v[88:91]
    v_mfma_f32_16x16x32_bf16 v[92:95], v[224:227], v[68:71], v[92:95]
    v_mfma_f32_16x16x32_bf16 v[96:99], v[228:231], v[68:71], v[96:99]
    v_add_u32 v65, 73728, v62
    v_add_u32 v66, 73728, v63
    v_add_u32 v67, 73728, v64
    s_waitcnt vmcnt(0)
    s_barrier
    ds_read_b64_tr_b16 v[232:233], v65 offset:0
    ds_read_b64_tr_b16 v[234:235], v65 offset:512
    ds_read_b64_tr_b16 v[236:237], v66 offset:0
    ds_read_b64_tr_b16 v[238:239], v66 offset:512
    ds_read_b64_tr_b16 v[240:241], v67 offset:0
    ds_read_b64_tr_b16 v[242:243], v67 offset:512
    ds_read_b64_tr_b16 v[244:245], v65 offset:4096
    ds_read_b64_tr_b16 v[246:247], v65 offset:4608
    ds_read_b64_tr_b16 v[248:249], v66 offset:4096
    ds_read_b64_tr_b16 v[250:251], v66 offset:4608
    ds_read_b64_tr_b16 v[252:253], v67 offset:4096
    ds_read_b64_tr_b16 v[254:255], v67 offset:4608
    s_waitcnt lgkmcnt(0)
    v_mfma_f32_16x16x32_bf16 v[88:91], v[232:235], v[68:71], v[88:91]
    v_mfma_f32_16x16x32_bf16 v[92:95], v[236:239], v[68:71], v[92:95]
    v_mfma_f32_16x16x32_bf16 v[96:99], v[240:243], v[68:71], v[96:99]
    v_mfma_f32_16x16x32_bf16 v[88:91], v[244:247], v[68:71], v[88:91]
    v_mfma_f32_16x16x32_bf16 v[92:95], v[248:251], v[68:71], v[92:95]
    v_mfma_f32_16x16x32_bf16 v[96:99], v[252:255], v[68:71], v[96:99]
    s_barrier
    s_mov_b32 s37, 0xffff0000
    v_lshlrev_b32 v100, 16, v16
    v_and_b32 v101, s37, v16
    v_lshlrev_b32 v102, 16, v17
    v_and_b32 v103, s37, v17
    v_lshlrev_b32 v104, 16, v18
    v_and_b32 v105, s37, v18
    v_lshlrev_b32 v106, 16, v19
    v_and_b32 v107, s37, v19
    v_lshlrev_b32 v108, 16, v20
    v_and_b32 v109, s37, v20
    v_lshlrev_b32 v110, 16, v21
    v_and_b32 v111, s37, v21
    s_cmp_lg_u32 s32, 0
    s_cbranch_scc1 L_arv9
    s_add_u32 s20, s82, 0x80
    s_addc_u32 s21, s83, 0
    s_mov_b32 s22, 0x4
    s_mov_b32 s23, 0x00020000
    buffer_load_dword v56, v124, s[20:23], 0 offen sc1
    s_waitcnt vmcnt(0)
    v_cmp_eq_u32 vcc, v124, v56
    s_cbranch_vccnz L_spin10
L_back11:
L_arv9:
    s_add_u32 s96, s41, 2031616
    s_mov_b32 s98, s41
    s_mov_b32 s45, 0x5530000
    buffer_load_dword v7, v5, s[16:19], s45 offen sc1
    s_waitcnt vmcnt(0)
    v_cmp_ne_u32 vcc, 0, v7
    s_cbranch_vccnz L_spin12
L_back13:
    s_barrier
    s_add_u32 m0, s43, 0
    s_add_u32 s42, s41, 0
    buffer_load_dwordx4 v1, s[16:19], s42 offen offset:0 sc1 lds
    buffer_load_dwordx4 v1, s[16:19], s42 offen offset:1024 sc1 lds
    buffer_load_dwordx4 v1, s[16:19], s42 offen offset:2048 sc1 lds
    buffer_load_dwordx4 v1, s[16:19], s42 offen offset:3072 sc1 lds
    s_add_u32 m0, s43, 16384
    s_add_u32 s42, s41, 16384
    buffer_load_dwordx4 v1, s[16:19], s42 offen offset:0 sc1 lds
    buffer_load_dwordx4 v1, s[16:19], s42 offen offset:1024 sc1 lds
    buffer_load_dwordx4 v1, s[16:19], s42 offen offset:2048 sc1 lds
    buffer_load_dwordx4 v1, s[16:19], s42 offen offset:3072 sc1 lds
    s_add_u32 m0, s43, 32768
    s_add_u32 s42, s41, 32768
    buffer_load_dwordx4 v1, s[16:19], s42 offen offset:0 sc1 lds
    buffer_load_dwordx4 v1, s[16:19], s42 offen offset:1024 sc1 lds
    buffer_load_dwordx4 v1, s[16:19], s42 offen offset:2048 sc1 lds
    buffer_load_dwordx4 v1, s[16:19], s42 offen offset:3072 sc1 lds
    s_add_u32 m0, s43, 49152
    s_add_u32 s42, s41, 49152
    buffer_load_dwordx4 v1, s[16:19], s42 offen offset:0 sc1 lds
    buffer_load_dwordx4 v1, s[16:19], s42 offen offset:1024 sc1 lds
    buffer_load_dwordx4 v1, s[16:19], s42 offen offset:2048 sc1 lds
    buffer_load_dwordx4 v1, s[16:19], s42 offen offset:3072 sc1 lds
    s_add_u32 s45, s45, 65536
    s_waitcnt vmcnt(0) lgkmcnt(0)
    s_barrier
    ds_read_b128 v[56:59], v1 offset:0
    ds_read_b128 v[60:63], v1 offset:1024
    ds_read_b128 v[64:67], v1 offset:2048
    ds_read_b128 v[68:71], v1 offset:3072
    s_mov_b32 s36, 0
    s_waitcnt lgkmcnt(0)
    s_nop 7
L_a_b0:
    v_mfma_f32_16x16x32_bf16 v[8:11], a[0:3], v[56:59], 0
    s_and_b32 s44, s90, 0xffffffff
    ds_read_b128 v[72:75], v1 offset:4096
    v_mul_f32 v120, v48, v116
    v_mfma_f32_16x16x32_bf16 v[16:19], a[0:3], v[60:63], 0
    s_cmp_lt_i32 s36, 1
    v_mul_f32 v121, v49, v116
    v_mul_f32 v120, v120, abs(v48)
    v_mfma_f32_16x16x32_bf16 v[20:23], a[4:7], v[60:63], 0
    s_cselect_b32 s44, 0x5e00000, s44
    v_mul_f32 v121, v121, abs(v49)
    v_cvt_pk_bf16_f32 v48, v120, v121
    v_mfma_f32_16x16x32_bf16 v[12:15], a[4:7], v[56:59], 0
    s_add_u32 s49, s44, s87
    ds_read_b128 v[76:79], v1 offset:5120
    v_pk_max_i16 v48, v48, 0
    v_mfma_f32_16x16x32_bf16 v[24:27], a[8:11], v[56:59], 0
    s_max_u32 s44, s44, s88
    v_mul_f32 v120, v50, v116
    v_mul_f32 v121, v51, v116
    v_mfma_f32_16x16x32_bf16 v[28:31], a[8:11], v[60:63], 0
    s_waitcnt lgkmcnt(2)
    v_mul_f32 v120, v120, abs(v50)
    v_mul_f32 v121, v121, abs(v51)
    v_mfma_f32_16x16x32_bf16 v[8:11], a[12:15], v[64:67], v[8:11]
    s_add_u32 s90, s90, 262144
    ds_read_b128 v[80:83], v1 offset:6144
    v_cvt_pk_bf16_f32 v49, v120, v121
    v_mfma_f32_16x16x32_bf16 v[16:19], a[12:15], v[68:71], v[16:19]
    s_add_u32 m0, s52, 73728
    v_pk_max_i16 v49, v49, 0
    s_add_u32 s42, s46, s52
    v_mfma_f32_16x16x32_bf16 v[20:23], a[16:19], v[68:71], v[20:23]
    buffer_load_dwordx4 v1, s[16:19], s42 offen sc1 lds
    v_mfma_f32_16x16x32_bf16 v[12:15], a[16:19], v[64:67], v[12:15]
    s_add_u32 s98, s98, 65536
    ds_read_b128 v[84:87], v1 offset:7168
    s_min_i32 s98, s98, s96
    v_mfma_f32_16x16x32_bf16 v[24:27], a[20:23], v[64:67], v[24:27]
    s_and_b32 s41, s98, 0xffffffff
    ds_write_b64 v3, v[48:49] offset:4096
    v_mfma_f32_16x16x32_bf16 v[28:31], a[20:23], v[68:71], v[28:31]
    s_waitcnt lgkmcnt(3)
    v_mul_f32 v120, v52, v117
    v_mul_f32 v121, v53, v117
    v_mfma_f32_16x16x32_bf16 v[8:11], a[24:27], v[72:75], v[8:11]
    ds_read_b128 v[56:59], v1 offset:8192
    v_mul_f32 v120, v120, abs(v52)
    v_mfma_f32_16x16x32_bf16 v[16:19], a[24:27], v[76:79], v[16:19]
    v_mul_f32 v121, v121, abs(v53)
    v_cvt_pk_bf16_f32 v52, v120, v121
    v_mfma_f32_16x16x32_bf16 v[20:23], a[28:31], v[76:79], v[20:23]
    v_pk_max_i16 v52, v52, 0
    v_mul_f32 v120, v54, v117
    v_mfma_f32_16x16x32_bf16 v[12:15], a[28:31], v[72:75], v[12:15]
    ds_read_b128 v[60:63], v1 offset:9216
    v_mul_f32 v121, v55, v117
    v_mfma_f32_16x16x32_bf16 v[24:27], a[32:35], v[72:75], v[24:27]
    v_mul_f32 v120, v120, abs(v54)
    v_mul_f32 v121, v121, abs(v55)
    v_mfma_f32_16x16x32_bf16 v[28:31], a[32:35], v[76:79], v[28:31]
    s_waitcnt lgkmcnt(3)
    v_cvt_pk_bf16_f32 v53, v120, v121
    v_pk_max_i16 v53, v53, 0
    v_mfma_f32_16x16x32_bf16 v[8:11], a[36:39], v[80:83], v[8:11]
    ds_read_b128 v[64:67], v1 offset:10240
    v_mfma_f32_16x16x32_bf16 v[16:19], a[36:39], v[84:87], v[16:19]
    ds_write_b64 v3, v[52:53] offset:5120
    v_mfma_f32_16x16x32_bf16 v[20:23], a[40:43], v[84:87], v[20:23]
    v_mul_f32 v120, v32, v116
    v_mul_f32 v121, v33, v116
    v_mfma_f32_16x16x32_bf16 v[12:15], a[40:43], v[80:83], v[12:15]
    ds_read_b128 v[68:71], v1 offset:11264
    v_mul_f32 v120, v120, abs(v32)
    v_mfma_f32_16x16x32_bf16 v[24:27], a[44:47], v[80:83], v[24:27]
    v_mul_f32 v121, v121, abs(v33)
    v_cvt_pk_bf16_f32 v32, v120, v121
    v_mfma_f32_16x16x32_bf16 v[28:31], a[44:47], v[84:87], v[28:31]
    s_waitcnt lgkmcnt(3)
    v_pk_max_i16 v32, v32, 0
    v_mul_f32 v120, v34, v116
    v_mfma_f32_16x16x32_bf16 v[8:11], a[48:51], v[56:59], v[8:11]
    ds_read_b128 v[72:75], v1 offset:12288
    v_mul_f32 v121, v35, v116
    v_mfma_f32_16x16x32_bf16 v[16:19], a[48:51], v[60:63], v[16:19]
    v_mul_f32 v120, v120, abs(v34)
    v_mul_f32 v121, v121, abs(v35)
    v_mfma_f32_16x16x32_bf16 v[20:23], a[52:55], v[60:63], v[20:23]
    v_cvt_pk_bf16_f32 v33, v120, v121
    v_pk_max_i16 v33, v33, 0
    v_mfma_f32_16x16x32_bf16 v[12:15], a[52:55], v[56:59], v[12:15]
    ds_read_b128 v[76:79], v1 offset:13312
    v_mul_f32 v120, v36, v116
    v_mfma_f32_16x16x32_bf16 v[24:27], a[56:59], v[56:59], v[24:27]
    v_mul_f32 v121, v37, v116
    v_mul_f32 v120, v120, abs(v36)
    v_mfma_f32_16x16x32_bf16 v[28:31], a[56:59], v[60:63], v[28:31]
    s_waitcnt vmcnt(9) lgkmcnt(2)
    s_barrier
    v_mul_f32 v121, v121, abs(v37)
    v_mfma_f32_16x16x32_bf16 v[8:11], a[60:63], v[64:67], v[8:11]
    ds_read_b128 v[80:83], v1 offset:14336
    v_cvt_pk_bf16_f32 v34, v120, v121
    v_mfma_f32_16x16x32_bf16 v[16:19], a[60:63], v[68:71], v[16:19]
    ds_read_b128 v[48:51], v4 offset:4096
    v_pk_max_i16 v34, v34, 0
    v_mfma_f32_16x16x32_bf16 v[20:23], a[64:67], v[68:71], v[20:23]
    buffer_load_dword v7, v5, s[16:19], s45 offen sc1
    v_mfma_f32_16x16x32_bf16 v[12:15], a[64:67], v[64:67], v[12:15]
    ds_read_b128 v[84:87], v1 offset:15360
    v_mul_f32 v120, v38, v116
    v_mfma_f32_16x16x32_bf16 v[24:27], a[68:71], v[64:67], v[24:27]
    v_mul_f32 v121, v39, v116
    v_mul_f32 v120, v120, abs(v38)
    v_mfma_f32_16x16x32_bf16 v[28:31], a[68:71], v[68:71], v[28:31]
    s_waitcnt lgkmcnt(3)
    v_mul_f32 v121, v121, abs(v39)
    v_cvt_pk_bf16_f32 v35, v120, v121
    v_mfma_f32_16x16x32_bf16 v[8:11], a[72:75], v[72:75], v[8:11]
    s_waitcnt lgkmcnt(1)
    ds_read_b128 v[56:59], v1 offset:16384
    v_pk_max_i16 v35, v35, 0
    v_mfma_f32_16x16x32_bf16 v[16:19], a[72:75], v[76:79], v[16:19]
    buffer_store_dwordx4 v[48:51], v1, s[16:19], s49 offen sc1
    v_mfma_f32_16x16x32_bf16 v[20:23], a[76:79], v[76:79], v[20:23]
    buffer_store_dwordx4 v[32:35], v1, s[16:19], s44 offen offset:0 sc1
    v_mfma_f32_16x16x32_bf16 v[12:15], a[76:79], v[72:75], v[12:15]
    ds_read_b128 v[60:63], v1 offset:17408
    v_mul_f32 v120, v40, v117
    v_mfma_f32_16x16x32_bf16 v[24:27], a[80:83], v[72:75], v[24:27]
    v_mul_f32 v121, v41, v117
    v_mul_f32 v120, v120, abs(v40)
    v_mfma_f32_16x16x32_bf16 v[28:31], a[80:83], v[76:79], v[28:31]
    s_waitcnt lgkmcnt(2)
    v_mul_f32 v121, v121, abs(v41)
    v_cvt_pk_bf16_f32 v40, v120, v121
    v_mfma_f32_16x16x32_bf16 v[8:11], a[84:87], v[80:83], v[8:11]
    ds_read_b128 v[64:67], v1 offset:18432
    v_pk_max_i16 v40, v40, 0
    v_mfma_f32_16x16x32_bf16 v[16:19], a[84:87], v[84:87], v[16:19]
    v_mul_f32 v120, v42, v117
    v_mul_f32 v121, v43, v117
    v_mfma_f32_16x16x32_bf16 v[20:23], a[88:91], v[84:87], v[20:23]
    v_mul_f32 v120, v120, abs(v42)
    v_mul_f32 v121, v121, abs(v43)
    v_mfma_f32_16x16x32_bf16 v[12:15], a[88:91], v[80:83], v[12:15]
    ds_read_b128 v[68:71], v1 offset:19456
    v_cvt_pk_bf16_f32 v41, v120, v121
    v_mfma_f32_16x16x32_bf16 v[24:27], a[92:95], v[80:83], v[24:27]
    v_pk_max_i16 v41, v41, 0
    v_mul_f32 v120, v44, v117
    v_mfma_f32_16x16x32_bf16 v[28:31], a[92:95], v[84:87], v[28:31]
    s_waitcnt lgkmcnt(2)
    v_mul_f32 v121, v45, v117
    v_mul_f32 v120, v120, abs(v44)
    v_mfma_f32_16x16x32_bf16 v[8:11], a[96:99], v[56:59], v[8:11]
    ds_read_b128 v[72:75], v1 offset:20480
    v_mul_f32 v121, v121, abs(v45)
    v_mfma_f32_16x16x32_bf16 v[16:19], a[96:99], v[60:63], v[16:19]
    v_cvt_pk_bf16_f32 v42, v120, v121
    v_pk_max_i16 v42, v42, 0
    v_mfma_f32_16x16x32_bf16 v[20:23], a[100:103], v[60:63], v[20:23]
    v_mul_f32 v120, v46, v117
    v_mul_f32 v121, v47, v117
    v_mfma_f32_16x16x32_bf16 v[12:15], a[100:103], v[56:59], v[12:15]
    ds_read_b128 v[76:79], v1 offset:21504
    v_mul_f32 v120, v120, abs(v46)
    v_mfma_f32_16x16x32_bf16 v[24:27], a[104:107], v[56:59], v[24:27]
    v_mul_f32 v121, v121, abs(v47)
    v_cvt_pk_bf16_f32 v43, v120, v121
    v_mfma_f32_16x16x32_bf16 v[28:31], a[104:107], v[60:63], v[28:31]
    s_waitcnt lgkmcnt(2)
    v_pk_max_i16 v43, v43, 0
    v_mfma_f32_16x16x32_bf16 v[8:11], a[108:111], v[64:67], v[8:11]
    ds_read_b128 v[80:83], v1 offset:22528
    v_mfma_f32_16x16x32_bf16 v[16:19], a[108:111], v[68:71], v[16:19]
    buffer_store_dwordx4 v[40:43], v1, s[16:19], s44 offen offset:1024 sc1
    v_mfma_f32_16x16x32_bf16 v[20:23], a[112:115], v[68:71], v[20:23]
    v_mfma_f32_16x16x32_bf16 v[12:15], a[112:115], v[64:67], v[12:15]
    ds_read_b128 v[84:87], v1 offset:23552
    v_mfma_f32_16x16x32_bf16 v[24:27], a[116:119], v[64:67], v[24:27]
    v_mfma_f32_16x16x32_bf16 v[28:31], a[116:119], v[68:71], v[28:31]
    s_waitcnt lgkmcnt(2)
    v_mfma_f32_16x16x32_bf16 v[8:11], a[120:123], v[72:75], v[8:11]
    ds_read_b128 v[56:59], v1 offset:24576
    v_mfma_f32_16x16x32_bf16 v[16:19], a[120:123], v[76:79], v[16:19]
    v_mfma_f32_16x16x32_bf16 v[20:23], a[124:127], v[76:79], v[20:23]
    v_mfma_f32_16x16x32_bf16 v[12:15], a[124:127], v[72:75], v[12:15]
    ds_read_b128 v[60:63], v1 offset:25600
    v_mfma_f32_16x16x32_bf16 v[24:27], a[128:131], v[72:75], v[24:27]
    v_mfma_f32_16x16x32_bf16 v[28:31], a[128:131], v[76:79], v[28:31]
    s_waitcnt lgkmcnt(2)
    v_mfma_f32_16x16x32_bf16 v[8:11], a[132:135], v[80:83], v[8:11]
    ds_read_b128 v[64:67], v1 offset:26624
    v_mfma_f32_16x16x32_bf16 v[16:19], a[132:135], v[84:87], v[16:19]
    v_mfma_f32_16x16x32_bf16 v[20:23], a[136:139], v[84:87], v[20:23]
    v_mfma_f32_16x16x32_bf16 v[12:15], a[136:139], v[80:83], v[12:15]
    ds_read_b128 v[68:71], v1 offset:27648
    v_mfma_f32_16x16x32_bf16 v[24:27], a[140:143], v[80:83], v[24:27]
    v_mfma_f32_16x16x32_bf16 v[28:31], a[140:143], v[84:87], v[28:31]
    s_waitcnt lgkmcnt(2)
    v_mfma_f32_16x16x32_bf16 v[8:11], a[144:147], v[56:59], v[8:11]
    ds_read_b128 v[72:75], v1 offset:28672
    v_mfma_f32_16x16x32_bf16 v[16:19], a[144:147], v[60:63], v[16:19]
    v_mfma_f32_16x16x32_bf16 v[20:23], a[148:151], v[60:63], v[20:23]
    v_mfma_f32_16x16x32_bf16 v[12:15], a[148:151], v[56:59], v[12:15]
    ds_read_b128 v[76:79], v1 offset:29696
    v_mfma_f32_16x16x32_bf16 v[24:27], a[152:155], v[56:59], v[24:27]
    v_mfma_f32_16x16x32_bf16 v[28:31], a[152:155], v[60:63], v[28:31]
    s_waitcnt lgkmcnt(2)
    v_mfma_f32_16x16x32_bf16 v[8:11], a[156:159], v[64:67], v[8:11]
    ds_read_b128 v[80:83], v1 offset:30720
    v_mfma_f32_16x16x32_bf16 v[16:19], a[156:159], v[68:71], v[16:19]
    s_waitcnt vmcnt(3)
    v_cmp_ne_u32 vcc, 0, v7
    v_mfma_f32_16x16x32_bf16 v[20:23], a[160:163], v[68:71], v[20:23]
    v_mfma_f32_16x16x32_bf16 v[12:15], a[160:163], v[64:67], v[12:15]
    s_cbranch_vccnz L_spin14
L_back15:
    ds_read_b128 v[84:87], v1 offset:31744
    v_mfma_f32_16x16x32_bf16 v[24:27], a[164:167], v[64:67], v[24:27]
    v_mfma_f32_16x16x32_bf16 v[28:31], a[164:167], v[68:71], v[28:31]
    s_waitcnt vmcnt(4) lgkmcnt(2)
    s_barrier
    v_mfma_f32_16x16x32_bf16 v[8:11], a[168:171], v[72:75], v[8:11]
    s_add_u32 m0, s43, 98304
    ds_read_b128 v[56:59], v1 offset:32768
    s_add_u32 s42, s41, 0
    v_mfma_f32_16x16x32_bf16 v[16:19], a[168:171], v[76:79], v[16:19]
    buffer_load_dwordx4 v1, s[16:19], s42 offen offset:0 sc1 lds
    v_mfma_f32_16x16x32_bf16 v[20:23], a[172:175], v[76:79], v[20:23]
    ds_read_b64 v[36:37], v118 offset:0
    v_mfma_f32_16x16x32_bf16 v[12:15], a[172:175], v[72:75], v[12:15]
    ds_read_b128 v[60:63], v1 offset:33792
    v_mfma_f32_16x16x32_bf16 v[24:27], a[176:179], v[72:75], v[24:27]
    ds_read_b64 v[38:39], v118 offset:128
    v_mfma_f32_16x16x32_bf16 v[28:31], a[176:179], v[76:79], v[28:31]
    s_waitcnt lgkmcnt(4)
    ds_read_b64 v[40:41], v118 offset:256
    v_mfma_f32_16x16x32_bf16 v[8:11], a[180:183], v[80:83], v[8:11]
    ds_read_b128 v[64:67], v1 offset:34816
    v_mfma_f32_16x16x32_bf16 v[16:19], a[180:183], v[84:87], v[16:19]
    buffer_load_dwordx4 v1, s[16:19], s42 offen offset:1024 sc1 lds
    v_mfma_f32_16x16x32_bf16 v[20:23], a[184:187], v[84:87], v[20:23]
    ds_read_b64 v[42:43], v118 offset:384
    v_mfma_f32_16x16x32_bf16 v[12:15], a[184:187], v[80:83], v[12:15]
    ds_read_b128 v[68:71], v1 offset:35840
    v_mfma_f32_16x16x32_bf16 v[24:27], a[188:191], v[80:83], v[24:27]
    v_mfma_f32_16x16x32_bf16 v[28:31], a[188:191], v[84:87], v[28:31]
    s_waitcnt lgkmcnt(5)
    v_mfma_f32_16x16x32_bf16 v[8:11], a[192:195], v[56:59], v[8:11]
    ds_read_b128 v[72:75], v1 offset:36864
    v_mfma_f32_16x16x32_bf16 v[16:19], a[192:195], v[60:63], v[16:19]
    buffer_load_dwordx4 v1, s[16:19], s42 offen offset:2048 sc1 lds
    v_mfma_f32_16x16x32_bf16 v[20:23], a[196:199], v[60:63], v[20:23]
    s_waitcnt lgkmcnt(2)
    v_max3_u32 v44, v36, v37, v38
    v_max3_u32 v45, v39, v40, v41
    v_mfma_f32_16x16x32_bf16 v[12:15], a[196:199], v[56:59], v[12:15]
    ds_read_b128 v[76:79], v1 offset:37888
    v_max3_u32 v44, v44, v42, v43
    v_mfma_f32_16x16x32_bf16 v[24:27], a[200:203], v[56:59], v[24:27]
    v_max_u32 v44, v44, v45
    v_cmp_eq_u32 vcc, -1, v44
    v_mfma_f32_16x16x32_bf16 v[28:31], a[200:203], v[60:63], v[28:31]
    s_waitcnt lgkmcnt(2)
    v_mfma_f32_16x16x32_bf16 v[8:11], a[204:207], v[64:67], v[8:11]
    s_cbranch_vccnz L_sspin16
L_sback17:
    ds_read_b128 v[80:83], v1 offset:38912
    v_add_f32 v44, v40, v42
    v_mfma_f32_16x16x32_bf16 v[16:19], a[204:207], v[68:71], v[16:19]
    buffer_load_dwordx4 v1, s[16:19], s42 offen offset:3072 sc1 lds
    v_mfma_f32_16x16x32_bf16 v[20:23], a[208:211], v[68:71], v[20:23]
    s_add_u32 m0, s43, 114688
    v_add_f32 v45, v41, v43
    v_add_f32 v36, v36, v38
    v_mfma_f32_16x16x32_bf16 v[12:15], a[208:211], v[64:67], v[12:15]
    s_add_u32 s42, s41, 16384
    ds_read_b128 v[84:87], v1 offset:39936
    v_add_f32 v37, v37, v39
    v_mfma_f32_16x16x32_bf16 v[24:27], a[212:215], v[64:67], v[24:27]
    v_add_f32 v36, v36, v44
    v_add_f32 v37, v37, v45
    v_mfma_f32_16x16x32_bf16 v[28:31], a[212:215], v[68:71], v[28:31]
    s_waitcnt lgkmcnt(2)
    v_mov_b32 v44, v36
    v_mov_b32 v45, v37
    v_mfma_f32_16x16x32_bf16 v[8:11], a[216:219], v[72:75], v[8:11]
    ds_read_b128 v[56:59], v1 offset:40960
    v_mfma_f32_16x16x32_bf16 v[16:19], a[216:219], v[76:79], v[16:19]
    buffer_load_dwordx4 v1, s[16:19], s42 offen offset:0 sc1 lds
    v_mfma_f32_16x16x32_bf16 v[20:23], a[220:223], v[76:79], v[20:23]
    v_permlane32_swap_b32 v36, v44
    v_mfma_f32_16x16x32_bf16 v[12:15], a[220:223], v[72:75], v[12:15]
    ds_read_b128 v[60:63], v1 offset:41984
    v_mfma_f32_16x16x32_bf16 v[24:27], a[224:227], v[72:75], v[24:27]
    v_permlane32_swap_b32 v37, v45
    v_mfma_f32_16x16x32_bf16 v[28:31], a[224:227], v[76:79], v[28:31]
    s_waitcnt lgkmcnt(2)
    v_add_f32 v36, v36, v44
    v_add_f32 v37, v37, v45
    v_mfma_f32_16x16x32_bf16 v[8:11], a[228:231], v[80:83], v[8:11]
    ds_read_b128 v[64:67], v1 offset:43008
    v_mul_f32 v112, 0xba800000, v36
    v_mfma_f32_16x16x32_bf16 v[16:19], a[228:231], v[84:87], v[16:19]
    buffer_load_dwordx4 v1, s[16:19], s42 offen offset:1024 sc1 lds
    v_mfma_f32_16x16x32_bf16 v[20:23], a[232:235], v[84:87], v[20:23]
    v_mul_f32 v37, 0x3a800000, v37
    v_fma_f32 v37, -v112, v112, v37
    v_mfma_f32_16x16x32_bf16 v[12:15], a[232:235], v[80:83], v[12:15]
    ds_read_b128 v[68:71], v1 offset:44032
    v_mov_b32 v113, v112
    v_mfma_f32_16x16x32_bf16 v[24:27], a[236:239], v[80:83], v[24:27]
    s_waitcnt vmcnt(6)
    v_max_f32 v37, 0, v37
    v_add_f32 v37, 0x3727c5ac, v37
    v_mfma_f32_16x16x32_bf16 v[28:31], a[236:239], v[84:87], v[28:31]
    s_waitcnt lgkmcnt(2)
    v_rsq_f32 v116, v37
    v_mfma_f32_16x16x32_bf16 v[8:11], a[240:243], v[56:59], v[8:11]
    s_barrier
    ds_read_b128 v[72:75], v1 offset:45056
    v_mfma_f32_16x16x32_bf16 v[16:19], a[240:243], v[60:63], v[16:19]
    buffer_store_dword v124, v124, s[16:19], s91 offen sc1
    v_mfma_f32_16x16x32_bf16 v[20:23], a[244:247], v[60:63], v[20:23]
    buffer_load_dwordx4 v1, s[16:19], s42 offen offset:2048 sc1 lds
    v_mfma_f32_16x16x32_bf16 v[12:15], a[244:247], v[56:59], v[12:15]
    s_add_u32 s91, s91, 65536
    ds_read_b128 v[76:79], v1 offset:46080
    v_mfma_f32_16x16x32_bf16 v[24:27], a[248:251], v[56:59], v[24:27]
    v_permlane16_swap_b32 v112, v113
    v_mfma_f32_16x16x32_bf16 v[28:31], a[248:251], v[60:63], v[28:31]
    s_waitcnt lgkmcnt(2)
    v_mul_f32 v114, v37, v116
    v_mul_f32 v116, v116, v116
    v_mfma_f32_16x16x32_bf16 v[8:11], a[252:255], v[64:67], v[8:11]
    ds_read_b128 v[80:83], v1 offset:47104
    v_mov_b32 v115, v114
    v_mfma_f32_16x16x32_bf16 v[16:19], a[252:255], v[68:71], v[16:19]
    v_mov_b32 v117, v116
    v_fmac_f32 v12, v112, v92
    v_mfma_f32_16x16x32_bf16 v[20:23], v[128:131], v[68:71], v[20:23]
    buffer_load_dwordx4 v1, s[16:19], s42 offen offset:3072 sc1 lds
    v_mfma_f32_16x16x32_bf16 v[12:15], v[128:131], v[64:67], v[12:15]
    s_add_u32 m0, s43, 131072
    ds_read_b128 v[84:87], v1 offset:48128
    v_fmac_f32 v8, v112, v88
    v_mfma_f32_16x16x32_bf16 v[24:27], v[132:135], v[64:67], v[24:27]
    s_add_u32 s42, s41, 32768
    v_permlane16_swap_b32 v114, v115
    v_mfma_f32_16x16x32_bf16 v[28:31], v[132:135], v[68:71], v[28:31]
    s_waitcnt lgkmcnt(2)
    v_permlane16_swap_b32 v116, v117
    v_mfma_f32_16x16x32_bf16 v[8:11], v[136:139], v[72:75], v[8:11]
    s_add_u32 s46, s46, 2048
    ds_read_b128 v[56:59], v1 offset:49152
    v_fmac_f32 v13, v112, v93
    v_mfma_f32_16x16x32_bf16 v[16:19], v[136:139], v[76:79], v[16:19]
    s_min_u32 s46, s46, s55
    v_fmac_f32 v14, v112, v94
    v_fmac_f32 v15, v112, v95
    v_mfma_f32_16x16x32_bf16 v[20:23], v[140:143], v[76:79], v[20:23]
    buffer_load_dwordx4 v1, s[16:19], s42 offen offset:0 sc1 lds
    v_mfma_f32_16x16x32_bf16 v[12:15], v[140:143], v[72:75], v[12:15]
    ds_read_b128 v[60:63], v1 offset:50176
    v_fmac_f32 v9, v112, v89
    v_mfma_f32_16x16x32_bf16 v[24:27], v[144:147], v[72:75], v[24:27]
    v_fmac_f32 v10, v112, v90
    v_fmac_f32 v11, v112, v91
    v_mfma_f32_16x16x32_bf16 v[28:31], v[144:147], v[76:79], v[28:31]
    s_waitcnt lgkmcnt(2)
    v_fmac_f32 v16, v113, v88
    v_fmac_f32 v17, v113, v89
    v_mfma_f32_16x16x32_bf16 v[8:11], v[148:151], v[80:83], v[8:11]
    ds_read_b128 v[64:67], v1 offset:51200
    v_fmac_f32 v12, v114, v104
    v_mfma_f32_16x16x32_bf16 v[16:19], v[148:151], v[84:87], v[16:19]
    v_fmac_f32 v13, v114, v105
    v_fmac_f32 v14, v114, v106
    v_mfma_f32_16x16x32_bf16 v[20:23], v[152:155], v[84:87], v[20:23]
    buffer_load_dwordx4 v1, s[16:19], s42 offen offset:1024 sc1 lds
    v_mfma_f32_16x16x32_bf16 v[12:15], v[152:155], v[80:83], v[12:15]
    ds_read_b128 v[68:71], v1 offset:52224
    v_fmac_f32 v8, v114, v100
    v_mfma_f32_16x16x32_bf16 v[24:27], v[156:159], v[80:83], v[24:27]
    v_fmac_f32 v9, v114, v101
    v_fmac_f32 v10, v114, v102
    v_mfma_f32_16x16x32_bf16 v[28:31], v[156:159], v[84:87], v[28:31]
    s_waitcnt lgkmcnt(2)
    v_fmac_f32 v18, v113, v90
    v_fmac_f32 v19, v113, v91
    v_mfma_f32_16x16x32_bf16 v[8:11], v[160:163], v[56:59], v[8:11]
    ds_read_b128 v[72:75], v1 offset:53248
    v_fmac_f32 v15, v114, v107
    v_mfma_f32_16x16x32_bf16 v[16:19], v[160:163], v[60:63], v[16:19]
    v_fmac_f32 v24, v112, v96
    v_fmac_f32 v25, v112, v97
    v_mfma_f32_16x16x32_bf16 v[20:23], v[164:167], v[60:63], v[20:23]
    buffer_load_dwordx4 v1, s[16:19], s42 offen offset:2048 sc1 lds
    v_mfma_f32_16x16x32_bf16 v[12:15], v[164:167], v[56:59], v[12:15]
    ds_read_b128 v[76:79], v1 offset:54272
    v_fmac_f32 v11, v114, v103
    v_mfma_f32_16x16x32_bf16 v[24:27], v[168:171], v[56:59], v[24:27]
    v_fmac_f32 v16, v115, v100
    v_fmac_f32 v17, v115, v101
    v_mfma_f32_16x16x32_bf16 v[28:31], v[168:171], v[60:63], v[28:31]
    s_waitcnt lgkmcnt(2)
    v_fmac_f32 v18, v115, v102
    v_fmac_f32 v19, v115, v103
    v_mfma_f32_16x16x32_bf16 v[8:11], v[172:175], v[64:67], v[8:11]
    ds_read_b128 v[80:83], v1 offset:55296
    v_fmac_f32 v20, v113, v92
    v_mfma_f32_16x16x32_bf16 v[16:19], v[172:175], v[68:71], v[16:19]
    v_fmac_f32 v26, v112, v98
    v_fmac_f32 v27, v112, v99
    v_mfma_f32_16x16x32_bf16 v[20:23], v[176:179], v[68:71], v[20:23]
    buffer_load_dwordx4 v1, s[16:19], s42 offen offset:3072 sc1 lds
    v_mfma_f32_16x16x32_bf16 v[12:15], v[176:179], v[64:67], v[12:15]
    s_add_u32 m0, s43, 147456
    ds_read_b128 v[84:87], v1 offset:56320
    v_fmac_f32 v28, v113, v96
    v_mfma_f32_16x16x32_bf16 v[24:27], v[180:183], v[64:67], v[24:27]
    s_add_u32 s42, s41, 49152
    v_fmac_f32 v21, v113, v93
    v_fmac_f32 v22, v113, v94
    v_mfma_f32_16x16x32_bf16 v[28:31], v[180:183], v[68:71], v[28:31]
    s_waitcnt lgkmcnt(2)
    v_fmac_f32 v23, v113, v95
    v_fmac_f32 v20, v115, v104
    v_mfma_f32_16x16x32_bf16 v[8:11], v[184:187], v[72:75], v[8:11]
    ds_read_b128 v[56:59], v1 offset:57344
    v_fmac_f32 v21, v115, v105
    v_mfma_f32_16x16x32_bf16 v[16:19], v[184:187], v[76:79], v[16:19]
    v_fmac_f32 v24, v114, v108
    v_fmac_f32 v25, v114, v109
    v_mfma_f32_16x16x32_bf16 v[20:23], v[188:191], v[76:79], v[20:23]
    buffer_load_dwordx4 v1, s[16:19], s42 offen offset:0 sc1 lds
    v_mfma_f32_16x16x32_bf16 v[12:15], v[188:191], v[72:75], v[12:15]
    ds_read_b128 v[60:63], v1 offset:58368
    v_fmac_f32 v29, v113, v97
    v_mfma_f32_16x16x32_bf16 v[24:27], v[192:195], v[72:75], v[24:27]
    s_nop 0
    v_fmac_f32 v22, v115, v106
    v_fmac_f32 v23, v115, v107
    v_mfma_f32_16x16x32_bf16 v[28:31], v[192:195], v[76:79], v[28:31]
    s_waitcnt lgkmcnt(2)
    v_mfma_f32_16x16x32_bf16 v[8:11], v[196:199], v[80:83], v[8:11]
    ds_read_b128 v[64:67], v1 offset:59392
    v_fmac_f32 v26, v114, v110
    v_mfma_f32_16x16x32_bf16 v[16:19], v[196:199], v[84:87], v[16:19]
    v_fmac_f32 v27, v114, v111
    v_fmac_f32 v30, v113, v98
    v_mfma_f32_16x16x32_bf16 v[20:23], v[200:203], v[84:87], v[20:23]
    buffer_load_dwordx4 v1, s[16:19], s42 offen offset:1024 sc1 lds
    v_mfma_f32_16x16x32_bf16 v[12:15], v[200:203], v[80:83], v[12:15]
    ds_read_b128 v[68:71], v1 offset:60416
    v_fmac_f32 v31, v113, v99
    v_mfma_f32_16x16x32_bf16 v[24:27], v[204:207], v[80:83], v[24:27]
    v_mfma_f32_16x16x32_bf16 v[28:31], v[204:207], v[84:87], v[28:31]
    s_waitcnt lgkmcnt(2)
    v_mfma_f32_16x16x32_bf16 v[8:11], v[208:211], v[56:59], v[8:11]
    ds_read_b128 v[72:75], v1 offset:61440
    v_mfma_f32_16x16x32_bf16 v[16:19], v[208:211], v[60:63], v[16:19]
    v_mfma_f32_16x16x32_bf16 v[20:23], v[212:215], v[60:63], v[20:23]
    buffer_load_dwordx4 v1, s[16:19], s42 offen offset:2048 sc1 lds
    v_mfma_f32_16x16x32_bf16 v[12:15], v[212:215], v[56:59], v[12:15]
    ds_read_b128 v[76:79], v1 offset:62464
    v_fmac_f32 v28, v115, v108
    v_mfma_f32_16x16x32_bf16 v[24:27], v[216:219], v[56:59], v[24:27]
    v_mfma_f32_16x16x32_bf16 v[28:31], v[216:219], v[60:63], v[28:31]
    s_waitcnt lgkmcnt(2)
    v_mfma_f32_16x16x32_bf16 v[8:11], v[220:223], v[64:67], v[8:11]
    ds_read_b128 v[80:83], v1 offset:63488
    v_mfma_f32_16x16x32_bf16 v[16:19], v[220:223], v[68:71], v[16:19]
    v_mfma_f32_16x16x32_bf16 v[20:23], v[224:227], v[68:71], v[20:23]
    buffer_load_dwordx4 v1, s[16:19], s42 offen offset:3072 sc1 lds
    v_mfma_f32_16x16x32_bf16 v[12:15], v[224:227], v[64:67], v[12:15]
    s_add_u32 s45, s45, 65536
    ds_read_b128 v[84:87], v1 offset:64512
    v_fmac_f32 v29, v115, v109
    v_mfma_f32_16x16x32_bf16 v[24:27], v[228:231], v[64:67], v[24:27]
    v_mfma_f32_16x16x32_bf16 v[28:31], v[228:231], v[68:71], v[28:31]
    s_waitcnt vmcnt(13) lgkmcnt(2)
    s_barrier
    v_mfma_f32_16x16x32_bf16 v[8:11], v[232:235], v[72:75], v[8:11]
    ds_read_b128 v[56:59], v2 offset:0
    v_mfma_f32_16x16x32_bf16 v[16:19], v[232:235], v[76:79], v[16:19]
    s_nop 0
    v_fmac_f32 v30, v115, v110
    v_fmac_f32 v31, v115, v111
    v_mfma_f32_16x16x32_bf16 v[20:23], v[236:239], v[76:79], v[20:23]
    v_mfma_f32_16x16x32_bf16 v[12:15], v[236:239], v[72:75], v[12:15]
    ds_read_b128 v[60:63], v2 offset:1024
    v_mfma_f32_16x16x32_bf16 v[24:27], v[240:243], v[72:75], v[24:27]
    v_mfma_f32_16x16x32_bf16 v[28:31], v[240:243], v[76:79], v[28:31]
    s_waitcnt lgkmcnt(2)
    v_mfma_f32_16x16x32_bf16 v[8:11], v[244:247], v[80:83], v[8:11]
    ds_read_b128 v[64:67], v2 offset:2048
    v_mfma_f32_16x16x32_bf16 v[16:19], v[244:247], v[84:87], v[16:19]
    v_mfma_f32_16x16x32_bf16 v[20:23], v[248:251], v[84:87], v[20:23]
    v_mfma_f32_16x16x32_bf16 v[12:15], v[248:251], v[80:83], v[12:15]
    ds_read_b128 v[68:71], v2 offset:3072
    v_mfma_f32_16x16x32_bf16 v[24:27], v[252:255], v[80:83], v[24:27]
    s_add_u32 s36, s36, 1
    v_mfma_f32_16x16x32_bf16 v[28:31], v[252:255], v[84:87], v[28:31]
    s_waitcnt lgkmcnt(2)
L_a_b1:
    v_mfma_f32_16x16x32_bf16 v[32:35], a[0:3], v[56:59], 0
    s_and_b32 s44, s90, 0xffffffff
    ds_read_b128 v[72:75], v2 offset:4096
    v_mul_f32 v120, v24, v116
    v_mfma_f32_16x16x32_bf16 v[40:43], a[0:3], v[60:63], 0
    s_cmp_lt_i32 s36, 1
    v_mul_f32 v121, v25, v116
    v_mul_f32 v120, v120, abs(v24)
    v_mfma_f32_16x16x32_bf16 v[44:47], a[4:7], v[60:63], 0
    s_cselect_b32 s44, 0x5e00000, s44
    v_mul_f32 v121, v121, abs(v25)
    v_cvt_pk_bf16_f32 v24, v120, v121
    v_mfma_f32_16x16x32_bf16 v[36:39], a[4:7], v[56:59], 0
    s_add_u32 s49, s44, s87
    ds_read_b128 v[76:79], v2 offset:5120
    v_pk_max_i16 v24, v24, 0
    v_mfma_f32_16x16x32_bf16 v[48:51], a[8:11], v[56:59], 0
    s_max_u32 s44, s44, s88
    v_mul_f32 v120, v26, v116
    v_mul_f32 v121, v27, v116
    v_mfma_f32_16x16x32_bf16 v[52:55], a[8:11], v[60:63], 0
    s_waitcnt lgkmcnt(2)
    v_mul_f32 v120, v120, abs(v26)
    v_mul_f32 v121, v121, abs(v27)
    v_mfma_f32_16x16x32_bf16 v[32:35], a[12:15], v[64:67], v[32:35]
    s_add_u32 s90, s90, 262144
    ds_read_b128 v[80:83], v2 offset:6144
    v_cvt_pk_bf16_f32 v25, v120, v121
    v_mfma_f32_16x16x32_bf16 v[40:43], a[12:15], v[68:71], v[40:43]
    s_add_u32 m0, s52, 73728
    v_pk_max_i16 v25, v25, 0
    s_add_u32 s42, s46, s52
    v_mfma_f32_16x16x32_bf16 v[44:47], a[16:19], v[68:71], v[44:47]
    buffer_load_dwordx4 v1, s[16:19], s42 offen sc1 lds
    v_mfma_f32_16x16x32_bf16 v[36:39], a[16:19], v[64:67], v[36:39]
    s_add_u32 s98, s98, 65536
    ds_read_b128 v[84:87], v2 offset:7168
    s_min_i32 s98, s98, s96
    v_mfma_f32_16x16x32_bf16 v[48:51], a[20:23], v[64:67], v[48:51]
    s_and_b32 s41, s98, 0xffffffff
    ds_write_b64 v3, v[24:25] offset:0
    v_mfma_f32_16x16x32_bf16 v[52:55], a[20:23], v[68:71], v[52:55]
    s_waitcnt lgkmcnt(3)
    v_mul_f32 v120, v28, v117
    v_mul_f32 v121, v29, v117
    v_mfma_f32_16x16x32_bf16 v[32:35], a[24:27], v[72:75], v[32:35]
    ds_read_b128 v[56:59], v2 offset:8192
    v_mul_f32 v120, v120, abs(v28)
    v_mfma_f32_16x16x32_bf16 v[40:43], a[24:27], v[76:79], v[40:43]
    v_mul_f32 v121, v121, abs(v29)
    v_cvt_pk_bf16_f32 v28, v120, v121
    v_mfma_f32_16x16x32_bf16 v[44:47], a[28:31], v[76:79], v[44:47]
    v_pk_max_i16 v28, v28, 0
    v_mul_f32 v120, v30, v117
    v_mfma_f32_16x16x32_bf16 v[36:39], a[28:31], v[72:75], v[36:39]
    ds_read_b128 v[60:63], v2 offset:9216
    v_mul_f32 v121, v31, v117
    v_mfma_f32_16x16x32_bf16 v[48:51], a[32:35], v[72:75], v[48:51]
    v_mul_f32 v120, v120, abs(v30)
    v_mul_f32 v121, v121, abs(v31)
    v_mfma_f32_16x16x32_bf16 v[52:55], a[32:35], v[76:79], v[52:55]
    s_waitcnt lgkmcnt(3)
    v_cvt_pk_bf16_f32 v29, v120, v121
    v_pk_max_i16 v29, v29, 0
    v_mfma_f32_16x16x32_bf16 v[32:35], a[36:39], v[80:83], v[32:35]
    ds_read_b128 v[64:67], v2 offset:10240
    v_mfma_f32_16x16x32_bf16 v[40:43], a[36:39], v[84:87], v[40:43]
    ds_write_b64 v3, v[28:29] offset:1024
    v_mfma_f32_16x16x32_bf16 v[44:47], a[40:43], v[84:87], v[44:47]
    v_mul_f32 v120, v8, v116
    v_mul_f32 v121, v9, v116
    v_mfma_f32_16x16x32_bf16 v[36:39], a[40:43], v[80:83], v[36:39]
    ds_read_b128 v[68:71], v2 offset:11264
    v_mul_f32 v120, v120, abs(v8)
    v_mfma_f32_16x16x32_bf16 v[48:51], a[44:47], v[80:83], v[48:51]
    v_mul_f32 v121, v121, abs(v9)
    v_cvt_pk_bf16_f32 v8, v120, v121
    v_mfma_f32_16x16x32_bf16 v[52:55], a[44:47], v[84:87], v[52:55]
    s_waitcnt lgkmcnt(3)
    v_pk_max_i16 v8, v8, 0
    v_mul_f32 v120, v10, v116
    v_mfma_f32_16x16x32_bf16 v[32:35], a[48:51], v[56:59], v[32:35]
    ds_read_b128 v[72:75], v2 offset:12288
    v_mul_f32 v121, v11, v116
    v_mfma_f32_16x16x32_bf16 v[40:43], a[48:51], v[60:63], v[40:43]
    v_mul_f32 v120, v120, abs(v10)
    v_mul_f32 v121, v121, abs(v11)
    v_mfma_f32_16x16x32_bf16 v[44:47], a[52:55], v[60:63], v[44:47]
    v_cvt_pk_bf16_f32 v9, v120, v121
    v_pk_max_i16 v9, v9, 0
    v_mfma_f32_16x16x32_bf16 v[36:39], a[52:55], v[56:59], v[36:39]
    ds_read_b128 v[76:79], v2 offset:13312
    v_mul_f32 v120, v12, v116
    v_mfma_f32_16x16x32_bf16 v[48:51], a[56:59], v[56:59], v[48:51]
    v_mul_f32 v121, v13, v116
    v_mul_f32 v120, v120, abs(v12)
    v_mfma_f32_16x16x32_bf16 v[52:55], a[56:59], v[60:63], v[52:55]
    s_waitcnt vmcnt(9) lgkmcnt(2)
    s_barrier
    v_mul_f32 v121, v121, abs(v13)
    v_mfma_f32_16x16x32_bf16 v[32:35], a[60:63], v[64:67], v[32:35]
    ds_read_b128 v[80:83], v2 offset:14336
    v_cvt_pk_bf16_f32 v10, v120, v121
    v_mfma_f32_16x16x32_bf16 v[40:43], a[60:63], v[68:71], v[40:43]
    ds_read_b128 v[24:27], v4 offset:0
    v_pk_max_i16 v10, v10, 0
    v_mfma_f32_16x16x32_bf16 v[44:47], a[64:67], v[68:71], v[44:47]
    buffer_load_dword v7, v5, s[16:19], s45 offen sc1
    v_mfma_f32_16x16x32_bf16 v[36:39], a[64:67], v[64:67], v[36:39]
    ds_read_b128 v[84:87], v2 offset:15360
    v_mul_f32 v120, v14, v116
    v_mfma_f32_16x16x32_bf16 v[48:51], a[68:71], v[64:67], v[48:51]
    v_mul_f32 v121, v15, v116
    v_mul_f32 v120, v120, abs(v14)
    v_mfma_f32_16x16x32_bf16 v[52:55], a[68:71], v[68:71], v[52:55]
    s_waitcnt lgkmcnt(3)
    v_mul_f32 v121, v121, abs(v15)
    v_cvt_pk_bf16_f32 v11, v120, v121
    v_mfma_f32_16x16x32_bf16 v[32:35], a[72:75], v[72:75], v[32:35]
    s_waitcnt lgkmcnt(1)
    ds_read_b128 v[56:59], v2 offset:16384
    v_pk_max_i16 v11, v11, 0
    v_mfma_f32_16x16x32_bf16 v[40:43], a[72:75], v[76:79], v[40:43]
    buffer_store_dwordx4 v[24:27], v1, s[16:19], s49 offen sc1
    v_mfma_f32_16x16x32_bf16 v[44:47], a[76:79], v[76:79], v[44:47]
    buffer_store_dwordx4 v[8:11], v1, s[16:19], s44 offen offset:0 sc1
    v_mfma_f32_16x16x32_bf16 v[36:39], a[76:79], v[72:75], v[36:39]
    ds_read_b128 v[60:63], v2 offset:17408
    v_mul_f32 v120, v16, v117
    v_mfma_f32_16x16x32_bf16 v[48:51], a[80:83], v[72:75], v[48:51]
    v_mul_f32 v121, v17, v117
    v_mul_f32 v120, v120, abs(v16)
    v_mfma_f32_16x16x32_bf16 v[52:55], a[80:83], v[76:79], v[52:55]
    s_waitcnt lgkmcnt(2)
    v_mul_f32 v121, v121, abs(v17)
    v_cvt_pk_bf16_f32 v16, v120, v121
    v_mfma_f32_16x16x32_bf16 v[32:35], a[84:87], v[80:83], v[32:35]
    ds_read_b128 v[64:67], v2 offset:18432
    v_pk_max_i16 v16, v16, 0
    v_mfma_f32_16x16x32_bf16 v[40:43], a[84:87], v[84:87], v[40:43]
    v_mul_f32 v120, v18, v117
    v_mul_f32 v121, v19, v117
    v_mfma_f32_16x16x32_bf16 v[44:47], a[88:91], v[84:87], v[44:47]
    v_mul_f32 v120, v120, abs(v18)
    v_mul_f32 v121, v121, abs(v19)
    v_mfma_f32_16x16x32_bf16 v[36:39], a[88:91], v[80:83], v[36:39]
    ds_read_b128 v[68:71], v2 offset:19456
    v_cvt_pk_bf16_f32 v17, v120, v121
    v_mfma_f32_16x16x32_bf16 v[48:51], a[92:95], v[80:83], v[48:51]
    v_pk_max_i16 v17, v17, 0
    v_mul_f32 v120, v20, v117
    v_mfma_f32_16x16x32_bf16 v[52:55], a[92:95], v[84:87], v[52:55]
    s_waitcnt lgkmcnt(2)
    v_mul_f32 v121, v21, v117
    v_mul_f32 v120, v120, abs(v20)
    v_mfma_f32_16x16x32_bf16 v[32:35], a[96:99], v[56:59], v[32:35]
    ds_read_b128 v[72:75], v2 offset:20480
    v_mul_f32 v121, v121, abs(v21)
    v_mfma_f32_16x16x32_bf16 v[40:43], a[96:99], v[60:63], v[40:43]
    v_cvt_pk_bf16_f32 v18, v120, v121
    v_pk_max_i16 v18, v18, 0
    v_mfma_f32_16x16x32_bf16 v[44:47], a[100:103], v[60:63], v[44:47]
    v_mul_f32 v120, v22, v117
    v_mul_f32 v121, v23, v117
    v_mfma_f32_16x16x32_bf16 v[36:39], a[100:103], v[56:59], v[36:39]
    ds_read_b128 v[76:79], v2 offset:21504
    v_mul_f32 v120, v120, abs(v22)
    v_mfma_f32_16x16x32_bf16 v[48:51], a[104:107], v[56:59], v[48:51]
    v_mul_f32 v121, v121, abs(v23)
    v_cvt_pk_bf16_f32 v19, v120, v121
    v_mfma_f32_16x16x32_bf16 v[52:55], a[104:107], v[60:63], v[52:55]
    s_waitcnt lgkmcnt(2)
    v_pk_max_i16 v19, v19, 0
    v_mfma_f32_16x16x32_bf16 v[32:35], a[108:111], v[64:67], v[32:35]
    ds_read_b128 v[80:83], v2 offset:22528
    v_mfma_f32_16x16x32_bf16 v[40:43], a[108:111], v[68:71], v[40:43]
    buffer_store_dwordx4 v[16:19], v1, s[16:19], s44 offen offset:1024 sc1
    v_mfma_f32_16x16x32_bf16 v[44:47], a[112:115], v[68:71], v[44:47]
    v_mfma_f32_16x16x32_bf16 v[36:39], a[112:115], v[64:67], v[36:39]
    ds_read_b128 v[84:87], v2 offset:23552
    v_mfma_f32_16x16x32_bf16 v[48:51], a[116:119], v[64:67], v[48:51]
    v_mfma_f32_16x16x32_bf16 v[52:55], a[116:119], v[68:71], v[52:55]
    s_waitcnt lgkmcnt(2)
    v_mfma_f32_16x16x32_bf16 v[32:35], a[120:123], v[72:75], v[32:35]
    ds_read_b128 v[56:59], v2 offset:24576
    v_mfma_f32_16x16x32_bf16 v[40:43], a[120:123], v[76:79], v[40:43]
    v_mfma_f32_16x16x32_bf16 v[44:47], a[124:127], v[76:79], v[44:47]
    v_mfma_f32_16x16x32_bf16 v[36:39], a[124:127], v[72:75], v[36:39]
    ds_read_b128 v[60:63], v2 offset:25600
    v_mfma_f32_16x16x32_bf16 v[48:51], a[128:131], v[72:75], v[48:51]
    v_mfma_f32_16x16x32_bf16 v[52:55], a[128:131], v[76:79], v[52:55]
    s_waitcnt lgkmcnt(2)
    v_mfma_f32_16x16x32_bf16 v[32:35], a[132:135], v[80:83], v[32:35]
    ds_read_b128 v[64:67], v2 offset:26624
    v_mfma_f32_16x16x32_bf16 v[40:43], a[132:135], v[84:87], v[40:43]
    v_mfma_f32_16x16x32_bf16 v[44:47], a[136:139], v[84:87], v[44:47]
    v_mfma_f32_16x16x32_bf16 v[36:39], a[136:139], v[80:83], v[36:39]
    ds_read_b128 v[68:71], v2 offset:27648
    v_mfma_f32_16x16x32_bf16 v[48:51], a[140:143], v[80:83], v[48:51]
    v_mfma_f32_16x16x32_bf16 v[52:55], a[140:143], v[84:87], v[52:55]
    s_waitcnt lgkmcnt(2)
    v_mfma_f32_16x16x32_bf16 v[32:35], a[144:147], v[56:59], v[32:35]
    ds_read_b128 v[72:75], v2 offset:28672
    v_mfma_f32_16x16x32_bf16 v[40:43], a[144:147], v[60:63], v[40:43]
    v_mfma_f32_16x16x32_bf16 v[44:47], a[148:151], v[60:63], v[44:47]
    v_mfma_f32_16x16x32_bf16 v[36:39], a[148:151], v[56:59], v[36:39]
    ds_read_b128 v[76:79], v2 offset:29696
    v_mfma_f32_16x16x32_bf16 v[48:51], a[152:155], v[56:59], v[48:51]
    v_mfma_f32_16x16x32_bf16 v[52:55], a[152:155], v[60:63], v[52:55]
    s_waitcnt lgkmcnt(2)
    v_mfma_f32_16x16x32_bf16 v[32:35], a[156:159], v[64:67], v[32:35]
    ds_read_b128 v[80:83], v2 offset:30720
    v_mfma_f32_16x16x32_bf16 v[40:43], a[156:159], v[68:71], v[40:43]
    s_waitcnt vmcnt(3)
    v_cmp_ne_u32 vcc, 0, v7
    v_mfma_f32_16x16x32_bf16 v[44:47], a[160:163], v[68:71], v[44:47]
    v_mfma_f32_16x16x32_bf16 v[36:39], a[160:163], v[64:67], v[36:39]
    s_cbranch_vccnz L_spin18
L_back19:
    ds_read_b128 v[84:87], v2 offset:31744
    v_mfma_f32_16x16x32_bf16 v[48:51], a[164:167], v[64:67], v[48:51]
    v_mfma_f32_16x16x32_bf16 v[52:55], a[164:167], v[68:71], v[52:55]
    s_waitcnt vmcnt(4) lgkmcnt(2)
    s_barrier
    v_mfma_f32_16x16x32_bf16 v[32:35], a[168:171], v[72:75], v[32:35]
    s_add_u32 m0, s43, 0
    ds_read_b128 v[56:59], v2 offset:32768
    s_add_u32 s42, s41, 0
    v_mfma_f32_16x16x32_bf16 v[40:43], a[168:171], v[76:79], v[40:43]
    buffer_load_dwordx4 v1, s[16:19], s42 offen offset:0 sc1 lds
    v_mfma_f32_16x16x32_bf16 v[44:47], a[172:175], v[76:79], v[44:47]
    ds_read_b64 v[12:13], v118 offset:0
    v_mfma_f32_16x16x32_bf16 v[36:39], a[172:175], v[72:75], v[36:39]
    ds_read_b128 v[60:63], v2 offset:33792
    v_mfma_f32_16x16x32_bf16 v[48:51], a[176:179], v[72:75], v[48:51]
    ds_read_b64 v[14:15], v118 offset:128
    v_mfma_f32_16x16x32_bf16 v[52:55], a[176:179], v[76:79], v[52:55]
    s_waitcnt lgkmcnt(4)
    ds_read_b64 v[16:17], v118 offset:256
    v_mfma_f32_16x16x32_bf16 v[32:35], a[180:183], v[80:83], v[32:35]
    ds_read_b128 v[64:67], v2 offset:34816
    v_mfma_f32_16x16x32_bf16 v[40:43], a[180:183], v[84:87], v[40:43]
    buffer_load_dwordx4 v1, s[16:19], s42 offen offset:1024 sc1 lds
    v_mfma_f32_16x16x32_bf16 v[44:47], a[184:187], v[84:87], v[44:47]
    ds_read_b64 v[18:19], v118 offset:384
    v_mfma_f32_16x16x32_bf16 v[36:39], a[184:187], v[80:83], v[36:39]
    ds_read_b128 v[68:71], v2 offset:35840
    v_mfma_f32_16x16x32_bf16 v[48:51], a[188:191], v[80:83], v[48:51]
    v_mfma_f32_16x16x32_bf16 v[52:55], a[188:191], v[84:87], v[52:55]
    s_waitcnt lgkmcnt(5)
    v_mfma_f32_16x16x32_bf16 v[32:35], a[192:195], v[56:59], v[32:35]
    ds_read_b128 v[72:75], v2 offset:36864
    v_mfma_f32_16x16x32_bf16 v[40:43], a[192:195], v[60:63], v[40:43]
    buffer_load_dwordx4 v1, s[16:19], s42 offen offset:2048 sc1 lds
    v_mfma_f32_16x16x32_bf16 v[44:47], a[196:199], v[60:63], v[44:47]
    s_waitcnt lgkmcnt(2)
    v_max3_u32 v20, v12, v13, v14
    v_max3_u32 v21, v15, v16, v17
    v_mfma_f32_16x16x32_bf16 v[36:39], a[196:199], v[56:59], v[36:39]
    ds_read_b128 v[76:79], v2 offset:37888
    v_max3_u32 v20, v20, v18, v19
    v_mfma_f32_16x16x32_bf16 v[48:51], a[200:203], v[56:59], v[48:51]
    v_max_u32 v20, v20, v21
    v_cmp_eq_u32 vcc, -1, v20
    v_mfma_f32_16x16x32_bf16 v[52:55], a[200:203], v[60:63], v[52:55]
    s_waitcnt lgkmcnt(2)
    v_mfma_f32_16x16x32_bf16 v[32:35], a[204:207], v[64:67], v[32:35]
    s_cbranch_vccnz L_sspin20
L_sback21:
    ds_read_b128 v[80:83], v2 offset:38912
    v_add_f32 v20, v16, v18
    v_mfma_f32_16x16x32_bf16 v[40:43], a[204:207], v[68:71], v[40:43]
    buffer_load_dwordx4 v1, s[16:19], s42 offen offset:3072 sc1 lds
    v_mfma_f32_16x16x32_bf16 v[44:47], a[208:211], v[68:71], v[44:47]
    s_add_u32 m0, s43, 16384
    v_add_f32 v21, v17, v19
    v_add_f32 v12, v12, v14
    v_mfma_f32_16x16x32_bf16 v[36:39], a[208:211], v[64:67], v[36:39]
    s_add_u32 s42, s41, 16384
    ds_read_b128 v[84:87], v2 offset:39936
    v_add_f32 v13, v13, v15
    v_mfma_f32_16x16x32_bf16 v[48:51], a[212:215], v[64:67], v[48:51]
    v_add_f32 v12, v12, v20
    v_add_f32 v13, v13, v21
    v_mfma_f32_16x16x32_bf16 v[52:55], a[212:215], v[68:71], v[52:55]
    s_waitcnt lgkmcnt(2)
    v_mov_b32 v20, v12
    v_mov_b32 v21, v13
    v_mfma_f32_16x16x32_bf16 v[32:35], a[216:219], v[72:75], v[32:35]
    ds_read_b128 v[56:59], v2 offset:40960
    v_mfma_f32_16x16x32_bf16 v[40:43], a[216:219], v[76:79], v[40:43]
    buffer_load_dwordx4 v1, s[16:19], s42 offen offset:0 sc1 lds
    v_mfma_f32_16x16x32_bf16 v[44:47], a[220:223], v[76:79], v[44:47]
    v_permlane32_swap_b32 v12, v20
    v_mfma_f32_16x16x32_bf16 v[36:39], a[220:223], v[72:75], v[36:39]
    ds_read_b128 v[60:63], v2 offset:41984
    v_mfma_f32_16x16x32_bf16 v[48:51], a[224:227], v[72:75], v[48:51]
    v_permlane32_swap_b32 v13, v21
    v_mfma_f32_16x16x32_bf16 v[52:55], a[224:227], v[76:79], v[52:55]
    s_waitcnt lgkmcnt(2)
    v_add_f32 v12, v12, v20
    v_add_f32 v13, v13, v21
    v_mfma_f32_16x16x32_bf16 v[32:35], a[228:231], v[80:83], v[32:35]
    ds_read_b128 v[64:67], v2 offset:43008
    v_mul_f32 v112, 0xba800000, v12
    v_mfma_f32_16x16x32_bf16 v[40:43], a[228:231], v[84:87], v[40:43]
    buffer_load_dwordx4 v1, s[16:19], s42 offen offset:1024 sc1 lds
    v_mfma_f32_16x16x32_bf16 v[44:47], a[232:235], v[84:87], v[44:47]
    v_mul_f32 v13, 0x3a800000, v13
    v_fma_f32 v13, -v112, v112, v13
    v_mfma_f32_16x16x32_bf16 v[36:39], a[232:235], v[80:83], v[36:39]
    ds_read_b128 v[68:71], v2 offset:44032
    v_mov_b32 v113, v112
    v_mfma_f32_16x16x32_bf16 v[48:51], a[236:239], v[80:83], v[48:51]
    s_waitcnt vmcnt(6)
    v_max_f32 v13, 0, v13
    v_add_f32 v13, 0x3727c5ac, v13
    v_mfma_f32_16x16x32_bf16 v[52:55], a[236:239], v[84:87], v[52:55]
    s_waitcnt lgkmcnt(2)
    v_rsq_f32 v116, v13
    v_mfma_f32_16x16x32_bf16 v[32:35], a[240:243], v[56:59], v[32:35]
    s_barrier
    ds_read_b128 v[72:75], v2 offset:45056
    v_mfma_f32_16x16x32_bf16 v[40:43], a[240:243], v[60:63], v[40:43]
    buffer_store_dword v124, v124, s[16:19], s91 offen sc1
    v_mfma_f32_16x16x32_bf16 v[44:47], a[244:247], v[60:63], v[44:47]
    buffer_load_dwordx4 v1, s[16:19], s42 offen offset:2048 sc1 lds
    v_mfma_f32_16x16x32_bf16 v[36:39], a[244:247], v[56:59], v[36:39]
    s_add_u32 s91, s91, 65536
    ds_read_b128 v[76:79], v2 offset:46080
    v_mfma_f32_16x16x32_bf16 v[48:51], a[248:251], v[56:59], v[48:51]
    v_permlane16_swap_b32 v112, v113
    v_mfma_f32_16x16x32_bf16 v[52:55], a[248:251], v[60:63], v[52:55]
    s_waitcnt lgkmcnt(2)
    v_mul_f32 v114, v13, v116
    v_mul_f32 v116, v116, v116
    v_mfma_f32_16x16x32_bf16 v[32:35], a[252:255], v[64:67], v[32:35]
    ds_read_b128 v[80:83], v2 offset:47104
    v_mov_b32 v115, v114
    v_mfma_f32_16x16x32_bf16 v[40:43], a[252:255], v[68:71], v[40:43]
    v_mov_b32 v117, v116
    v_fmac_f32 v36, v112, v92
    v_mfma_f32_16x16x32_bf16 v[44:47], v[128:131], v[68:71], v[44:47]
    buffer_load_dwordx4 v1, s[16:19], s42 offen offset:3072 sc1 lds
    v_mfma_f32_16x16x32_bf16 v[36:39], v[128:131], v[64:67], v[36:39]
    s_add_u32 m0, s43, 32768
    ds_read_b128 v[84:87], v2 offset:48128
    v_fmac_f32 v32, v112, v88
    v_mfma_f32_16x16x32_bf16 v[48:51], v[132:135], v[64:67], v[48:51]
    s_add_u32 s42, s41, 32768
    v_permlane16_swap_b32 v114, v115
    v_mfma_f32_16x16x32_bf16 v[52:55], v[132:135], v[68:71], v[52:55]
    s_waitcnt lgkmcnt(2)
    v_permlane16_swap_b32 v116, v117
    v_mfma_f32_16x16x32_bf16 v[32:35], v[136:139], v[72:75], v[32:35]
    s_add_u32 s46, s46, 2048
    ds_read_b128 v[56:59], v2 offset:49152
    v_fmac_f32 v37, v112, v93
    v_mfma_f32_16x16x32_bf16 v[40:43], v[136:139], v[76:79], v[40:43]
    s_min_u32 s46, s46, s55
    v_fmac_f32 v38, v112, v94
    v_fmac_f32 v39, v112, v95
    v_mfma_f32_16x16x32_bf16 v[44:47], v[140:143], v[76:79], v[44:47]
    buffer_load_dwordx4 v1, s[16:19], s42 offen offset:0 sc1 lds
    v_mfma_f32_16x16x32_bf16 v[36:39], v[140:143], v[72:75], v[36:39]
    ds_read_b128 v[60:63], v2 offset:50176
    v_fmac_f32 v33, v112, v89
    v_mfma_f32_16x16x32_bf16 v[48:51], v[144:147], v[72:75], v[48:51]
    v_fmac_f32 v34, v112, v90
    v_fmac_f32 v35, v112, v91
    v_mfma_f32_16x16x32_bf16 v[52:55], v[144:147], v[76:79], v[52:55]
    s_waitcnt lgkmcnt(2)
    v_fmac_f32 v40, v113, v88
    v_fmac_f32 v41, v113, v89
    v_mfma_f32_16x16x32_bf16 v[32:35], v[148:151], v[80:83], v[32:35]
    ds_read_b128 v[64:67], v2 offset:51200
    v_fmac_f32 v36, v114, v104
    v_mfma_f32_16x16x32_bf16 v[40:43], v[148:151], v[84:87], v[40:43]
    v_fmac_f32 v37, v114, v105
    v_fmac_f32 v38, v114, v106
    v_mfma_f32_16x16x32_bf16 v[44:47], v[152:155], v[84:87], v[44:47]
    buffer_load_dwordx4 v1, s[16:19], s42 offen offset:1024 sc1 lds
    v_mfma_f32_16x16x32_bf16 v[36:39], v[152:155], v[80:83], v[36:39]
    ds_read_b128 v[68:71], v2 offset:52224
    v_fmac_f32 v32, v114, v100
    v_mfma_f32_16x16x32_bf16 v[48:51], v[156:159], v[80:83], v[48:51]
    v_fmac_f32 v33, v114, v101
    v_fmac_f32 v34, v114, v102
    v_mfma_f32_16x16x32_bf16 v[52:55], v[156:159], v[84:87], v[52:55]
    s_waitcnt lgkmcnt(2)
    v_fmac_f32 v42, v113, v90
    v_fmac_f32 v43, v113, v91
    v_mfma_f32_16x16x32_bf16 v[32:35], v[160:163], v[56:59], v[32:35]
    ds_read_b128 v[72:75], v2 offset:53248
    v_fmac_f32 v39, v114, v107
    v_mfma_f32_16x16x32_bf16 v[40:43], v[160:163], v[60:63], v[40:43]
    v_fmac_f32 v48, v112, v96
    v_fmac_f32 v49, v112, v97
    v_mfma_f32_16x16x32_bf16 v[44:47], v[164:167], v[60:63], v[44:47]
    buffer_load_dwordx4 v1, s[16:19], s42 offen offset:2048 sc1 lds
    v_mfma_f32_16x16x32_bf16 v[36:39], v[164:167], v[56:59], v[36:39]
    ds_read_b128 v[76:79], v2 offset:54272
    v_fmac_f32 v35, v114, v103
    v_mfma_f32_16x16x32_bf16 v[48:51], v[168:171], v[56:59], v[48:51]
    v_fmac_f32 v40, v115, v100
    v_fmac_f32 v41, v115, v101
    v_mfma_f32_16x16x32_bf16 v[52:55], v[168:171], v[60:63], v[52:55]
    s_waitcnt lgkmcnt(2)
    v_fmac_f32 v42, v115, v102
    v_fmac_f32 v43, v115, v103
    v_mfma_f32_16x16x32_bf16 v[32:35], v[172:175], v[64:67], v[32:35]
    ds_read_b128 v[80:83], v2 offset:55296
    v_fmac_f32 v44, v113, v92
    v_mfma_f32_16x16x32_bf16 v[40:43], v[172:175], v[68:71], v[40:43]
    v_fmac_f32 v50, v112, v98
    v_fmac_f32 v51, v112, v99
    v_mfma_f32_16x16x32_bf16 v[44:47], v[176:179], v[68:71], v[44:47]
    buffer_load_dwordx4 v1, s[16:19], s42 offen offset:3072 sc1 lds
    v_mfma_f32_16x16x32_bf16 v[36:39], v[176:179], v[64:67], v[36:39]
    s_add_u32 m0, s43, 49152
    ds_read_b128 v[84:87], v2 offset:56320
    v_fmac_f32 v52, v113, v96
    v_mfma_f32_16x16x32_bf16 v[48:51], v[180:183], v[64:67], v[48:51]
    s_add_u32 s42, s41, 49152
    v_fmac_f32 v45, v113, v93
    v_fmac_f32 v46, v113, v94
    v_mfma_f32_16x16x32_bf16 v[52:55], v[180:183], v[68:71], v[52:55]
    s_waitcnt lgkmcnt(2)
    v_fmac_f32 v47, v113, v95
    v_fmac_f32 v44, v115, v104
    v_mfma_f32_16x16x32_bf16 v[32:35], v[184:187], v[72:75], v[32:35]
    ds_read_b128 v[56:59], v2 offset:57344
    v_fmac_f32 v45, v115, v105
    v_mfma_f32_16x16x32_bf16 v[40:43], v[184:187], v[76:79], v[40:43]
    v_fmac_f32 v48, v114, v108
    v_fmac_f32 v49, v114, v109
    v_mfma_f32_16x16x32_bf16 v[44:47], v[188:191], v[76:79], v[44:47]
    buffer_load_dwordx4 v1, s[16:19], s42 offen offset:0 sc1 lds
    v_mfma_f32_16x16x32_bf16 v[36:39], v[188:191], v[72:75], v[36:39]
    ds_read_b128 v[60:63], v2 offset:58368
    v_fmac_f32 v53, v113, v97
    v_mfma_f32_16x16x32_bf16 v[48:51], v[192:195], v[72:75], v[48:51]
    s_nop 0
    v_fmac_f32 v46, v115, v106
    v_fmac_f32 v47, v115, v107
    v_mfma_f32_16x16x32_bf16 v[52:55], v[192:195], v[76:79], v[52:55]
    s_waitcnt lgkmcnt(2)
    v_mfma_f32_16x16x32_bf16 v[32:35], v[196:199], v[80:83], v[32:35]
    ds_read_b128 v[64:67], v2 offset:59392
    v_fmac_f32 v50, v114, v110
    v_mfma_f32_16x16x32_bf16 v[40:43], v[196:199], v[84:87], v[40:43]
    v_fmac_f32 v51, v114, v111
    v_fmac_f32 v54, v113, v98
    v_mfma_f32_16x16x32_bf16 v[44:47], v[200:203], v[84:87], v[44:47]
    buffer_load_dwordx4 v1, s[16:19], s42 offen offset:1024 sc1 lds
    v_mfma_f32_16x16x32_bf16 v[36:39], v[200:203], v[80:83], v[36:39]
    ds_read_b128 v[68:71], v2 offset:60416
    v_fmac_f32 v55, v113, v99
    v_mfma_f32_16x16x32_bf16 v[48:51], v[204:207], v[80:83], v[48:51]
    v_mfma_f32_16x16x32_bf16 v[52:55], v[204:207], v[84:87], v[52:55]
    s_waitcnt lgkmcnt(2)
    v_mfma_f32_16x16x32_bf16 v[32:35], v[208:211], v[56:59], v[32:35]
    ds_read_b128 v[72:75], v2 offset:61440
    v_mfma_f32_16x16x32_bf16 v[40:43], v[208:211], v[60:63], v[40:43]
    v_mfma_f32_16x16x32_bf16 v[44:47], v[212:215], v[60:63], v[44:47]
    buffer_load_dwordx4 v1, s[16:19], s42 offen offset:2048 sc1 lds
    v_mfma_f32_16x16x32_bf16 v[36:39], v[212:215], v[56:59], v[36:39]
    ds_read_b128 v[76:79], v2 offset:62464
    v_fmac_f32 v52, v115, v108
    v_mfma_f32_16x16x32_bf16 v[48:51], v[216:219], v[56:59], v[48:51]
    v_mfma_f32_16x16x32_bf16 v[52:55], v[216:219], v[60:63], v[52:55]
    s_waitcnt lgkmcnt(2)
    v_mfma_f32_16x16x32_bf16 v[32:35], v[220:223], v[64:67], v[32:35]
    ds_read_b128 v[80:83], v2 offset:63488
    v_mfma_f32_16x16x32_bf16 v[40:43], v[220:223], v[68:71], v[40:43]
    v_mfma_f32_16x16x32_bf16 v[44:47], v[224:227], v[68:71], v[44:47]
    buffer_load_dwordx4 v1, s[16:19], s42 offen offset:3072 sc1 lds
    v_mfma_f32_16x16x32_bf16 v[36:39], v[224:227], v[64:67], v[36:39]
    s_add_u32 s45, s45, 65536
    ds_read_b128 v[84:87], v2 offset:64512
    v_fmac_f32 v53, v115, v109
    v_mfma_f32_16x16x32_bf16 v[48:51], v[228:231], v[64:67], v[48:51]
    v_mfma_f32_16x16x32_bf16 v[52:55], v[228:231], v[68:71], v[52:55]
    s_waitcnt vmcnt(13) lgkmcnt(2)
    s_barrier
    v_mfma_f32_16x16x32_bf16 v[32:35], v[232:235], v[72:75], v[32:35]
    ds_read_b128 v[56:59], v1 offset:0
    v_mfma_f32_16x16x32_bf16 v[40:43], v[232:235], v[76:79], v[40:43]
    s_nop 0
    v_fmac_f32 v54, v115, v110
    v_fmac_f32 v55, v115, v111
    v_mfma_f32_16x16x32_bf16 v[44:47], v[236:239], v[76:79], v[44:47]
    v_mfma_f32_16x16x32_bf16 v[36:39], v[236:239], v[72:75], v[36:39]
    ds_read_b128 v[60:63], v1 offset:1024
    v_mfma_f32_16x16x32_bf16 v[48:51], v[240:243], v[72:75], v[48:51]
    v_mfma_f32_16x16x32_bf16 v[52:55], v[240:243], v[76:79], v[52:55]
    s_waitcnt lgkmcnt(2)
    v_mfma_f32_16x16x32_bf16 v[32:35], v[244:247], v[80:83], v[32:35]
    ds_read_b128 v[64:67], v1 offset:2048
    v_mfma_f32_16x16x32_bf16 v[40:43], v[244:247], v[84:87], v[40:43]
    v_mfma_f32_16x16x32_bf16 v[44:47], v[248:251], v[84:87], v[44:47]
    v_mfma_f32_16x16x32_bf16 v[36:39], v[248:251], v[80:83], v[36:39]
    ds_read_b128 v[68:71], v1 offset:3072
    v_mfma_f32_16x16x32_bf16 v[48:51], v[252:255], v[80:83], v[48:51]
    s_add_u32 s36, s36, 1
    v_mfma_f32_16x16x32_bf16 v[52:55], v[252:255], v[84:87], v[52:55]
    s_waitcnt lgkmcnt(2)
    s_cmp_lt_u32 s36, 32
    s_cbranch_scc1 L_a_b0
    s_nop 7
    s_and_b32 s44, s90, 0xffffffff
    s_cmp_lt_i32 s36, 1
    s_cselect_b32 s44, 0x5e00000, s44
    s_add_u32 s49, s44, s87
    s_max_u32 s44, s44, s88
    s_add_u32 s90, s90, 262144
    v_mul_f32 v120, v48, v116
    v_mul_f32 v121, v49, v116
    v_mul_f32 v120, v120, abs(v48)
    v_mul_f32 v121, v121, abs(v49)
    v_cvt_pk_bf16_f32 v48, v120, v121
    v_pk_max_i16 v48, v48, 0
    v_mul_f32 v120, v50, v116
    v_mul_f32 v121, v51, v116
    v_mul_f32 v120, v120, abs(v50)
    v_mul_f32 v121, v121, abs(v51)
    v_cvt_pk_bf16_f32 v49, v120, v121
    v_pk_max_i16 v49, v49, 0
    ds_write_b64 v3, v[48:49] offset:4096
    v_mul_f32 v120, v52, v117
    v_mul_f32 v121, v53, v117
    v_mul_f32 v120, v120, abs(v52)
    v_mul_f32 v121, v121, abs(v53)
    v_cvt_pk_bf16_f32 v52, v120, v121
    v_pk_max_i16 v52, v52, 0
    v_mul_f32 v120, v54, v117
    v_mul_f32 v121, v55, v117
    v_mul_f32 v120, v120, abs(v54)
    v_mul_f32 v121, v121, abs(v55)
    v_cvt_pk_bf16_f32 v53, v120, v121
    v_pk_max_i16 v53, v53, 0
    ds_write_b64 v3, v[52:53] offset:5120
    v_mul_f32 v120, v32, v116
    v_mul_f32 v121, v33, v116
    v_mul_f32 v120, v120, abs(v32)
    v_mul_f32 v121, v121, abs(v33)
    v_cvt_pk_bf16_f32 v32, v120, v121
    v_pk_max_i16 v32, v32, 0
    v_mul_f32 v120, v34, v116
    v_mul_f32 v121, v35, v116
    v_mul_f32 v120, v120, abs(v34)
    v_mul_f32 v121, v121, abs(v35)
    v_cvt_pk_bf16_f32 v33, v120, v121
    v_pk_max_i16 v33, v33, 0
    v_mul_f32 v120, v36, v116
    v_mul_f32 v121, v37, v116
    v_mul_f32 v120, v120, abs(v36)
    v_mul_f32 v121, v121, abs(v37)
    v_cvt_pk_bf16_f32 v34, v120, v121
    v_pk_max_i16 v34, v34, 0
    v_mul_f32 v120, v38, v116
    v_mul_f32 v121, v39, v116
    v_mul_f32 v120, v120, abs(v38)
    v_mul_f32 v121, v121, abs(v39)
    v_cvt_pk_bf16_f32 v35, v120, v121
    v_pk_max_i16 v35, v35, 0
    buffer_store_dwordx4 v[32:35], v1, s[16:19], s44 offen offset:0 sc1
    v_mul_f32 v120, v40, v117
    v_mul_f32 v121, v41, v117
    v_mul_f32 v120, v120, abs(v40)
    s_waitcnt lgkmcnt(0)
    s_barrier
    ds_read_b128 v[48:51], v4 offset:4096
    v_mul_f32 v121, v121, abs(v41)
    v_cvt_pk_bf16_f32 v40, v120, v121
    v_pk_max_i16 v40, v40, 0
    v_mul_f32 v120, v42, v117
    v_mul_f32 v121, v43, v117
    v_mul_f32 v120, v120, abs(v42)
    v_mul_f32 v121, v121, abs(v43)
    v_cvt_pk_bf16_f32 v41, v120, v121
    v_pk_max_i16 v41, v41, 0
    s_waitcnt lgkmcnt(0)
    buffer_store_dwordx4 v[48:51], v1, s[16:19], s49 offen sc1
    v_mul_f32 v120, v44, v117
    v_mul_f32 v121, v45, v117
    v_mul_f32 v120, v120, abs(v44)
    v_mul_f32 v121, v121, abs(v45)
    v_cvt_pk_bf16_f32 v42, v120, v121
    v_pk_max_i16 v42, v42, 0
    v_mul_f32 v120, v46, v117
    v_mul_f32 v121, v47, v117
    v_mul_f32 v120, v120, abs(v46)
    v_mul_f32 v121, v121, abs(v47)
    v_cvt_pk_bf16_f32 v43, v120, v121
    v_pk_max_i16 v43, v43, 0
    buffer_store_dwordx4 v[40:43], v1, s[16:19], s44 offen offset:1024 sc1
    s_waitcnt vmcnt(0)
    s_barrier
    buffer_store_dword v124, v124, s[16:19], s91 offen sc1
    s_add_u32 s91, s91, 65536
    s_waitcnt vmcnt(0)
    s_endpgm
L_spin10:
    s_mov_b32 s40, 0x20000
L_spin10_l:
    buffer_load_dword v56, v124, s[20:23], 0 offen sc1
    s_sub_u32 s40, s40, 1
    s_waitcnt vmcnt(0)
    v_cmp_eq_u32 vcc, v124, v56
    s_cbranch_scc1 L_back11
    s_cbranch_vccz L_back11
    s_sleep 8
    s_branch L_spin10_l
L_spin12:
    s_mov_b32 s40, 0x20000
L_spin12_l:
    buffer_load_dword v7, v5, s[16:19], s45 offen sc1
    s_sub_u32 s40, s40, 1
    s_waitcnt vmcnt(0)
    v_cmp_ne_u32 vcc, 0, v7
    s_cbranch_scc1 L_back13
    s_cbranch_vccz L_back13
    s_sleep 2
    s_branch L_spin12_l
L_spin14:
    s_mov_b32 s40, 0x20000
L_spin14_l:
    buffer_load_dword v7, v5, s[16:19], s45 offen sc1
    s_sub_u32 s40, s40, 1
    s_waitcnt vmcnt(0)
    v_cmp_ne_u32 vcc, 0, v7
    s_cbranch_scc1 L_back15
    s_cbranch_vccz L_back15
    s_sleep 2
    s_branch L_spin14_l
L_sspin16:
    s_mov_b32 s40, 0x20000
L_sspin16_l:
    buffer_load_dwordx2 v[36:37], v6, s[16:19], s46 offen offset:0 sc1
    buffer_load_dwordx2 v[38:39], v6, s[16:19], s46 offen offset:128 sc1
    buffer_load_dwordx2 v[40:41], v6, s[16:19], s46 offen offset:256 sc1
    buffer_load_dwordx2 v[42:43], v6, s[16:19], s46 offen offset:384 sc1
    s_sub_u32 s40, s40, 1
    s_waitcnt vmcnt(0)
    v_max3_u32 v44, v36, v37, v38
    v_max3_u32 v45, v39, v40, v41
    v_max3_u32 v44, v44, v42, v43
    v_max_u32 v44, v44, v45
    v_cmp_eq_u32 vcc, -1, v44
    s_cbranch_scc1 L_sback17
    s_cbranch_vccz L_sback17
    s_sleep 4
    s_branch L_sspin16_l
L_spin18:
    s_mov_b32 s40, 0x20000
L_spin18_l:
    buffer_load_dword v7, v5, s[16:19], s45 offen sc1
    s_sub_u32 s40, s40, 1
    s_waitcnt vmcnt(0)
    v_cmp_ne_u32 vcc, 0, v7
    s_cbranch_scc1 L_back19
    s_cbranch_vccz L_back19
    s_sleep 2
    s_branch L_spin18_l
L_sspin20:
    s_mov_b32 s40, 0x20000
L_sspin20_l:
    buffer_load_dwordx2 v[12:13], v6, s[16:19], s46 offen offset:0 sc1
    buffer_load_dwordx2 v[14:15], v6, s[16:19], s46 offen offset:128 sc1
    buffer_load_dwordx2 v[16:17], v6, s[16:19], s46 offen offset:256 sc1
    buffer_load_dwordx2 v[18:19], v6, s[16:19], s46 offen offset:384 sc1
    s_sub_u32 s40, s40, 1
    s_waitcnt vmcnt(0)
    v_max3_u32 v20, v12, v13, v14
    v_max3_u32 v21, v15, v16, v17
    v_max3_u32 v20, v20, v18, v19
    v_max_u32 v20, v20, v21
    v_cmp_eq_u32 vcc, -1, v20
    s_cbranch_scc1 L_sback21
    s_cbranch_vccz L_sback21
    s_sleep 4
    s_branch L_sspin20_l
L_odd:
    s_mov_b32 s33, s47
    s_lshl2_add_u32 s53, s48, s47
    s_cmp_lt_u32 s48, 8
    s_cselect_b32 s34, 16, 32
    s_add_u32 s34, s34, s48
    s_sub_u32 s37, s48, 8
    s_cmp_lt_u32 s37, 20
    s_cselect_b32 s44, -16, 0
    s_cmp_lt_u32 s37, 4
    s_cselect_b32 s44, 64, s44
    s_add_u32 s44, s44, s53
    s_lshl2_add_u32 s44, s44, s32
    s_lshl_b32 s44, s44, 13
    v_lshlrev_b32 v6, 7, v0
    s_waitcnt lgkmcnt(0)
    s_mov_b32 s12, s66
    s_mov_b32 s13, s67
    s_mov_b32 s14, 0x400000
    s_mov_b32 s15, 0x00020000
    s_mov_b32 s16, s84
    s_mov_b32 s17, s85
    s_mov_b32 s18, 0x5e00000
    s_mov_b32 s19, 0x00020000
    v_min_u32 v124, 1, v0
    v_lshlrev_b32 v124, 30, v124
    s_cmp_lt_u32 s48, 8
    s_cbranch_scc1 L_touch
    s_sub_u32 s37, s48, 12
    s_cmp_lt_u32 s37, 16
    s_cbranch_scc1 L_lines
    s_lshl_b32 s50, s33, 5
    s_or_b32 s37, s48, 16
    s_add_u32 s50, s50, s37
    s_lshl_b32 s46, s50, 15
    s_lshl_b32 s37, s32, 9
    s_add_u32 s46, s46, s37
    v_lshrrev_b32 v48, 3, v0
    v_and_b32 v49, 0x70, v1
    v_lshl_add_u32 v48, v48, 11, v49
    v_add_u32 v49, 16384, v48
    s_mov_b32 s8, s64
    s_mov_b32 s9, s65
    s_mov_b32 s10, 0x400000
    s_mov_b32 s11, 0x00020000
    buffer_load_dwordx4 v[16:19], v48, s[8:11], s46 offen offset:0
    buffer_load_dwordx4 v[20:23], v48, s[8:11], s46 offen offset:128
    buffer_load_dwordx4 v[24:27], v48, s[8:11], s46 offen offset:256
    buffer_load_dwordx4 v[28:31], v48, s[8:11], s46 offen offset:384
    buffer_load_dwordx4 v[32:35], v49, s[8:11], s46 offen offset:0
    buffer_load_dwordx4 v[36:39], v49, s[8:11], s46 offen offset:128
    buffer_load_dwordx4 v[40:43], v49, s[8:11], s46 offen offset:256
    buffer_load_dwordx4 v[44:47], v49, s[8:11], s46 offen offset:384
    s_mov_b32 s86, 0x3f803f80
    v_and_b32 v56, 1, v0
    v_lshlrev_b32 v56, 7, v56
    v_bfe_u32 v57, v0, 1, 1
    v_lshl_add_u32 v56, v57, 6, v56
    v_and_b32 v57, 0x38, v0
    v_add_u32 v56, v57, v56
    s_sub_u32 s46, 127, s50
    s_lshl_b32 s46, s46, 10
    s_lshl_b32 s37, s32, 8
    s_add_u32 s46, s46, s37
    s_add_u32 s46, s46, 0x5400000
    s_waitcnt vmcnt(0)
    v_dot2_f32_bf16 v48, v16, s86, 0
    v_dot2_f32_bf16 v49, v16, v16, 0
    v_dot2_f32_bf16 v50, v24, s86, 0
    v_dot2_f32_bf16 v51, v24, v24, 0
    v_dot2_f32_bf16 v52, v32, s86, 0
    v_dot2_f32_bf16 v53, v32, v32, 0
    v_dot2_f32_bf16 v54, v40, s86, 0
    v_dot2_f32_bf16 v55, v40, v40, 0
    v_dot2_f32_bf16 v48, v17, s86, v48
    v_dot2_f32_bf16 v49, v17, v17, v49
    v_dot2_f32_bf16 v50, v25, s86, v50
    v_dot2_f32_bf16 v51, v25, v25, v51
    v_dot2_f32_bf16 v52, v33, s86, v52
    v_dot2_f32_bf16 v53, v33, v33, v53
    v_dot2_f32_bf16 v54, v41, s86, v54
    v_dot2_f32_bf16 v55, v41, v41, v55
    v_dot2_f32_bf16 v48, v18, s86, v48
    v_dot2_f32_bf16 v49, v18, v18, v49
    v_dot2_f32_bf16 v50, v26, s86, v50
    v_dot2_f32_bf16 v51, v26, v26, v51
    v_dot2_f32_bf16 v52, v34, s86, v52
    v_dot2_f32_bf16 v53, v34, v34, v53
    v_dot2_f32_bf16 v54, v42, s86, v54
    v_dot2_f32_bf16 v55, v42, v42, v55
    v_dot2_f32_bf16 v48, v19, s86, v48
    v_dot2_f32_bf16 v49, v19, v19, v49
    v_dot2_f32_bf16 v50, v27, s86, v50
    v_dot2_f32_bf16 v51, v27, v27, v51
    v_dot2_f32_bf16 v52, v35, s86, v52
    v_dot2_f32_bf16 v53, v35, v35, v53
    v_dot2_f32_bf16 v54, v43, s86, v54
    v_dot2_f32_bf16 v55, v43, v43, v55
    v_dot2_f32_bf16 v48, v20, s86, v48
    v_dot2_f32_bf16 v49, v20, v20, v49
    v_dot2_f32_bf16 v50, v28, s86, v50
    v_dot2_f32_bf16 v51, v28, v28, v51
    v_dot2_f32_bf16 v52, v36, s86, v52
    v_dot2_f32_bf16 v53, v36, v36, v53
    v_dot2_f32_bf16 v54, v44, s86, v54
    v_dot2_f32_bf16 v55, v44, v44, v55
    v_dot2_f32_bf16 v48, v21, s86, v48
    v_dot2_f32_bf16 v49, v21, v21, v49
    v_dot2_f32_bf16 v50, v29, s86, v50
    v_dot2_f32_bf16 v51, v29, v29, v51
    v_dot2_f32_bf16 v52, v37, s86, v52
    v_dot2_f32_bf16 v53, v37, v37, v53
    v_dot2_f32_bf16 v54, v45, s86, v54
    v_dot2_f32_bf16 v55, v45, v45, v55
    v_dot2_f32_bf16 v48, v22, s86, v48
    v_dot2_f32_bf16 v49, v22, v22, v49
    v_dot2_f32_bf16 v50, v30, s86, v50
    v_dot2_f32_bf16 v51, v30, v30, v51
    v_dot2_f32_bf16 v52, v38, s86, v52
    v_dot2_f32_bf16 v53, v38, v38, v53
    v_dot2_f32_bf16 v54, v46, s86, v54
    v_dot2_f32_bf16 v55, v46, v46, v55
    v_dot2_f32_bf16 v48, v23, s86, v48
    v_dot2_f32_bf16 v49, v23, v23, v49
    v_dot2_f32_bf16 v50, v31, s86, v50
    v_dot2_f32_bf16 v51, v31, v31, v51
    v_dot2_f32_bf16 v52, v39, s86, v52
    v_dot2_f32_bf16 v53, v39, v39, v53
    v_dot2_f32_bf16 v54, v47, s86, v54
    v_dot2_f32_bf16 v55, v47, v47, v55
    v_add_f32_dpp v48, v48, v48 quad_perm:[1,0,3,2] row_mask:0xf bank_mask:0xf
    v_add_f32_dpp v49, v49, v49 quad_perm:[1,0,3,2] row_mask:0xf bank_mask:0xf
    v_add_f32_dpp v50, v50, v50 quad_perm:[1,0,3,2] row_mask:0xf bank_mask:0xf
    v_add_f32_dpp v51, v51, v51 quad_perm:[1,0,3,2] row_mask:0xf bank_mask:0xf
    v_add_f32_dpp v52, v52, v52 quad_perm:[1,0,3,2] row_mask:0xf bank_mask:0xf
    v_add_f32_dpp v53, v53, v53 quad_perm:[1,0,3,2] row_mask:0xf bank_mask:0xf
    v_add_f32_dpp v54, v54, v54 quad_perm:[1,0,3,2] row_mask:0xf bank_mask:0xf
    v_add_f32_dpp v55, v55, v55 quad_perm:[1,0,3,2] row_mask:0xf bank_mask:0xf
    v_add_f32_dpp v48, v48, v48 quad_perm:[2,3,0,1] row_mask:0xf bank_mask:0xf
    v_add_f32_dpp v49, v49, v49 quad_perm:[2,3,0,1] row_mask:0xf bank_mask:0xf
    v_add_f32_dpp v50, v50, v50 quad_perm:[2,3,0,1] row_mask:0xf bank_mask:0xf
    v_add_f32_dpp v51, v51, v51 quad_perm:[2,3,0,1] row_mask:0xf bank_mask:0xf
    v_add_f32_dpp v52, v52, v52 quad_perm:[2,3,0,1] row_mask:0xf bank_mask:0xf
    v_add_f32_dpp v53, v53, v53 quad_perm:[2,3,0,1] row_mask:0xf bank_mask:0xf
    v_add_f32_dpp v54, v54, v54 quad_perm:[2,3,0,1] row_mask:0xf bank_mask:0xf
    v_add_f32_dpp v55, v55, v55 quad_perm:[2,3,0,1] row_mask:0xf bank_mask:0xf
    v_add_f32_dpp v48, v48, v48 row_half_mirror row_mask:0xf bank_mask:0xf
    v_add_f32_dpp v49, v49, v49 row_half_mirror row_mask:0xf bank_mask:0xf
    v_add_f32_dpp v50, v50, v50 row_half_mirror row_mask:0xf bank_mask:0xf
    v_add_f32_dpp v51, v51, v51 row_half_mirror row_mask:0xf bank_mask:0xf
    v_add_f32_dpp v52, v52, v52 row_half_mirror row_mask:0xf bank_mask:0xf
    v_add_f32_dpp v53, v53, v53 row_half_mirror row_mask:0xf bank_mask:0xf
    v_add_f32_dpp v54, v54, v54 row_half_mirror row_mask:0xf bank_mask:0xf
    v_add_f32_dpp v55, v55, v55 row_half_mirror row_mask:0xf bank_mask:0xf
    s_mov_b32 exec_lo, 0x2020202
    s_mov_b32 exec_hi, 0x2020202
    v_mov_b32 v48, v50
    v_mov_b32 v49, v51
    s_mov_b32 exec_lo, 0x4040404
    s_mov_b32 exec_hi, 0x4040404
    v_mov_b32 v48, v52
    v_mov_b32 v49, v53
    s_mov_b32 exec_lo, 0x8080808
    s_mov_b32 exec_hi, 0x8080808
    v_mov_b32 v48, v54
    v_mov_b32 v49, v55
    s_mov_b32 exec_lo, 0x0f0f0f0f
    s_mov_b32 exec_hi, 0x0f0f0f0f
    buffer_store_dwordx2 v[48:49], v56, s[16:19], s46 offen sc1
    s_mov_b64 exec, -1
    s_waitcnt vmcnt(0)
    s_branch L_job_end
L_lines:
    buffer_load_dword v248, v6, s[12:15], s44 offen
    s_mov_b32 s12, s68
    s_mov_b32 s13, s69
    s_mov_b32 s14, 0x200000
    s_mov_b32 s15, 0x00020000
    s_sub_u32 s39, 0x180, s12
    s_and_b32 s39, s39, 0x380
    s_sub_u32 s37, s48, 12
    s_lshl2_add_u32 s37, s37, s32
    s_lshl_b32 s37, s37, 15
    s_add_u32 s39, s39, s37
    v_and_b32 v7, 31, v0
    v_lshlrev_b32 v7, 10, v7
    buffer_load_dword v247, v7, s[12:15], s39 offen
    s_mov_b32 s14, 0
    s_sub_u32 s53, s53, 48
    s_and_b32 s37, s53, 7
    s_cmp_lt_u32 s37, 2
    s_cselect_b32 s87, 2, 3
    s_cselect_b32 s36, 34, 32
    s_cmp_ge_u32 s53, 32
    s_cselect_b32 s87, 2, s87
    s_cselect_b32 s36, 35, s36
    s_cselect_b32 s38, 5, 0
    s_cmp_lt_u32 s37, s38
    s_cselect_b32 s37, 0x5e00000, 0
    s_lshl_b32 s38, s53, 10
    s_add_u32 s37, s37, s38
    s_lshl_b32 s38, s32, 16
    s_add_u32 s37, s37, s38
    s_add_u32 s37, s37, 0x5500000
    s_sub_u32 s87, s32, s87
    s_cmp_lt_u32 s87, s36
    s_cselect_b32 s38, -1, 0
    v_mov_b32 v16, s38
    s_add_u32 s87, s87, 4
    buffer_store_dwordx4 v[16:19], v1, s[16:19], s37 offen sc1
    s_add_u32 s37, s37, 262144
    s_cmp_lt_u32 s87, s36
    s_cselect_b32 s38, -1, 0
    v_mov_b32 v20, s38
    s_add_u32 s87, s87, 4
    buffer_store_dwordx4 v[20:23], v1, s[16:19], s37 offen sc1
    s_add_u32 s37, s37, 262144
    s_cmp_lt_u32 s87, s36
    s_cselect_b32 s38, -1, 0
    v_mov_b32 v24, s38
    s_add_u32 s87, s87, 4
    buffer_store_dwordx4 v[24:27], v1, s[16:19], s37 offen sc1
    s_add_u32 s37, s37, 262144
    s_cmp_lt_u32 s87, s36
    s_cselect_b32 s38, -1, 0
    v_mov_b32 v28, s38
    s_add_u32 s87, s87, 4
    buffer_store_dwordx4 v[28:31], v1, s[16:19], s37 offen sc1
    s_add_u32 s37, s37, 262144
    s_cmp_lt_u32 s87, s36
    s_cselect_b32 s38, -1, 0
    v_mov_b32 v32, s38
    s_add_u32 s87, s87, 4
    buffer_store_dwordx4 v[32:35], v1, s[16:19], s37 offen sc1
    s_add_u32 s37, s37, 262144
    s_cmp_lt_u32 s87, s36
    s_cselect_b32 s38, -1, 0
    v_mov_b32 v36, s38
    s_add_u32 s87, s87, 4
    buffer_store_dwordx4 v[36:39], v1, s[16:19], s37 offen sc1
    s_add_u32 s37, s37, 262144
    s_cmp_lt_u32 s87, s36
    s_cselect_b32 s38, -1, 0
    v_mov_b32 v40, s38
    s_add_u32 s87, s87, 4
    buffer_store_dwordx4 v[40:43], v1, s[16:19], s37 offen sc1
    s_add_u32 s37, s37, 262144
    s_cmp_lt_u32 s87, s36
    s_cselect_b32 s38, -1, 0
    v_mov_b32 v44, s38
    s_add_u32 s87, s87, 4
    buffer_store_dwordx4 v[44:47], v1, s[16:19], s37 offen sc1
    s_add_u32 s37, s37, 262144
    s_cmp_lt_u32 s87, s36
    s_cselect_b32 s38, -1, 0
    v_mov_b32 v48, s38
    s_add_u32 s87, s87, 4
    buffer_store_dwordx4 v[48:51], v1, s[16:19], s37 offen sc1
    s_add_u32 s37, s37, 262144
    s_cmp_lt_u32 s87, s36
    s_cselect_b32 s38, -1, 0
    v_mov_b32 v52, s38
    s_add_u32 s87, s87, 4
    buffer_store_dwordx4 v[52:55], v1, s[16:19], s37 offen sc1
    s_add_u32 s37, s37, 262144
    v_mov_b32 v8, -1
    v_mov_b32 v9, -1
    v_mov_b32 v10, -1
    v_mov_b32 v11, -1
    s_lshl2_add_u32 s38, s53, s32
    s_lshl_b32 s38, s38, 10
    s_add_u32 s38, s38, 0x5440000
    buffer_store_dwordx4 v[8:11], v1, s[16:19], s38 offen sc1
    s_waitcnt vmcnt(0)
L_job_end:
    s_mov_b32 s8, s82
    s_mov_b32 s9, s83
    s_mov_b32 s10, 0x100
    s_mov_b32 s11, 0x00020000
    v_mov_b32 v123, 1
    s_barrier
    s_cmp_lg_u32 s32, 3
    s_cbranch_scc1 L_arr22
    buffer_atomic_add v123, v124, s[8:11], 0 offen sc0
    s_waitcnt vmcnt(0)
    v_readfirstlane_b32 s37, v123
    s_nop 0
    s_cmp_lg_u32 s37, 95
    s_cbranch_scc1 L_arr22
    buffer_store_dword v123, v124, s[8:11], 0 offen offset:128 sc1
L_arr22:
L_touch:
    buffer_load_dword v248, v6, s[12:15], s44 offen
    s_lshl_b32 s91, s33, 6
    s_add_u32 s91, s91, s34
    s_lshl_b32 s91, s91, 7
    s_add_u32 s91, s91, 0x5520000
    s_cmp_eq_u32 s32, 1
    s_cselect_b32 s91, s91, 0x5f00000
    s_cmp_ge_u32 s34, 60
    s_cbranch_scc1 L_role_60
    s_cmp_ge_u32 s34, 44
    s_cbranch_scc1 L_role_44
    s_cmp_ge_u32 s34, 40
    s_cbranch_scc1 L_role_40
L_role_16:
    s_sub_u32 s35, s34, 16
    s_lshl_b32 s54, s35, 8
    s_mov_b32 s12, s68
    s_mov_b32 s13, s69
    s_mov_b32 s14, 0x200000
    s_mov_b32 s15, 0x00020000
    s_mov_b32 s39, 2048
    v_lshrrev_b32 v52, 3, v0
    v_lshlrev_b32 v53, 2, v0
    v_and_b32 v53, 64, v53
    v_and_b32 v54, 0x70, v1
    v_xor_b32 v53, v53, v54
    v_mad_u32_u24 v44, v52, s39, v53
    v_add_u32 v45, 16384, v44
    v_add_u32 v46, 128, v44
    v_add_u32 v47, 16512, v44
    s_mul_i32 s38, s32, 32768
    s_add_u32 s54, s54, s38
    s_lshl_b32 s42, s32, 11
    s_add_u32 m0, s42, 0
    s_nop 0
    buffer_load_dwordx4 v44, s[12:15], s54 offen lds
    s_add_u32 m0, s42, 1024
    s_nop 0
    buffer_load_dwordx4 v45, s[12:15], s54 offen lds
    s_add_u32 m0, s42, 8192
    s_nop 0
    buffer_load_dwordx4 v46, s[12:15], s54 offen lds
    s_add_u32 m0, s42, 9216
    s_nop 0
    buffer_load_dwordx4 v47, s[12:15], s54 offen lds
    s_add_u32 s54, s54, 131072
    s_add_u32 m0, s42, 16384
    s_nop 0
    buffer_load_dwordx4 v44, s[12:15], s54 offen lds
    s_add_u32 m0, s42, 17408
    s_nop 0
    buffer_load_dwordx4 v45, s[12:15], s54 offen lds
    s_add_u32 m0, s42, 24576
    s_nop 0
    buffer_load_dwordx4 v46, s[12:15], s54 offen lds
    s_add_u32 m0, s42, 25600
    s_nop 0
    buffer_load_dwordx4 v47, s[12:15], s54 offen lds
    s_add_u32 s54, s54, 131072
    s_add_u32 m0, s42, 32768
    s_nop 0
    buffer_load_dwordx4 v44, s[12:15], s54 offen lds
    s_add_u32 m0, s42, 33792
    s_nop 0
    buffer_load_dwordx4 v45, s[12:15], s54 offen lds
    s_add_u32 m0, s42, 40960
    s_nop 0
    buffer_load_dwordx4 v46, s[12:15], s54 offen lds
    s_add_u32 m0, s42, 41984
    s_nop 0
    buffer_load_dwordx4 v47, s[12:15], s54 offen lds
    s_add_u32 s54, s54, 131072
    s_add_u32 m0, s42, 49152
    s_nop 0
    buffer_load_dwordx4 v44, s[12:15], s54 offen lds
    s_add_u32 m0, s42, 50176
    s_nop 0
    buffer_load_dwordx4 v45, s[12:15], s54 offen lds
    s_add_u32 m0, s42, 57344
    s_nop 0
    buffer_load_dwordx4 v46, s[12:15], s54 offen lds
    s_add_u32 m0, s42, 58368
    s_nop 0
    buffer_load_dwordx4 v47, s[12:15], s54 offen lds
    s_add_u32 s54, s54, 131072
    s_add_u32 m0, s42, 65536
    s_nop 0
    buffer_load_dwordx4 v44, s[12:15], s54 offen lds
    s_add_u32 m0, s42, 66560
    s_nop 0
    buffer_load_dwordx4 v45, s[12:15], s54 offen lds
    s_add_u32 m0, s42, 73728
    s_nop 0
    buffer_load_dwordx4 v46, s[12:15], s54 offen lds
    s_add_u32 m0, s42, 74752
    s_nop 0
    buffer_load_dwordx4 v47, s[12:15], s54 offen lds
    s_add_u32 s54, s54, 131072
    v_lshrrev_b32 v52, 4, v0
    v_bfe_u32 v53, v0, 2, 2
    v_lshl_add_u32 v52, v52, 3, v53
    v_lshlrev_b32 v52, 7, v52
    v_lshrrev_b32 v53, 1, v53
    v_lshl_add_u32 v52, v53, 6, v52
    v_and_b32 v53, 3, v0
    v_lshl_add_u32 v52, v53, 4, v52
    s_lshr_b32 s37, s32, 1
    s_lshl_b32 s37, s37, 13
    s_and_b32 s38, s32, 1
    s_lshl_b32 s38, s38, 6
    s_add_u32 s37, s37, s38
    s_add_u32 s37, s37, 0
    v_xor_b32 v48, s37, v52
    s_lshr_b32 s37, s32, 1
    s_lshl_b32 s37, s37, 13
    s_and_b32 s38, s32, 1
    s_lshl_b32 s38, s38, 6
    s_add_u32 s37, s37, s38
    s_add_u32 s37, s37, 8
    v_xor_b32 v49, s37, v52
    v_add_u32 v2, 98304, v1
    v_mov_b32 v108, 0
    v_mov_b32 v109, 0
    v_mov_b32 v110, 0
    v_mov_b32 v111, 0
    v_mov_b32 v112, 0
    v_mov_b32 v113, 0
    v_mov_b32 v114, 0
    v_mov_b32 v115, 0
    v_mov_b32 v13, 0x3f80
    v_and_b32 v12, 1, v0
    v_lshlrev_b32 v12, 4, v12
    v_lshlrev_b32 v12, v12, v13
    s_mov_b32 exec_lo, 0x300003
    s_mov_b32 exec_hi, 0x30000300
    v_mov_b32 v108, v12
    v_mov_b32 v114, v12
    s_mov_b32 exec_lo, 0xc0000c
    s_mov_b32 exec_hi, 0xc0000c00
    v_mov_b32 v109, v12
    v_mov_b32 v115, v12
    s_mov_b64 exec, -1
    s_lshl_b32 s37, s33, 6
    s_add_u32 s37, s37, 0
    s_lshl_b32 s37, s37, 7
    v_lshl_add_u32 v4, v0, 7, s37
    s_cmp_eq_u32 s32, 0
    s_cselect_b32 s37, 16, 0
    v_cmp_le_u32 vcc, s37, v0
    s_nop 1
    v_cndmask_b32 v4, v4, 2.0, vcc
    s_mov_b32 s86, 0x3f803f80
    s_lshl_b32 s43, s32, 12
    s_mul_i32 s41, s33, 2097152
    s_add_u32 s41, s41, 0x0
    s_add_u32 s41, s41, s43
    s_lshl_b32 s38, s35, 2
    s_add_u32 s38, s38, s32
    s_mul_i32 s90, s33, 2097152
    s_add_u32 s90, s90, 0x7f0000
    s_lshl_b32 s37, s38, 11
    s_add_u32 s90, s90, s37
    v_and_b32 v12, 15, v0
    v_and_b32 v13, 0x30, v0
    v_lshl_add_u32 v3, v12, 11, v13
    s_lshl_b32 s37, s38, 6
    v_add_u32 v3, s37, v3
    s_lshl_b32 s50, s33, 20
    s_add_u32 s50, s50, 983040
    s_add_u32 s88, s84, 0x5000000
    s_addc_u32 s89, s85, 0
    s_mov_b32 s8, s64
    s_mov_b32 s9, s65
    s_mov_b32 s10, 0x400000
    s_mov_b32 s11, 0x00020000
    v_bfe_u32 v13, v0, 4, 1
    v_lshl_add_u32 v12, v12, 1, v13
    s_lshl_b32 s37, s32, 2
    s_add_u32 s37, s37, 65536
    v_lshl_add_u32 v6, v12, 4, s37
    v_add_u32 v7, 65536, v1
    v_and_b32 v12, 31, v0
    v_lshrrev_b32 v13, 5, v0
    v_lshlrev_b32 v12, 2, v12
    v_lshl_add_u32 v8, v13, 10, v12
    s_mul_i32 s46, s33, 65536
    s_add_u32 s46, s46, 0x543f800
    s_lshl_b32 s37, s35, 7
    s_add_u32 s46, s46, s37
    s_cmp_eq_u32 s32, 2
    s_cselect_b32 s46, s46, 0x5f00000
    s_mov_b32 s36, -1
    v_add_u32 v50, 0, v48
    v_add_u32 v51, 0, v49
    s_waitcnt vmcnt(16)
    s_barrier
    ds_read_b64_tr_b16 a[0:1], v50 offset:0
    ds_read_b64_tr_b16 a[2:3], v50 offset:512
    ds_read_b64_tr_b16 a[4:5], v51 offset:0
    ds_read_b64_tr_b16 a[6:7], v51 offset:512
    ds_read_b64_tr_b16 a[8:9], v50 offset:4096
    ds_read_b64_tr_b16 a[10:11], v50 offset:4608
    ds_read_b64_tr_b16 a[12:13], v51 offset:4096
    ds_read_b64_tr_b16 a[14:15], v51 offset:4608
    s_add_u32 m0, s42, 81920
    s_nop 0
    buffer_load_dwordx4 v44, s[12:15], s54 offen lds
    s_add_u32 m0, s42, 82944
    s_nop 0
    buffer_load_dwordx4 v45, s[12:15], s54 offen lds
    s_add_u32 m0, s42, 90112
    s_nop 0
    buffer_load_dwordx4 v46, s[12:15], s54 offen lds
    s_add_u32 m0, s42, 91136
    s_nop 0
    buffer_load_dwordx4 v47, s[12:15], s54 offen lds
    s_add_u32 s54, s54, 131072
    s_waitcnt lgkmcnt(0)
    v_add_u32 v50, 16384, v48
    v_add_u32 v51, 16384, v49
    s_waitcnt vmcnt(16)
    s_barrier
    ds_read_b64_tr_b16 a[16:17], v50 offset:0
    ds_read_b64_tr_b16 a[18:19], v50 offset:512
    ds_read_b64_tr_b16 a[20:21], v51 offset:0
    ds_read_b64_tr_b16 a[22:23], v51 offset:512
    ds_read_b64_tr_b16 a[24:25], v50 offset:4096
    ds_read_b64_tr_b16 a[26:27], v50 offset:4608
    ds_read_b64_tr_b16 a[28:29], v51 offset:4096
    ds_read_b64_tr_b16 a[30:31], v51 offset:4608
    s_add_u32 m0, s42, 0
    s_nop 0
    buffer_load_dwordx4 v44, s[12:15], s54 offen lds
    s_add_u32 m0, s42, 1024
    s_nop 0
    buffer_load_dwordx4 v45, s[12:15], s54 offen lds
    s_add_u32 m0, s42, 8192
    s_nop 0
    buffer_load_dwordx4 v46, s[12:15], s54 offen lds
    s_add_u32 m0, s42, 9216
    s_nop 0
    buffer_load_dwordx4 v47, s[12:15], s54 offen lds
    s_add_u32 s54, s54, 131072
    s_waitcnt lgkmcnt(0)
    v_add_u32 v50, 32768, v48
    v_add_u32 v51, 32768, v49
    s_waitcnt vmcnt(16)
    s_barrier
    ds_read_b64_tr_b16 a[32:33], v50 offset:0
    ds_read_b64_tr_b16 a[34:35], v50 offset:512
    ds_read_b64_tr_b16 a[36:37], v51 offset:0
    ds_read_b64_tr_b16 a[38:39], v51 offset:512
    ds_read_b64_tr_b16 a[40:41], v50 offset:4096
    ds_read_b64_tr_b16 a[42:43], v50 offset:4608
    ds_read_b64_tr_b16 a[44:45], v51 offset:4096
    ds_read_b64_tr_b16 a[46:47], v51 offset:4608
    s_add_u32 m0, s42, 16384
    s_nop 0
    buffer_load_dwordx4 v44, s[12:15], s54 offen lds
    s_add_u32 m0, s42, 17408
    s_nop 0
    buffer_load_dwordx4 v45, s[12:15], s54 offen lds
    s_add_u32 m0, s42, 24576
    s_nop 0
    buffer_load_dwordx4 v46, s[12:15], s54 offen lds
    s_add_u32 m0, s42, 25600
    s_nop 0
    buffer_load_dwordx4 v47, s[12:15], s54 offen lds
    s_add_u32 s54, s54, 131072
    s_waitcnt lgkmcnt(0)
    v_add_u32 v50, 49152, v48
    v_add_u32 v51, 49152, v49
    s_waitcnt vmcnt(16)
    s_barrier
    ds_read_b64_tr_b16 a[48:49], v50 offset:0
    ds_read_b64_tr_b16 a[50:51], v50 offset:512
    ds_read_b64_tr_b16 a[52:53], v51 offset:0
    ds_read_b64_tr_b16 a[54:55], v51 offset:512
    ds_read_b64_tr_b16 a[56:57], v50 offset:4096
    ds_read_b64_tr_b16 a[58:59], v50 offset:4608
    ds_read_b64_tr_b16 a[60:61], v51 offset:4096
    ds_read_b64_tr_b16 a[62:63], v51 offset:4608
    s_add_u32 m0, s42, 32768
    s_nop 0
    buffer_load_dwordx4 v44, s[12:15], s54 offen lds
    s_add_u32 m0, s42, 33792
    s_nop 0
    buffer_load_dwordx4 v45, s[12:15], s54 offen lds
    s_add_u32 m0, s42, 40960
    s_nop 0
    buffer_load_dwordx4 v46, s[12:15], s54 offen lds
    s_add_u32 m0, s42, 41984
    s_nop 0
    buffer_load_dwordx4 v47, s[12:15], s54 offen lds
    s_add_u32 s54, s54, 131072
    s_waitcnt lgkmcnt(0)
    v_add_u32 v50, 65536, v48
    v_add_u32 v51, 65536, v49
    s_waitcnt vmcnt(16)
    s_barrier
    ds_read_b64_tr_b16 a[64:65], v50 offset:0
    ds_read_b64_tr_b16 a[66:67], v50 offset:512
    ds_read_b64_tr_b16 a[68:69], v51 offset:0
    ds_read_b64_tr_b16 a[70:71], v51 offset:512
    ds_read_b64_tr_b16 a[72:73], v50 offset:4096
    ds_read_b64_tr_b16 a[74:75], v50 offset:4608
    ds_read_b64_tr_b16 a[76:77], v51 offset:4096
    ds_read_b64_tr_b16 a[78:79], v51 offset:4608
    s_add_u32 m0, s42, 49152
    s_nop 0
    buffer_load_dwordx4 v44, s[12:15], s54 offen lds
    s_add_u32 m0, s42, 50176
    s_nop 0
    buffer_load_dwordx4 v45, s[12:15], s54 offen lds
    s_add_u32 m0, s42, 57344
    s_nop 0
    buffer_load_dwordx4 v46, s[12:15], s54 offen lds
    s_add_u32 m0, s42, 58368
    s_nop 0
    buffer_load_dwordx4 v47, s[12:15], s54 offen lds
    s_add_u32 s54, s54, 131072
    s_waitcnt lgkmcnt(0)
    v_add_u32 v50, 81920, v48
    v_add_u32 v51, 81920, v49
    s_waitcnt vmcnt(16)
    s_barrier
    ds_read_b64_tr_b16 a[80:81], v50 offset:0
    ds_read_b64_tr_b16 a[82:83], v50 offset:512
    ds_read_b64_tr_b16 a[84:85], v51 offset:0
    ds_read_b64_tr_b16 a[86:87], v51 offset:512
    ds_read_b64_tr_b16 a[88:89], v50 offset:4096
    ds_read_b64_tr_b16 a[90:91], v50 offset:4608
    ds_read_b64_tr_b16 a[92:93], v51 offset:4096
    ds_read_b64_tr_b16 a[94:95], v51 offset:4608
    s_add_u32 m0, s42, 65536
    s_nop 0
    buffer_load_dwordx4 v44, s[12:15], s54 offen lds
    s_add_u32 m0, s42, 66560
    s_nop 0
    buffer_load_dwordx4 v45, s[12:15], s54 offen lds
    s_add_u32 m0, s42, 73728
    s_nop 0
    buffer_load_dwordx4 v46, s[12:15], s54 offen lds
    s_add_u32 m0, s42, 74752
    s_nop 0
    buffer_load_dwordx4 v47, s[12:15], s54 offen lds
    s_add_u32 s54, s54, 131072
    s_waitcnt lgkmcnt(0)
    v_add_u32 v50, 0, v48
    v_add_u32 v51, 0, v49
    s_waitcnt vmcnt(16)
    s_barrier
    ds_read_b64_tr_b16 a[96:97], v50 offset:0
    ds_read_b64_tr_b16 a[98:99], v50 offset:512
    ds_read_b64_tr_b16 a[100:101], v51 offset:0
    ds_read_b64_tr_b16 a[102:103], v51 offset:512
    ds_read_b64_tr_b16 a[104:105], v50 offset:4096
    ds_read_b64_tr_b16 a[106:107], v50 offset:4608
    ds_read_b64_tr_b16 a[108:109], v51 offset:4096
    ds_read_b64_tr_b16 a[110:111], v51 offset:4608
    s_add_u32 m0, s42, 81920
    s_nop 0
    buffer_load_dwordx4 v44, s[12:15], s54 offen lds
    s_add_u32 m0, s42, 82944
    s_nop 0
    buffer_load_dwordx4 v45, s[12:15], s54 offen lds
    s_add_u32 m0, s42, 90112
    s_nop 0
    buffer_load_dwordx4 v46, s[12:15], s54 offen lds
    s_add_u32 m0, s42, 91136
    s_nop 0
    buffer_load_dwordx4 v47, s[12:15], s54 offen lds
    s_add_u32 s54, s54, 131072
    s_waitcnt lgkmcnt(0)
    v_add_u32 v50, 16384, v48
    v_add_u32 v51, 16384, v49
    s_waitcnt vmcnt(16)
    s_barrier
    ds_read_b64_tr_b16 a[112:113], v50 offset:0
    ds_read_b64_tr_b16 a[114:115], v50 offset:512
    ds_read_b64_tr_b16 a[116:117], v51 offset:0
    ds_read_b64_tr_b16 a[118:119], v51 offset:512
    ds_read_b64_tr_b16 a[120:121], v50 offset:4096
    ds_read_b64_tr_b16 a[122:123], v50 offset:4608
    ds_read_b64_tr_b16 a[124:125], v51 offset:4096
    ds_read_b64_tr_b16 a[126:127], v51 offset:4608
    s_add_u32 m0, s42, 0
    s_nop 0
    buffer_load_dwordx4 v44, s[12:15], s54 offen lds
    s_add_u32 m0, s42, 1024
    s_nop 0
    buffer_load_dwordx4 v45, s[12:15], s54 offen lds
    s_add_u32 m0, s42, 8192
    s_nop 0
    buffer_load_dwordx4 v46, s[12:15], s54 offen lds
    s_add_u32 m0, s42, 9216
    s_nop 0
    buffer_load_dwordx4 v47, s[12:15], s54 offen lds
    s_add_u32 s54, s54, 131072
    s_waitcnt lgkmcnt(0)
    v_add_u32 v50, 32768, v48
    v_add_u32 v51, 32768, v49
    s_waitcnt vmcnt(16)
    s_barrier
    ds_read_b64_tr_b16 a[128:129], v50 offset:0
    ds_read_b64_tr_b16 a[130:131], v50 offset:512
    ds_read_b64_tr_b16 a[132:133], v51 offset:0
    ds_read_b64_tr_b16 a[134:135], v51 offset:512
    ds_read_b64_tr_b16 a[136:137], v50 offset:4096
    ds_read_b64_tr_b16 a[138:139], v50 offset:4608
    ds_read_b64_tr_b16 a[140:141], v51 offset:4096
    ds_read_b64_tr_b16 a[142:143], v51 offset:4608
    s_add_u32 m0, s42, 16384
    s_nop 0
    buffer_load_dwordx4 v44, s[12:15], s54 offen lds
    s_add_u32 m0, s42, 17408
    s_nop 0
    buffer_load_dwordx4 v45, s[12:15], s54 offen lds
    s_add_u32 m0, s42, 24576
    s_nop 0
    buffer_load_dwordx4 v46, s[12:15], s54 offen lds
    s_add_u32 m0, s42, 25600
    s_nop 0
    buffer_load_dwordx4 v47, s[12:15], s54 offen lds
    s_add_u32 s54, s54, 131072
    s_waitcnt lgkmcnt(0)
    v_add_u32 v50, 49152, v48
    v_add_u32 v51, 49152, v49
    s_waitcnt vmcnt(16)
    s_barrier
    ds_read_b64_tr_b16 a[144:145], v50 offset:0
    ds_read_b64_tr_b16 a[146:147], v50 offset:512
    ds_read_b64_tr_b16 a[148:149], v51 offset:0
    ds_read_b64_tr_b16 a[150:151], v51 offset:512
    ds_read_b64_tr_b16 a[152:153], v50 offset:4096
    ds_read_b64_tr_b16 a[154:155], v50 offset:4608
    ds_read_b64_tr_b16 a[156:157], v51 offset:4096
    ds_read_b64_tr_b16 a[158:159], v51 offset:4608
    s_add_u32 m0, s42, 32768
    s_nop 0
    buffer_load_dwordx4 v44, s[12:15], s54 offen lds
    s_add_u32 m0, s42, 33792
    s_nop 0
    buffer_load_dwordx4 v45, s[12:15], s54 offen lds
    s_add_u32 m0, s42, 40960
    s_nop 0
    buffer_load_dwordx4 v46, s[12:15], s54 offen lds
    s_add_u32 m0, s42, 41984
    s_nop 0
    buffer_load_dwordx4 v47, s[12:15], s54 offen lds
    s_add_u32 s54, s54, 131072
    s_waitcnt lgkmcnt(0)
    v_add_u32 v50, 65536, v48
    v_add_u32 v51, 65536, v49
    s_waitcnt vmcnt(16)
    s_barrier
    ds_read_b64_tr_b16 a[160:161], v50 offset:0
    ds_read_b64_tr_b16 a[162:163], v50 offset:512
    ds_read_b64_tr_b16 a[164:165], v51 offset:0
    ds_read_b64_tr_b16 a[166:167], v51 offset:512
    ds_read_b64_tr_b16 a[168:169], v50 offset:4096
    ds_read_b64_tr_b16 a[170:171], v50 offset:4608
    ds_read_b64_tr_b16 a[172:173], v51 offset:4096
    ds_read_b64_tr_b16 a[174:175], v51 offset:4608
    s_add_u32 m0, s42, 49152
    s_nop 0
    buffer_load_dwordx4 v44, s[12:15], s54 offen lds
    s_add_u32 m0, s42, 50176
    s_nop 0
    buffer_load_dwordx4 v45, s[12:15], s54 offen lds
    s_add_u32 m0, s42, 57344
    s_nop 0
    buffer_load_dwordx4 v46, s[12:15], s54 offen lds
    s_add_u32 m0, s42, 58368
    s_nop 0
    buffer_load_dwordx4 v47, s[12:15], s54 offen lds
    s_add_u32 s54, s54, 131072
    s_waitcnt lgkmcnt(0)
    v_add_u32 v50, 81920, v48
    v_add_u32 v51, 81920, v49
    s_waitcnt vmcnt(16)
    s_barrier
    ds_read_b64_tr_b16 a[176:177], v50 offset:0
    ds_read_b64_tr_b16 a[178:179], v50 offset:512
    ds_read_b64_tr_b16 a[180:181], v51 offset:0
    ds_read_b64_tr_b16 a[182:183], v51 offset:512
    ds_read_b64_tr_b16 a[184:185], v50 offset:4096
    ds_read_b64_tr_b16 a[186:187], v50 offset:4608
    ds_read_b64_tr_b16 a[188:189], v51 offset:4096
    ds_read_b64_tr_b16 a[190:191], v51 offset:4608
    s_waitcnt lgkmcnt(0)
    v_add_u32 v50, 0, v48
    v_add_u32 v51, 0, v49
    s_waitcnt vmcnt(12)
    s_barrier
    ds_read_b64_tr_b16 a[192:193], v50 offset:0
    ds_read_b64_tr_b16 a[194:195], v50 offset:512
    ds_read_b64_tr_b16 a[196:197], v51 offset:0
    ds_read_b64_tr_b16 a[198:199], v51 offset:512
    ds_read_b64_tr_b16 a[200:201], v50 offset:4096
    ds_read_b64_tr_b16 a[202:203], v50 offset:4608
    ds_read_b64_tr_b16 a[204:205], v51 offset:4096
    ds_read_b64_tr_b16 a[206:207], v51 offset:4608
    s_waitcnt lgkmcnt(0)
    v_add_u32 v50, 16384, v48
    v_add_u32 v51, 16384, v49
    s_waitcnt vmcnt(8)
    s_barrier
    ds_read_b64_tr_b16 a[208:209], v50 offset:0
    ds_read_b64_tr_b16 a[210:211], v50 offset:512
    ds_read_b64_tr_b16 a[212:213], v51 offset:0
    ds_read_b64_tr_b16 a[214:215], v51 offset:512
    ds_read_b64_tr_b16 a[216:217], v50 offset:4096
    ds_read_b64_tr_b16 a[218:219], v50 offset:4608
    ds_read_b64_tr_b16 a[220:221], v51 offset:4096
    ds_read_b64_tr_b16 a[222:223], v51 offset:4608
    s_waitcnt lgkmcnt(0)
    v_add_u32 v50, 32768, v48
    v_add_u32 v51, 32768, v49
    s_waitcnt vmcnt(4)
    s_barrier
    ds_read_b64_tr_b16 a[224:225], v50 offset:0
    ds_read_b64_tr_b16 a[226:227], v50 offset:512
    ds_read_b64_tr_b16 a[228:229], v51 offset:0
    ds_read_b64_tr_b16 a[230:231], v51 offset:512
    ds_read_b64_tr_b16 a[232:233], v50 offset:4096
    ds_read_b64_tr_b16 a[234:235], v50 offset:4608
    ds_read_b64_tr_b16 a[236:237], v51 offset:4096
    ds_read_b64_tr_b16 a[238:239], v51 offset:4608
    s_waitcnt lgkmcnt(0)
    v_add_u32 v50, 49152, v48
    v_add_u32 v51, 49152, v49
    s_waitcnt vmcnt(0)
    s_barrier
    ds_read_b64_tr_b16 a[240:241], v50 offset:0
    ds_read_b64_tr_b16 a[242:243], v50 offset:512
    ds_read_b64_tr_b16 a[244:245], v51 offset:0
    ds_read_b64_tr_b16 a[246:247], v51 offset:512
    ds_read_b64_tr_b16 a[248:249], v50 offset:4096
    ds_read_b64_tr_b16 a[250:251], v50 offset:4608
    ds_read_b64_tr_b16 a[252:253], v51 offset:4096
    ds_read_b64_tr_b16 a[254:255], v51 offset:4608
    s_waitcnt lgkmcnt(0)
    s_barrier
    s_cmp_lg_u32 s32, 0
    s_cbranch_scc1 L_arv23
    s_add_u32 s20, s82, 0x80
    s_addc_u32 s21, s83, 0
    s_mov_b32 s22, 0x4
    s_mov_b32 s23, 0x00020000
    buffer_load_dword v12, v124, s[20:23], 0 offen sc1
    s_waitcnt vmcnt(0)
    v_cmp_eq_u32 vcc, v124, v12
    s_cbranch_vccnz L_spin24
L_back25:
L_arv23:
    s_add_u32 s47, s36, 1
    s_min_i32 s47, s47, 31
    s_max_i32 s47, s47, 0
    s_cmp_ge_u32 s47, 16
    s_cselect_b32 s8, s88, s64
    s_cselect_b32 s9, s89, s65
    s_and_b32 s47, s47, 15
    s_lshl_b32 s47, s47, 16
    s_sub_u32 s47, s50, s47
    s_add_u32 s48, s47, 32768
    buffer_load_dwordx4 v[128:131], v3, s[8:11], s48 offen sc1
    buffer_load_dwordx4 v[132:135], v3, s[8:11], s47 offen sc1
    s_add_u32 s96, s41, 2031616
    s_mov_b32 s98, s41
    s_mov_b32 s45, 0x5540000
    buffer_load_dword v136, v4, s[16:19], s45 offen sc1
    s_waitcnt vmcnt(0)
    v_cmp_ne_u32 vcc, 0, v136
    s_cbranch_vccnz L_spin26
L_back27:
    s_barrier
    s_add_u32 m0, s43, 0
    s_add_u32 s42, s41, 0
    buffer_load_dwordx4 v1, s[16:19], s42 offen offset:0 sc1 lds
    buffer_load_dwordx4 v1, s[16:19], s42 offen offset:1024 sc1 lds
    buffer_load_dwordx4 v1, s[16:19], s42 offen offset:2048 sc1 lds
    buffer_load_dwordx4 v1, s[16:19], s42 offen offset:3072 sc1 lds
    s_add_u32 m0, s43, 16384
    s_add_u32 s42, s41, 16384
    buffer_load_dwordx4 v1, s[16:19], s42 offen offset:0 sc1 lds
    buffer_load_dwordx4 v1, s[16:19], s42 offen offset:1024 sc1 lds
    buffer_load_dwordx4 v1, s[16:19], s42 offen offset:2048 sc1 lds
    buffer_load_dwordx4 v1, s[16:19], s42 offen offset:3072 sc1 lds
    s_add_u32 m0, s43, 32768
    s_add_u32 s42, s41, 32768
    buffer_load_dwordx4 v1, s[16:19], s42 offen offset:0 sc1 lds
    buffer_load_dwordx4 v1, s[16:19], s42 offen offset:1024 sc1 lds
    buffer_load_dwordx4 v1, s[16:19], s42 offen offset:2048 sc1 lds
    buffer_load_dwordx4 v1, s[16:19], s42 offen offset:3072 sc1 lds
    s_add_u32 s45, s45, 65536
    s_waitcnt vmcnt(0) lgkmcnt(0)
    s_barrier
    v_mfma_f32_16x16x32_bf16 v[12:15], v[108:111], v[128:131], 0
    v_mfma_f32_16x16x32_bf16 v[16:19], v[112:115], v[128:131], 0
    v_mfma_f32_16x16x32_bf16 v[20:23], v[108:111], v[132:135], 0
    v_mfma_f32_16x16x32_bf16 v[24:27], v[112:115], v[132:135], 0
    ds_read_b128 v[44:47], v1 offset:0
    ds_read_b128 v[48:51], v1 offset:1024
    ds_read_b128 v[52:55], v1 offset:2048
    ds_read_b128 v[56:59], v1 offset:3072
    s_mov_b32 s36, 0
    s_waitcnt lgkmcnt(0)
    s_nop 7
L_o_b0:
    s_waitcnt lgkmcnt(2)
    v_mfma_f32_16x16x32_bf16 v[12:15], a[0:3], v[44:47], v[12:15]
    ds_read_b128 v[60:63], v1 offset:4096
    ds_read_b128 v[140:143], v7
    v_mfma_f32_16x16x32_bf16 v[20:23], a[0:3], v[48:51], v[20:23]
    s_cmp_eq_u32 s36, 0
    s_cselect_b32 s49, 0x5e00000, s46
    v_mfma_f32_16x16x32_bf16 v[24:27], a[4:7], v[48:51], v[24:27]
    ds_read_b128 v[64:67], v1 offset:5120
    v_mfma_f32_16x16x32_bf16 v[16:19], a[4:7], v[44:47], v[16:19]
    s_waitcnt lgkmcnt(3)
    v_mfma_f32_16x16x32_bf16 v[12:15], a[8:11], v[52:55], v[12:15]
    s_waitcnt lgkmcnt(1)
    ds_read_b128 v[68:71], v1 offset:6144
    v_add_f32 v140, v140, v141
    v_mfma_f32_16x16x32_bf16 v[20:23], a[8:11], v[56:59], v[20:23]
    v_add_f32 v142, v142, v143
    v_add_f32 v140, v140, v142
    v_mfma_f32_16x16x32_bf16 v[24:27], a[12:15], v[56:59], v[24:27]
    ds_read_b128 v[72:75], v1 offset:7168
    v_min_u32 v140, -2, v140
    v_mfma_f32_16x16x32_bf16 v[16:19], a[12:15], v[52:55], v[16:19]
    s_waitcnt lgkmcnt(2)
    buffer_store_dword v140, v8, s[16:19], s49 offen sc1
    v_mfma_f32_16x16x32_bf16 v[12:15], a[16:19], v[60:63], v[12:15]
    ds_read_b128 v[44:47], v1 offset:8192
    v_mfma_f32_16x16x32_bf16 v[20:23], a[16:19], v[64:67], v[20:23]
    v_mfma_f32_16x16x32_bf16 v[24:27], a[20:23], v[64:67], v[24:27]
    s_add_u32 m0, s43, 49152
    ds_read_b128 v[48:51], v1 offset:9216
    s_add_u32 s42, s41, 49152
    v_mfma_f32_16x16x32_bf16 v[16:19], a[20:23], v[60:63], v[16:19]
    s_waitcnt lgkmcnt(2)
    buffer_load_dwordx4 v1, s[16:19], s42 offen offset:0 sc1 lds
    v_mfma_f32_16x16x32_bf16 v[12:15], a[24:27], v[68:71], v[12:15]
    ds_read_b128 v[52:55], v1 offset:10240
    v_mfma_f32_16x16x32_bf16 v[20:23], a[24:27], v[72:75], v[20:23]
    v_mfma_f32_16x16x32_bf16 v[24:27], a[28:31], v[72:75], v[24:27]
    ds_read_b128 v[56:59], v1 offset:11264
    buffer_load_dwordx4 v1, s[16:19], s42 offen offset:1024 sc1 lds
    v_mfma_f32_16x16x32_bf16 v[16:19], a[28:31], v[68:71], v[16:19]
    s_waitcnt lgkmcnt(2)
    v_mfma_f32_16x16x32_bf16 v[12:15], a[32:35], v[44:47], v[12:15]
    ds_read_b128 v[60:63], v1 offset:12288
    v_mfma_f32_16x16x32_bf16 v[20:23], a[32:35], v[48:51], v[20:23]
    buffer_load_dwordx4 v1, s[16:19], s42 offen offset:2048 sc1 lds
    v_mfma_f32_16x16x32_bf16 v[24:27], a[36:39], v[48:51], v[24:27]
    ds_read_b128 v[64:67], v1 offset:13312
    v_mfma_f32_16x16x32_bf16 v[16:19], a[36:39], v[44:47], v[16:19]
    s_waitcnt lgkmcnt(2)
    v_mfma_f32_16x16x32_bf16 v[12:15], a[40:43], v[52:55], v[12:15]
    ds_read_b128 v[68:71], v1 offset:14336
    buffer_load_dwordx4 v1, s[16:19], s42 offen offset:3072 sc1 lds
    v_mfma_f32_16x16x32_bf16 v[20:23], a[40:43], v[56:59], v[20:23]
    s_add_u32 s98, s98, 65536
    s_min_i32 s98, s98, s96
    s_and_b32 s41, s98, 0xffffffff
    v_mfma_f32_16x16x32_bf16 v[24:27], a[44:47], v[56:59], v[24:27]
    s_add_u32 m0, s43, 98304
    ds_read_b128 v[72:75], v1 offset:15360
    s_add_u32 s42, s41, 0
    v_mfma_f32_16x16x32_bf16 v[16:19], a[44:47], v[52:55], v[16:19]
    s_waitcnt vmcnt(11) lgkmcnt(2)
    s_barrier
    v_mfma_f32_16x16x32_bf16 v[12:15], a[48:51], v[60:63], v[12:15]
    ds_read_b128 v[44:47], v1 offset:16384
    v_mfma_f32_16x16x32_bf16 v[20:23], a[48:51], v[64:67], v[20:23]
    v_mfma_f32_16x16x32_bf16 v[24:27], a[52:55], v[64:67], v[24:27]
    s_add_u32 s47, s36, 1
    ds_read_b128 v[48:51], v1 offset:17408
    s_min_i32 s47, s47, 31
    v_mfma_f32_16x16x32_bf16 v[16:19], a[52:55], v[60:63], v[16:19]
    s_waitcnt lgkmcnt(2)
    s_max_i32 s47, s47, 0
    s_cmp_ge_u32 s47, 16
    v_mfma_f32_16x16x32_bf16 v[12:15], a[56:59], v[68:71], v[12:15]
    s_cselect_b32 s8, s88, s64
    ds_read_b128 v[52:55], v1 offset:18432
    s_cselect_b32 s9, s89, s65
    v_mfma_f32_16x16x32_bf16 v[20:23], a[56:59], v[72:75], v[20:23]
    s_and_b32 s47, s47, 15
    s_lshl_b32 s47, s47, 16
    s_sub_u32 s47, s50, s47
    v_mfma_f32_16x16x32_bf16 v[24:27], a[60:63], v[72:75], v[24:27]
    s_add_u32 s48, s47, 32768
    ds_read_b128 v[56:59], v1 offset:19456
    buffer_load_dwordx4 v[128:131], v3, s[8:11], s48 offen sc1
    v_mfma_f32_16x16x32_bf16 v[16:19], a[60:63], v[68:71], v[16:19]
    s_waitcnt lgkmcnt(2)
    buffer_load_dwordx4 v[132:135], v3, s[8:11], s47 offen sc1
    v_mfma_f32_16x16x32_bf16 v[12:15], a[64:67], v[44:47], v[12:15]
    s_add_u32 s90, s90, 65536
    ds_read_b128 v[60:63], v1 offset:20480
    s_add_u32 s46, s46, 2048
    v_mfma_f32_16x16x32_bf16 v[20:23], a[64:67], v[48:51], v[20:23]
    s_and_b32 s44, s90, 0xffffffff
    v_mfma_f32_16x16x32_bf16 v[24:27], a[68:71], v[48:51], v[24:27]
    ds_read_b128 v[64:67], v1 offset:21504
    buffer_load_dword v136, v4, s[16:19], s45 offen sc1
    v_mfma_f32_16x16x32_bf16 v[16:19], a[68:71], v[44:47], v[16:19]
    s_waitcnt lgkmcnt(2)
    v_mfma_f32_16x16x32_bf16 v[12:15], a[72:75], v[52:55], v[12:15]
    ds_read_b128 v[68:71], v1 offset:22528
    v_mfma_f32_16x16x32_bf16 v[20:23], a[72:75], v[56:59], v[20:23]
    v_mfma_f32_16x16x32_bf16 v[24:27], a[76:79], v[56:59], v[24:27]
    ds_read_b128 v[72:75], v1 offset:23552
    v_mfma_f32_16x16x32_bf16 v[16:19], a[76:79], v[52:55], v[16:19]
    s_waitcnt lgkmcnt(2)
    v_mfma_f32_16x16x32_bf16 v[12:15], a[80:83], v[60:63], v[12:15]
    s_waitcnt vmcnt(12)
    ds_read_b128 v[44:47], v1 offset:24576
    s_barrier
    v_mfma_f32_16x16x32_bf16 v[20:23], a[80:83], v[64:67], v[20:23]
    buffer_store_dword v124, v124, s[16:19], s91 offen sc1
    v_mfma_f32_16x16x32_bf16 v[24:27], a[84:87], v[64:67], v[24:27]
    s_add_u32 s91, s91, 65536
    ds_read_b128 v[48:51], v1 offset:25600
    v_mfma_f32_16x16x32_bf16 v[16:19], a[84:87], v[60:63], v[16:19]
    s_waitcnt lgkmcnt(2)
    v_mfma_f32_16x16x32_bf16 v[12:15], a[88:91], v[68:71], v[12:15]
    ds_read_b128 v[52:55], v1 offset:26624
    v_mfma_f32_16x16x32_bf16 v[20:23], a[88:91], v[72:75], v[20:23]
    v_mfma_f32_16x16x32_bf16 v[24:27], a[92:95], v[72:75], v[24:27]
    ds_read_b128 v[56:59], v1 offset:27648
    v_mfma_f32_16x16x32_bf16 v[16:19], a[92:95], v[68:71], v[16:19]
    s_waitcnt lgkmcnt(2)
    v_mfma_f32_16x16x32_bf16 v[12:15], a[96:99], v[44:47], v[12:15]
    ds_read_b128 v[60:63], v1 offset:28672
    v_mfma_f32_16x16x32_bf16 v[20:23], a[96:99], v[48:51], v[20:23]
    v_mfma_f32_16x16x32_bf16 v[24:27], a[100:103], v[48:51], v[24:27]
    ds_read_b128 v[64:67], v1 offset:29696
    v_mfma_f32_16x16x32_bf16 v[16:19], a[100:103], v[44:47], v[16:19]
    s_waitcnt lgkmcnt(2)
    v_mfma_f32_16x16x32_bf16 v[12:15], a[104:107], v[52:55], v[12:15]
    ds_read_b128 v[68:71], v1 offset:30720
    v_mfma_f32_16x16x32_bf16 v[20:23], a[104:107], v[56:59], v[20:23]
    v_mfma_f32_16x16x32_bf16 v[24:27], a[108:111], v[56:59], v[24:27]
    ds_read_b128 v[72:75], v1 offset:31744
    v_mfma_f32_16x16x32_bf16 v[16:19], a[108:111], v[52:55], v[16:19]
    s_waitcnt vmcnt(9) lgkmcnt(2)
    s_barrier
    v_mfma_f32_16x16x32_bf16 v[12:15], a[112:115], v[60:63], v[12:15]
    ds_read_b128 v[44:47], v1 offset:32768
    v_mfma_f32_16x16x32_bf16 v[20:23], a[112:115], v[64:67], v[20:23]
    v_mfma_f32_16x16x32_bf16 v[24:27], a[116:119], v[64:67], v[24:27]
    ds_read_b128 v[48:51], v1 offset:33792
    v_mfma_f32_16x16x32_bf16 v[16:19], a[116:119], v[60:63], v[16:19]
    s_waitcnt lgkmcnt(2)
    v_mfma_f32_16x16x32_bf16 v[12:15], a[120:123], v[68:71], v[12:15]
    ds_read_b128 v[52:55], v1 offset:34816
    v_mfma_f32_16x16x32_bf16 v[20:23], a[120:123], v[72:75], v[20:23]
    v_mfma_f32_16x16x32_bf16 v[24:27], a[124:127], v[72:75], v[24:27]
    ds_read_b128 v[56:59], v1 offset:35840
    v_mfma_f32_16x16x32_bf16 v[16:19], a[124:127], v[68:71], v[16:19]
    s_waitcnt lgkmcnt(2)
    v_mfma_f32_16x16x32_bf16 v[12:15], a[128:131], v[44:47], v[12:15]
    ds_read_b128 v[60:63], v1 offset:36864
    v_mfma_f32_16x16x32_bf16 v[20:23], a[128:131], v[48:51], v[20:23]
    v_mfma_f32_16x16x32_bf16 v[24:27], a[132:135], v[48:51], v[24:27]
    ds_read_b128 v[64:67], v1 offset:37888
    v_mfma_f32_16x16x32_bf16 v[16:19], a[132:135], v[44:47], v[16:19]
    s_waitcnt lgkmcnt(2)
    v_mfma_f32_16x16x32_bf16 v[12:15], a[136:139], v[52:55], v[12:15]
    ds_read_b128 v[68:71], v1 offset:38912
    v_mfma_f32_16x16x32_bf16 v[20:23], a[136:139], v[56:59], v[20:23]
    v_mfma_f32_16x16x32_bf16 v[24:27], a[140:143], v[56:59], v[24:27]
    ds_read_b128 v[72:75], v1 offset:39936
    v_mfma_f32_16x16x32_bf16 v[16:19], a[140:143], v[52:55], v[16:19]
    s_waitcnt lgkmcnt(2)
    v_mfma_f32_16x16x32_bf16 v[12:15], a[144:147], v[60:63], v[12:15]
    ds_read_b128 v[44:47], v1 offset:40960
    v_mfma_f32_16x16x32_bf16 v[20:23], a[144:147], v[64:67], v[20:23]
    v_mfma_f32_16x16x32_bf16 v[24:27], a[148:151], v[64:67], v[24:27]
    ds_read_b128 v[48:51], v1 offset:41984
    v_mfma_f32_16x16x32_bf16 v[16:19], a[148:151], v[60:63], v[16:19]
    s_waitcnt lgkmcnt(2)
    v_mfma_f32_16x16x32_bf16 v[12:15], a[152:155], v[68:71], v[12:15]
    ds_read_b128 v[52:55], v1 offset:43008
    v_mfma_f32_16x16x32_bf16 v[20:23], a[152:155], v[72:75], v[20:23]
    v_mfma_f32_16x16x32_bf16 v[24:27], a[156:159], v[72:75], v[24:27]
    ds_read_b128 v[56:59], v1 offset:44032
    v_mfma_f32_16x16x32_bf16 v[16:19], a[156:159], v[68:71], v[16:19]
    s_waitcnt lgkmcnt(2)
    v_mfma_f32_16x16x32_bf16 v[12:15], a[160:163], v[44:47], v[12:15]
    ds_read_b128 v[60:63], v1 offset:45056
    v_mfma_f32_16x16x32_bf16 v[20:23], a[160:163], v[48:51], v[20:23]
    v_mfma_f32_16x16x32_bf16 v[24:27], a[164:167], v[48:51], v[24:27]
    ds_read_b128 v[64:67], v1 offset:46080
    v_mfma_f32_16x16x32_bf16 v[16:19], a[164:167], v[44:47], v[16:19]
    s_waitcnt lgkmcnt(2)
    v_mfma_f32_16x16x32_bf16 v[12:15], a[168:171], v[52:55], v[12:15]
    ds_read_b128 v[68:71], v1 offset:47104
    v_mfma_f32_16x16x32_bf16 v[20:23], a[168:171], v[56:59], v[20:23]
    v_mfma_f32_16x16x32_bf16 v[24:27], a[172:175], v[56:59], v[24:27]
    ds_read_b128 v[72:75], v1 offset:48128
    v_mfma_f32_16x16x32_bf16 v[16:19], a[172:175], v[52:55], v[16:19]
    s_waitcnt vmcnt(4) lgkmcnt(2)
    s_barrier
    v_mfma_f32_16x16x32_bf16 v[12:15], a[176:179], v[60:63], v[12:15]
    ds_read_b128 v[44:47], v1 offset:49152
    v_mfma_f32_16x16x32_bf16 v[20:23], a[176:179], v[64:67], v[20:23]
    v_mfma_f32_16x16x32_bf16 v[24:27], a[180:183], v[64:67], v[24:27]
    ds_read_b128 v[48:51], v1 offset:50176
    v_mfma_f32_16x16x32_bf16 v[16:19], a[180:183], v[60:63], v[16:19]
    s_waitcnt lgkmcnt(2)
    v_mfma_f32_16x16x32_bf16 v[12:15], a[184:187], v[68:71], v[12:15]
    s_waitcnt vmcnt(1)
    ds_read_b128 v[52:55], v1 offset:51200
    v_cmp_ne_u32 vcc, 0, v136
    v_mfma_f32_16x16x32_bf16 v[20:23], a[184:187], v[72:75], v[20:23]
    v_mfma_f32_16x16x32_bf16 v[24:27], a[188:191], v[72:75], v[24:27]
    s_cbranch_vccnz L_spin28
L_back29:
    ds_read_b128 v[56:59], v1 offset:52224
    s_barrier
    v_mfma_f32_16x16x32_bf16 v[16:19], a[188:191], v[68:71], v[16:19]
    s_waitcnt lgkmcnt(2)
    s_add_u32 s45, s45, 65536
    buffer_load_dwordx4 v1, s[16:19], s42 offen offset:0 sc1 lds
    v_mfma_f32_16x16x32_bf16 v[12:15], a[192:195], v[44:47], v[12:15]
    s_waitcnt vmcnt(3)
    ds_read_b128 v[60:63], v1 offset:53248
    v_mfma_f32_16x16x32_bf16 v[28:31], v[108:111], v[128:131], 0
    v_mfma_f32_16x16x32_bf16 v[32:35], v[112:115], v[128:131], 0
    v_mfma_f32_16x16x32_bf16 v[36:39], v[108:111], v[132:135], 0
    v_mfma_f32_16x16x32_bf16 v[40:43], v[112:115], v[132:135], 0
    v_mfma_f32_16x16x32_bf16 v[20:23], a[192:195], v[48:51], v[20:23]
    v_mfma_f32_16x16x32_bf16 v[24:27], a[196:199], v[48:51], v[24:27]
    ds_read_b128 v[64:67], v1 offset:54272
    v_mfma_f32_16x16x32_bf16 v[16:19], a[196:199], v[44:47], v[16:19]
    s_waitcnt lgkmcnt(2)
    buffer_load_dwordx4 v1, s[16:19], s42 offen offset:1024 sc1 lds
    v_mfma_f32_16x16x32_bf16 v[12:15], a[200:203], v[52:55], v[12:15]
    ds_read_b128 v[68:71], v1 offset:55296
    v_mfma_f32_16x16x32_bf16 v[20:23], a[200:203], v[56:59], v[20:23]
    v_mfma_f32_16x16x32_bf16 v[24:27], a[204:207], v[56:59], v[24:27]
    ds_read_b128 v[72:75], v1 offset:56320
    v_mfma_f32_16x16x32_bf16 v[16:19], a[204:207], v[52:55], v[16:19]
    s_waitcnt lgkmcnt(2)
    buffer_load_dwordx4 v1, s[16:19], s42 offen offset:2048 sc1 lds
    v_mfma_f32_16x16x32_bf16 v[12:15], a[208:211], v[60:63], v[12:15]
    ds_read_b128 v[44:47], v1 offset:57344
    v_mfma_f32_16x16x32_bf16 v[20:23], a[208:211], v[64:67], v[20:23]
    v_mfma_f32_16x16x32_bf16 v[24:27], a[212:215], v[64:67], v[24:27]
    ds_read_b128 v[48:51], v1 offset:58368
    v_mfma_f32_16x16x32_bf16 v[16:19], a[212:215], v[60:63], v[16:19]
    s_waitcnt lgkmcnt(2)
    buffer_load_dwordx4 v1, s[16:19], s42 offen offset:3072 sc1 lds
    v_mfma_f32_16x16x32_bf16 v[12:15], a[216:219], v[68:71], v[12:15]
    s_add_u32 m0, s43, 114688
    ds_read_b128 v[52:55], v1 offset:59392
    s_add_u32 s42, s41, 16384
    v_mfma_f32_16x16x32_bf16 v[20:23], a[216:219], v[72:75], v[20:23]
    v_mfma_f32_16x16x32_bf16 v[24:27], a[220:223], v[72:75], v[24:27]
    ds_read_b128 v[56:59], v1 offset:60416
    v_mfma_f32_16x16x32_bf16 v[16:19], a[220:223], v[68:71], v[16:19]
    s_waitcnt lgkmcnt(2)
    buffer_load_dwordx4 v1, s[16:19], s42 offen offset:0 sc1 lds
    v_mfma_f32_16x16x32_bf16 v[12:15], a[224:227], v[44:47], v[12:15]
    ds_read_b128 v[60:63], v1 offset:61440
    v_mfma_f32_16x16x32_bf16 v[20:23], a[224:227], v[48:51], v[20:23]
    v_mfma_f32_16x16x32_bf16 v[24:27], a[228:231], v[48:51], v[24:27]
    ds_read_b128 v[64:67], v1 offset:62464
    v_mfma_f32_16x16x32_bf16 v[16:19], a[228:231], v[44:47], v[16:19]
    s_waitcnt lgkmcnt(2)
    buffer_load_dwordx4 v1, s[16:19], s42 offen offset:1024 sc1 lds
    v_mfma_f32_16x16x32_bf16 v[12:15], a[232:235], v[52:55], v[12:15]
    ds_read_b128 v[68:71], v1 offset:63488
    v_mfma_f32_16x16x32_bf16 v[20:23], a[232:235], v[56:59], v[20:23]
    v_mfma_f32_16x16x32_bf16 v[24:27], a[236:239], v[56:59], v[24:27]
    ds_read_b128 v[72:75], v1 offset:64512
    v_mfma_f32_16x16x32_bf16 v[16:19], a[236:239], v[52:55], v[16:19]
    s_waitcnt lgkmcnt(2)
    buffer_load_dwordx4 v1, s[16:19], s42 offen offset:2048 sc1 lds
    v_mfma_f32_16x16x32_bf16 v[12:15], a[240:243], v[60:63], v[12:15]
    v_mfma_f32_16x16x32_bf16 v[20:23], a[240:243], v[64:67], v[20:23]
    v_mfma_f32_16x16x32_bf16 v[24:27], a[244:247], v[64:67], v[24:27]
    v_mfma_f32_16x16x32_bf16 v[16:19], a[244:247], v[60:63], v[16:19]
    s_waitcnt lgkmcnt(0)
    buffer_load_dwordx4 v1, s[16:19], s42 offen offset:3072 sc1 lds
    v_mfma_f32_16x16x32_bf16 v[12:15], a[248:251], v[68:71], v[12:15]
    v_mfma_f32_16x16x32_bf16 v[20:23], a[248:251], v[72:75], v[20:23]
    v_mfma_f32_16x16x32_bf16 v[24:27], a[252:255], v[72:75], v[24:27]
    v_mfma_f32_16x16x32_bf16 v[16:19], a[252:255], v[68:71], v[16:19]
    s_nop 1
    v_cvt_pk_bf16_f32 v148, v12, v13
    v_cvt_pk_bf16_f32 v149, v14, v15
    s_nop 3
    v_cvt_pk_bf16_f32 v150, v16, v17
    v_cvt_pk_bf16_f32 v151, v18, v19
    buffer_store_dwordx4 v[148:151], v1, s[16:19], s44 offen offset:0 sc1
    v_cvt_pk_bf16_f32 v152, v20, v21
    v_cvt_pk_bf16_f32 v153, v22, v23
    v_cvt_pk_bf16_f32 v154, v24, v25
    v_cvt_pk_bf16_f32 v155, v26, v27
    buffer_store_dwordx4 v[152:155], v1, s[16:19], s44 offen offset:1024 sc1
    s_add_u32 m0, s43, 131072
    s_add_u32 s42, s41, 32768
    v_add_f32 v140, v12, v13
    v_add_f32 v144, v20, v21
    v_mul_f32 v141, v12, v12
    v_mul_f32 v145, v20, v20
    buffer_load_dwordx4 v1, s[16:19], s42 offen offset:0 sc1 lds
    v_fmac_f32 v141, v13, v13
    v_fmac_f32 v145, v21, v21
    v_add_f32 v140, v140, v14
    v_add_f32 v144, v144, v22
    v_fmac_f32 v141, v14, v14
    v_fmac_f32 v145, v22, v22
    v_add_f32 v140, v140, v15
    v_add_f32 v144, v144, v23
    buffer_load_dwordx4 v1, s[16:19], s42 offen offset:1024 sc1 lds
    v_fmac_f32 v141, v15, v15
    v_fmac_f32 v145, v23, v23
    v_add_f32 v140, v140, v16
    v_add_f32 v144, v144, v24
    v_fmac_f32 v141, v16, v16
    v_fmac_f32 v145, v24, v24
    v_add_f32 v140, v140, v17
    v_add_f32 v144, v144, v25
    buffer_load_dwordx4 v1, s[16:19], s42 offen offset:2048 sc1 lds
    v_fmac_f32 v141, v17, v17
    v_fmac_f32 v145, v25, v25
    v_add_f32 v140, v140, v18
    v_add_f32 v144, v144, v26
    v_fmac_f32 v141, v18, v18
    v_fmac_f32 v145, v26, v26
    v_add_f32 v140, v140, v19
    v_add_f32 v144, v144, v27
    buffer_load_dwordx4 v1, s[16:19], s42 offen offset:3072 sc1 lds
    v_fmac_f32 v141, v19, v19
    v_fmac_f32 v145, v27, v27
    s_nop 0
    v_permlane16_swap_b32 v140, v141
    v_permlane16_swap_b32 v144, v145
    v_add_f32 v140, v140, v141
    v_add_f32 v144, v144, v145
    v_mov_b32 v142, v140
    v_mov_b32 v146, v144
    s_nop 0
    v_permlane32_swap_b32 v140, v142
    v_permlane32_swap_b32 v144, v146
    v_add_f32 v140, v140, v142
    v_add_f32 v144, v144, v146
    ds_write_b32 v6, v140 offset:0
    ds_write_b32 v6, v144 offset:512
    s_waitcnt vmcnt(10) lgkmcnt(0)
    s_barrier
    ds_read_b128 v[44:47], v2 offset:0
    ds_read_b128 v[48:51], v2 offset:1024
    ds_read_b128 v[52:55], v2 offset:2048
    ds_read_b128 v[56:59], v2 offset:3072
    s_add_u32 s36, s36, 1
L_o_b1:
    s_waitcnt lgkmcnt(2)
    v_mfma_f32_16x16x32_bf16 v[28:31], a[0:3], v[44:47], v[28:31]
    ds_read_b128 v[60:63], v2 offset:4096
    ds_read_b128 v[140:143], v7
    v_mfma_f32_16x16x32_bf16 v[36:39], a[0:3], v[48:51], v[36:39]
    s_cmp_eq_u32 s36, 0
    s_cselect_b32 s49, 0x5e00000, s46
    v_mfma_f32_16x16x32_bf16 v[40:43], a[4:7], v[48:51], v[40:43]
    ds_read_b128 v[64:67], v2 offset:5120
    v_mfma_f32_16x16x32_bf16 v[32:35], a[4:7], v[44:47], v[32:35]
    s_waitcnt lgkmcnt(3)
    v_mfma_f32_16x16x32_bf16 v[28:31], a[8:11], v[52:55], v[28:31]
    s_waitcnt lgkmcnt(1)
    ds_read_b128 v[68:71], v2 offset:6144
    v_add_f32 v140, v140, v141
    v_mfma_f32_16x16x32_bf16 v[36:39], a[8:11], v[56:59], v[36:39]
    v_add_f32 v142, v142, v143
    v_add_f32 v140, v140, v142
    v_mfma_f32_16x16x32_bf16 v[40:43], a[12:15], v[56:59], v[40:43]
    ds_read_b128 v[72:75], v2 offset:7168
    v_min_u32 v140, -2, v140
    v_mfma_f32_16x16x32_bf16 v[32:35], a[12:15], v[52:55], v[32:35]
    s_waitcnt lgkmcnt(2)
    buffer_store_dword v140, v8, s[16:19], s49 offen sc1
    v_mfma_f32_16x16x32_bf16 v[28:31], a[16:19], v[60:63], v[28:31]
    ds_read_b128 v[44:47], v2 offset:8192
    v_mfma_f32_16x16x32_bf16 v[36:39], a[16:19], v[64:67], v[36:39]
    v_mfma_f32_16x16x32_bf16 v[40:43], a[20:23], v[64:67], v[40:43]
    s_add_u32 m0, s43, 147456
    ds_read_b128 v[48:51], v2 offset:9216
    s_add_u32 s42, s41, 49152
    v_mfma_f32_16x16x32_bf16 v[32:35], a[20:23], v[60:63], v[32:35]
    s_waitcnt lgkmcnt(2)
    buffer_load_dwordx4 v1, s[16:19], s42 offen offset:0 sc1 lds
    v_mfma_f32_16x16x32_bf16 v[28:31], a[24:27], v[68:71], v[28:31]
    ds_read_b128 v[52:55], v2 offset:10240
    v_mfma_f32_16x16x32_bf16 v[36:39], a[24:27], v[72:75], v[36:39]
    v_mfma_f32_16x16x32_bf16 v[40:43], a[28:31], v[72:75], v[40:43]
    ds_read_b128 v[56:59], v2 offset:11264
    buffer_load_dwordx4 v1, s[16:19], s42 offen offset:1024 sc1 lds
    v_mfma_f32_16x16x32_bf16 v[32:35], a[28:31], v[68:71], v[32:35]
    s_waitcnt lgkmcnt(2)
    v_mfma_f32_16x16x32_bf16 v[28:31], a[32:35], v[44:47], v[28:31]
    ds_read_b128 v[60:63], v2 offset:12288
    v_mfma_f32_16x16x32_bf16 v[36:39], a[32:35], v[48:51], v[36:39]
    buffer_load_dwordx4 v1, s[16:19], s42 offen offset:2048 sc1 lds
    v_mfma_f32_16x16x32_bf16 v[40:43], a[36:39], v[48:51], v[40:43]
    ds_read_b128 v[64:67], v2 offset:13312
    v_mfma_f32_16x16x32_bf16 v[32:35], a[36:39], v[44:47], v[32:35]
    s_waitcnt lgkmcnt(2)
    v_mfma_f32_16x16x32_bf16 v[28:31], a[40:43], v[52:55], v[28:31]
    ds_read_b128 v[68:71], v2 offset:14336
    buffer_load_dwordx4 v1, s[16:19], s42 offen offset:3072 sc1 lds
    v_mfma_f32_16x16x32_bf16 v[36:39], a[40:43], v[56:59], v[36:39]
    s_add_u32 s98, s98, 65536
    s_min_i32 s98, s98, s96
    s_and_b32 s41, s98, 0xffffffff
    v_mfma_f32_16x16x32_bf16 v[40:43], a[44:47], v[56:59], v[40:43]
    s_add_u32 m0, s43, 0
    ds_read_b128 v[72:75], v2 offset:15360
    s_add_u32 s42, s41, 0
    v_mfma_f32_16x16x32_bf16 v[32:35], a[44:47], v[52:55], v[32:35]
    s_waitcnt vmcnt(11) lgkmcnt(2)
    s_barrier
    v_mfma_f32_16x16x32_bf16 v[28:31], a[48:51], v[60:63], v[28:31]
    ds_read_b128 v[44:47], v2 offset:16384
    v_mfma_f32_16x16x32_bf16 v[36:39], a[48:51], v[64:67], v[36:39]
    v_mfma_f32_16x16x32_bf16 v[40:43], a[52:55], v[64:67], v[40:43]
    s_add_u32 s47, s36, 1
    ds_read_b128 v[48:51], v2 offset:17408
    s_min_i32 s47, s47, 31
    v_mfma_f32_16x16x32_bf16 v[32:35], a[52:55], v[60:63], v[32:35]
    s_waitcnt lgkmcnt(2)
    s_max_i32 s47, s47, 0
    s_cmp_ge_u32 s47, 16
    v_mfma_f32_16x16x32_bf16 v[28:31], a[56:59], v[68:71], v[28:31]
    s_cselect_b32 s8, s88, s64
    ds_read_b128 v[52:55], v2 offset:18432
    s_cselect_b32 s9, s89, s65
    v_mfma_f32_16x16x32_bf16 v[36:39], a[56:59], v[72:75], v[36:39]
    s_and_b32 s47, s47, 15
    s_lshl_b32 s47, s47, 16
    s_sub_u32 s47, s50, s47
    v_mfma_f32_16x16x32_bf16 v[40:43], a[60:63], v[72:75], v[40:43]
    s_add_u32 s48, s47, 32768
    ds_read_b128 v[56:59], v2 offset:19456
    buffer_load_dwordx4 v[128:131], v3, s[8:11], s48 offen sc1
    v_mfma_f32_16x16x32_bf16 v[32:35], a[60:63], v[68:71], v[32:35]
    s_waitcnt lgkmcnt(2)
    buffer_load_dwordx4 v[132:135], v3, s[8:11], s47 offen sc1
    v_mfma_f32_16x16x32_bf16 v[28:31], a[64:67], v[44:47], v[28:31]
    s_add_u32 s90, s90, 65536
    ds_read_b128 v[60:63], v2 offset:20480
    s_add_u32 s46, s46, 2048
    v_mfma_f32_16x16x32_bf16 v[36:39], a[64:67], v[48:51], v[36:39]
    s_and_b32 s44, s90, 0xffffffff
    v_mfma_f32_16x16x32_bf16 v[40:43], a[68:71], v[48:51], v[40:43]
    ds_read_b128 v[64:67], v2 offset:21504
    buffer_load_dword v136, v4, s[16:19], s45 offen sc1
    v_mfma_f32_16x16x32_bf16 v[32:35], a[68:71], v[44:47], v[32:35]
    s_waitcnt lgkmcnt(2)
    v_mfma_f32_16x16x32_bf16 v[28:31], a[72:75], v[52:55], v[28:31]
    ds_read_b128 v[68:71], v2 offset:22528
    v_mfma_f32_16x16x32_bf16 v[36:39], a[72:75], v[56:59], v[36:39]
    v_mfma_f32_16x16x32_bf16 v[40:43], a[76:79], v[56:59], v[40:43]
    ds_read_b128 v[72:75], v2 offset:23552
    v_mfma_f32_16x16x32_bf16 v[32:35], a[76:79], v[52:55], v[32:35]
    s_waitcnt lgkmcnt(2)
    v_mfma_f32_16x16x32_bf16 v[28:31], a[80:83], v[60:63], v[28:31]
    s_waitcnt vmcnt(12)
    ds_read_b128 v[44:47], v2 offset:24576
    s_barrier
    v_mfma_f32_16x16x32_bf16 v[36:39], a[80:83], v[64:67], v[36:39]
    buffer_store_dword v124, v124, s[16:19], s91 offen sc1
    v_mfma_f32_16x16x32_bf16 v[40:43], a[84:87], v[64:67], v[40:43]
    s_add_u32 s91, s91, 65536
    ds_read_b128 v[48:51], v2 offset:25600
    v_mfma_f32_16x16x32_bf16 v[32:35], a[84:87], v[60:63], v[32:35]
    s_waitcnt lgkmcnt(2)
    v_mfma_f32_16x16x32_bf16 v[28:31], a[88:91], v[68:71], v[28:31]
    ds_read_b128 v[52:55], v2 offset:26624
    v_mfma_f32_16x16x32_bf16 v[36:39], a[88:91], v[72:75], v[36:39]
    v_mfma_f32_16x16x32_bf16 v[40:43], a[92:95], v[72:75], v[40:43]
    ds_read_b128 v[56:59], v2 offset:27648
    v_mfma_f32_16x16x32_bf16 v[32:35], a[92:95], v[68:71], v[32:35]
    s_waitcnt lgkmcnt(2)
    v_mfma_f32_16x16x32_bf16 v[28:31], a[96:99], v[44:47], v[28:31]
    ds_read_b128 v[60:63], v2 offset:28672
    v_mfma_f32_16x16x32_bf16 v[36:39], a[96:99], v[48:51], v[36:39]
    v_mfma_f32_16x16x32_bf16 v[40:43], a[100:103], v[48:51], v[40:43]
    ds_read_b128 v[64:67], v2 offset:29696
    v_mfma_f32_16x16x32_bf16 v[32:35], a[100:103], v[44:47], v[32:35]
    s_waitcnt lgkmcnt(2)
    v_mfma_f32_16x16x32_bf16 v[28:31], a[104:107], v[52:55], v[28:31]
    ds_read_b128 v[68:71], v2 offset:30720
    v_mfma_f32_16x16x32_bf16 v[36:39], a[104:107], v[56:59], v[36:39]
    v_mfma_f32_16x16x32_bf16 v[40:43], a[108:111], v[56:59], v[40:43]
    ds_read_b128 v[72:75], v2 offset:31744
    v_mfma_f32_16x16x32_bf16 v[32:35], a[108:111], v[52:55], v[32:35]
    s_waitcnt vmcnt(9) lgkmcnt(2)
    s_barrier
    v_mfma_f32_16x16x32_bf16 v[28:31], a[112:115], v[60:63], v[28:31]
    ds_read_b128 v[44:47], v2 offset:32768
    v_mfma_f32_16x16x32_bf16 v[36:39], a[112:115], v[64:67], v[36:39]
    v_mfma_f32_16x16x32_bf16 v[40:43], a[116:119], v[64:67], v[40:43]
    ds_read_b128 v[48:51], v2 offset:33792
    v_mfma_f32_16x16x32_bf16 v[32:35], a[116:119], v[60:63], v[32:35]
    s_waitcnt lgkmcnt(2)
    v_mfma_f32_16x16x32_bf16 v[28:31], a[120:123], v[68:71], v[28:31]
    ds_read_b128 v[52:55], v2 offset:34816
    v_mfma_f32_16x16x32_bf16 v[36:39], a[120:123], v[72:75], v[36:39]
    v_mfma_f32_16x16x32_bf16 v[40:43], a[124:127], v[72:75], v[40:43]
    ds_read_b128 v[56:59], v2 offset:35840
    v_mfma_f32_16x16x32_bf16 v[32:35], a[124:127], v[68:71], v[32:35]
    s_waitcnt lgkmcnt(2)
    v_mfma_f32_16x16x32_bf16 v[28:31], a[128:131], v[44:47], v[28:31]
    ds_read_b128 v[60:63], v2 offset:36864
    v_mfma_f32_16x16x32_bf16 v[36:39], a[128:131], v[48:51], v[36:39]
    v_mfma_f32_16x16x32_bf16 v[40:43], a[132:135], v[48:51], v[40:43]
    ds_read_b128 v[64:67], v2 offset:37888
    v_mfma_f32_16x16x32_bf16 v[32:35], a[132:135], v[44:47], v[32:35]
    s_waitcnt lgkmcnt(2)
    v_mfma_f32_16x16x32_bf16 v[28:31], a[136:139], v[52:55], v[28:31]
    ds_read_b128 v[68:71], v2 offset:38912
    v_mfma_f32_16x16x32_bf16 v[36:39], a[136:139], v[56:59], v[36:39]
    v_mfma_f32_16x16x32_bf16 v[40:43], a[140:143], v[56:59], v[40:43]
    ds_read_b128 v[72:75], v2 offset:39936
    v_mfma_f32_16x16x32_bf16 v[32:35], a[140:143], v[52:55], v[32:35]
    s_waitcnt lgkmcnt(2)
    v_mfma_f32_16x16x32_bf16 v[28:31], a[144:147], v[60:63], v[28:31]
    ds_read_b128 v[44:47], v2 offset:40960
    v_mfma_f32_16x16x32_bf16 v[36:39], a[144:147], v[64:67], v[36:39]
    v_mfma_f32_16x16x32_bf16 v[40:43], a[148:151], v[64:67], v[40:43]
    ds_read_b128 v[48:51], v2 offset:41984
    v_mfma_f32_16x16x32_bf16 v[32:35], a[148:151], v[60:63], v[32:35]
    s_waitcnt lgkmcnt(2)
    v_mfma_f32_16x16x32_bf16 v[28:31], a[152:155], v[68:71], v[28:31]
    ds_read_b128 v[52:55], v2 offset:43008
    v_mfma_f32_16x16x32_bf16 v[36:39], a[152:155], v[72:75], v[36:39]
    v_mfma_f32_16x16x32_bf16 v[40:43], a[156:159], v[72:75], v[40:43]
    ds_read_b128 v[56:59], v2 offset:44032
    v_mfma_f32_16x16x32_bf16 v[32:35], a[156:159], v[68:71], v[32:35]
    s_waitcnt lgkmcnt(2)
    v_mfma_f32_16x16x32_bf16 v[28:31], a[160:163], v[44:47], v[28:31]
    ds_read_b128 v[60:63], v2 offset:45056
    v_mfma_f32_16x16x32_bf16 v[36:39], a[160:163], v[48:51], v[36:39]
    v_mfma_f32_16x16x32_bf16 v[40:43], a[164:167], v[48:51], v[40:43]
    ds_read_b128 v[64:67], v2 offset:46080
    v_mfma_f32_16x16x32_bf16 v[32:35], a[164:167], v[44:47], v[32:35]
    s_waitcnt lgkmcnt(2)
    v_mfma_f32_16x16x32_bf16 v[28:31], a[168:171], v[52:55], v[28:31]
    ds_read_b128 v[68:71], v2 offset:47104
    v_mfma_f32_16x16x32_bf16 v[36:39], a[168:171], v[56:59], v[36:39]
    v_mfma_f32_16x16x32_bf16 v[40:43], a[172:175], v[56:59], v[40:43]
    ds_read_b128 v[72:75], v2 offset:48128
    v_mfma_f32_16x16x32_bf16 v[32:35], a[172:175], v[52:55], v[32:35]
    s_waitcnt vmcnt(4) lgkmcnt(2)
    s_barrier
    v_mfma_f32_16x16x32_bf16 v[28:31], a[176:179], v[60:63], v[28:31]
    ds_read_b128 v[44:47], v2 offset:49152
    v_mfma_f32_16x16x32_bf16 v[36:39], a[176:179], v[64:67], v[36:39]
    v_mfma_f32_16x16x32_bf16 v[40:43], a[180:183], v[64:67], v[40:43]
    ds_read_b128 v[48:51], v2 offset:50176
    v_mfma_f32_16x16x32_bf16 v[32:35], a[180:183], v[60:63], v[32:35]
    s_waitcnt lgkmcnt(2)
    v_mfma_f32_16x16x32_bf16 v[28:31], a[184:187], v[68:71], v[28:31]
    s_waitcnt vmcnt(1)
    ds_read_b128 v[52:55], v2 offset:51200
    v_cmp_ne_u32 vcc, 0, v136
    v_mfma_f32_16x16x32_bf16 v[36:39], a[184:187], v[72:75], v[36:39]
    v_mfma_f32_16x16x32_bf16 v[40:43], a[188:191], v[72:75], v[40:43]
    s_cbranch_vccnz L_spin30
L_back31:
    ds_read_b128 v[56:59], v2 offset:52224
    s_barrier
    v_mfma_f32_16x16x32_bf16 v[32:35], a[188:191], v[68:71], v[32:35]
    s_waitcnt lgkmcnt(2)
    s_add_u32 s45, s45, 65536
    buffer_load_dwordx4 v1, s[16:19], s42 offen offset:0 sc1 lds
    v_mfma_f32_16x16x32_bf16 v[28:31], a[192:195], v[44:47], v[28:31]
    s_waitcnt vmcnt(3)
    ds_read_b128 v[60:63], v2 offset:53248
    v_mfma_f32_16x16x32_bf16 v[12:15], v[108:111], v[128:131], 0
    v_mfma_f32_16x16x32_bf16 v[16:19], v[112:115], v[128:131], 0
    v_mfma_f32_16x16x32_bf16 v[20:23], v[108:111], v[132:135], 0
    v_mfma_f32_16x16x32_bf16 v[24:27], v[112:115], v[132:135], 0
    v_mfma_f32_16x16x32_bf16 v[36:39], a[192:195], v[48:51], v[36:39]
    v_mfma_f32_16x16x32_bf16 v[40:43], a[196:199], v[48:51], v[40:43]
    ds_read_b128 v[64:67], v2 offset:54272
    v_mfma_f32_16x16x32_bf16 v[32:35], a[196:199], v[44:47], v[32:35]
    s_waitcnt lgkmcnt(2)
    buffer_load_dwordx4 v1, s[16:19], s42 offen offset:1024 sc1 lds
    v_mfma_f32_16x16x32_bf16 v[28:31], a[200:203], v[52:55], v[28:31]
    ds_read_b128 v[68:71], v2 offset:55296
    v_mfma_f32_16x16x32_bf16 v[36:39], a[200:203], v[56:59], v[36:39]
    v_mfma_f32_16x16x32_bf16 v[40:43], a[204:207], v[56:59], v[40:43]
    ds_read_b128 v[72:75], v2 offset:56320
    v_mfma_f32_16x16x32_bf16 v[32:35], a[204:207], v[52:55], v[32:35]
    s_waitcnt lgkmcnt(2)
    buffer_load_dwordx4 v1, s[16:19], s42 offen offset:2048 sc1 lds
    v_mfma_f32_16x16x32_bf16 v[28:31], a[208:211], v[60:63], v[28:31]
    ds_read_b128 v[44:47], v2 offset:57344
    v_mfma_f32_16x16x32_bf16 v[36:39], a[208:211], v[64:67], v[36:39]
    v_mfma_f32_16x16x32_bf16 v[40:43], a[212:215], v[64:67], v[40:43]
    ds_read_b128 v[48:51], v2 offset:58368
    v_mfma_f32_16x16x32_bf16 v[32:35], a[212:215], v[60:63], v[32:35]
    s_waitcnt lgkmcnt(2)
    buffer_load_dwordx4 v1, s[16:19], s42 offen offset:3072 sc1 lds
    v_mfma_f32_16x16x32_bf16 v[28:31], a[216:219], v[68:71], v[28:31]
    s_add_u32 m0, s43, 16384
    ds_read_b128 v[52:55], v2 offset:59392
    s_add_u32 s42, s41, 16384
    v_mfma_f32_16x16x32_bf16 v[36:39], a[216:219], v[72:75], v[36:39]
    v_mfma_f32_16x16x32_bf16 v[40:43], a[220:223], v[72:75], v[40:43]
    ds_read_b128 v[56:59], v2 offset:60416
    v_mfma_f32_16x16x32_bf16 v[32:35], a[220:223], v[68:71], v[32:35]
    s_waitcnt lgkmcnt(2)
    buffer_load_dwordx4 v1, s[16:19], s42 offen offset:0 sc1 lds
    v_mfma_f32_16x16x32_bf16 v[28:31], a[224:227], v[44:47], v[28:31]
    ds_read_b128 v[60:63], v2 offset:61440
    v_mfma_f32_16x16x32_bf16 v[36:39], a[224:227], v[48:51], v[36:39]
    v_mfma_f32_16x16x32_bf16 v[40:43], a[228:231], v[48:51], v[40:43]
    ds_read_b128 v[64:67], v2 offset:62464
    v_mfma_f32_16x16x32_bf16 v[32:35], a[228:231], v[44:47], v[32:35]
    s_waitcnt lgkmcnt(2)
    buffer_load_dwordx4 v1, s[16:19], s42 offen offset:1024 sc1 lds
    v_mfma_f32_16x16x32_bf16 v[28:31], a[232:235], v[52:55], v[28:31]
    ds_read_b128 v[68:71], v2 offset:63488
    v_mfma_f32_16x16x32_bf16 v[36:39], a[232:235], v[56:59], v[36:39]
    v_mfma_f32_16x16x32_bf16 v[40:43], a[236:239], v[56:59], v[40:43]
    ds_read_b128 v[72:75], v2 offset:64512
    v_mfma_f32_16x16x32_bf16 v[32:35], a[236:239], v[52:55], v[32:35]
    s_waitcnt lgkmcnt(2)
    buffer_load_dwordx4 v1, s[16:19], s42 offen offset:2048 sc1 lds
    v_mfma_f32_16x16x32_bf16 v[28:31], a[240:243], v[60:63], v[28:31]
    v_mfma_f32_16x16x32_bf16 v[36:39], a[240:243], v[64:67], v[36:39]
    v_mfma_f32_16x16x32_bf16 v[40:43], a[244:247], v[64:67], v[40:43]
    v_mfma_f32_16x16x32_bf16 v[32:35], a[244:247], v[60:63], v[32:35]
    s_waitcnt lgkmcnt(0)
    buffer_load_dwordx4 v1, s[16:19], s42 offen offset:3072 sc1 lds
    v_mfma_f32_16x16x32_bf16 v[28:31], a[248:251], v[68:71], v[28:31]
    v_mfma_f32_16x16x32_bf16 v[36:39], a[248:251], v[72:75], v[36:39]
    v_mfma_f32_16x16x32_bf16 v[40:43], a[252:255], v[72:75], v[40:43]
    v_mfma_f32_16x16x32_bf16 v[32:35], a[252:255], v[68:71], v[32:35]
    s_nop 1
    v_cvt_pk_bf16_f32 v148, v28, v29
    v_cvt_pk_bf16_f32 v149, v30, v31
    s_nop 3
    v_cvt_pk_bf16_f32 v150, v32, v33
    v_cvt_pk_bf16_f32 v151, v34, v35
    buffer_store_dwordx4 v[148:151], v1, s[16:19], s44 offen offset:0 sc1
    v_cvt_pk_bf16_f32 v152, v36, v37
    v_cvt_pk_bf16_f32 v153, v38, v39
    v_cvt_pk_bf16_f32 v154, v40, v41
    v_cvt_pk_bf16_f32 v155, v42, v43
    buffer_store_dwordx4 v[152:155], v1, s[16:19], s44 offen offset:1024 sc1
    s_add_u32 m0, s43, 32768
    s_add_u32 s42, s41, 32768
    v_add_f32 v140, v28, v29
    v_add_f32 v144, v36, v37
    v_mul_f32 v141, v28, v28
    v_mul_f32 v145, v36, v36
    buffer_load_dwordx4 v1, s[16:19], s42 offen offset:0 sc1 lds
    v_fmac_f32 v141, v29, v29
    v_fmac_f32 v145, v37, v37
    v_add_f32 v140, v140, v30
    v_add_f32 v144, v144, v38
    v_fmac_f32 v141, v30, v30
    v_fmac_f32 v145, v38, v38
    v_add_f32 v140, v140, v31
    v_add_f32 v144, v144, v39
    buffer_load_dwordx4 v1, s[16:19], s42 offen offset:1024 sc1 lds
    v_fmac_f32 v141, v31, v31
    v_fmac_f32 v145, v39, v39
    v_add_f32 v140, v140, v32
    v_add_f32 v144, v144, v40
    v_fmac_f32 v141, v32, v32
    v_fmac_f32 v145, v40, v40
    v_add_f32 v140, v140, v33
    v_add_f32 v144, v144, v41
    buffer_load_dwordx4 v1, s[16:19], s42 offen offset:2048 sc1 lds
    v_fmac_f32 v141, v33, v33
    v_fmac_f32 v145, v41, v41
    v_add_f32 v140, v140, v34
    v_add_f32 v144, v144, v42
    v_fmac_f32 v141, v34, v34
    v_fmac_f32 v145, v42, v42
    v_add_f32 v140, v140, v35
    v_add_f32 v144, v144, v43
    buffer_load_dwordx4 v1, s[16:19], s42 offen offset:3072 sc1 lds
    v_fmac_f32 v141, v35, v35
    v_fmac_f32 v145, v43, v43
    s_nop 0
    v_permlane16_swap_b32 v140, v141
    v_permlane16_swap_b32 v144, v145
    v_add_f32 v140, v140, v141
    v_add_f32 v144, v144, v145
    v_mov_b32 v142, v140
    v_mov_b32 v146, v144
    s_nop 0
    v_permlane32_swap_b32 v140, v142
    v_permlane32_swap_b32 v144, v146
    v_add_f32 v140, v140, v142
    v_add_f32 v144, v144, v146
    ds_write_b32 v6, v140 offset:0
    ds_write_b32 v6, v144 offset:512
    s_waitcnt vmcnt(10) lgkmcnt(0)
    s_barrier
    ds_read_b128 v[44:47], v1 offset:0
    ds_read_b128 v[48:51], v1 offset:1024
    ds_read_b128 v[52:55], v1 offset:2048
    ds_read_b128 v[56:59], v1 offset:3072
    s_add_u32 s36, s36, 1
    s_cmp_lt_u32 s36, 32
    s_cbranch_scc1 L_o_b0
    s_nop 7
    ds_read_b128 v[140:143], v7
    s_cmp_eq_u32 s36, 0
    s_cselect_b32 s49, 0x5e00000, s46
    s_waitcnt lgkmcnt(0)
    v_add_f32 v140, v140, v141
    v_add_f32 v142, v142, v143
    v_add_f32 v140, v140, v142
    v_min_u32 v140, -2, v140
    buffer_store_dword v140, v8, s[16:19], s49 offen sc1
    s_waitcnt vmcnt(5)
    s_barrier
    buffer_store_dword v124, v124, s[16:19], s91 offen sc1
    s_add_u32 s91, s91, 65536
    s_waitcnt vmcnt(0)
    s_endpgm
L_spin24:
    s_mov_b32 s40, 0x20000
L_spin24_l:
    buffer_load_dword v12, v124, s[20:23], 0 offen sc1
    s_sub_u32 s40, s40, 1
    s_waitcnt vmcnt(0)
    v_cmp_eq_u32 vcc, v124, v12
    s_cbranch_scc1 L_back25
    s_cbranch_vccz L_back25
    s_sleep 8
    s_branch L_spin24_l
L_spin26:
    s_mov_b32 s40, 0x20000
L_spin26_l:
    buffer_load_dword v136, v4, s[16:19], s45 offen sc1
    s_sub_u32 s40, s40, 1
    s_waitcnt vmcnt(0)
    v_cmp_ne_u32 vcc, 0, v136
    s_cbranch_scc1 L_back27
    s_cbranch_vccz L_back27
    s_sleep 2
    s_branch L_spin26_l
L_spin28:
    s_mov_b32 s40, 0x20000
L_spin28_l:
    buffer_load_dword v136, v4, s[16:19], s45 offen sc1
    s_sub_u32 s40, s40, 1
    s_waitcnt vmcnt(0)
    v_cmp_ne_u32 vcc, 0, v136
    s_cbranch_scc1 L_back29
    s_cbranch_vccz L_back29
    s_sleep 2
    s_branch L_spin28_l
L_spin30:
    s_mov_b32 s40, 0x20000
L_spin30_l:
    buffer_load_dword v136, v4, s[16:19], s45 offen sc1
    s_sub_u32 s40, s40, 1
    s_waitcnt vmcnt(0)
    v_cmp_ne_u32 vcc, 0, v136
    s_cbranch_scc1 L_back31
    s_cbranch_vccz L_back31
    s_sleep 2
    s_branch L_spin30_l
L_role_40:
    s_sub_u32 s35, s34, 40
    s_lshl_b32 s51, s35, 2
    s_add_u32 s51, s51, 96
    s_lshl_b32 s54, s51, 6
    s_mov_b32 s12, s72
    s_mov_b32 s13, s73
    s_mov_b32 s14, 0x700000
    s_mov_b32 s15, 0x00020000
    s_mov_b32 s39, 7168
    v_lshrrev_b32 v64, 3, v0
    v_lshlrev_b32 v65, 2, v0
    v_and_b32 v65, 64, v65
    v_and_b32 v66, 0x70, v1
    v_xor_b32 v65, v65, v66
    v_mad_u32_u24 v56, v64, s39, v65
    v_add_u32 v57, 57344, v56
    v_add_u32 v58, 128, v56
    v_add_u32 v59, 57472, v56
    s_mul_i32 s38, s32, 114688
    s_add_u32 s54, s54, s38
    s_lshl_b32 s42, s32, 11
    s_add_u32 m0, s42, 0
    s_nop 0
    buffer_load_dwordx4 v56, s[12:15], s54 offen lds
    s_add_u32 m0, s42, 1024
    s_nop 0
    buffer_load_dwordx4 v57, s[12:15], s54 offen lds
    s_add_u32 m0, s42, 8192
    s_nop 0
    buffer_load_dwordx4 v58, s[12:15], s54 offen lds
    s_add_u32 m0, s42, 9216
    s_nop 0
    buffer_load_dwordx4 v59, s[12:15], s54 offen lds
    s_add_u32 s54, s54, 458752
    s_add_u32 m0, s42, 16384
    s_nop 0
    buffer_load_dwordx4 v56, s[12:15], s54 offen lds
    s_add_u32 m0, s42, 17408
    s_nop 0
    buffer_load_dwordx4 v57, s[12:15], s54 offen lds
    s_add_u32 m0, s42, 24576
    s_nop 0
    buffer_load_dwordx4 v58, s[12:15], s54 offen lds
    s_add_u32 m0, s42, 25600
    s_nop 0
    buffer_load_dwordx4 v59, s[12:15], s54 offen lds
    s_add_u32 s54, s54, 458752
    s_add_u32 m0, s42, 32768
    s_nop 0
    buffer_load_dwordx4 v56, s[12:15], s54 offen lds
    s_add_u32 m0, s42, 33792
    s_nop 0
    buffer_load_dwordx4 v57, s[12:15], s54 offen lds
    s_add_u32 m0, s42, 40960
    s_nop 0
    buffer_load_dwordx4 v58, s[12:15], s54 offen lds
    s_add_u32 m0, s42, 41984
    s_nop 0
    buffer_load_dwordx4 v59, s[12:15], s54 offen lds
    s_add_u32 s54, s54, 458752
    s_add_u32 m0, s42, 49152
    s_nop 0
    buffer_load_dwordx4 v56, s[12:15], s54 offen lds
    s_add_u32 m0, s42, 50176
    s_nop 0
    buffer_load_dwordx4 v57, s[12:15], s54 offen lds
    s_add_u32 m0, s42, 57344
    s_nop 0
    buffer_load_dwordx4 v58, s[12:15], s54 offen lds
    s_add_u32 m0, s42, 58368
    s_nop 0
    buffer_load_dwordx4 v59, s[12:15], s54 offen lds
    s_add_u32 s54, s54, 458752
    s_add_u32 m0, s42, 65536
    s_nop 0
    buffer_load_dwordx4 v56, s[12:15], s54 offen lds
    s_add_u32 m0, s42, 66560
    s_nop 0
    buffer_load_dwordx4 v57, s[12:15], s54 offen lds
    s_add_u32 m0, s42, 73728
    s_nop 0
    buffer_load_dwordx4 v58, s[12:15], s54 offen lds
    s_add_u32 m0, s42, 74752
    s_nop 0
    buffer_load_dwordx4 v59, s[12:15], s54 offen lds
    s_add_u32 s54, s54, 458752
    v_lshrrev_b32 v64, 4, v0
    v_bfe_u32 v65, v0, 2, 2
    v_lshl_add_u32 v64, v64, 3, v65
    v_lshlrev_b32 v64, 7, v64
    v_lshrrev_b32 v65, 1, v65
    v_lshl_add_u32 v64, v65, 6, v64
    v_and_b32 v65, 3, v0
    v_lshl_add_u32 v64, v65, 4, v64
    s_lshr_b32 s37, s32, 1
    s_lshl_b32 s37, s37, 13
    s_and_b32 s38, s32, 1
    s_lshl_b32 s38, s38, 6
    s_add_u32 s37, s37, s38
    s_add_u32 s37, s37, 0
    v_xor_b32 v60, s37, v64
    s_lshr_b32 s37, s32, 1
    s_lshl_b32 s37, s37, 13
    s_and_b32 s38, s32, 1
    s_lshl_b32 s38, s38, 6
    s_add_u32 s37, s37, s38
    s_add_u32 s37, s37, 8
    v_xor_b32 v61, s37, v64
    v_mov_b32 v64, 0x3f803f80
    v_mov_b32 v65, 0x3f803f80
    v_mov_b32 v66, 0x3f803f80
    v_mov_b32 v67, 0x3f803f80
    v_add_u32 v2, 98304, v1
    s_lshl_b32 s37, s33, 6
    s_add_u32 s37, s37, 16
    s_lshl_b32 s37, s37, 7
    v_lshl_add_u32 v5, v0, 7, s37
    s_cmp_eq_u32 s32, 0
    s_cselect_b32 s37, 8, 0
    v_cmp_le_u32 vcc, s37, v0
    s_nop 1
    v_cndmask_b32 v5, v5, 2.0, vcc
    s_lshl_b32 s43, s32, 12
    s_mul_i32 s41, s33, 2097152
    s_add_u32 s41, s41, 0x800000
    s_add_u32 s41, s41, s43
    s_mul_i32 s90, s33, 8388608
    s_add_u32 s90, s90, 0xfc0000
    s_add_u32 s37, s51, s32
    s_lshl_b32 s37, s37, 11
    s_add_u32 s90, s90, s37
    s_lshl_b32 s37, s32, 10
    s_sub_u32 s87, 8192, s37
    s_lshl_b32 s38, s35, 1
    s_lshr_b32 s39, s32, 1
    s_add_u32 s38, s38, s39
    s_cmp_eq_u32 s38, 36
    s_cselect_b32 s88, 0x5e00000, 0
    s_and_b32 s38, s32, 1
    s_lshl_b32 s38, s38, 3
    s_and_b32 s39, s32, 2
    s_lshl_b32 s39, s39, 10
    s_add_u32 s38, s38, s39
    s_add_u32 s38, s38, 65536
    v_add_u32 v3, s38, v1
    s_add_u32 s37, s37, 65536
    v_add_u32 v4, s37, v1
    v_and_b32 v6, 15, v0
    v_lshlrev_b32 v6, 3, v6
    v_lshrrev_b32 v8, 5, v0
    v_lshl_add_u32 v6, v8, 9, v6
    v_and_b32 v8, 16, v0
    v_lshl_add_u32 v6, v8, 6, v6
    v_add_u32 v118, 73728, v6
    s_mul_i32 s46, s33, 65536
    s_add_u32 s46, s46, 0x5440000
    s_add_u32 s55, s46, 63488
    s_and_b32 s52, s32, 1
    s_lshl_b32 s52, s52, 10
    s_mov_b32 s8, s74
    s_mov_b32 s9, s75
    s_mov_b32 s10, 0x1c00
    s_mov_b32 s11, 0x00020000
    v_and_b32 v8, 0x30, v0
    s_add_u32 s37, s51, s32
    s_lshl_b32 s37, s37, 6
    buffer_load_dwordx4 v[16:19], v8, s[8:11], s37 offen
    s_lshr_b32 s37, s32, 1
    s_add_u32 s37, s37, s51
    s_lshl_b32 s37, s37, 6
    s_and_b32 s38, s32, 1
    s_lshl_b32 s38, s38, 3
    s_add_u32 s37, s37, s38
    buffer_load_dwordx2 v[20:21], v8, s[8:11], s37 offen offset:256
    v_add_u32 v62, 0, v60
    v_add_u32 v63, 0, v61
    s_waitcnt vmcnt(18)
    s_barrier
    ds_read_b64_tr_b16 a[0:1], v62 offset:0
    ds_read_b64_tr_b16 a[2:3], v62 offset:512
    ds_read_b64_tr_b16 a[4:5], v63 offset:0
    ds_read_b64_tr_b16 a[6:7], v63 offset:512
    ds_read_b64_tr_b16 a[8:9], v62 offset:4096
    ds_read_b64_tr_b16 a[10:11], v62 offset:4608
    ds_read_b64_tr_b16 a[12:13], v63 offset:4096
    ds_read_b64_tr_b16 a[14:15], v63 offset:4608
    s_add_u32 m0, s42, 81920
    s_nop 0
    buffer_load_dwordx4 v56, s[12:15], s54 offen lds
    s_add_u32 m0, s42, 82944
    s_nop 0
    buffer_load_dwordx4 v57, s[12:15], s54 offen lds
    s_add_u32 m0, s42, 90112
    s_nop 0
    buffer_load_dwordx4 v58, s[12:15], s54 offen lds
    s_add_u32 m0, s42, 91136
    s_nop 0
    buffer_load_dwordx4 v59, s[12:15], s54 offen lds
    s_add_u32 s54, s54, 458752
    s_waitcnt lgkmcnt(0)
    v_mfma_f32_16x16x32_bf16 v[88:91], a[0:3], v[64:67], 0
    v_mfma_f32_16x16x32_bf16 v[92:95], a[4:7], v[64:67], 0
    v_mfma_f32_16x16x32_bf16 v[88:91], a[8:11], v[64:67], v[88:91]
    v_mfma_f32_16x16x32_bf16 v[92:95], a[12:15], v[64:67], v[92:95]
    v_add_u32 v62, 16384, v60
    v_add_u32 v63, 16384, v61
    s_waitcnt vmcnt(18)
    s_barrier
    ds_read_b64_tr_b16 a[16:17], v62 offset:0
    ds_read_b64_tr_b16 a[18:19], v62 offset:512
    ds_read_b64_tr_b16 a[20:21], v63 offset:0
    ds_read_b64_tr_b16 a[22:23], v63 offset:512
    ds_read_b64_tr_b16 a[24:25], v62 offset:4096
    ds_read_b64_tr_b16 a[26:27], v62 offset:4608
    ds_read_b64_tr_b16 a[28:29], v63 offset:4096
    ds_read_b64_tr_b16 a[30:31], v63 offset:4608
    s_add_u32 m0, s42, 0
    s_nop 0
    buffer_load_dwordx4 v56, s[12:15], s54 offen lds
    s_add_u32 m0, s42, 1024
    s_nop 0
    buffer_load_dwordx4 v57, s[12:15], s54 offen lds
    s_add_u32 m0, s42, 8192
    s_nop 0
    buffer_load_dwordx4 v58, s[12:15], s54 offen lds
    s_add_u32 m0, s42, 9216
    s_nop 0
    buffer_load_dwordx4 v59, s[12:15], s54 offen lds
    s_add_u32 s54, s54, 458752
    s_waitcnt lgkmcnt(0)
    v_mfma_f32_16x16x32_bf16 v[88:91], a[16:19], v[64:67], v[88:91]
    v_mfma_f32_16x16x32_bf16 v[92:95], a[20:23], v[64:67], v[92:95]
    v_mfma_f32_16x16x32_bf16 v[88:91], a[24:27], v[64:67], v[88:91]
    v_mfma_f32_16x16x32_bf16 v[92:95], a[28:31], v[64:67], v[92:95]
    v_add_u32 v62, 32768, v60
    v_add_u32 v63, 32768, v61
    s_waitcnt vmcnt(18)
    s_barrier
    ds_read_b64_tr_b16 a[32:33], v62 offset:0
    ds_read_b64_tr_b16 a[34:35], v62 offset:512
    ds_read_b64_tr_b16 a[36:37], v63 offset:0
    ds_read_b64_tr_b16 a[38:39], v63 offset:512
    ds_read_b64_tr_b16 a[40:41], v62 offset:4096
    ds_read_b64_tr_b16 a[42:43], v62 offset:4608
    ds_read_b64_tr_b16 a[44:45], v63 offset:4096
    ds_read_b64_tr_b16 a[46:47], v63 offset:4608
    s_add_u32 m0, s42, 16384
    s_nop 0
    buffer_load_dwordx4 v56, s[12:15], s54 offen lds
    s_add_u32 m0, s42, 17408
    s_nop 0
    buffer_load_dwordx4 v57, s[12:15], s54 offen lds
    s_add_u32 m0, s42, 24576
    s_nop 0
    buffer_load_dwordx4 v58, s[12:15], s54 offen lds
    s_add_u32 m0, s42, 25600
    s_nop 0
    buffer_load_dwordx4 v59, s[12:15], s54 offen lds
    s_add_u32 s54, s54, 458752
    s_waitcnt lgkmcnt(0)
    v_mfma_f32_16x16x32_bf16 v[88:91], a[32:35], v[64:67], v[88:91]
    v_mfma_f32_16x16x32_bf16 v[92:95], a[36:39], v[64:67], v[92:95]
    v_mfma_f32_16x16x32_bf16 v[88:91], a[40:43], v[64:67], v[88:91]
    v_mfma_f32_16x16x32_bf16 v[92:95], a[44:47], v[64:67], v[92:95]
    v_add_u32 v62, 49152, v60
    v_add_u32 v63, 49152, v61
    s_waitcnt vmcnt(18)
    s_barrier
    ds_read_b64_tr_b16 a[48:49], v62 offset:0
    ds_read_b64_tr_b16 a[50:51], v62 offset:512
    ds_read_b64_tr_b16 a[52:53], v63 offset:0
    ds_read_b64_tr_b16 a[54:55], v63 offset:512
    ds_read_b64_tr_b16 a[56:57], v62 offset:4096
    ds_read_b64_tr_b16 a[58:59], v62 offset:4608
    ds_read_b64_tr_b16 a[60:61], v63 offset:4096
    ds_read_b64_tr_b16 a[62:63], v63 offset:4608
    s_add_u32 m0, s42, 32768
    s_nop 0
    buffer_load_dwordx4 v56, s[12:15], s54 offen lds
    s_add_u32 m0, s42, 33792
    s_nop 0
    buffer_load_dwordx4 v57, s[12:15], s54 offen lds
    s_add_u32 m0, s42, 40960
    s_nop 0
    buffer_load_dwordx4 v58, s[12:15], s54 offen lds
    s_add_u32 m0, s42, 41984
    s_nop 0
    buffer_load_dwordx4 v59, s[12:15], s54 offen lds
    s_add_u32 s54, s54, 458752
    s_waitcnt lgkmcnt(0)
    v_mfma_f32_16x16x32_bf16 v[88:91], a[48:51], v[64:67], v[88:91]
    v_mfma_f32_16x16x32_bf16 v[92:95], a[52:55], v[64:67], v[92:95]
    v_mfma_f32_16x16x32_bf16 v[88:91], a[56:59], v[64:67], v[88:91]
    v_mfma_f32_16x16x32_bf16 v[92:95], a[60:63], v[64:67], v[92:95]
    v_add_u32 v62, 65536, v60
    v_add_u32 v63, 65536, v61
    s_waitcnt vmcnt(18)
    s_barrier
    ds_read_b64_tr_b16 a[64:65], v62 offset:0
    ds_read_b64_tr_b16 a[66:67], v62 offset:512
    ds_read_b64_tr_b16 a[68:69], v63 offset:0
    ds_read_b64_tr_b16 a[70:71], v63 offset:512
    ds_read_b64_tr_b16 a[72:73], v62 offset:4096
    ds_read_b64_tr_b16 a[74:75], v62 offset:4608
    ds_read_b64_tr_b16 a[76:77], v63 offset:4096
    ds_read_b64_tr_b16 a[78:79], v63 offset:4608
    s_add_u32 m0, s42, 49152
    s_nop 0
    buffer_load_dwordx4 v56, s[12:15], s54 offen lds
    s_add_u32 m0, s42, 50176
    s_nop 0
    buffer_load_dwordx4 v57, s[12:15], s54 offen lds
    s_add_u32 m0, s42, 57344
    s_nop 0
    buffer_load_dwordx4 v58, s[12:15], s54 offen lds
    s_add_u32 m0, s42, 58368
    s_nop 0
    buffer_load_dwordx4 v59, s[12:15], s54 offen lds
    s_add_u32 s54, s54, 458752
    s_waitcnt lgkmcnt(0)
    v_mfma_f32_16x16x32_bf16 v[88:91], a[64:67], v[64:67], v[88:91]
    v_mfma_f32_16x16x32_bf16 v[92:95], a[68:71], v[64:67], v[92:95]
    v_mfma_f32_16x16x32_bf16 v[88:91], a[72:75], v[64:67], v[88:91]
    v_mfma_f32_16x16x32_bf16 v[92:95], a[76:79], v[64:67], v[92:95]
    v_add_u32 v62, 81920, v60
    v_add_u32 v63, 81920, v61
    s_waitcnt vmcnt(16)
    s_barrier
    ds_read_b64_tr_b16 a[80:81], v62 offset:0
    ds_read_b64_tr_b16 a[82:83], v62 offset:512
    ds_read_b64_tr_b16 a[84:85], v63 offset:0
    ds_read_b64_tr_b16 a[86:87], v63 offset:512
    ds_read_b64_tr_b16 a[88:89], v62 offset:4096
    ds_read_b64_tr_b16 a[90:91], v62 offset:4608
    ds_read_b64_tr_b16 a[92:93], v63 offset:4096
    ds_read_b64_tr_b16 a[94:95], v63 offset:4608
    s_add_u32 m0, s42, 65536
    s_nop 0
    buffer_load_dwordx4 v56, s[12:15], s54 offen lds
    s_add_u32 m0, s42, 66560
    s_nop 0
    buffer_load_dwordx4 v57, s[12:15], s54 offen lds
    s_add_u32 m0, s42, 73728
    s_nop 0
    buffer_load_dwordx4 v58, s[12:15], s54 offen lds
    s_add_u32 m0, s42, 74752
    s_nop 0
    buffer_load_dwordx4 v59, s[12:15], s54 offen lds
    s_add_u32 s54, s54, 458752
    s_waitcnt lgkmcnt(0)
    v_mfma_f32_16x16x32_bf16 v[88:91], a[80:83], v[64:67], v[88:91]
    v_mfma_f32_16x16x32_bf16 v[92:95], a[84:87], v[64:67], v[92:95]
    v_mfma_f32_16x16x32_bf16 v[88:91], a[88:91], v[64:67], v[88:91]
    v_mfma_f32_16x16x32_bf16 v[92:95], a[92:95], v[64:67], v[92:95]
    v_add_u32 v62, 0, v60
    v_add_u32 v63, 0, v61
    s_waitcnt vmcnt(16)
    s_barrier
    ds_read_b64_tr_b16 a[96:97], v62 offset:0
    ds_read_b64_tr_b16 a[98:99], v62 offset:512
    ds_read_b64_tr_b16 a[100:101], v63 offset:0
    ds_read_b64_tr_b16 a[102:103], v63 offset:512
    ds_read_b64_tr_b16 a[104:105], v62 offset:4096
    ds_read_b64_tr_b16 a[106:107], v62 offset:4608
    ds_read_b64_tr_b16 a[108:109], v63 offset:4096
    ds_read_b64_tr_b16 a[110:111], v63 offset:4608
    s_add_u32 m0, s42, 81920
    s_nop 0
    buffer_load_dwordx4 v56, s[12:15], s54 offen lds
    s_add_u32 m0, s42, 82944
    s_nop 0
    buffer_load_dwordx4 v57, s[12:15], s54 offen lds
    s_add_u32 m0, s42, 90112
    s_nop 0
    buffer_load_dwordx4 v58, s[12:15], s54 offen lds
    s_add_u32 m0, s42, 91136
    s_nop 0
    buffer_load_dwordx4 v59, s[12:15], s54 offen lds
    s_add_u32 s54, s54, 458752
    s_waitcnt lgkmcnt(0)
    v_mfma_f32_16x16x32_bf16 v[88:91], a[96:99], v[64:67], v[88:91]
    v_mfma_f32_16x16x32_bf16 v[92:95], a[100:103], v[64:67], v[92:95]
    v_mfma_f32_16x16x32_bf16 v[88:91], a[104:107], v[64:67], v[88:91]
    v_mfma_f32_16x16x32_bf16 v[92:95], a[108:111], v[64:67], v[92:95]
    v_add_u32 v62, 16384, v60
    v_add_u32 v63, 16384, v61
    s_waitcnt vmcnt(16)
    s_barrier
    ds_read_b64_tr_b16 a[112:113], v62 offset:0
    ds_read_b64_tr_b16 a[114:115], v62 offset:512
    ds_read_b64_tr_b16 a[116:117], v63 offset:0
    ds_read_b64_tr_b16 a[118:119], v63 offset:512
    ds_read_b64_tr_b16 a[120:121], v62 offset:4096
    ds_read_b64_tr_b16 a[122:123], v62 offset:4608
    ds_read_b64_tr_b16 a[124:125], v63 offset:4096
    ds_read_b64_tr_b16 a[126:127], v63 offset:4608
    s_add_u32 m0, s42, 0
    s_nop 0
    buffer_load_dwordx4 v56, s[12:15], s54 offen lds
    s_add_u32 m0, s42, 1024
    s_nop 0
    buffer_load_dwordx4 v57, s[12:15], s54 offen lds
    s_add_u32 m0, s42, 8192
    s_nop 0
    buffer_load_dwordx4 v58, s[12:15], s54 offen lds
    s_add_u32 m0, s42, 9216
    s_nop 0
    buffer_load_dwordx4 v59, s[12:15], s54 offen lds
    s_add_u32 s54, s54, 458752
    s_waitcnt lgkmcnt(0)
    v_mfma_f32_16x16x32_bf16 v[88:91], a[112:115], v[64:67], v[88:91]
    v_mfma_f32_16x16x32_bf16 v[92:95], a[116:119], v[64:67], v[92:95]
    v_mfma_f32_16x16x32_bf16 v[88:91], a[120:123], v[64:67], v[88:91]
    v_mfma_f32_16x16x32_bf16 v[92:95], a[124:127], v[64:67], v[92:95]
    v_add_u32 v62, 32768, v60
    v_add_u32 v63, 32768, v61
    s_waitcnt vmcnt(16)
    s_barrier
    ds_read_b64_tr_b16 a[128:129], v62 offset:0
    ds_read_b64_tr_b16 a[130:131], v62 offset:512
    ds_read_b64_tr_b16 a[132:133], v63 offset:0
    ds_read_b64_tr_b16 a[134:135], v63 offset:512
    ds_read_b64_tr_b16 a[136:137], v62 offset:4096
    ds_read_b64_tr_b16 a[138:139], v62 offset:4608
    ds_read_b64_tr_b16 a[140:141], v63 offset:4096
    ds_read_b64_tr_b16 a[142:143], v63 offset:4608
    s_add_u32 m0, s42, 16384
    s_nop 0
    buffer_load_dwordx4 v56, s[12:15], s54 offen lds
    s_add_u32 m0, s42, 17408
    s_nop 0
    buffer_load_dwordx4 v57, s[12:15], s54 offen lds
    s_add_u32 m0, s42, 24576
    s_nop 0
    buffer_load_dwordx4 v58, s[12:15], s54 offen lds
    s_add_u32 m0, s42, 25600
    s_nop 0
    buffer_load_dwordx4 v59, s[12:15], s54 offen lds
    s_add_u32 s54, s54, 458752
    s_waitcnt lgkmcnt(0)
    v_mfma_f32_16x16x32_bf16 v[88:91], a[128:131], v[64:67], v[88:91]
    v_mfma_f32_16x16x32_bf16 v[92:95], a[132:135], v[64:67], v[92:95]
    v_mfma_f32_16x16x32_bf16 v[88:91], a[136:139], v[64:67], v[88:91]
    v_mfma_f32_16x16x32_bf16 v[92:95], a[140:143], v[64:67], v[92:95]
    v_add_u32 v62, 49152, v60
    v_add_u32 v63, 49152, v61
    s_waitcnt vmcnt(16)
    s_barrier
    ds_read_b64_tr_b16 a[144:145], v62 offset:0
    ds_read_b64_tr_b16 a[146:147], v62 offset:512
    ds_read_b64_tr_b16 a[148:149], v63 offset:0
    ds_read_b64_tr_b16 a[150:151], v63 offset:512
    ds_read_b64_tr_b16 a[152:153], v62 offset:4096
    ds_read_b64_tr_b16 a[154:155], v62 offset:4608
    ds_read_b64_tr_b16 a[156:157], v63 offset:4096
    ds_read_b64_tr_b16 a[158:159], v63 offset:4608
    s_add_u32 m0, s42, 32768
    s_nop 0
    buffer_load_dwordx4 v56, s[12:15], s54 offen lds
    s_add_u32 m0, s42, 33792
    s_nop 0
    buffer_load_dwordx4 v57, s[12:15], s54 offen lds
    s_add_u32 m0, s42, 40960
    s_nop 0
    buffer_load_dwordx4 v58, s[12:15], s54 offen lds
    s_add_u32 m0, s42, 41984
    s_nop 0
    buffer_load_dwordx4 v59, s[12:15], s54 offen lds
    s_add_u32 s54, s54, 458752
    s_waitcnt lgkmcnt(0)
    v_mfma_f32_16x16x32_bf16 v[88:91], a[144:147], v[64:67], v[88:91]
    v_mfma_f32_16x16x32_bf16 v[92:95], a[148:151], v[64:67], v[92:95]
    v_mfma_f32_16x16x32_bf16 v[88:91], a[152:155], v[64:67], v[88:91]
    v_mfma_f32_16x16x32_bf16 v[92:95], a[156:159], v[64:67], v[92:95]
    v_add_u32 v62, 65536, v60
    v_add_u32 v63, 65536, v61
    s_waitcnt vmcnt(16)
    s_barrier
    ds_read_b64_tr_b16 a[160:161], v62 offset:0
    ds_read_b64_tr_b16 a[162:163], v62 offset:512
    ds_read_b64_tr_b16 a[164:165], v63 offset:0
    ds_read_b64_tr_b16 a[166:167], v63 offset:512
    ds_read_b64_tr_b16 a[168:169], v62 offset:4096
    ds_read_b64_tr_b16 a[170:171], v62 offset:4608
    ds_read_b64_tr_b16 a[172:173], v63 offset:4096
    ds_read_b64_tr_b16 a[174:175], v63 offset:4608
    s_add_u32 m0, s42, 49152
    s_nop 0
    buffer_load_dwordx4 v56, s[12:15], s54 offen lds
    s_add_u32 m0, s42, 50176
    s_nop 0
    buffer_load_dwordx4 v57, s[12:15], s54 offen lds
    s_add_u32 m0, s42, 57344
    s_nop 0
    buffer_load_dwordx4 v58, s[12:15], s54 offen lds
    s_add_u32 m0, s42, 58368
    s_nop 0
    buffer_load_dwordx4 v59, s[12:15], s54 offen lds
    s_add_u32 s54, s54, 458752
    s_waitcnt lgkmcnt(0)
    v_mfma_f32_16x16x32_bf16 v[88:91], a[160:163], v[64:67], v[88:91]
    v_mfma_f32_16x16x32_bf16 v[92:95], a[164:167], v[64:67], v[92:95]
    v_mfma_f32_16x16x32_bf16 v[88:91], a[168:171], v[64:67], v[88:91]
    v_mfma_f32_16x16x32_bf16 v[92:95], a[172:175], v[64:67], v[92:95]
    v_add_u32 v62, 81920, v60
    v_add_u32 v63, 81920, v61
    s_waitcnt vmcnt(16)
    s_barrier
    ds_read_b64_tr_b16 a[176:177], v62 offset:0
    ds_read_b64_tr_b16 a[178:179], v62 offset:512
    ds_read_b64_tr_b16 a[180:181], v63 offset:0
    ds_read_b64_tr_b16 a[182:183], v63 offset:512
    ds_read_b64_tr_b16 a[184:185], v62 offset:4096
    ds_read_b64_tr_b16 a[186:187], v62 offset:4608
    ds_read_b64_tr_b16 a[188:189], v63 offset:4096
    ds_read_b64_tr_b16 a[190:191], v63 offset:4608
    s_waitcnt lgkmcnt(0)
    v_mfma_f32_16x16x32_bf16 v[88:91], a[176:179], v[64:67], v[88:91]
    v_mfma_f32_16x16x32_bf16 v[92:95], a[180:183], v[64:67], v[92:95]
    v_mfma_f32_16x16x32_bf16 v[88:91], a[184:187], v[64:67], v[88:91]
    v_mfma_f32_16x16x32_bf16 v[92:95], a[188:191], v[64:67], v[92:95]
    v_add_u32 v62, 0, v60
    v_add_u32 v63, 0, v61
    s_waitcnt vmcnt(12)
    s_barrier
    ds_read_b64_tr_b16 a[192:193], v62 offset:0
    ds_read_b64_tr_b16 a[194:195], v62 offset:512
    ds_read_b64_tr_b16 a[196:197], v63 offset:0
    ds_read_b64_tr_b16 a[198:199], v63 offset:512
    ds_read_b64_tr_b16 a[200:201], v62 offset:4096
    ds_read_b64_tr_b16 a[202:203], v62 offset:4608
    ds_read_b64_tr_b16 a[204:205], v63 offset:4096
    ds_read_b64_tr_b16 a[206:207], v63 offset:4608
    s_waitcnt lgkmcnt(0)
    v_mfma_f32_16x16x32_bf16 v[88:91], a[192:195], v[64:67], v[88:91]
    v_mfma_f32_16x16x32_bf16 v[92:95], a[196:199], v[64:67], v[92:95]
    v_mfma_f32_16x16x32_bf16 v[88:91], a[200:203], v[64:67], v[88:91]
    v_mfma_f32_16x16x32_bf16 v[92:95], a[204:207], v[64:67], v[92:95]
    v_add_u32 v62, 16384, v60
    v_add_u32 v63, 16384, v61
    s_waitcnt vmcnt(8)
    s_barrier
    ds_read_b64_tr_b16 a[208:209], v62 offset:0
    ds_read_b64_tr_b16 a[210:211], v62 offset:512
    ds_read_b64_tr_b16 a[212:213], v63 offset:0
    ds_read_b64_tr_b16 a[214:215], v63 offset:512
    ds_read_b64_tr_b16 a[216:217], v62 offset:4096
    ds_read_b64_tr_b16 a[218:219], v62 offset:4608
    ds_read_b64_tr_b16 a[220:221], v63 offset:4096
    ds_read_b64_tr_b16 a[222:223], v63 offset:4608
    s_waitcnt lgkmcnt(0)
    v_mfma_f32_16x16x32_bf16 v[88:91], a[208:211], v[64:67], v[88:91]
    v_mfma_f32_16x16x32_bf16 v[92:95], a[212:215], v[64:67], v[92:95]
    v_mfma_f32_16x16x32_bf16 v[88:91], a[216:219], v[64:67], v[88:91]
    v_mfma_f32_16x16x32_bf16 v[92:95], a[220:223], v[64:67], v[92:95]
    v_add_u32 v62, 32768, v60
    v_add_u32 v63, 32768, v61
    s_waitcnt vmcnt(4)
    s_barrier
    ds_read_b64_tr_b16 a[224:225], v62 offset:0
    ds_read_b64_tr_b16 a[226:227], v62 offset:512
    ds_read_b64_tr_b16 a[228:229], v63 offset:0
    ds_read_b64_tr_b16 a[230:231], v63 offset:512
    ds_read_b64_tr_b16 a[232:233], v62 offset:4096
    ds_read_b64_tr_b16 a[234:235], v62 offset:4608
    ds_read_b64_tr_b16 a[236:237], v63 offset:4096
    ds_read_b64_tr_b16 a[238:239], v63 offset:4608
    s_waitcnt lgkmcnt(0)
    v_mfma_f32_16x16x32_bf16 v[88:91], a[224:227], v[64:67], v[88:91]
    v_mfma_f32_16x16x32_bf16 v[92:95], a[228:231], v[64:67], v[92:95]
    v_mfma_f32_16x16x32_bf16 v[88:91], a[232:235], v[64:67], v[88:91]
    v_mfma_f32_16x16x32_bf16 v[92:95], a[236:239], v[64:67], v[92:95]
    v_add_u32 v62, 49152, v60
    v_add_u32 v63, 49152, v61
    s_waitcnt vmcnt(0)
    s_barrier
    ds_read_b64_tr_b16 a[240:241], v62 offset:0
    ds_read_b64_tr_b16 a[242:243], v62 offset:512
    ds_read_b64_tr_b16 a[244:245], v63 offset:0
    ds_read_b64_tr_b16 a[246:247], v63 offset:512
    ds_read_b64_tr_b16 a[248:249], v62 offset:4096
    ds_read_b64_tr_b16 a[250:251], v62 offset:4608
    ds_read_b64_tr_b16 a[252:253], v63 offset:4096
    ds_read_b64_tr_b16 a[254:255], v63 offset:4608
    s_waitcnt lgkmcnt(0)
    v_mfma_f32_16x16x32_bf16 v[88:91], a[240:243], v[64:67], v[88:91]
    v_mfma_f32_16x16x32_bf16 v[92:95], a[244:247], v[64:67], v[92:95]
    v_mfma_f32_16x16x32_bf16 v[88:91], a[248:251], v[64:67], v[88:91]
    v_mfma_f32_16x16x32_bf16 v[92:95], a[252:255], v[64:67], v[92:95]
    s_barrier
    s_mov_b32 s37, 0xffff0000
    v_lshlrev_b32 v100, 16, v16
    v_and_b32 v101, s37, v16
    v_lshlrev_b32 v102, 16, v17
    v_and_b32 v103, s37, v17
    v_lshlrev_b32 v104, 16, v18
    v_and_b32 v105, s37, v18
    v_lshlrev_b32 v106, 16, v19
    v_and_b32 v107, s37, v19
    v_lshlrev_b32 v108, 16, v20
    v_and_b32 v109, s37, v20
    v_lshlrev_b32 v110, 16, v21
    v_and_b32 v111, s37, v21
    s_cmp_lg_u32 s32, 0
    s_cbranch_scc1 L_arv32
    s_add_u32 s20, s82, 0x80
    s_addc_u32 s21, s83, 0
    s_mov_b32 s22, 0x4
    s_mov_b32 s23, 0x00020000
    buffer_load_dword v56, v124, s[20:23], 0 offen sc1
    s_waitcnt vmcnt(0)
    v_cmp_eq_u32 vcc, v124, v56
    s_cbranch_vccnz L_spin33
L_back34:
L_arv32:
    s_add_u32 s96, s41, 2031616
    s_mov_b32 s98, s41
    s_mov_b32 s45, 0x5530000
    buffer_load_dword v7, v5, s[16:19], s45 offen sc1
    s_waitcnt vmcnt(0)
    v_cmp_ne_u32 vcc, 0, v7
    s_cbranch_vccnz L_spin35
L_back36:
    s_barrier
    s_add_u32 m0, s43, 0
    s_add_u32 s42, s41, 0
    buffer_load_dwordx4 v1, s[16:19], s42 offen offset:0 sc1 lds
    buffer_load_dwordx4 v1, s[16:19], s42 offen offset:1024 sc1 lds
    buffer_load_dwordx4 v1, s[16:19], s42 offen offset:2048 sc1 lds
    buffer_load_dwordx4 v1, s[16:19], s42 offen offset:3072 sc1 lds
    s_add_u32 m0, s43, 16384
    s_add_u32 s42, s41, 16384
    buffer_load_dwordx4 v1, s[16:19], s42 offen offset:0 sc1 lds
    buffer_load_dwordx4 v1, s[16:19], s42 offen offset:1024 sc1 lds
    buffer_load_dwordx4 v1, s[16:19], s42 offen offset:2048 sc1 lds
    buffer_load_dwordx4 v1, s[16:19], s42 offen offset:3072 sc1 lds
    s_add_u32 s45, s45, 65536
    s_waitcnt vmcnt(0) lgkmcnt(0)
    s_barrier
    ds_read_b128 v[56:59], v1 offset:0
    ds_read_b128 v[60:63], v1 offset:1024
    ds_read_b128 v[64:67], v1 offset:2048
    ds_read_b128 v[68:71], v1 offset:3072
    s_mov_b32 s36, 0
    s_waitcnt lgkmcnt(0)
    s_nop 7
L_l_b0:
    s_waitcnt lgkmcnt(2)
    v_mfma_f32_16x16x32_bf16 v[8:11], a[0:3], v[56:59], 0
    s_add_u32 m0, s52, 73728
    ds_read_b128 v[72:75], v1 offset:4096
    s_add_u32 s42, s46, s52
    v_mfma_f32_16x16x32_bf16 v[16:19], a[0:3], v[60:63], 0
    buffer_load_dwordx4 v1, s[16:19], s42 offen sc1 lds
    v_mfma_f32_16x16x32_bf16 v[20:23], a[4:7], v[60:63], 0
    s_add_u32 m0, s43, 32768
    ds_read_b128 v[76:79], v1 offset:5120
    s_add_u32 s42, s41, 32768
    v_mfma_f32_16x16x32_bf16 v[12:15], a[4:7], v[56:59], 0
    s_waitcnt lgkmcnt(2)
    buffer_load_dwordx4 v1, s[16:19], s42 offen offset:0 sc1 lds
    v_mfma_f32_16x16x32_bf16 v[8:11], a[8:11], v[64:67], v[8:11]
    s_and_b32 s44, s90, 0xffffffff
    ds_read_b128 v[80:83], v1 offset:6144
    s_cmp_lt_i32 s36, 1
    v_mfma_f32_16x16x32_bf16 v[16:19], a[8:11], v[68:71], v[16:19]
    buffer_load_dwordx4 v1, s[16:19], s42 offen offset:1024 sc1 lds
    v_mfma_f32_16x16x32_bf16 v[20:23], a[12:15], v[68:71], v[20:23]
    s_cselect_b32 s44, 0x5e00000, s44
    ds_read_b128 v[84:87], v1 offset:7168
    s_add_u32 s90, s90, 262144
    v_mfma_f32_16x16x32_bf16 v[12:15], a[12:15], v[64:67], v[12:15]
    s_waitcnt lgkmcnt(2)
    buffer_load_dwordx4 v1, s[16:19], s42 offen offset:2048 sc1 lds
    v_mfma_f32_16x16x32_bf16 v[8:11], a[16:19], v[72:75], v[8:11]
    ds_read_b128 v[56:59], v1 offset:8192
    v_add_f32 v32, v32, v128
    v_mfma_f32_16x16x32_bf16 v[16:19], a[16:19], v[76:79], v[16:19]
    buffer_load_dwordx4 v1, s[16:19], s42 offen offset:3072 sc1 lds
    v_mfma_f32_16x16x32_bf16 v[20:23], a[20:23], v[76:79], v[20:23]
    s_add_u32 m0, s43, 49152
    ds_read_b128 v[60:63], v1 offset:9216
    v_add_f32 v33, v33, v129
    v_mfma_f32_16x16x32_bf16 v[12:15], a[20:23], v[72:75], v[12:15]
    s_waitcnt lgkmcnt(2)
    v_mul_f32 v120, v32, v116
    v_mul_f32 v121, v33, v116
    v_mfma_f32_16x16x32_bf16 v[8:11], a[24:27], v[80:83], v[8:11]
    s_add_u32 s42, s41, 49152
    ds_read_b128 v[64:67], v1 offset:10240
    buffer_load_dwordx4 v1, s[16:19], s42 offen offset:0 sc1 lds
    v_mfma_f32_16x16x32_bf16 v[16:19], a[24:27], v[84:87], v[16:19]
    v_mul_f32 v120, v120, abs(v32)
    v_mul_f32 v121, v121, abs(v33)
    v_mfma_f32_16x16x32_bf16 v[20:23], a[28:31], v[84:87], v[20:23]
    ds_read_b128 v[68:71], v1 offset:11264
    buffer_load_dwordx4 v1, s[16:19], s42 offen offset:1024 sc1 lds
    v_mfma_f32_16x16x32_bf16 v[12:15], a[28:31], v[80:83], v[12:15]
    s_waitcnt lgkmcnt(2)
    v_cvt_pk_bf16_f32 v32, v120, v121
    v_pk_max_i16 v32, v32, 0
    v_mfma_f32_16x16x32_bf16 v[8:11], a[32:35], v[56:59], v[8:11]
    ds_read_b128 v[72:75], v1 offset:12288
    buffer_load_dwordx4 v1, s[16:19], s42 offen offset:2048 sc1 lds
    v_mfma_f32_16x16x32_bf16 v[16:19], a[32:35], v[60:63], v[16:19]
    v_add_f32 v34, v34, v130
    v_add_f32 v35, v35, v131
    v_mfma_f32_16x16x32_bf16 v[20:23], a[36:39], v[60:63], v[20:23]
    ds_read_b128 v[76:79], v1 offset:13312
    buffer_load_dwordx4 v1, s[16:19], s42 offen offset:3072 sc1 lds
    v_mfma_f32_16x16x32_bf16 v[12:15], a[36:39], v[56:59], v[12:15]
    s_waitcnt lgkmcnt(2)
    v_mul_f32 v120, v34, v116
    v_mul_f32 v121, v35, v116
    v_mfma_f32_16x16x32_bf16 v[8:11], a[40:43], v[64:67], v[8:11]
    s_add_u32 s98, s98, 65536
    ds_read_b128 v[80:83], v1 offset:14336
    v_mul_f32 v120, v120, abs(v34)
    v_mfma_f32_16x16x32_bf16 v[16:19], a[40:43], v[68:71], v[16:19]
    s_min_i32 s98, s98, s96
    v_mul_f32 v121, v121, abs(v35)
    v_cvt_pk_bf16_f32 v33, v120, v121
    v_mfma_f32_16x16x32_bf16 v[20:23], a[44:47], v[68:71], v[20:23]
    s_and_b32 s41, s98, 0xffffffff
    ds_read_b128 v[84:87], v1 offset:15360
    v_pk_max_i16 v33, v33, 0
    v_mfma_f32_16x16x32_bf16 v[12:15], a[44:47], v[64:67], v[12:15]
    s_waitcnt vmcnt(9) lgkmcnt(2)
    s_barrier
    v_add_f32 v36, v36, v132
    v_mfma_f32_16x16x32_bf16 v[8:11], a[48:51], v[72:75], v[8:11]
    ds_read_b128 v[56:59], v1 offset:16384
    v_add_f32 v37, v37, v133
    v_mfma_f32_16x16x32_bf16 v[16:19], a[48:51], v[76:79], v[16:19]
    v_mul_f32 v120, v36, v116
    v_mul_f32 v121, v37, v116
    v_mfma_f32_16x16x32_bf16 v[20:23], a[52:55], v[76:79], v[20:23]
    ds_read_b128 v[60:63], v1 offset:17408
    v_mul_f32 v120, v120, abs(v36)
    v_mfma_f32_16x16x32_bf16 v[12:15], a[52:55], v[72:75], v[12:15]
    s_waitcnt lgkmcnt(2)
    v_mul_f32 v121, v121, abs(v37)
    v_cvt_pk_bf16_f32 v34, v120, v121
    v_mfma_f32_16x16x32_bf16 v[8:11], a[56:59], v[80:83], v[8:11]
    ds_read_b128 v[64:67], v1 offset:18432
    v_pk_max_i16 v34, v34, 0
    v_mfma_f32_16x16x32_bf16 v[16:19], a[56:59], v[84:87], v[16:19]
    v_add_f32 v38, v38, v134
    v_add_f32 v39, v39, v135
    v_mfma_f32_16x16x32_bf16 v[20:23], a[60:63], v[84:87], v[20:23]
    ds_read_b128 v[68:71], v1 offset:19456
    v_mul_f32 v120, v38, v116
    v_mfma_f32_16x16x32_bf16 v[12:15], a[60:63], v[80:83], v[12:15]
    s_waitcnt lgkmcnt(2)
    v_mul_f32 v121, v39, v116
    v_mul_f32 v120, v120, abs(v38)
    v_mfma_f32_16x16x32_bf16 v[8:11], a[64:67], v[56:59], v[8:11]
    ds_read_b128 v[72:75], v1 offset:20480
    v_mul_f32 v121, v121, abs(v39)
    v_mfma_f32_16x16x32_bf16 v[16:19], a[64:67], v[60:63], v[16:19]
    v_cvt_pk_bf16_f32 v35, v120, v121
    v_pk_max_i16 v35, v35, 0
    v_mfma_f32_16x16x32_bf16 v[20:23], a[68:71], v[60:63], v[20:23]
    ds_read_b128 v[76:79], v1 offset:21504
    buffer_store_dwordx4 v[32:35], v1, s[16:19], s44 offen offset:0 sc1
    v_mfma_f32_16x16x32_bf16 v[12:15], a[68:71], v[56:59], v[12:15]
    s_waitcnt lgkmcnt(2)
    v_add_f32 v40, v40, v136
    v_add_f32 v41, v41, v137
    v_mfma_f32_16x16x32_bf16 v[8:11], a[72:75], v[64:67], v[8:11]
    ds_read_b128 v[80:83], v1 offset:22528
    v_mul_f32 v120, v40, v117
    v_mfma_f32_16x16x32_bf16 v[16:19], a[72:75], v[68:71], v[16:19]
    v_mul_f32 v121, v41, v117
    v_mul_f32 v120, v120, abs(v40)
    v_mfma_f32_16x16x32_bf16 v[20:23], a[76:79], v[68:71], v[20:23]
    ds_read_b128 v[84:87], v1 offset:23552
    v_mul_f32 v121, v121, abs(v41)
    v_mfma_f32_16x16x32_bf16 v[12:15], a[76:79], v[64:67], v[12:15]
    s_waitcnt lgkmcnt(2)
    v_cvt_pk_bf16_f32 v40, v120, v121
    v_pk_max_i16 v40, v40, 0
    v_mfma_f32_16x16x32_bf16 v[8:11], a[80:83], v[72:75], v[8:11]
    ds_read_b128 v[56:59], v1 offset:24576
    v_add_f32 v42, v42, v138
    v_mfma_f32_16x16x32_bf16 v[16:19], a[80:83], v[76:79], v[16:19]
    v_add_f32 v43, v43, v139
    v_mul_f32 v120, v42, v117
    v_mfma_f32_16x16x32_bf16 v[20:23], a[84:87], v[76:79], v[20:23]
    ds_read_b128 v[60:63], v1 offset:25600
    v_mul_f32 v121, v43, v117
    v_mfma_f32_16x16x32_bf16 v[12:15], a[84:87], v[72:75], v[12:15]
    s_waitcnt lgkmcnt(2)
    v_mul_f32 v120, v120, abs(v42)
    v_mul_f32 v121, v121, abs(v43)
    v_mfma_f32_16x16x32_bf16 v[8:11], a[88:91], v[80:83], v[8:11]
    ds_read_b128 v[64:67], v1 offset:26624
    v_cvt_pk_bf16_f32 v41, v120, v121
    v_mfma_f32_16x16x32_bf16 v[16:19], a[88:91], v[84:87], v[16:19]
    v_pk_max_i16 v41, v41, 0
    v_add_f32 v44, v44, v140
    v_mfma_f32_16x16x32_bf16 v[20:23], a[92:95], v[84:87], v[20:23]
    ds_read_b128 v[68:71], v1 offset:27648
    v_add_f32 v45, v45, v141
    v_mfma_f32_16x16x32_bf16 v[12:15], a[92:95], v[80:83], v[12:15]
    s_waitcnt lgkmcnt(2)
    v_mul_f32 v120, v44, v117
    v_mul_f32 v121, v45, v117
    v_mfma_f32_16x16x32_bf16 v[8:11], a[96:99], v[56:59], v[8:11]
    ds_read_b128 v[72:75], v1 offset:28672
    v_mul_f32 v120, v120, abs(v44)
    v_mfma_f32_16x16x32_bf16 v[16:19], a[96:99], v[60:63], v[16:19]
    v_mul_f32 v121, v121, abs(v45)
    v_cvt_pk_bf16_f32 v42, v120, v121
    v_mfma_f32_16x16x32_bf16 v[20:23], a[100:103], v[60:63], v[20:23]
    ds_read_b128 v[76:79], v1 offset:29696
    buffer_load_dword v7, v5, s[16:19], s45 offen sc1
    v_mfma_f32_16x16x32_bf16 v[12:15], a[100:103], v[56:59], v[12:15]
    s_waitcnt lgkmcnt(2)
    v_pk_max_i16 v42, v42, 0
    v_add_f32 v46, v46, v142
    v_mfma_f32_16x16x32_bf16 v[8:11], a[104:107], v[64:67], v[8:11]
    ds_read_b128 v[80:83], v1 offset:30720
    v_add_f32 v47, v47, v143
    v_mfma_f32_16x16x32_bf16 v[16:19], a[104:107], v[68:71], v[16:19]
    v_mul_f32 v120, v46, v117
    v_mul_f32 v121, v47, v117
    v_mfma_f32_16x16x32_bf16 v[20:23], a[108:111], v[68:71], v[20:23]
    ds_read_b128 v[84:87], v1 offset:31744
    v_mul_f32 v120, v120, abs(v46)
    v_mfma_f32_16x16x32_bf16 v[12:15], a[108:111], v[64:67], v[12:15]
    s_waitcnt vmcnt(6) lgkmcnt(2)
    s_barrier
    v_mul_f32 v121, v121, abs(v47)
    v_mfma_f32_16x16x32_bf16 v[8:11], a[112:115], v[72:75], v[8:11]
    ds_read_b128 v[56:59], v1 offset:32768
    v_cvt_pk_bf16_f32 v43, v120, v121
    v_mfma_f32_16x16x32_bf16 v[16:19], a[112:115], v[76:79], v[16:19]
    v_pk_max_i16 v43, v43, 0
    buffer_store_dwordx4 v[40:43], v1, s[16:19], s44 offen offset:1024 sc1
    v_mfma_f32_16x16x32_bf16 v[20:23], a[116:119], v[76:79], v[20:23]
    s_add_u32 m0, s43, 98304
    ds_read_b128 v[60:63], v1 offset:33792
    ds_read_b64 v[144:145], v118 offset:0
    v_mfma_f32_16x16x32_bf16 v[12:15], a[116:119], v[72:75], v[12:15]
    s_waitcnt lgkmcnt(3)
    ds_read_b64 v[146:147], v118 offset:128
    ds_read_b64 v[148:149], v118 offset:256
    v_mfma_f32_16x16x32_bf16 v[8:11], a[120:123], v[80:83], v[8:11]
    s_add_u32 s42, s41, 0
    ds_read_b128 v[64:67], v1 offset:34816
    ds_read_b64 v[150:151], v118 offset:384
    v_mfma_f32_16x16x32_bf16 v[16:19], a[120:123], v[84:87], v[16:19]
    v_mfma_f32_16x16x32_bf16 v[20:23], a[124:127], v[84:87], v[20:23]
    ds_read_b128 v[68:71], v1 offset:35840
    v_mfma_f32_16x16x32_bf16 v[12:15], a[124:127], v[80:83], v[12:15]
    s_waitcnt lgkmcnt(6)
    v_mfma_f32_16x16x32_bf16 v[8:11], a[128:131], v[56:59], v[8:11]
    ds_read_b128 v[72:75], v1 offset:36864
    v_mfma_f32_16x16x32_bf16 v[16:19], a[128:131], v[60:63], v[16:19]
    s_waitcnt lgkmcnt(2)
    v_max3_u32 v152, v144, v145, v146
    v_max3_u32 v153, v147, v148, v149
    v_mfma_f32_16x16x32_bf16 v[20:23], a[132:135], v[60:63], v[20:23]
    ds_read_b128 v[76:79], v1 offset:37888
    v_max3_u32 v152, v152, v150, v151
    v_mfma_f32_16x16x32_bf16 v[12:15], a[132:135], v[56:59], v[12:15]
    s_waitcnt lgkmcnt(2)
    v_max_u32 v152, v152, v153
    v_cmp_eq_u32 vcc, -1, v152
    v_mfma_f32_16x16x32_bf16 v[8:11], a[136:139], v[64:67], v[8:11]
    ds_read_b128 v[80:83], v1 offset:38912
    v_mfma_f32_16x16x32_bf16 v[16:19], a[136:139], v[68:71], v[16:19]
    s_cbranch_vccnz L_sspin39
L_sback40:
    v_add_f32 v152, v148, v150
    v_add_f32 v153, v149, v151
    v_mfma_f32_16x16x32_bf16 v[20:23], a[140:143], v[68:71], v[20:23]
    ds_read_b128 v[84:87], v1 offset:39936
    v_add_f32 v144, v144, v146
    v_mfma_f32_16x16x32_bf16 v[12:15], a[140:143], v[64:67], v[12:15]
    s_waitcnt lgkmcnt(2)
    v_add_f32 v145, v145, v147
    v_add_f32 v144, v144, v152
    v_mfma_f32_16x16x32_bf16 v[8:11], a[144:147], v[72:75], v[8:11]
    ds_read_b128 v[56:59], v1 offset:40960
    v_add_f32 v145, v145, v153
    v_mfma_f32_16x16x32_bf16 v[16:19], a[144:147], v[76:79], v[16:19]
    v_mov_b32 v152, v144
    v_mov_b32 v153, v145
    v_mfma_f32_16x16x32_bf16 v[20:23], a[148:151], v[76:79], v[20:23]
    ds_read_b128 v[60:63], v1 offset:41984
    v_permlane32_swap_b32 v144, v152
    v_mfma_f32_16x16x32_bf16 v[12:15], a[148:151], v[72:75], v[12:15]
    s_waitcnt lgkmcnt(2)
    v_permlane32_swap_b32 v145, v153
    v_mfma_f32_16x16x32_bf16 v[8:11], a[152:155], v[80:83], v[8:11]
    ds_read_b128 v[64:67], v1 offset:43008
    v_add_f32 v144, v144, v152
    v_mfma_f32_16x16x32_bf16 v[16:19], a[152:155], v[84:87], v[16:19]
    v_add_f32 v145, v145, v153
    v_mul_f32 v112, 0xba800000, v144
    v_mfma_f32_16x16x32_bf16 v[20:23], a[156:159], v[84:87], v[20:23]
    ds_read_b128 v[68:71], v1 offset:44032
    v_mul_f32 v145, 0x3a800000, v145
    v_mfma_f32_16x16x32_bf16 v[12:15], a[156:159], v[80:83], v[12:15]
    s_waitcnt lgkmcnt(2)
    v_fma_f32 v145, -v112, v112, v145
    v_mov_b32 v113, v112
    v_mfma_f32_16x16x32_bf16 v[8:11], a[160:163], v[56:59], v[8:11]
    ds_read_b128 v[72:75], v1 offset:45056
    v_max_f32 v145, 0, v145
    v_mfma_f32_16x16x32_bf16 v[16:19], a[160:163], v[60:63], v[16:19]
    v_add_f32 v145, 0x3727c5ac, v145
    v_rsq_f32 v116, v145
    v_mfma_f32_16x16x32_bf16 v[20:23], a[164:167], v[60:63], v[20:23]
    ds_read_b128 v[76:79], v1 offset:46080
    v_permlane16_swap_b32 v112, v113
    v_mfma_f32_16x16x32_bf16 v[12:15], a[164:167], v[56:59], v[12:15]
    s_waitcnt lgkmcnt(2)
    v_mul_f32 v114, v145, v116
    v_mul_f32 v116, v116, v116
    v_mfma_f32_16x16x32_bf16 v[8:11], a[168:171], v[64:67], v[8:11]
    s_waitcnt vmcnt(0)
    ds_read_b128 v[80:83], v1 offset:47104
    v_mov_b32 v115, v114
    v_mfma_f32_16x16x32_bf16 v[16:19], a[168:171], v[68:71], v[16:19]
    s_barrier
    buffer_store_dword v124, v124, s[16:19], s91 offen sc1
    v_mfma_f32_16x16x32_bf16 v[20:23], a[172:175], v[68:71], v[20:23]
    s_add_u32 s91, s91, 65536
    ds_read_b128 v[84:87], v1 offset:48128
    v_cmp_ne_u32 vcc, 0, v7
    v_mfma_f32_16x16x32_bf16 v[12:15], a[172:175], v[64:67], v[12:15]
    s_waitcnt lgkmcnt(2)
    v_mov_b32 v117, v116
    v_permlane16_swap_b32 v114, v115
    v_mfma_f32_16x16x32_bf16 v[8:11], a[176:179], v[72:75], v[8:11]
    s_cbranch_vccnz L_spin37
L_back38:
    ds_read_b128 v[56:59], v1 offset:49152
    v_permlane16_swap_b32 v116, v117
    v_mfma_f32_16x16x32_bf16 v[16:19], a[176:179], v[76:79], v[16:19]
    s_barrier
    buffer_load_dwordx4 v1, s[16:19], s42 offen offset:0 sc1 lds
    v_mfma_f32_16x16x32_bf16 v[20:23], a[180:183], v[76:79], v[20:23]
    s_add_u32 s46, s46, 2048
    ds_read_b128 v[60:63], v1 offset:50176
    buffer_load_dwordx4 v1, s[16:19], s42 offen offset:1024 sc1 lds
    v_mfma_f32_16x16x32_bf16 v[12:15], a[180:183], v[72:75], v[12:15]
    s_waitcnt lgkmcnt(2)
    buffer_load_dwordx4 v1, s[16:19], s42 offen offset:2048 sc1 lds
    v_mfma_f32_16x16x32_bf16 v[8:11], a[184:187], v[80:83], v[8:11]
    ds_read_b128 v[64:67], v1 offset:51200
    buffer_load_dwordx4 v1, s[16:19], s42 offen offset:3072 sc1 lds
    v_mfma_f32_16x16x32_bf16 v[16:19], a[184:187], v[84:87], v[16:19]
    s_add_u32 m0, s43, 114688
    v_mul_f32 v128, v112, v88
    v_fmac_f32 v128, v114, v100
    v_mfma_f32_16x16x32_bf16 v[20:23], a[188:191], v[84:87], v[20:23]
    s_add_u32 s42, s41, 16384
    ds_read_b128 v[68:71], v1 offset:52224
    v_mul_f32 v129, v112, v89
    v_mfma_f32_16x16x32_bf16 v[12:15], a[188:191], v[80:83], v[12:15]
    s_waitcnt lgkmcnt(2)
    v_fmac_f32 v129, v114, v101
    v_mul_f32 v130, v112, v90
    v_mfma_f32_16x16x32_bf16 v[8:11], a[192:195], v[56:59], v[8:11]
    ds_read_b128 v[72:75], v1 offset:53248
    buffer_load_dwordx4 v1, s[16:19], s42 offen offset:0 sc1 lds
    v_mfma_f32_16x16x32_bf16 v[16:19], a[192:195], v[60:63], v[16:19]
    v_fmac_f32 v130, v114, v102
    v_mul_f32 v131, v112, v91
    v_mfma_f32_16x16x32_bf16 v[20:23], a[196:199], v[60:63], v[20:23]
    ds_read_b128 v[76:79], v1 offset:54272
    v_fmac_f32 v131, v114, v103
    v_mfma_f32_16x16x32_bf16 v[12:15], a[196:199], v[56:59], v[12:15]
    s_waitcnt lgkmcnt(2)
    v_mul_f32 v132, v112, v92
    v_fmac_f32 v132, v114, v104
    v_mfma_f32_16x16x32_bf16 v[8:11], a[200:203], v[64:67], v[8:11]
    ds_read_b128 v[80:83], v1 offset:55296
    buffer_load_dwordx4 v1, s[16:19], s42 offen offset:1024 sc1 lds
    v_mfma_f32_16x16x32_bf16 v[16:19], a[200:203], v[68:71], v[16:19]
    v_mul_f32 v133, v112, v93
    v_fmac_f32 v133, v114, v105
    v_mfma_f32_16x16x32_bf16 v[20:23], a[204:207], v[68:71], v[20:23]
    ds_read_b128 v[84:87], v1 offset:56320
    v_mul_f32 v134, v112, v94
    v_mfma_f32_16x16x32_bf16 v[12:15], a[204:207], v[64:67], v[12:15]
    s_waitcnt lgkmcnt(2)
    v_fmac_f32 v134, v114, v106
    v_mul_f32 v135, v112, v95
    v_mfma_f32_16x16x32_bf16 v[8:11], a[208:211], v[72:75], v[8:11]
    ds_read_b128 v[56:59], v1 offset:57344
    buffer_load_dwordx4 v1, s[16:19], s42 offen offset:2048 sc1 lds
    v_mfma_f32_16x16x32_bf16 v[16:19], a[208:211], v[76:79], v[16:19]
    v_fmac_f32 v135, v114, v107
    v_mul_f32 v136, v113, v88
    v_mfma_f32_16x16x32_bf16 v[20:23], a[212:215], v[76:79], v[20:23]
    ds_read_b128 v[60:63], v1 offset:58368
    v_fmac_f32 v136, v115, v100
    v_mfma_f32_16x16x32_bf16 v[12:15], a[212:215], v[72:75], v[12:15]
    s_waitcnt lgkmcnt(2)
    v_mul_f32 v137, v113, v89
    v_fmac_f32 v137, v115, v101
    v_mfma_f32_16x16x32_bf16 v[8:11], a[216:219], v[80:83], v[8:11]
    ds_read_b128 v[64:67], v1 offset:59392
    buffer_load_dwordx4 v1, s[16:19], s42 offen offset:3072 sc1 lds
    v_mfma_f32_16x16x32_bf16 v[16:19], a[216:219], v[84:87], v[16:19]
    s_add_u32 s45, s45, 65536
    v_mul_f32 v138, v113, v90
    v_fmac_f32 v138, v115, v102
    v_mfma_f32_16x16x32_bf16 v[20:23], a[220:223], v[84:87], v[20:23]
    ds_read_b128 v[68:71], v1 offset:60416
    v_mul_f32 v139, v113, v91
    v_mfma_f32_16x16x32_bf16 v[12:15], a[220:223], v[80:83], v[12:15]
    s_waitcnt lgkmcnt(2)
    v_fmac_f32 v139, v115, v103
    v_mul_f32 v140, v113, v92
    v_mfma_f32_16x16x32_bf16 v[8:11], a[224:227], v[56:59], v[8:11]
    ds_read_b128 v[72:75], v1 offset:61440
    v_fmac_f32 v140, v115, v104
    v_mfma_f32_16x16x32_bf16 v[16:19], a[224:227], v[60:63], v[16:19]
    v_mul_f32 v141, v113, v93
    v_fmac_f32 v141, v115, v105
    v_mfma_f32_16x16x32_bf16 v[20:23], a[228:231], v[60:63], v[20:23]
    ds_read_b128 v[76:79], v1 offset:62464
    v_mul_f32 v142, v113, v94
    v_mfma_f32_16x16x32_bf16 v[12:15], a[228:231], v[56:59], v[12:15]
    s_waitcnt lgkmcnt(2)
    v_fmac_f32 v142, v115, v106
    v_mul_f32 v143, v113, v95
    v_mfma_f32_16x16x32_bf16 v[8:11], a[232:235], v[64:67], v[8:11]
    ds_read_b128 v[80:83], v1 offset:63488
    v_fmac_f32 v143, v115, v107
    v_mfma_f32_16x16x32_bf16 v[16:19], a[232:235], v[68:71], v[16:19]
    v_mfma_f32_16x16x32_bf16 v[20:23], a[236:239], v[68:71], v[20:23]
    ds_read_b128 v[84:87], v1 offset:64512
    v_mfma_f32_16x16x32_bf16 v[12:15], a[236:239], v[64:67], v[12:15]
    s_waitcnt vmcnt(4) lgkmcnt(2)
    s_barrier
    v_mfma_f32_16x16x32_bf16 v[8:11], a[240:243], v[72:75], v[8:11]
    ds_read_b128 v[56:59], v2 offset:0
    v_mfma_f32_16x16x32_bf16 v[16:19], a[240:243], v[76:79], v[16:19]
    v_mfma_f32_16x16x32_bf16 v[20:23], a[244:247], v[76:79], v[20:23]
    ds_read_b128 v[60:63], v2 offset:1024
    v_mfma_f32_16x16x32_bf16 v[12:15], a[244:247], v[72:75], v[12:15]
    s_waitcnt lgkmcnt(2)
    v_mfma_f32_16x16x32_bf16 v[8:11], a[248:251], v[80:83], v[8:11]
    ds_read_b128 v[64:67], v2 offset:2048
    v_mfma_f32_16x16x32_bf16 v[16:19], a[248:251], v[84:87], v[16:19]
    v_mfma_f32_16x16x32_bf16 v[20:23], a[252:255], v[84:87], v[20:23]
    ds_read_b128 v[68:71], v2 offset:3072
    v_mfma_f32_16x16x32_bf16 v[12:15], a[252:255], v[80:83], v[12:15]
    s_add_u32 s36, s36, 1
L_l_b1:
    s_waitcnt lgkmcnt(2)
    v_mfma_f32_16x16x32_bf16 v[32:35], a[0:3], v[56:59], 0
    s_add_u32 m0, s52, 73728
    ds_read_b128 v[72:75], v2 offset:4096
    s_add_u32 s42, s46, s52
    v_mfma_f32_16x16x32_bf16 v[40:43], a[0:3], v[60:63], 0
    buffer_load_dwordx4 v1, s[16:19], s42 offen sc1 lds
    v_mfma_f32_16x16x32_bf16 v[44:47], a[4:7], v[60:63], 0
    s_add_u32 m0, s43, 131072
    ds_read_b128 v[76:79], v2 offset:5120
    s_add_u32 s42, s41, 32768
    v_mfma_f32_16x16x32_bf16 v[36:39], a[4:7], v[56:59], 0
    s_waitcnt lgkmcnt(2)
    buffer_load_dwordx4 v1, s[16:19], s42 offen offset:0 sc1 lds
    v_mfma_f32_16x16x32_bf16 v[32:35], a[8:11], v[64:67], v[32:35]
    s_and_b32 s44, s90, 0xffffffff
    ds_read_b128 v[80:83], v2 offset:6144
    s_cmp_lt_i32 s36, 1
    v_mfma_f32_16x16x32_bf16 v[40:43], a[8:11], v[68:71], v[40:43]
    buffer_load_dwordx4 v1, s[16:19], s42 offen offset:1024 sc1 lds
    v_mfma_f32_16x16x32_bf16 v[44:47], a[12:15], v[68:71], v[44:47]
    s_cselect_b32 s44, 0x5e00000, s44
    ds_read_b128 v[84:87], v2 offset:7168
    s_add_u32 s90, s90, 262144
    v_mfma_f32_16x16x32_bf16 v[36:39], a[12:15], v[64:67], v[36:39]
    s_waitcnt lgkmcnt(2)
    buffer_load_dwordx4 v1, s[16:19], s42 offen offset:2048 sc1 lds
    v_mfma_f32_16x16x32_bf16 v[32:35], a[16:19], v[72:75], v[32:35]
    ds_read_b128 v[56:59], v2 offset:8192
    v_add_f32 v8, v8, v128
    v_mfma_f32_16x16x32_bf16 v[40:43], a[16:19], v[76:79], v[40:43]
    buffer_load_dwordx4 v1, s[16:19], s42 offen offset:3072 sc1 lds
    v_mfma_f32_16x16x32_bf16 v[44:47], a[20:23], v[76:79], v[44:47]
    s_add_u32 m0, s43, 147456
    ds_read_b128 v[60:63], v2 offset:9216
    v_add_f32 v9, v9, v129
    v_mfma_f32_16x16x32_bf16 v[36:39], a[20:23], v[72:75], v[36:39]
    s_waitcnt lgkmcnt(2)
    v_mul_f32 v120, v8, v116
    v_mul_f32 v121, v9, v116
    v_mfma_f32_16x16x32_bf16 v[32:35], a[24:27], v[80:83], v[32:35]
    s_add_u32 s42, s41, 49152
    ds_read_b128 v[64:67], v2 offset:10240
    buffer_load_dwordx4 v1, s[16:19], s42 offen offset:0 sc1 lds
    v_mfma_f32_16x16x32_bf16 v[40:43], a[24:27], v[84:87], v[40:43]
    v_mul_f32 v120, v120, abs(v8)
    v_mul_f32 v121, v121, abs(v9)
    v_mfma_f32_16x16x32_bf16 v[44:47], a[28:31], v[84:87], v[44:47]
    ds_read_b128 v[68:71], v2 offset:11264
    buffer_load_dwordx4 v1, s[16:19], s42 offen offset:1024 sc1 lds
    v_mfma_f32_16x16x32_bf16 v[36:39], a[28:31], v[80:83], v[36:39]
    s_waitcnt lgkmcnt(2)
    v_cvt_pk_bf16_f32 v8, v120, v121
    v_pk_max_i16 v8, v8, 0
    v_mfma_f32_16x16x32_bf16 v[32:35], a[32:35], v[56:59], v[32:35]
    ds_read_b128 v[72:75], v2 offset:12288
    buffer_load_dwordx4 v1, s[16:19], s42 offen offset:2048 sc1 lds
    v_mfma_f32_16x16x32_bf16 v[40:43], a[32:35], v[60:63], v[40:43]
    v_add_f32 v10, v10, v130
    v_add_f32 v11, v11, v131
    v_mfma_f32_16x16x32_bf16 v[44:47], a[36:39], v[60:63], v[44:47]
    ds_read_b128 v[76:79], v2 offset:13312
    buffer_load_dwordx4 v1, s[16:19], s42 offen offset:3072 sc1 lds
    v_mfma_f32_16x16x32_bf16 v[36:39], a[36:39], v[56:59], v[36:39]
    s_waitcnt lgkmcnt(2)
    v_mul_f32 v120, v10, v116
    v_mul_f32 v121, v11, v116
    v_mfma_f32_16x16x32_bf16 v[32:35], a[40:43], v[64:67], v[32:35]
    s_add_u32 s98, s98, 65536
    ds_read_b128 v[80:83], v2 offset:14336
    v_mul_f32 v120, v120, abs(v10)
    v_mfma_f32_16x16x32_bf16 v[40:43], a[40:43], v[68:71], v[40:43]
    s_min_i32 s98, s98, s96
    v_mul_f32 v121, v121, abs(v11)
    v_cvt_pk_bf16_f32 v9, v120, v121
    v_mfma_f32_16x16x32_bf16 v[44:47], a[44:47], v[68:71], v[44:47]
    s_and_b32 s41, s98, 0xffffffff
    ds_read_b128 v[84:87], v2 offset:15360
    v_pk_max_i16 v9, v9, 0
    v_mfma_f32_16x16x32_bf16 v[36:39], a[44:47], v[64:67], v[36:39]
    s_waitcnt vmcnt(9) lgkmcnt(2)
    s_barrier
    v_add_f32 v12, v12, v132
    v_mfma_f32_16x16x32_bf16 v[32:35], a[48:51], v[72:75], v[32:35]
    ds_read_b128 v[56:59], v2 offset:16384
    v_add_f32 v13, v13, v133
    v_mfma_f32_16x16x32_bf16 v[40:43], a[48:51], v[76:79], v[40:43]
    v_mul_f32 v120, v12, v116
    v_mul_f32 v121, v13, v116
    v_mfma_f32_16x16x32_bf16 v[44:47], a[52:55], v[76:79], v[44:47]
    ds_read_b128 v[60:63], v2 offset:17408
    v_mul_f32 v120, v120, abs(v12)
    v_mfma_f32_16x16x32_bf16 v[36:39], a[52:55], v[72:75], v[36:39]
    s_waitcnt lgkmcnt(2)
    v_mul_f32 v121, v121, abs(v13)
    v_cvt_pk_bf16_f32 v10, v120, v121
    v_mfma_f32_16x16x32_bf16 v[32:35], a[56:59], v[80:83], v[32:35]
    ds_read_b128 v[64:67], v2 offset:18432
    v_pk_max_i16 v10, v10, 0
    v_mfma_f32_16x16x32_bf16 v[40:43], a[56:59], v[84:87], v[40:43]
    v_add_f32 v14, v14, v134
    v_add_f32 v15, v15, v135
    v_mfma_f32_16x16x32_bf16 v[44:47], a[60:63], v[84:87], v[44:47]
    ds_read_b128 v[68:71], v2 offset:19456
    v_mul_f32 v120, v14, v116
    v_mfma_f32_16x16x32_bf16 v[36:39], a[60:63], v[80:83], v[36:39]
    s_waitcnt lgkmcnt(2)
    v_mul_f32 v121, v15, v116
    v_mul_f32 v120, v120, abs(v14)
    v_mfma_f32_16x16x32_bf16 v[32:35], a[64:67], v[56:59], v[32:35]
    ds_read_b128 v[72:75], v2 offset:20480
    v_mul_f32 v121, v121, abs(v15)
    v_mfma_f32_16x16x32_bf16 v[40:43], a[64:67], v[60:63], v[40:43]
    v_cvt_pk_bf16_f32 v11, v120, v121
    v_pk_max_i16 v11, v11, 0
    v_mfma_f32_16x16x32_bf16 v[44:47], a[68:71], v[60:63], v[44:47]
    ds_read_b128 v[76:79], v2 offset:21504
    buffer_store_dwordx4 v[8:11], v1, s[16:19], s44 offen offset:0 sc1
    v_mfma_f32_16x16x32_bf16 v[36:39], a[68:71], v[56:59], v[36:39]
    s_waitcnt lgkmcnt(2)
    v_add_f32 v16, v16, v136
    v_add_f32 v17, v17, v137
    v_mfma_f32_16x16x32_bf16 v[32:35], a[72:75], v[64:67], v[32:35]
    ds_read_b128 v[80:83], v2 offset:22528
    v_mul_f32 v120, v16, v117
    v_mfma_f32_16x16x32_bf16 v[40:43], a[72:75], v[68:71], v[40:43]
    v_mul_f32 v121, v17, v117
    v_mul_f32 v120, v120, abs(v16)
    v_mfma_f32_16x16x32_bf16 v[44:47], a[76:79], v[68:71], v[44:47]
    ds_read_b128 v[84:87], v2 offset:23552
    v_mul_f32 v121, v121, abs(v17)
    v_mfma_f32_16x16x32_bf16 v[36:39], a[76:79], v[64:67], v[36:39]
    s_waitcnt lgkmcnt(2)
    v_cvt_pk_bf16_f32 v16, v120, v121
    v_pk_max_i16 v16, v16, 0
    v_mfma_f32_16x16x32_bf16 v[32:35], a[80:83], v[72:75], v[32:35]
    ds_read_b128 v[56:59], v2 offset:24576
    v_add_f32 v18, v18, v138
    v_mfma_f32_16x16x32_bf16 v[40:43], a[80:83], v[76:79], v[40:43]
    v_add_f32 v19, v19, v139
    v_mul_f32 v120, v18, v117
    v_mfma_f32_16x16x32_bf16 v[44:47], a[84:87], v[76:79], v[44:47]
    ds_read_b128 v[60:63], v2 offset:25600
    v_mul_f32 v121, v19, v117
    v_mfma_f32_16x16x32_bf16 v[36:39], a[84:87], v[72:75], v[36:39]
    s_waitcnt lgkmcnt(2)
    v_mul_f32 v120, v120, abs(v18)
    v_mul_f32 v121, v121, abs(v19)
    v_mfma_f32_16x16x32_bf16 v[32:35], a[88:91], v[80:83], v[32:35]
    ds_read_b128 v[64:67], v2 offset:26624
    v_cvt_pk_bf16_f32 v17, v120, v121
    v_mfma_f32_16x16x32_bf16 v[40:43], a[88:91], v[84:87], v[40:43]
    v_pk_max_i16 v17, v17, 0
    v_add_f32 v20, v20, v140
    v_mfma_f32_16x16x32_bf16 v[44:47], a[92:95], v[84:87], v[44:47]
    ds_read_b128 v[68:71], v2 offset:27648
    v_add_f32 v21, v21, v141
    v_mfma_f32_16x16x32_bf16 v[36:39], a[92:95], v[80:83], v[36:39]
    s_waitcnt lgkmcnt(2)
    v_mul_f32 v120, v20, v117
    v_mul_f32 v121, v21, v117
    v_mfma_f32_16x16x32_bf16 v[32:35], a[96:99], v[56:59], v[32:35]
    ds_read_b128 v[72:75], v2 offset:28672
    v_mul_f32 v120, v120, abs(v20)
    v_mfma_f32_16x16x32_bf16 v[40:43], a[96:99], v[60:63], v[40:43]
    v_mul_f32 v121, v121, abs(v21)
    v_cvt_pk_bf16_f32 v18, v120, v121
    v_mfma_f32_16x16x32_bf16 v[44:47], a[100:103], v[60:63], v[44:47]
    ds_read_b128 v[76:79], v2 offset:29696
    buffer_load_dword v7, v5, s[16:19], s45 offen sc1
    v_mfma_f32_16x16x32_bf16 v[36:39], a[100:103], v[56:59], v[36:39]
    s_waitcnt lgkmcnt(2)
    v_pk_max_i16 v18, v18, 0
    v_add_f32 v22, v22, v142
    v_mfma_f32_16x16x32_bf16 v[32:35], a[104:107], v[64:67], v[32:35]
    ds_read_b128 v[80:83], v2 offset:30720
    v_add_f32 v23, v23, v143
    v_mfma_f32_16x16x32_bf16 v[40:43], a[104:107], v[68:71], v[40:43]
    v_mul_f32 v120, v22, v117
    v_mul_f32 v121, v23, v117
    v_mfma_f32_16x16x32_bf16 v[44:47], a[108:111], v[68:71], v[44:47]
    ds_read_b128 v[84:87], v2 offset:31744
    v_mul_f32 v120, v120, abs(v22)
    v_mfma_f32_16x16x32_bf16 v[36:39], a[108:111], v[64:67], v[36:39]
    s_waitcnt vmcnt(6) lgkmcnt(2)
    s_barrier
    v_mul_f32 v121, v121, abs(v23)
    v_mfma_f32_16x16x32_bf16 v[32:35], a[112:115], v[72:75], v[32:35]
    ds_read_b128 v[56:59], v2 offset:32768
    v_cvt_pk_bf16_f32 v19, v120, v121
    v_mfma_f32_16x16x32_bf16 v[40:43], a[112:115], v[76:79], v[40:43]
    v_pk_max_i16 v19, v19, 0
    buffer_store_dwordx4 v[16:19], v1, s[16:19], s44 offen offset:1024 sc1
    v_mfma_f32_16x16x32_bf16 v[44:47], a[116:119], v[76:79], v[44:47]
    s_add_u32 m0, s43, 0
    ds_read_b128 v[60:63], v2 offset:33792
    ds_read_b64 v[144:145], v118 offset:0
    v_mfma_f32_16x16x32_bf16 v[36:39], a[116:119], v[72:75], v[36:39]
    s_waitcnt lgkmcnt(3)
    ds_read_b64 v[146:147], v118 offset:128
    ds_read_b64 v[148:149], v118 offset:256
    v_mfma_f32_16x16x32_bf16 v[32:35], a[120:123], v[80:83], v[32:35]
    s_add_u32 s42, s41, 0
    ds_read_b128 v[64:67], v2 offset:34816
    ds_read_b64 v[150:151], v118 offset:384
    v_mfma_f32_16x16x32_bf16 v[40:43], a[120:123], v[84:87], v[40:43]
    v_mfma_f32_16x16x32_bf16 v[44:47], a[124:127], v[84:87], v[44:47]
    ds_read_b128 v[68:71], v2 offset:35840
    v_mfma_f32_16x16x32_bf16 v[36:39], a[124:127], v[80:83], v[36:39]
    s_waitcnt lgkmcnt(6)
    v_mfma_f32_16x16x32_bf16 v[32:35], a[128:131], v[56:59], v[32:35]
    ds_read_b128 v[72:75], v2 offset:36864
    v_mfma_f32_16x16x32_bf16 v[40:43], a[128:131], v[60:63], v[40:43]
    s_waitcnt lgkmcnt(2)
    v_max3_u32 v152, v144, v145, v146
    v_max3_u32 v153, v147, v148, v149
    v_mfma_f32_16x16x32_bf16 v[44:47], a[132:135], v[60:63], v[44:47]
    ds_read_b128 v[76:79], v2 offset:37888
    v_max3_u32 v152, v152, v150, v151
    v_mfma_f32_16x16x32_bf16 v[36:39], a[132:135], v[56:59], v[36:39]
    s_waitcnt lgkmcnt(2)
    v_max_u32 v152, v152, v153
    v_cmp_eq_u32 vcc, -1, v152
    v_mfma_f32_16x16x32_bf16 v[32:35], a[136:139], v[64:67], v[32:35]
    ds_read_b128 v[80:83], v2 offset:38912
    v_mfma_f32_16x16x32_bf16 v[40:43], a[136:139], v[68:71], v[40:43]
    s_cbranch_vccnz L_sspin43
L_sback44:
    v_add_f32 v152, v148, v150
    v_add_f32 v153, v149, v151
    v_mfma_f32_16x16x32_bf16 v[44:47], a[140:143], v[68:71], v[44:47]
    ds_read_b128 v[84:87], v2 offset:39936
    v_add_f32 v144, v144, v146
    v_mfma_f32_16x16x32_bf16 v[36:39], a[140:143], v[64:67], v[36:39]
    s_waitcnt lgkmcnt(2)
    v_add_f32 v145, v145, v147
    v_add_f32 v144, v144, v152
    v_mfma_f32_16x16x32_bf16 v[32:35], a[144:147], v[72:75], v[32:35]
    ds_read_b128 v[56:59], v2 offset:40960
    v_add_f32 v145, v145, v153
    v_mfma_f32_16x16x32_bf16 v[40:43], a[144:147], v[76:79], v[40:43]
    v_mov_b32 v152, v144
    v_mov_b32 v153, v145
    v_mfma_f32_16x16x32_bf16 v[44:47], a[148:151], v[76:79], v[44:47]
    ds_read_b128 v[60:63], v2 offset:41984
    v_permlane32_swap_b32 v144, v152
    v_mfma_f32_16x16x32_bf16 v[36:39], a[148:151], v[72:75], v[36:39]
    s_waitcnt lgkmcnt(2)
    v_permlane32_swap_b32 v145, v153
    v_mfma_f32_16x16x32_bf16 v[32:35], a[152:155], v[80:83], v[32:35]
    ds_read_b128 v[64:67], v2 offset:43008
    v_add_f32 v144, v144, v152
    v_mfma_f32_16x16x32_bf16 v[40:43], a[152:155], v[84:87], v[40:43]
    v_add_f32 v145, v145, v153
    v_mul_f32 v112, 0xba800000, v144
    v_mfma_f32_16x16x32_bf16 v[44:47], a[156:159], v[84:87], v[44:47]
    ds_read_b128 v[68:71], v2 offset:44032
    v_mul_f32 v145, 0x3a800000, v145
    v_mfma_f32_16x16x32_bf16 v[36:39], a[156:159], v[80:83], v[36:39]
    s_waitcnt lgkmcnt(2)
    v_fma_f32 v145, -v112, v112, v145
    v_mov_b32 v113, v112
    v_mfma_f32_16x16x32_bf16 v[32:35], a[160:163], v[56:59], v[32:35]
    ds_read_b128 v[72:75], v2 offset:45056
    v_max_f32 v145, 0, v145
    v_mfma_f32_16x16x32_bf16 v[40:43], a[160:163], v[60:63], v[40:43]
    v_add_f32 v145, 0x3727c5ac, v145
    v_rsq_f32 v116, v145
    v_mfma_f32_16x16x32_bf16 v[44:47], a[164:167], v[60:63], v[44:47]
    ds_read_b128 v[76:79], v2 offset:46080
    v_permlane16_swap_b32 v112, v113
    v_mfma_f32_16x16x32_bf16 v[36:39], a[164:167], v[56:59], v[36:39]
    s_waitcnt lgkmcnt(2)
    v_mul_f32 v114, v145, v116
    v_mul_f32 v116, v116, v116
    v_mfma_f32_16x16x32_bf16 v[32:35], a[168:171], v[64:67], v[32:35]
    s_waitcnt vmcnt(0)
    ds_read_b128 v[80:83], v2 offset:47104
    v_mov_b32 v115, v114
    v_mfma_f32_16x16x32_bf16 v[40:43], a[168:171], v[68:71], v[40:43]
    s_barrier
    buffer_store_dword v124, v124, s[16:19], s91 offen sc1
    v_mfma_f32_16x16x32_bf16 v[44:47], a[172:175], v[68:71], v[44:47]
    s_add_u32 s91, s91, 65536
    ds_read_b128 v[84:87], v2 offset:48128
    v_cmp_ne_u32 vcc, 0, v7
    v_mfma_f32_16x16x32_bf16 v[36:39], a[172:175], v[64:67], v[36:39]
    s_waitcnt lgkmcnt(2)
    v_mov_b32 v117, v116
    v_permlane16_swap_b32 v114, v115
    v_mfma_f32_16x16x32_bf16 v[32:35], a[176:179], v[72:75], v[32:35]
    s_cbranch_vccnz L_spin41
L_back42:
    ds_read_b128 v[56:59], v2 offset:49152
    v_permlane16_swap_b32 v116, v117
    v_mfma_f32_16x16x32_bf16 v[40:43], a[176:179], v[76:79], v[40:43]
    s_barrier
    buffer_load_dwordx4 v1, s[16:19], s42 offen offset:0 sc1 lds
    v_mfma_f32_16x16x32_bf16 v[44:47], a[180:183], v[76:79], v[44:47]
    s_add_u32 s46, s46, 2048
    ds_read_b128 v[60:63], v2 offset:50176
    buffer_load_dwordx4 v1, s[16:19], s42 offen offset:1024 sc1 lds
    v_mfma_f32_16x16x32_bf16 v[36:39], a[180:183], v[72:75], v[36:39]
    s_waitcnt lgkmcnt(2)
    buffer_load_dwordx4 v1, s[16:19], s42 offen offset:2048 sc1 lds
    v_mfma_f32_16x16x32_bf16 v[32:35], a[184:187], v[80:83], v[32:35]
    ds_read_b128 v[64:67], v2 offset:51200
    buffer_load_dwordx4 v1, s[16:19], s42 offen offset:3072 sc1 lds
    v_mfma_f32_16x16x32_bf16 v[40:43], a[184:187], v[84:87], v[40:43]
    s_add_u32 m0, s43, 16384
    v_mul_f32 v128, v112, v88
    v_fmac_f32 v128, v114, v100
    v_mfma_f32_16x16x32_bf16 v[44:47], a[188:191], v[84:87], v[44:47]
    s_add_u32 s42, s41, 16384
    ds_read_b128 v[68:71], v2 offset:52224
    v_mul_f32 v129, v112, v89
    v_mfma_f32_16x16x32_bf16 v[36:39], a[188:191], v[80:83], v[36:39]
    s_waitcnt lgkmcnt(2)
    v_fmac_f32 v129, v114, v101
    v_mul_f32 v130, v112, v90
    v_mfma_f32_16x16x32_bf16 v[32:35], a[192:195], v[56:59], v[32:35]
    ds_read_b128 v[72:75], v2 offset:53248
    buffer_load_dwordx4 v1, s[16:19], s42 offen offset:0 sc1 lds
    v_mfma_f32_16x16x32_bf16 v[40:43], a[192:195], v[60:63], v[40:43]
    v_fmac_f32 v130, v114, v102
    v_mul_f32 v131, v112, v91
    v_mfma_f32_16x16x32_bf16 v[44:47], a[196:199], v[60:63], v[44:47]
    ds_read_b128 v[76:79], v2 offset:54272
    v_fmac_f32 v131, v114, v103
    v_mfma_f32_16x16x32_bf16 v[36:39], a[196:199], v[56:59], v[36:39]
    s_waitcnt lgkmcnt(2)
    v_mul_f32 v132, v112, v92
    v_fmac_f32 v132, v114, v104
    v_mfma_f32_16x16x32_bf16 v[32:35], a[200:203], v[64:67], v[32:35]
    ds_read_b128 v[80:83], v2 offset:55296
    buffer_load_dwordx4 v1, s[16:19], s42 offen offset:1024 sc1 lds
    v_mfma_f32_16x16x32_bf16 v[40:43], a[200:203], v[68:71], v[40:43]
    v_mul_f32 v133, v112, v93
    v_fmac_f32 v133, v114, v105
    v_mfma_f32_16x16x32_bf16 v[44:47], a[204:207], v[68:71], v[44:47]
    ds_read_b128 v[84:87], v2 offset:56320
    v_mul_f32 v134, v112, v94
    v_mfma_f32_16x16x32_bf16 v[36:39], a[204:207], v[64:67], v[36:39]
    s_waitcnt lgkmcnt(2)
    v_fmac_f32 v134, v114, v106
    v_mul_f32 v135, v112, v95
    v_mfma_f32_16x16x32_bf16 v[32:35], a[208:211], v[72:75], v[32:35]
    ds_read_b128 v[56:59], v2 offset:57344
    buffer_load_dwordx4 v1, s[16:19], s42 offen offset:2048 sc1 lds
    v_mfma_f32_16x16x32_bf16 v[40:43], a[208:211], v[76:79], v[40:43]
    v_fmac_f32 v135, v114, v107
    v_mul_f32 v136, v113, v88
    v_mfma_f32_16x16x32_bf16 v[44:47], a[212:215], v[76:79], v[44:47]
    ds_read_b128 v[60:63], v2 offset:58368
    v_fmac_f32 v136, v115, v100
    v_mfma_f32_16x16x32_bf16 v[36:39], a[212:215], v[72:75], v[36:39]
    s_waitcnt lgkmcnt(2)
    v_mul_f32 v137, v113, v89
    v_fmac_f32 v137, v115, v101
    v_mfma_f32_16x16x32_bf16 v[32:35], a[216:219], v[80:83], v[32:35]
    ds_read_b128 v[64:67], v2 offset:59392
    buffer_load_dwordx4 v1, s[16:19], s42 offen offset:3072 sc1 lds
    v_mfma_f32_16x16x32_bf16 v[40:43], a[216:219], v[84:87], v[40:43]
    s_add_u32 s45, s45, 65536
    v_mul_f32 v138, v113, v90
    v_fmac_f32 v138, v115, v102
    v_mfma_f32_16x16x32_bf16 v[44:47], a[220:223], v[84:87], v[44:47]
    ds_read_b128 v[68:71], v2 offset:60416
    v_mul_f32 v139, v113, v91
    v_mfma_f32_16x16x32_bf16 v[36:39], a[220:223], v[80:83], v[36:39]
    s_waitcnt lgkmcnt(2)
    v_fmac_f32 v139, v115, v103
    v_mul_f32 v140, v113, v92
    v_mfma_f32_16x16x32_bf16 v[32:35], a[224:227], v[56:59], v[32:35]
    ds_read_b128 v[72:75], v2 offset:61440
    v_fmac_f32 v140, v115, v104
    v_mfma_f32_16x16x32_bf16 v[40:43], a[224:227], v[60:63], v[40:43]
    v_mul_f32 v141, v113, v93
    v_fmac_f32 v141, v115, v105
    v_mfma_f32_16x16x32_bf16 v[44:47], a[228:231], v[60:63], v[44:47]
    ds_read_b128 v[76:79], v2 offset:62464
    v_mul_f32 v142, v113, v94
    v_mfma_f32_16x16x32_bf16 v[36:39], a[228:231], v[56:59], v[36:39]
    s_waitcnt lgkmcnt(2)
    v_fmac_f32 v142, v115, v106
    v_mul_f32 v143, v113, v95
    v_mfma_f32_16x16x32_bf16 v[32:35], a[232:235], v[64:67], v[32:35]
    ds_read_b128 v[80:83], v2 offset:63488
    v_fmac_f32 v143, v115, v107
    v_mfma_f32_16x16x32_bf16 v[40:43], a[232:235], v[68:71], v[40:43]
    v_mfma_f32_16x16x32_bf16 v[44:47], a[236:239], v[68:71], v[44:47]
    ds_read_b128 v[84:87], v2 offset:64512
    v_mfma_f32_16x16x32_bf16 v[36:39], a[236:239], v[64:67], v[36:39]
    s_waitcnt vmcnt(4) lgkmcnt(2)
    s_barrier
    v_mfma_f32_16x16x32_bf16 v[32:35], a[240:243], v[72:75], v[32:35]
    ds_read_b128 v[56:59], v1 offset:0
    v_mfma_f32_16x16x32_bf16 v[40:43], a[240:243], v[76:79], v[40:43]
    v_mfma_f32_16x16x32_bf16 v[44:47], a[244:247], v[76:79], v[44:47]
    ds_read_b128 v[60:63], v1 offset:1024
    v_mfma_f32_16x16x32_bf16 v[36:39], a[244:247], v[72:75], v[36:39]
    s_waitcnt lgkmcnt(2)
    v_mfma_f32_16x16x32_bf16 v[32:35], a[248:251], v[80:83], v[32:35]
    ds_read_b128 v[64:67], v1 offset:2048
    v_mfma_f32_16x16x32_bf16 v[40:43], a[248:251], v[84:87], v[40:43]
    v_mfma_f32_16x16x32_bf16 v[44:47], a[252:255], v[84:87], v[44:47]
    ds_read_b128 v[68:71], v1 offset:3072
    v_mfma_f32_16x16x32_bf16 v[36:39], a[252:255], v[80:83], v[36:39]
    s_add_u32 s36, s36, 1
    s_cmp_lt_u32 s36, 32
    s_cbranch_scc1 L_l_b0
    s_nop 7
    s_and_b32 s44, s90, 0xffffffff
    s_cmp_lt_i32 s36, 1
    s_cselect_b32 s44, 0x5e00000, s44
    s_add_u32 s90, s90, 262144
    v_add_f32 v32, v32, v128
    v_add_f32 v33, v33, v129
    v_mul_f32 v120, v32, v116
    v_mul_f32 v121, v33, v116
    v_mul_f32 v120, v120, abs(v32)
    v_mul_f32 v121, v121, abs(v33)
    v_cvt_pk_bf16_f32 v32, v120, v121
    v_pk_max_i16 v32, v32, 0
    v_add_f32 v34, v34, v130
    v_add_f32 v35, v35, v131
    v_mul_f32 v120, v34, v116
    v_mul_f32 v121, v35, v116
    v_mul_f32 v120, v120, abs(v34)
    v_mul_f32 v121, v121, abs(v35)
    v_cvt_pk_bf16_f32 v33, v120, v121
    v_pk_max_i16 v33, v33, 0
    v_add_f32 v36, v36, v132
    v_add_f32 v37, v37, v133
    v_mul_f32 v120, v36, v116
    v_mul_f32 v121, v37, v116
    v_mul_f32 v120, v120, abs(v36)
    v_mul_f32 v121, v121, abs(v37)
    v_cvt_pk_bf16_f32 v34, v120, v121
    v_pk_max_i16 v34, v34, 0
    v_add_f32 v38, v38, v134
    v_add_f32 v39, v39, v135
    v_mul_f32 v120, v38, v116
    v_mul_f32 v121, v39, v116
    v_mul_f32 v120, v120, abs(v38)
    v_mul_f32 v121, v121, abs(v39)
    v_cvt_pk_bf16_f32 v35, v120, v121
    v_pk_max_i16 v35, v35, 0
    buffer_store_dwordx4 v[32:35], v1, s[16:19], s44 offen offset:0 sc1
    v_add_f32 v40, v40, v136
    v_add_f32 v41, v41, v137
    v_mul_f32 v120, v40, v117
    v_mul_f32 v121, v41, v117
    v_mul_f32 v120, v120, abs(v40)
    v_mul_f32 v121, v121, abs(v41)
    v_cvt_pk_bf16_f32 v40, v120, v121
    v_pk_max_i16 v40, v40, 0
    v_add_f32 v42, v42, v138
    v_add_f32 v43, v43, v139
    v_mul_f32 v120, v42, v117
    v_mul_f32 v121, v43, v117
    v_mul_f32 v120, v120, abs(v42)
    v_mul_f32 v121, v121, abs(v43)
    v_cvt_pk_bf16_f32 v41, v120, v121
    v_pk_max_i16 v41, v41, 0
    v_add_f32 v44, v44, v140
    v_add_f32 v45, v45, v141
    v_mul_f32 v120, v44, v117
    v_mul_f32 v121, v45, v117
    v_mul_f32 v120, v120, abs(v44)
    v_mul_f32 v121, v121, abs(v45)
    v_cvt_pk_bf16_f32 v42, v120, v121
    v_pk_max_i16 v42, v42, 0
    v_add_f32 v46, v46, v142
    v_add_f32 v47, v47, v143
    v_mul_f32 v120, v46, v117
    v_mul_f32 v121, v47, v117
    v_mul_f32 v120, v120, abs(v46)
    v_mul_f32 v121, v121, abs(v47)
    v_cvt_pk_bf16_f32 v43, v120, v121
    v_pk_max_i16 v43, v43, 0
    buffer_store_dwordx4 v[40:43], v1, s[16:19], s44 offen offset:1024 sc1
    s_waitcnt vmcnt(0)
    s_barrier
    buffer_store_dword v124, v124, s[16:19], s91 offen sc1
    s_add_u32 s91, s91, 65536
    s_waitcnt vmcnt(0)
    s_endpgm
L_spin33:
    s_mov_b32 s40, 0x20000
L_spin33_l:
    buffer_load_dword v56, v124, s[20:23], 0 offen sc1
    s_sub_u32 s40, s40, 1
    s_waitcnt vmcnt(0)
    v_cmp_eq_u32 vcc, v124, v56
    s_cbranch_scc1 L_back34
    s_cbranch_vccz L_back34
    s_sleep 8
    s_branch L_spin33_l
L_spin35:
    s_mov_b32 s40, 0x20000
L_spin35_l:
    buffer_load_dword v7, v5, s[16:19], s45 offen sc1
    s_sub_u32 s40, s40, 1
    s_waitcnt vmcnt(0)
    v_cmp_ne_u32 vcc, 0, v7
    s_cbranch_scc1 L_back36
    s_cbranch_vccz L_back36
    s_sleep 2
    s_branch L_spin35_l
L_spin37:
    s_mov_b32 s40, 0x20000
L_spin37_l:
    buffer_load_dword v7, v5, s[16:19], s45 offen sc1
    s_sub_u32 s40, s40, 1
    s_waitcnt vmcnt(0)
    v_cmp_ne_u32 vcc, 0, v7
    s_cbranch_scc1 L_back38
    s_cbranch_vccz L_back38
    s_sleep 2
    s_branch L_spin37_l
L_sspin39:
    s_mov_b32 s40, 0x20000
L_sspin39_l:
    buffer_load_dwordx2 v[144:145], v6, s[16:19], s46 offen offset:0 sc1
    buffer_load_dwordx2 v[146:147], v6, s[16:19], s46 offen offset:128 sc1
    buffer_load_dwordx2 v[148:149], v6, s[16:19], s46 offen offset:256 sc1
    buffer_load_dwordx2 v[150:151], v6, s[16:19], s46 offen offset:384 sc1
    s_sub_u32 s40, s40, 1
    s_waitcnt vmcnt(0)
    v_max3_u32 v152, v144, v145, v146
    v_max3_u32 v153, v147, v148, v149
    v_max3_u32 v152, v152, v150, v151
    v_max_u32 v152, v152, v153
    v_cmp_eq_u32 vcc, -1, v152
    s_cbranch_scc1 L_sback40
    s_cbranch_vccz L_sback40
    s_sleep 4
    s_branch L_sspin39_l
L_spin41:
    s_mov_b32 s40, 0x20000
L_spin41_l:
    buffer_load_dword v7, v5, s[16:19], s45 offen sc1
    s_sub_u32 s40, s40, 1
    s_waitcnt vmcnt(0)
    v_cmp_ne_u32 vcc, 0, v7
    s_cbranch_scc1 L_back42
    s_cbranch_vccz L_back42
    s_sleep 2
    s_branch L_spin41_l
L_sspin43:
    s_mov_b32 s40, 0x20000
L_sspin43_l:
    buffer_load_dwordx2 v[144:145], v6, s[16:19], s46 offen offset:0 sc1
    buffer_load_dwordx2 v[146:147], v6, s[16:19], s46 offen offset:128 sc1
    buffer_load_dwordx2 v[148:149], v6, s[16:19], s46 offen offset:256 sc1
    buffer_load_dwordx2 v[150:151], v6, s[16:19], s46 offen offset:384 sc1
    s_sub_u32 s40, s40, 1
    s_waitcnt vmcnt(0)
    v_max3_u32 v152, v144, v145, v146
    v_max3_u32 v153, v147, v148, v149
    v_max3_u32 v152, v152, v150, v151
    v_max_u32 v152, v152, v153
    v_cmp_eq_u32 vcc, -1, v152
    s_cbranch_scc1 L_sback44
    s_cbranch_vccz L_sback44
    s_sleep 4
    s_branch L_sspin43_l
L_role_44:
    s_sub_u32 s35, s34, 44
    s_cmp_ge_u32 s35, 12
    s_cbranch_scc1 L_bf_nost
    s_lshl_b32 s50, s33, 4
    s_add_u32 s50, s50, s35
    s_lshl_b32 s50, s50, 1
    s_lshl_b32 s46, s50, 15
    s_lshl_b32 s37, s32, 9
    s_add_u32 s46, s46, s37
    v_lshrrev_b32 v48, 3, v0
    v_and_b32 v49, 0x70, v1
    v_lshl_add_u32 v48, v48, 11, v49
    v_add_u32 v49, 16384, v48
    s_mov_b32 s8, s64
    s_mov_b32 s9, s65
    s_mov_b32 s10, 0x400000
    s_mov_b32 s11, 0x00020000
    buffer_load_dwordx4 v[16:19], v48, s[8:11], s46 offen offset:0
    buffer_load_dwordx4 v[20:23], v48, s[8:11], s46 offen offset:128
    buffer_load_dwordx4 v[24:27], v48, s[8:11], s46 offen offset:256
    buffer_load_dwordx4 v[28:31], v48, s[8:11], s46 offen offset:384
    buffer_load_dwordx4 v[32:35], v49, s[8:11], s46 offen offset:0
    buffer_load_dwordx4 v[36:39], v49, s[8:11], s46 offen offset:128
    buffer_load_dwordx4 v[40:43], v49, s[8:11], s46 offen offset:256
    buffer_load_dwordx4 v[44:47], v49, s[8:11], s46 offen offset:384
    s_xor_b32 s50, s50, 1
    s_lshl_b32 s46, s50, 15
    s_lshl_b32 s37, s32, 9
    s_add_u32 s46, s46, s37
    v_lshrrev_b32 v96, 3, v0
    v_and_b32 v97, 0x70, v1
    v_lshl_add_u32 v96, v96, 11, v97
    v_add_u32 v97, 16384, v96
    s_mov_b32 s8, s64
    s_mov_b32 s9, s65
    s_mov_b32 s10, 0x400000
    s_mov_b32 s11, 0x00020000
    buffer_load_dwordx4 v[64:67], v96, s[8:11], s46 offen offset:0
    buffer_load_dwordx4 v[68:71], v96, s[8:11], s46 offen offset:128
    buffer_load_dwordx4 v[72:75], v96, s[8:11], s46 offen offset:256
    buffer_load_dwordx4 v[76:79], v96, s[8:11], s46 offen offset:384
    buffer_load_dwordx4 v[80:83], v97, s[8:11], s46 offen offset:0
    buffer_load_dwordx4 v[84:87], v97, s[8:11], s46 offen offset:128
    buffer_load_dwordx4 v[88:91], v97, s[8:11], s46 offen offset:256
    buffer_load_dwordx4 v[92:95], v97, s[8:11], s46 offen offset:384
    s_xor_b32 s50, s50, 1
    s_mov_b32 s86, 0x3f803f80
    v_and_b32 v56, 1, v0
    v_lshlrev_b32 v56, 7, v56
    v_bfe_u32 v57, v0, 1, 1
    v_lshl_add_u32 v56, v57, 6, v56
    v_and_b32 v57, 0x38, v0
    v_add_u32 v56, v57, v56
    s_sub_u32 s46, 127, s50
    s_lshl_b32 s46, s46, 10
    s_lshl_b32 s37, s32, 8
    s_add_u32 s46, s46, s37
    s_add_u32 s46, s46, 0x5400000
    s_waitcnt vmcnt(8)
    v_dot2_f32_bf16 v48, v16, s86, 0
    v_dot2_f32_bf16 v49, v16, v16, 0
    v_dot2_f32_bf16 v50, v24, s86, 0
    v_dot2_f32_bf16 v51, v24, v24, 0
    v_dot2_f32_bf16 v52, v32, s86, 0
    v_dot2_f32_bf16 v53, v32, v32, 0
    v_dot2_f32_bf16 v54, v40, s86, 0
    v_dot2_f32_bf16 v55, v40, v40, 0
    v_dot2_f32_bf16 v48, v17, s86, v48
    v_dot2_f32_bf16 v49, v17, v17, v49
    v_dot2_f32_bf16 v50, v25, s86, v50
    v_dot2_f32_bf16 v51, v25, v25, v51
    v_dot2_f32_bf16 v52, v33, s86, v52
    v_dot2_f32_bf16 v53, v33, v33, v53
    v_dot2_f32_bf16 v54, v41, s86, v54
    v_dot2_f32_bf16 v55, v41, v41, v55
    v_dot2_f32_bf16 v48, v18, s86, v48
    v_dot2_f32_bf16 v49, v18, v18, v49
    v_dot2_f32_bf16 v50, v26, s86, v50
    v_dot2_f32_bf16 v51, v26, v26, v51
    v_dot2_f32_bf16 v52, v34, s86, v52
    v_dot2_f32_bf16 v53, v34, v34, v53
    v_dot2_f32_bf16 v54, v42, s86, v54
    v_dot2_f32_bf16 v55, v42, v42, v55
    v_dot2_f32_bf16 v48, v19, s86, v48
    v_dot2_f32_bf16 v49, v19, v19, v49
    v_dot2_f32_bf16 v50, v27, s86, v50
    v_dot2_f32_bf16 v51, v27, v27, v51
    v_dot2_f32_bf16 v52, v35, s86, v52
    v_dot2_f32_bf16 v53, v35, v35, v53
    v_dot2_f32_bf16 v54, v43, s86, v54
    v_dot2_f32_bf16 v55, v43, v43, v55
    v_dot2_f32_bf16 v48, v20, s86, v48
    v_dot2_f32_bf16 v49, v20, v20, v49
    v_dot2_f32_bf16 v50, v28, s86, v50
    v_dot2_f32_bf16 v51, v28, v28, v51
    v_dot2_f32_bf16 v52, v36, s86, v52
    v_dot2_f32_bf16 v53, v36, v36, v53
    v_dot2_f32_bf16 v54, v44, s86, v54
    v_dot2_f32_bf16 v55, v44, v44, v55
    v_dot2_f32_bf16 v48, v21, s86, v48
    v_dot2_f32_bf16 v49, v21, v21, v49
    v_dot2_f32_bf16 v50, v29, s86, v50
    v_dot2_f32_bf16 v51, v29, v29, v51
    v_dot2_f32_bf16 v52, v37, s86, v52
    v_dot2_f32_bf16 v53, v37, v37, v53
    v_dot2_f32_bf16 v54, v45, s86, v54
    v_dot2_f32_bf16 v55, v45, v45, v55
    v_dot2_f32_bf16 v48, v22, s86, v48
    v_dot2_f32_bf16 v49, v22, v22, v49
    v_dot2_f32_bf16 v50, v30, s86, v50
    v_dot2_f32_bf16 v51, v30, v30, v51
    v_dot2_f32_bf16 v52, v38, s86, v52
    v_dot2_f32_bf16 v53, v38, v38, v53
    v_dot2_f32_bf16 v54, v46, s86, v54
    v_dot2_f32_bf16 v55, v46, v46, v55
    v_dot2_f32_bf16 v48, v23, s86, v48
    v_dot2_f32_bf16 v49, v23, v23, v49
    v_dot2_f32_bf16 v50, v31, s86, v50
    v_dot2_f32_bf16 v51, v31, v31, v51
    v_dot2_f32_bf16 v52, v39, s86, v52
    v_dot2_f32_bf16 v53, v39, v39, v53
    v_dot2_f32_bf16 v54, v47, s86, v54
    v_dot2_f32_bf16 v55, v47, v47, v55
    v_add_f32_dpp v48, v48, v48 quad_perm:[1,0,3,2] row_mask:0xf bank_mask:0xf
    v_add_f32_dpp v49, v49, v49 quad_perm:[1,0,3,2] row_mask:0xf bank_mask:0xf
    v_add_f32_dpp v50, v50, v50 quad_perm:[1,0,3,2] row_mask:0xf bank_mask:0xf
    v_add_f32_dpp v51, v51, v51 quad_perm:[1,0,3,2] row_mask:0xf bank_mask:0xf
    v_add_f32_dpp v52, v52, v52 quad_perm:[1,0,3,2] row_mask:0xf bank_mask:0xf
    v_add_f32_dpp v53, v53, v53 quad_perm:[1,0,3,2] row_mask:0xf bank_mask:0xf
    v_add_f32_dpp v54, v54, v54 quad_perm:[1,0,3,2] row_mask:0xf bank_mask:0xf
    v_add_f32_dpp v55, v55, v55 quad_perm:[1,0,3,2] row_mask:0xf bank_mask:0xf
    v_add_f32_dpp v48, v48, v48 quad_perm:[2,3,0,1] row_mask:0xf bank_mask:0xf
    v_add_f32_dpp v49, v49, v49 quad_perm:[2,3,0,1] row_mask:0xf bank_mask:0xf
    v_add_f32_dpp v50, v50, v50 quad_perm:[2,3,0,1] row_mask:0xf bank_mask:0xf
    v_add_f32_dpp v51, v51, v51 quad_perm:[2,3,0,1] row_mask:0xf bank_mask:0xf
    v_add_f32_dpp v52, v52, v52 quad_perm:[2,3,0,1] row_mask:0xf bank_mask:0xf
    v_add_f32_dpp v53, v53, v53 quad_perm:[2,3,0,1] row_mask:0xf bank_mask:0xf
    v_add_f32_dpp v54, v54, v54 quad_perm:[2,3,0,1] row_mask:0xf bank_mask:0xf
    v_add_f32_dpp v55, v55, v55 quad_perm:[2,3,0,1] row_mask:0xf bank_mask:0xf
    v_add_f32_dpp v48, v48, v48 row_half_mirror row_mask:0xf bank_mask:0xf
    v_add_f32_dpp v49, v49, v49 row_half_mirror row_mask:0xf bank_mask:0xf
    v_add_f32_dpp v50, v50, v50 row_half_mirror row_mask:0xf bank_mask:0xf
    v_add_f32_dpp v51, v51, v51 row_half_mirror row_mask:0xf bank_mask:0xf
    v_add_f32_dpp v52, v52, v52 row_half_mirror row_mask:0xf bank_mask:0xf
    v_add_f32_dpp v53, v53, v53 row_half_mirror row_mask:0xf bank_mask:0xf
    v_add_f32_dpp v54, v54, v54 row_half_mirror row_mask:0xf bank_mask:0xf
    v_add_f32_dpp v55, v55, v55 row_half_mirror row_mask:0xf bank_mask:0xf
    s_mov_b32 exec_lo, 0x2020202
    s_mov_b32 exec_hi, 0x2020202
    v_mov_b32 v48, v50
    v_mov_b32 v49, v51
    s_mov_b32 exec_lo, 0x4040404
    s_mov_b32 exec_hi, 0x4040404
    v_mov_b32 v48, v52
    v_mov_b32 v49, v53
    s_mov_b32 exec_lo, 0x8080808
    s_mov_b32 exec_hi, 0x8080808
    v_mov_b32 v48, v54
    v_mov_b32 v49, v55
    s_mov_b32 exec_lo, 0x0f0f0f0f
    s_mov_b32 exec_hi, 0x0f0f0f0f
    buffer_store_dwordx2 v[48:49], v56, s[16:19], s46 offen sc1
    s_mov_b64 exec, -1
    s_xor_b32 s50, s50, 1
    s_mov_b32 s86, 0x3f803f80
    v_and_b32 v104, 1, v0
    v_lshlrev_b32 v104, 7, v104
    v_bfe_u32 v105, v0, 1, 1
    v_lshl_add_u32 v104, v105, 6, v104
    v_and_b32 v105, 0x38, v0
    v_add_u32 v104, v105, v104
    s_sub_u32 s46, 127, s50
    s_lshl_b32 s46, s46, 10
    s_lshl_b32 s37, s32, 8
    s_add_u32 s46, s46, s37
    s_add_u32 s46, s46, 0x5400000
    s_waitcnt vmcnt(1)
    v_dot2_f32_bf16 v96, v64, s86, 0
    v_dot2_f32_bf16 v97, v64, v64, 0
    v_dot2_f32_bf16 v98, v72, s86, 0
    v_dot2_f32_bf16 v99, v72, v72, 0
    v_dot2_f32_bf16 v100, v80, s86, 0
    v_dot2_f32_bf16 v101, v80, v80, 0
    v_dot2_f32_bf16 v102, v88, s86, 0
    v_dot2_f32_bf16 v103, v88, v88, 0
    v_dot2_f32_bf16 v96, v65, s86, v96
    v_dot2_f32_bf16 v97, v65, v65, v97
    v_dot2_f32_bf16 v98, v73, s86, v98
    v_dot2_f32_bf16 v99, v73, v73, v99
    v_dot2_f32_bf16 v100, v81, s86, v100
    v_dot2_f32_bf16 v101, v81, v81, v101
    v_dot2_f32_bf16 v102, v89, s86, v102
    v_dot2_f32_bf16 v103, v89, v89, v103
    v_dot2_f32_bf16 v96, v66, s86, v96
    v_dot2_f32_bf16 v97, v66, v66, v97
    v_dot2_f32_bf16 v98, v74, s86, v98
    v_dot2_f32_bf16 v99, v74, v74, v99
    v_dot2_f32_bf16 v100, v82, s86, v100
    v_dot2_f32_bf16 v101, v82, v82, v101
    v_dot2_f32_bf16 v102, v90, s86, v102
    v_dot2_f32_bf16 v103, v90, v90, v103
    v_dot2_f32_bf16 v96, v67, s86, v96
    v_dot2_f32_bf16 v97, v67, v67, v97
    v_dot2_f32_bf16 v98, v75, s86, v98
    v_dot2_f32_bf16 v99, v75, v75, v99
    v_dot2_f32_bf16 v100, v83, s86, v100
    v_dot2_f32_bf16 v101, v83, v83, v101
    v_dot2_f32_bf16 v102, v91, s86, v102
    v_dot2_f32_bf16 v103, v91, v91, v103
    v_dot2_f32_bf16 v96, v68, s86, v96
    v_dot2_f32_bf16 v97, v68, v68, v97
    v_dot2_f32_bf16 v98, v76, s86, v98
    v_dot2_f32_bf16 v99, v76, v76, v99
    v_dot2_f32_bf16 v100, v84, s86, v100
    v_dot2_f32_bf16 v101, v84, v84, v101
    v_dot2_f32_bf16 v102, v92, s86, v102
    v_dot2_f32_bf16 v103, v92, v92, v103
    v_dot2_f32_bf16 v96, v69, s86, v96
    v_dot2_f32_bf16 v97, v69, v69, v97
    v_dot2_f32_bf16 v98, v77, s86, v98
    v_dot2_f32_bf16 v99, v77, v77, v99
    v_dot2_f32_bf16 v100, v85, s86, v100
    v_dot2_f32_bf16 v101, v85, v85, v101
    v_dot2_f32_bf16 v102, v93, s86, v102
    v_dot2_f32_bf16 v103, v93, v93, v103
    v_dot2_f32_bf16 v96, v70, s86, v96
    v_dot2_f32_bf16 v97, v70, v70, v97
    v_dot2_f32_bf16 v98, v78, s86, v98
    v_dot2_f32_bf16 v99, v78, v78, v99
    v_dot2_f32_bf16 v100, v86, s86, v100
    v_dot2_f32_bf16 v101, v86, v86, v101
    v_dot2_f32_bf16 v102, v94, s86, v102
    v_dot2_f32_bf16 v103, v94, v94, v103
    v_dot2_f32_bf16 v96, v71, s86, v96
    v_dot2_f32_bf16 v97, v71, v71, v97
    v_dot2_f32_bf16 v98, v79, s86, v98
    v_dot2_f32_bf16 v99, v79, v79, v99
    v_dot2_f32_bf16 v100, v87, s86, v100
    v_dot2_f32_bf16 v101, v87, v87, v101
    v_dot2_f32_bf16 v102, v95, s86, v102
    v_dot2_f32_bf16 v103, v95, v95, v103
    v_add_f32_dpp v96, v96, v96 quad_perm:[1,0,3,2] row_mask:0xf bank_mask:0xf
    v_add_f32_dpp v97, v97, v97 quad_perm:[1,0,3,2] row_mask:0xf bank_mask:0xf
    v_add_f32_dpp v98, v98, v98 quad_perm:[1,0,3,2] row_mask:0xf bank_mask:0xf
    v_add_f32_dpp v99, v99, v99 quad_perm:[1,0,3,2] row_mask:0xf bank_mask:0xf
    v_add_f32_dpp v100, v100, v100 quad_perm:[1,0,3,2] row_mask:0xf bank_mask:0xf
    v_add_f32_dpp v101, v101, v101 quad_perm:[1,0,3,2] row_mask:0xf bank_mask:0xf
    v_add_f32_dpp v102, v102, v102 quad_perm:[1,0,3,2] row_mask:0xf bank_mask:0xf
    v_add_f32_dpp v103, v103, v103 quad_perm:[1,0,3,2] row_mask:0xf bank_mask:0xf
    v_add_f32_dpp v96, v96, v96 quad_perm:[2,3,0,1] row_mask:0xf bank_mask:0xf
    v_add_f32_dpp v97, v97, v97 quad_perm:[2,3,0,1] row_mask:0xf bank_mask:0xf
    v_add_f32_dpp v98, v98, v98 quad_perm:[2,3,0,1] row_mask:0xf bank_mask:0xf
    v_add_f32_dpp v99, v99, v99 quad_perm:[2,3,0,1] row_mask:0xf bank_mask:0xf
    v_add_f32_dpp v100, v100, v100 quad_perm:[2,3,0,1] row_mask:0xf bank_mask:0xf
    v_add_f32_dpp v101, v101, v101 quad_perm:[2,3,0,1] row_mask:0xf bank_mask:0xf
    v_add_f32_dpp v102, v102, v102 quad_perm:[2,3,0,1] row_mask:0xf bank_mask:0xf
    v_add_f32_dpp v103, v103, v103 quad_perm:[2,3,0,1] row_mask:0xf bank_mask:0xf
    v_add_f32_dpp v96, v96, v96 row_half_mirror row_mask:0xf bank_mask:0xf
    v_add_f32_dpp v97, v97, v97 row_half_mirror row_mask:0xf bank_mask:0xf
    v_add_f32_dpp v98, v98, v98 row_half_mirror row_mask:0xf bank_mask:0xf
    v_add_f32_dpp v99, v99, v99 row_half_mirror row_mask:0xf bank_mask:0xf
    v_add_f32_dpp v100, v100, v100 row_half_mirror row_mask:0xf bank_mask:0xf
    v_add_f32_dpp v101, v101, v101 row_half_mirror row_mask:0xf bank_mask:0xf
    v_add_f32_dpp v102, v102, v102 row_half_mirror row_mask:0xf bank_mask:0xf
    v_add_f32_dpp v103, v103, v103 row_half_mirror row_mask:0xf bank_mask:0xf
    s_mov_b32 exec_lo, 0x2020202
    s_mov_b32 exec_hi, 0x2020202
    v_mov_b32 v96, v98
    v_mov_b32 v97, v99
    s_mov_b32 exec_lo, 0x4040404
    s_mov_b32 exec_hi, 0x4040404
    v_mov_b32 v96, v100
    v_mov_b32 v97, v101
    s_mov_b32 exec_lo, 0x8080808
    s_mov_b32 exec_hi, 0x8080808
    v_mov_b32 v96, v102
    v_mov_b32 v97, v103
    s_mov_b32 exec_lo, 0x0f0f0f0f
    s_mov_b32 exec_hi, 0x0f0f0f0f
    buffer_store_dwordx2 v[96:97], v104, s[16:19], s46 offen sc1
    s_mov_b64 exec, -1
    s_xor_b32 s50, s50, 1
L_bf_nost:
    s_cmp_lg_u32 s32, 0
    s_cbranch_scc1 L_arv45
    s_add_u32 s20, s82, 0x80
    s_addc_u32 s21, s83, 0
    s_mov_b32 s22, 0x4
    s_mov_b32 s23, 0x00020000
    buffer_load_dword v8, v124, s[20:23], 0 offen sc1
    s_waitcnt vmcnt(0)
    v_cmp_eq_u32 vcc, v124, v8
    s_cbranch_vccnz L_spin46
L_back47:
L_arv45:
    s_waitcnt vmcnt(0)
    s_barrier
    s_add_u32 s39, s91, 32768
    buffer_store_dword v124, v124, s[16:19], s39 offen sc1
    s_cmp_lt_u32 s35, 12
    s_cbranch_scc1 L_bf_nopf
    s_add_u32 s12, s72, 0x400000
    s_addc_u32 s13, s73, 0
    s_mov_b32 s14, 0x300000
    s_mov_b32 s15, 0x00020000
    s_sub_u32 s37, s35, 12
    s_lshl2_add_u32 s37, s37, s33
    s_lshl2_add_u32 s37, s37, s32
    s_lshl_b32 s37, s37, 13
    v_lshlrev_b32 v6, 7, v0
    buffer_load_dword v240, v6, s[12:15], s37 offen
    s_add_u32 s37, s37, 1048576
    buffer_load_dword v241, v6, s[12:15], s37 offen
    s_add_u32 s37, s37, 1048576
    buffer_load_dword v242, v6, s[12:15], s37 offen
    s_add_u32 s37, s37, 1048576
L_bf_nopf:
    s_lshr_b32 s51, s35, 2
    s_and_b32 s87, s35, 3
    s_mul_i32 s54, s51, 1441792
    s_lshl_b32 s37, s87, 9
    s_add_u32 s54, s54, s37
    s_mov_b32 s12, s76
    s_mov_b32 s13, s77
    s_mov_b32 s14, 0x700000
    s_mov_b32 s15, 0x00020000
    s_mov_b32 s39, 2048
    v_lshrrev_b32 v64, 3, v0
    v_lshlrev_b32 v65, 2, v0
    v_and_b32 v65, 64, v65
    v_and_b32 v66, 0x70, v1
    v_xor_b32 v65, v65, v66
    v_mad_u32_u24 v48, v64, s39, v65
    v_add_u32 v49, 16384, v48
    v_add_u32 v50, 128, v48
    v_add_u32 v51, 16512, v48
    v_add_u32 v52, 256, v48
    v_add_u32 v53, 16640, v48
    v_add_u32 v54, 384, v48
    v_add_u32 v55, 16768, v48
    s_mul_i32 s38, s32, 32768
    s_add_u32 s54, s54, s38
    s_lshl_b32 s42, s32, 11
    s_add_u32 m0, s42, 0
    s_nop 0
    buffer_load_dwordx4 v48, s[12:15], s54 offen lds
    s_add_u32 m0, s42, 1024
    s_nop 0
    buffer_load_dwordx4 v49, s[12:15], s54 offen lds
    s_add_u32 m0, s42, 8192
    s_nop 0
    buffer_load_dwordx4 v50, s[12:15], s54 offen lds
    s_add_u32 m0, s42, 9216
    s_nop 0
    buffer_load_dwordx4 v51, s[12:15], s54 offen lds
    s_add_u32 m0, s42, 16384
    s_nop 0
    buffer_load_dwordx4 v52, s[12:15], s54 offen lds
    s_add_u32 m0, s42, 17408
    s_nop 0
    buffer_load_dwordx4 v53, s[12:15], s54 offen lds
    s_add_u32 m0, s42, 24576
    s_nop 0
    buffer_load_dwordx4 v54, s[12:15], s54 offen lds
    s_add_u32 m0, s42, 25600
    s_nop 0
    buffer_load_dwordx4 v55, s[12:15], s54 offen lds
    s_add_u32 s54, s54, 131072
    s_add_u32 m0, s42, 32768
    s_nop 0
    buffer_load_dwordx4 v48, s[12:15], s54 offen lds
    s_add_u32 m0, s42, 33792
    s_nop 0
    buffer_load_dwordx4 v49, s[12:15], s54 offen lds
    s_add_u32 m0, s42, 40960
    s_nop 0
    buffer_load_dwordx4 v50, s[12:15], s54 offen lds
    s_add_u32 m0, s42, 41984
    s_nop 0
    buffer_load_dwordx4 v51, s[12:15], s54 offen lds
    s_add_u32 m0, s42, 49152
    s_nop 0
    buffer_load_dwordx4 v52, s[12:15], s54 offen lds
    s_add_u32 m0, s42, 50176
    s_nop 0
    buffer_load_dwordx4 v53, s[12:15], s54 offen lds
    s_add_u32 m0, s42, 57344
    s_nop 0
    buffer_load_dwordx4 v54, s[12:15], s54 offen lds
    s_add_u32 m0, s42, 58368
    s_nop 0
    buffer_load_dwordx4 v55, s[12:15], s54 offen lds
    s_add_u32 s54, s54, 131072
    s_add_u32 m0, s42, 65536
    s_nop 0
    buffer_load_dwordx4 v48, s[12:15], s54 offen lds
    s_add_u32 m0, s42, 66560
    s_nop 0
    buffer_load_dwordx4 v49, s[12:15], s54 offen lds
    s_add_u32 m0, s42, 73728
    s_nop 0
    buffer_load_dwordx4 v50, s[12:15], s54 offen lds
    s_add_u32 m0, s42, 74752
    s_nop 0
    buffer_load_dwordx4 v51, s[12:15], s54 offen lds
    s_add_u32 m0, s42, 81920
    s_nop 0
    buffer_load_dwordx4 v52, s[12:15], s54 offen lds
    s_add_u32 m0, s42, 82944
    s_nop 0
    buffer_load_dwordx4 v53, s[12:15], s54 offen lds
    s_add_u32 m0, s42, 90112
    s_nop 0
    buffer_load_dwordx4 v54, s[12:15], s54 offen lds
    s_add_u32 m0, s42, 91136
    s_nop 0
    buffer_load_dwordx4 v55, s[12:15], s54 offen lds
    s_add_u32 s54, s54, 131072
    s_add_u32 m0, s42, 98304
    s_nop 0
    buffer_load_dwordx4 v48, s[12:15], s54 offen lds
    s_add_u32 m0, s42, 99328
    s_nop 0
    buffer_load_dwordx4 v49, s[12:15], s54 offen lds
    s_add_u32 m0, s42, 106496
    s_nop 0
    buffer_load_dwordx4 v50, s[12:15], s54 offen lds
    s_add_u32 m0, s42, 107520
    s_nop 0
    buffer_load_dwordx4 v51, s[12:15], s54 offen lds
    s_add_u32 m0, s42, 114688
    s_nop 0
    buffer_load_dwordx4 v52, s[12:15], s54 offen lds
    s_add_u32 m0, s42, 115712
    s_nop 0
    buffer_load_dwordx4 v53, s[12:15], s54 offen lds
    s_add_u32 m0, s42, 122880
    s_nop 0
    buffer_load_dwordx4 v54, s[12:15], s54 offen lds
    s_add_u32 m0, s42, 123904
    s_nop 0
    buffer_load_dwordx4 v55, s[12:15], s54 offen lds
    s_add_u32 s54, s54, 131072
    v_lshrrev_b32 v64, 4, v0
    v_bfe_u32 v65, v0, 2, 2
    v_lshl_add_u32 v64, v64, 3, v65
    v_lshlrev_b32 v64, 7, v64
    v_lshrrev_b32 v65, 1, v65
    v_lshl_add_u32 v64, v65, 6, v64
    v_and_b32 v65, 3, v0
    v_lshl_add_u32 v64, v65, 4, v64
    s_lshl_b32 s37, s32, 13
    s_and_b32 s38, s51, 2
    s_lshl_b32 s38, s38, 5
    s_xor_b32 s38, s38, 0
    s_add_u32 s37, s37, s38
    v_xor_b32 v56, s37, v64
    s_lshl_b32 s37, s32, 13
    s_and_b32 s38, s51, 2
    s_lshl_b32 s38, s38, 5
    s_xor_b32 s38, s38, 8
    s_add_u32 s37, s37, s38
    v_xor_b32 v57, s37, v64
    s_lshl_b32 s37, s32, 13
    s_and_b32 s38, s51, 2
    s_lshl_b32 s38, s38, 5
    s_xor_b32 s38, s38, 64
    s_add_u32 s37, s37, s38
    v_xor_b32 v58, s37, v64
    s_lshl_b32 s37, s32, 13
    s_and_b32 s38, s51, 2
    s_lshl_b32 s38, s38, 5
    s_xor_b32 s38, s38, 72
    s_add_u32 s37, s37, s38
    v_xor_b32 v59, s37, v64
    s_and_b32 s39, s51, 1
    s_lshl_b32 s37, s39, 10
    v_add_u32 v2, s37, v1
    v_xor_b32 v3, 1024, v2
    v_add_u32 v4, 98304, v2
    v_add_u32 v5, 98304, v3
    s_mul_i32 s38, s51, 11*43
    s_lshr_b32 s38, s38, 7
    s_add_u32 s38, s38, 24
    s_lshl_b32 s37, s33, 6
    s_add_u32 s37, s37, s38
    s_lshl_b32 s37, s37, 7
    v_lshl_add_u32 v6, v0, 7, s37
    s_cmp_eq_u32 s32, 0
    s_cselect_b32 s37, 5, 0
    v_cmp_le_u32 vcc, s37, v0
    s_nop 1
    v_cndmask_b32 v6, v6, 2.0, vcc
    s_mul_i32 s43, s32, 4096
    s_mul_i32 s88, s32, 3072
    s_sub_u32 s89, s88, s43
    s_mul_i32 s41, s33, 8388608
    s_add_u32 s41, s41, 0x1000000
    s_mul_i32 s37, s51, 45056
    s_add_u32 s41, s41, s37
    s_add_u32 s41, s41, s43
    s_mul_i32 s90, s33, 8388608
    s_add_u32 s90, s90, 0x2fc0000
    s_lshl_b32 s37, s87, 16
    s_add_u32 s90, s90, s37
    s_lshl_b32 s37, s32, 12
    s_add_u32 s90, s90, s37
    s_and_b32 s37, s51, 3
    s_lshl_b32 s37, s37, 14
    s_add_u32 s90, s90, s37
    v_mov_b32 v104, 0
    v_mov_b32 v105, 0
    v_mov_b32 v106, 0
    v_mov_b32 v107, 0
    v_mov_b32 v108, 0
    v_mov_b32 v109, 0
    v_mov_b32 v110, 0
    v_mov_b32 v111, 0
    v_mov_b32 v17, 0x3f80
    v_and_b32 v16, 1, v0
    v_lshlrev_b32 v16, 4, v16
    v_lshlrev_b32 v16, v16, v17
    s_mov_b32 exec_lo, 0x300003
    s_mov_b32 exec_hi, 0x30000300
    v_mov_b32 v104, v16
    v_mov_b32 v110, v16
    s_mov_b32 exec_lo, 0xc0000c
    s_mov_b32 exec_hi, 0xc0000c00
    v_mov_b32 v105, v16
    v_mov_b32 v111, v16
    s_mov_b64 exec, -1
    s_add_u32 s38, s87, 44
    s_lshl_b32 s37, s33, 6
    s_add_u32 s37, s37, s38
    s_lshl_b32 s37, s37, 7
    v_lshl_add_u32 v8, v0, 9, s37
    v_cmp_le_u32 vcc, 5, v0
    s_nop 1
    v_cndmask_b32 v8, v8, 2.0, vcc
    s_lshl_b32 s38, s87, 2
    s_add_u32 s38, s38, s32
    s_lshl_b32 s38, s38, 1
    s_lshr_b32 s37, s51, 1
    s_add_u32 s38, s38, s37
    s_mul_i32 s53, s33, 2097152
    s_add_u32 s53, s53, 0x7f0000
    s_lshl_b32 s37, s38, 11
    s_add_u32 s53, s53, s37
    s_lshl_b32 s37, s39, 10
    s_add_u32 s53, s53, s37
    v_and_b32 v16, 15, v0
    v_and_b32 v17, 0x30, v0
    s_lshl_b32 s38, s38, 6
    s_mov_b32 s8, s78
    s_mov_b32 s9, s79
    s_mov_b32 s10, 0x800
    s_mov_b32 s11, 0x00020000
    buffer_load_dwordx4 v[24:27], v17, s[8:11], s38 offen
    v_lshl_add_u32 v9, v16, 11, v17
    v_add_u32 v9, s38, v9
    s_lshl_b32 s50, s33, 5
    s_add_u32 s50, s50, 31
    s_sub_u32 s50, s50, s39
    v_bfe_u32 v17, v0, 4, 1
    v_lshl_add_u32 v16, v16, 1, v17
    s_lshl_b32 s37, s32, 2
    s_add_u32 s37, s37, 65536
    v_lshl_add_u32 v10, v16, 4, s37
    v_and_b32 v16, 31, v0
    v_lshrrev_b32 v12, 5, v0
    v_lshlrev_b32 v12, 30, v12
    v_lshl_add_u32 v12, v16, 2, v12
    v_lshlrev_b32 v16, 4, v16
    v_add_u32 v11, 65536, v16
    s_lshl_b32 s37, s87, 1
    s_lshr_b32 s38, s51, 1
    s_add_u32 s37, s37, s38
    s_lshl_b32 s37, s37, 7
    s_add_u32 s55, s37, 0x543fc00
    s_cmp_eq_u32 s32, 2
    s_cselect_b32 s55, s55, 0x5f00000
    v_add_u32 v60, 0, v56
    v_add_u32 v61, 0, v57
    v_add_u32 v62, 0, v58
    v_add_u32 v63, 0, v59
    s_waitcnt vmcnt(25)
    s_barrier
    ds_read_b64_tr_b16 a[0:1], v60 offset:0
    ds_read_b64_tr_b16 a[2:3], v60 offset:512
    ds_read_b64_tr_b16 a[4:5], v61 offset:0
    ds_read_b64_tr_b16 a[6:7], v61 offset:512
    ds_read_b64_tr_b16 a[8:9], v62 offset:0
    ds_read_b64_tr_b16 a[10:11], v62 offset:512
    ds_read_b64_tr_b16 a[12:13], v63 offset:0
    ds_read_b64_tr_b16 a[14:15], v63 offset:512
    ds_read_b64_tr_b16 a[16:17], v60 offset:4096
    ds_read_b64_tr_b16 a[18:19], v60 offset:4608
    ds_read_b64_tr_b16 a[20:21], v61 offset:4096
    ds_read_b64_tr_b16 a[22:23], v61 offset:4608
    ds_read_b64_tr_b16 a[24:25], v62 offset:4096
    ds_read_b64_tr_b16 a[26:27], v62 offset:4608
    ds_read_b64_tr_b16 a[28:29], v63 offset:4096
    ds_read_b64_tr_b16 a[30:31], v63 offset:4608
    s_add_u32 m0, s42, 131072
    s_nop 0
    buffer_load_dwordx4 v48, s[12:15], s54 offen lds
    s_add_u32 m0, s42, 132096
    s_nop 0
    buffer_load_dwordx4 v49, s[12:15], s54 offen lds
    s_add_u32 m0, s42, 139264
    s_nop 0
    buffer_load_dwordx4 v50, s[12:15], s54 offen lds
    s_add_u32 m0, s42, 140288
    s_nop 0
    buffer_load_dwordx4 v51, s[12:15], s54 offen lds
    s_add_u32 m0, s42, 147456
    s_nop 0
    buffer_load_dwordx4 v52, s[12:15], s54 offen lds
    s_add_u32 m0, s42, 148480
    s_nop 0
    buffer_load_dwordx4 v53, s[12:15], s54 offen lds
    s_add_u32 m0, s42, 155648
    s_nop 0
    buffer_load_dwordx4 v54, s[12:15], s54 offen lds
    s_add_u32 m0, s42, 156672
    s_nop 0
    buffer_load_dwordx4 v55, s[12:15], s54 offen lds
    s_add_u32 s54, s54, 131072
    s_waitcnt lgkmcnt(0)
    v_add_u32 v60, 32768, v56
    v_add_u32 v61, 32768, v57
    v_add_u32 v62, 32768, v58
    v_add_u32 v63, 32768, v59
    s_waitcnt vmcnt(25)
    s_barrier
    ds_read_b64_tr_b16 a[32:33], v60 offset:0
    ds_read_b64_tr_b16 a[34:35], v60 offset:512
    ds_read_b64_tr_b16 a[36:37], v61 offset:0
    ds_read_b64_tr_b16 a[38:39], v61 offset:512
    ds_read_b64_tr_b16 a[40:41], v62 offset:0
    ds_read_b64_tr_b16 a[42:43], v62 offset:512
    ds_read_b64_tr_b16 a[44:45], v63 offset:0
    ds_read_b64_tr_b16 a[46:47], v63 offset:512
    ds_read_b64_tr_b16 a[48:49], v60 offset:4096
    ds_read_b64_tr_b16 a[50:51], v60 offset:4608
    ds_read_b64_tr_b16 a[52:53], v61 offset:4096
    ds_read_b64_tr_b16 a[54:55], v61 offset:4608
    ds_read_b64_tr_b16 a[56:57], v62 offset:4096
    ds_read_b64_tr_b16 a[58:59], v62 offset:4608
    ds_read_b64_tr_b16 a[60:61], v63 offset:4096
    ds_read_b64_tr_b16 a[62:63], v63 offset:4608
    s_add_u32 m0, s42, 0
    s_nop 0
    buffer_load_dwordx4 v48, s[12:15], s54 offen lds
    s_add_u32 m0, s42, 1024
    s_nop 0
    buffer_load_dwordx4 v49, s[12:15], s54 offen lds
    s_add_u32 m0, s42, 8192
    s_nop 0
    buffer_load_dwordx4 v50, s[12:15], s54 offen lds
    s_add_u32 m0, s42, 9216
    s_nop 0
    buffer_load_dwordx4 v51, s[12:15], s54 offen lds
    s_add_u32 m0, s42, 16384
    s_nop 0
    buffer_load_dwordx4 v52, s[12:15], s54 offen lds
    s_add_u32 m0, s42, 17408
    s_nop 0
    buffer_load_dwordx4 v53, s[12:15], s54 offen lds
    s_add_u32 m0, s42, 24576
    s_nop 0
    buffer_load_dwordx4 v54, s[12:15], s54 offen lds
    s_add_u32 m0, s42, 25600
    s_nop 0
    buffer_load_dwordx4 v55, s[12:15], s54 offen lds
    s_add_u32 s54, s54, 131072
    s_waitcnt lgkmcnt(0)
    v_add_u32 v60, 65536, v56
    v_add_u32 v61, 65536, v57
    v_add_u32 v62, 65536, v58
    v_add_u32 v63, 65536, v59
    s_waitcnt vmcnt(25)
    s_barrier
    ds_read_b64_tr_b16 a[64:65], v60 offset:0
    ds_read_b64_tr_b16 a[66:67], v60 offset:512
    ds_read_b64_tr_b16 a[68:69], v61 offset:0
    ds_read_b64_tr_b16 a[70:71], v61 offset:512
    ds_read_b64_tr_b16 a[72:73], v62 offset:0
    ds_read_b64_tr_b16 a[74:75], v62 offset:512
    ds_read_b64_tr_b16 a[76:77], v63 offset:0
    ds_read_b64_tr_b16 a[78:79], v63 offset:512
    ds_read_b64_tr_b16 a[80:81], v60 offset:4096
    ds_read_b64_tr_b16 a[82:83], v60 offset:4608
    ds_read_b64_tr_b16 a[84:85], v61 offset:4096
    ds_read_b64_tr_b16 a[86:87], v61 offset:4608
    ds_read_b64_tr_b16 a[88:89], v62 offset:4096
    ds_read_b64_tr_b16 a[90:91], v62 offset:4608
    ds_read_b64_tr_b16 a[92:93], v63 offset:4096
    ds_read_b64_tr_b16 a[94:95], v63 offset:4608
    s_add_u32 m0, s42, 32768
    s_nop 0
    buffer_load_dwordx4 v48, s[12:15], s54 offen lds
    s_add_u32 m0, s42, 33792
    s_nop 0
    buffer_load_dwordx4 v49, s[12:15], s54 offen lds
    s_add_u32 m0, s42, 40960
    s_nop 0
    buffer_load_dwordx4 v50, s[12:15], s54 offen lds
    s_add_u32 m0, s42, 41984
    s_nop 0
    buffer_load_dwordx4 v51, s[12:15], s54 offen lds
    s_add_u32 m0, s42, 49152
    s_nop 0
    buffer_load_dwordx4 v52, s[12:15], s54 offen lds
    s_add_u32 m0, s42, 50176
    s_nop 0
    buffer_load_dwordx4 v53, s[12:15], s54 offen lds
    s_add_u32 m0, s42, 57344
    s_nop 0
    buffer_load_dwordx4 v54, s[12:15], s54 offen lds
    s_add_u32 m0, s42, 58368
    s_nop 0
    buffer_load_dwordx4 v55, s[12:15], s54 offen lds
    s_add_u32 s54, s54, 131072
    s_waitcnt lgkmcnt(0)
    v_add_u32 v60, 98304, v56
    v_add_u32 v61, 98304, v57
    v_add_u32 v62, 98304, v58
    v_add_u32 v63, 98304, v59
    s_waitcnt vmcnt(25)
    s_barrier
    ds_read_b64_tr_b16 a[96:97], v60 offset:0
    ds_read_b64_tr_b16 a[98:99], v60 offset:512
    ds_read_b64_tr_b16 a[100:101], v61 offset:0
    ds_read_b64_tr_b16 a[102:103], v61 offset:512
    ds_read_b64_tr_b16 a[104:105], v62 offset:0
    ds_read_b64_tr_b16 a[106:107], v62 offset:512
    ds_read_b64_tr_b16 a[108:109], v63 offset:0
    ds_read_b64_tr_b16 a[110:111], v63 offset:512
    ds_read_b64_tr_b16 a[112:113], v60 offset:4096
    ds_read_b64_tr_b16 a[114:115], v60 offset:4608
    ds_read_b64_tr_b16 a[116:117], v61 offset:4096
    ds_read_b64_tr_b16 a[118:119], v61 offset:4608
    ds_read_b64_tr_b16 a[120:121], v62 offset:4096
    ds_read_b64_tr_b16 a[122:123], v62 offset:4608
    ds_read_b64_tr_b16 a[124:125], v63 offset:4096
    ds_read_b64_tr_b16 a[126:127], v63 offset:4608
    s_add_u32 m0, s42, 65536
    s_nop 0
    buffer_load_dwordx4 v48, s[12:15], s54 offen lds
    s_add_u32 m0, s42, 66560
    s_nop 0
    buffer_load_dwordx4 v49, s[12:15], s54 offen lds
    s_add_u32 m0, s42, 73728
    s_nop 0
    buffer_load_dwordx4 v50, s[12:15], s54 offen lds
    s_add_u32 m0, s42, 74752
    s_nop 0
    buffer_load_dwordx4 v51, s[12:15], s54 offen lds
    s_add_u32 m0, s42, 81920
    s_nop 0
    buffer_load_dwordx4 v52, s[12:15], s54 offen lds
    s_add_u32 m0, s42, 82944
    s_nop 0
    buffer_load_dwordx4 v53, s[12:15], s54 offen lds
    s_add_u32 m0, s42, 90112
    s_nop 0
    buffer_load_dwordx4 v54, s[12:15], s54 offen lds
    s_add_u32 m0, s42, 91136
    s_nop 0
    buffer_load_dwordx4 v55, s[12:15], s54 offen lds
    s_add_u32 s54, s54, 131072
    s_waitcnt lgkmcnt(0)
    v_add_u32 v60, 131072, v56
    v_add_u32 v61, 131072, v57
    v_add_u32 v62, 131072, v58
    v_add_u32 v63, 131072, v59
    s_waitcnt vmcnt(24)
    s_barrier
    ds_read_b64_tr_b16 a[128:129], v60 offset:0
    ds_read_b64_tr_b16 a[130:131], v60 offset:512
    ds_read_b64_tr_b16 a[132:133], v61 offset:0
    ds_read_b64_tr_b16 a[134:135], v61 offset:512
    ds_read_b64_tr_b16 a[136:137], v62 offset:0
    ds_read_b64_tr_b16 a[138:139], v62 offset:512
    ds_read_b64_tr_b16 a[140:141], v63 offset:0
    ds_read_b64_tr_b16 a[142:143], v63 offset:512
    ds_read_b64_tr_b16 a[144:145], v60 offset:4096
    ds_read_b64_tr_b16 a[146:147], v60 offset:4608
    ds_read_b64_tr_b16 a[148:149], v61 offset:4096
    ds_read_b64_tr_b16 a[150:151], v61 offset:4608
    ds_read_b64_tr_b16 a[152:153], v62 offset:4096
    ds_read_b64_tr_b16 a[154:155], v62 offset:4608
    ds_read_b64_tr_b16 a[156:157], v63 offset:4096
    ds_read_b64_tr_b16 a[158:159], v63 offset:4608
    s_add_u32 m0, s42, 98304
    s_nop 0
    buffer_load_dwordx4 v48, s[12:15], s54 offen lds
    s_add_u32 m0, s42, 99328
    s_nop 0
    buffer_load_dwordx4 v49, s[12:15], s54 offen lds
    s_add_u32 m0, s42, 106496
    s_nop 0
    buffer_load_dwordx4 v50, s[12:15], s54 offen lds
    s_add_u32 m0, s42, 107520
    s_nop 0
    buffer_load_dwordx4 v51, s[12:15], s54 offen lds
    s_add_u32 m0, s42, 114688
    s_nop 0
    buffer_load_dwordx4 v52, s[12:15], s54 offen lds
    s_add_u32 m0, s42, 115712
    s_nop 0
    buffer_load_dwordx4 v53, s[12:15], s54 offen lds
    s_add_u32 m0, s42, 122880
    s_nop 0
    buffer_load_dwordx4 v54, s[12:15], s54 offen lds
    s_add_u32 m0, s42, 123904
    s_nop 0
    buffer_load_dwordx4 v55, s[12:15], s54 offen lds
    s_add_u32 s54, s54, 131072
    s_waitcnt lgkmcnt(0)
    v_add_u32 v60, 0, v56
    v_add_u32 v61, 0, v57
    v_add_u32 v62, 0, v58
    v_add_u32 v63, 0, v59
    s_waitcnt vmcnt(24)
    s_barrier
    ds_read_b64_tr_b16 a[160:161], v60 offset:0
    ds_read_b64_tr_b16 a[162:163], v60 offset:512
    ds_read_b64_tr_b16 a[164:165], v61 offset:0
    ds_read_b64_tr_b16 a[166:167], v61 offset:512
    ds_read_b64_tr_b16 a[168:169], v62 offset:0
    ds_read_b64_tr_b16 a[170:171], v62 offset:512
    ds_read_b64_tr_b16 a[172:173], v63 offset:0
    ds_read_b64_tr_b16 a[174:175], v63 offset:512
    ds_read_b64_tr_b16 a[176:177], v60 offset:4096
    ds_read_b64_tr_b16 a[178:179], v60 offset:4608
    ds_read_b64_tr_b16 a[180:181], v61 offset:4096
    ds_read_b64_tr_b16 a[182:183], v61 offset:4608
    ds_read_b64_tr_b16 a[184:185], v62 offset:4096
    ds_read_b64_tr_b16 a[186:187], v62 offset:4608
    ds_read_b64_tr_b16 a[188:189], v63 offset:4096
    ds_read_b64_tr_b16 a[190:191], v63 offset:4608
    s_add_u32 m0, s42, 131072
    s_nop 0
    buffer_load_dwordx4 v48, s[12:15], s54 offen lds
    s_add_u32 m0, s42, 132096
    s_nop 0
    buffer_load_dwordx4 v49, s[12:15], s54 offen lds
    s_add_u32 m0, s42, 139264
    s_nop 0
    buffer_load_dwordx4 v50, s[12:15], s54 offen lds
    s_add_u32 m0, s42, 140288
    s_nop 0
    buffer_load_dwordx4 v51, s[12:15], s54 offen lds
    s_add_u32 m0, s42, 147456
    s_nop 0
    buffer_load_dwordx4 v52, s[12:15], s54 offen lds
    s_add_u32 m0, s42, 148480
    s_nop 0
    buffer_load_dwordx4 v53, s[12:15], s54 offen lds
    s_add_u32 m0, s42, 155648
    s_nop 0
    buffer_load_dwordx4 v54, s[12:15], s54 offen lds
    s_add_u32 m0, s42, 156672
    s_nop 0
    buffer_load_dwordx4 v55, s[12:15], s54 offen lds
    s_add_u32 s54, s54, 131072
    s_waitcnt lgkmcnt(0)
    v_add_u32 v60, 32768, v56
    v_add_u32 v61, 32768, v57
    v_add_u32 v62, 32768, v58
    v_add_u32 v63, 32768, v59
    s_waitcnt vmcnt(24)
    s_barrier
    ds_read_b64_tr_b16 a[192:193], v60 offset:0
    ds_read_b64_tr_b16 a[194:195], v60 offset:512
    ds_read_b64_tr_b16 a[196:197], v61 offset:0
    ds_read_b64_tr_b16 a[198:199], v61 offset:512
    ds_read_b64_tr_b16 a[200:201], v62 offset:0
    ds_read_b64_tr_b16 a[202:203], v62 offset:512
    ds_read_b64_tr_b16 a[204:205], v63 offset:0
    ds_read_b64_tr_b16 a[206:207], v63 offset:512
    ds_read_b64_tr_b16 a[208:209], v60 offset:4096
    ds_read_b64_tr_b16 a[210:211], v60 offset:4608
    ds_read_b64_tr_b16 a[212:213], v61 offset:4096
    ds_read_b64_tr_b16 a[214:215], v61 offset:4608
    ds_read_b64_tr_b16 a[216:217], v62 offset:4096
    ds_read_b64_tr_b16 a[218:219], v62 offset:4608
    ds_read_b64_tr_b16 a[220:221], v63 offset:4096
    ds_read_b64_tr_b16 a[222:223], v63 offset:4608
    s_add_u32 m0, s42, 0
    s_nop 0
    buffer_load_dwordx4 v48, s[12:15], s54 offen lds
    s_add_u32 m0, s42, 1024
    s_nop 0
    buffer_load_dwordx4 v49, s[12:15], s54 offen lds
    s_add_u32 m0, s42, 8192
    s_nop 0
    buffer_load_dwordx4 v50, s[12:15], s54 offen lds
    s_add_u32 m0, s42, 9216
    s_nop 0
    buffer_load_dwordx4 v51, s[12:15], s54 offen lds
    s_add_u32 m0, s42, 16384
    s_nop 0
    buffer_load_dwordx4 v52, s[12:15], s54 offen lds
    s_add_u32 m0, s42, 17408
    s_nop 0
    buffer_load_dwordx4 v53, s[12:15], s54 offen lds
    s_add_u32 m0, s42, 24576
    s_nop 0
    buffer_load_dwordx4 v54, s[12:15], s54 offen lds
    s_add_u32 m0, s42, 25600
    s_nop 0
    buffer_load_dwordx4 v55, s[12:15], s54 offen lds
    s_add_u32 s54, s54, 131072
    s_waitcnt lgkmcnt(0)
    v_add_u32 v60, 65536, v56
    v_add_u32 v61, 65536, v57
    v_add_u32 v62, 65536, v58
    v_add_u32 v63, 65536, v59
    s_waitcnt vmcnt(24)
    s_barrier
    ds_read_b64_tr_b16 a[224:225], v60 offset:0
    ds_read_b64_tr_b16 a[226:227], v60 offset:512
    ds_read_b64_tr_b16 a[228:229], v61 offset:0
    ds_read_b64_tr_b16 a[230:231], v61 offset:512
    ds_read_b64_tr_b16 a[232:233], v62 offset:0
    ds_read_b64_tr_b16 a[234:235], v62 offset:512
    ds_read_b64_tr_b16 a[236:237], v63 offset:0
    ds_read_b64_tr_b16 a[238:239], v63 offset:512
    ds_read_b64_tr_b16 a[240:241], v60 offset:4096
    ds_read_b64_tr_b16 a[242:243], v60 offset:4608
    ds_read_b64_tr_b16 a[244:245], v61 offset:4096
    ds_read_b64_tr_b16 a[246:247], v61 offset:4608
    ds_read_b64_tr_b16 a[248:249], v62 offset:4096
    ds_read_b64_tr_b16 a[250:251], v62 offset:4608
    ds_read_b64_tr_b16 a[252:253], v63 offset:4096
    ds_read_b64_tr_b16 a[254:255], v63 offset:4608
    s_waitcnt lgkmcnt(0)
    v_add_u32 v60, 98304, v56
    v_add_u32 v61, 98304, v57
    v_add_u32 v62, 98304, v58
    v_add_u32 v63, 98304, v59
    s_waitcnt vmcnt(16)
    s_barrier
    ds_read_b64_tr_b16 v[160:161], v60 offset:0
    ds_read_b64_tr_b16 v[162:163], v60 offset:512
    ds_read_b64_tr_b16 v[164:165], v61 offset:0
    ds_read_b64_tr_b16 v[166:167], v61 offset:512
    ds_read_b64_tr_b16 v[168:169], v62 offset:0
    ds_read_b64_tr_b16 v[170:171], v62 offset:512
    ds_read_b64_tr_b16 v[172:173], v63 offset:0
    ds_read_b64_tr_b16 v[174:175], v63 offset:512
    ds_read_b64_tr_b16 v[176:177], v60 offset:4096
    ds_read_b64_tr_b16 v[178:179], v60 offset:4608
    ds_read_b64_tr_b16 v[180:181], v61 offset:4096
    ds_read_b64_tr_b16 v[182:183], v61 offset:4608
    ds_read_b64_tr_b16 v[184:185], v62 offset:4096
    ds_read_b64_tr_b16 v[186:187], v62 offset:4608
    ds_read_b64_tr_b16 v[188:189], v63 offset:4096
    ds_read_b64_tr_b16 v[190:191], v63 offset:4608
    s_waitcnt lgkmcnt(0)
    v_add_u32 v60, 131072, v56
    v_add_u32 v61, 131072, v57
    v_add_u32 v62, 131072, v58
    v_add_u32 v63, 131072, v59
    s_waitcnt vmcnt(8)
    s_barrier
    ds_read_b64_tr_b16 v[192:193], v60 offset:0
    ds_read_b64_tr_b16 v[194:195], v60 offset:512
    ds_read_b64_tr_b16 v[196:197], v61 offset:0
    ds_read_b64_tr_b16 v[198:199], v61 offset:512
    ds_read_b64_tr_b16 v[200:201], v62 offset:0
    ds_read_b64_tr_b16 v[202:203], v62 offset:512
    ds_read_b64_tr_b16 v[204:205], v63 offset:0
    ds_read_b64_tr_b16 v[206:207], v63 offset:512
    ds_read_b64_tr_b16 v[208:209], v60 offset:4096
    ds_read_b64_tr_b16 v[210:211], v60 offset:4608
    ds_read_b64_tr_b16 v[212:213], v61 offset:4096
    ds_read_b64_tr_b16 v[214:215], v61 offset:4608
    ds_read_b64_tr_b16 v[216:217], v62 offset:4096
    ds_read_b64_tr_b16 v[218:219], v62 offset:4608
    ds_read_b64_tr_b16 v[220:221], v63 offset:4096
    ds_read_b64_tr_b16 v[222:223], v63 offset:4608
    s_waitcnt lgkmcnt(0)
    v_add_u32 v60, 0, v56
    v_add_u32 v61, 0, v57
    v_add_u32 v62, 0, v58
    v_add_u32 v63, 0, v59
    s_waitcnt vmcnt(0)
    s_barrier
    ds_read_b64_tr_b16 v[224:225], v60 offset:0
    ds_read_b64_tr_b16 v[226:227], v60 offset:512
    ds_read_b64_tr_b16 v[228:229], v61 offset:0
    ds_read_b64_tr_b16 v[230:231], v61 offset:512
    ds_read_b64_tr_b16 v[232:233], v62 offset:0
    ds_read_b64_tr_b16 v[234:235], v62 offset:512
    ds_read_b64_tr_b16 v[236:237], v63 offset:0
    ds_read_b64_tr_b16 v[238:239], v63 offset:512
    ds_read_b64_tr_b16 v[240:241], v60 offset:4096
    ds_read_b64_tr_b16 v[242:243], v60 offset:4608
    ds_read_b64_tr_b16 v[244:245], v61 offset:4096
    ds_read_b64_tr_b16 v[246:247], v61 offset:4608
    ds_read_b64_tr_b16 v[248:249], v62 offset:4096
    ds_read_b64_tr_b16 v[250:251], v62 offset:4608
    ds_read_b64_tr_b16 v[252:253], v63 offset:4096
    ds_read_b64_tr_b16 v[254:255], v63 offset:4608
    s_waitcnt lgkmcnt(0)
    s_barrier
    s_mov_b32 s37, 0xffff0000
    v_lshlrev_b32 v112, 16, v24
    v_and_b32 v113, s37, v24
    v_lshlrev_b32 v114, 16, v25
    v_and_b32 v115, s37, v25
    v_lshlrev_b32 v116, 16, v26
    v_and_b32 v117, s37, v26
    v_lshlrev_b32 v118, 16, v27
    v_and_b32 v119, s37, v27
    s_add_u32 s37, s90, 8388608
    v_mov_b32 v16, -1
    v_mov_b32 v17, -1
    v_mov_b32 v18, -1
    v_mov_b32 v19, -1
    buffer_store_dwordx4 v[16:19], v1, s[16:19], s37 offen offset:0 sc1
    buffer_store_dwordx4 v[16:19], v1, s[16:19], s37 offen offset:1024 sc1
    buffer_store_dwordx4 v[16:19], v1, s[16:19], s37 offen offset:2048 sc1
    buffer_store_dwordx4 v[16:19], v1, s[16:19], s37 offen offset:3072 sc1
    s_cmp_lg_u32 s32, 0
    s_cbranch_scc1 L_arv48
    s_add_u32 s20, s82, 0x80
    s_addc_u32 s21, s83, 0
    s_mov_b32 s22, 0x4
    s_mov_b32 s23, 0x00020000
    buffer_load_dword v80, v124, s[20:23], 0 offen sc1
    s_waitcnt vmcnt(0)
    v_cmp_eq_u32 vcc, v124, v80
    s_cbranch_vccnz L_spin49
L_back50:
L_arv48:
    s_add_u32 s96, s41, 8126464
    s_mov_b32 s98, s41
    s_mov_b32 s45, 0x5530000
    buffer_load_dword v96, v6, s[16:19], s45 offen sc1
    s_waitcnt vmcnt(0)
    v_cmp_ne_u32 vcc, 0, v96
    s_cbranch_vccnz L_spin51
L_back52:
    s_barrier
    s_add_u32 m0, s43, 0
    s_add_u32 s42, s41, 0
    buffer_load_dwordx4 v1, s[16:19], s42 offen offset:0 sc1 lds
    buffer_load_dwordx4 v1, s[16:19], s42 offen offset:1024 sc1 lds
    buffer_load_dwordx4 v1, s[16:19], s42 offen offset:2048 sc1 lds
    buffer_load_dwordx4 v1, s[16:19], s42 offen offset:3072 sc1 lds
    s_add_u32 m0, s88, 16384
    s_add_u32 s42, s41, 16384
    s_add_u32 s42, s42, s89
    buffer_load_dwordx4 v1, s[16:19], s42 offen offset:0 sc1 lds
    buffer_load_dwordx4 v1, s[16:19], s42 offen offset:1024 sc1 lds
    buffer_load_dwordx4 v1, s[16:19], s42 offen offset:2048 sc1 lds
    s_add_u32 m0, s43, 28672
    s_add_u32 s42, s41, 28672
    buffer_load_dwordx4 v1, s[16:19], s42 offen offset:0 sc1 lds
    buffer_load_dwordx4 v1, s[16:19], s42 offen offset:1024 sc1 lds
    buffer_load_dwordx4 v1, s[16:19], s42 offen offset:2048 sc1 lds
    buffer_load_dwordx4 v1, s[16:19], s42 offen offset:3072 sc1 lds
    s_add_u32 s45, s45, 65536
    s_waitcnt vmcnt(0) lgkmcnt(0)
    s_barrier
    s_mov_b32 s52, 0x5e00000
    s_mov_b32 s46, 0x5e00000
    s_add_u32 s20, s84, 0x5e00000
    s_addc_u32 s21, s85, 0
    s_mov_b32 s22, 0x400000
    s_mov_b32 s23, 0x00020000
    ds_read_b128 v[80:83], v2 offset:0
    ds_read_b128 v[84:87], v3 offset:0
    s_mov_b32 s36, 0
    s_waitcnt lgkmcnt(0)
    s_nop 7
L_bf_b0:
    v_mfma_f32_16x16x32_bf16 v[16:19], a[0:3], v[80:83], v[112:115]
    s_sub_u32 s47, s45, 196608
    ds_read_b128 v[88:91], v2 offset:2048
    s_max_u32 s47, s47, 0x5500000
    v_mfma_f32_16x16x32_bf16 v[24:27], a[0:3], v[84:87], 0
    buffer_load_dword v13, v8, s[16:19], s47 offen sc1
    v_mfma_f32_16x16x32_bf16 v[28:31], a[4:7], v[84:87], 0
    s_and_b32 s38, s53, 0xffffffff
    ds_read_b128 v[92:95], v3 offset:2048
    s_cmp_lt_i32 s36, 1
    v_mfma_f32_16x16x32_bf16 v[20:23], a[4:7], v[80:83], v[116:119]
    s_cselect_b32 s38, 0x5e00000, s38
    v_mfma_f32_16x16x32_bf16 v[32:35], a[8:11], v[80:83], 0
    buffer_load_dwordx4 v[136:139], v1, s[16:19], s38 offen sc1
    v_mfma_f32_16x16x32_bf16 v[40:43], a[8:11], v[84:87], 0
    s_add_u32 s53, s53, 65536
    ds_read_b128 v[144:147], v11 offset:0
    s_and_b32 s44, s90, 0xffffffff
    v_mfma_f32_16x16x32_bf16 v[44:47], a[12:15], v[84:87], 0
    s_cmp_lt_i32 s36, 1
    s_cselect_b32 s44, 0x5e00000, s44
    s_xor_b32 s49, s44, 16384
    v_mfma_f32_16x16x32_bf16 v[36:39], a[12:15], v[80:83], 0
    s_waitcnt lgkmcnt(1)
    v_cvt_pk_bf16_f32 v56, v56, v57
    v_cvt_pk_bf16_f32 v57, v58, v59
    v_mfma_f32_16x16x32_bf16 v[16:19], a[16:19], v[88:91], v[16:19]
    ds_read_b128 v[80:83], v2 offset:4096
    v_cvt_pk_bf16_f32 v58, v60, v61
    v_mfma_f32_16x16x32_bf16 v[24:27], a[16:19], v[92:95], v[24:27]
    v_cvt_pk_bf16_f32 v59, v62, v63
    v_mfma_f32_16x16x32_bf16 v[28:31], a[20:23], v[92:95], v[28:31]
    s_waitcnt lgkmcnt(1)
    ds_read_b128 v[84:87], v3 offset:4096
    v_add_f32 v144, v144, v145
    v_mfma_f32_16x16x32_bf16 v[20:23], a[20:23], v[88:91], v[20:23]
    buffer_store_dwordx4 v[56:59], v1, s[16:19], s49 offen offset:0 sc1
    v_mfma_f32_16x16x32_bf16 v[32:35], a[24:27], v[88:91], v[32:35]
    s_xor_b32 s49, s44, 32768
    v_cvt_pk_bf16_f32 v64, v64, v65
    v_cvt_pk_bf16_f32 v65, v66, v67
    v_mfma_f32_16x16x32_bf16 v[40:43], a[24:27], v[92:95], v[40:43]
    v_cvt_pk_bf16_f32 v66, v68, v69
    v_cvt_pk_bf16_f32 v67, v70, v71
    v_mfma_f32_16x16x32_bf16 v[44:47], a[28:31], v[92:95], v[44:47]
    buffer_store_dwordx4 v[64:67], v1, s[16:19], s49 offen offset:1024 sc1
    v_mfma_f32_16x16x32_bf16 v[36:39], a[28:31], v[88:91], v[36:39]
    s_waitcnt lgkmcnt(0)
    v_add_f32 v146, v146, v147
    v_add_f32 v144, v144, v146
    v_mfma_f32_16x16x32_bf16 v[16:19], a[32:35], v[80:83], v[16:19]
    s_xor_b32 s49, s44, 49152
    ds_read_b128 v[88:91], v2 offset:6144
    v_cvt_pk_bf16_f32 v72, v72, v73
    v_mfma_f32_16x16x32_bf16 v[24:27], a[32:35], v[84:87], v[24:27]
    v_cvt_pk_bf16_f32 v73, v74, v75
    v_cvt_pk_bf16_f32 v74, v76, v77
    v_mfma_f32_16x16x32_bf16 v[28:31], a[36:39], v[84:87], v[28:31]
    ds_read_b128 v[92:95], v3 offset:6144
    v_cvt_pk_bf16_f32 v75, v78, v79
    v_mfma_f32_16x16x32_bf16 v[20:23], a[36:39], v[80:83], v[20:23]
    buffer_store_dwordx4 v[72:75], v1, s[16:19], s49 offen offset:2048 sc1
    v_mfma_f32_16x16x32_bf16 v[32:35], a[40:43], v[80:83], v[32:35]
    s_add_u32 s90, s90, 262144
    v_mfma_f32_16x16x32_bf16 v[40:43], a[40:43], v[84:87], v[40:43]
    v_mfma_f32_16x16x32_bf16 v[44:47], a[44:47], v[84:87], v[44:47]
    buffer_store_dword v144, v12, s[16:19], s46 offen sc1
    v_mfma_f32_16x16x32_bf16 v[36:39], a[44:47], v[80:83], v[36:39]
    s_waitcnt lgkmcnt(0)
    v_mfma_f32_16x16x32_bf16 v[16:19], a[48:51], v[88:91], v[16:19]
    s_add_u32 s98, s98, 262144
    ds_read_b128 v[80:83], v2 offset:8192
    s_min_i32 s98, s98, s96
    v_mfma_f32_16x16x32_bf16 v[24:27], a[48:51], v[92:95], v[24:27]
    s_and_b32 s41, s98, 0xffffffff
    s_add_u32 m0, s43, 98304
    s_add_u32 s42, s41, 0
    v_mfma_f32_16x16x32_bf16 v[28:31], a[52:55], v[92:95], v[28:31]
    ds_read_b128 v[84:87], v3 offset:8192
    v_mfma_f32_16x16x32_bf16 v[20:23], a[52:55], v[88:91], v[20:23]
    v_mfma_f32_16x16x32_bf16 v[32:35], a[56:59], v[88:91], v[32:35]
    v_mfma_f32_16x16x32_bf16 v[40:43], a[56:59], v[92:95], v[40:43]
    v_mfma_f32_16x16x32_bf16 v[44:47], a[60:63], v[92:95], v[44:47]
    v_mfma_f32_16x16x32_bf16 v[36:39], a[60:63], v[88:91], v[36:39]
    s_waitcnt lgkmcnt(0)
    v_mfma_f32_16x16x32_bf16 v[16:19], a[64:67], v[80:83], v[16:19]
    ds_read_b128 v[88:91], v2 offset:10240
    v_mfma_f32_16x16x32_bf16 v[24:27], a[64:67], v[84:87], v[24:27]
    v_mfma_f32_16x16x32_bf16 v[28:31], a[68:71], v[84:87], v[28:31]
    ds_read_b128 v[92:95], v3 offset:10240
    v_mfma_f32_16x16x32_bf16 v[20:23], a[68:71], v[80:83], v[20:23]
    v_mfma_f32_16x16x32_bf16 v[32:35], a[72:75], v[80:83], v[32:35]
    v_mfma_f32_16x16x32_bf16 v[40:43], a[72:75], v[84:87], v[40:43]
    v_mfma_f32_16x16x32_bf16 v[44:47], a[76:79], v[84:87], v[44:47]
    v_mfma_f32_16x16x32_bf16 v[36:39], a[76:79], v[80:83], v[36:39]
    s_waitcnt lgkmcnt(0)
    v_mfma_f32_16x16x32_bf16 v[16:19], a[80:83], v[88:91], v[16:19]
    ds_read_b128 v[80:83], v2 offset:12288
    v_mfma_f32_16x16x32_bf16 v[24:27], a[80:83], v[92:95], v[24:27]
    v_mfma_f32_16x16x32_bf16 v[28:31], a[84:87], v[92:95], v[28:31]
    ds_read_b128 v[84:87], v3 offset:12288
    v_mfma_f32_16x16x32_bf16 v[20:23], a[84:87], v[88:91], v[20:23]
    v_mfma_f32_16x16x32_bf16 v[32:35], a[88:91], v[88:91], v[32:35]
    s_waitcnt vmcnt(5)
    v_cmp_ne_u32 vcc, 0, v13
    v_mfma_f32_16x16x32_bf16 v[40:43], a[88:91], v[92:95], v[40:43]
    v_mfma_f32_16x16x32_bf16 v[44:47], a[92:95], v[92:95], v[44:47]
    s_cbranch_vccnz L_spin53
L_back54:
    s_sub_u32 s48, s90, 524288
    s_and_b32 s48, s48, 0xffffffff
    v_mfma_f32_16x16x32_bf16 v[36:39], a[92:95], v[88:91], v[36:39]
    s_waitcnt lgkmcnt(0)
    s_cmp_lt_i32 s36, 2
    s_cselect_b32 s48, s52, s48
    v_mfma_f32_16x16x32_bf16 v[16:19], a[96:99], v[80:83], v[16:19]
    ds_read_b128 v[88:91], v2 offset:14336
    v_mfma_f32_16x16x32_bf16 v[24:27], a[96:99], v[84:87], v[24:27]
    buffer_load_dwordx4 v[140:143], v1, s[16:19], s48 offen offset:0 sc1
    v_mfma_f32_16x16x32_bf16 v[28:31], a[100:103], v[84:87], v[28:31]
    ds_read_b128 v[92:95], v3 offset:14336
    v_mfma_f32_16x16x32_bf16 v[20:23], a[100:103], v[80:83], v[20:23]
    v_mfma_f32_16x16x32_bf16 v[32:35], a[104:107], v[80:83], v[32:35]
    buffer_load_dword v96, v6, s[16:19], s45 offen sc1
    v_mfma_f32_16x16x32_bf16 v[40:43], a[104:107], v[84:87], v[40:43]
    v_mfma_f32_16x16x32_bf16 v[44:47], a[108:111], v[84:87], v[44:47]
    v_mfma_f32_16x16x32_bf16 v[36:39], a[108:111], v[80:83], v[36:39]
    s_waitcnt lgkmcnt(0)
    v_mfma_f32_16x16x32_bf16 v[16:19], a[112:115], v[88:91], v[16:19]
    ds_read_b128 v[80:83], v2 offset:16384
    v_mfma_f32_16x16x32_bf16 v[24:27], a[112:115], v[92:95], v[24:27]
    buffer_load_dwordx4 v[144:147], v1, s[16:19], s48 offen offset:1024 sc1
    v_mfma_f32_16x16x32_bf16 v[28:31], a[116:119], v[92:95], v[28:31]
    ds_read_b128 v[84:87], v3 offset:16384
    v_mfma_f32_16x16x32_bf16 v[20:23], a[116:119], v[88:91], v[20:23]
    v_mfma_f32_16x16x32_bf16 v[32:35], a[120:123], v[88:91], v[32:35]
    buffer_load_dwordx4 v[148:151], v1, s[16:19], s48 offen offset:2048 sc1
    v_mfma_f32_16x16x32_bf16 v[40:43], a[120:123], v[92:95], v[40:43]
    v_mfma_f32_16x16x32_bf16 v[44:47], a[124:127], v[92:95], v[44:47]
    v_mfma_f32_16x16x32_bf16 v[36:39], a[124:127], v[88:91], v[36:39]
    s_waitcnt lgkmcnt(0)
    v_mfma_f32_16x16x32_bf16 v[16:19], a[128:131], v[80:83], v[16:19]
    ds_read_b128 v[88:91], v2 offset:18432
    v_mfma_f32_16x16x32_bf16 v[24:27], a[128:131], v[84:87], v[24:27]
    buffer_load_dwordx4 v[152:155], v1, s[16:19], s48 offen offset:3072 sc1
    v_mfma_f32_16x16x32_bf16 v[28:31], a[132:135], v[84:87], v[28:31]
    s_sub_u32 s47, s36, 2
    ds_read_b128 v[92:95], v3 offset:18432
    s_cmp_lt_u32 s47, 16
    v_mfma_f32_16x16x32_bf16 v[20:23], a[132:135], v[80:83], v[20:23]
    s_cselect_b32 s48, 0x5000000, s52
    s_add_u32 s20, s84, s48
    s_addc_u32 s21, s85, 0
    v_mfma_f32_16x16x32_bf16 v[32:35], a[136:139], v[80:83], v[32:35]
    s_cmp_ge_i32 s47, 16
    s_cselect_b32 s20, s80, s20
    s_cselect_b32 s21, s81, s21
    v_mfma_f32_16x16x32_bf16 v[40:43], a[136:139], v[84:87], v[40:43]
    s_and_b32 s48, s47, 15
    s_lshl_b32 s48, s48, 1
    s_sub_u32 s48, s50, s48
    v_mfma_f32_16x16x32_bf16 v[44:47], a[140:143], v[84:87], v[44:47]
    s_lshl_b32 s46, s48, 10
    s_sub_u32 s46, s55, s46
    s_cmp_lt_u32 s47, 16
    v_mfma_f32_16x16x32_bf16 v[36:39], a[140:143], v[80:83], v[36:39]
    s_waitcnt lgkmcnt(0)
    s_cselect_b32 s46, s46, s52
    s_lshl_b32 s48, s48, 15
    v_mfma_f32_16x16x32_bf16 v[16:19], a[144:147], v[88:91], v[16:19]
    ds_read_b128 v[80:83], v2 offset:20480
    v_mfma_f32_16x16x32_bf16 v[24:27], a[144:147], v[92:95], v[24:27]
    v_mfma_f32_16x16x32_bf16 v[28:31], a[148:151], v[92:95], v[28:31]
    ds_read_b128 v[84:87], v3 offset:20480
    v_mfma_f32_16x16x32_bf16 v[20:23], a[148:151], v[88:91], v[20:23]
    v_mfma_f32_16x16x32_bf16 v[32:35], a[152:155], v[88:91], v[32:35]
    v_mfma_f32_16x16x32_bf16 v[40:43], a[152:155], v[92:95], v[40:43]
    v_mfma_f32_16x16x32_bf16 v[44:47], a[156:159], v[92:95], v[44:47]
    v_mfma_f32_16x16x32_bf16 v[36:39], a[156:159], v[88:91], v[36:39]
    s_waitcnt lgkmcnt(0)
    v_mfma_f32_16x16x32_bf16 v[16:19], a[160:163], v[80:83], v[16:19]
    ds_read_b128 v[88:91], v2 offset:22528
    v_mfma_f32_16x16x32_bf16 v[24:27], a[160:163], v[84:87], v[24:27]
    v_mfma_f32_16x16x32_bf16 v[28:31], a[164:167], v[84:87], v[28:31]
    ds_read_b128 v[92:95], v3 offset:22528
    v_mfma_f32_16x16x32_bf16 v[20:23], a[164:167], v[80:83], v[20:23]
    v_mfma_f32_16x16x32_bf16 v[32:35], a[168:171], v[80:83], v[32:35]
    v_mfma_f32_16x16x32_bf16 v[40:43], a[168:171], v[84:87], v[40:43]
    v_mfma_f32_16x16x32_bf16 v[44:47], a[172:175], v[84:87], v[44:47]
    v_mfma_f32_16x16x32_bf16 v[36:39], a[172:175], v[80:83], v[36:39]
    s_waitcnt lgkmcnt(0)
    v_mfma_f32_16x16x32_bf16 v[16:19], a[176:179], v[88:91], v[16:19]
    ds_read_b128 v[80:83], v2 offset:24576
    v_mfma_f32_16x16x32_bf16 v[24:27], a[176:179], v[92:95], v[24:27]
    v_mfma_f32_16x16x32_bf16 v[28:31], a[180:183], v[92:95], v[28:31]
    ds_read_b128 v[84:87], v3 offset:24576
    v_mfma_f32_16x16x32_bf16 v[20:23], a[180:183], v[88:91], v[20:23]
    v_mfma_f32_16x16x32_bf16 v[32:35], a[184:187], v[88:91], v[32:35]
    v_mfma_f32_16x16x32_bf16 v[40:43], a[184:187], v[92:95], v[40:43]
    v_mfma_f32_16x16x32_bf16 v[44:47], a[188:191], v[92:95], v[44:47]
    s_waitcnt vmcnt(3)
    v_cmp_ne_u32 vcc, 0, v96
    v_mfma_f32_16x16x32_bf16 v[36:39], a[188:191], v[88:91], v[36:39]
    s_waitcnt lgkmcnt(0)
    v_mfma_f32_16x16x32_bf16 v[16:19], a[192:195], v[80:83], v[16:19]
    s_cbranch_vccnz L_spin55
L_back56:
    ds_read_b128 v[88:91], v2 offset:26624
    s_barrier
    v_mfma_f32_16x16x32_bf16 v[24:27], a[192:195], v[84:87], v[24:27]
    buffer_load_dwordx4 v1, s[16:19], s42 offen offset:0 sc1 lds
    v_mfma_f32_16x16x32_bf16 v[28:31], a[196:199], v[84:87], v[28:31]
    ds_read_b128 v[92:95], v3 offset:26624
    v_mfma_f32_16x16x32_bf16 v[20:23], a[196:199], v[80:83], v[20:23]
    v_mfma_f32_16x16x32_bf16 v[32:35], a[200:203], v[80:83], v[32:35]
    v_mfma_f32_16x16x32_bf16 v[40:43], a[200:203], v[84:87], v[40:43]
    buffer_load_dwordx4 v1, s[16:19], s42 offen offset:1024 sc1 lds
    v_mfma_f32_16x16x32_bf16 v[44:47], a[204:207], v[84:87], v[44:47]
    v_mfma_f32_16x16x32_bf16 v[36:39], a[204:207], v[80:83], v[36:39]
    s_waitcnt lgkmcnt(0)
    v_mfma_f32_16x16x32_bf16 v[16:19], a[208:211], v[88:91], v[16:19]
    ds_read_b128 v[80:83], v2 offset:28672
    v_mfma_f32_16x16x32_bf16 v[24:27], a[208:211], v[92:95], v[24:27]
    buffer_load_dwordx4 v1, s[16:19], s42 offen offset:2048 sc1 lds
    v_mfma_f32_16x16x32_bf16 v[28:31], a[212:215], v[92:95], v[28:31]
    ds_read_b128 v[84:87], v3 offset:28672
    v_mfma_f32_16x16x32_bf16 v[20:23], a[212:215], v[88:91], v[20:23]
    v_mfma_f32_16x16x32_bf16 v[32:35], a[216:219], v[88:91], v[32:35]
    v_mfma_f32_16x16x32_bf16 v[40:43], a[216:219], v[92:95], v[40:43]
    buffer_load_dwordx4 v1, s[16:19], s42 offen offset:3072 sc1 lds
    v_mfma_f32_16x16x32_bf16 v[44:47], a[220:223], v[92:95], v[44:47]
    s_add_u32 m0, s88, 114688
    s_add_u32 s42, s41, 16384
    s_add_u32 s42, s42, s89
    v_mfma_f32_16x16x32_bf16 v[36:39], a[220:223], v[88:91], v[36:39]
    s_waitcnt lgkmcnt(0)
    v_mfma_f32_16x16x32_bf16 v[16:19], a[224:227], v[80:83], v[16:19]
    ds_read_b128 v[88:91], v2 offset:30720
    v_mfma_f32_16x16x32_bf16 v[24:27], a[224:227], v[84:87], v[24:27]
    buffer_load_dwordx4 v1, s[16:19], s42 offen offset:0 sc1 lds
    v_mfma_f32_16x16x32_bf16 v[28:31], a[228:231], v[84:87], v[28:31]
    ds_read_b128 v[92:95], v3 offset:30720
    v_mfma_f32_16x16x32_bf16 v[20:23], a[228:231], v[80:83], v[20:23]
    v_mfma_f32_16x16x32_bf16 v[32:35], a[232:235], v[80:83], v[32:35]
    s_waitcnt vmcnt(5)
    v_mfma_f32_16x16x32_bf16 v[128:131], v[104:107], v[140:143], v[128:131]
    v_mfma_f32_16x16x32_bf16 v[132:135], v[108:111], v[140:143], v[132:135]
    v_mfma_f32_16x16x32_bf16 v[128:131], v[104:107], v[144:147], v[128:131]
    v_mfma_f32_16x16x32_bf16 v[132:135], v[108:111], v[144:147], v[132:135]
    v_mfma_f32_16x16x32_bf16 v[128:131], v[104:107], v[148:151], v[128:131]
    v_mfma_f32_16x16x32_bf16 v[132:135], v[108:111], v[148:151], v[132:135]
    v_mfma_f32_16x16x32_bf16 v[128:131], v[104:107], v[152:155], v[128:131]
    v_mfma_f32_16x16x32_bf16 v[132:135], v[108:111], v[152:155], v[132:135]
    v_mfma_f32_16x16x32_bf16 v[40:43], a[232:235], v[84:87], v[40:43]
    buffer_load_dwordx4 v1, s[16:19], s42 offen offset:1024 sc1 lds
    v_mfma_f32_16x16x32_bf16 v[44:47], a[236:239], v[84:87], v[44:47]
    s_nop 0
    v_cvt_pk_bf16_f32 v140, v128, v129
    v_cvt_pk_bf16_f32 v141, v130, v131
    v_mfma_f32_16x16x32_bf16 v[36:39], a[236:239], v[80:83], v[36:39]
    s_waitcnt lgkmcnt(0)
    v_cvt_pk_bf16_f32 v142, v132, v133
    v_cvt_pk_bf16_f32 v143, v134, v135
    v_mfma_f32_16x16x32_bf16 v[16:19], a[240:243], v[88:91], v[16:19]
    ds_read_b128 v[80:83], v2 offset:32768
    v_mfma_f32_16x16x32_bf16 v[24:27], a[240:243], v[92:95], v[24:27]
    buffer_load_dwordx4 v1, s[16:19], s42 offen offset:2048 sc1 lds
    v_mfma_f32_16x16x32_bf16 v[28:31], a[244:247], v[92:95], v[28:31]
    ds_read_b128 v[84:87], v3 offset:32768
    v_mfma_f32_16x16x32_bf16 v[20:23], a[244:247], v[88:91], v[20:23]
    v_mfma_f32_16x16x32_bf16 v[32:35], a[248:251], v[88:91], v[32:35]
    buffer_store_dword v124, v124, s[16:19], s91 offen sc1
    v_mfma_f32_16x16x32_bf16 v[40:43], a[248:251], v[92:95], v[40:43]
    s_add_u32 s91, s91, 65536
    s_add_u32 s39, s91, -163840
    v_mfma_f32_16x16x32_bf16 v[44:47], a[252:255], v[92:95], v[44:47]
    v_mfma_f32_16x16x32_bf16 v[36:39], a[252:255], v[88:91], v[36:39]
    s_waitcnt lgkmcnt(0)
    v_mfma_f32_16x16x32_bf16 v[16:19], v[160:163], v[80:83], v[16:19]
    ds_read_b128 v[88:91], v2 offset:34816
    v_mfma_f32_16x16x32_bf16 v[24:27], v[160:163], v[84:87], v[24:27]
    buffer_store_dword v124, v124, s[16:19], s39 offen sc1
    v_mfma_f32_16x16x32_bf16 v[28:31], v[164:167], v[84:87], v[28:31]
    ds_read_b128 v[92:95], v3 offset:34816
    v_mfma_f32_16x16x32_bf16 v[20:23], v[164:167], v[80:83], v[20:23]
    v_mfma_f32_16x16x32_bf16 v[32:35], v[168:171], v[80:83], v[32:35]
    buffer_store_dwordx4 v[140:143], v9, s[20:23], s48 offen sc1
    v_mfma_f32_16x16x32_bf16 v[40:43], v[168:171], v[84:87], v[40:43]
    v_add_f32 v100, v128, v129
    v_mul_f32 v101, v128, v128
    v_mfma_f32_16x16x32_bf16 v[44:47], v[172:175], v[84:87], v[44:47]
    v_fmac_f32 v101, v129, v129
    v_add_f32 v100, v100, v130
    v_mfma_f32_16x16x32_bf16 v[36:39], v[172:175], v[80:83], v[36:39]
    s_waitcnt lgkmcnt(0)
    v_fmac_f32 v101, v130, v130
    v_add_f32 v100, v100, v131
    v_mfma_f32_16x16x32_bf16 v[16:19], v[176:179], v[88:91], v[16:19]
    ds_read_b128 v[80:83], v2 offset:36864
    v_fmac_f32 v101, v131, v131
    v_mfma_f32_16x16x32_bf16 v[24:27], v[176:179], v[92:95], v[24:27]
    v_add_f32 v100, v100, v132
    v_fmac_f32 v101, v132, v132
    v_mfma_f32_16x16x32_bf16 v[28:31], v[180:183], v[92:95], v[28:31]
    ds_read_b128 v[84:87], v3 offset:36864
    v_add_f32 v100, v100, v133
    v_mfma_f32_16x16x32_bf16 v[20:23], v[180:183], v[88:91], v[20:23]
    v_fmac_f32 v101, v133, v133
    v_add_f32 v100, v100, v134
    v_mfma_f32_16x16x32_bf16 v[32:35], v[184:187], v[88:91], v[32:35]
    v_fmac_f32 v101, v134, v134
    v_add_f32 v100, v100, v135
    v_mfma_f32_16x16x32_bf16 v[40:43], v[184:187], v[92:95], v[40:43]
    v_fmac_f32 v101, v135, v135
    v_mfma_f32_16x16x32_bf16 v[44:47], v[188:191], v[92:95], v[44:47]
    v_permlane16_swap_b32 v100, v101
    v_mfma_f32_16x16x32_bf16 v[36:39], v[188:191], v[88:91], v[36:39]
    s_waitcnt lgkmcnt(0)
    v_add_f32 v100, v100, v101
    v_mov_b32 v102, v100
    v_mfma_f32_16x16x32_bf16 v[16:19], v[192:195], v[80:83], v[16:19]
    ds_read_b128 v[88:91], v2 offset:38912
    v_mfma_f32_16x16x32_bf16 v[24:27], v[192:195], v[84:87], v[24:27]
    v_permlane32_swap_b32 v100, v102
    v_mfma_f32_16x16x32_bf16 v[28:31], v[196:199], v[84:87], v[28:31]
    ds_read_b128 v[92:95], v3 offset:38912
    v_add_f32 v100, v100, v102
    v_mfma_f32_16x16x32_bf16 v[20:23], v[196:199], v[80:83], v[20:23]
    ds_write_b32 v10, v100 offset:512
    v_mfma_f32_16x16x32_bf16 v[32:35], v[200:203], v[80:83], v[32:35]
    s_waitcnt vmcnt(19)
    v_mfma_f32_16x16x32_bf16 v[128:131], v[104:107], v[136:139], v[48:51]
    v_mfma_f32_16x16x32_bf16 v[132:135], v[108:111], v[136:139], v[52:55]
    v_mfma_f32_16x16x32_bf16 v[40:43], v[200:203], v[84:87], v[40:43]
    v_mfma_f32_16x16x32_bf16 v[44:47], v[204:207], v[84:87], v[44:47]
    s_add_u32 m0, s43, 126976
    s_add_u32 s42, s41, 28672
    v_mfma_f32_16x16x32_bf16 v[36:39], v[204:207], v[80:83], v[36:39]
    s_waitcnt lgkmcnt(1)
    v_mfma_f32_16x16x32_bf16 v[16:19], v[208:211], v[88:91], v[16:19]
    ds_read_b128 v[80:83], v2 offset:40960
    v_mfma_f32_16x16x32_bf16 v[24:27], v[208:211], v[92:95], v[24:27]
    buffer_load_dwordx4 v1, s[16:19], s42 offen offset:0 sc1 lds
    v_mfma_f32_16x16x32_bf16 v[28:31], v[212:215], v[92:95], v[28:31]
    ds_read_b128 v[84:87], v3 offset:40960
    v_mfma_f32_16x16x32_bf16 v[20:23], v[212:215], v[88:91], v[20:23]
    v_mfma_f32_16x16x32_bf16 v[32:35], v[216:219], v[88:91], v[32:35]
    v_mfma_f32_16x16x32_bf16 v[40:43], v[216:219], v[92:95], v[40:43]
    v_mfma_f32_16x16x32_bf16 v[44:47], v[220:223], v[92:95], v[44:47]
    buffer_load_dwordx4 v1, s[16:19], s42 offen offset:1024 sc1 lds
    v_mfma_f32_16x16x32_bf16 v[36:39], v[220:223], v[88:91], v[36:39]
    s_waitcnt lgkmcnt(0)
    v_mfma_f32_16x16x32_bf16 v[16:19], v[224:227], v[80:83], v[16:19]
    ds_read_b128 v[88:91], v2 offset:43008
    v_mfma_f32_16x16x32_bf16 v[24:27], v[224:227], v[84:87], v[24:27]
    v_mfma_f32_16x16x32_bf16 v[28:31], v[228:231], v[84:87], v[28:31]
    ds_read_b128 v[92:95], v3 offset:43008
    v_mfma_f32_16x16x32_bf16 v[20:23], v[228:231], v[80:83], v[20:23]
    buffer_load_dwordx4 v1, s[16:19], s42 offen offset:2048 sc1 lds
    v_mfma_f32_16x16x32_bf16 v[32:35], v[232:235], v[80:83], v[32:35]
    v_mfma_f32_16x16x32_bf16 v[40:43], v[232:235], v[84:87], v[40:43]
    v_mfma_f32_16x16x32_bf16 v[44:47], v[236:239], v[84:87], v[44:47]
    v_mfma_f32_16x16x32_bf16 v[36:39], v[236:239], v[80:83], v[36:39]
    s_waitcnt vmcnt(6) lgkmcnt(0)
    s_barrier
    v_mfma_f32_16x16x32_bf16 v[16:19], v[240:243], v[88:91], v[16:19]
    ds_read_b128 v[80:83], v4 offset:0
    v_mfma_f32_16x16x32_bf16 v[24:27], v[240:243], v[92:95], v[24:27]
    buffer_load_dwordx4 v1, s[16:19], s42 offen offset:3072 sc1 lds
    v_mfma_f32_16x16x32_bf16 v[28:31], v[244:247], v[92:95], v[28:31]
    s_add_u32 s45, s45, 65536
    ds_read_b128 v[84:87], v5 offset:0
    v_mfma_f32_16x16x32_bf16 v[20:23], v[244:247], v[88:91], v[20:23]
    v_mfma_f32_16x16x32_bf16 v[32:35], v[248:251], v[88:91], v[32:35]
    v_mfma_f32_16x16x32_bf16 v[40:43], v[248:251], v[92:95], v[40:43]
    v_mfma_f32_16x16x32_bf16 v[44:47], v[252:255], v[92:95], v[44:47]
    s_add_u32 s36, s36, 1
    v_mfma_f32_16x16x32_bf16 v[36:39], v[252:255], v[88:91], v[36:39]
    s_waitcnt lgkmcnt(0)
L_bf_b1:
    v_mfma_f32_16x16x32_bf16 v[48:51], a[0:3], v[80:83], v[112:115]
    s_sub_u32 s47, s45, 196608
    ds_read_b128 v[88:91], v4 offset:2048
    s_max_u32 s47, s47, 0x5500000
    v_mfma_f32_16x16x32_bf16 v[56:59], a[0:3], v[84:87], 0
    buffer_load_dword v13, v8, s[16:19], s47 offen sc1
    v_mfma_f32_16x16x32_bf16 v[60:63], a[4:7], v[84:87], 0
    s_and_b32 s38, s53, 0xffffffff
    ds_read_b128 v[92:95], v5 offset:2048
    s_cmp_lt_i32 s36, 1
    v_mfma_f32_16x16x32_bf16 v[52:55], a[4:7], v[80:83], v[116:119]
    s_cselect_b32 s38, 0x5e00000, s38
    v_mfma_f32_16x16x32_bf16 v[64:67], a[8:11], v[80:83], 0
    buffer_load_dwordx4 v[136:139], v1, s[16:19], s38 offen sc1
    v_mfma_f32_16x16x32_bf16 v[72:75], a[8:11], v[84:87], 0
    s_add_u32 s53, s53, 65536
    ds_read_b128 v[144:147], v11 offset:512
    s_and_b32 s44, s90, 0xffffffff
    v_mfma_f32_16x16x32_bf16 v[76:79], a[12:15], v[84:87], 0
    s_cmp_lt_i32 s36, 1
    s_cselect_b32 s44, 0x5e00000, s44
    s_xor_b32 s49, s44, 16384
    v_mfma_f32_16x16x32_bf16 v[68:71], a[12:15], v[80:83], 0
    s_waitcnt lgkmcnt(1)
    v_cvt_pk_bf16_f32 v24, v24, v25
    v_cvt_pk_bf16_f32 v25, v26, v27
    v_mfma_f32_16x16x32_bf16 v[48:51], a[16:19], v[88:91], v[48:51]
    ds_read_b128 v[80:83], v4 offset:4096
    v_cvt_pk_bf16_f32 v26, v28, v29
    v_mfma_f32_16x16x32_bf16 v[56:59], a[16:19], v[92:95], v[56:59]
    v_cvt_pk_bf16_f32 v27, v30, v31
    v_mfma_f32_16x16x32_bf16 v[60:63], a[20:23], v[92:95], v[60:63]
    s_waitcnt lgkmcnt(1)
    ds_read_b128 v[84:87], v5 offset:4096
    v_add_f32 v144, v144, v145
    v_mfma_f32_16x16x32_bf16 v[52:55], a[20:23], v[88:91], v[52:55]
    buffer_store_dwordx4 v[24:27], v1, s[16:19], s49 offen offset:0 sc1
    v_mfma_f32_16x16x32_bf16 v[64:67], a[24:27], v[88:91], v[64:67]
    s_xor_b32 s49, s44, 32768
    v_cvt_pk_bf16_f32 v32, v32, v33
    v_cvt_pk_bf16_f32 v33, v34, v35
    v_mfma_f32_16x16x32_bf16 v[72:75], a[24:27], v[92:95], v[72:75]
    v_cvt_pk_bf16_f32 v34, v36, v37
    v_cvt_pk_bf16_f32 v35, v38, v39
    v_mfma_f32_16x16x32_bf16 v[76:79], a[28:31], v[92:95], v[76:79]
    buffer_store_dwordx4 v[32:35], v1, s[16:19], s49 offen offset:1024 sc1
    v_mfma_f32_16x16x32_bf16 v[68:71], a[28:31], v[88:91], v[68:71]
    s_waitcnt lgkmcnt(0)
    v_add_f32 v146, v146, v147
    v_add_f32 v144, v144, v146
    v_mfma_f32_16x16x32_bf16 v[48:51], a[32:35], v[80:83], v[48:51]
    s_xor_b32 s49, s44, 49152
    ds_read_b128 v[88:91], v4 offset:6144
    v_cvt_pk_bf16_f32 v40, v40, v41
    v_mfma_f32_16x16x32_bf16 v[56:59], a[32:35], v[84:87], v[56:59]
    v_cvt_pk_bf16_f32 v41, v42, v43
    v_cvt_pk_bf16_f32 v42, v44, v45
    v_mfma_f32_16x16x32_bf16 v[60:63], a[36:39], v[84:87], v[60:63]
    ds_read_b128 v[92:95], v5 offset:6144
    v_cvt_pk_bf16_f32 v43, v46, v47
    v_mfma_f32_16x16x32_bf16 v[52:55], a[36:39], v[80:83], v[52:55]
    buffer_store_dwordx4 v[40:43], v1, s[16:19], s49 offen offset:2048 sc1
    v_mfma_f32_16x16x32_bf16 v[64:67], a[40:43], v[80:83], v[64:67]
    s_add_u32 s90, s90, 262144
    v_mfma_f32_16x16x32_bf16 v[72:75], a[40:43], v[84:87], v[72:75]
    v_mfma_f32_16x16x32_bf16 v[76:79], a[44:47], v[84:87], v[76:79]
    buffer_store_dword v144, v12, s[16:19], s46 offen sc1
    v_mfma_f32_16x16x32_bf16 v[68:71], a[44:47], v[80:83], v[68:71]
    s_waitcnt lgkmcnt(0)
    v_mfma_f32_16x16x32_bf16 v[48:51], a[48:51], v[88:91], v[48:51]
    s_add_u32 s98, s98, 262144
    ds_read_b128 v[80:83], v4 offset:8192
    s_min_i32 s98, s98, s96
    v_mfma_f32_16x16x32_bf16 v[56:59], a[48:51], v[92:95], v[56:59]
    s_and_b32 s41, s98, 0xffffffff
    s_add_u32 m0, s43, 0
    s_add_u32 s42, s41, 0
    v_mfma_f32_16x16x32_bf16 v[60:63], a[52:55], v[92:95], v[60:63]
    ds_read_b128 v[84:87], v5 offset:8192
    v_mfma_f32_16x16x32_bf16 v[52:55], a[52:55], v[88:91], v[52:55]
    v_mfma_f32_16x16x32_bf16 v[64:67], a[56:59], v[88:91], v[64:67]
    v_mfma_f32_16x16x32_bf16 v[72:75], a[56:59], v[92:95], v[72:75]
    v_mfma_f32_16x16x32_bf16 v[76:79], a[60:63], v[92:95], v[76:79]
    v_mfma_f32_16x16x32_bf16 v[68:71], a[60:63], v[88:91], v[68:71]
    s_waitcnt lgkmcnt(0)
    v_mfma_f32_16x16x32_bf16 v[48:51], a[64:67], v[80:83], v[48:51]
    ds_read_b128 v[88:91], v4 offset:10240
    v_mfma_f32_16x16x32_bf16 v[56:59], a[64:67], v[84:87], v[56:59]
    v_mfma_f32_16x16x32_bf16 v[60:63], a[68:71], v[84:87], v[60:63]
    ds_read_b128 v[92:95], v5 offset:10240
    v_mfma_f32_16x16x32_bf16 v[52:55], a[68:71], v[80:83], v[52:55]
    v_mfma_f32_16x16x32_bf16 v[64:67], a[72:75], v[80:83], v[64:67]
    v_mfma_f32_16x16x32_bf16 v[72:75], a[72:75], v[84:87], v[72:75]
    v_mfma_f32_16x16x32_bf16 v[76:79], a[76:79], v[84:87], v[76:79]
    v_mfma_f32_16x16x32_bf16 v[68:71], a[76:79], v[80:83], v[68:71]
    s_waitcnt lgkmcnt(0)
    v_mfma_f32_16x16x32_bf16 v[48:51], a[80:83], v[88:91], v[48:51]
    ds_read_b128 v[80:83], v4 offset:12288
    v_mfma_f32_16x16x32_bf16 v[56:59], a[80:83], v[92:95], v[56:59]
    v_mfma_f32_16x16x32_bf16 v[60:63], a[84:87], v[92:95], v[60:63]
    ds_read_b128 v[84:87], v5 offset:12288
    v_mfma_f32_16x16x32_bf16 v[52:55], a[84:87], v[88:91], v[52:55]
    v_mfma_f32_16x16x32_bf16 v[64:67], a[88:91], v[88:91], v[64:67]
    s_waitcnt vmcnt(5)
    v_cmp_ne_u32 vcc, 0, v13
    v_mfma_f32_16x16x32_bf16 v[72:75], a[88:91], v[92:95], v[72:75]
    v_mfma_f32_16x16x32_bf16 v[76:79], a[92:95], v[92:95], v[76:79]
    s_cbranch_vccnz L_spin57
L_back58:
    s_sub_u32 s48, s90, 524288
    s_and_b32 s48, s48, 0xffffffff
    v_mfma_f32_16x16x32_bf16 v[68:71], a[92:95], v[88:91], v[68:71]
    s_waitcnt lgkmcnt(0)
    s_cmp_lt_i32 s36, 2
    s_cselect_b32 s48, s52, s48
    v_mfma_f32_16x16x32_bf16 v[48:51], a[96:99], v[80:83], v[48:51]
    ds_read_b128 v[88:91], v4 offset:14336
    v_mfma_f32_16x16x32_bf16 v[56:59], a[96:99], v[84:87], v[56:59]
    buffer_load_dwordx4 v[140:143], v1, s[16:19], s48 offen offset:0 sc1
    v_mfma_f32_16x16x32_bf16 v[60:63], a[100:103], v[84:87], v[60:63]
    ds_read_b128 v[92:95], v5 offset:14336
    v_mfma_f32_16x16x32_bf16 v[52:55], a[100:103], v[80:83], v[52:55]
    v_mfma_f32_16x16x32_bf16 v[64:67], a[104:107], v[80:83], v[64:67]
    buffer_load_dword v96, v6, s[16:19], s45 offen sc1
    v_mfma_f32_16x16x32_bf16 v[72:75], a[104:107], v[84:87], v[72:75]
    v_mfma_f32_16x16x32_bf16 v[76:79], a[108:111], v[84:87], v[76:79]
    v_mfma_f32_16x16x32_bf16 v[68:71], a[108:111], v[80:83], v[68:71]
    s_waitcnt lgkmcnt(0)
    v_mfma_f32_16x16x32_bf16 v[48:51], a[112:115], v[88:91], v[48:51]
    ds_read_b128 v[80:83], v4 offset:16384
    v_mfma_f32_16x16x32_bf16 v[56:59], a[112:115], v[92:95], v[56:59]
    buffer_load_dwordx4 v[144:147], v1, s[16:19], s48 offen offset:1024 sc1
    v_mfma_f32_16x16x32_bf16 v[60:63], a[116:119], v[92:95], v[60:63]
    ds_read_b128 v[84:87], v5 offset:16384
    v_mfma_f32_16x16x32_bf16 v[52:55], a[116:119], v[88:91], v[52:55]
    v_mfma_f32_16x16x32_bf16 v[64:67], a[120:123], v[88:91], v[64:67]
    buffer_load_dwordx4 v[148:151], v1, s[16:19], s48 offen offset:2048 sc1
    v_mfma_f32_16x16x32_bf16 v[72:75], a[120:123], v[92:95], v[72:75]
    v_mfma_f32_16x16x32_bf16 v[76:79], a[124:127], v[92:95], v[76:79]
    v_mfma_f32_16x16x32_bf16 v[68:71], a[124:127], v[88:91], v[68:71]
    s_waitcnt lgkmcnt(0)
    v_mfma_f32_16x16x32_bf16 v[48:51], a[128:131], v[80:83], v[48:51]
    ds_read_b128 v[88:91], v4 offset:18432
    v_mfma_f32_16x16x32_bf16 v[56:59], a[128:131], v[84:87], v[56:59]
    buffer_load_dwordx4 v[152:155], v1, s[16:19], s48 offen offset:3072 sc1
    v_mfma_f32_16x16x32_bf16 v[60:63], a[132:135], v[84:87], v[60:63]
    s_sub_u32 s47, s36, 2
    ds_read_b128 v[92:95], v5 offset:18432
    s_cmp_lt_u32 s47, 16
    v_mfma_f32_16x16x32_bf16 v[52:55], a[132:135], v[80:83], v[52:55]
    s_cselect_b32 s48, 0x5000000, s52
    s_add_u32 s20, s84, s48
    s_addc_u32 s21, s85, 0
    v_mfma_f32_16x16x32_bf16 v[64:67], a[136:139], v[80:83], v[64:67]
    s_cmp_ge_i32 s47, 16
    s_cselect_b32 s20, s80, s20
    s_cselect_b32 s21, s81, s21
    v_mfma_f32_16x16x32_bf16 v[72:75], a[136:139], v[84:87], v[72:75]
    s_and_b32 s48, s47, 15
    s_lshl_b32 s48, s48, 1
    s_sub_u32 s48, s50, s48
    v_mfma_f32_16x16x32_bf16 v[76:79], a[140:143], v[84:87], v[76:79]
    s_lshl_b32 s46, s48, 10
    s_sub_u32 s46, s55, s46
    s_cmp_lt_u32 s47, 16
    v_mfma_f32_16x16x32_bf16 v[68:71], a[140:143], v[80:83], v[68:71]
    s_waitcnt lgkmcnt(0)
    s_cselect_b32 s46, s46, s52
    s_lshl_b32 s48, s48, 15
    v_mfma_f32_16x16x32_bf16 v[48:51], a[144:147], v[88:91], v[48:51]
    ds_read_b128 v[80:83], v4 offset:20480
    v_mfma_f32_16x16x32_bf16 v[56:59], a[144:147], v[92:95], v[56:59]
    v_mfma_f32_16x16x32_bf16 v[60:63], a[148:151], v[92:95], v[60:63]
    ds_read_b128 v[84:87], v5 offset:20480
    v_mfma_f32_16x16x32_bf16 v[52:55], a[148:151], v[88:91], v[52:55]
    v_mfma_f32_16x16x32_bf16 v[64:67], a[152:155], v[88:91], v[64:67]
    v_mfma_f32_16x16x32_bf16 v[72:75], a[152:155], v[92:95], v[72:75]
    v_mfma_f32_16x16x32_bf16 v[76:79], a[156:159], v[92:95], v[76:79]
    v_mfma_f32_16x16x32_bf16 v[68:71], a[156:159], v[88:91], v[68:71]
    s_waitcnt lgkmcnt(0)
    v_mfma_f32_16x16x32_bf16 v[48:51], a[160:163], v[80:83], v[48:51]
    ds_read_b128 v[88:91], v4 offset:22528
    v_mfma_f32_16x16x32_bf16 v[56:59], a[160:163], v[84:87], v[56:59]
    v_mfma_f32_16x16x32_bf16 v[60:63], a[164:167], v[84:87], v[60:63]
    ds_read_b128 v[92:95], v5 offset:22528
    v_mfma_f32_16x16x32_bf16 v[52:55], a[164:167], v[80:83], v[52:55]
    v_mfma_f32_16x16x32_bf16 v[64:67], a[168:171], v[80:83], v[64:67]
    v_mfma_f32_16x16x32_bf16 v[72:75], a[168:171], v[84:87], v[72:75]
    v_mfma_f32_16x16x32_bf16 v[76:79], a[172:175], v[84:87], v[76:79]
    v_mfma_f32_16x16x32_bf16 v[68:71], a[172:175], v[80:83], v[68:71]
    s_waitcnt lgkmcnt(0)
    v_mfma_f32_16x16x32_bf16 v[48:51], a[176:179], v[88:91], v[48:51]
    ds_read_b128 v[80:83], v4 offset:24576
    v_mfma_f32_16x16x32_bf16 v[56:59], a[176:179], v[92:95], v[56:59]
    v_mfma_f32_16x16x32_bf16 v[60:63], a[180:183], v[92:95], v[60:63]
    ds_read_b128 v[84:87], v5 offset:24576
    v_mfma_f32_16x16x32_bf16 v[52:55], a[180:183], v[88:91], v[52:55]
    v_mfma_f32_16x16x32_bf16 v[64:67], a[184:187], v[88:91], v[64:67]
    v_mfma_f32_16x16x32_bf16 v[72:75], a[184:187], v[92:95], v[72:75]
    v_mfma_f32_16x16x32_bf16 v[76:79], a[188:191], v[92:95], v[76:79]
    s_waitcnt vmcnt(3)
    v_cmp_ne_u32 vcc, 0, v96
    v_mfma_f32_16x16x32_bf16 v[68:71], a[188:191], v[88:91], v[68:71]
    s_waitcnt lgkmcnt(0)
    v_mfma_f32_16x16x32_bf16 v[48:51], a[192:195], v[80:83], v[48:51]
    s_cbranch_vccnz L_spin59
L_back60:
    ds_read_b128 v[88:91], v4 offset:26624
    s_barrier
    v_mfma_f32_16x16x32_bf16 v[56:59], a[192:195], v[84:87], v[56:59]
    buffer_load_dwordx4 v1, s[16:19], s42 offen offset:0 sc1 lds
    v_mfma_f32_16x16x32_bf16 v[60:63], a[196:199], v[84:87], v[60:63]
    ds_read_b128 v[92:95], v5 offset:26624
    v_mfma_f32_16x16x32_bf16 v[52:55], a[196:199], v[80:83], v[52:55]
    v_mfma_f32_16x16x32_bf16 v[64:67], a[200:203], v[80:83], v[64:67]
    v_mfma_f32_16x16x32_bf16 v[72:75], a[200:203], v[84:87], v[72:75]
    buffer_load_dwordx4 v1, s[16:19], s42 offen offset:1024 sc1 lds
    v_mfma_f32_16x16x32_bf16 v[76:79], a[204:207], v[84:87], v[76:79]
    v_mfma_f32_16x16x32_bf16 v[68:71], a[204:207], v[80:83], v[68:71]
    s_waitcnt lgkmcnt(0)
    v_mfma_f32_16x16x32_bf16 v[48:51], a[208:211], v[88:91], v[48:51]
    ds_read_b128 v[80:83], v4 offset:28672
    v_mfma_f32_16x16x32_bf16 v[56:59], a[208:211], v[92:95], v[56:59]
    buffer_load_dwordx4 v1, s[16:19], s42 offen offset:2048 sc1 lds
    v_mfma_f32_16x16x32_bf16 v[60:63], a[212:215], v[92:95], v[60:63]
    ds_read_b128 v[84:87], v5 offset:28672
    v_mfma_f32_16x16x32_bf16 v[52:55], a[212:215], v[88:91], v[52:55]
    v_mfma_f32_16x16x32_bf16 v[64:67], a[216:219], v[88:91], v[64:67]
    v_mfma_f32_16x16x32_bf16 v[72:75], a[216:219], v[92:95], v[72:75]
    buffer_load_dwordx4 v1, s[16:19], s42 offen offset:3072 sc1 lds
    v_mfma_f32_16x16x32_bf16 v[76:79], a[220:223], v[92:95], v[76:79]
    s_add_u32 m0, s88, 16384
    s_add_u32 s42, s41, 16384
    s_add_u32 s42, s42, s89
    v_mfma_f32_16x16x32_bf16 v[68:71], a[220:223], v[88:91], v[68:71]
    s_waitcnt lgkmcnt(0)
    v_mfma_f32_16x16x32_bf16 v[48:51], a[224:227], v[80:83], v[48:51]
    ds_read_b128 v[88:91], v4 offset:30720
    v_mfma_f32_16x16x32_bf16 v[56:59], a[224:227], v[84:87], v[56:59]
    buffer_load_dwordx4 v1, s[16:19], s42 offen offset:0 sc1 lds
    v_mfma_f32_16x16x32_bf16 v[60:63], a[228:231], v[84:87], v[60:63]
    ds_read_b128 v[92:95], v5 offset:30720
    v_mfma_f32_16x16x32_bf16 v[52:55], a[228:231], v[80:83], v[52:55]
    v_mfma_f32_16x16x32_bf16 v[64:67], a[232:235], v[80:83], v[64:67]
    s_waitcnt vmcnt(5)
    v_mfma_f32_16x16x32_bf16 v[128:131], v[104:107], v[140:143], v[128:131]
    v_mfma_f32_16x16x32_bf16 v[132:135], v[108:111], v[140:143], v[132:135]
    v_mfma_f32_16x16x32_bf16 v[128:131], v[104:107], v[144:147], v[128:131]
    v_mfma_f32_16x16x32_bf16 v[132:135], v[108:111], v[144:147], v[132:135]
    v_mfma_f32_16x16x32_bf16 v[128:131], v[104:107], v[148:151], v[128:131]
    v_mfma_f32_16x16x32_bf16 v[132:135], v[108:111], v[148:151], v[132:135]
    v_mfma_f32_16x16x32_bf16 v[128:131], v[104:107], v[152:155], v[128:131]
    v_mfma_f32_16x16x32_bf16 v[132:135], v[108:111], v[152:155], v[132:135]
    v_mfma_f32_16x16x32_bf16 v[72:75], a[232:235], v[84:87], v[72:75]
    buffer_load_dwordx4 v1, s[16:19], s42 offen offset:1024 sc1 lds
    v_mfma_f32_16x16x32_bf16 v[76:79], a[236:239], v[84:87], v[76:79]
    s_nop 0
    v_cvt_pk_bf16_f32 v140, v128, v129
    v_cvt_pk_bf16_f32 v141, v130, v131
    v_mfma_f32_16x16x32_bf16 v[68:71], a[236:239], v[80:83], v[68:71]
    s_waitcnt lgkmcnt(0)
    v_cvt_pk_bf16_f32 v142, v132, v133
    v_cvt_pk_bf16_f32 v143, v134, v135
    v_mfma_f32_16x16x32_bf16 v[48:51], a[240:243], v[88:91], v[48:51]
    ds_read_b128 v[80:83], v4 offset:32768
    v_mfma_f32_16x16x32_bf16 v[56:59], a[240:243], v[92:95], v[56:59]
    buffer_load_dwordx4 v1, s[16:19], s42 offen offset:2048 sc1 lds
    v_mfma_f32_16x16x32_bf16 v[60:63], a[244:247], v[92:95], v[60:63]
    ds_read_b128 v[84:87], v5 offset:32768
    v_mfma_f32_16x16x32_bf16 v[52:55], a[244:247], v[88:91], v[52:55]
    v_mfma_f32_16x16x32_bf16 v[64:67], a[248:251], v[88:91], v[64:67]
    buffer_store_dword v124, v124, s[16:19], s91 offen sc1
    v_mfma_f32_16x16x32_bf16 v[72:75], a[248:251], v[92:95], v[72:75]
    s_add_u32 s91, s91, 65536
    s_add_u32 s39, s91, -163840
    v_mfma_f32_16x16x32_bf16 v[76:79], a[252:255], v[92:95], v[76:79]
    v_mfma_f32_16x16x32_bf16 v[68:71], a[252:255], v[88:91], v[68:71]
    s_waitcnt lgkmcnt(0)
    v_mfma_f32_16x16x32_bf16 v[48:51], v[160:163], v[80:83], v[48:51]
    ds_read_b128 v[88:91], v4 offset:34816
    v_mfma_f32_16x16x32_bf16 v[56:59], v[160:163], v[84:87], v[56:59]
    buffer_store_dword v124, v124, s[16:19], s39 offen sc1
    v_mfma_f32_16x16x32_bf16 v[60:63], v[164:167], v[84:87], v[60:63]
    ds_read_b128 v[92:95], v5 offset:34816
    v_mfma_f32_16x16x32_bf16 v[52:55], v[164:167], v[80:83], v[52:55]
    v_mfma_f32_16x16x32_bf16 v[64:67], v[168:171], v[80:83], v[64:67]
    buffer_store_dwordx4 v[140:143], v9, s[20:23], s48 offen sc1
    v_mfma_f32_16x16x32_bf16 v[72:75], v[168:171], v[84:87], v[72:75]
    v_add_f32 v100, v128, v129
    v_mul_f32 v101, v128, v128
    v_mfma_f32_16x16x32_bf16 v[76:79], v[172:175], v[84:87], v[76:79]
    v_fmac_f32 v101, v129, v129
    v_add_f32 v100, v100, v130
    v_mfma_f32_16x16x32_bf16 v[68:71], v[172:175], v[80:83], v[68:71]
    s_waitcnt lgkmcnt(0)
    v_fmac_f32 v101, v130, v130
    v_add_f32 v100, v100, v131
    v_mfma_f32_16x16x32_bf16 v[48:51], v[176:179], v[88:91], v[48:51]
    ds_read_b128 v[80:83], v4 offset:36864
    v_fmac_f32 v101, v131, v131
    v_mfma_f32_16x16x32_bf16 v[56:59], v[176:179], v[92:95], v[56:59]
    v_add_f32 v100, v100, v132
    v_fmac_f32 v101, v132, v132
    v_mfma_f32_16x16x32_bf16 v[60:63], v[180:183], v[92:95], v[60:63]
    ds_read_b128 v[84:87], v5 offset:36864
    v_add_f32 v100, v100, v133
    v_mfma_f32_16x16x32_bf16 v[52:55], v[180:183], v[88:91], v[52:55]
    v_fmac_f32 v101, v133, v133
    v_add_f32 v100, v100, v134
    v_mfma_f32_16x16x32_bf16 v[64:67], v[184:187], v[88:91], v[64:67]
    v_fmac_f32 v101, v134, v134
    v_add_f32 v100, v100, v135
    v_mfma_f32_16x16x32_bf16 v[72:75], v[184:187], v[92:95], v[72:75]
    v_fmac_f32 v101, v135, v135
    v_mfma_f32_16x16x32_bf16 v[76:79], v[188:191], v[92:95], v[76:79]
    v_permlane16_swap_b32 v100, v101
    v_mfma_f32_16x16x32_bf16 v[68:71], v[188:191], v[88:91], v[68:71]
    s_waitcnt lgkmcnt(0)
    v_add_f32 v100, v100, v101
    v_mov_b32 v102, v100
    v_mfma_f32_16x16x32_bf16 v[48:51], v[192:195], v[80:83], v[48:51]
    ds_read_b128 v[88:91], v4 offset:38912
    v_mfma_f32_16x16x32_bf16 v[56:59], v[192:195], v[84:87], v[56:59]
    v_permlane32_swap_b32 v100, v102
    v_mfma_f32_16x16x32_bf16 v[60:63], v[196:199], v[84:87], v[60:63]
    ds_read_b128 v[92:95], v5 offset:38912
    v_add_f32 v100, v100, v102
    v_mfma_f32_16x16x32_bf16 v[52:55], v[196:199], v[80:83], v[52:55]
    ds_write_b32 v10, v100 offset:0
    v_mfma_f32_16x16x32_bf16 v[64:67], v[200:203], v[80:83], v[64:67]
    s_waitcnt vmcnt(19)
    v_mfma_f32_16x16x32_bf16 v[128:131], v[104:107], v[136:139], v[16:19]
    v_mfma_f32_16x16x32_bf16 v[132:135], v[108:111], v[136:139], v[20:23]
    v_mfma_f32_16x16x32_bf16 v[72:75], v[200:203], v[84:87], v[72:75]
    v_mfma_f32_16x16x32_bf16 v[76:79], v[204:207], v[84:87], v[76:79]
    s_add_u32 m0, s43, 28672
    s_add_u32 s42, s41, 28672
    v_mfma_f32_16x16x32_bf16 v[68:71], v[204:207], v[80:83], v[68:71]
    s_waitcnt lgkmcnt(1)
    v_mfma_f32_16x16x32_bf16 v[48:51], v[208:211], v[88:91], v[48:51]
    ds_read_b128 v[80:83], v4 offset:40960
    v_mfma_f32_16x16x32_bf16 v[56:59], v[208:211], v[92:95], v[56:59]
    buffer_load_dwordx4 v1, s[16:19], s42 offen offset:0 sc1 lds
    v_mfma_f32_16x16x32_bf16 v[60:63], v[212:215], v[92:95], v[60:63]
    ds_read_b128 v[84:87], v5 offset:40960
    v_mfma_f32_16x16x32_bf16 v[52:55], v[212:215], v[88:91], v[52:55]
    v_mfma_f32_16x16x32_bf16 v[64:67], v[216:219], v[88:91], v[64:67]
    v_mfma_f32_16x16x32_bf16 v[72:75], v[216:219], v[92:95], v[72:75]
    v_mfma_f32_16x16x32_bf16 v[76:79], v[220:223], v[92:95], v[76:79]
    buffer_load_dwordx4 v1, s[16:19], s42 offen offset:1024 sc1 lds
    v_mfma_f32_16x16x32_bf16 v[68:71], v[220:223], v[88:91], v[68:71]
    s_waitcnt lgkmcnt(0)
    v_mfma_f32_16x16x32_bf16 v[48:51], v[224:227], v[80:83], v[48:51]
    ds_read_b128 v[88:91], v4 offset:43008
    v_mfma_f32_16x16x32_bf16 v[56:59], v[224:227], v[84:87], v[56:59]
    v_mfma_f32_16x16x32_bf16 v[60:63], v[228:231], v[84:87], v[60:63]
    ds_read_b128 v[92:95], v5 offset:43008
    v_mfma_f32_16x16x32_bf16 v[52:55], v[228:231], v[80:83], v[52:55]
    buffer_load_dwordx4 v1, s[16:19], s42 offen offset:2048 sc1 lds
    v_mfma_f32_16x16x32_bf16 v[64:67], v[232:235], v[80:83], v[64:67]
    v_mfma_f32_16x16x32_bf16 v[72:75], v[232:235], v[84:87], v[72:75]
    v_mfma_f32_16x16x32_bf16 v[76:79], v[236:239], v[84:87], v[76:79]
    v_mfma_f32_16x16x32_bf16 v[68:71], v[236:239], v[80:83], v[68:71]
    s_waitcnt vmcnt(6) lgkmcnt(0)
    s_barrier
    v_mfma_f32_16x16x32_bf16 v[48:51], v[240:243], v[88:91], v[48:51]
    ds_read_b128 v[80:83], v2 offset:0
    v_mfma_f32_16x16x32_bf16 v[56:59], v[240:243], v[92:95], v[56:59]
    buffer_load_dwordx4 v1, s[16:19], s42 offen offset:3072 sc1 lds
    v_mfma_f32_16x16x32_bf16 v[60:63], v[244:247], v[92:95], v[60:63]
    s_add_u32 s45, s45, 65536
    ds_read_b128 v[84:87], v3 offset:0
    v_mfma_f32_16x16x32_bf16 v[52:55], v[244:247], v[88:91], v[52:55]
    v_mfma_f32_16x16x32_bf16 v[64:67], v[248:251], v[88:91], v[64:67]
    v_mfma_f32_16x16x32_bf16 v[72:75], v[248:251], v[92:95], v[72:75]
    v_mfma_f32_16x16x32_bf16 v[76:79], v[252:255], v[92:95], v[76:79]
    s_add_u32 s36, s36, 1
    v_mfma_f32_16x16x32_bf16 v[68:71], v[252:255], v[88:91], v[68:71]
    s_waitcnt lgkmcnt(0)
    s_cmp_lt_u32 s36, 32
    s_cbranch_scc1 L_bf_b0
    s_nop 7
    s_sub_u32 s47, s45, 196608
    s_max_u32 s47, s47, 0x5500000
    buffer_load_dword v13, v8, s[16:19], s47 offen sc1
    s_and_b32 s38, s53, 0xffffffff
    s_cmp_lt_i32 s36, 1
    s_cselect_b32 s38, 0x5e00000, s38
    buffer_load_dwordx4 v[136:139], v1, s[16:19], s38 offen sc1
    s_add_u32 s53, s53, 65536
    s_and_b32 s44, s90, 0xffffffff
    s_cmp_lt_i32 s36, 1
    s_cselect_b32 s44, 0x5e00000, s44
    s_xor_b32 s49, s44, 16384
    v_cvt_pk_bf16_f32 v56, v56, v57
    v_cvt_pk_bf16_f32 v57, v58, v59
    v_cvt_pk_bf16_f32 v58, v60, v61
    v_cvt_pk_bf16_f32 v59, v62, v63
    v_min_u32 v56, -2, v56
    v_min_u32 v57, -2, v57
    v_min_u32 v58, -2, v58
    v_min_u32 v59, -2, v59
    buffer_store_dwordx4 v[56:59], v1, s[16:19], s49 offen offset:0 sc1
    s_xor_b32 s49, s44, 32768
    v_cvt_pk_bf16_f32 v64, v64, v65
    v_cvt_pk_bf16_f32 v65, v66, v67
    v_cvt_pk_bf16_f32 v66, v68, v69
    v_cvt_pk_bf16_f32 v67, v70, v71
    v_min_u32 v64, -2, v64
    v_min_u32 v65, -2, v65
    v_min_u32 v66, -2, v66
    v_min_u32 v67, -2, v67
    buffer_store_dwordx4 v[64:67], v1, s[16:19], s49 offen offset:1024 sc1
    s_xor_b32 s49, s44, 49152
    v_cvt_pk_bf16_f32 v72, v72, v73
    v_cvt_pk_bf16_f32 v73, v74, v75
    v_cvt_pk_bf16_f32 v74, v76, v77
    v_cvt_pk_bf16_f32 v75, v78, v79
    v_min_u32 v72, -2, v72
    v_min_u32 v73, -2, v73
    v_min_u32 v74, -2, v74
    v_min_u32 v75, -2, v75
    buffer_store_dwordx4 v[72:75], v1, s[16:19], s49 offen offset:2048 sc1
    s_add_u32 s90, s90, 262144
    s_waitcnt vmcnt(4)
    v_cmp_ne_u32 vcc, 0, v13
    s_cbranch_vccnz L_spin61
L_back62:
    s_barrier
    s_sub_u32 s48, s90, 524288
    s_and_b32 s48, s48, 0xffffffff
    s_cmp_lt_i32 s36, 2
    s_cselect_b32 s48, s52, s48
    buffer_load_dwordx4 v[140:143], v1, s[16:19], s48 offen offset:0 sc1
    buffer_load_dwordx4 v[144:147], v1, s[16:19], s48 offen offset:1024 sc1
    buffer_load_dwordx4 v[148:151], v1, s[16:19], s48 offen offset:2048 sc1
    buffer_load_dwordx4 v[152:155], v1, s[16:19], s48 offen offset:3072 sc1
    s_sub_u32 s47, s36, 2
    s_cmp_lt_u32 s47, 16
    s_cselect_b32 s48, 0x5000000, s52
    s_add_u32 s20, s84, s48
    s_addc_u32 s21, s85, 0
    s_cmp_ge_i32 s47, 16
    s_cselect_b32 s20, s80, s20
    s_cselect_b32 s21, s81, s21
    s_and_b32 s48, s47, 15
    s_lshl_b32 s48, s48, 1
    s_sub_u32 s48, s50, s48
    s_lshl_b32 s46, s48, 10
    s_sub_u32 s46, s55, s46
    s_cmp_lt_u32 s47, 16
    s_cselect_b32 s46, s46, s52
    s_lshl_b32 s48, s48, 15
    s_waitcnt vmcnt(7)
    v_mfma_f32_16x16x32_bf16 v[48:51], v[104:107], v[136:139], v[48:51]
    v_mfma_f32_16x16x32_bf16 v[52:55], v[108:111], v[136:139], v[52:55]
    s_waitcnt vmcnt(4)
    buffer_load_dwordx4 v[160:163], v1, s[16:19], s44 offen offset:0 sc1
    buffer_load_dwordx4 v[164:167], v1, s[16:19], s44 offen offset:1024 sc1
    buffer_load_dwordx4 v[168:171], v1, s[16:19], s44 offen offset:2048 sc1
    buffer_load_dwordx4 v[172:175], v1, s[16:19], s44 offen offset:3072 sc1
    s_waitcnt vmcnt(4)
    v_mfma_f32_16x16x32_bf16 v[128:131], v[104:107], v[140:143], v[128:131]
    v_mfma_f32_16x16x32_bf16 v[132:135], v[108:111], v[140:143], v[132:135]
    v_mfma_f32_16x16x32_bf16 v[128:131], v[104:107], v[144:147], v[128:131]
    v_mfma_f32_16x16x32_bf16 v[132:135], v[108:111], v[144:147], v[132:135]
    v_mfma_f32_16x16x32_bf16 v[128:131], v[104:107], v[148:151], v[128:131]
    v_mfma_f32_16x16x32_bf16 v[132:135], v[108:111], v[148:151], v[132:135]
    v_mfma_f32_16x16x32_bf16 v[128:131], v[104:107], v[152:155], v[128:131]
    v_mfma_f32_16x16x32_bf16 v[132:135], v[108:111], v[152:155], v[132:135]
    s_nop 5
    v_cvt_pk_bf16_f32 v140, v128, v129
    v_cvt_pk_bf16_f32 v141, v130, v131
    v_cvt_pk_bf16_f32 v142, v132, v133
    v_cvt_pk_bf16_f32 v143, v134, v135
    s_waitcnt vmcnt(0)
    v_max3_u32 v176, v160, v161, v162
    v_max3_u32 v177, v163, v164, v165
    v_max3_u32 v178, v166, v167, v168
    v_max3_u32 v179, v169, v170, v171
    v_max3_u32 v180, v172, v173, v174
    v_max3_u32 v176, v176, v177, v178
    v_max3_u32 v179, v179, v180, v175
    v_max_u32 v176, v176, v179
    v_cmp_eq_u32 vcc, -1, v176
    s_cbranch_vccnz L_gspin63
L_gback64:
    buffer_store_dwordx4 v[140:143], v9, s[20:23], s48 offen sc1
    v_mfma_f32_16x16x32_bf16 v[48:51], v[104:107], v[160:163], v[48:51]
    v_mfma_f32_16x16x32_bf16 v[52:55], v[108:111], v[160:163], v[52:55]
    v_mfma_f32_16x16x32_bf16 v[48:51], v[104:107], v[164:167], v[48:51]
    v_mfma_f32_16x16x32_bf16 v[52:55], v[108:111], v[164:167], v[52:55]
    v_mfma_f32_16x16x32_bf16 v[48:51], v[104:107], v[168:171], v[48:51]
    v_mfma_f32_16x16x32_bf16 v[52:55], v[108:111], v[168:171], v[52:55]
    v_mfma_f32_16x16x32_bf16 v[48:51], v[104:107], v[172:175], v[48:51]
    v_mfma_f32_16x16x32_bf16 v[52:55], v[108:111], v[172:175], v[52:55]
    s_sub_u32 s48, s48, 65536
    s_nop 4
    v_cvt_pk_bf16_f32 v160, v48, v49
    v_cvt_pk_bf16_f32 v161, v50, v51
    v_cvt_pk_bf16_f32 v162, v52, v53
    v_cvt_pk_bf16_f32 v163, v54, v55
    buffer_store_dwordx4 v[160:163], v9, s[20:23], s48 offen sc1
    s_waitcnt vmcnt(0)
    s_endpgm
L_spin46:
    s_mov_b32 s40, 0x20000
L_spin46_l:
    buffer_load_dword v8, v124, s[20:23], 0 offen sc1
    s_sub_u32 s40, s40, 1
    s_waitcnt vmcnt(0)
    v_cmp_eq_u32 vcc, v124, v8
    s_cbranch_scc1 L_back47
    s_cbranch_vccz L_back47
    s_sleep 8
    s_branch L_spin46_l
L_spin49:
    s_mov_b32 s40, 0x20000
L_spin49_l:
    buffer_load_dword v80, v124, s[20:23], 0 offen sc1
    s_sub_u32 s40, s40, 1
    s_waitcnt vmcnt(0)
    v_cmp_eq_u32 vcc, v124, v80
    s_cbranch_scc1 L_back50
    s_cbranch_vccz L_back50
    s_sleep 8
    s_branch L_spin49_l
L_spin51:
    s_mov_b32 s40, 0x20000
L_spin51_l:
    buffer_load_dword v96, v6, s[16:19], s45 offen sc1
    s_sub_u32 s40, s40, 1
    s_waitcnt vmcnt(0)
    v_cmp_ne_u32 vcc, 0, v96
    s_cbranch_scc1 L_back52
    s_cbranch_vccz L_back52
    s_sleep 2
    s_branch L_spin51_l
L_spin53:
    s_mov_b32 s40, 0x20000
L_spin53_l:
    buffer_load_dword v13, v8, s[16:19], s47 offen sc1
    s_sub_u32 s40, s40, 1
    s_waitcnt vmcnt(0)
    v_cmp_ne_u32 vcc, 0, v13
    s_cbranch_scc1 L_back54
    s_cbranch_vccz L_back54
    s_sleep 2
    s_branch L_spin53_l
L_spin55:
    s_mov_b32 s40, 0x20000
L_spin55_l:
    buffer_load_dword v96, v6, s[16:19], s45 offen sc1
    s_sub_u32 s40, s40, 1
    s_waitcnt vmcnt(0)
    v_cmp_ne_u32 vcc, 0, v96
    s_cbranch_scc1 L_back56
    s_cbranch_vccz L_back56
    s_sleep 2
    s_branch L_spin55_l
L_spin57:
    s_mov_b32 s40, 0x20000
L_spin57_l:
    buffer_load_dword v13, v8, s[16:19], s47 offen sc1
    s_sub_u32 s40, s40, 1
    s_waitcnt vmcnt(0)
    v_cmp_ne_u32 vcc, 0, v13
    s_cbranch_scc1 L_back58
    s_cbranch_vccz L_back58
    s_sleep 2
    s_branch L_spin57_l
L_spin59:
    s_mov_b32 s40, 0x20000
L_spin59_l:
    buffer_load_dword v96, v6, s[16:19], s45 offen sc1
    s_sub_u32 s40, s40, 1
    s_waitcnt vmcnt(0)
    v_cmp_ne_u32 vcc, 0, v96
    s_cbranch_scc1 L_back60
    s_cbranch_vccz L_back60
    s_sleep 2
    s_branch L_spin59_l
L_spin61:
    s_mov_b32 s40, 0x20000
L_spin61_l:
    buffer_load_dword v13, v8, s[16:19], s47 offen sc1
    s_sub_u32 s40, s40, 1
    s_waitcnt vmcnt(0)
    v_cmp_ne_u32 vcc, 0, v13
    s_cbranch_scc1 L_back62
    s_cbranch_vccz L_back62
    s_sleep 2
    s_branch L_spin61_l
L_gspin63:
    s_mov_b32 s40, 0x20000
L_gspin63_l:
    buffer_load_dwordx4 v[160:163], v1, s[16:19], s44 offen offset:0 sc1
    buffer_load_dwordx4 v[164:167], v1, s[16:19], s44 offen offset:1024 sc1
    buffer_load_dwordx4 v[168:171], v1, s[16:19], s44 offen offset:2048 sc1
    buffer_load_dwordx4 v[172:175], v1, s[16:19], s44 offen offset:3072 sc1
    s_sub_u32 s40, s40, 1
    s_waitcnt vmcnt(0)
    v_max3_u32 v176, v160, v161, v162
    v_max3_u32 v177, v163, v164, v165
    v_max3_u32 v178, v166, v167, v168
    v_max3_u32 v179, v169, v170, v171
    v_max3_u32 v180, v172, v173, v174
    v_max3_u32 v176, v176, v177, v178
    v_max3_u32 v179, v179, v180, v175
    v_max_u32 v176, v176, v179
    v_cmp_eq_u32 vcc, -1, v176
    s_cbranch_scc1 L_gback64
    s_cbranch_vccz L_gback64
    s_sleep 2
    s_branch L_gspin63_l
L_role_60:
    s_sub_u32 s35, s34, 44
    s_barrier
    s_add_u32 s12, s72, 0x400000
    s_addc_u32 s13, s73, 0
    s_mov_b32 s14, 0x300000
    s_mov_b32 s15, 0x00020000
    s_sub_u32 s37, s35, 12
    s_lshl2_add_u32 s37, s37, s33
    s_lshl2_add_u32 s37, s37, s32
    s_lshl_b32 s37, s37, 13
    v_lshlrev_b32 v6, 7, v0
    buffer_load_dword v240, v6, s[12:15], s37 offen
    s_add_u32 s37, s37, 1048576
    buffer_load_dword v241, v6, s[12:15], s37 offen
    s_add_u32 s37, s37, 1048576
    buffer_load_dword v242, v6, s[12:15], s37 offen
    s_add_u32 s37, s37, 1048576
    s_lshr_b32 s51, s35, 2
    s_and_b32 s87, s35, 3
    s_mul_i32 s54, s51, 1441792
    s_lshl_b32 s37, s87, 9
    s_add_u32 s54, s54, s37
    s_mov_b32 s12, s76
    s_mov_b32 s13, s77
    s_mov_b32 s14, 0x700000
    s_mov_b32 s15, 0x00020000
    s_mov_b32 s39, 2048
    v_lshrrev_b32 v64, 3, v0
    v_lshlrev_b32 v65, 2, v0
    v_and_b32 v65, 64, v65
    v_and_b32 v66, 0x70, v1
    v_xor_b32 v65, v65, v66
    v_mad_u32_u24 v48, v64, s39, v65
    v_add_u32 v49, 16384, v48
    v_add_u32 v50, 128, v48
    v_add_u32 v51, 16512, v48
    v_add_u32 v52, 256, v48
    v_add_u32 v53, 16640, v48
    v_add_u32 v54, 384, v48
    v_add_u32 v55, 16768, v48
    s_mul_i32 s38, s32, 32768
    s_add_u32 s54, s54, s38
    s_lshl_b32 s42, s32, 11
    s_add_u32 m0, s42, 0
    s_nop 0
    buffer_load_dwordx4 v48, s[12:15], s54 offen lds
    s_add_u32 m0, s42, 1024
    s_nop 0
    buffer_load_dwordx4 v49, s[12:15], s54 offen lds
    s_add_u32 m0, s42, 8192
    s_nop 0
    buffer_load_dwordx4 v50, s[12:15], s54 offen lds
    s_add_u32 m0, s42, 9216
    s_nop 0
    buffer_load_dwordx4 v51, s[12:15], s54 offen lds
    s_add_u32 m0, s42, 16384
    s_nop 0
    buffer_load_dwordx4 v52, s[12:15], s54 offen lds
    s_add_u32 m0, s42, 17408
    s_nop 0
    buffer_load_dwordx4 v53, s[12:15], s54 offen lds
    s_add_u32 m0, s42, 24576
    s_nop 0
    buffer_load_dwordx4 v54, s[12:15], s54 offen lds
    s_add_u32 m0, s42, 25600
    s_nop 0
    buffer_load_dwordx4 v55, s[12:15], s54 offen lds
    s_add_u32 s54, s54, 131072
    s_add_u32 m0, s42, 32768
    s_nop 0
    buffer_load_dwordx4 v48, s[12:15], s54 offen lds
    s_add_u32 m0, s42, 33792
    s_nop 0
    buffer_load_dwordx4 v49, s[12:15], s54 offen lds
    s_add_u32 m0, s42, 40960
    s_nop 0
    buffer_load_dwordx4 v50, s[12:15], s54 offen lds
    s_add_u32 m0, s42, 41984
    s_nop 0
    buffer_load_dwordx4 v51, s[12:15], s54 offen lds
    s_add_u32 m0, s42, 49152
    s_nop 0
    buffer_load_dwordx4 v52, s[12:15], s54 offen lds
    s_add_u32 m0, s42, 50176
    s_nop 0
    buffer_load_dwordx4 v53, s[12:15], s54 offen lds
    s_add_u32 m0, s42, 57344
    s_nop 0
    buffer_load_dwordx4 v54, s[12:15], s54 offen lds
    s_add_u32 m0, s42, 58368
    s_nop 0
    buffer_load_dwordx4 v55, s[12:15], s54 offen lds
    s_add_u32 s54, s54, 131072
    s_add_u32 m0, s42, 65536
    s_nop 0
    buffer_load_dwordx4 v48, s[12:15], s54 offen lds
    s_add_u32 m0, s42, 66560
    s_nop 0
    buffer_load_dwordx4 v49, s[12:15], s54 offen lds
    s_add_u32 m0, s42, 73728
    s_nop 0
    buffer_load_dwordx4 v50, s[12:15], s54 offen lds
    s_add_u32 m0, s42, 74752
    s_nop 0
    buffer_load_dwordx4 v51, s[12:15], s54 offen lds
    s_add_u32 m0, s42, 81920
    s_nop 0
    buffer_load_dwordx4 v52, s[12:15], s54 offen lds
    s_add_u32 m0, s42, 82944
    s_nop 0
    buffer_load_dwordx4 v53, s[12:15], s54 offen lds
    s_add_u32 m0, s42, 90112
    s_nop 0
    buffer_load_dwordx4 v54, s[12:15], s54 offen lds
    s_add_u32 m0, s42, 91136
    s_nop 0
    buffer_load_dwordx4 v55, s[12:15], s54 offen lds
    s_add_u32 s54, s54, 131072
    s_add_u32 m0, s42, 98304
    s_nop 0
    buffer_load_dwordx4 v48, s[12:15], s54 offen lds
    s_add_u32 m0, s42, 99328
    s_nop 0
    buffer_load_dwordx4 v49, s[12:15], s54 offen lds
    s_add_u32 m0, s42, 106496
    s_nop 0
    buffer_load_dwordx4 v50, s[12:15], s54 offen lds
    s_add_u32 m0, s42, 107520
    s_nop 0
    buffer_load_dwordx4 v51, s[12:15], s54 offen lds
    s_add_u32 m0, s42, 114688
    s_nop 0
    buffer_load_dwordx4 v52, s[12:15], s54 offen lds
    s_add_u32 m0, s42, 115712
    s_nop 0
    buffer_load_dwordx4 v53, s[12:15], s54 offen lds
    s_add_u32 m0, s42, 122880
    s_nop 0
    buffer_load_dwordx4 v54, s[12:15], s54 offen lds
    s_add_u32 m0, s42, 123904
    s_nop 0
    buffer_load_dwordx4 v55, s[12:15], s54 offen lds
    s_add_u32 s54, s54, 131072
    v_lshrrev_b32 v64, 4, v0
    v_bfe_u32 v65, v0, 2, 2
    v_lshl_add_u32 v64, v64, 3, v65
    v_lshlrev_b32 v64, 7, v64
    v_lshrrev_b32 v65, 1, v65
    v_lshl_add_u32 v64, v65, 6, v64
    v_and_b32 v65, 3, v0
    v_lshl_add_u32 v64, v65, 4, v64
    s_lshl_b32 s37, s32, 13
    s_and_b32 s38, s51, 2
    s_lshl_b32 s38, s38, 5
    s_xor_b32 s38, s38, 0
    s_add_u32 s37, s37, s38
    v_xor_b32 v56, s37, v64
    s_lshl_b32 s37, s32, 13
    s_and_b32 s38, s51, 2
    s_lshl_b32 s38, s38, 5
    s_xor_b32 s38, s38, 8
    s_add_u32 s37, s37, s38
    v_xor_b32 v57, s37, v64
    s_lshl_b32 s37, s32, 13
    s_and_b32 s38, s51, 2
    s_lshl_b32 s38, s38, 5
    s_xor_b32 s38, s38, 64
    s_add_u32 s37, s37, s38
    v_xor_b32 v58, s37, v64
    s_lshl_b32 s37, s32, 13
    s_and_b32 s38, s51, 2
    s_lshl_b32 s38, s38, 5
    s_xor_b32 s38, s38, 72
    s_add_u32 s37, s37, s38
    v_xor_b32 v59, s37, v64
    s_and_b32 s39, s51, 1
    s_lshl_b32 s37, s39, 10
    v_add_u32 v2, s37, v1
    v_xor_b32 v3, 1024, v2
    v_add_u32 v4, 98304, v2
    v_add_u32 v5, 98304, v3
    s_mul_i32 s38, s51, 11*43
    s_lshr_b32 s38, s38, 7
    s_add_u32 s38, s38, 24
    s_lshl_b32 s37, s33, 6
    s_add_u32 s37, s37, s38
    s_lshl_b32 s37, s37, 7
    v_lshl_add_u32 v6, v0, 7, s37
    s_cmp_eq_u32 s32, 0
    s_cselect_b32 s37, 6, 0
    v_cmp_le_u32 vcc, s37, v0
    s_nop 1
    v_cndmask_b32 v6, v6, 2.0, vcc
    s_mul_i32 s43, s32, 4096
    s_mul_i32 s88, s32, 3072
    s_sub_u32 s89, s88, s43
    s_mul_i32 s41, s33, 8388608
    s_add_u32 s41, s41, 0x1000000
    s_mul_i32 s37, s51, 45056
    s_add_u32 s41, s41, s37
    s_add_u32 s41, s41, s43
    s_mul_i32 s90, s33, 8388608
    s_add_u32 s90, s90, 0x2fc0000
    s_lshl_b32 s37, s87, 16
    s_add_u32 s90, s90, s37
    s_lshl_b32 s37, s32, 12
    s_add_u32 s90, s90, s37
    s_and_b32 s37, s51, 3
    s_lshl_b32 s37, s37, 14
    s_add_u32 s90, s90, s37
    v_add_u32 v60, 0, v56
    v_add_u32 v61, 0, v57
    v_add_u32 v62, 0, v58
    v_add_u32 v63, 0, v59
    s_waitcnt vmcnt(24)
    s_barrier
    ds_read_b64_tr_b16 a[0:1], v60 offset:0
    ds_read_b64_tr_b16 a[2:3], v60 offset:512
    ds_read_b64_tr_b16 a[4:5], v61 offset:0
    ds_read_b64_tr_b16 a[6:7], v61 offset:512
    ds_read_b64_tr_b16 a[8:9], v62 offset:0
    ds_read_b64_tr_b16 a[10:11], v62 offset:512
    ds_read_b64_tr_b16 a[12:13], v63 offset:0
    ds_read_b64_tr_b16 a[14:15], v63 offset:512
    ds_read_b64_tr_b16 a[16:17], v60 offset:4096
    ds_read_b64_tr_b16 a[18:19], v60 offset:4608
    ds_read_b64_tr_b16 a[20:21], v61 offset:4096
    ds_read_b64_tr_b16 a[22:23], v61 offset:4608
    ds_read_b64_tr_b16 a[24:25], v62 offset:4096
    ds_read_b64_tr_b16 a[26:27], v62 offset:4608
    ds_read_b64_tr_b16 a[28:29], v63 offset:4096
    ds_read_b64_tr_b16 a[30:31], v63 offset:4608
    s_add_u32 m0, s42, 131072
    s_nop 0
    buffer_load_dwordx4 v48, s[12:15], s54 offen lds
    s_add_u32 m0, s42, 132096
    s_nop 0
    buffer_load_dwordx4 v49, s[12:15], s54 offen lds
    s_add_u32 m0, s42, 139264
    s_nop 0
    buffer_load_dwordx4 v50, s[12:15], s54 offen lds
    s_add_u32 m0, s42, 140288
    s_nop 0
    buffer_load_dwordx4 v51, s[12:15], s54 offen lds
    s_add_u32 m0, s42, 147456
    s_nop 0
    buffer_load_dwordx4 v52, s[12:15], s54 offen lds
    s_add_u32 m0, s42, 148480
    s_nop 0
    buffer_load_dwordx4 v53, s[12:15], s54 offen lds
    s_add_u32 m0, s42, 155648
    s_nop 0
    buffer_load_dwordx4 v54, s[12:15], s54 offen lds
    s_add_u32 m0, s42, 156672
    s_nop 0
    buffer_load_dwordx4 v55, s[12:15], s54 offen lds
    s_add_u32 s54, s54, 131072
    s_waitcnt lgkmcnt(0)
    v_add_u32 v60, 32768, v56
    v_add_u32 v61, 32768, v57
    v_add_u32 v62, 32768, v58
    v_add_u32 v63, 32768, v59
    s_waitcnt vmcnt(24)
    s_barrier
    ds_read_b64_tr_b16 a[32:33], v60 offset:0
    ds_read_b64_tr_b16 a[34:35], v60 offset:512
    ds_read_b64_tr_b16 a[36:37], v61 offset:0
    ds_read_b64_tr_b16 a[38:39], v61 offset:512
    ds_read_b64_tr_b16 a[40:41], v62 offset:0
    ds_read_b64_tr_b16 a[42:43], v62 offset:512
    ds_read_b64_tr_b16 a[44:45], v63 offset:0
    ds_read_b64_tr_b16 a[46:47], v63 offset:512
    ds_read_b64_tr_b16 a[48:49], v60 offset:4096
    ds_read_b64_tr_b16 a[50:51], v60 offset:4608
    ds_read_b64_tr_b16 a[52:53], v61 offset:4096
    ds_read_b64_tr_b16 a[54:55], v61 offset:4608
    ds_read_b64_tr_b16 a[56:57], v62 offset:4096
    ds_read_b64_tr_b16 a[58:59], v62 offset:4608
    ds_read_b64_tr_b16 a[60:61], v63 offset:4096
    ds_read_b64_tr_b16 a[62:63], v63 offset:4608
    s_add_u32 m0, s42, 0
    s_nop 0
    buffer_load_dwordx4 v48, s[12:15], s54 offen lds
    s_add_u32 m0, s42, 1024
    s_nop 0
    buffer_load_dwordx4 v49, s[12:15], s54 offen lds
    s_add_u32 m0, s42, 8192
    s_nop 0
    buffer_load_dwordx4 v50, s[12:15], s54 offen lds
    s_add_u32 m0, s42, 9216
    s_nop 0
    buffer_load_dwordx4 v51, s[12:15], s54 offen lds
    s_add_u32 m0, s42, 16384
    s_nop 0
    buffer_load_dwordx4 v52, s[12:15], s54 offen lds
    s_add_u32 m0, s42, 17408
    s_nop 0
    buffer_load_dwordx4 v53, s[12:15], s54 offen lds
    s_add_u32 m0, s42, 24576
    s_nop 0
    buffer_load_dwordx4 v54, s[12:15], s54 offen lds
    s_add_u32 m0, s42, 25600
    s_nop 0
    buffer_load_dwordx4 v55, s[12:15], s54 offen lds
    s_add_u32 s54, s54, 131072
    s_waitcnt lgkmcnt(0)
    v_add_u32 v60, 65536, v56
    v_add_u32 v61, 65536, v57
    v_add_u32 v62, 65536, v58
    v_add_u32 v63, 65536, v59
    s_waitcnt vmcnt(24)
    s_barrier
    ds_read_b64_tr_b16 a[64:65], v60 offset:0
    ds_read_b64_tr_b16 a[66:67], v60 offset:512
    ds_read_b64_tr_b16 a[68:69], v61 offset:0
    ds_read_b64_tr_b16 a[70:71], v61 offset:512
    ds_read_b64_tr_b16 a[72:73], v62 offset:0
    ds_read_b64_tr_b16 a[74:75], v62 offset:512
    ds_read_b64_tr_b16 a[76:77], v63 offset:0
    ds_read_b64_tr_b16 a[78:79], v63 offset:512
    ds_read_b64_tr_b16 a[80:81], v60 offset:4096
    ds_read_b64_tr_b16 a[82:83], v60 offset:4608
    ds_read_b64_tr_b16 a[84:85], v61 offset:4096
    ds_read_b64_tr_b16 a[86:87], v61 offset:4608
    ds_read_b64_tr_b16 a[88:89], v62 offset:4096
    ds_read_b64_tr_b16 a[90:91], v62 offset:4608
    ds_read_b64_tr_b16 a[92:93], v63 offset:4096
    ds_read_b64_tr_b16 a[94:95], v63 offset:4608
    s_add_u32 m0, s42, 32768
    s_nop 0
    buffer_load_dwordx4 v48, s[12:15], s54 offen lds
    s_add_u32 m0, s42, 33792
    s_nop 0
    buffer_load_dwordx4 v49, s[12:15], s54 offen lds
    s_add_u32 m0, s42, 40960
    s_nop 0
    buffer_load_dwordx4 v50, s[12:15], s54 offen lds
    s_add_u32 m0, s42, 41984
    s_nop 0
    buffer_load_dwordx4 v51, s[12:15], s54 offen lds
    s_add_u32 m0, s42, 49152
    s_nop 0
    buffer_load_dwordx4 v52, s[12:15], s54 offen lds
    s_add_u32 m0, s42, 50176
    s_nop 0
    buffer_load_dwordx4 v53, s[12:15], s54 offen lds
    s_add_u32 m0, s42, 57344
    s_nop 0
    buffer_load_dwordx4 v54, s[12:15], s54 offen lds
    s_add_u32 m0, s42, 58368
    s_nop 0
    buffer_load_dwordx4 v55, s[12:15], s54 offen lds
    s_add_u32 s54, s54, 131072
    s_waitcnt lgkmcnt(0)
    v_add_u32 v60, 98304, v56
    v_add_u32 v61, 98304, v57
    v_add_u32 v62, 98304, v58
    v_add_u32 v63, 98304, v59
    s_waitcnt vmcnt(24)
    s_barrier
    ds_read_b64_tr_b16 a[96:97], v60 offset:0
    ds_read_b64_tr_b16 a[98:99], v60 offset:512
    ds_read_b64_tr_b16 a[100:101], v61 offset:0
    ds_read_b64_tr_b16 a[102:103], v61 offset:512
    ds_read_b64_tr_b16 a[104:105], v62 offset:0
    ds_read_b64_tr_b16 a[106:107], v62 offset:512
    ds_read_b64_tr_b16 a[108:109], v63 offset:0
    ds_read_b64_tr_b16 a[110:111], v63 offset:512
    ds_read_b64_tr_b16 a[112:113], v60 offset:4096
    ds_read_b64_tr_b16 a[114:115], v60 offset:4608
    ds_read_b64_tr_b16 a[116:117], v61 offset:4096
    ds_read_b64_tr_b16 a[118:119], v61 offset:4608
    ds_read_b64_tr_b16 a[120:121], v62 offset:4096
    ds_read_b64_tr_b16 a[122:123], v62 offset:4608
    ds_read_b64_tr_b16 a[124:125], v63 offset:4096
    ds_read_b64_tr_b16 a[126:127], v63 offset:4608
    s_add_u32 m0, s42, 65536
    s_nop 0
    buffer_load_dwordx4 v48, s[12:15], s54 offen lds
    s_add_u32 m0, s42, 66560
    s_nop 0
    buffer_load_dwordx4 v49, s[12:15], s54 offen lds
    s_add_u32 m0, s42, 73728
    s_nop 0
    buffer_load_dwordx4 v50, s[12:15], s54 offen lds
    s_add_u32 m0, s42, 74752
    s_nop 0
    buffer_load_dwordx4 v51, s[12:15], s54 offen lds
    s_add_u32 m0, s42, 81920
    s_nop 0
    buffer_load_dwordx4 v52, s[12:15], s54 offen lds
    s_add_u32 m0, s42, 82944
    s_nop 0
    buffer_load_dwordx4 v53, s[12:15], s54 offen lds
    s_add_u32 m0, s42, 90112
    s_nop 0
    buffer_load_dwordx4 v54, s[12:15], s54 offen lds
    s_add_u32 m0, s42, 91136
    s_nop 0
    buffer_load_dwordx4 v55, s[12:15], s54 offen lds
    s_add_u32 s54, s54, 131072
    s_waitcnt lgkmcnt(0)
    v_add_u32 v60, 131072, v56
    v_add_u32 v61, 131072, v57
    v_add_u32 v62, 131072, v58
    v_add_u32 v63, 131072, v59
    s_waitcnt vmcnt(24)
    s_barrier
    ds_read_b64_tr_b16 a[128:129], v60 offset:0
    ds_read_b64_tr_b16 a[130:131], v60 offset:512
    ds_read_b64_tr_b16 a[132:133], v61 offset:0
    ds_read_b64_tr_b16 a[134:135], v61 offset:512
    ds_read_b64_tr_b16 a[136:137], v62 offset:0
    ds_read_b64_tr_b16 a[138:139], v62 offset:512
    ds_read_b64_tr_b16 a[140:141], v63 offset:0
    ds_read_b64_tr_b16 a[142:143], v63 offset:512
    ds_read_b64_tr_b16 a[144:145], v60 offset:4096
    ds_read_b64_tr_b16 a[146:147], v60 offset:4608
    ds_read_b64_tr_b16 a[148:149], v61 offset:4096
    ds_read_b64_tr_b16 a[150:151], v61 offset:4608
    ds_read_b64_tr_b16 a[152:153], v62 offset:4096
    ds_read_b64_tr_b16 a[154:155], v62 offset:4608
    ds_read_b64_tr_b16 a[156:157], v63 offset:4096
    ds_read_b64_tr_b16 a[158:159], v63 offset:4608
    s_add_u32 m0, s42, 98304
    s_nop 0
    buffer_load_dwordx4 v48, s[12:15], s54 offen lds
    s_add_u32 m0, s42, 99328
    s_nop 0
    buffer_load_dwordx4 v49, s[12:15], s54 offen lds
    s_add_u32 m0, s42, 106496
    s_nop 0
    buffer_load_dwordx4 v50, s[12:15], s54 offen lds
    s_add_u32 m0, s42, 107520
    s_nop 0
    buffer_load_dwordx4 v51, s[12:15], s54 offen lds
    s_add_u32 m0, s42, 114688
    s_nop 0
    buffer_load_dwordx4 v52, s[12:15], s54 offen lds
    s_add_u32 m0, s42, 115712
    s_nop 0
    buffer_load_dwordx4 v53, s[12:15], s54 offen lds
    s_add_u32 m0, s42, 122880
    s_nop 0
    buffer_load_dwordx4 v54, s[12:15], s54 offen lds
    s_add_u32 m0, s42, 123904
    s_nop 0
    buffer_load_dwordx4 v55, s[12:15], s54 offen lds
    s_add_u32 s54, s54, 131072
    s_waitcnt lgkmcnt(0)
    v_add_u32 v60, 0, v56
    v_add_u32 v61, 0, v57
    v_add_u32 v62, 0, v58
    v_add_u32 v63, 0, v59
    s_waitcnt vmcnt(24)
    s_barrier
    ds_read_b64_tr_b16 a[160:161], v60 offset:0
    ds_read_b64_tr_b16 a[162:163], v60 offset:512
    ds_read_b64_tr_b16 a[164:165], v61 offset:0
    ds_read_b64_tr_b16 a[166:167], v61 offset:512
    ds_read_b64_tr_b16 a[168:169], v62 offset:0
    ds_read_b64_tr_b16 a[170:171], v62 offset:512
    ds_read_b64_tr_b16 a[172:173], v63 offset:0
    ds_read_b64_tr_b16 a[174:175], v63 offset:512
    ds_read_b64_tr_b16 a[176:177], v60 offset:4096
    ds_read_b64_tr_b16 a[178:179], v60 offset:4608
    ds_read_b64_tr_b16 a[180:181], v61 offset:4096
    ds_read_b64_tr_b16 a[182:183], v61 offset:4608
    ds_read_b64_tr_b16 a[184:185], v62 offset:4096
    ds_read_b64_tr_b16 a[186:187], v62 offset:4608
    ds_read_b64_tr_b16 a[188:189], v63 offset:4096
    ds_read_b64_tr_b16 a[190:191], v63 offset:4608
    s_add_u32 m0, s42, 131072
    s_nop 0
    buffer_load_dwordx4 v48, s[12:15], s54 offen lds
    s_add_u32 m0, s42, 132096
    s_nop 0
    buffer_load_dwordx4 v49, s[12:15], s54 offen lds
    s_add_u32 m0, s42, 139264
    s_nop 0
    buffer_load_dwordx4 v50, s[12:15], s54 offen lds
    s_add_u32 m0, s42, 140288
    s_nop 0
    buffer_load_dwordx4 v51, s[12:15], s54 offen lds
    s_add_u32 m0, s42, 147456
    s_nop 0
    buffer_load_dwordx4 v52, s[12:15], s54 offen lds
    s_add_u32 m0, s42, 148480
    s_nop 0
    buffer_load_dwordx4 v53, s[12:15], s54 offen lds
    s_add_u32 m0, s42, 155648
    s_nop 0
    buffer_load_dwordx4 v54, s[12:15], s54 offen lds
    s_add_u32 m0, s42, 156672
    s_nop 0
    buffer_load_dwordx4 v55, s[12:15], s54 offen lds
    s_add_u32 s54, s54, 131072
    s_waitcnt lgkmcnt(0)
    v_add_u32 v60, 32768, v56
    v_add_u32 v61, 32768, v57
    v_add_u32 v62, 32768, v58
    v_add_u32 v63, 32768, v59
    s_waitcnt vmcnt(24)
    s_barrier
    ds_read_b64_tr_b16 a[192:193], v60 offset:0
    ds_read_b64_tr_b16 a[194:195], v60 offset:512
    ds_read_b64_tr_b16 a[196:197], v61 offset:0
    ds_read_b64_tr_b16 a[198:199], v61 offset:512
    ds_read_b64_tr_b16 a[200:201], v62 offset:0
    ds_read_b64_tr_b16 a[202:203], v62 offset:512
    ds_read_b64_tr_b16 a[204:205], v63 offset:0
    ds_read_b64_tr_b16 a[206:207], v63 offset:512
    ds_read_b64_tr_b16 a[208:209], v60 offset:4096
    ds_read_b64_tr_b16 a[210:211], v60 offset:4608
    ds_read_b64_tr_b16 a[212:213], v61 offset:4096
    ds_read_b64_tr_b16 a[214:215], v61 offset:4608
    ds_read_b64_tr_b16 a[216:217], v62 offset:4096
    ds_read_b64_tr_b16 a[218:219], v62 offset:4608
    ds_read_b64_tr_b16 a[220:221], v63 offset:4096
    ds_read_b64_tr_b16 a[222:223], v63 offset:4608
    s_add_u32 m0, s42, 0
    s_nop 0
    buffer_load_dwordx4 v48, s[12:15], s54 offen lds
    s_add_u32 m0, s42, 1024
    s_nop 0
    buffer_load_dwordx4 v49, s[12:15], s54 offen lds
    s_add_u32 m0, s42, 8192
    s_nop 0
    buffer_load_dwordx4 v50, s[12:15], s54 offen lds
    s_add_u32 m0, s42, 9216
    s_nop 0
    buffer_load_dwordx4 v51, s[12:15], s54 offen lds
    s_add_u32 m0, s42, 16384
    s_nop 0
    buffer_load_dwordx4 v52, s[12:15], s54 offen lds
    s_add_u32 m0, s42, 17408
    s_nop 0
    buffer_load_dwordx4 v53, s[12:15], s54 offen lds
    s_add_u32 m0, s42, 24576
    s_nop 0
    buffer_load_dwordx4 v54, s[12:15], s54 offen lds
    s_add_u32 m0, s42, 25600
    s_nop 0
    buffer_load_dwordx4 v55, s[12:15], s54 offen lds
    s_add_u32 s54, s54, 131072
    s_waitcnt lgkmcnt(0)
    v_add_u32 v60, 65536, v56
    v_add_u32 v61, 65536, v57
    v_add_u32 v62, 65536, v58
    v_add_u32 v63, 65536, v59
    s_waitcnt vmcnt(24)
    s_barrier
    ds_read_b64_tr_b16 a[224:225], v60 offset:0
    ds_read_b64_tr_b16 a[226:227], v60 offset:512
    ds_read_b64_tr_b16 a[228:229], v61 offset:0
    ds_read_b64_tr_b16 a[230:231], v61 offset:512
    ds_read_b64_tr_b16 a[232:233], v62 offset:0
    ds_read_b64_tr_b16 a[234:235], v62 offset:512
    ds_read_b64_tr_b16 a[236:237], v63 offset:0
    ds_read_b64_tr_b16 a[238:239], v63 offset:512
    ds_read_b64_tr_b16 a[240:241], v60 offset:4096
    ds_read_b64_tr_b16 a[242:243], v60 offset:4608
    ds_read_b64_tr_b16 a[244:245], v61 offset:4096
    ds_read_b64_tr_b16 a[246:247], v61 offset:4608
    ds_read_b64_tr_b16 a[248:249], v62 offset:4096
    ds_read_b64_tr_b16 a[250:251], v62 offset:4608
    ds_read_b64_tr_b16 a[252:253], v63 offset:4096
    ds_read_b64_tr_b16 a[254:255], v63 offset:4608
    s_add_u32 m0, s42, 32768
    s_nop 0
    buffer_load_dwordx4 v48, s[12:15], s54 offen lds
    s_add_u32 m0, s42, 33792
    s_nop 0
    buffer_load_dwordx4 v49, s[12:15], s54 offen lds
    s_add_u32 m0, s42, 40960
    s_nop 0
    buffer_load_dwordx4 v50, s[12:15], s54 offen lds
    s_add_u32 m0, s42, 41984
    s_nop 0
    buffer_load_dwordx4 v51, s[12:15], s54 offen lds
    s_add_u32 m0, s42, 49152
    s_nop 0
    buffer_load_dwordx4 v52, s[12:15], s54 offen lds
    s_add_u32 m0, s42, 50176
    s_nop 0
    buffer_load_dwordx4 v53, s[12:15], s54 offen lds
    s_add_u32 m0, s42, 57344
    s_nop 0
    buffer_load_dwordx4 v54, s[12:15], s54 offen lds
    s_add_u32 m0, s42, 58368
    s_nop 0
    buffer_load_dwordx4 v55, s[12:15], s54 offen lds
    s_add_u32 s54, s54, 131072
    s_waitcnt lgkmcnt(0)
    v_add_u32 v60, 98304, v56
    v_add_u32 v61, 98304, v57
    v_add_u32 v62, 98304, v58
    v_add_u32 v63, 98304, v59
    s_waitcnt vmcnt(24)
    s_barrier
    ds_read_b64_tr_b16 v[128:129], v60 offset:0
    ds_read_b64_tr_b16 v[130:131], v60 offset:512
    ds_read_b64_tr_b16 v[132:133], v61 offset:0
    ds_read_b64_tr_b16 v[134:135], v61 offset:512
    ds_read_b64_tr_b16 v[136:137], v62 offset:0
    ds_read_b64_tr_b16 v[138:139], v62 offset:512
    ds_read_b64_tr_b16 v[140:141], v63 offset:0
    ds_read_b64_tr_b16 v[142:143], v63 offset:512
    ds_read_b64_tr_b16 v[144:145], v60 offset:4096
    ds_read_b64_tr_b16 v[146:147], v60 offset:4608
    ds_read_b64_tr_b16 v[148:149], v61 offset:4096
    ds_read_b64_tr_b16 v[150:151], v61 offset:4608
    ds_read_b64_tr_b16 v[152:153], v62 offset:4096
    ds_read_b64_tr_b16 v[154:155], v62 offset:4608
    ds_read_b64_tr_b16 v[156:157], v63 offset:4096
    ds_read_b64_tr_b16 v[158:159], v63 offset:4608
    s_waitcnt lgkmcnt(0)
    v_add_u32 v60, 131072, v56
    v_add_u32 v61, 131072, v57
    v_add_u32 v62, 131072, v58
    v_add_u32 v63, 131072, v59
    s_waitcnt vmcnt(16)
    s_barrier
    ds_read_b64_tr_b16 v[160:161], v60 offset:0
    ds_read_b64_tr_b16 v[162:163], v60 offset:512
    ds_read_b64_tr_b16 v[164:165], v61 offset:0
    ds_read_b64_tr_b16 v[166:167], v61 offset:512
    ds_read_b64_tr_b16 v[168:169], v62 offset:0
    ds_read_b64_tr_b16 v[170:171], v62 offset:512
    ds_read_b64_tr_b16 v[172:173], v63 offset:0
    ds_read_b64_tr_b16 v[174:175], v63 offset:512
    ds_read_b64_tr_b16 v[176:177], v60 offset:4096
    ds_read_b64_tr_b16 v[178:179], v60 offset:4608
    ds_read_b64_tr_b16 v[180:181], v61 offset:4096
    ds_read_b64_tr_b16 v[182:183], v61 offset:4608
    ds_read_b64_tr_b16 v[184:185], v62 offset:4096
    ds_read_b64_tr_b16 v[186:187], v62 offset:4608
    ds_read_b64_tr_b16 v[188:189], v63 offset:4096
    ds_read_b64_tr_b16 v[190:191], v63 offset:4608
    s_waitcnt lgkmcnt(0)
    v_add_u32 v60, 0, v56
    v_add_u32 v61, 0, v57
    v_add_u32 v62, 0, v58
    v_add_u32 v63, 0, v59
    s_waitcnt vmcnt(8)
    s_barrier
    ds_read_b64_tr_b16 v[192:193], v60 offset:0
    ds_read_b64_tr_b16 v[194:195], v60 offset:512
    ds_read_b64_tr_b16 v[196:197], v61 offset:0
    ds_read_b64_tr_b16 v[198:199], v61 offset:512
    ds_read_b64_tr_b16 v[200:201], v62 offset:0
    ds_read_b64_tr_b16 v[202:203], v62 offset:512
    ds_read_b64_tr_b16 v[204:205], v63 offset:0
    ds_read_b64_tr_b16 v[206:207], v63 offset:512
    ds_read_b64_tr_b16 v[208:209], v60 offset:4096
    ds_read_b64_tr_b16 v[210:211], v60 offset:4608
    ds_read_b64_tr_b16 v[212:213], v61 offset:4096
    ds_read_b64_tr_b16 v[214:215], v61 offset:4608
    ds_read_b64_tr_b16 v[216:217], v62 offset:4096
    ds_read_b64_tr_b16 v[218:219], v62 offset:4608
    ds_read_b64_tr_b16 v[220:221], v63 offset:4096
    ds_read_b64_tr_b16 v[222:223], v63 offset:4608
    s_waitcnt lgkmcnt(0)
    v_add_u32 v60, 32768, v56
    v_add_u32 v61, 32768, v57
    v_add_u32 v62, 32768, v58
    v_add_u32 v63, 32768, v59
    s_waitcnt vmcnt(0)
    s_barrier
    ds_read_b64_tr_b16 v[224:225], v60 offset:0
    ds_read_b64_tr_b16 v[226:227], v60 offset:512
    ds_read_b64_tr_b16 v[228:229], v61 offset:0
    ds_read_b64_tr_b16 v[230:231], v61 offset:512
    ds_read_b64_tr_b16 v[232:233], v62 offset:0
    ds_read_b64_tr_b16 v[234:235], v62 offset:512
    ds_read_b64_tr_b16 v[236:237], v63 offset:0
    ds_read_b64_tr_b16 v[238:239], v63 offset:512
    ds_read_b64_tr_b16 v[240:241], v60 offset:4096
    ds_read_b64_tr_b16 v[242:243], v60 offset:4608
    ds_read_b64_tr_b16 v[244:245], v61 offset:4096
    ds_read_b64_tr_b16 v[246:247], v61 offset:4608
    ds_read_b64_tr_b16 v[248:249], v62 offset:4096
    ds_read_b64_tr_b16 v[250:251], v62 offset:4608
    ds_read_b64_tr_b16 v[252:253], v63 offset:4096
    ds_read_b64_tr_b16 v[254:255], v63 offset:4608
    s_waitcnt lgkmcnt(0)
    s_barrier
    s_cmp_lg_u32 s32, 0
    s_cbranch_scc1 L_arv65
    s_add_u32 s20, s82, 0x80
    s_addc_u32 s21, s83, 0
    s_mov_b32 s22, 0x4
    s_mov_b32 s23, 0x00020000
    buffer_load_dword v80, v124, s[20:23], 0 offen sc1
    s_waitcnt vmcnt(0)
    v_cmp_eq_u32 vcc, v124, v80
    s_cbranch_vccnz L_spin66
L_back67:
L_arv65:
    s_add_u32 s96, s41, 8126464
    s_mov_b32 s98, s41
    s_mov_b32 s45, 0x5530000
    buffer_load_dword v96, v6, s[16:19], s45 offen sc1
    s_waitcnt vmcnt(0)
    v_cmp_ne_u32 vcc, 0, v96
    s_cbranch_vccnz L_spin68
L_back69:
    s_barrier
    s_add_u32 m0, s43, 0
    s_add_u32 s42, s41, 0
    buffer_load_dwordx4 v1, s[16:19], s42 offen offset:0 sc1 lds
    buffer_load_dwordx4 v1, s[16:19], s42 offen offset:1024 sc1 lds
    buffer_load_dwordx4 v1, s[16:19], s42 offen offset:2048 sc1 lds
    buffer_load_dwordx4 v1, s[16:19], s42 offen offset:3072 sc1 lds
    s_add_u32 m0, s43, 16384
    s_add_u32 s42, s41, 16384
    buffer_load_dwordx4 v1, s[16:19], s42 offen offset:0 sc1 lds
    buffer_load_dwordx4 v1, s[16:19], s42 offen offset:1024 sc1 lds
    buffer_load_dwordx4 v1, s[16:19], s42 offen offset:2048 sc1 lds
    buffer_load_dwordx4 v1, s[16:19], s42 offen offset:3072 sc1 lds
    s_add_u32 m0, s43, 32768
    s_add_u32 s42, s41, 32768
    buffer_load_dwordx4 v1, s[16:19], s42 offen offset:0 sc1 lds
    buffer_load_dwordx4 v1, s[16:19], s42 offen offset:1024 sc1 lds
    buffer_load_dwordx4 v1, s[16:19], s42 offen offset:2048 sc1 lds
    buffer_load_dwordx4 v1, s[16:19], s42 offen offset:3072 sc1 lds
    s_add_u32 s45, s45, 65536
    s_waitcnt vmcnt(0) lgkmcnt(0)
    s_barrier
    s_mov_b32 s52, 0x5e00000
    s_mov_b32 s46, 0x5e00000
    s_add_u32 s20, s84, 0x5e00000
    s_addc_u32 s21, s85, 0
    s_mov_b32 s22, 0x400000
    s_mov_b32 s23, 0x00020000
    ds_read_b128 v[80:83], v2 offset:0
    ds_read_b128 v[84:87], v3 offset:0
    s_mov_b32 s36, 0
    s_waitcnt lgkmcnt(0)
    s_nop 7
L_bs_b0:
    v_mfma_f32_16x16x32_bf16 v[16:19], a[0:3], v[80:83], 0
    s_and_b32 s44, s90, 0xffffffff
    ds_read_b128 v[88:91], v2 offset:2048
    s_cmp_lt_i32 s36, 1
    v_mfma_f32_16x16x32_bf16 v[24:27], a[0:3], v[84:87], 0
    s_cselect_b32 s44, 0x5e00000, s44
    s_xor_b32 s49, s44, 0
    v_cvt_pk_bf16_f32 v48, v48, v49
    v_mfma_f32_16x16x32_bf16 v[28:31], a[4:7], v[84:87], 0
    ds_read_b128 v[92:95], v3 offset:2048
    v_cvt_pk_bf16_f32 v49, v50, v51
    v_mfma_f32_16x16x32_bf16 v[20:23], a[4:7], v[80:83], 0
    v_cvt_pk_bf16_f32 v50, v52, v53
    v_cvt_pk_bf16_f32 v51, v54, v55
    v_mfma_f32_16x16x32_bf16 v[32:35], a[8:11], v[80:83], 0
    buffer_store_dwordx4 v[48:51], v1, s[16:19], s49 offen offset:3072 sc1
    v_mfma_f32_16x16x32_bf16 v[40:43], a[8:11], v[84:87], 0
    s_xor_b32 s49, s44, 16384
    v_cvt_pk_bf16_f32 v56, v56, v57
    v_cvt_pk_bf16_f32 v57, v58, v59
    v_mfma_f32_16x16x32_bf16 v[44:47], a[12:15], v[84:87], 0
    v_cvt_pk_bf16_f32 v58, v60, v61
    v_cvt_pk_bf16_f32 v59, v62, v63
    v_mfma_f32_16x16x32_bf16 v[36:39], a[12:15], v[80:83], 0
    s_waitcnt lgkmcnt(0)
    v_mfma_f32_16x16x32_bf16 v[16:19], a[16:19], v[88:91], v[16:19]
    ds_read_b128 v[80:83], v2 offset:4096
    v_mfma_f32_16x16x32_bf16 v[24:27], a[16:19], v[92:95], v[24:27]
    buffer_store_dwordx4 v[56:59], v1, s[16:19], s49 offen offset:3072 sc1
    v_mfma_f32_16x16x32_bf16 v[28:31], a[20:23], v[92:95], v[28:31]
    s_xor_b32 s49, s44, 32768
    ds_read_b128 v[84:87], v3 offset:4096
    v_cvt_pk_bf16_f32 v64, v64, v65
    v_mfma_f32_16x16x32_bf16 v[20:23], a[20:23], v[88:91], v[20:23]
    v_cvt_pk_bf16_f32 v65, v66, v67
    v_cvt_pk_bf16_f32 v66, v68, v69
    v_mfma_f32_16x16x32_bf16 v[32:35], a[24:27], v[88:91], v[32:35]
    v_cvt_pk_bf16_f32 v67, v70, v71
    v_mfma_f32_16x16x32_bf16 v[40:43], a[24:27], v[92:95], v[40:43]
    buffer_store_dwordx4 v[64:67], v1, s[16:19], s49 offen offset:3072 sc1
    v_mfma_f32_16x16x32_bf16 v[44:47], a[28:31], v[92:95], v[44:47]
    s_xor_b32 s49, s44, 49152
    v_cvt_pk_bf16_f32 v72, v72, v73
    v_cvt_pk_bf16_f32 v73, v74, v75
    v_mfma_f32_16x16x32_bf16 v[36:39], a[28:31], v[88:91], v[36:39]
    s_waitcnt lgkmcnt(0)
    v_cvt_pk_bf16_f32 v74, v76, v77
    v_cvt_pk_bf16_f32 v75, v78, v79
    v_mfma_f32_16x16x32_bf16 v[16:19], a[32:35], v[80:83], v[16:19]
    ds_read_b128 v[88:91], v2 offset:6144
    v_mfma_f32_16x16x32_bf16 v[24:27], a[32:35], v[84:87], v[24:27]
    buffer_store_dwordx4 v[72:75], v1, s[16:19], s49 offen offset:3072 sc1
    v_mfma_f32_16x16x32_bf16 v[28:31], a[36:39], v[84:87], v[28:31]
    s_add_u32 s90, s90, 262144
    ds_read_b128 v[92:95], v3 offset:6144
    v_mfma_f32_16x16x32_bf16 v[20:23], a[36:39], v[80:83], v[20:23]
    v_mfma_f32_16x16x32_bf16 v[32:35], a[40:43], v[80:83], v[32:35]
    v_mfma_f32_16x16x32_bf16 v[40:43], a[40:43], v[84:87], v[40:43]
    v_mfma_f32_16x16x32_bf16 v[44:47], a[44:47], v[84:87], v[44:47]
    v_mfma_f32_16x16x32_bf16 v[36:39], a[44:47], v[80:83], v[36:39]
    s_waitcnt lgkmcnt(0)
    v_mfma_f32_16x16x32_bf16 v[16:19], a[48:51], v[88:91], v[16:19]
    s_add_u32 s98, s98, 262144
    ds_read_b128 v[80:83], v2 offset:8192
    s_min_i32 s98, s98, s96
    v_mfma_f32_16x16x32_bf16 v[24:27], a[48:51], v[92:95], v[24:27]
    s_and_b32 s41, s98, 0xffffffff
    s_add_u32 m0, s43, 98304
    s_add_u32 s42, s41, 0
    v_mfma_f32_16x16x32_bf16 v[28:31], a[52:55], v[92:95], v[28:31]
    ds_read_b128 v[84:87], v3 offset:8192
    v_mfma_f32_16x16x32_bf16 v[20:23], a[52:55], v[88:91], v[20:23]
    v_mfma_f32_16x16x32_bf16 v[32:35], a[56:59], v[88:91], v[32:35]
    v_mfma_f32_16x16x32_bf16 v[40:43], a[56:59], v[92:95], v[40:43]
    v_mfma_f32_16x16x32_bf16 v[44:47], a[60:63], v[92:95], v[44:47]
    v_mfma_f32_16x16x32_bf16 v[36:39], a[60:63], v[88:91], v[36:39]
    s_waitcnt lgkmcnt(0)
    v_mfma_f32_16x16x32_bf16 v[16:19], a[64:67], v[80:83], v[16:19]
    ds_read_b128 v[88:91], v2 offset:10240
    v_mfma_f32_16x16x32_bf16 v[24:27], a[64:67], v[84:87], v[24:27]
    v_mfma_f32_16x16x32_bf16 v[28:31], a[68:71], v[84:87], v[28:31]
    ds_read_b128 v[92:95], v3 offset:10240
    v_mfma_f32_16x16x32_bf16 v[20:23], a[68:71], v[80:83], v[20:23]
    v_mfma_f32_16x16x32_bf16 v[32:35], a[72:75], v[80:83], v[32:35]
    v_mfma_f32_16x16x32_bf16 v[40:43], a[72:75], v[84:87], v[40:43]
    v_mfma_f32_16x16x32_bf16 v[44:47], a[76:79], v[84:87], v[44:47]
    v_mfma_f32_16x16x32_bf16 v[36:39], a[76:79], v[80:83], v[36:39]
    s_waitcnt lgkmcnt(0)
    v_mfma_f32_16x16x32_bf16 v[16:19], a[80:83], v[88:91], v[16:19]
    ds_read_b128 v[80:83], v2 offset:12288
    v_mfma_f32_16x16x32_bf16 v[24:27], a[80:83], v[92:95], v[24:27]
    v_mfma_f32_16x16x32_bf16 v[28:31], a[84:87], v[92:95], v[28:31]
    ds_read_b128 v[84:87], v3 offset:12288
    v_mfma_f32_16x16x32_bf16 v[20:23], a[84:87], v[88:91], v[20:23]
    v_mfma_f32_16x16x32_bf16 v[32:35], a[88:91], v[88:91], v[32:35]
    v_mfma_f32_16x16x32_bf16 v[40:43], a[88:91], v[92:95], v[40:43]
    v_mfma_f32_16x16x32_bf16 v[44:47], a[92:95], v[92:95], v[44:47]
    v_mfma_f32_16x16x32_bf16 v[36:39], a[92:95], v[88:91], v[36:39]
    s_waitcnt lgkmcnt(0)
    v_mfma_f32_16x16x32_bf16 v[16:19], a[96:99], v[80:83], v[16:19]
    ds_read_b128 v[88:91], v2 offset:14336
    v_mfma_f32_16x16x32_bf16 v[24:27], a[96:99], v[84:87], v[24:27]
    v_mfma_f32_16x16x32_bf16 v[28:31], a[100:103], v[84:87], v[28:31]
    ds_read_b128 v[92:95], v3 offset:14336
    v_mfma_f32_16x16x32_bf16 v[20:23], a[100:103], v[80:83], v[20:23]
    v_mfma_f32_16x16x32_bf16 v[32:35], a[104:107], v[80:83], v[32:35]
    v_mfma_f32_16x16x32_bf16 v[40:43], a[104:107], v[84:87], v[40:43]
    v_mfma_f32_16x16x32_bf16 v[44:47], a[108:111], v[84:87], v[44:47]
    v_mfma_f32_16x16x32_bf16 v[36:39], a[108:111], v[80:83], v[36:39]
    s_waitcnt lgkmcnt(0)
    v_mfma_f32_16x16x32_bf16 v[16:19], a[112:115], v[88:91], v[16:19]
    ds_read_b128 v[80:83], v2 offset:16384
    v_mfma_f32_16x16x32_bf16 v[24:27], a[112:115], v[92:95], v[24:27]
    v_mfma_f32_16x16x32_bf16 v[28:31], a[116:119], v[92:95], v[28:31]
    ds_read_b128 v[84:87], v3 offset:16384
    v_mfma_f32_16x16x32_bf16 v[20:23], a[116:119], v[88:91], v[20:23]
    v_mfma_f32_16x16x32_bf16 v[32:35], a[120:123], v[88:91], v[32:35]
    v_mfma_f32_16x16x32_bf16 v[40:43], a[120:123], v[92:95], v[40:43]
    v_mfma_f32_16x16x32_bf16 v[44:47], a[124:127], v[92:95], v[44:47]
    buffer_load_dword v96, v6, s[16:19], s45 offen sc1
    v_mfma_f32_16x16x32_bf16 v[36:39], a[124:127], v[88:91], v[36:39]
    s_waitcnt lgkmcnt(0)
    v_mfma_f32_16x16x32_bf16 v[16:19], a[128:131], v[80:83], v[16:19]
    ds_read_b128 v[88:91], v2 offset:18432
    v_mfma_f32_16x16x32_bf16 v[24:27], a[128:131], v[84:87], v[24:27]
    v_mfma_f32_16x16x32_bf16 v[28:31], a[132:135], v[84:87], v[28:31]
    ds_read_b128 v[92:95], v3 offset:18432
    v_mfma_f32_16x16x32_bf16 v[20:23], a[132:135], v[80:83], v[20:23]
    v_mfma_f32_16x16x32_bf16 v[32:35], a[136:139], v[80:83], v[32:35]
    v_mfma_f32_16x16x32_bf16 v[40:43], a[136:139], v[84:87], v[40:43]
    v_mfma_f32_16x16x32_bf16 v[44:47], a[140:143], v[84:87], v[44:47]
    v_mfma_f32_16x16x32_bf16 v[36:39], a[140:143], v[80:83], v[36:39]
    s_waitcnt lgkmcnt(0)
    v_mfma_f32_16x16x32_bf16 v[16:19], a[144:147], v[88:91], v[16:19]
    ds_read_b128 v[80:83], v2 offset:20480
    v_mfma_f32_16x16x32_bf16 v[24:27], a[144:147], v[92:95], v[24:27]
    v_mfma_f32_16x16x32_bf16 v[28:31], a[148:151], v[92:95], v[28:31]
    ds_read_b128 v[84:87], v3 offset:20480
    v_mfma_f32_16x16x32_bf16 v[20:23], a[148:151], v[88:91], v[20:23]
    v_mfma_f32_16x16x32_bf16 v[32:35], a[152:155], v[88:91], v[32:35]
    v_mfma_f32_16x16x32_bf16 v[40:43], a[152:155], v[92:95], v[40:43]
    v_mfma_f32_16x16x32_bf16 v[44:47], a[156:159], v[92:95], v[44:47]
    v_mfma_f32_16x16x32_bf16 v[36:39], a[156:159], v[88:91], v[36:39]
    s_waitcnt lgkmcnt(0)
    v_mfma_f32_16x16x32_bf16 v[16:19], a[160:163], v[80:83], v[16:19]
    ds_read_b128 v[88:91], v2 offset:22528
    v_mfma_f32_16x16x32_bf16 v[24:27], a[160:163], v[84:87], v[24:27]
    v_mfma_f32_16x16x32_bf16 v[28:31], a[164:167], v[84:87], v[28:31]
    ds_read_b128 v[92:95], v3 offset:22528
    v_mfma_f32_16x16x32_bf16 v[20:23], a[164:167], v[80:83], v[20:23]
    v_mfma_f32_16x16x32_bf16 v[32:35], a[168:171], v[80:83], v[32:35]
    v_mfma_f32_16x16x32_bf16 v[40:43], a[168:171], v[84:87], v[40:43]
    v_mfma_f32_16x16x32_bf16 v[44:47], a[172:175], v[84:87], v[44:47]
    v_mfma_f32_16x16x32_bf16 v[36:39], a[172:175], v[80:83], v[36:39]
    s_waitcnt lgkmcnt(0)
    v_mfma_f32_16x16x32_bf16 v[16:19], a[176:179], v[88:91], v[16:19]
    ds_read_b128 v[80:83], v2 offset:24576
    v_mfma_f32_16x16x32_bf16 v[24:27], a[176:179], v[92:95], v[24:27]
    v_mfma_f32_16x16x32_bf16 v[28:31], a[180:183], v[92:95], v[28:31]
    ds_read_b128 v[84:87], v3 offset:24576
    v_mfma_f32_16x16x32_bf16 v[20:23], a[180:183], v[88:91], v[20:23]
    v_mfma_f32_16x16x32_bf16 v[32:35], a[184:187], v[88:91], v[32:35]
    v_mfma_f32_16x16x32_bf16 v[40:43], a[184:187], v[92:95], v[40:43]
    v_mfma_f32_16x16x32_bf16 v[44:47], a[188:191], v[92:95], v[44:47]
    v_mfma_f32_16x16x32_bf16 v[36:39], a[188:191], v[88:91], v[36:39]
    s_waitcnt lgkmcnt(0)
    v_mfma_f32_16x16x32_bf16 v[16:19], a[192:195], v[80:83], v[16:19]
    ds_read_b128 v[88:91], v2 offset:26624
    v_mfma_f32_16x16x32_bf16 v[24:27], a[192:195], v[84:87], v[24:27]
    v_mfma_f32_16x16x32_bf16 v[28:31], a[196:199], v[84:87], v[28:31]
    ds_read_b128 v[92:95], v3 offset:26624
    v_mfma_f32_16x16x32_bf16 v[20:23], a[196:199], v[80:83], v[20:23]
    v_mfma_f32_16x16x32_bf16 v[32:35], a[200:203], v[80:83], v[32:35]
    v_mfma_f32_16x16x32_bf16 v[40:43], a[200:203], v[84:87], v[40:43]
    v_mfma_f32_16x16x32_bf16 v[44:47], a[204:207], v[84:87], v[44:47]
    v_mfma_f32_16x16x32_bf16 v[36:39], a[204:207], v[80:83], v[36:39]
    s_waitcnt lgkmcnt(0)
    v_mfma_f32_16x16x32_bf16 v[16:19], a[208:211], v[88:91], v[16:19]
    ds_read_b128 v[80:83], v2 offset:28672
    v_mfma_f32_16x16x32_bf16 v[24:27], a[208:211], v[92:95], v[24:27]
    v_mfma_f32_16x16x32_bf16 v[28:31], a[212:215], v[92:95], v[28:31]
    s_waitcnt vmcnt(0)
    ds_read_b128 v[84:87], v3 offset:28672
    v_cmp_ne_u32 vcc, 0, v96
    v_mfma_f32_16x16x32_bf16 v[20:23], a[212:215], v[88:91], v[20:23]
    v_mfma_f32_16x16x32_bf16 v[32:35], a[216:219], v[88:91], v[32:35]
    s_cbranch_vccnz L_spin70
L_back71:
    s_barrier
    v_mfma_f32_16x16x32_bf16 v[40:43], a[216:219], v[92:95], v[40:43]
    buffer_load_dwordx4 v1, s[16:19], s42 offen offset:0 sc1 lds
    v_mfma_f32_16x16x32_bf16 v[44:47], a[220:223], v[92:95], v[44:47]
    v_mfma_f32_16x16x32_bf16 v[36:39], a[220:223], v[88:91], v[36:39]
    s_waitcnt lgkmcnt(0)
    v_mfma_f32_16x16x32_bf16 v[16:19], a[224:227], v[80:83], v[16:19]
    ds_read_b128 v[88:91], v2 offset:30720
    v_mfma_f32_16x16x32_bf16 v[24:27], a[224:227], v[84:87], v[24:27]
    buffer_load_dwordx4 v1, s[16:19], s42 offen offset:1024 sc1 lds
    v_mfma_f32_16x16x32_bf16 v[28:31], a[228:231], v[84:87], v[28:31]
    ds_read_b128 v[92:95], v3 offset:30720
    v_mfma_f32_16x16x32_bf16 v[20:23], a[228:231], v[80:83], v[20:23]
    v_mfma_f32_16x16x32_bf16 v[32:35], a[232:235], v[80:83], v[32:35]
    v_mfma_f32_16x16x32_bf16 v[40:43], a[232:235], v[84:87], v[40:43]
    buffer_load_dwordx4 v1, s[16:19], s42 offen offset:2048 sc1 lds
    v_mfma_f32_16x16x32_bf16 v[44:47], a[236:239], v[84:87], v[44:47]
    v_mfma_f32_16x16x32_bf16 v[36:39], a[236:239], v[80:83], v[36:39]
    s_waitcnt lgkmcnt(0)
    v_mfma_f32_16x16x32_bf16 v[16:19], a[240:243], v[88:91], v[16:19]
    ds_read_b128 v[80:83], v2 offset:32768
    v_mfma_f32_16x16x32_bf16 v[24:27], a[240:243], v[92:95], v[24:27]
    buffer_load_dwordx4 v1, s[16:19], s42 offen offset:3072 sc1 lds
    v_mfma_f32_16x16x32_bf16 v[28:31], a[244:247], v[92:95], v[28:31]
    s_add_u32 m0, s43, 114688
    ds_read_b128 v[84:87], v3 offset:32768
    s_add_u32 s42, s41, 16384
    v_mfma_f32_16x16x32_bf16 v[20:23], a[244:247], v[88:91], v[20:23]
    v_mfma_f32_16x16x32_bf16 v[32:35], a[248:251], v[88:91], v[32:35]
    v_mfma_f32_16x16x32_bf16 v[40:43], a[248:251], v[92:95], v[40:43]
    buffer_load_dwordx4 v1, s[16:19], s42 offen offset:0 sc1 lds
    v_mfma_f32_16x16x32_bf16 v[44:47], a[252:255], v[92:95], v[44:47]
    v_mfma_f32_16x16x32_bf16 v[36:39], a[252:255], v[88:91], v[36:39]
    s_waitcnt lgkmcnt(0)
    v_mfma_f32_16x16x32_bf16 v[16:19], v[128:131], v[80:83], v[16:19]
    ds_read_b128 v[88:91], v2 offset:34816
    v_mfma_f32_16x16x32_bf16 v[24:27], v[128:131], v[84:87], v[24:27]
    buffer_load_dwordx4 v1, s[16:19], s42 offen offset:1024 sc1 lds
    v_mfma_f32_16x16x32_bf16 v[28:31], v[132:135], v[84:87], v[28:31]
    ds_read_b128 v[92:95], v3 offset:34816
    v_mfma_f32_16x16x32_bf16 v[20:23], v[132:135], v[80:83], v[20:23]
    v_mfma_f32_16x16x32_bf16 v[32:35], v[136:139], v[80:83], v[32:35]
    v_mfma_f32_16x16x32_bf16 v[40:43], v[136:139], v[84:87], v[40:43]
    buffer_load_dwordx4 v1, s[16:19], s42 offen offset:2048 sc1 lds
    v_mfma_f32_16x16x32_bf16 v[44:47], v[140:143], v[84:87], v[44:47]
    v_mfma_f32_16x16x32_bf16 v[36:39], v[140:143], v[80:83], v[36:39]
    s_waitcnt lgkmcnt(0)
    v_mfma_f32_16x16x32_bf16 v[16:19], v[144:147], v[88:91], v[16:19]
    ds_read_b128 v[80:83], v2 offset:36864
    v_mfma_f32_16x16x32_bf16 v[24:27], v[144:147], v[92:95], v[24:27]
    buffer_load_dwordx4 v1, s[16:19], s42 offen offset:3072 sc1 lds
    v_mfma_f32_16x16x32_bf16 v[28:31], v[148:151], v[92:95], v[28:31]
    ds_read_b128 v[84:87], v3 offset:36864
    v_mfma_f32_16x16x32_bf16 v[20:23], v[148:151], v[88:91], v[20:23]
    v_mfma_f32_16x16x32_bf16 v[32:35], v[152:155], v[88:91], v[32:35]
    buffer_store_dword v124, v124, s[16:19], s91 offen sc1
    v_mfma_f32_16x16x32_bf16 v[40:43], v[152:155], v[92:95], v[40:43]
    s_add_u32 s91, s91, 65536
    v_mfma_f32_16x16x32_bf16 v[44:47], v[156:159], v[92:95], v[44:47]
    v_mfma_f32_16x16x32_bf16 v[36:39], v[156:159], v[88:91], v[36:39]
    s_waitcnt lgkmcnt(0)
    v_mfma_f32_16x16x32_bf16 v[16:19], v[160:163], v[80:83], v[16:19]
    ds_read_b128 v[88:91], v2 offset:38912
    v_mfma_f32_16x16x32_bf16 v[24:27], v[160:163], v[84:87], v[24:27]
    v_mfma_f32_16x16x32_bf16 v[28:31], v[164:167], v[84:87], v[28:31]
    ds_read_b128 v[92:95], v3 offset:38912
    v_mfma_f32_16x16x32_bf16 v[20:23], v[164:167], v[80:83], v[20:23]
    v_mfma_f32_16x16x32_bf16 v[32:35], v[168:171], v[80:83], v[32:35]
    v_mfma_f32_16x16x32_bf16 v[40:43], v[168:171], v[84:87], v[40:43]
    v_mfma_f32_16x16x32_bf16 v[44:47], v[172:175], v[84:87], v[44:47]
    v_mfma_f32_16x16x32_bf16 v[36:39], v[172:175], v[80:83], v[36:39]
    s_waitcnt lgkmcnt(0)
    v_mfma_f32_16x16x32_bf16 v[16:19], v[176:179], v[88:91], v[16:19]
    ds_read_b128 v[80:83], v2 offset:40960
    v_mfma_f32_16x16x32_bf16 v[24:27], v[176:179], v[92:95], v[24:27]
    v_mfma_f32_16x16x32_bf16 v[28:31], v[180:183], v[92:95], v[28:31]
    ds_read_b128 v[84:87], v3 offset:40960
    v_mfma_f32_16x16x32_bf16 v[20:23], v[180:183], v[88:91], v[20:23]
    v_mfma_f32_16x16x32_bf16 v[32:35], v[184:187], v[88:91], v[32:35]
    v_mfma_f32_16x16x32_bf16 v[40:43], v[184:187], v[92:95], v[40:43]
    v_mfma_f32_16x16x32_bf16 v[44:47], v[188:191], v[92:95], v[44:47]
    v_mfma_f32_16x16x32_bf16 v[36:39], v[188:191], v[88:91], v[36:39]
    s_waitcnt lgkmcnt(0)
    v_mfma_f32_16x16x32_bf16 v[16:19], v[192:195], v[80:83], v[16:19]
    ds_read_b128 v[88:91], v2 offset:43008
    v_mfma_f32_16x16x32_bf16 v[24:27], v[192:195], v[84:87], v[24:27]
    v_mfma_f32_16x16x32_bf16 v[28:31], v[196:199], v[84:87], v[28:31]
    s_add_u32 m0, s43, 131072
    ds_read_b128 v[92:95], v3 offset:43008
    s_add_u32 s42, s41, 32768
    v_mfma_f32_16x16x32_bf16 v[20:23], v[196:199], v[80:83], v[20:23]
    buffer_load_dwordx4 v1, s[16:19], s42 offen offset:0 sc1 lds
    v_mfma_f32_16x16x32_bf16 v[32:35], v[200:203], v[80:83], v[32:35]
    v_mfma_f32_16x16x32_bf16 v[40:43], v[200:203], v[84:87], v[40:43]
    v_mfma_f32_16x16x32_bf16 v[44:47], v[204:207], v[84:87], v[44:47]
    v_mfma_f32_16x16x32_bf16 v[36:39], v[204:207], v[80:83], v[36:39]
    s_waitcnt lgkmcnt(0)
    v_mfma_f32_16x16x32_bf16 v[16:19], v[208:211], v[88:91], v[16:19]
    ds_read_b128 v[80:83], v2 offset:45056
    v_mfma_f32_16x16x32_bf16 v[24:27], v[208:211], v[92:95], v[24:27]
    buffer_load_dwordx4 v1, s[16:19], s42 offen offset:1024 sc1 lds
    v_mfma_f32_16x16x32_bf16 v[28:31], v[212:215], v[92:95], v[28:31]
    ds_read_b128 v[84:87], v3 offset:45056
    v_mfma_f32_16x16x32_bf16 v[20:23], v[212:215], v[88:91], v[20:23]
    v_mfma_f32_16x16x32_bf16 v[32:35], v[216:219], v[88:91], v[32:35]
    v_mfma_f32_16x16x32_bf16 v[40:43], v[216:219], v[92:95], v[40:43]
    v_mfma_f32_16x16x32_bf16 v[44:47], v[220:223], v[92:95], v[44:47]
    buffer_load_dwordx4 v1, s[16:19], s42 offen offset:2048 sc1 lds
    v_mfma_f32_16x16x32_bf16 v[36:39], v[220:223], v[88:91], v[36:39]
    s_waitcnt lgkmcnt(0)
    v_mfma_f32_16x16x32_bf16 v[16:19], v[224:227], v[80:83], v[16:19]
    ds_read_b128 v[88:91], v2 offset:47104
    v_mfma_f32_16x16x32_bf16 v[24:27], v[224:227], v[84:87], v[24:27]
    v_mfma_f32_16x16x32_bf16 v[28:31], v[228:231], v[84:87], v[28:31]
    ds_read_b128 v[92:95], v3 offset:47104
    v_mfma_f32_16x16x32_bf16 v[20:23], v[228:231], v[80:83], v[20:23]
    buffer_load_dwordx4 v1, s[16:19], s42 offen offset:3072 sc1 lds
    v_mfma_f32_16x16x32_bf16 v[32:35], v[232:235], v[80:83], v[32:35]
    s_add_u32 s45, s45, 65536
    v_mfma_f32_16x16x32_bf16 v[40:43], v[232:235], v[84:87], v[40:43]
    v_mfma_f32_16x16x32_bf16 v[44:47], v[236:239], v[84:87], v[44:47]
    v_mfma_f32_16x16x32_bf16 v[36:39], v[236:239], v[80:83], v[36:39]
    s_waitcnt vmcnt(5) lgkmcnt(0)
    s_barrier
    v_mfma_f32_16x16x32_bf16 v[16:19], v[240:243], v[88:91], v[16:19]
    ds_read_b128 v[80:83], v4 offset:0
    v_mfma_f32_16x16x32_bf16 v[24:27], v[240:243], v[92:95], v[24:27]
    v_mfma_f32_16x16x32_bf16 v[28:31], v[244:247], v[92:95], v[28:31]
    ds_read_b128 v[84:87], v5 offset:0
    v_mfma_f32_16x16x32_bf16 v[20:23], v[244:247], v[88:91], v[20:23]
    v_mfma_f32_16x16x32_bf16 v[32:35], v[248:251], v[88:91], v[32:35]
    v_mfma_f32_16x16x32_bf16 v[40:43], v[248:251], v[92:95], v[40:43]
    v_mfma_f32_16x16x32_bf16 v[44:47], v[252:255], v[92:95], v[44:47]
    s_add_u32 s36, s36, 1
    v_mfma_f32_16x16x32_bf16 v[36:39], v[252:255], v[88:91], v[36:39]
    s_waitcnt lgkmcnt(0)
L_bs_b1:
    v_mfma_f32_16x16x32_bf16 v[48:51], a[0:3], v[80:83], 0
    s_and_b32 s44, s90, 0xffffffff
    ds_read_b128 v[88:91], v4 offset:2048
    s_cmp_lt_i32 s36, 1
    v_mfma_f32_16x16x32_bf16 v[56:59], a[0:3], v[84:87], 0
    s_cselect_b32 s44, 0x5e00000, s44
    s_xor_b32 s49, s44, 0
    v_cvt_pk_bf16_f32 v16, v16, v17
    v_mfma_f32_16x16x32_bf16 v[60:63], a[4:7], v[84:87], 0
    ds_read_b128 v[92:95], v5 offset:2048
    v_cvt_pk_bf16_f32 v17, v18, v19
    v_mfma_f32_16x16x32_bf16 v[52:55], a[4:7], v[80:83], 0
    v_cvt_pk_bf16_f32 v18, v20, v21
    v_cvt_pk_bf16_f32 v19, v22, v23
    v_mfma_f32_16x16x32_bf16 v[64:67], a[8:11], v[80:83], 0
    buffer_store_dwordx4 v[16:19], v1, s[16:19], s49 offen offset:3072 sc1
    v_mfma_f32_16x16x32_bf16 v[72:75], a[8:11], v[84:87], 0
    s_xor_b32 s49, s44, 16384
    v_cvt_pk_bf16_f32 v24, v24, v25
    v_cvt_pk_bf16_f32 v25, v26, v27
    v_mfma_f32_16x16x32_bf16 v[76:79], a[12:15], v[84:87], 0
    v_cvt_pk_bf16_f32 v26, v28, v29
    v_cvt_pk_bf16_f32 v27, v30, v31
    v_mfma_f32_16x16x32_bf16 v[68:71], a[12:15], v[80:83], 0
    s_waitcnt lgkmcnt(0)
    v_mfma_f32_16x16x32_bf16 v[48:51], a[16:19], v[88:91], v[48:51]
    ds_read_b128 v[80:83], v4 offset:4096
    v_mfma_f32_16x16x32_bf16 v[56:59], a[16:19], v[92:95], v[56:59]
    buffer_store_dwordx4 v[24:27], v1, s[16:19], s49 offen offset:3072 sc1
    v_mfma_f32_16x16x32_bf16 v[60:63], a[20:23], v[92:95], v[60:63]
    s_xor_b32 s49, s44, 32768
    ds_read_b128 v[84:87], v5 offset:4096
    v_cvt_pk_bf16_f32 v32, v32, v33
    v_mfma_f32_16x16x32_bf16 v[52:55], a[20:23], v[88:91], v[52:55]
    v_cvt_pk_bf16_f32 v33, v34, v35
    v_cvt_pk_bf16_f32 v34, v36, v37
    v_mfma_f32_16x16x32_bf16 v[64:67], a[24:27], v[88:91], v[64:67]
    v_cvt_pk_bf16_f32 v35, v38, v39
    v_mfma_f32_16x16x32_bf16 v[72:75], a[24:27], v[92:95], v[72:75]
    buffer_store_dwordx4 v[32:35], v1, s[16:19], s49 offen offset:3072 sc1
    v_mfma_f32_16x16x32_bf16 v[76:79], a[28:31], v[92:95], v[76:79]
    s_xor_b32 s49, s44, 49152
    v_cvt_pk_bf16_f32 v40, v40, v41
    v_cvt_pk_bf16_f32 v41, v42, v43
    v_mfma_f32_16x16x32_bf16 v[68:71], a[28:31], v[88:91], v[68:71]
    s_waitcnt lgkmcnt(0)
    v_cvt_pk_bf16_f32 v42, v44, v45
    v_cvt_pk_bf16_f32 v43, v46, v47
    v_mfma_f32_16x16x32_bf16 v[48:51], a[32:35], v[80:83], v[48:51]
    ds_read_b128 v[88:91], v4 offset:6144
    v_mfma_f32_16x16x32_bf16 v[56:59], a[32:35], v[84:87], v[56:59]
    buffer_store_dwordx4 v[40:43], v1, s[16:19], s49 offen offset:3072 sc1
    v_mfma_f32_16x16x32_bf16 v[60:63], a[36:39], v[84:87], v[60:63]
    s_add_u32 s90, s90, 262144
    ds_read_b128 v[92:95], v5 offset:6144
    v_mfma_f32_16x16x32_bf16 v[52:55], a[36:39], v[80:83], v[52:55]
    v_mfma_f32_16x16x32_bf16 v[64:67], a[40:43], v[80:83], v[64:67]
    v_mfma_f32_16x16x32_bf16 v[72:75], a[40:43], v[84:87], v[72:75]
    v_mfma_f32_16x16x32_bf16 v[76:79], a[44:47], v[84:87], v[76:79]
    v_mfma_f32_16x16x32_bf16 v[68:71], a[44:47], v[80:83], v[68:71]
    s_waitcnt lgkmcnt(0)
    v_mfma_f32_16x16x32_bf16 v[48:51], a[48:51], v[88:91], v[48:51]
    s_add_u32 s98, s98, 262144
    ds_read_b128 v[80:83], v4 offset:8192
    s_min_i32 s98, s98, s96
    v_mfma_f32_16x16x32_bf16 v[56:59], a[48:51], v[92:95], v[56:59]
    s_and_b32 s41, s98, 0xffffffff
    s_add_u32 m0, s43, 0
    s_add_u32 s42, s41, 0
    v_mfma_f32_16x16x32_bf16 v[60:63], a[52:55], v[92:95], v[60:63]
    ds_read_b128 v[84:87], v5 offset:8192
    v_mfma_f32_16x16x32_bf16 v[52:55], a[52:55], v[88:91], v[52:55]
    v_mfma_f32_16x16x32_bf16 v[64:67], a[56:59], v[88:91], v[64:67]
    v_mfma_f32_16x16x32_bf16 v[72:75], a[56:59], v[92:95], v[72:75]
    v_mfma_f32_16x16x32_bf16 v[76:79], a[60:63], v[92:95], v[76:79]
    v_mfma_f32_16x16x32_bf16 v[68:71], a[60:63], v[88:91], v[68:71]
    s_waitcnt lgkmcnt(0)
    v_mfma_f32_16x16x32_bf16 v[48:51], a[64:67], v[80:83], v[48:51]
    ds_read_b128 v[88:91], v4 offset:10240
    v_mfma_f32_16x16x32_bf16 v[56:59], a[64:67], v[84:87], v[56:59]
    v_mfma_f32_16x16x32_bf16 v[60:63], a[68:71], v[84:87], v[60:63]
    ds_read_b128 v[92:95], v5 offset:10240
    v_mfma_f32_16x16x32_bf16 v[52:55], a[68:71], v[80:83], v[52:55]
    v_mfma_f32_16x16x32_bf16 v[64:67], a[72:75], v[80:83], v[64:67]
    v_mfma_f32_16x16x32_bf16 v[72:75], a[72:75], v[84:87], v[72:75]
    v_mfma_f32_16x16x32_bf16 v[76:79], a[76:79], v[84:87], v[76:79]
    v_mfma_f32_16x16x32_bf16 v[68:71], a[76:79], v[80:83], v[68:71]
    s_waitcnt lgkmcnt(0)
    v_mfma_f32_16x16x32_bf16 v[48:51], a[80:83], v[88:91], v[48:51]
    ds_read_b128 v[80:83], v4 offset:12288
    v_mfma_f32_16x16x32_bf16 v[56:59], a[80:83], v[92:95], v[56:59]
    v_mfma_f32_16x16x32_bf16 v[60:63], a[84:87], v[92:95], v[60:63]
    ds_read_b128 v[84:87], v5 offset:12288
    v_mfma_f32_16x16x32_bf16 v[52:55], a[84:87], v[88:91], v[52:55]
    v_mfma_f32_16x16x32_bf16 v[64:67], a[88:91], v[88:91], v[64:67]
    v_mfma_f32_16x16x32_bf16 v[72:75], a[88:91], v[92:95], v[72:75]
    v_mfma_f32_16x16x32_bf16 v[76:79], a[92:95], v[92:95], v[76:79]
    v_mfma_f32_16x16x32_bf16 v[68:71], a[92:95], v[88:91], v[68:71]
    s_waitcnt lgkmcnt(0)
    v_mfma_f32_16x16x32_bf16 v[48:51], a[96:99], v[80:83], v[48:51]
    ds_read_b128 v[88:91], v4 offset:14336
    v_mfma_f32_16x16x32_bf16 v[56:59], a[96:99], v[84:87], v[56:59]
    v_mfma_f32_16x16x32_bf16 v[60:63], a[100:103], v[84:87], v[60:63]
    ds_read_b128 v[92:95], v5 offset:14336
    v_mfma_f32_16x16x32_bf16 v[52:55], a[100:103], v[80:83], v[52:55]
    v_mfma_f32_16x16x32_bf16 v[64:67], a[104:107], v[80:83], v[64:67]
    v_mfma_f32_16x16x32_bf16 v[72:75], a[104:107], v[84:87], v[72:75]
    v_mfma_f32_16x16x32_bf16 v[76:79], a[108:111], v[84:87], v[76:79]
    v_mfma_f32_16x16x32_bf16 v[68:71], a[108:111], v[80:83], v[68:71]
    s_waitcnt lgkmcnt(0)
    v_mfma_f32_16x16x32_bf16 v[48:51], a[112:115], v[88:91], v[48:51]
    ds_read_b128 v[80:83], v4 offset:16384
    v_mfma_f32_16x16x32_bf16 v[56:59], a[112:115], v[92:95], v[56:59]
    v_mfma_f32_16x16x32_bf16 v[60:63], a[116:119], v[92:95], v[60:63]
    ds_read_b128 v[84:87], v5 offset:16384
    v_mfma_f32_16x16x32_bf16 v[52:55], a[116:119], v[88:91], v[52:55]
    v_mfma_f32_16x16x32_bf16 v[64:67], a[120:123], v[88:91], v[64:67]
    v_mfma_f32_16x16x32_bf16 v[72:75], a[120:123], v[92:95], v[72:75]
    v_mfma_f32_16x16x32_bf16 v[76:79], a[124:127], v[92:95], v[76:79]
    buffer_load_dword v96, v6, s[16:19], s45 offen sc1
    v_mfma_f32_16x16x32_bf16 v[68:71], a[124:127], v[88:91], v[68:71]
    s_waitcnt lgkmcnt(0)
    v_mfma_f32_16x16x32_bf16 v[48:51], a[128:131], v[80:83], v[48:51]
    ds_read_b128 v[88:91], v4 offset:18432
    v_mfma_f32_16x16x32_bf16 v[56:59], a[128:131], v[84:87], v[56:59]
    v_mfma_f32_16x16x32_bf16 v[60:63], a[132:135], v[84:87], v[60:63]
    ds_read_b128 v[92:95], v5 offset:18432
    v_mfma_f32_16x16x32_bf16 v[52:55], a[132:135], v[80:83], v[52:55]
    v_mfma_f32_16x16x32_bf16 v[64:67], a[136:139], v[80:83], v[64:67]
    v_mfma_f32_16x16x32_bf16 v[72:75], a[136:139], v[84:87], v[72:75]
    v_mfma_f32_16x16x32_bf16 v[76:79], a[140:143], v[84:87], v[76:79]
    v_mfma_f32_16x16x32_bf16 v[68:71], a[140:143], v[80:83], v[68:71]
    s_waitcnt lgkmcnt(0)
    v_mfma_f32_16x16x32_bf16 v[48:51], a[144:147], v[88:91], v[48:51]
    ds_read_b128 v[80:83], v4 offset:20480
    v_mfma_f32_16x16x32_bf16 v[56:59], a[144:147], v[92:95], v[56:59]
    v_mfma_f32_16x16x32_bf16 v[60:63], a[148:151], v[92:95], v[60:63]
    ds_read_b128 v[84:87], v5 offset:20480
    v_mfma_f32_16x16x32_bf16 v[52:55], a[148:151], v[88:91], v[52:55]
    v_mfma_f32_16x16x32_bf16 v[64:67], a[152:155], v[88:91], v[64:67]
    v_mfma_f32_16x16x32_bf16 v[72:75], a[152:155], v[92:95], v[72:75]
    v_mfma_f32_16x16x32_bf16 v[76:79], a[156:159], v[92:95], v[76:79]
    v_mfma_f32_16x16x32_bf16 v[68:71], a[156:159], v[88:91], v[68:71]
    s_waitcnt lgkmcnt(0)
    v_mfma_f32_16x16x32_bf16 v[48:51], a[160:163], v[80:83], v[48:51]
    ds_read_b128 v[88:91], v4 offset:22528
    v_mfma_f32_16x16x32_bf16 v[56:59], a[160:163], v[84:87], v[56:59]
    v_mfma_f32_16x16x32_bf16 v[60:63], a[164:167], v[84:87], v[60:63]
    ds_read_b128 v[92:95], v5 offset:22528
    v_mfma_f32_16x16x32_bf16 v[52:55], a[164:167], v[80:83], v[52:55]
    v_mfma_f32_16x16x32_bf16 v[64:67], a[168:171], v[80:83], v[64:67]
    v_mfma_f32_16x16x32_bf16 v[72:75], a[168:171], v[84:87], v[72:75]
    v_mfma_f32_16x16x32_bf16 v[76:79], a[172:175], v[84:87], v[76:79]
    v_mfma_f32_16x16x32_bf16 v[68:71], a[172:175], v[80:83], v[68:71]
    s_waitcnt lgkmcnt(0)
    v_mfma_f32_16x16x32_bf16 v[48:51], a[176:179], v[88:91], v[48:51]
    ds_read_b128 v[80:83], v4 offset:24576
    v_mfma_f32_16x16x32_bf16 v[56:59], a[176:179], v[92:95], v[56:59]
    v_mfma_f32_16x16x32_bf16 v[60:63], a[180:183], v[92:95], v[60:63]
    ds_read_b128 v[84:87], v5 offset:24576
    v_mfma_f32_16x16x32_bf16 v[52:55], a[180:183], v[88:91], v[52:55]
    v_mfma_f32_16x16x32_bf16 v[64:67], a[184:187], v[88:91], v[64:67]
    v_mfma_f32_16x16x32_bf16 v[72:75], a[184:187], v[92:95], v[72:75]
    v_mfma_f32_16x16x32_bf16 v[76:79], a[188:191], v[92:95], v[76:79]
    v_mfma_f32_16x16x32_bf16 v[68:71], a[188:191], v[88:91], v[68:71]
    s_waitcnt lgkmcnt(0)
    v_mfma_f32_16x16x32_bf16 v[48:51], a[192:195], v[80:83], v[48:51]
    ds_read_b128 v[88:91], v4 offset:26624
    v_mfma_f32_16x16x32_bf16 v[56:59], a[192:195], v[84:87], v[56:59]
    v_mfma_f32_16x16x32_bf16 v[60:63], a[196:199], v[84:87], v[60:63]
    ds_read_b128 v[92:95], v5 offset:26624
    v_mfma_f32_16x16x32_bf16 v[52:55], a[196:199], v[80:83], v[52:55]
    v_mfma_f32_16x16x32_bf16 v[64:67], a[200:203], v[80:83], v[64:67]
    v_mfma_f32_16x16x32_bf16 v[72:75], a[200:203], v[84:87], v[72:75]
    v_mfma_f32_16x16x32_bf16 v[76:79], a[204:207], v[84:87], v[76:79]
    v_mfma_f32_16x16x32_bf16 v[68:71], a[204:207], v[80:83], v[68:71]
    s_waitcnt lgkmcnt(0)
    v_mfma_f32_16x16x32_bf16 v[48:51], a[208:211], v[88:91], v[48:51]
    ds_read_b128 v[80:83], v4 offset:28672
    v_mfma_f32_16x16x32_bf16 v[56:59], a[208:211], v[92:95], v[56:59]
    v_mfma_f32_16x16x32_bf16 v[60:63], a[212:215], v[92:95], v[60:63]
    s_waitcnt vmcnt(0)
    ds_read_b128 v[84:87], v5 offset:28672
    v_cmp_ne_u32 vcc, 0, v96
    v_mfma_f32_16x16x32_bf16 v[52:55], a[212:215], v[88:91], v[52:55]
    v_mfma_f32_16x16x32_bf16 v[64:67], a[216:219], v[88:91], v[64:67]
    s_cbranch_vccnz L_spin72
L_back73:
    s_barrier
    v_mfma_f32_16x16x32_bf16 v[72:75], a[216:219], v[92:95], v[72:75]
    buffer_load_dwordx4 v1, s[16:19], s42 offen offset:0 sc1 lds
    v_mfma_f32_16x16x32_bf16 v[76:79], a[220:223], v[92:95], v[76:79]
    v_mfma_f32_16x16x32_bf16 v[68:71], a[220:223], v[88:91], v[68:71]
    s_waitcnt lgkmcnt(0)
    v_mfma_f32_16x16x32_bf16 v[48:51], a[224:227], v[80:83], v[48:51]
    ds_read_b128 v[88:91], v4 offset:30720
    v_mfma_f32_16x16x32_bf16 v[56:59], a[224:227], v[84:87], v[56:59]
    buffer_load_dwordx4 v1, s[16:19], s42 offen offset:1024 sc1 lds
    v_mfma_f32_16x16x32_bf16 v[60:63], a[228:231], v[84:87], v[60:63]
    ds_read_b128 v[92:95], v5 offset:30720
    v_mfma_f32_16x16x32_bf16 v[52:55], a[228:231], v[80:83], v[52:55]
    v_mfma_f32_16x16x32_bf16 v[64:67], a[232:235], v[80:83], v[64:67]
    v_mfma_f32_16x16x32_bf16 v[72:75], a[232:235], v[84:87], v[72:75]
    buffer_load_dwordx4 v1, s[16:19], s42 offen offset:2048 sc1 lds
    v_mfma_f32_16x16x32_bf16 v[76:79], a[236:239], v[84:87], v[76:79]
    v_mfma_f32_16x16x32_bf16 v[68:71], a[236:239], v[80:83], v[68:71]
    s_waitcnt lgkmcnt(0)
    v_mfma_f32_16x16x32_bf16 v[48:51], a[240:243], v[88:91], v[48:51]
    ds_read_b128 v[80:83], v4 offset:32768
    v_mfma_f32_16x16x32_bf16 v[56:59], a[240:243], v[92:95], v[56:59]
    buffer_load_dwordx4 v1, s[16:19], s42 offen offset:3072 sc1 lds
    v_mfma_f32_16x16x32_bf16 v[60:63], a[244:247], v[92:95], v[60:63]
    s_add_u32 m0, s43, 16384
    ds_read_b128 v[84:87], v5 offset:32768
    s_add_u32 s42, s41, 16384
    v_mfma_f32_16x16x32_bf16 v[52:55], a[244:247], v[88:91], v[52:55]
    v_mfma_f32_16x16x32_bf16 v[64:67], a[248:251], v[88:91], v[64:67]
    v_mfma_f32_16x16x32_bf16 v[72:75], a[248:251], v[92:95], v[72:75]
    buffer_load_dwordx4 v1, s[16:19], s42 offen offset:0 sc1 lds
    v_mfma_f32_16x16x32_bf16 v[76:79], a[252:255], v[92:95], v[76:79]
    v_mfma_f32_16x16x32_bf16 v[68:71], a[252:255], v[88:91], v[68:71]
    s_waitcnt lgkmcnt(0)
    v_mfma_f32_16x16x32_bf16 v[48:51], v[128:131], v[80:83], v[48:51]
    ds_read_b128 v[88:91], v4 offset:34816
    v_mfma_f32_16x16x32_bf16 v[56:59], v[128:131], v[84:87], v[56:59]
    buffer_load_dwordx4 v1, s[16:19], s42 offen offset:1024 sc1 lds
    v_mfma_f32_16x16x32_bf16 v[60:63], v[132:135], v[84:87], v[60:63]
    ds_read_b128 v[92:95], v5 offset:34816
    v_mfma_f32_16x16x32_bf16 v[52:55], v[132:135], v[80:83], v[52:55]
    v_mfma_f32_16x16x32_bf16 v[64:67], v[136:139], v[80:83], v[64:67]
    v_mfma_f32_16x16x32_bf16 v[72:75], v[136:139], v[84:87], v[72:75]
    buffer_load_dwordx4 v1, s[16:19], s42 offen offset:2048 sc1 lds
    v_mfma_f32_16x16x32_bf16 v[76:79], v[140:143], v[84:87], v[76:79]
    v_mfma_f32_16x16x32_bf16 v[68:71], v[140:143], v[80:83], v[68:71]
    s_waitcnt lgkmcnt(0)
    v_mfma_f32_16x16x32_bf16 v[48:51], v[144:147], v[88:91], v[48:51]
    ds_read_b128 v[80:83], v4 offset:36864
    v_mfma_f32_16x16x32_bf16 v[56:59], v[144:147], v[92:95], v[56:59]
    buffer_load_dwordx4 v1, s[16:19], s42 offen offset:3072 sc1 lds
    v_mfma_f32_16x16x32_bf16 v[60:63], v[148:151], v[92:95], v[60:63]
    ds_read_b128 v[84:87], v5 offset:36864
    v_mfma_f32_16x16x32_bf16 v[52:55], v[148:151], v[88:91], v[52:55]
    v_mfma_f32_16x16x32_bf16 v[64:67], v[152:155], v[88:91], v[64:67]
    buffer_store_dword v124, v124, s[16:19], s91 offen sc1
    v_mfma_f32_16x16x32_bf16 v[72:75], v[152:155], v[92:95], v[72:75]
    s_add_u32 s91, s91, 65536
    v_mfma_f32_16x16x32_bf16 v[76:79], v[156:159], v[92:95], v[76:79]
    v_mfma_f32_16x16x32_bf16 v[68:71], v[156:159], v[88:91], v[68:71]
    s_waitcnt lgkmcnt(0)
    v_mfma_f32_16x16x32_bf16 v[48:51], v[160:163], v[80:83], v[48:51]
    ds_read_b128 v[88:91], v4 offset:38912
    v_mfma_f32_16x16x32_bf16 v[56:59], v[160:163], v[84:87], v[56:59]
    v_mfma_f32_16x16x32_bf16 v[60:63], v[164:167], v[84:87], v[60:63]
    ds_read_b128 v[92:95], v5 offset:38912
    v_mfma_f32_16x16x32_bf16 v[52:55], v[164:167], v[80:83], v[52:55]
    v_mfma_f32_16x16x32_bf16 v[64:67], v[168:171], v[80:83], v[64:67]
    v_mfma_f32_16x16x32_bf16 v[72:75], v[168:171], v[84:87], v[72:75]
    v_mfma_f32_16x16x32_bf16 v[76:79], v[172:175], v[84:87], v[76:79]
    v_mfma_f32_16x16x32_bf16 v[68:71], v[172:175], v[80:83], v[68:71]
    s_waitcnt lgkmcnt(0)
    v_mfma_f32_16x16x32_bf16 v[48:51], v[176:179], v[88:91], v[48:51]
    ds_read_b128 v[80:83], v4 offset:40960
    v_mfma_f32_16x16x32_bf16 v[56:59], v[176:179], v[92:95], v[56:59]
    v_mfma_f32_16x16x32_bf16 v[60:63], v[180:183], v[92:95], v[60:63]
    ds_read_b128 v[84:87], v5 offset:40960
    v_mfma_f32_16x16x32_bf16 v[52:55], v[180:183], v[88:91], v[52:55]
    v_mfma_f32_16x16x32_bf16 v[64:67], v[184:187], v[88:91], v[64:67]
    v_mfma_f32_16x16x32_bf16 v[72:75], v[184:187], v[92:95], v[72:75]
    v_mfma_f32_16x16x32_bf16 v[76:79], v[188:191], v[92:95], v[76:79]
    v_mfma_f32_16x16x32_bf16 v[68:71], v[188:191], v[88:91], v[68:71]
    s_waitcnt lgkmcnt(0)
    v_mfma_f32_16x16x32_bf16 v[48:51], v[192:195], v[80:83], v[48:51]
    ds_read_b128 v[88:91], v4 offset:43008
    v_mfma_f32_16x16x32_bf16 v[56:59], v[192:195], v[84:87], v[56:59]
    v_mfma_f32_16x16x32_bf16 v[60:63], v[196:199], v[84:87], v[60:63]
    s_add_u32 m0, s43, 32768
    ds_read_b128 v[92:95], v5 offset:43008
    s_add_u32 s42, s41, 32768
    v_mfma_f32_16x16x32_bf16 v[52:55], v[196:199], v[80:83], v[52:55]
    buffer_load_dwordx4 v1, s[16:19], s42 offen offset:0 sc1 lds
    v_mfma_f32_16x16x32_bf16 v[64:67], v[200:203], v[80:83], v[64:67]
    v_mfma_f32_16x16x32_bf16 v[72:75], v[200:203], v[84:87], v[72:75]
    v_mfma_f32_16x16x32_bf16 v[76:79], v[204:207], v[84:87], v[76:79]
    v_mfma_f32_16x16x32_bf16 v[68:71], v[204:207], v[80:83], v[68:71]
    s_waitcnt lgkmcnt(0)
    v_mfma_f32_16x16x32_bf16 v[48:51], v[208:211], v[88:91], v[48:51]
    ds_read_b128 v[80:83], v4 offset:45056
    v_mfma_f32_16x16x32_bf16 v[56:59], v[208:211], v[92:95], v[56:59]
    buffer_load_dwordx4 v1, s[16:19], s42 offen offset:1024 sc1 lds
    v_mfma_f32_16x16x32_bf16 v[60:63], v[212:215], v[92:95], v[60:63]
    ds_read_b128 v[84:87], v5 offset:45056
    v_mfma_f32_16x16x32_bf16 v[52:55], v[212:215], v[88:91], v[52:55]
    v_mfma_f32_16x16x32_bf16 v[64:67], v[216:219], v[88:91], v[64:67]
    v_mfma_f32_16x16x32_bf16 v[72:75], v[216:219], v[92:95], v[72:75]
    v_mfma_f32_16x16x32_bf16 v[76:79], v[220:223], v[92:95], v[76:79]
    buffer_load_dwordx4 v1, s[16:19], s42 offen offset:2048 sc1 lds
    v_mfma_f32_16x16x32_bf16 v[68:71], v[220:223], v[88:91], v[68:71]
    s_waitcnt lgkmcnt(0)
    v_mfma_f32_16x16x32_bf16 v[48:51], v[224:227], v[80:83], v[48:51]
    ds_read_b128 v[88:91], v4 offset:47104
    v_mfma_f32_16x16x32_bf16 v[56:59], v[224:227], v[84:87], v[56:59]
    v_mfma_f32_16x16x32_bf16 v[60:63], v[228:231], v[84:87], v[60:63]
    ds_read_b128 v[92:95], v5 offset:47104
    v_mfma_f32_16x16x32_bf16 v[52:55], v[228:231], v[80:83], v[52:55]
    buffer_load_dwordx4 v1, s[16:19], s42 offen offset:3072 sc1 lds
    v_mfma_f32_16x16x32_bf16 v[64:67], v[232:235], v[80:83], v[64:67]
    s_add_u32 s45, s45, 65536
    v_mfma_f32_16x16x32_bf16 v[72:75], v[232:235], v[84:87], v[72:75]
    v_mfma_f32_16x16x32_bf16 v[76:79], v[236:239], v[84:87], v[76:79]
    v_mfma_f32_16x16x32_bf16 v[68:71], v[236:239], v[80:83], v[68:71]
    s_waitcnt vmcnt(5) lgkmcnt(0)
    s_barrier
    v_mfma_f32_16x16x32_bf16 v[48:51], v[240:243], v[88:91], v[48:51]
    ds_read_b128 v[80:83], v2 offset:0
    v_mfma_f32_16x16x32_bf16 v[56:59], v[240:243], v[92:95], v[56:59]
    v_mfma_f32_16x16x32_bf16 v[60:63], v[244:247], v[92:95], v[60:63]
    ds_read_b128 v[84:87], v3 offset:0
    v_mfma_f32_16x16x32_bf16 v[52:55], v[244:247], v[88:91], v[52:55]
    v_mfma_f32_16x16x32_bf16 v[64:67], v[248:251], v[88:91], v[64:67]
    v_mfma_f32_16x16x32_bf16 v[72:75], v[248:251], v[92:95], v[72:75]
    v_mfma_f32_16x16x32_bf16 v[76:79], v[252:255], v[92:95], v[76:79]
    s_add_u32 s36, s36, 1
    v_mfma_f32_16x16x32_bf16 v[68:71], v[252:255], v[88:91], v[68:71]
    s_waitcnt lgkmcnt(0)
    s_cmp_lt_u32 s36, 32
    s_cbranch_scc1 L_bs_b0
    s_nop 7
    s_and_b32 s44, s90, 0xffffffff
    s_cmp_lt_i32 s36, 1
    s_cselect_b32 s44, 0x5e00000, s44
    s_xor_b32 s49, s44, 0
    v_cvt_pk_bf16_f32 v48, v48, v49
    v_cvt_pk_bf16_f32 v49, v50, v51
    v_cvt_pk_bf16_f32 v50, v52, v53
    v_cvt_pk_bf16_f32 v51, v54, v55
    v_min_u32 v48, -2, v48
    v_min_u32 v49, -2, v49
    v_min_u32 v50, -2, v50
    v_min_u32 v51, -2, v51
    buffer_store_dwordx4 v[48:51], v1, s[16:19], s49 offen offset:3072 sc1
    s_xor_b32 s49, s44, 16384
    v_cvt_pk_bf16_f32 v56, v56, v57
    v_cvt_pk_bf16_f32 v57, v58, v59
    v_cvt_pk_bf16_f32 v58, v60, v61
    v_cvt_pk_bf16_f32 v59, v62, v63
    v_min_u32 v56, -2, v56
    v_min_u32 v57, -2, v57
    v_min_u32 v58, -2, v58
    v_min_u32 v59, -2, v59
    buffer_store_dwordx4 v[56:59], v1, s[16:19], s49 offen offset:3072 sc1
    s_xor_b32 s49, s44, 32768
    v_cvt_pk_bf16_f32 v64, v64, v65
    v_cvt_pk_bf16_f32 v65, v66, v67
    v_cvt_pk_bf16_f32 v66, v68, v69
    v_cvt_pk_bf16_f32 v67, v70, v71
    v_min_u32 v64, -2, v64
    v_min_u32 v65, -2, v65
    v_min_u32 v66, -2, v66
    v_min_u32 v67, -2, v67
    buffer_store_dwordx4 v[64:67], v1, s[16:19], s49 offen offset:3072 sc1
    s_xor_b32 s49, s44, 49152
    v_cvt_pk_bf16_f32 v72, v72, v73
    v_cvt_pk_bf16_f32 v73, v74, v75
    v_cvt_pk_bf16_f32 v74, v76, v77
    v_cvt_pk_bf16_f32 v75, v78, v79
    v_min_u32 v72, -2, v72
    v_min_u32 v73, -2, v73
    v_min_u32 v74, -2, v74
    v_min_u32 v75, -2, v75
    buffer_store_dwordx4 v[72:75], v1, s[16:19], s49 offen offset:3072 sc1
    s_add_u32 s90, s90, 262144
    s_waitcnt vmcnt(0)
    s_endpgm
L_spin66:
    s_mov_b32 s40, 0x20000
L_spin66_l:
    buffer_load_dword v80, v124, s[20:23], 0 offen sc1
    s_sub_u32 s40, s40, 1
    s_waitcnt vmcnt(0)
    v_cmp_eq_u32 vcc, v124, v80
    s_cbranch_scc1 L_back67
    s_cbranch_vccz L_back67
    s_sleep 8
    s_branch L_spin66_l
L_spin68:
    s_mov_b32 s40, 0x20000
L_spin68_l:
    buffer_load_dword v96, v6, s[16:19], s45 offen sc1
    s_sub_u32 s40, s40, 1
    s_waitcnt vmcnt(0)
    v_cmp_ne_u32 vcc, 0, v96
    s_cbranch_scc1 L_back69
    s_cbranch_vccz L_back69
    s_sleep 2
    s_branch L_spin68_l
L_spin70:
    s_mov_b32 s40, 0x20000
L_spin70_l:
    buffer_load_dword v96, v6, s[16:19], s45 offen sc1
    s_sub_u32 s40, s40, 1
    s_waitcnt vmcnt(0)
    v_cmp_ne_u32 vcc, 0, v96
    s_cbranch_scc1 L_back71
    s_cbranch_vccz L_back71
    s_sleep 2
    s_branch L_spin70_l
L_spin72:
    s_mov_b32 s40, 0x20000
L_spin72_l:
    buffer_load_dword v96, v6, s[16:19], s45 offen sc1
    s_sub_u32 s40, s40, 1
    s_waitcnt vmcnt(0)
    v_cmp_ne_u32 vcc, 0, v96
    s_cbranch_scc1 L_back73
    s_cbranch_vccz L_back73
    s_sleep 2
    s_branch L_spin72_l
L_code_end:
    s_endpgm
.section .rodata,"a"
.p2align 6
.amdhsa_kernel interleave_layers__sliding_local_dilated__dense_activation_squared_relu__prompt_kernel
  .amdhsa_next_free_vgpr 512
  .amdhsa_next_free_sgpr 102
  .amdhsa_accum_offset 256
  .amdhsa_group_segment_fixed_size 0
  .amdhsa_kernarg_size 88
  .amdhsa_user_sgpr_count 2
  .amdhsa_user_sgpr_kernarg_segment_ptr 1
  .amdhsa_system_sgpr_workgroup_id_x 1
.end_amdhsa_kernel
```

```asm
; @launch grid=(256,1,1) block=(256,1,1) lds=163840
.amdgcn_target "amdgcn-amd-amdhsa--gfx950"
.text
.globl interleave_layers__sliding_local_dilated__dense_activation_squared_relu__prompt_kernel
.p2align 8
.type interleave_layers__sliding_local_dilated__dense_activation_squared_relu__prompt_kernel,@function
interleave_layers__sliding_local_dilated__dense_activation_squared_relu__prompt_kernel:
    s_load_dwordx16 s[64:79], s[0:1], 0x0
    s_load_dwordx4 s[80:83], s[0:1], 0x40
    s_load_dwordx2 s[84:85], s[0:1], 0x50
    v_lshrrev_b32 v1, 6, v0
    s_cmp_ge_u32 s2, 256
    s_cbranch_scc1 L_code_end
    s_getpc_b64 s[20:21]
L_pc:
    s_mov_b32 s22, L_code_end-L_pc
    s_mov_b32 s23, 0x00020000
    v_lshlrev_b32 v7, 12, v0
    s_lshl_b32 s37, s2, 4
    buffer_load_dword v252, v7, s[20:23], s37 offen
    v_readfirstlane_b32 s32, v1
    v_and_b32 v0, 63, v0
    v_lshlrev_b32 v1, 4, v0
    s_bfe_u32 s47, s2, 0x20001
    s_and_b32 s37, s2, 0x81
    s_cmp_lg_u32 s37, 0
    s_cbranch_scc1 L_other
    s_bfe_u32 s33, s2, 0x20003
    s_lshr_b32 s34, s2, 5
    s_lshl2_add_u32 s34, s47, s34
    s_mov_b32 s35, s34
    s_movk_i32 s39, 6144
    s_lshl_b32 s54, s35, 7
    v_lshrrev_b32 v32, 3, v0
    v_lshlrev_b32 v33, 2, v0
    v_and_b32 v33, 64, v33
    v_and_b32 v34, 0x70, v1
    v_xor_b32 v33, v33, v34
    v_mad_u32_u24 v20, v32, s39, v33
    v_add_u32 v21, 49152, v20
    v_add_u32 v22, 2048, v20
    v_add_u32 v23, 51200, v20
    v_add_u32 v24, 4096, v20
    v_add_u32 v25, 53248, v20
    s_mul_i32 s38, s32, 98304
    s_add_u32 s54, s54, s38
    s_lshl_b32 s42, s32, 11
    s_lshr_b32 s51, s32, 1
    s_lshl_b32 s50, s33, 5
    s_add_u32 s53, s50, 31
    s_lshl_b32 s53, s53, 8
    s_add_u32 s53, s53, s51
    s_lshl_b32 s53, s53, 7
    s_add_u32 s50, s50, 30
    s_sub_u32 s50, s50, s51
    s_lshl_b32 s41, s50, 15
    s_lshl_b32 s43, s32, 10
    v_lshlrev_b32 v37, 1, v0
    v_and_b32 v37, 0x60, v37
    v_xor_b32 v37, v37, v34
    s_and_b32 s37, s32, 1
    s_lshl_b32 s37, s37, 14
    v_lshl_add_u32 v6, v32, 11, v37
    v_add_u32 v6, s37, v6
    s_waitcnt lgkmcnt(0)
    s_mov_b32 s12, s66
    s_mov_b32 s13, s67
    s_mov_b32 s14, 0x600000
    s_mov_b32 s15, 0x00020000
    s_mov_b32 s8, s64
    s_mov_b32 s9, s65
    s_mov_b32 s10, 0x400000
    s_mov_b32 s11, 0x00020000
    s_add_u32 m0, s43, 131072
    s_nop 0
    buffer_load_dwordx4 v6, s[8:11], s53 offen offset:0 sc1 lds
    s_add_u32 m0, s43, 98304
    s_nop 0
    buffer_load_dwordx4 v6, s[8:11], s41 offen offset:0 sc1 lds
    s_add_u32 m0, s42, 73728
    s_nop 0
    buffer_load_dwordx4 v20, s[12:15], s54 offen lds
    s_add_u32 m0, s42, 74752
    s_nop 0
    buffer_load_dwordx4 v21, s[12:15], s54 offen lds
    s_add_u32 m0, s42, 81920
    s_nop 0
    buffer_load_dwordx4 v22, s[12:15], s54 offen lds
    s_add_u32 m0, s42, 82944
    s_nop 0
    buffer_load_dwordx4 v23, s[12:15], s54 offen lds
    s_add_u32 m0, s42, 90112
    s_nop 0
    buffer_load_dwordx4 v24, s[12:15], s54 offen lds
    s_add_u32 m0, s42, 91136
    s_nop 0
    buffer_load_dwordx4 v25, s[12:15], s54 offen lds
    s_add_u32 s54, s54, 393216
    v_lshrrev_b32 v32, 4, v0
    v_bfe_u32 v33, v0, 2, 2
    v_lshl_add_u32 v32, v32, 3, v33
    v_lshlrev_b32 v32, 7, v32
    v_lshrrev_b32 v33, 1, v33
    v_lshl_add_u32 v32, v33, 6, v32
    v_and_b32 v33, 3, v0
    v_lshl_add_u32 v32, v33, 4, v32
    s_lshl_b32 s37, s51, 6
    s_and_b32 s38, s32, 1
    s_lshl_b32 s38, s38, 3
    s_add_u32 s37, s37, s38
    s_add_u32 s37, s37, 0
    v_xor_b32 v26, s37, v32
    s_lshl_b32 s37, s51, 6
    s_and_b32 s38, s32, 1
    s_lshl_b32 s38, s38, 3
    s_add_u32 s37, s37, s38
    s_add_u32 s37, s37, 8192
    v_xor_b32 v27, s37, v32
    s_lshl_b32 s37, s51, 6
    s_and_b32 s38, s32, 1
    s_lshl_b32 s38, s38, 3
    s_add_u32 s37, s37, s38
    s_add_u32 s37, s37, 16384
    v_xor_b32 v28, s37, v32
    v_mov_b32 v32, 0x3f803f80
    v_mov_b32 v33, 0x3f803f80
    v_mov_b32 v34, 0x3f803f80
    v_mov_b32 v35, 0x3f803f80
    v_and_b32 v36, 15, v0
    v_lshrrev_b32 v37, 4, v0
    v_and_b32 v38, 6, v36
    v_xor_b32 v38, v37, v38
    v_lshlrev_b32 v38, 4, v38
    v_lshl_add_u32 v2, v36, 7, v38
    v_xor_b32 v3, 64, v2
    v_add_u32 v4, 98304, v2
    v_add_u32 v5, 98304, v3
    s_add_u32 m0, s43, 102272
    s_nop 0
    buffer_load_dwordx4 v6, s[8:11], s41 offen offset:128 sc1 lds
    s_add_u32 m0, s42, 0
    s_nop 0
    buffer_load_dwordx4 v20, s[12:15], s54 offen lds
    s_add_u32 m0, s42, 1024
    s_nop 0
    buffer_load_dwordx4 v21, s[12:15], s54 offen lds
    s_add_u32 m0, s42, 8192
    s_nop 0
    buffer_load_dwordx4 v22, s[12:15], s54 offen lds
    s_add_u32 m0, s42, 9216
    s_nop 0
    buffer_load_dwordx4 v23, s[12:15], s54 offen lds
    s_add_u32 m0, s42, 16384
    s_nop 0
    buffer_load_dwordx4 v24, s[12:15], s54 offen lds
    s_add_u32 m0, s42, 17408
    s_nop 0
    buffer_load_dwordx4 v25, s[12:15], s54 offen lds
    s_add_u32 s54, s54, 393216
    s_add_u32 m0, s43, 134912
    s_nop 0
    buffer_load_dwordx4 v6, s[8:11], s53 offen offset:256 sc1 lds
    s_add_u32 m0, s43, 106240
    s_nop 0
    buffer_load_dwordx4 v6, s[8:11], s41 offen offset:256 sc1 lds
    s_add_u32 m0, s42, 24576
    s_nop 0
    buffer_load_dwordx4 v20, s[12:15], s54 offen lds
    s_add_u32 m0, s42, 25600
    s_nop 0
    buffer_load_dwordx4 v21, s[12:15], s54 offen lds
    s_add_u32 m0, s42, 32768
    s_nop 0
    buffer_load_dwordx4 v22, s[12:15], s54 offen lds
    s_add_u32 m0, s42, 33792
    s_nop 0
    buffer_load_dwordx4 v23, s[12:15], s54 offen lds
    s_add_u32 m0, s42, 40960
    s_nop 0
    buffer_load_dwordx4 v24, s[12:15], s54 offen lds
    s_add_u32 m0, s42, 41984
    s_nop 0
    buffer_load_dwordx4 v25, s[12:15], s54 offen lds
    s_add_u32 s54, s54, 393216
    s_mov_b32 s36, -1
    v_add_u32 v29, 73728, v26
    v_add_u32 v30, 73728, v27
    v_add_u32 v31, 73728, v28
    s_waitcnt vmcnt(15) lgkmcnt(0)
    s_barrier
    ds_read_b128 v[68:71], v4 offset:0
    s_add_u32 m0, s43, 110208
    ds_read_b128 v[72:75], v4 offset:2048
    buffer_load_dwordx4 v6, s[8:11], s41 offen offset:384 sc1 lds
    ds_read_b128 v[76:79], v4 offset:32768
    s_add_u32 m0, s42, 49152
    ds_read_b64_tr_b16 a[0:1], v29 offset:0
    buffer_load_dwordx4 v20, s[12:15], s54 offen lds
    ds_read_b64_tr_b16 a[2:3], v29 offset:512
    s_add_u32 m0, s42, 50176
    ds_read_b64_tr_b16 a[4:5], v30 offset:0
    buffer_load_dwordx4 v21, s[12:15], s54 offen lds
    ds_read_b64_tr_b16 a[6:7], v30 offset:512
    s_add_u32 m0, s42, 57344
    ds_read_b64_tr_b16 a[8:9], v31 offset:0
    buffer_load_dwordx4 v22, s[12:15], s54 offen lds
    ds_read_b64_tr_b16 a[10:11], v31 offset:512
    s_waitcnt lgkmcnt(4)
    v_mfma_f32_16x16x32_bf16 v[44:47], a[0:3], v[68:71], 0
    s_add_u32 m0, s42, 58368
    ds_read_b128 v[80:83], v5 offset:0
    v_mfma_f32_16x16x32_bf16 v[48:51], a[0:3], v[72:75], 0
    ds_read_b128 v[84:87], v5 offset:2048
    v_mfma_f32_16x16x32_bf16 v[92:95], a[0:3], v[76:79], 0
    ds_read_b128 v[88:91], v5 offset:32768
    s_waitcnt lgkmcnt(5)
    v_mfma_f32_16x16x32_bf16 v[52:55], a[4:7], v[68:71], 0
    ds_read_b64_tr_b16 a[12:13], v29 offset:4096
    v_mfma_f32_16x16x32_bf16 v[56:59], a[4:7], v[72:75], 0
    ds_read_b64_tr_b16 a[14:15], v29 offset:4608
    v_mfma_f32_16x16x32_bf16 v[96:99], a[4:7], v[76:79], 0
    ds_read_b64_tr_b16 a[16:17], v30 offset:4096
    s_waitcnt lgkmcnt(6)
    v_mfma_f32_16x16x32_bf16 v[60:63], a[8:11], v[68:71], 0
    ds_read_b64_tr_b16 a[18:19], v30 offset:4608
    v_mfma_f32_16x16x32_bf16 v[64:67], a[8:11], v[72:75], 0
    ds_read_b64_tr_b16 a[20:21], v31 offset:4096
    v_mfma_f32_16x16x32_bf16 v[118:121], a[8:11], v[76:79], 0
    ds_read_b64_tr_b16 a[22:23], v31 offset:4608
    v_mfma_f32_16x16x32_bf16 v[100:103], a[0:3], v[32:35], 0
    buffer_load_dwordx4 v23, s[12:15], s54 offen lds
    v_mfma_f32_16x16x32_bf16 v[104:107], a[4:7], v[32:35], 0
    s_add_u32 m0, s42, 65536
    s_nop 0
    buffer_load_dwordx4 v24, s[12:15], s54 offen lds
    v_mfma_f32_16x16x32_bf16 v[108:111], a[8:11], v[32:35], 0
    s_add_u32 m0, s42, 66560
    s_nop 0
    buffer_load_dwordx4 v25, s[12:15], s54 offen lds
    s_add_u32 s54, s54, 393216
    s_mov_b32 s16, s84
    s_mov_b32 s17, s85
    s_mov_b32 s18, 0x5e00000
    s_mov_b32 s19, 0x00020000
    v_min_u32 v124, 1, v0
    v_lshlrev_b32 v124, 30, v124
    s_lshl_b32 s91, s33, 6
    s_add_u32 s91, s91, s34
    s_lshl_b32 s91, s91, 7
    s_add_u32 s91, s91, 0x5520000
    s_cmp_eq_u32 s32, 1
    s_cselect_b32 s91, s91, 0x5f00000
    s_add_u32 s88, s84, 0x5000000
    s_addc_u32 s89, s85, 0
    s_mov_b32 s97, 14
    s_and_b32 s38, s32, 1
    v_lshlrev_b32 v40, 1, v0
    v_and_b32 v40, 0x30, v40
    v_xor_b32 v40, v40, v1
    s_mul_i32 s37, s51, 3072
    s_add_u32 s37, s37, 65536
    s_lshl_b32 s39, s38, 3
    s_add_u32 s39, s39, s37
    v_add_u32 v7, s39, v40
    v_bfe_u32 v38, v0, 1, 2
    v_xor_b32 v38, v38, v37
    s_waitcnt vmcnt(15) lgkmcnt(0)
    s_barrier
    v_mfma_f32_16x16x32_bf16 v[44:47], a[12:15], v[80:83], v[44:47]
    s_add_u32 m0, s43, 138752
    ds_read_b128 v[68:71], v4 offset:4096
    ds_read_b128 v[72:75], v4 offset:6144
    v_mfma_f32_16x16x32_bf16 v[48:51], a[12:15], v[84:87], v[48:51]
    ds_read_b128 v[76:79], v4 offset:34816
    ds_read_b64_tr_b16 a[24:25], v26 offset:0
    v_mfma_f32_16x16x32_bf16 v[92:95], a[12:15], v[88:91], v[92:95]
    buffer_load_dwordx4 v6, s[8:11], s53 offen offset:512 sc1 lds
    v_mfma_f32_16x16x32_bf16 v[52:55], a[16:19], v[80:83], v[52:55]
    s_add_u32 m0, s43, 114176
    ds_read_b64_tr_b16 a[26:27], v26 offset:512
    v_mfma_f32_16x16x32_bf16 v[56:59], a[16:19], v[84:87], v[56:59]
    buffer_load_dwordx4 v6, s[8:11], s41 offen offset:512 sc1 lds
    v_mfma_f32_16x16x32_bf16 v[96:99], a[16:19], v[88:91], v[96:99]
    s_add_u32 m0, s42, 73728
    ds_read_b64_tr_b16 a[28:29], v27 offset:0
    v_mfma_f32_16x16x32_bf16 v[60:63], a[20:23], v[80:83], v[60:63]
    ds_read_b64_tr_b16 a[30:31], v27 offset:512
    v_mfma_f32_16x16x32_bf16 v[64:67], a[20:23], v[84:87], v[64:67]
    buffer_load_dwordx4 v20, s[12:15], s54 offen lds
    v_mfma_f32_16x16x32_bf16 v[118:121], a[20:23], v[88:91], v[118:121]
    s_add_u32 m0, s42, 74752
    ds_read_b64_tr_b16 a[32:33], v28 offset:0
    v_mfma_f32_16x16x32_bf16 v[100:103], a[12:15], v[32:35], v[100:103]
    buffer_load_dwordx4 v21, s[12:15], s54 offen lds
    v_mfma_f32_16x16x32_bf16 v[104:107], a[16:19], v[32:35], v[104:107]
    s_add_u32 m0, s42, 81920
    ds_read_b64_tr_b16 a[34:35], v28 offset:512
    v_mfma_f32_16x16x32_bf16 v[108:111], a[20:23], v[32:35], v[108:111]
    buffer_load_dwordx4 v22, s[12:15], s54 offen lds
    s_waitcnt lgkmcnt(4)
    v_mfma_f32_16x16x32_bf16 v[44:47], a[24:27], v[68:71], v[44:47]
    s_add_u32 m0, s42, 82944
    ds_read_b128 v[80:83], v5 offset:4096
    v_mfma_f32_16x16x32_bf16 v[48:51], a[24:27], v[72:75], v[48:51]
    ds_read_b128 v[84:87], v5 offset:6144
    v_mfma_f32_16x16x32_bf16 v[92:95], a[24:27], v[76:79], v[92:95]
    ds_read_b128 v[88:91], v5 offset:34816
    s_waitcnt lgkmcnt(5)
    v_mfma_f32_16x16x32_bf16 v[52:55], a[28:31], v[68:71], v[52:55]
    ds_read_b64_tr_b16 a[36:37], v26 offset:4096
    v_mfma_f32_16x16x32_bf16 v[56:59], a[28:31], v[72:75], v[56:59]
    ds_read_b64_tr_b16 a[38:39], v26 offset:4608
    v_mfma_f32_16x16x32_bf16 v[96:99], a[28:31], v[76:79], v[96:99]
    ds_read_b64_tr_b16 a[40:41], v27 offset:4096
    s_waitcnt lgkmcnt(6)
    v_mfma_f32_16x16x32_bf16 v[60:63], a[32:35], v[68:71], v[60:63]
    ds_read_b64_tr_b16 a[42:43], v27 offset:4608
    v_mfma_f32_16x16x32_bf16 v[64:67], a[32:35], v[72:75], v[64:67]
    ds_read_b64_tr_b16 a[44:45], v28 offset:4096
    v_mfma_f32_16x16x32_bf16 v[118:121], a[32:35], v[76:79], v[118:121]
    ds_read_b64_tr_b16 a[46:47], v28 offset:4608
    v_mfma_f32_16x16x32_bf16 v[100:103], a[24:27], v[32:35], v[100:103]
    buffer_load_dwordx4 v23, s[12:15], s54 offen lds
    v_mfma_f32_16x16x32_bf16 v[104:107], a[28:31], v[32:35], v[104:107]
    s_add_u32 m0, s42, 90112
    s_nop 0
    buffer_load_dwordx4 v24, s[12:15], s54 offen lds
    v_mfma_f32_16x16x32_bf16 v[108:111], a[32:35], v[32:35], v[108:111]
    s_add_u32 m0, s42, 91136
    s_nop 0
    buffer_load_dwordx4 v25, s[12:15], s54 offen lds
    s_add_u32 s54, s54, 393216
    v_lshlrev_b32 v38, 4, v38
    v_lshl_add_u32 v38, v36, 6, v38
    v_add_u32 v8, s39, v38
    s_mul_i32 s39, s38, 6144
    s_add_u32 s39, s39, s37
    v_add_u32 v9, s39, v40
    s_cmp_eq_u32 s38, 0
    s_cselect_b32 s39, 18432, 0
    s_add_u32 s39, s39, s37
    v_add_u32 v10, s39, v40
    s_sub_u32 s39, s33, 1
    s_max_i32 s39, s39, 0
    v_mov_b32 v38, s33
    v_mov_b32 v39, s39
    v_mov_b32 v12, 1048576
    v_mov_b32 v41, 131072
    v_cmp_lt_u32 vcc, 15, v0
    s_nop 1
    v_cndmask_b32 v38, v38, v39, vcc
    v_cndmask_b32 v12, v12, v41, vcc
    v_lshl_add_u32 v38, v38, 6, v36
    v_add_u32 v38, 697644, v38
    v_lshlrev_b32 v11, 7, v38
    s_cmp_eq_u32 s32, 0
    s_cselect_b32 s37, 32, 0
    v_cmp_le_u32 vcc, s37, v0
    s_nop 1
    v_cndmask_b32 v11, v11, 2.0, vcc
    s_waitcnt vmcnt(15) lgkmcnt(0)
    s_barrier
    v_mfma_f32_16x16x32_bf16 v[44:47], a[36:39], v[80:83], v[44:47]
    s_add_u32 m0, s43, 118144
    ds_read_b128 v[68:71], v4 offset:8192
    ds_read_b128 v[72:75], v4 offset:10240
    v_mfma_f32_16x16x32_bf16 v[48:51], a[36:39], v[84:87], v[48:51]
    ds_read_b128 v[76:79], v4 offset:36864
    v_mfma_f32_16x16x32_bf16 v[92:95], a[36:39], v[88:91], v[92:95]
    buffer_load_dwordx4 v6, s[8:11], s41 offen offset:640 sc1 lds
    v_mfma_f32_16x16x32_bf16 v[52:55], a[40:43], v[80:83], v[52:55]
    s_add_u32 m0, s42, 0
    ds_read_b64_tr_b16 a[48:49], v26 offset:24576
    v_mfma_f32_16x16x32_bf16 v[56:59], a[40:43], v[84:87], v[56:59]
    buffer_load_dwordx4 v20, s[12:15], s54 offen lds
    v_mfma_f32_16x16x32_bf16 v[96:99], a[40:43], v[88:91], v[96:99]
    s_add_u32 m0, s42, 1024
    ds_read_b64_tr_b16 a[50:51], v26 offset:25088
    v_mfma_f32_16x16x32_bf16 v[60:63], a[44:47], v[80:83], v[60:63]
    ds_read_b64_tr_b16 a[52:53], v27 offset:24576
    v_mfma_f32_16x16x32_bf16 v[64:67], a[44:47], v[84:87], v[64:67]
    buffer_load_dwordx4 v21, s[12:15], s54 offen lds
    v_mfma_f32_16x16x32_bf16 v[118:121], a[44:47], v[88:91], v[118:121]
    s_add_u32 m0, s42, 8192
    ds_read_b64_tr_b16 a[54:55], v27 offset:25088
    v_mfma_f32_16x16x32_bf16 v[100:103], a[36:39], v[32:35], v[100:103]
    buffer_load_dwordx4 v22, s[12:15], s54 offen lds
    v_mfma_f32_16x16x32_bf16 v[104:107], a[40:43], v[32:35], v[104:107]
    ds_read_b64_tr_b16 a[56:57], v28 offset:24576
    v_mfma_f32_16x16x32_bf16 v[108:111], a[44:47], v[32:35], v[108:111]
    ds_read_b64_tr_b16 a[58:59], v28 offset:25088
    s_waitcnt lgkmcnt(4)
    v_mfma_f32_16x16x32_bf16 v[44:47], a[48:51], v[68:71], v[44:47]
    s_add_u32 m0, s42, 9216
    ds_read_b128 v[80:83], v5 offset:8192
    v_mfma_f32_16x16x32_bf16 v[48:51], a[48:51], v[72:75], v[48:51]
    ds_read_b128 v[84:87], v5 offset:10240
    v_mfma_f32_16x16x32_bf16 v[92:95], a[48:51], v[76:79], v[92:95]
    ds_read_b128 v[88:91], v5 offset:36864
    s_waitcnt lgkmcnt(5)
    v_mfma_f32_16x16x32_bf16 v[52:55], a[52:55], v[68:71], v[52:55]
    ds_read_b64_tr_b16 a[60:61], v26 offset:28672
    v_mfma_f32_16x16x32_bf16 v[56:59], a[52:55], v[72:75], v[56:59]
    ds_read_b64_tr_b16 a[62:63], v26 offset:29184
    v_mfma_f32_16x16x32_bf16 v[96:99], a[52:55], v[76:79], v[96:99]
    ds_read_b64_tr_b16 a[64:65], v27 offset:28672
    s_waitcnt lgkmcnt(6)
    v_mfma_f32_16x16x32_bf16 v[60:63], a[56:59], v[68:71], v[60:63]
    ds_read_b64_tr_b16 a[66:67], v27 offset:29184
    v_mfma_f32_16x16x32_bf16 v[64:67], a[56:59], v[72:75], v[64:67]
    ds_read_b64_tr_b16 a[68:69], v28 offset:28672
    v_mfma_f32_16x16x32_bf16 v[118:121], a[56:59], v[76:79], v[118:121]
    ds_read_b64_tr_b16 a[70:71], v28 offset:29184
    v_mfma_f32_16x16x32_bf16 v[100:103], a[48:51], v[32:35], v[100:103]
    buffer_load_dwordx4 v23, s[12:15], s54 offen lds
    v_mfma_f32_16x16x32_bf16 v[104:107], a[52:55], v[32:35], v[104:107]
    s_add_u32 m0, s42, 16384
    s_nop 0
    buffer_load_dwordx4 v24, s[12:15], s54 offen lds
    v_mfma_f32_16x16x32_bf16 v[108:111], a[56:59], v[32:35], v[108:111]
    s_add_u32 m0, s42, 17408
    s_nop 0
    buffer_load_dwordx4 v25, s[12:15], s54 offen lds
    s_add_u32 s54, s54, 393216
    s_mov_b32 s45, -786432
    v_and_b32 v13, 15, v0
    v_lshlrev_b32 v13, 3, v13
    v_lshrrev_b32 v38, 5, v0
    v_lshl_add_u32 v13, v38, 9, v13
    v_and_b32 v38, 16, v0
    v_lshl_add_u32 v13, v38, 6, v13
    v_add_u32 v13, 90112, v13
    s_lshl_b32 s52, s51, 10
    s_or_b32 s96, s50, 31
    s_mov_b32 s55, 0x541fc00
    s_lshl_b32 s46, s50, 10
    s_sub_u32 s46, s55, s46
    s_mov_b32 s56, 0xaaaaaaaa
    s_mov_b32 s57, 0xaaaaaaaa
    s_mov_b32 s58, 0xfff0ffff
    s_mov_b32 s59, 0xf000ff00
    s_mov_b32 s60, 0xffc0fffc
    s_mov_b32 s61, 0xc000fc00
    s_mov_b32 s86, 0x3e8293ee
    v_mov_b32 v38, 0x0c0c0c0c
    v_mov_b32 v36, 0xc0c0100
    v_mov_b32 v37, 0x1000c0c
    v_cndmask_b32 v36, v36, v37, s[56:57]
    v_cndmask_b32 v14, v36, v38, s[58:59]
    v_cndmask_b32 v16, v38, v36, s[58:59]
    s_waitcnt vmcnt(15) lgkmcnt(0)
    s_barrier
    v_mfma_f32_16x16x32_bf16 v[44:47], a[60:63], v[80:83], v[44:47]
    s_add_u32 m0, s43, 142592
    ds_read_b128 v[68:71], v4 offset:12288
    ds_read_b128 v[72:75], v4 offset:14336
    v_mfma_f32_16x16x32_bf16 v[48:51], a[60:63], v[84:87], v[48:51]
    ds_read_b128 v[76:79], v4 offset:38912
    ds_read_b64_tr_b16 a[72:73], v26 offset:49152
    v_mfma_f32_16x16x32_bf16 v[92:95], a[60:63], v[88:91], v[92:95]
    buffer_load_dwordx4 v6, s[8:11], s53 offen offset:768 sc1 lds
    v_mfma_f32_16x16x32_bf16 v[52:55], a[64:67], v[80:83], v[52:55]
    s_add_u32 m0, s43, 122112
    ds_read_b64_tr_b16 a[74:75], v26 offset:49664
    v_mfma_f32_16x16x32_bf16 v[56:59], a[64:67], v[84:87], v[56:59]
    buffer_load_dwordx4 v6, s[8:11], s41 offen offset:768 sc1 lds
    v_mfma_f32_16x16x32_bf16 v[96:99], a[64:67], v[88:91], v[96:99]
    s_add_u32 m0, s42, 24576
    ds_read_b64_tr_b16 a[76:77], v27 offset:49152
    v_mfma_f32_16x16x32_bf16 v[60:63], a[68:71], v[80:83], v[60:63]
    ds_read_b64_tr_b16 a[78:79], v27 offset:49664
    v_mfma_f32_16x16x32_bf16 v[64:67], a[68:71], v[84:87], v[64:67]
    buffer_load_dwordx4 v20, s[12:15], s54 offen lds
    v_mfma_f32_16x16x32_bf16 v[118:121], a[68:71], v[88:91], v[118:121]
    s_add_u32 m0, s42, 25600
    ds_read_b64_tr_b16 a[80:81], v28 offset:49152
    v_mfma_f32_16x16x32_bf16 v[100:103], a[60:63], v[32:35], v[100:103]
    buffer_load_dwordx4 v21, s[12:15], s54 offen lds
    v_mfma_f32_16x16x32_bf16 v[104:107], a[64:67], v[32:35], v[104:107]
    s_add_u32 m0, s42, 32768
    ds_read_b64_tr_b16 a[82:83], v28 offset:49664
    v_mfma_f32_16x16x32_bf16 v[108:111], a[68:71], v[32:35], v[108:111]
    buffer_load_dwordx4 v22, s[12:15], s54 offen lds
    s_waitcnt lgkmcnt(4)
    v_mfma_f32_16x16x32_bf16 v[44:47], a[72:75], v[68:71], v[44:47]
    s_add_u32 m0, s42, 33792
    ds_read_b128 v[80:83], v5 offset:12288
    v_mfma_f32_16x16x32_bf16 v[48:51], a[72:75], v[72:75], v[48:51]
    ds_read_b128 v[84:87], v5 offset:14336
    v_mfma_f32_16x16x32_bf16 v[92:95], a[72:75], v[76:79], v[92:95]
    ds_read_b128 v[88:91], v5 offset:38912
    s_waitcnt lgkmcnt(5)
    v_mfma_f32_16x16x32_bf16 v[52:55], a[76:79], v[68:71], v[52:55]
    ds_read_b64_tr_b16 a[84:85], v26 offset:53248
    v_mfma_f32_16x16x32_bf16 v[56:59], a[76:79], v[72:75], v[56:59]
    ds_read_b64_tr_b16 a[86:87], v26 offset:53760
    v_mfma_f32_16x16x32_bf16 v[96:99], a[76:79], v[76:79], v[96:99]
    ds_read_b64_tr_b16 a[88:89], v27 offset:53248
    s_waitcnt lgkmcnt(6)
    v_mfma_f32_16x16x32_bf16 v[60:63], a[80:83], v[68:71], v[60:63]
    ds_read_b64_tr_b16 a[90:91], v27 offset:53760
    v_mfma_f32_16x16x32_bf16 v[64:67], a[80:83], v[72:75], v[64:67]
    ds_read_b64_tr_b16 a[92:93], v28 offset:53248
    v_mfma_f32_16x16x32_bf16 v[118:121], a[80:83], v[76:79], v[118:121]
    ds_read_b64_tr_b16 a[94:95], v28 offset:53760
    v_mfma_f32_16x16x32_bf16 v[100:103], a[72:75], v[32:35], v[100:103]
    buffer_load_dwordx4 v23, s[12:15], s54 offen lds
    v_mfma_f32_16x16x32_bf16 v[104:107], a[76:79], v[32:35], v[104:107]
    s_add_u32 m0, s42, 40960
    s_nop 0
    buffer_load_dwordx4 v24, s[12:15], s54 offen lds
    v_mfma_f32_16x16x32_bf16 v[108:111], a[80:83], v[32:35], v[108:111]
    s_add_u32 m0, s42, 41984
    s_nop 0
    buffer_load_dwordx4 v25, s[12:15], s54 offen lds
    s_add_u32 s54, s54, 393216
    v_mov_b32 v36, 0xc0c0302
    v_mov_b32 v37, 0x3020c0c
    v_cndmask_b32 v36, v36, v37, s[56:57]
    v_cndmask_b32 v15, v36, v38, s[60:61]
    v_cndmask_b32 v17, v38, v36, s[60:61]
    v_mov_b32 v18, 0xff800000
    s_mul_i32 s90, s33, 2097152
    s_add_u32 s90, s90, 0xffff0000
    s_lshl_b32 s37, s35, 1
    s_add_u32 s37, s37, s51
    s_lshl_b32 s37, s37, 11
    s_add_u32 s90, s90, s37
    s_mul_i32 s37, s38, 1024
    s_add_u32 s90, s90, s37
    s_mov_b32 s87, -1024
    s_mov_b32 s24, 0xfffeffff
    s_mov_b32 s25, -1
    s_lshl_b32 s26, s38, 15
    s_mov_b32 s27, s38
    s_add_u32 s87, s87, 1024
    s_cmp_eq_u32 s33, 0
    s_cselect_b64 s[26:27], s[26:27], 0
    s_add_u32 s20, s82, 0x80
    s_addc_u32 s21, s83, 0
    s_mov_b32 s22, 0x80
    s_mov_b32 s23, 0x00020000
    v_lshl_add_u32 v36, s32, 7, v124
    v_mov_b32 v116, v36
    s_waitcnt vmcnt(15) lgkmcnt(0)
    s_barrier
    v_mfma_f32_16x16x32_bf16 v[44:47], a[84:87], v[80:83], v[44:47]
    s_add_u32 m0, s43, 126080
    ds_read_b128 v[68:71], v4 offset:16384
    ds_read_b128 v[72:75], v4 offset:18432
    v_mfma_f32_16x16x32_bf16 v[48:51], a[84:87], v[84:87], v[48:51]
    ds_read_b128 v[76:79], v4 offset:40960
    v_mfma_f32_16x16x32_bf16 v[92:95], a[84:87], v[88:91], v[92:95]
    buffer_load_dwordx4 v6, s[8:11], s41 offen offset:896 sc1 lds
    v_mfma_f32_16x16x32_bf16 v[52:55], a[88:91], v[80:83], v[52:55]
    s_add_u32 m0, s42, 49152
    ds_read_b64_tr_b16 a[96:97], v29 offset:0
    v_mfma_f32_16x16x32_bf16 v[56:59], a[88:91], v[84:87], v[56:59]
    buffer_load_dwordx4 v20, s[12:15], s54 offen lds
    v_mfma_f32_16x16x32_bf16 v[96:99], a[88:91], v[88:91], v[96:99]
    s_add_u32 m0, s42, 50176
    ds_read_b64_tr_b16 a[98:99], v29 offset:512
    v_mfma_f32_16x16x32_bf16 v[60:63], a[92:95], v[80:83], v[60:63]
    ds_read_b64_tr_b16 a[100:101], v30 offset:0
    v_mfma_f32_16x16x32_bf16 v[64:67], a[92:95], v[84:87], v[64:67]
    buffer_load_dwordx4 v21, s[12:15], s54 offen lds
    v_mfma_f32_16x16x32_bf16 v[118:121], a[92:95], v[88:91], v[118:121]
    s_add_u32 m0, s42, 57344
    ds_read_b64_tr_b16 a[102:103], v30 offset:512
    v_mfma_f32_16x16x32_bf16 v[100:103], a[84:87], v[32:35], v[100:103]
    buffer_load_dwordx4 v22, s[12:15], s54 offen lds
    v_mfma_f32_16x16x32_bf16 v[104:107], a[88:91], v[32:35], v[104:107]
    ds_read_b64_tr_b16 a[104:105], v31 offset:0
    v_mfma_f32_16x16x32_bf16 v[108:111], a[92:95], v[32:35], v[108:111]
    ds_read_b64_tr_b16 a[106:107], v31 offset:512
    s_waitcnt lgkmcnt(4)
    v_mfma_f32_16x16x32_bf16 v[44:47], a[96:99], v[68:71], v[44:47]
    s_add_u32 m0, s42, 58368
    ds_read_b128 v[80:83], v5 offset:16384
    v_mfma_f32_16x16x32_bf16 v[48:51], a[96:99], v[72:75], v[48:51]
    ds_read_b128 v[84:87], v5 offset:18432
    v_mfma_f32_16x16x32_bf16 v[92:95], a[96:99], v[76:79], v[92:95]
    ds_read_b128 v[88:91], v5 offset:40960
    s_waitcnt lgkmcnt(5)
    v_mfma_f32_16x16x32_bf16 v[52:55], a[100:103], v[68:71], v[52:55]
    ds_read_b64_tr_b16 a[108:109], v29 offset:4096
    v_mfma_f32_16x16x32_bf16 v[56:59], a[100:103], v[72:75], v[56:59]
    ds_read_b64_tr_b16 a[110:111], v29 offset:4608
    v_mfma_f32_16x16x32_bf16 v[96:99], a[100:103], v[76:79], v[96:99]
    ds_read_b64_tr_b16 a[112:113], v30 offset:4096
    s_waitcnt lgkmcnt(6)
    v_mfma_f32_16x16x32_bf16 v[60:63], a[104:107], v[68:71], v[60:63]
    ds_read_b64_tr_b16 a[114:115], v30 offset:4608
    v_mfma_f32_16x16x32_bf16 v[64:67], a[104:107], v[72:75], v[64:67]
    ds_read_b64_tr_b16 a[116:117], v31 offset:4096
    v_mfma_f32_16x16x32_bf16 v[118:121], a[104:107], v[76:79], v[118:121]
    ds_read_b64_tr_b16 a[118:119], v31 offset:4608
    v_mfma_f32_16x16x32_bf16 v[100:103], a[96:99], v[32:35], v[100:103]
    buffer_load_dwordx4 v23, s[12:15], s54 offen lds
    v_mfma_f32_16x16x32_bf16 v[104:107], a[100:103], v[32:35], v[104:107]
    s_add_u32 m0, s42, 65536
    s_nop 0
    buffer_load_dwordx4 v24, s[12:15], s54 offen lds
    v_mfma_f32_16x16x32_bf16 v[108:111], a[104:107], v[32:35], v[108:111]
    s_add_u32 m0, s42, 66560
    s_nop 0
    buffer_load_dwordx4 v25, s[12:15], s54 offen lds
    s_add_u32 s54, s54, 393216
    s_waitcnt vmcnt(15) lgkmcnt(0)
    s_barrier
    v_mfma_f32_16x16x32_bf16 v[44:47], a[108:111], v[80:83], v[44:47]
    s_add_u32 m0, s43, 146432
    ds_read_b128 v[68:71], v4 offset:20480
    ds_read_b128 v[72:75], v4 offset:22528
    v_mfma_f32_16x16x32_bf16 v[48:51], a[108:111], v[84:87], v[48:51]
    ds_read_b128 v[76:79], v4 offset:43008
    ds_read_b64_tr_b16 a[120:121], v26 offset:0
    v_mfma_f32_16x16x32_bf16 v[92:95], a[108:111], v[88:91], v[92:95]
    buffer_load_dwordx4 v6, s[8:11], s53 offen offset:1024 sc1 lds
    v_mfma_f32_16x16x32_bf16 v[52:55], a[112:115], v[80:83], v[52:55]
    s_add_u32 m0, s43, 97280
    ds_read_b64_tr_b16 a[122:123], v26 offset:512
    v_mfma_f32_16x16x32_bf16 v[56:59], a[112:115], v[84:87], v[56:59]
    buffer_load_dwordx4 v6, s[8:11], s41 offen offset:1024 sc1 lds
    v_mfma_f32_16x16x32_bf16 v[96:99], a[112:115], v[88:91], v[96:99]
    s_add_u32 m0, s42, 73728
    ds_read_b64_tr_b16 a[124:125], v27 offset:0
    v_mfma_f32_16x16x32_bf16 v[60:63], a[116:119], v[80:83], v[60:63]
    ds_read_b64_tr_b16 a[126:127], v27 offset:512
    v_mfma_f32_16x16x32_bf16 v[64:67], a[116:119], v[84:87], v[64:67]
    buffer_load_dwordx4 v20, s[12:15], s54 offen lds
    v_mfma_f32_16x16x32_bf16 v[118:121], a[116:119], v[88:91], v[118:121]
    s_add_u32 m0, s42, 74752
    ds_read_b64_tr_b16 a[128:129], v28 offset:0
    v_mfma_f32_16x16x32_bf16 v[100:103], a[108:111], v[32:35], v[100:103]
    buffer_load_dwordx4 v21, s[12:15], s54 offen lds
    v_mfma_f32_16x16x32_bf16 v[104:107], a[112:115], v[32:35], v[104:107]
    s_add_u32 m0, s42, 81920
    ds_read_b64_tr_b16 a[130:131], v28 offset:512
    v_mfma_f32_16x16x32_bf16 v[108:111], a[116:119], v[32:35], v[108:111]
    buffer_load_dwordx4 v22, s[12:15], s54 offen lds
    s_waitcnt lgkmcnt(4)
    v_mfma_f32_16x16x32_bf16 v[44:47], a[120:123], v[68:71], v[44:47]
    s_add_u32 m0, s42, 82944
    ds_read_b128 v[80:83], v5 offset:20480
    v_mfma_f32_16x16x32_bf16 v[48:51], a[120:123], v[72:75], v[48:51]
    ds_read_b128 v[84:87], v5 offset:22528
    v_mfma_f32_16x16x32_bf16 v[92:95], a[120:123], v[76:79], v[92:95]
    ds_read_b128 v[88:91], v5 offset:43008
    s_waitcnt lgkmcnt(5)
    v_mfma_f32_16x16x32_bf16 v[52:55], a[124:127], v[68:71], v[52:55]
    ds_read_b64_tr_b16 a[132:133], v26 offset:4096
    v_mfma_f32_16x16x32_bf16 v[56:59], a[124:127], v[72:75], v[56:59]
    ds_read_b64_tr_b16 a[134:135], v26 offset:4608
    v_mfma_f32_16x16x32_bf16 v[96:99], a[124:127], v[76:79], v[96:99]
    ds_read_b64_tr_b16 a[136:137], v27 offset:4096
    s_waitcnt lgkmcnt(6)
    v_mfma_f32_16x16x32_bf16 v[60:63], a[128:131], v[68:71], v[60:63]
    ds_read_b64_tr_b16 a[138:139], v27 offset:4608
    v_mfma_f32_16x16x32_bf16 v[64:67], a[128:131], v[72:75], v[64:67]
    ds_read_b64_tr_b16 a[140:141], v28 offset:4096
    v_mfma_f32_16x16x32_bf16 v[118:121], a[128:131], v[76:79], v[118:121]
    ds_read_b64_tr_b16 a[142:143], v28 offset:4608
    v_mfma_f32_16x16x32_bf16 v[100:103], a[120:123], v[32:35], v[100:103]
    buffer_load_dwordx4 v23, s[12:15], s54 offen lds
    v_mfma_f32_16x16x32_bf16 v[104:107], a[124:127], v[32:35], v[104:107]
    s_add_u32 m0, s42, 90112
    s_nop 0
    buffer_load_dwordx4 v24, s[12:15], s54 offen lds
    v_mfma_f32_16x16x32_bf16 v[108:111], a[128:131], v[32:35], v[108:111]
    s_add_u32 m0, s42, 91136
    s_nop 0
    buffer_load_dwordx4 v25, s[12:15], s54 offen lds
    s_add_u32 s54, s54, 393216
    s_waitcnt vmcnt(15) lgkmcnt(0)
    s_barrier
    v_mfma_f32_16x16x32_bf16 v[44:47], a[132:135], v[80:83], v[44:47]
    s_add_u32 m0, s43, 101248
    ds_read_b128 v[68:71], v4 offset:24576
    ds_read_b128 v[72:75], v4 offset:26624
    v_mfma_f32_16x16x32_bf16 v[48:51], a[132:135], v[84:87], v[48:51]
    ds_read_b128 v[76:79], v4 offset:45056
    v_mfma_f32_16x16x32_bf16 v[92:95], a[132:135], v[88:91], v[92:95]
    buffer_load_dwordx4 v6, s[8:11], s41 offen offset:1152 sc1 lds
    v_mfma_f32_16x16x32_bf16 v[52:55], a[136:139], v[80:83], v[52:55]
    s_add_u32 m0, s42, 0
    ds_read_b64_tr_b16 a[144:145], v26 offset:24576
    v_mfma_f32_16x16x32_bf16 v[56:59], a[136:139], v[84:87], v[56:59]
    buffer_load_dwordx4 v20, s[12:15], s54 offen lds
    v_mfma_f32_16x16x32_bf16 v[96:99], a[136:139], v[88:91], v[96:99]
    s_add_u32 m0, s42, 1024
    ds_read_b64_tr_b16 a[146:147], v26 offset:25088
    v_mfma_f32_16x16x32_bf16 v[60:63], a[140:143], v[80:83], v[60:63]
    ds_read_b64_tr_b16 a[148:149], v27 offset:24576
    v_mfma_f32_16x16x32_bf16 v[64:67], a[140:143], v[84:87], v[64:67]
    buffer_load_dwordx4 v21, s[12:15], s54 offen lds
    v_mfma_f32_16x16x32_bf16 v[118:121], a[140:143], v[88:91], v[118:121]
    s_add_u32 m0, s42, 8192
    ds_read_b64_tr_b16 a[150:151], v27 offset:25088
    v_mfma_f32_16x16x32_bf16 v[100:103], a[132:135], v[32:35], v[100:103]
    buffer_load_dwordx4 v22, s[12:15], s54 offen lds
    v_mfma_f32_16x16x32_bf16 v[104:107], a[136:139], v[32:35], v[104:107]
    ds_read_b64_tr_b16 a[152:153], v28 offset:24576
    v_mfma_f32_16x16x32_bf16 v[108:111], a[140:143], v[32:35], v[108:111]
    ds_read_b64_tr_b16 a[154:155], v28 offset:25088
    s_waitcnt lgkmcnt(4)
    v_mfma_f32_16x16x32_bf16 v[44:47], a[144:147], v[68:71], v[44:47]
    s_add_u32 m0, s42, 9216
    ds_read_b128 v[80:83], v5 offset:24576
    v_mfma_f32_16x16x32_bf16 v[48:51], a[144:147], v[72:75], v[48:51]
    ds_read_b128 v[84:87], v5 offset:26624
    v_mfma_f32_16x16x32_bf16 v[92:95], a[144:147], v[76:79], v[92:95]
    ds_read_b128 v[88:91], v5 offset:45056
    s_waitcnt lgkmcnt(5)
    v_mfma_f32_16x16x32_bf16 v[52:55], a[148:151], v[68:71], v[52:55]
    ds_read_b64_tr_b16 a[156:157], v26 offset:28672
    v_mfma_f32_16x16x32_bf16 v[56:59], a[148:151], v[72:75], v[56:59]
    ds_read_b64_tr_b16 a[158:159], v26 offset:29184
    v_mfma_f32_16x16x32_bf16 v[96:99], a[148:151], v[76:79], v[96:99]
    ds_read_b64_tr_b16 a[160:161], v27 offset:28672
    s_waitcnt lgkmcnt(6)
    v_mfma_f32_16x16x32_bf16 v[60:63], a[152:155], v[68:71], v[60:63]
    ds_read_b64_tr_b16 a[162:163], v27 offset:29184
    v_mfma_f32_16x16x32_bf16 v[64:67], a[152:155], v[72:75], v[64:67]
    ds_read_b64_tr_b16 a[164:165], v28 offset:28672
    v_mfma_f32_16x16x32_bf16 v[118:121], a[152:155], v[76:79], v[118:121]
    ds_read_b64_tr_b16 a[166:167], v28 offset:29184
    v_mfma_f32_16x16x32_bf16 v[100:103], a[144:147], v[32:35], v[100:103]
    buffer_load_dwordx4 v23, s[12:15], s54 offen lds
    v_mfma_f32_16x16x32_bf16 v[104:107], a[148:151], v[32:35], v[104:107]
    s_add_u32 m0, s42, 16384
    s_nop 0
    buffer_load_dwordx4 v24, s[12:15], s54 offen lds
    v_mfma_f32_16x16x32_bf16 v[108:111], a[152:155], v[32:35], v[108:111]
    s_add_u32 m0, s42, 17408
    s_nop 0
    buffer_load_dwordx4 v25, s[12:15], s54 offen lds
    s_add_u32 s54, s54, 393216
    s_waitcnt vmcnt(15) lgkmcnt(0)
    s_barrier
    v_mfma_f32_16x16x32_bf16 v[44:47], a[156:159], v[80:83], v[44:47]
    s_add_u32 m0, s43, 150272
    ds_read_b128 v[68:71], v4 offset:28672
    ds_read_b128 v[72:75], v4 offset:30720
    v_mfma_f32_16x16x32_bf16 v[48:51], a[156:159], v[84:87], v[48:51]
    ds_read_b128 v[76:79], v4 offset:47104
    ds_read_b64_tr_b16 a[168:169], v26 offset:49152
    v_mfma_f32_16x16x32_bf16 v[92:95], a[156:159], v[88:91], v[92:95]
    buffer_load_dwordx4 v6, s[8:11], s53 offen offset:1280 sc1 lds
    v_mfma_f32_16x16x32_bf16 v[52:55], a[160:163], v[80:83], v[52:55]
    s_add_u32 m0, s43, 105216
    ds_read_b64_tr_b16 a[170:171], v26 offset:49664
    v_mfma_f32_16x16x32_bf16 v[56:59], a[160:163], v[84:87], v[56:59]
    buffer_load_dwordx4 v6, s[8:11], s41 offen offset:1280 sc1 lds
    v_mfma_f32_16x16x32_bf16 v[96:99], a[160:163], v[88:91], v[96:99]
    s_add_u32 m0, s42, 24576
    ds_read_b64_tr_b16 a[172:173], v27 offset:49152
    v_mfma_f32_16x16x32_bf16 v[60:63], a[164:167], v[80:83], v[60:63]
    ds_read_b64_tr_b16 a[174:175], v27 offset:49664
    v_mfma_f32_16x16x32_bf16 v[64:67], a[164:167], v[84:87], v[64:67]
    buffer_load_dwordx4 v20, s[12:15], s54 offen lds
    v_mfma_f32_16x16x32_bf16 v[118:121], a[164:167], v[88:91], v[118:121]
    s_add_u32 m0, s42, 25600
    ds_read_b64_tr_b16 a[176:177], v28 offset:49152
    v_mfma_f32_16x16x32_bf16 v[100:103], a[156:159], v[32:35], v[100:103]
    buffer_load_dwordx4 v21, s[12:15], s54 offen lds
    v_mfma_f32_16x16x32_bf16 v[104:107], a[160:163], v[32:35], v[104:107]
    s_add_u32 m0, s42, 32768
    ds_read_b64_tr_b16 a[178:179], v28 offset:49664
    v_mfma_f32_16x16x32_bf16 v[108:111], a[164:167], v[32:35], v[108:111]
    buffer_load_dwordx4 v22, s[12:15], s54 offen lds
    s_waitcnt lgkmcnt(4)
    v_mfma_f32_16x16x32_bf16 v[44:47], a[168:171], v[68:71], v[44:47]
    s_add_u32 m0, s42, 33792
    ds_read_b128 v[80:83], v5 offset:28672
    v_mfma_f32_16x16x32_bf16 v[48:51], a[168:171], v[72:75], v[48:51]
    ds_read_b128 v[84:87], v5 offset:30720
    v_mfma_f32_16x16x32_bf16 v[92:95], a[168:171], v[76:79], v[92:95]
    ds_read_b128 v[88:91], v5 offset:47104
    s_waitcnt lgkmcnt(5)
    v_mfma_f32_16x16x32_bf16 v[52:55], a[172:175], v[68:71], v[52:55]
    ds_read_b64_tr_b16 a[180:181], v26 offset:53248
    v_mfma_f32_16x16x32_bf16 v[56:59], a[172:175], v[72:75], v[56:59]
    ds_read_b64_tr_b16 a[182:183], v26 offset:53760
    v_mfma_f32_16x16x32_bf16 v[96:99], a[172:175], v[76:79], v[96:99]
    ds_read_b64_tr_b16 a[184:185], v27 offset:53248
    s_waitcnt lgkmcnt(6)
    v_mfma_f32_16x16x32_bf16 v[60:63], a[176:179], v[68:71], v[60:63]
    ds_read_b64_tr_b16 a[186:187], v27 offset:53760
    v_mfma_f32_16x16x32_bf16 v[64:67], a[176:179], v[72:75], v[64:67]
    ds_read_b64_tr_b16 a[188:189], v28 offset:53248
    v_mfma_f32_16x16x32_bf16 v[118:121], a[176:179], v[76:79], v[118:121]
    ds_read_b64_tr_b16 a[190:191], v28 offset:53760
    v_mfma_f32_16x16x32_bf16 v[100:103], a[168:171], v[32:35], v[100:103]
    buffer_load_dwordx4 v23, s[12:15], s54 offen lds
    v_mfma_f32_16x16x32_bf16 v[104:107], a[172:175], v[32:35], v[104:107]
    s_add_u32 m0, s42, 40960
    s_nop 0
    buffer_load_dwordx4 v24, s[12:15], s54 offen lds
    v_mfma_f32_16x16x32_bf16 v[108:111], a[176:179], v[32:35], v[108:111]
    s_add_u32 m0, s42, 41984
    s_nop 0
    buffer_load_dwordx4 v25, s[12:15], s54 offen lds
    s_add_u32 s54, s54, 393216
    s_waitcnt vmcnt(15) lgkmcnt(0)
    s_barrier
    v_mfma_f32_16x16x32_bf16 v[44:47], a[180:183], v[80:83], v[44:47]
    s_add_u32 m0, s43, 109184
    ds_read_b128 v[68:71], v4 offset:0
    ds_read_b128 v[72:75], v4 offset:2048
    v_mfma_f32_16x16x32_bf16 v[48:51], a[180:183], v[84:87], v[48:51]
    ds_read_b128 v[76:79], v4 offset:49152
    v_mfma_f32_16x16x32_bf16 v[92:95], a[180:183], v[88:91], v[92:95]
    buffer_load_dwordx4 v6, s[8:11], s41 offen offset:1408 sc1 lds
    v_mfma_f32_16x16x32_bf16 v[52:55], a[184:187], v[80:83], v[52:55]
    s_add_u32 m0, s42, 49152
    ds_read_b64_tr_b16 a[192:193], v29 offset:0
    v_mfma_f32_16x16x32_bf16 v[56:59], a[184:187], v[84:87], v[56:59]
    buffer_load_dwordx4 v20, s[12:15], s54 offen lds
    v_mfma_f32_16x16x32_bf16 v[96:99], a[184:187], v[88:91], v[96:99]
    s_add_u32 m0, s42, 50176
    ds_read_b64_tr_b16 a[194:195], v29 offset:512
    v_mfma_f32_16x16x32_bf16 v[60:63], a[188:191], v[80:83], v[60:63]
    ds_read_b64_tr_b16 a[196:197], v30 offset:0
    v_mfma_f32_16x16x32_bf16 v[64:67], a[188:191], v[84:87], v[64:67]
    buffer_load_dwordx4 v21, s[12:15], s54 offen lds
    v_mfma_f32_16x16x32_bf16 v[118:121], a[188:191], v[88:91], v[118:121]
    s_add_u32 m0, s42, 57344
    ds_read_b64_tr_b16 a[198:199], v30 offset:512
    v_mfma_f32_16x16x32_bf16 v[100:103], a[180:183], v[32:35], v[100:103]
    buffer_load_dwordx4 v22, s[12:15], s54 offen lds
    v_mfma_f32_16x16x32_bf16 v[104:107], a[184:187], v[32:35], v[104:107]
    ds_read_b64_tr_b16 a[200:201], v31 offset:0
    v_mfma_f32_16x16x32_bf16 v[108:111], a[188:191], v[32:35], v[108:111]
    ds_read_b64_tr_b16 a[202:203], v31 offset:512
    s_waitcnt lgkmcnt(4)
    v_mfma_f32_16x16x32_bf16 v[44:47], a[192:195], v[68:71], v[44:47]
    s_add_u32 m0, s42, 58368
    ds_read_b128 v[80:83], v5 offset:0
    v_mfma_f32_16x16x32_bf16 v[48:51], a[192:195], v[72:75], v[48:51]
    ds_read_b128 v[84:87], v5 offset:2048
    v_mfma_f32_16x16x32_bf16 v[92:95], a[192:195], v[76:79], v[92:95]
    ds_read_b128 v[88:91], v5 offset:49152
    s_waitcnt lgkmcnt(5)
    v_mfma_f32_16x16x32_bf16 v[52:55], a[196:199], v[68:71], v[52:55]
    ds_read_b64_tr_b16 a[204:205], v29 offset:4096
    v_mfma_f32_16x16x32_bf16 v[56:59], a[196:199], v[72:75], v[56:59]
    ds_read_b64_tr_b16 a[206:207], v29 offset:4608
    v_mfma_f32_16x16x32_bf16 v[96:99], a[196:199], v[76:79], v[96:99]
    ds_read_b64_tr_b16 a[208:209], v30 offset:4096
    s_waitcnt lgkmcnt(6)
    v_mfma_f32_16x16x32_bf16 v[60:63], a[200:203], v[68:71], v[60:63]
    ds_read_b64_tr_b16 a[210:211], v30 offset:4608
    v_mfma_f32_16x16x32_bf16 v[64:67], a[200:203], v[72:75], v[64:67]
    ds_read_b64_tr_b16 a[212:213], v31 offset:4096
    v_mfma_f32_16x16x32_bf16 v[118:121], a[200:203], v[76:79], v[118:121]
    ds_read_b64_tr_b16 a[214:215], v31 offset:4608
    v_mfma_f32_16x16x32_bf16 v[100:103], a[192:195], v[32:35], v[100:103]
    buffer_load_dwordx4 v23, s[12:15], s54 offen lds
    v_mfma_f32_16x16x32_bf16 v[104:107], a[196:199], v[32:35], v[104:107]
    s_add_u32 m0, s42, 65536
    s_nop 0
    buffer_load_dwordx4 v24, s[12:15], s54 offen lds
    v_mfma_f32_16x16x32_bf16 v[108:111], a[200:203], v[32:35], v[108:111]
    s_add_u32 m0, s42, 66560
    s_nop 0
    buffer_load_dwordx4 v25, s[12:15], s54 offen lds
    s_add_u32 s54, s54, 393216
    s_waitcnt vmcnt(15) lgkmcnt(0)
    s_barrier
    v_mfma_f32_16x16x32_bf16 v[44:47], a[204:207], v[80:83], v[44:47]
    s_add_u32 m0, s43, 154112
    ds_read_b128 v[68:71], v4 offset:4096
    ds_read_b128 v[72:75], v4 offset:6144
    v_mfma_f32_16x16x32_bf16 v[48:51], a[204:207], v[84:87], v[48:51]
    ds_read_b128 v[76:79], v4 offset:51200
    ds_read_b64_tr_b16 a[216:217], v26 offset:0
    v_mfma_f32_16x16x32_bf16 v[92:95], a[204:207], v[88:91], v[92:95]
    buffer_load_dwordx4 v6, s[8:11], s53 offen offset:1536 sc1 lds
    v_mfma_f32_16x16x32_bf16 v[52:55], a[208:211], v[80:83], v[52:55]
    s_add_u32 m0, s43, 113152
    ds_read_b64_tr_b16 a[218:219], v26 offset:512
    v_mfma_f32_16x16x32_bf16 v[56:59], a[208:211], v[84:87], v[56:59]
    buffer_load_dwordx4 v6, s[8:11], s41 offen offset:1536 sc1 lds
    v_mfma_f32_16x16x32_bf16 v[96:99], a[208:211], v[88:91], v[96:99]
    s_add_u32 m0, s42, 73728
    ds_read_b64_tr_b16 a[220:221], v27 offset:0
    v_mfma_f32_16x16x32_bf16 v[60:63], a[212:215], v[80:83], v[60:63]
    ds_read_b64_tr_b16 a[222:223], v27 offset:512
    v_mfma_f32_16x16x32_bf16 v[64:67], a[212:215], v[84:87], v[64:67]
    buffer_load_dwordx4 v20, s[12:15], s54 offen lds
    v_mfma_f32_16x16x32_bf16 v[118:121], a[212:215], v[88:91], v[118:121]
    s_add_u32 m0, s42, 74752
    ds_read_b64_tr_b16 a[224:225], v28 offset:0
    v_mfma_f32_16x16x32_bf16 v[100:103], a[204:207], v[32:35], v[100:103]
    buffer_load_dwordx4 v21, s[12:15], s54 offen lds
    v_mfma_f32_16x16x32_bf16 v[104:107], a[208:211], v[32:35], v[104:107]
    s_add_u32 m0, s42, 81920
    ds_read_b64_tr_b16 a[226:227], v28 offset:512
    v_mfma_f32_16x16x32_bf16 v[108:111], a[212:215], v[32:35], v[108:111]
    buffer_load_dwordx4 v22, s[12:15], s54 offen lds
    s_waitcnt lgkmcnt(4)
    v_mfma_f32_16x16x32_bf16 v[44:47], a[216:219], v[68:71], v[44:47]
    s_add_u32 m0, s42, 82944
    ds_read_b128 v[80:83], v5 offset:4096
    v_mfma_f32_16x16x32_bf16 v[48:51], a[216:219], v[72:75], v[48:51]
    ds_read_b128 v[84:87], v5 offset:6144
    v_mfma_f32_16x16x32_bf16 v[92:95], a[216:219], v[76:79], v[92:95]
    ds_read_b128 v[88:91], v5 offset:51200
    s_waitcnt lgkmcnt(5)
    v_mfma_f32_16x16x32_bf16 v[52:55], a[220:223], v[68:71], v[52:55]
    ds_read_b64_tr_b16 a[228:229], v26 offset:4096
    v_mfma_f32_16x16x32_bf16 v[56:59], a[220:223], v[72:75], v[56:59]
    ds_read_b64_tr_b16 a[230:231], v26 offset:4608
    v_mfma_f32_16x16x32_bf16 v[96:99], a[220:223], v[76:79], v[96:99]
    ds_read_b64_tr_b16 a[232:233], v27 offset:4096
    s_waitcnt lgkmcnt(6)
    v_mfma_f32_16x16x32_bf16 v[60:63], a[224:227], v[68:71], v[60:63]
    ds_read_b64_tr_b16 a[234:235], v27 offset:4608
    v_mfma_f32_16x16x32_bf16 v[64:67], a[224:227], v[72:75], v[64:67]
    ds_read_b64_tr_b16 a[236:237], v28 offset:4096
    v_mfma_f32_16x16x32_bf16 v[118:121], a[224:227], v[76:79], v[118:121]
    ds_read_b64_tr_b16 a[238:239], v28 offset:4608
    v_mfma_f32_16x16x32_bf16 v[100:103], a[216:219], v[32:35], v[100:103]
    buffer_load_dwordx4 v23, s[12:15], s54 offen lds
    v_mfma_f32_16x16x32_bf16 v[104:107], a[220:223], v[32:35], v[104:107]
    s_add_u32 m0, s42, 90112
    s_nop 0
    buffer_load_dwordx4 v24, s[12:15], s54 offen lds
    v_mfma_f32_16x16x32_bf16 v[108:111], a[224:227], v[32:35], v[108:111]
    s_add_u32 m0, s42, 91136
    s_nop 0
    buffer_load_dwordx4 v25, s[12:15], s54 offen lds
    s_add_u32 s54, s54, 393216
    s_waitcnt vmcnt(15) lgkmcnt(0)
    s_barrier
    v_mfma_f32_16x16x32_bf16 v[44:47], a[228:231], v[80:83], v[44:47]
    s_add_u32 m0, s43, 117120
    ds_read_b128 v[68:71], v4 offset:8192
    ds_read_b128 v[72:75], v4 offset:10240
    v_mfma_f32_16x16x32_bf16 v[48:51], a[228:231], v[84:87], v[48:51]
    ds_read_b128 v[76:79], v4 offset:53248
    v_mfma_f32_16x16x32_bf16 v[92:95], a[228:231], v[88:91], v[92:95]
    buffer_load_dwordx4 v6, s[8:11], s41 offen offset:1664 sc1 lds
    v_mfma_f32_16x16x32_bf16 v[52:55], a[232:235], v[80:83], v[52:55]
    s_add_u32 m0, s42, 0
    ds_read_b64_tr_b16 a[240:241], v26 offset:24576
    v_mfma_f32_16x16x32_bf16 v[56:59], a[232:235], v[84:87], v[56:59]
    buffer_load_dwordx4 v20, s[12:15], s54 offen lds
    v_mfma_f32_16x16x32_bf16 v[96:99], a[232:235], v[88:91], v[96:99]
    s_add_u32 m0, s42, 1024
    ds_read_b64_tr_b16 a[242:243], v26 offset:25088
    v_mfma_f32_16x16x32_bf16 v[60:63], a[236:239], v[80:83], v[60:63]
    ds_read_b64_tr_b16 a[244:245], v27 offset:24576
    v_mfma_f32_16x16x32_bf16 v[64:67], a[236:239], v[84:87], v[64:67]
    buffer_load_dwordx4 v21, s[12:15], s54 offen lds
    v_mfma_f32_16x16x32_bf16 v[118:121], a[236:239], v[88:91], v[118:121]
    s_add_u32 m0, s42, 8192
    ds_read_b64_tr_b16 a[246:247], v27 offset:25088
    v_mfma_f32_16x16x32_bf16 v[100:103], a[228:231], v[32:35], v[100:103]
    buffer_load_dwordx4 v22, s[12:15], s54 offen lds
    v_mfma_f32_16x16x32_bf16 v[104:107], a[232:235], v[32:35], v[104:107]
    ds_read_b64_tr_b16 a[248:249], v28 offset:24576
    v_mfma_f32_16x16x32_bf16 v[108:111], a[236:239], v[32:35], v[108:111]
    ds_read_b64_tr_b16 a[250:251], v28 offset:25088
    s_waitcnt lgkmcnt(4)
    v_mfma_f32_16x16x32_bf16 v[44:47], a[240:243], v[68:71], v[44:47]
    s_add_u32 m0, s42, 9216
    ds_read_b128 v[80:83], v5 offset:8192
    v_mfma_f32_16x16x32_bf16 v[48:51], a[240:243], v[72:75], v[48:51]
    ds_read_b128 v[84:87], v5 offset:10240
    v_mfma_f32_16x16x32_bf16 v[92:95], a[240:243], v[76:79], v[92:95]
    ds_read_b128 v[88:91], v5 offset:53248
    s_waitcnt lgkmcnt(5)
    v_mfma_f32_16x16x32_bf16 v[52:55], a[244:247], v[68:71], v[52:55]
    ds_read_b64_tr_b16 a[252:253], v26 offset:28672
    v_mfma_f32_16x16x32_bf16 v[56:59], a[244:247], v[72:75], v[56:59]
    ds_read_b64_tr_b16 a[254:255], v26 offset:29184
    v_mfma_f32_16x16x32_bf16 v[96:99], a[244:247], v[76:79], v[96:99]
    ds_read_b64_tr_b16 v[128:129], v27 offset:28672
    s_waitcnt lgkmcnt(6)
    v_mfma_f32_16x16x32_bf16 v[60:63], a[248:251], v[68:71], v[60:63]
    ds_read_b64_tr_b16 v[130:131], v27 offset:29184
    v_mfma_f32_16x16x32_bf16 v[64:67], a[248:251], v[72:75], v[64:67]
    ds_read_b64_tr_b16 v[132:133], v28 offset:28672
    v_mfma_f32_16x16x32_bf16 v[118:121], a[248:251], v[76:79], v[118:121]
    ds_read_b64_tr_b16 v[134:135], v28 offset:29184
    v_mfma_f32_16x16x32_bf16 v[100:103], a[240:243], v[32:35], v[100:103]
    buffer_load_dwordx4 v23, s[12:15], s54 offen lds
    v_mfma_f32_16x16x32_bf16 v[104:107], a[244:247], v[32:35], v[104:107]
    s_add_u32 m0, s42, 16384
    s_nop 0
    buffer_load_dwordx4 v24, s[12:15], s54 offen lds
    v_mfma_f32_16x16x32_bf16 v[108:111], a[248:251], v[32:35], v[108:111]
    s_add_u32 m0, s42, 17408
    s_nop 0
    buffer_load_dwordx4 v25, s[12:15], s54 offen lds
    s_add_u32 s54, s54, 393216
    s_waitcnt vmcnt(15) lgkmcnt(0)
    s_barrier
    v_mfma_f32_16x16x32_bf16 v[44:47], a[252:255], v[80:83], v[44:47]
    buffer_load_dword v37, v36, s[20:23], 64 offen sc1
    v_mfma_f32_16x16x32_bf16 v[48:51], a[252:255], v[84:87], v[48:51]
    s_add_u32 m0, s43, 157952
    ds_read_b128 v[68:71], v4 offset:12288
    ds_read_b128 v[72:75], v4 offset:14336
    v_mfma_f32_16x16x32_bf16 v[92:95], a[252:255], v[88:91], v[92:95]
    buffer_load_dwordx4 v6, s[8:11], s53 offen offset:1792 sc1 lds
    v_mfma_f32_16x16x32_bf16 v[52:55], v[128:131], v[80:83], v[52:55]
    s_add_u32 m0, s43, 121088
    ds_read_b128 v[76:79], v4 offset:55296
    ds_read_b64_tr_b16 v[136:137], v26 offset:49152
    v_mfma_f32_16x16x32_bf16 v[56:59], v[128:131], v[84:87], v[56:59]
    buffer_load_dwordx4 v6, s[8:11], s41 offen offset:1792 sc1 lds
    v_mfma_f32_16x16x32_bf16 v[96:99], v[128:131], v[88:91], v[96:99]
    s_add_u32 m0, s42, 24576
    ds_read_b64_tr_b16 v[138:139], v26 offset:49664
    ds_read_b64_tr_b16 v[140:141], v27 offset:49152
    v_mfma_f32_16x16x32_bf16 v[60:63], v[132:135], v[80:83], v[60:63]
    ds_read_b64_tr_b16 v[142:143], v27 offset:49664
    v_mfma_f32_16x16x32_bf16 v[64:67], v[132:135], v[84:87], v[64:67]
    buffer_load_dwordx4 v20, s[12:15], s54 offen lds
    v_mfma_f32_16x16x32_bf16 v[118:121], v[132:135], v[88:91], v[118:121]
    s_add_u32 m0, s42, 25600
    ds_read_b64_tr_b16 v[144:145], v28 offset:49152
    v_mfma_f32_16x16x32_bf16 v[100:103], a[252:255], v[32:35], v[100:103]
    buffer_load_dwordx4 v21, s[12:15], s54 offen lds
    v_mfma_f32_16x16x32_bf16 v[104:107], v[128:131], v[32:35], v[104:107]
    s_add_u32 m0, s42, 32768
    ds_read_b64_tr_b16 v[146:147], v28 offset:49664
    v_mfma_f32_16x16x32_bf16 v[108:111], v[132:135], v[32:35], v[108:111]
    buffer_load_dwordx4 v22, s[12:15], s54 offen lds
    s_waitcnt lgkmcnt(4)
    v_mfma_f32_16x16x32_bf16 v[44:47], v[136:139], v[68:71], v[44:47]
    s_add_u32 m0, s42, 33792
    ds_read_b128 v[80:83], v5 offset:12288
    v_mfma_f32_16x16x32_bf16 v[48:51], v[136:139], v[72:75], v[48:51]
    ds_read_b128 v[84:87], v5 offset:14336
    v_mfma_f32_16x16x32_bf16 v[92:95], v[136:139], v[76:79], v[92:95]
    ds_read_b128 v[88:91], v5 offset:55296
    s_waitcnt lgkmcnt(5)
    v_mfma_f32_16x16x32_bf16 v[52:55], v[140:143], v[68:71], v[52:55]
    ds_read_b64_tr_b16 v[148:149], v26 offset:53248
    v_mfma_f32_16x16x32_bf16 v[56:59], v[140:143], v[72:75], v[56:59]
    ds_read_b64_tr_b16 v[150:151], v26 offset:53760
    v_mfma_f32_16x16x32_bf16 v[96:99], v[140:143], v[76:79], v[96:99]
    ds_read_b64_tr_b16 v[152:153], v27 offset:53248
    s_waitcnt lgkmcnt(6)
    v_mfma_f32_16x16x32_bf16 v[60:63], v[144:147], v[68:71], v[60:63]
    ds_read_b64_tr_b16 v[154:155], v27 offset:53760
    v_mfma_f32_16x16x32_bf16 v[64:67], v[144:147], v[72:75], v[64:67]
    ds_read_b64_tr_b16 v[156:157], v28 offset:53248
    v_mfma_f32_16x16x32_bf16 v[118:121], v[144:147], v[76:79], v[118:121]
    ds_read_b64_tr_b16 v[158:159], v28 offset:53760
    v_mfma_f32_16x16x32_bf16 v[100:103], v[136:139], v[32:35], v[100:103]
    buffer_load_dwordx4 v23, s[12:15], s54 offen lds
    v_mfma_f32_16x16x32_bf16 v[104:107], v[140:143], v[32:35], v[104:107]
    s_add_u32 m0, s42, 40960
    s_nop 0
    buffer_load_dwordx4 v24, s[12:15], s54 offen lds
    v_mfma_f32_16x16x32_bf16 v[108:111], v[144:147], v[32:35], v[108:111]
    s_add_u32 m0, s42, 41984
    s_nop 0
    buffer_load_dwordx4 v25, s[12:15], s54 offen lds
    s_add_u32 s54, s54, 393216
    s_waitcnt vmcnt(16) lgkmcnt(0)
    s_barrier
    v_mfma_f32_16x16x32_bf16 v[44:47], v[148:151], v[80:83], v[44:47]
    s_add_u32 m0, s43, 125056
    ds_read_b128 v[68:71], v4 offset:16384
    ds_read_b128 v[72:75], v4 offset:18432
    v_mfma_f32_16x16x32_bf16 v[48:51], v[148:151], v[84:87], v[48:51]
    ds_read_b128 v[76:79], v4 offset:57344
    v_mfma_f32_16x16x32_bf16 v[92:95], v[148:151], v[88:91], v[92:95]
    buffer_load_dwordx4 v6, s[8:11], s41 offen offset:1920 sc1 lds
    v_mfma_f32_16x16x32_bf16 v[52:55], v[152:155], v[80:83], v[52:55]
    s_add_u32 m0, s42, 49152
    ds_read_b64_tr_b16 v[160:161], v29 offset:0
    v_mfma_f32_16x16x32_bf16 v[56:59], v[152:155], v[84:87], v[56:59]
    buffer_load_dwordx4 v20, s[12:15], s54 offen lds
    v_mfma_f32_16x16x32_bf16 v[96:99], v[152:155], v[88:91], v[96:99]
    s_add_u32 m0, s42, 50176
    ds_read_b64_tr_b16 v[162:163], v29 offset:512
    v_mfma_f32_16x16x32_bf16 v[60:63], v[156:159], v[80:83], v[60:63]
    ds_read_b64_tr_b16 v[164:165], v30 offset:0
    v_mfma_f32_16x16x32_bf16 v[64:67], v[156:159], v[84:87], v[64:67]
    buffer_load_dwordx4 v21, s[12:15], s54 offen lds
    v_mfma_f32_16x16x32_bf16 v[118:121], v[156:159], v[88:91], v[118:121]
    s_add_u32 m0, s42, 57344
    ds_read_b64_tr_b16 v[166:167], v30 offset:512
    v_mfma_f32_16x16x32_bf16 v[100:103], v[148:151], v[32:35], v[100:103]
    buffer_load_dwordx4 v22, s[12:15], s54 offen lds
    v_mfma_f32_16x16x32_bf16 v[104:107], v[152:155], v[32:35], v[104:107]
    ds_read_b64_tr_b16 v[168:169], v31 offset:0
    v_mfma_f32_16x16x32_bf16 v[108:111], v[156:159], v[32:35], v[108:111]
    ds_read_b64_tr_b16 v[170:171], v31 offset:512
    s_waitcnt lgkmcnt(4)
    v_mfma_f32_16x16x32_bf16 v[44:47], v[160:163], v[68:71], v[44:47]
    s_add_u32 m0, s42, 58368
    ds_read_b128 v[80:83], v5 offset:16384
    v_mfma_f32_16x16x32_bf16 v[48:51], v[160:163], v[72:75], v[48:51]
    ds_read_b128 v[84:87], v5 offset:18432
    v_mfma_f32_16x16x32_bf16 v[92:95], v[160:163], v[76:79], v[92:95]
    ds_read_b128 v[88:91], v5 offset:57344
    s_waitcnt lgkmcnt(5)
    v_mfma_f32_16x16x32_bf16 v[52:55], v[164:167], v[68:71], v[52:55]
    ds_read_b64_tr_b16 v[172:173], v29 offset:4096
    v_mfma_f32_16x16x32_bf16 v[56:59], v[164:167], v[72:75], v[56:59]
    ds_read_b64_tr_b16 v[174:175], v29 offset:4608
    v_mfma_f32_16x16x32_bf16 v[96:99], v[164:167], v[76:79], v[96:99]
    ds_read_b64_tr_b16 v[176:177], v30 offset:4096
    s_waitcnt lgkmcnt(6)
    v_mfma_f32_16x16x32_bf16 v[60:63], v[168:171], v[68:71], v[60:63]
    ds_read_b64_tr_b16 v[178:179], v30 offset:4608
    v_mfma_f32_16x16x32_bf16 v[64:67], v[168:171], v[72:75], v[64:67]
    ds_read_b64_tr_b16 v[180:181], v31 offset:4096
    v_mfma_f32_16x16x32_bf16 v[118:121], v[168:171], v[76:79], v[118:121]
    ds_read_b64_tr_b16 v[182:183], v31 offset:4608
    v_mfma_f32_16x16x32_bf16 v[100:103], v[160:163], v[32:35], v[100:103]
    buffer_load_dwordx4 v23, s[12:15], s54 offen lds
    v_mfma_f32_16x16x32_bf16 v[104:107], v[164:167], v[32:35], v[104:107]
    s_add_u32 m0, s42, 65536
    s_nop 0
    buffer_load_dwordx4 v24, s[12:15], s54 offen lds
    v_mfma_f32_16x16x32_bf16 v[108:111], v[168:171], v[32:35], v[108:111]
    s_add_u32 m0, s42, 66560
    s_nop 0
    buffer_load_dwordx4 v25, s[12:15], s54 offen lds
    s_add_u32 s54, s54, 393216
    s_waitcnt vmcnt(15) lgkmcnt(0)
    v_cmp_eq_u32 vcc, v36, v37
    s_cbranch_vccnz L_spin1
L_back2:
    s_barrier
    v_mfma_f32_16x16x32_bf16 v[44:47], v[172:175], v[80:83], v[44:47]
    s_lshl_b32 s53, s33, 15
    s_sub_u32 s53, 0x5418000, s53
    s_add_u32 m0, s52, 94208
    ds_read_b128 v[68:71], v4 offset:20480
    v_mfma_f32_16x16x32_bf16 v[48:51], v[172:175], v[84:87], v[48:51]
    ds_read_b128 v[72:75], v4 offset:22528
    v_mfma_f32_16x16x32_bf16 v[92:95], v[172:175], v[88:91], v[92:95]
    buffer_load_dwordx4 v1, s[16:19], s53 offen sc1 lds
    v_mfma_f32_16x16x32_bf16 v[52:55], v[176:179], v[80:83], v[52:55]
    ds_read_b128 v[76:79], v4 offset:59392
    v_mfma_f32_16x16x32_bf16 v[56:59], v[176:179], v[84:87], v[56:59]
    ds_read_b64_tr_b16 v[184:185], v26 offset:0
    v_mfma_f32_16x16x32_bf16 v[96:99], v[176:179], v[88:91], v[96:99]
    ds_read_b64_tr_b16 v[186:187], v26 offset:512
    v_mfma_f32_16x16x32_bf16 v[60:63], v[180:183], v[80:83], v[60:63]
    ds_read_b64_tr_b16 v[188:189], v27 offset:0
    v_mfma_f32_16x16x32_bf16 v[64:67], v[180:183], v[84:87], v[64:67]
    ds_read_b64_tr_b16 v[190:191], v27 offset:512
    v_mfma_f32_16x16x32_bf16 v[118:121], v[180:183], v[88:91], v[118:121]
    ds_read_b64_tr_b16 v[192:193], v28 offset:0
    v_mfma_f32_16x16x32_bf16 v[100:103], v[172:175], v[32:35], v[100:103]
    ds_read_b64_tr_b16 v[194:195], v28 offset:512
    v_mfma_f32_16x16x32_bf16 v[104:107], v[176:179], v[32:35], v[104:107]
    v_mfma_f32_16x16x32_bf16 v[108:111], v[180:183], v[32:35], v[108:111]
    s_waitcnt lgkmcnt(4)
    v_mfma_f32_16x16x32_bf16 v[44:47], v[184:187], v[68:71], v[44:47]
    s_add_u32 m0, s52, 92160
    ds_read_b128 v[80:83], v5 offset:20480
    v_mfma_f32_16x16x32_bf16 v[48:51], v[184:187], v[72:75], v[48:51]
    ds_read_b128 v[84:87], v5 offset:22528
    v_mfma_f32_16x16x32_bf16 v[92:95], v[184:187], v[76:79], v[92:95]
    ds_read_b128 v[88:91], v5 offset:59392
    s_waitcnt lgkmcnt(5)
    v_mfma_f32_16x16x32_bf16 v[52:55], v[188:191], v[68:71], v[52:55]
    ds_read_b64_tr_b16 v[196:197], v26 offset:4096
    v_mfma_f32_16x16x32_bf16 v[56:59], v[188:191], v[72:75], v[56:59]
    ds_read_b64_tr_b16 v[198:199], v26 offset:4608
    v_mfma_f32_16x16x32_bf16 v[96:99], v[188:191], v[76:79], v[96:99]
    ds_read_b64_tr_b16 v[200:201], v27 offset:4096
    s_waitcnt lgkmcnt(6)
    v_mfma_f32_16x16x32_bf16 v[60:63], v[192:195], v[68:71], v[60:63]
    ds_read_b64_tr_b16 v[202:203], v27 offset:4608
    v_mfma_f32_16x16x32_bf16 v[64:67], v[192:195], v[72:75], v[64:67]
    ds_read_b64_tr_b16 v[204:205], v28 offset:4096
    v_mfma_f32_16x16x32_bf16 v[118:121], v[192:195], v[76:79], v[118:121]
    ds_read_b64_tr_b16 v[206:207], v28 offset:4608
    v_mfma_f32_16x16x32_bf16 v[100:103], v[184:187], v[32:35], v[100:103]
    v_mfma_f32_16x16x32_bf16 v[104:107], v[188:191], v[32:35], v[104:107]
    buffer_load_dwordx4 v1, s[16:19], s46 offen sc1 lds
    v_mfma_f32_16x16x32_bf16 v[108:111], v[192:195], v[32:35], v[108:111]
    s_cmp_eq_u32 s36, s97
    s_cselect_b32 s47, 32, -2
    s_cselect_b64 s[8:9], s[88:89], s[8:9]
    s_cselect_b32 s55, 0x543fc00, s55
    s_add_u32 s50, s50, s47
    s_max_i32 s47, s50, 0
    s_min_i32 s47, s47, s96
    s_lshl_b32 s41, s47, 15
    s_lshl_b32 s46, s47, 10
    s_sub_u32 s46, s55, s46
    s_add_u32 m0, s52, 90112
    s_nop 0
    buffer_load_dwordx4 v1, s[16:19], s46 offen sc1 lds
    s_add_u32 s91, s91, 65536
    s_waitcnt vmcnt(10) lgkmcnt(0)
    s_barrier
    v_mfma_f32_16x16x32_bf16 v[44:47], v[196:199], v[80:83], v[44:47]
    ds_read_b128 v[68:71], v4 offset:24576
    ds_read_b128 v[72:75], v4 offset:26624
    v_mfma_f32_16x16x32_bf16 v[48:51], v[196:199], v[84:87], v[48:51]
    ds_read_b128 v[76:79], v4 offset:61440
    v_mfma_f32_16x16x32_bf16 v[92:95], v[196:199], v[88:91], v[92:95]
    buffer_load_dword v117, v116, s[20:23], 0 offen sc1
    v_mfma_f32_16x16x32_bf16 v[52:55], v[200:203], v[80:83], v[52:55]
    s_add_u32 m0, s43, 0
    ds_read_b64_tr_b16 v[208:209], v26 offset:24576
    v_mfma_f32_16x16x32_bf16 v[56:59], v[200:203], v[84:87], v[56:59]
    buffer_load_dwordx4 v6, s[8:11], s41 offen offset:0 sc1 lds
    v_mfma_f32_16x16x32_bf16 v[96:99], v[200:203], v[88:91], v[96:99]
    s_add_u32 m0, s43, 3968
    ds_read_b64_tr_b16 v[210:211], v26 offset:25088
    v_mfma_f32_16x16x32_bf16 v[60:63], v[204:207], v[80:83], v[60:63]
    ds_read_b64_tr_b16 v[212:213], v27 offset:24576
    v_mfma_f32_16x16x32_bf16 v[64:67], v[204:207], v[84:87], v[64:67]
    buffer_load_dwordx4 v6, s[8:11], s41 offen offset:128 sc1 lds
    v_mfma_f32_16x16x32_bf16 v[118:121], v[204:207], v[88:91], v[118:121]
    s_add_u32 m0, s43, 7936
    ds_read_b64_tr_b16 v[214:215], v27 offset:25088
    v_mfma_f32_16x16x32_bf16 v[100:103], v[196:199], v[32:35], v[100:103]
    buffer_load_dwordx4 v6, s[8:11], s41 offen offset:256 sc1 lds
    v_mfma_f32_16x16x32_bf16 v[104:107], v[200:203], v[32:35], v[104:107]
    ds_read_b64_tr_b16 v[216:217], v28 offset:24576
    v_mfma_f32_16x16x32_bf16 v[108:111], v[204:207], v[32:35], v[108:111]
    ds_read_b64_tr_b16 v[218:219], v28 offset:25088
    s_waitcnt lgkmcnt(4)
    v_mfma_f32_16x16x32_bf16 v[44:47], v[208:211], v[68:71], v[44:47]
    s_add_u32 m0, s43, 11904
    ds_read_b128 v[80:83], v5 offset:24576
    v_mfma_f32_16x16x32_bf16 v[48:51], v[208:211], v[72:75], v[48:51]
    ds_read_b128 v[84:87], v5 offset:26624
    v_mfma_f32_16x16x32_bf16 v[92:95], v[208:211], v[76:79], v[92:95]
    ds_read_b128 v[88:91], v5 offset:61440
    s_waitcnt lgkmcnt(5)
    v_mfma_f32_16x16x32_bf16 v[52:55], v[212:215], v[68:71], v[52:55]
    ds_read_b64_tr_b16 v[220:221], v26 offset:28672
    v_mfma_f32_16x16x32_bf16 v[56:59], v[212:215], v[72:75], v[56:59]
    ds_read_b64_tr_b16 v[222:223], v26 offset:29184
    v_mfma_f32_16x16x32_bf16 v[96:99], v[212:215], v[76:79], v[96:99]
    ds_read_b64_tr_b16 v[224:225], v27 offset:28672
    s_waitcnt lgkmcnt(6)
    v_mfma_f32_16x16x32_bf16 v[60:63], v[216:219], v[68:71], v[60:63]
    ds_read_b64_tr_b16 v[226:227], v27 offset:29184
    v_mfma_f32_16x16x32_bf16 v[64:67], v[216:219], v[72:75], v[64:67]
    ds_read_b64_tr_b16 v[228:229], v28 offset:28672
    v_mfma_f32_16x16x32_bf16 v[118:121], v[216:219], v[76:79], v[118:121]
    ds_read_b64_tr_b16 v[230:231], v28 offset:29184
    v_mfma_f32_16x16x32_bf16 v[100:103], v[208:211], v[32:35], v[100:103]
    buffer_load_dwordx4 v6, s[8:11], s41 offen offset:384 sc1 lds
    v_mfma_f32_16x16x32_bf16 v[104:107], v[212:215], v[32:35], v[104:107]
    s_add_u32 m0, s43, 15872
    s_nop 0
    buffer_load_dwordx4 v6, s[8:11], s41 offen offset:512 sc1 lds
    v_mfma_f32_16x16x32_bf16 v[108:111], v[216:219], v[32:35], v[108:111]
    s_add_u32 m0, s43, 19840
    s_nop 0
    buffer_load_dwordx4 v6, s[8:11], s41 offen offset:640 sc1 lds
    s_waitcnt vmcnt(8) lgkmcnt(0)
    s_barrier
    v_mfma_f32_16x16x32_bf16 v[44:47], v[220:223], v[80:83], v[44:47]
    ds_read_b64 v[20:21], v13 offset:4096
    s_add_u32 m0, s43, 23808
    v_mfma_f32_16x16x32_bf16 v[48:51], v[220:223], v[84:87], v[48:51]
    ds_read_b64 v[22:23], v13 offset:4224
    buffer_load_dwordx4 v6, s[8:11], s41 offen offset:768 sc1 lds
    v_mfma_f32_16x16x32_bf16 v[92:95], v[220:223], v[88:91], v[92:95]
    ds_read_b64 v[24:25], v13 offset:4352
    s_add_u32 m0, s43, 27776
    v_mfma_f32_16x16x32_bf16 v[52:55], v[224:227], v[80:83], v[52:55]
    ds_read_b64 v[36:37], v13 offset:4480
    buffer_load_dwordx4 v6, s[8:11], s41 offen offset:896 sc1 lds
    v_mfma_f32_16x16x32_bf16 v[56:59], v[224:227], v[84:87], v[56:59]
    ds_read_b128 v[68:71], v4 offset:28672
    s_add_u32 m0, s43, 31744
    v_mfma_f32_16x16x32_bf16 v[96:99], v[224:227], v[88:91], v[96:99]
    ds_read_b128 v[72:75], v4 offset:30720
    buffer_load_dwordx4 v6, s[8:11], s41 offen offset:1024 sc1 lds
    v_mfma_f32_16x16x32_bf16 v[60:63], v[228:231], v[80:83], v[60:63]
    ds_read_b128 v[76:79], v4 offset:63488
    v_mfma_f32_16x16x32_bf16 v[64:67], v[228:231], v[84:87], v[64:67]
    ds_read_b64_tr_b16 v[232:233], v26 offset:49152
    v_mfma_f32_16x16x32_bf16 v[118:121], v[228:231], v[88:91], v[118:121]
    ds_read_b64_tr_b16 v[234:235], v26 offset:49664
    v_mfma_f32_16x16x32_bf16 v[100:103], v[220:223], v[32:35], v[100:103]
    ds_read_b64_tr_b16 v[236:237], v27 offset:49152
    v_mfma_f32_16x16x32_bf16 v[104:107], v[224:227], v[32:35], v[104:107]
    ds_read_b64_tr_b16 v[238:239], v27 offset:49664
    v_mfma_f32_16x16x32_bf16 v[108:111], v[228:231], v[32:35], v[108:111]
    ds_read_b64_tr_b16 v[240:241], v28 offset:49152
    ds_read_b64_tr_b16 v[242:243], v28 offset:49664
    s_waitcnt lgkmcnt(0)
    v_mfma_f32_16x16x32_bf16 v[44:47], v[232:235], v[68:71], v[44:47]
    ds_read_b64 v[30:31], v13 offset:2048
    s_add_u32 m0, s43, 35712
    v_add_f32 v42, v24, v36
    v_add_f32 v43, v25, v37
    v_mfma_f32_16x16x32_bf16 v[48:51], v[232:235], v[72:75], v[48:51]
    ds_read_b64 v[112:113], v13 offset:2176
    buffer_load_dwordx4 v6, s[8:11], s41 offen offset:1152 sc1 lds
    v_add_f32 v20, v20, v22
    v_add_f32 v21, v21, v23
    v_mfma_f32_16x16x32_bf16 v[92:95], v[232:235], v[76:79], v[92:95]
    ds_read_b64 v[114:115], v13 offset:2304
    s_add_u32 m0, s43, 39680
    v_add_f32 v20, v20, v42
    v_add_f32 v21, v21, v43
    v_mfma_f32_16x16x32_bf16 v[52:55], v[236:239], v[68:71], v[52:55]
    ds_read_b64 v[122:123], v13 offset:2432
    buffer_load_dwordx4 v6, s[8:11], s41 offen offset:1280 sc1 lds
    v_mov_b32 v42, v20
    v_mov_b32 v43, v21
    v_mfma_f32_16x16x32_bf16 v[56:59], v[236:239], v[72:75], v[56:59]
    ds_read_b128 v[80:83], v5 offset:28672
    s_add_u32 m0, s43, 43648
    v_permlane32_swap_b32 v20, v42
    v_permlane32_swap_b32 v21, v43
    v_mfma_f32_16x16x32_bf16 v[96:99], v[236:239], v[76:79], v[96:99]
    ds_read_b128 v[84:87], v5 offset:30720
    buffer_load_dwordx4 v6, s[8:11], s41 offen offset:1408 sc1 lds
    v_add_f32 v20, v20, v42
    v_add_f32 v21, v21, v43
    v_mfma_f32_16x16x32_bf16 v[60:63], v[240:243], v[68:71], v[60:63]
    ds_read_b128 v[88:91], v5 offset:63488
    v_mul_f32 v38, 0xba800000, v20
    v_mul_f32 v21, 0x3a800000, v21
    v_mfma_f32_16x16x32_bf16 v[64:67], v[240:243], v[72:75], v[64:67]
    ds_read_b64_tr_b16 v[244:245], v26 offset:53248
    v_fma_f32 v21, -v38, v38, v21
    v_mov_b32 v39, v38
    v_mfma_f32_16x16x32_bf16 v[118:121], v[240:243], v[76:79], v[118:121]
    ds_read_b64_tr_b16 v[246:247], v26 offset:53760
    v_max_f32 v21, 0, v21
    v_add_f32 v21, 0x3727c5ac, v21
    v_mfma_f32_16x16x32_bf16 v[100:103], v[232:235], v[32:35], v[100:103]
    ds_read_b64_tr_b16 v[248:249], v27 offset:53248
    v_rsq_f32 v40, v21
    v_permlane16_swap_b32 v38, v39
    v_mfma_f32_16x16x32_bf16 v[104:107], v[236:239], v[32:35], v[104:107]
    ds_read_b64_tr_b16 v[250:251], v27 offset:53760
    v_mov_b32 v41, v40
    s_nop 1
    v_permlane16_swap_b32 v40, v41
    v_mfma_f32_16x16x32_bf16 v[108:111], v[240:243], v[32:35], v[108:111]
    ds_read_b64_tr_b16 v[252:253], v28 offset:53248
    ds_read_b64_tr_b16 v[254:255], v28 offset:53760
    s_waitcnt vmcnt(12) lgkmcnt(0)
    v_cmp_eq_u32 vcc, v116, v117
    s_cbranch_vccnz L_spin3
L_back4:
    s_barrier
    v_mfma_f32_16x16x32_bf16 v[44:47], v[244:247], v[80:83], v[44:47]
    s_add_u32 m0, s43, 47616
    v_add_f32 v29, v114, v122
    v_add_f32 v19, v115, v123
    v_mfma_f32_16x16x32_bf16 v[48:51], v[244:247], v[84:87], v[48:51]
    buffer_load_dwordx4 v6, s[8:11], s41 offen offset:1536 sc1 lds
    v_add_f32 v30, v30, v112
    v_add_f32 v31, v31, v113
    v_mfma_f32_16x16x32_bf16 v[92:95], v[244:247], v[88:91], v[92:95]
    s_add_u32 m0, s43, 51584
    v_add_f32 v30, v30, v29
    v_add_f32 v31, v31, v19
    v_mfma_f32_16x16x32_bf16 v[52:55], v[248:251], v[80:83], v[52:55]
    buffer_load_dwordx4 v6, s[8:11], s41 offen offset:1664 sc1 lds
    v_mov_b32 v29, v30
    v_mov_b32 v19, v31
    v_mfma_f32_16x16x32_bf16 v[56:59], v[248:251], v[84:87], v[56:59]
    s_add_u32 m0, s43, 55552
    v_permlane32_swap_b32 v30, v29
    v_permlane32_swap_b32 v31, v19
    v_mfma_f32_16x16x32_bf16 v[96:99], v[248:251], v[88:91], v[96:99]
    buffer_load_dwordx4 v6, s[8:11], s41 offen offset:1792 sc1 lds
    v_add_f32 v30, v30, v29
    v_add_f32 v31, v31, v19
    v_mfma_f32_16x16x32_bf16 v[60:63], v[252:255], v[80:83], v[60:63]
    s_add_u32 m0, s43, 59520
    v_mul_f32 v112, 0xba800000, v30
    v_mul_f32 v31, 0x3a800000, v31
    v_mfma_f32_16x16x32_bf16 v[64:67], v[252:255], v[84:87], v[64:67]
    buffer_load_dwordx4 v6, s[8:11], s41 offen offset:1920 sc1 lds
    v_fma_f32 v31, -v112, v112, v31
    v_mov_b32 v113, v112
    v_mfma_f32_16x16x32_bf16 v[118:121], v[252:255], v[88:91], v[118:121]
    s_sub_u32 s53, s91, 65536
    v_max_f32 v31, 0, v31
    v_add_f32 v31, 0x3727c5ac, v31
    v_mfma_f32_16x16x32_bf16 v[100:103], v[244:247], v[32:35], v[100:103]
    buffer_store_dword v124, v124, s[16:19], s53 offen sc1
    v_rsq_f32 v114, v31
    v_permlane16_swap_b32 v112, v113
    v_mfma_f32_16x16x32_bf16 v[104:107], v[248:251], v[32:35], v[104:107]
    s_add_u32 s91, s91, 65536
    v_mov_b32 v115, v114
    s_nop 1
    v_permlane16_swap_b32 v114, v115
    v_mfma_f32_16x16x32_bf16 v[108:111], v[252:255], v[32:35], v[108:111]
    s_mov_b32 s36, 0
    v_mov_b32 v116, 0
    v_mov_b32 v117, v11
    s_cmp_eq_u32 s36, s97
    s_cselect_b32 s47, 32, -2
    s_cselect_b64 s[8:9], s[88:89], s[8:9]
    s_cselect_b32 s55, 0x543fc00, s55
    s_add_u32 s50, s50, s47
    s_max_i32 s47, s50, 0
    s_min_i32 s47, s47, s96
    s_lshl_b32 s41, s47, 15
    s_lshl_b32 s46, s47, 10
    s_sub_u32 s46, s55, s46
    s_cmp_eq_u32 s36, 17
    s_cselect_b32 s49, s87, 0x10000
    s_add_u32 s90, s90, s49
    s_and_b32 s49, s90, 0xffffffff
    s_bitcmp1_b64 s[24:25], s36
    s_cselect_b32 s44, s49, 0x5e00000
    s_bitcmp1_b64 s[26:27], s36
    s_cselect_b64 s[62:63], 0, -1
    v_fmac_f32 v92, v38, v100
    v_fmac_f32 v93, v38, v101
    v_fmac_f32 v94, v38, v102
    v_fmac_f32 v95, v38, v103
    v_mul_f32 v92, v92, v40
    v_mul_f32 v93, v93, v40
    v_mul_f32 v94, v94, v40
    v_mul_f32 v95, v95, v40
    v_cvt_pk_bf16_f32 v92, v92, v93
    v_cvt_pk_bf16_f32 v93, v94, v95
    ds_write_b64 v7, v[92:93] offset:6144
    v_fmac_f32 v96, v38, v104
    v_fmac_f32 v97, v38, v105
    v_fmac_f32 v98, v38, v106
    v_fmac_f32 v99, v38, v107
    v_mul_f32 v96, v96, v40
    v_mul_f32 v97, v97, v40
    v_mul_f32 v98, v98, v40
    v_mul_f32 v99, v99, v40
    v_cvt_pk_bf16_f32 v96, v96, v97
    v_cvt_pk_bf16_f32 v97, v98, v99
    ds_write_b64 v7, v[96:97] offset:7168
    v_fmac_f32 v118, v38, v108
    v_fmac_f32 v119, v38, v109
    v_fmac_f32 v120, v38, v110
    v_fmac_f32 v121, v38, v111
    v_mul_f32 v118, v118, v40
    v_mul_f32 v119, v119, v40
    v_mul_f32 v120, v120, v40
    v_mul_f32 v121, v121, v40
    v_cvt_pk_bf16_f32 v118, v118, v119
    v_cvt_pk_bf16_f32 v119, v120, v121
    ds_write_b64 v8, v[118:119] offset:8192
    v_fmac_f32 v44, v112, v100
    v_fmac_f32 v45, v112, v101
    v_fmac_f32 v46, v112, v102
    v_fmac_f32 v47, v112, v103
    v_fmac_f32 v48, v113, v100
    v_fmac_f32 v49, v113, v101
    v_fmac_f32 v50, v113, v102
    v_fmac_f32 v51, v113, v103
    v_fmac_f32 v52, v112, v104
    v_fmac_f32 v53, v112, v105
    v_fmac_f32 v54, v112, v106
    v_fmac_f32 v55, v112, v107
    v_fmac_f32 v56, v113, v104
    v_fmac_f32 v57, v113, v105
    v_fmac_f32 v58, v113, v106
    v_fmac_f32 v59, v113, v107
    v_fmac_f32 v60, v112, v108
    v_fmac_f32 v61, v112, v109
    v_fmac_f32 v62, v112, v110
    v_fmac_f32 v63, v112, v111
    v_fmac_f32 v64, v113, v108
    v_fmac_f32 v65, v113, v109
    v_fmac_f32 v66, v113, v110
    v_fmac_f32 v67, v113, v111
    s_waitcnt vmcnt(5) lgkmcnt(0)
    s_barrier
    ds_read_b128 v[68:71], v2 offset:0
    ds_read_b128 v[72:75], v2 offset:2048
    ds_read_b128 v[76:79], v3 offset:0
    ds_read_b128 v[80:83], v3 offset:2048
    s_mov_b32 s36, 1
    s_waitcnt lgkmcnt(0)
    s_nop 7
L_q_b0:
    v_mfma_f32_16x16x32_bf16 v[20:23], a[0:3], v[68:71], 0
    ds_read_b128 v[84:87], v2 offset:4096
    v_mul_f32 v44, v44, v114
    v_mfma_f32_16x16x32_bf16 v[24:27], a[0:3], v[72:75], 0
    v_mul_f32 v45, v45, v114
    v_mul_f32 v46, v46, v114
    v_mfma_f32_16x16x32_bf16 v[32:35], a[4:7], v[72:75], 0
    v_mul_f32 v47, v47, v114
    v_cvt_pk_bf16_f32 v44, v44, v45
    v_mfma_f32_16x16x32_bf16 v[28:31], a[4:7], v[68:71], 0
    ds_read_b128 v[88:91], v2 offset:6144
    v_cvt_pk_bf16_f32 v45, v46, v47
    v_mfma_f32_16x16x32_bf16 v[36:39], a[8:11], v[68:71], 0
    ds_write_b64 v7, v[44:45] offset:12288
    v_mfma_f32_16x16x32_bf16 v[40:43], a[8:11], v[72:75], 0
    s_waitcnt lgkmcnt(3)
    v_mul_f32 v48, v48, v115
    v_mul_f32 v49, v49, v115
    v_mfma_f32_16x16x32_bf16 v[20:23], a[12:15], v[76:79], v[20:23]
    ds_read_b128 v[92:95], v3 offset:4096
    v_mul_f32 v50, v50, v115
    v_mfma_f32_16x16x32_bf16 v[24:27], a[12:15], v[80:83], v[24:27]
    v_mul_f32 v51, v51, v115
    v_cvt_pk_bf16_f32 v48, v48, v49
    v_mfma_f32_16x16x32_bf16 v[32:35], a[16:19], v[80:83], v[32:35]
    v_cvt_pk_bf16_f32 v49, v50, v51
    v_mfma_f32_16x16x32_bf16 v[28:31], a[16:19], v[76:79], v[28:31]
    ds_read_b128 v[96:99], v3 offset:6144
    v_mfma_f32_16x16x32_bf16 v[36:39], a[20:23], v[76:79], v[36:39]
    ds_write_b64 v7, v[48:49] offset:18432
    v_mfma_f32_16x16x32_bf16 v[40:43], a[20:23], v[80:83], v[40:43]
    s_waitcnt lgkmcnt(4)
    v_mul_f32 v52, v52, v114
    v_mul_f32 v53, v53, v114
    v_mfma_f32_16x16x32_bf16 v[20:23], a[24:27], v[84:87], v[20:23]
    ds_read_b128 v[68:71], v2 offset:8192
    v_mul_f32 v54, v54, v114
    v_mfma_f32_16x16x32_bf16 v[24:27], a[24:27], v[88:91], v[24:27]
    v_mul_f32 v55, v55, v114
    v_cvt_pk_bf16_f32 v52, v52, v53
    v_mfma_f32_16x16x32_bf16 v[32:35], a[28:31], v[88:91], v[32:35]
    v_cvt_pk_bf16_f32 v53, v54, v55
    v_mfma_f32_16x16x32_bf16 v[28:31], a[28:31], v[84:87], v[28:31]
    ds_read_b128 v[72:75], v2 offset:10240
    v_mfma_f32_16x16x32_bf16 v[36:39], a[32:35], v[84:87], v[36:39]
    ds_write_b64 v7, v[52:53] offset:13312
    v_mfma_f32_16x16x32_bf16 v[40:43], a[32:35], v[88:91], v[40:43]
    s_waitcnt lgkmcnt(4)
    v_mul_f32 v56, v56, v115
    v_mul_f32 v57, v57, v115
    v_mfma_f32_16x16x32_bf16 v[20:23], a[36:39], v[92:95], v[20:23]
    ds_read_b128 v[76:79], v3 offset:8192
    v_mul_f32 v58, v58, v115
    v_mfma_f32_16x16x32_bf16 v[24:27], a[36:39], v[96:99], v[24:27]
    v_mul_f32 v59, v59, v115
    v_cvt_pk_bf16_f32 v56, v56, v57
    v_mfma_f32_16x16x32_bf16 v[32:35], a[40:43], v[96:99], v[32:35]
    v_cvt_pk_bf16_f32 v57, v58, v59
    v_mfma_f32_16x16x32_bf16 v[28:31], a[40:43], v[92:95], v[28:31]
    ds_read_b128 v[80:83], v3 offset:10240
    v_mfma_f32_16x16x32_bf16 v[36:39], a[44:47], v[92:95], v[36:39]
    ds_write_b64 v7, v[56:57] offset:19456
    v_mfma_f32_16x16x32_bf16 v[40:43], a[44:47], v[96:99], v[40:43]
    s_waitcnt lgkmcnt(4)
    v_mul_f32 v60, v60, v114
    v_mul_f32 v61, v61, v114
    v_mfma_f32_16x16x32_bf16 v[20:23], a[48:51], v[68:71], v[20:23]
    s_waitcnt vmcnt(1)
    ds_read_b128 v[84:87], v2 offset:12288
    v_cmp_ne_u32 vcc, 0, v116
    v_mfma_f32_16x16x32_bf16 v[24:27], a[48:51], v[72:75], v[24:27]
    v_mul_f32 v62, v62, v114
    v_mul_f32 v63, v63, v114
    v_mfma_f32_16x16x32_bf16 v[32:35], a[52:55], v[72:75], v[32:35]
    s_cbranch_vccnz L_spin5
L_back6:
    v_cvt_pk_bf16_f32 v60, v60, v61
    v_cvt_pk_bf16_f32 v61, v62, v63
    v_mfma_f32_16x16x32_bf16 v[28:31], a[52:55], v[68:71], v[28:31]
    ds_read_b128 v[88:91], v2 offset:14336
    v_mfma_f32_16x16x32_bf16 v[36:39], a[56:59], v[68:71], v[36:39]
    ds_write_b64 v8, v[60:61] offset:14336
    v_mfma_f32_16x16x32_bf16 v[40:43], a[56:59], v[72:75], v[40:43]
    s_waitcnt lgkmcnt(4)
    v_mul_f32 v64, v64, v115
    v_mul_f32 v65, v65, v115
    v_mfma_f32_16x16x32_bf16 v[20:23], a[60:63], v[76:79], v[20:23]
    ds_read_b128 v[92:95], v3 offset:12288
    v_mul_f32 v66, v66, v115
    v_mfma_f32_16x16x32_bf16 v[24:27], a[60:63], v[80:83], v[24:27]
    v_mul_f32 v67, v67, v115
    v_cvt_pk_bf16_f32 v64, v64, v65
    v_mfma_f32_16x16x32_bf16 v[32:35], a[64:67], v[80:83], v[32:35]
    v_cvt_pk_bf16_f32 v65, v66, v67
    v_mfma_f32_16x16x32_bf16 v[28:31], a[64:67], v[76:79], v[28:31]
    ds_read_b128 v[96:99], v3 offset:14336
    v_mfma_f32_16x16x32_bf16 v[36:39], a[68:71], v[76:79], v[36:39]
    ds_write_b64 v8, v[64:65] offset:20480
    v_mfma_f32_16x16x32_bf16 v[40:43], a[68:71], v[80:83], v[40:43]
    s_waitcnt lgkmcnt(4)
    v_mfma_f32_16x16x32_bf16 v[20:23], a[72:75], v[84:87], v[20:23]
    ds_read_b128 v[68:71], v2 offset:16384
    v_mfma_f32_16x16x32_bf16 v[24:27], a[72:75], v[88:91], v[24:27]
    v_mfma_f32_16x16x32_bf16 v[32:35], a[76:79], v[88:91], v[32:35]
    s_waitcnt lgkmcnt(1)
    s_barrier
    v_mfma_f32_16x16x32_bf16 v[28:31], a[76:79], v[84:87], v[28:31]
    ds_read_b128 v[72:75], v2 offset:18432
    v_mfma_f32_16x16x32_bf16 v[36:39], a[80:83], v[84:87], v[36:39]
    ds_read_b128 v[44:47], v9 offset:6144
    v_mfma_f32_16x16x32_bf16 v[40:43], a[80:83], v[88:91], v[40:43]
    s_waitcnt lgkmcnt(4)
    ds_read_b128 v[48:51], v9 offset:13312
    v_mfma_f32_16x16x32_bf16 v[20:23], a[84:87], v[92:95], v[20:23]
    ds_read_b128 v[76:79], v3 offset:16384
    v_mfma_f32_16x16x32_bf16 v[24:27], a[84:87], v[96:99], v[24:27]
    ds_read_b128 v[52:55], v9 offset:7168
    s_add_u32 m0, s43, 98304
    v_mfma_f32_16x16x32_bf16 v[32:35], a[88:91], v[96:99], v[32:35]
    buffer_load_dwordx4 v6, s[8:11], s41 offen offset:0 sc1 lds
    v_mfma_f32_16x16x32_bf16 v[28:31], a[88:91], v[92:95], v[28:31]
    s_add_u32 m0, s43, 102272
    ds_read_b128 v[80:83], v3 offset:18432
    v_mfma_f32_16x16x32_bf16 v[36:39], a[92:95], v[92:95], v[36:39]
    ds_read_b64_tr_b16 v[56:57], v9 offset:14336
    v_mfma_f32_16x16x32_bf16 v[40:43], a[92:95], v[96:99], v[40:43]
    s_waitcnt lgkmcnt(6)
    ds_read_b64_tr_b16 v[58:59], v9 offset:8192
    s_waitcnt lgkmcnt(3)
    v_mfma_f32_16x16x32_bf16 v[20:23], a[96:99], v[68:71], v[20:23]
    ds_read_b128 v[84:87], v2 offset:20480
    v_mfma_f32_16x16x32_bf16 v[64:67], v[48:51], v[44:47], 0
    ds_read_b64_tr_b16 v[60:61], v9 offset:14344
    v_mfma_f32_16x16x32_bf16 v[118:121], v[52:55], v[44:47], 0
    ds_read_b64_tr_b16 v[62:63], v9 offset:8200
    v_mfma_f32_16x16x32_bf16 v[24:27], a[96:99], v[72:75], v[24:27]
    v_mfma_f32_16x16x32_bf16 v[32:35], a[100:103], v[72:75], v[32:35]
    buffer_load_dwordx4 v6, s[8:11], s41 offen offset:128 sc1 lds
    v_mfma_f32_16x16x32_bf16 v[28:31], a[100:103], v[68:71], v[28:31]
    s_add_u32 m0, s43, 106240
    ds_read_b128 v[88:91], v2 offset:22528
    v_cndmask_b32 v64, v64, v65, s[56:57]
    v_mfma_f32_16x16x32_bf16 v[36:39], a[104:107], v[68:71], v[36:39]
    v_cndmask_b32 v66, v66, v67, s[56:57]
    v_cndmask_b32 v118, v118, v119, s[56:57]
    v_mfma_f32_16x16x32_bf16 v[40:43], a[104:107], v[72:75], v[40:43]
    s_waitcnt lgkmcnt(6)
    v_cndmask_b32 v120, v120, v121, s[56:57]
    v_cndmask_b32 v64, v18, v64, s[62:63]
    v_mfma_f32_16x16x32_bf16 v[20:23], a[108:111], v[76:79], v[20:23]
    ds_read_b128 v[92:95], v3 offset:20480
    v_cndmask_b32 v66, v18, v66, s[62:63]
    v_mfma_f32_16x16x32_bf16 v[24:27], a[108:111], v[80:83], v[24:27]
    v_cndmask_b32 v46, v64, v118, s[58:59]
    v_cndmask_b32 v47, v66, v120, s[60:61]
    v_mfma_f32_16x16x32_bf16 v[32:35], a[112:115], v[80:83], v[32:35]
    buffer_load_dwordx4 v6, s[8:11], s41 offen offset:256 sc1 lds
    v_mfma_f32_16x16x32_bf16 v[28:31], a[112:115], v[76:79], v[28:31]
    s_add_u32 m0, s43, 110208
    ds_read_b128 v[96:99], v3 offset:22528
    v_max_f32 v44, v46, v47
    v_mfma_f32_16x16x32_bf16 v[36:39], a[116:119], v[76:79], v[36:39]
    v_mov_b32 v45, v44
    v_mfma_f32_16x16x32_bf16 v[40:43], a[116:119], v[80:83], v[40:43]
    s_waitcnt lgkmcnt(2)
    v_permlane16_swap_b32 v44, v45
    v_mfma_f32_16x16x32_bf16 v[20:23], a[120:123], v[84:87], v[20:23]
    ds_read_b128 v[68:71], v2 offset:24576
    v_max_f32 v44, v44, v45
    v_mfma_f32_16x16x32_bf16 v[24:27], a[120:123], v[88:91], v[24:27]
    v_mov_b32 v45, v44
    v_mfma_f32_16x16x32_bf16 v[32:35], a[124:127], v[88:91], v[32:35]
    buffer_load_dwordx4 v6, s[8:11], s41 offen offset:384 sc1 lds
    v_mfma_f32_16x16x32_bf16 v[28:31], a[124:127], v[84:87], v[28:31]
    s_add_u32 m0, s43, 114176
    ds_read_b128 v[72:75], v2 offset:26624
    v_mfma_f32_16x16x32_bf16 v[36:39], a[128:131], v[84:87], v[36:39]
    v_permlane32_swap_b32 v44, v45
    v_mfma_f32_16x16x32_bf16 v[40:43], a[128:131], v[88:91], v[40:43]
    s_waitcnt lgkmcnt(2)
    v_max_f32 v44, v44, v45
    v_mul_f32 v44, s86, v44
    v_mfma_f32_16x16x32_bf16 v[20:23], a[132:135], v[92:95], v[20:23]
    ds_read_b128 v[76:79], v3 offset:24576
    v_fma_f32 v46, v46, s86, -v44
    v_mfma_f32_16x16x32_bf16 v[24:27], a[132:135], v[96:99], v[24:27]
    v_fma_f32 v47, v47, s86, -v44
    v_mfma_f32_16x16x32_bf16 v[32:35], a[136:139], v[96:99], v[32:35]
    buffer_load_dwordx4 v6, s[8:11], s41 offen offset:512 sc1 lds
    v_mfma_f32_16x16x32_bf16 v[28:31], a[136:139], v[92:95], v[28:31]
    s_add_u32 m0, s43, 118144
    ds_read_b128 v[80:83], v3 offset:26624
    v_mfma_f32_16x16x32_bf16 v[36:39], a[140:143], v[92:95], v[36:39]
    v_exp_f32 v46, v46
    v_mfma_f32_16x16x32_bf16 v[40:43], a[140:143], v[96:99], v[40:43]
    s_waitcnt lgkmcnt(2)
    v_exp_f32 v47, v47
    v_mfma_f32_16x16x32_bf16 v[20:23], a[144:147], v[68:71], v[20:23]
    ds_read_b128 v[84:87], v2 offset:28672
    v_cvt_pk_bf16_f32 v52, v46, v47
    v_mfma_f32_16x16x32_bf16 v[24:27], a[144:147], v[72:75], v[24:27]
    v_perm_b32 v48, v52, v52, v14
    v_perm_b32 v49, v52, v52, v15
    v_mfma_f32_16x16x32_bf16 v[32:35], a[148:151], v[72:75], v[32:35]
    buffer_load_dwordx4 v6, s[8:11], s41 offen offset:640 sc1 lds
    v_mfma_f32_16x16x32_bf16 v[28:31], a[148:151], v[68:71], v[28:31]
    s_add_u32 m0, s43, 122112
    ds_read_b128 v[88:91], v2 offset:30720
    v_perm_b32 v50, v52, v52, v16
    v_mfma_f32_16x16x32_bf16 v[36:39], a[152:155], v[68:71], v[36:39]
    v_perm_b32 v51, v52, v52, v17
    v_add_f32 v44, v46, v47
    v_mfma_f32_16x16x32_bf16 v[40:43], a[152:155], v[72:75], v[40:43]
    s_waitcnt lgkmcnt(2)
    v_mov_b32 v45, v44
    s_waitcnt lgkmcnt(9)
    v_mfma_f32_16x16x32_bf16 v[20:23], a[156:159], v[76:79], v[20:23]
    ds_read_b128 v[92:95], v3 offset:28672
    v_mfma_f32_16x16x32_bf16 v[64:67], v[56:59], v[48:51], 0
    v_mfma_f32_16x16x32_bf16 v[118:121], v[60:63], v[48:51], 0
    v_permlane16_swap_b32 v44, v45
    v_mfma_f32_16x16x32_bf16 v[24:27], a[156:159], v[80:83], v[24:27]
    v_add_f32 v44, v44, v45
    v_mov_b32 v45, v44
    v_mfma_f32_16x16x32_bf16 v[32:35], a[160:163], v[80:83], v[32:35]
    buffer_load_dwordx4 v6, s[8:11], s41 offen offset:768 sc1 lds
    v_mfma_f32_16x16x32_bf16 v[28:31], a[160:163], v[76:79], v[28:31]
    s_add_u32 m0, s43, 126080
    ds_read_b128 v[96:99], v3 offset:30720
    v_mfma_f32_16x16x32_bf16 v[36:39], a[164:167], v[76:79], v[36:39]
    v_permlane32_swap_b32 v44, v45
    v_mfma_f32_16x16x32_bf16 v[40:43], a[164:167], v[80:83], v[40:43]
    s_waitcnt lgkmcnt(2)
    v_add_f32 v44, v44, v45
    v_mfma_f32_16x16x32_bf16 v[20:23], a[168:171], v[84:87], v[20:23]
    ds_read_b128 v[68:71], v2 offset:32768
    v_mfma_f32_16x16x32_bf16 v[24:27], a[168:171], v[88:91], v[24:27]
    v_rcp_f32 v44, v44
    v_mfma_f32_16x16x32_bf16 v[32:35], a[172:175], v[88:91], v[32:35]
    buffer_load_dwordx4 v6, s[8:11], s41 offen offset:896 sc1 lds
    v_mfma_f32_16x16x32_bf16 v[28:31], a[172:175], v[84:87], v[28:31]
    s_add_u32 m0, s43, 130048
    ds_read_b128 v[72:75], v2 offset:34816
    v_mul_f32 v64, v64, v44
    v_mfma_f32_16x16x32_bf16 v[36:39], a[176:179], v[84:87], v[36:39]
    v_mul_f32 v65, v65, v44
    v_mul_f32 v66, v66, v44
    v_mfma_f32_16x16x32_bf16 v[40:43], a[176:179], v[88:91], v[40:43]
    s_waitcnt lgkmcnt(2)
    v_mul_f32 v67, v67, v44
    v_cvt_pk_bf16_f32 v52, v64, v65
    v_mfma_f32_16x16x32_bf16 v[20:23], a[180:183], v[92:95], v[20:23]
    ds_read_b128 v[76:79], v3 offset:32768
    v_cvt_pk_bf16_f32 v53, v66, v67
    v_mfma_f32_16x16x32_bf16 v[24:27], a[180:183], v[96:99], v[24:27]
    v_mul_f32 v118, v118, v44
    v_mul_f32 v119, v119, v44
    v_mfma_f32_16x16x32_bf16 v[32:35], a[184:187], v[96:99], v[32:35]
    buffer_load_dwordx4 v6, s[8:11], s41 offen offset:1024 sc1 lds
    v_mfma_f32_16x16x32_bf16 v[28:31], a[184:187], v[92:95], v[28:31]
    s_add_u32 m0, s43, 134016
    ds_read_b128 v[80:83], v3 offset:34816
    v_mul_f32 v120, v120, v44
    v_mfma_f32_16x16x32_bf16 v[36:39], a[188:191], v[92:95], v[36:39]
    v_mul_f32 v121, v121, v44
    v_cvt_pk_bf16_f32 v54, v118, v119
    v_mfma_f32_16x16x32_bf16 v[40:43], a[188:191], v[96:99], v[40:43]
    s_waitcnt lgkmcnt(2)
    v_cvt_pk_bf16_f32 v55, v120, v121
    v_mfma_f32_16x16x32_bf16 v[20:23], a[192:195], v[68:71], v[20:23]
    ds_read_b128 v[84:87], v2 offset:36864
    v_mfma_f32_16x16x32_bf16 v[24:27], a[192:195], v[72:75], v[24:27]
    buffer_store_dwordx4 v[52:55], v1, s[16:19], s44 offen sc1
    v_mfma_f32_16x16x32_bf16 v[32:35], a[196:199], v[72:75], v[32:35]
    buffer_load_dwordx4 v6, s[8:11], s41 offen offset:1152 sc1 lds
    v_mfma_f32_16x16x32_bf16 v[28:31], a[196:199], v[68:71], v[28:31]
    s_add_u32 m0, s43, 137984
    ds_read_b128 v[88:91], v2 offset:38912
    s_cmp_eq_u32 s36, 17
    v_mfma_f32_16x16x32_bf16 v[36:39], a[200:203], v[68:71], v[36:39]
    s_cselect_b32 s49, s87, 0x10000
    ds_read_b64 v[56:57], v13 offset:0
    s_add_u32 s90, s90, s49
    v_mfma_f32_16x16x32_bf16 v[40:43], a[200:203], v[72:75], v[40:43]
    s_waitcnt lgkmcnt(3)
    ds_read_b64 v[58:59], v13 offset:128
    s_and_b32 s49, s90, 0xffffffff
    v_mfma_f32_16x16x32_bf16 v[20:23], a[204:207], v[76:79], v[20:23]
    s_bitcmp1_b64 s[24:25], s36
    ds_read_b128 v[92:95], v3 offset:36864
    s_cselect_b32 s44, s49, 0x5e00000
    v_mfma_f32_16x16x32_bf16 v[24:27], a[204:207], v[80:83], v[24:27]
    s_bitcmp1_b64 s[26:27], s36
    ds_read_b64 v[60:61], v13 offset:256
    s_cselect_b64 s[62:63], 0, -1
    v_mfma_f32_16x16x32_bf16 v[32:35], a[208:211], v[80:83], v[32:35]
    buffer_load_dwordx4 v6, s[8:11], s41 offen offset:1280 sc1 lds
    v_mfma_f32_16x16x32_bf16 v[28:31], a[208:211], v[76:79], v[28:31]
    s_add_u32 m0, s43, 141952
    ds_read_b128 v[96:99], v3 offset:38912
    v_mfma_f32_16x16x32_bf16 v[36:39], a[212:215], v[76:79], v[36:39]
    ds_read_b64 v[62:63], v13 offset:384
    v_mfma_f32_16x16x32_bf16 v[40:43], a[212:215], v[80:83], v[40:43]
    s_waitcnt lgkmcnt(6)
    v_mfma_f32_16x16x32_bf16 v[20:23], a[216:219], v[84:87], v[20:23]
    ds_read_b128 v[68:71], v2 offset:40960
    v_mfma_f32_16x16x32_bf16 v[24:27], a[216:219], v[88:91], v[24:27]
    v_mfma_f32_16x16x32_bf16 v[32:35], a[220:223], v[88:91], v[32:35]
    buffer_load_dwordx4 v6, s[8:11], s41 offen offset:1408 sc1 lds
    v_mfma_f32_16x16x32_bf16 v[28:31], a[220:223], v[84:87], v[28:31]
    s_add_u32 m0, s43, 145920
    ds_read_b128 v[72:75], v2 offset:43008
    s_waitcnt lgkmcnt(2)
    v_mfma_f32_16x16x32_bf16 v[36:39], a[224:227], v[84:87], v[36:39]
    v_add_f32 v64, v60, v62
    v_add_f32 v65, v61, v63
    v_mfma_f32_16x16x32_bf16 v[40:43], a[224:227], v[88:91], v[40:43]
    s_waitcnt lgkmcnt(3)
    v_add_f32 v56, v56, v58
    v_add_f32 v57, v57, v59
    v_mfma_f32_16x16x32_bf16 v[20:23], a[228:231], v[92:95], v[20:23]
    ds_read_b128 v[76:79], v3 offset:40960
    v_add_f32 v56, v56, v64
    v_mfma_f32_16x16x32_bf16 v[24:27], a[228:231], v[96:99], v[24:27]
    v_add_f32 v57, v57, v65
    v_mov_b32 v64, v56
    v_mfma_f32_16x16x32_bf16 v[32:35], a[232:235], v[96:99], v[32:35]
    buffer_load_dwordx4 v6, s[8:11], s41 offen offset:1536 sc1 lds
    v_mfma_f32_16x16x32_bf16 v[28:31], a[232:235], v[92:95], v[28:31]
    s_add_u32 m0, s43, 149888
    ds_read_b128 v[80:83], v3 offset:43008
    v_mov_b32 v65, v57
    v_mfma_f32_16x16x32_bf16 v[36:39], a[236:239], v[92:95], v[36:39]
    v_permlane32_swap_b32 v56, v64
    v_mfma_f32_16x16x32_bf16 v[40:43], a[236:239], v[96:99], v[40:43]
    s_waitcnt lgkmcnt(2)
    v_permlane32_swap_b32 v57, v65
    v_mfma_f32_16x16x32_bf16 v[20:23], a[240:243], v[68:71], v[20:23]
    ds_read_b128 v[84:87], v2 offset:45056
    v_add_f32 v56, v56, v64
    v_mfma_f32_16x16x32_bf16 v[24:27], a[240:243], v[72:75], v[24:27]
    v_add_f32 v57, v57, v65
    v_mul_f32 v112, 0xba800000, v56
    v_mfma_f32_16x16x32_bf16 v[32:35], a[244:247], v[72:75], v[32:35]
    buffer_load_dwordx4 v6, s[8:11], s41 offen offset:1664 sc1 lds
    v_mfma_f32_16x16x32_bf16 v[28:31], a[244:247], v[68:71], v[28:31]
    s_add_u32 m0, s43, 153856
    ds_read_b128 v[88:91], v2 offset:47104
    v_mul_f32 v57, 0x3a800000, v57
    v_mfma_f32_16x16x32_bf16 v[36:39], a[248:251], v[68:71], v[36:39]
    v_fma_f32 v57, -v112, v112, v57
    v_mov_b32 v113, v112
    v_mfma_f32_16x16x32_bf16 v[40:43], a[248:251], v[72:75], v[40:43]
    s_waitcnt lgkmcnt(2)
    v_max_f32 v57, 0, v57
    v_add_f32 v57, 0x3727c5ac, v57
    v_mfma_f32_16x16x32_bf16 v[20:23], a[252:255], v[76:79], v[20:23]
    ds_read_b128 v[92:95], v3 offset:45056
    v_mfma_f32_16x16x32_bf16 v[24:27], a[252:255], v[80:83], v[24:27]
    v_rsq_f32 v114, v57
    v_mfma_f32_16x16x32_bf16 v[32:35], v[128:131], v[80:83], v[32:35]
    buffer_load_dwordx4 v6, s[8:11], s41 offen offset:1792 sc1 lds
    v_mfma_f32_16x16x32_bf16 v[28:31], v[128:131], v[76:79], v[28:31]
    s_add_u32 m0, s43, 157824
    ds_read_b128 v[96:99], v3 offset:47104
    v_mfma_f32_16x16x32_bf16 v[36:39], v[132:135], v[76:79], v[36:39]
    v_permlane16_swap_b32 v112, v113
    v_mfma_f32_16x16x32_bf16 v[40:43], v[132:135], v[80:83], v[40:43]
    s_waitcnt lgkmcnt(2)
    v_mov_b32 v115, v114
    v_fmac_f32 v24, v113, v100
    v_mfma_f32_16x16x32_bf16 v[20:23], v[136:139], v[84:87], v[20:23]
    ds_read_b128 v[68:71], v2 offset:49152
    v_fmac_f32 v28, v112, v104
    v_mfma_f32_16x16x32_bf16 v[24:27], v[136:139], v[88:91], v[24:27]
    v_permlane16_swap_b32 v114, v115
    v_mfma_f32_16x16x32_bf16 v[32:35], v[140:143], v[88:91], v[32:35]
    buffer_load_dwordx4 v6, s[8:11], s41 offen offset:1920 sc1 lds
    v_mfma_f32_16x16x32_bf16 v[28:31], v[140:143], v[84:87], v[28:31]
    s_add_u32 m0, s52, 92160
    ds_read_b128 v[72:75], v2 offset:51200
    v_fmac_f32 v20, v112, v100
    v_mfma_f32_16x16x32_bf16 v[36:39], v[144:147], v[84:87], v[36:39]
    v_fmac_f32 v21, v112, v101
    v_fmac_f32 v22, v112, v102
    v_mfma_f32_16x16x32_bf16 v[40:43], v[144:147], v[88:91], v[40:43]
    s_waitcnt lgkmcnt(2)
    v_fmac_f32 v25, v113, v101
    v_fmac_f32 v26, v113, v102
    v_mfma_f32_16x16x32_bf16 v[20:23], v[148:151], v[92:95], v[20:23]
    ds_read_b128 v[76:79], v3 offset:49152
    v_fmac_f32 v29, v112, v105
    v_mfma_f32_16x16x32_bf16 v[24:27], v[148:151], v[96:99], v[24:27]
    v_fmac_f32 v30, v112, v106
    v_fmac_f32 v31, v112, v107
    v_mfma_f32_16x16x32_bf16 v[32:35], v[152:155], v[96:99], v[32:35]
    buffer_load_dwordx4 v1, s[16:19], s46 offen sc1 lds
    v_mfma_f32_16x16x32_bf16 v[28:31], v[152:155], v[92:95], v[28:31]
    s_cmp_eq_u32 s36, s97
    ds_read_b128 v[80:83], v3 offset:51200
    v_med3_i32 v117, s45, 0, v12
    v_mfma_f32_16x16x32_bf16 v[36:39], v[156:159], v[92:95], v[36:39]
    s_cselect_b32 s47, 32, -2
    v_add_u32 v117, v117, v11
    v_fmac_f32 v23, v112, v103
    v_mfma_f32_16x16x32_bf16 v[40:43], v[156:159], v[96:99], v[40:43]
    s_waitcnt lgkmcnt(2)
    v_fmac_f32 v27, v113, v103
    v_fmac_f32 v32, v113, v104
    v_mfma_f32_16x16x32_bf16 v[20:23], v[160:163], v[68:71], v[20:23]
    s_cselect_b64 s[8:9], s[88:89], s[8:9]
    ds_read_b128 v[84:87], v2 offset:53248
    v_fmac_f32 v33, v113, v105
    v_mfma_f32_16x16x32_bf16 v[24:27], v[160:163], v[72:75], v[24:27]
    s_cselect_b32 s55, 0x543fc00, s55
    v_fmac_f32 v36, v112, v108
    v_fmac_f32 v37, v112, v109
    v_mfma_f32_16x16x32_bf16 v[32:35], v[164:167], v[72:75], v[32:35]
    s_add_u32 s45, s45, 65536
    v_fmac_f32 v38, v112, v110
    v_fmac_f32 v39, v112, v111
    v_mfma_f32_16x16x32_bf16 v[28:31], v[164:167], v[68:71], v[28:31]
    s_add_u32 s50, s50, s47
    ds_read_b128 v[88:91], v2 offset:55296
    v_fmac_f32 v40, v113, v108
    v_mfma_f32_16x16x32_bf16 v[36:39], v[168:171], v[68:71], v[36:39]
    buffer_load_dword v116, v117, s[16:19], 0 offen sc1
    v_mfma_f32_16x16x32_bf16 v[40:43], v[168:171], v[72:75], v[40:43]
    s_waitcnt lgkmcnt(2)
    v_fmac_f32 v34, v113, v106
    v_fmac_f32 v35, v113, v107
    v_mfma_f32_16x16x32_bf16 v[20:23], v[172:175], v[76:79], v[20:23]
    s_max_i32 s47, s50, 0
    ds_read_b128 v[92:95], v3 offset:53248
    s_min_i32 s47, s47, s96
    v_mfma_f32_16x16x32_bf16 v[24:27], v[172:175], v[80:83], v[24:27]
    s_lshl_b32 s41, s47, 15
    v_fmac_f32 v41, v113, v109
    v_fmac_f32 v42, v113, v110
    v_mfma_f32_16x16x32_bf16 v[32:35], v[176:179], v[80:83], v[32:35]
    s_lshl_b32 s46, s47, 10
    v_fmac_f32 v43, v113, v111
    s_sub_u32 s46, s55, s46
    v_mfma_f32_16x16x32_bf16 v[28:31], v[176:179], v[76:79], v[28:31]
    ds_read_b128 v[96:99], v3 offset:55296
    v_mfma_f32_16x16x32_bf16 v[36:39], v[180:183], v[76:79], v[36:39]
    v_mfma_f32_16x16x32_bf16 v[40:43], v[180:183], v[80:83], v[40:43]
    s_waitcnt lgkmcnt(2)
    v_mfma_f32_16x16x32_bf16 v[20:23], v[184:187], v[84:87], v[20:23]
    ds_read_b128 v[68:71], v2 offset:57344
    v_mfma_f32_16x16x32_bf16 v[24:27], v[184:187], v[88:91], v[24:27]
    v_mfma_f32_16x16x32_bf16 v[32:35], v[188:191], v[88:91], v[32:35]
    v_mfma_f32_16x16x32_bf16 v[28:31], v[188:191], v[84:87], v[28:31]
    ds_read_b128 v[72:75], v2 offset:59392
    v_mfma_f32_16x16x32_bf16 v[36:39], v[192:195], v[84:87], v[36:39]
    s_waitcnt vmcnt(9)
    s_barrier
    v_mfma_f32_16x16x32_bf16 v[40:43], v[192:195], v[88:91], v[40:43]
    s_waitcnt lgkmcnt(2)
    v_mfma_f32_16x16x32_bf16 v[20:23], v[196:199], v[92:95], v[20:23]
    ds_read_b128 v[76:79], v3 offset:57344
    v_mfma_f32_16x16x32_bf16 v[24:27], v[196:199], v[96:99], v[24:27]
    buffer_store_dword v124, v124, s[16:19], s91 offen sc1
    v_mfma_f32_16x16x32_bf16 v[32:35], v[200:203], v[96:99], v[32:35]
    s_add_u32 s91, s91, 65536
    v_mfma_f32_16x16x32_bf16 v[28:31], v[200:203], v[92:95], v[28:31]
    ds_read_b128 v[80:83], v3 offset:59392
    v_mfma_f32_16x16x32_bf16 v[36:39], v[204:207], v[92:95], v[36:39]
    v_mfma_f32_16x16x32_bf16 v[40:43], v[204:207], v[96:99], v[40:43]
    s_waitcnt lgkmcnt(2)
    v_mfma_f32_16x16x32_bf16 v[20:23], v[208:211], v[68:71], v[20:23]
    ds_read_b128 v[84:87], v2 offset:61440
    v_mfma_f32_16x16x32_bf16 v[24:27], v[208:211], v[72:75], v[24:27]
    v_mfma_f32_16x16x32_bf16 v[32:35], v[212:215], v[72:75], v[32:35]
    v_mfma_f32_16x16x32_bf16 v[28:31], v[212:215], v[68:71], v[28:31]
    ds_read_b128 v[88:91], v2 offset:63488
    v_mfma_f32_16x16x32_bf16 v[36:39], v[216:219], v[68:71], v[36:39]
    v_mfma_f32_16x16x32_bf16 v[40:43], v[216:219], v[72:75], v[40:43]
    s_waitcnt lgkmcnt(2)
    v_mfma_f32_16x16x32_bf16 v[20:23], v[220:223], v[76:79], v[20:23]
    ds_read_b128 v[92:95], v3 offset:61440
    v_mfma_f32_16x16x32_bf16 v[24:27], v[220:223], v[80:83], v[24:27]
    v_mfma_f32_16x16x32_bf16 v[32:35], v[224:227], v[80:83], v[32:35]
    v_mfma_f32_16x16x32_bf16 v[28:31], v[224:227], v[76:79], v[28:31]
    ds_read_b128 v[96:99], v3 offset:63488
    v_mfma_f32_16x16x32_bf16 v[36:39], v[228:231], v[76:79], v[36:39]
    v_mfma_f32_16x16x32_bf16 v[40:43], v[228:231], v[80:83], v[40:43]
    s_waitcnt lgkmcnt(2)
    v_mfma_f32_16x16x32_bf16 v[20:23], v[232:235], v[84:87], v[20:23]
    ds_read_b128 v[68:71], v4 offset:0
    v_mfma_f32_16x16x32_bf16 v[24:27], v[232:235], v[88:91], v[24:27]
    v_mfma_f32_16x16x32_bf16 v[32:35], v[236:239], v[88:91], v[32:35]
    v_mfma_f32_16x16x32_bf16 v[28:31], v[236:239], v[84:87], v[28:31]
    ds_read_b128 v[72:75], v4 offset:2048
    v_mfma_f32_16x16x32_bf16 v[36:39], v[240:243], v[84:87], v[36:39]
    v_mfma_f32_16x16x32_bf16 v[40:43], v[240:243], v[88:91], v[40:43]
    s_waitcnt lgkmcnt(2)
    v_mfma_f32_16x16x32_bf16 v[20:23], v[244:247], v[92:95], v[20:23]
    ds_read_b128 v[76:79], v5 offset:0
    v_mfma_f32_16x16x32_bf16 v[24:27], v[244:247], v[96:99], v[24:27]
    v_mfma_f32_16x16x32_bf16 v[32:35], v[248:251], v[96:99], v[32:35]
    v_mfma_f32_16x16x32_bf16 v[28:31], v[248:251], v[92:95], v[28:31]
    ds_read_b128 v[80:83], v5 offset:2048
    v_mfma_f32_16x16x32_bf16 v[36:39], v[252:255], v[92:95], v[36:39]
    s_add_u32 s36, s36, 1
    v_mfma_f32_16x16x32_bf16 v[40:43], v[252:255], v[96:99], v[40:43]
    s_waitcnt lgkmcnt(2)
    s_cmp_eq_u32 s36, 16
    s_cbranch_scc1 L_q_short
L_q_b1:
    v_mfma_f32_16x16x32_bf16 v[44:47], a[0:3], v[68:71], 0
    ds_read_b128 v[84:87], v4 offset:4096
    v_mul_f32 v20, v20, v114
    v_mfma_f32_16x16x32_bf16 v[48:51], a[0:3], v[72:75], 0
    v_mul_f32 v21, v21, v114
    v_mul_f32 v22, v22, v114
    v_mfma_f32_16x16x32_bf16 v[56:59], a[4:7], v[72:75], 0
    v_mul_f32 v23, v23, v114
    v_cvt_pk_bf16_f32 v20, v20, v21
    v_mfma_f32_16x16x32_bf16 v[52:55], a[4:7], v[68:71], 0
    ds_read_b128 v[88:91], v4 offset:6144
    v_cvt_pk_bf16_f32 v21, v22, v23
    v_mfma_f32_16x16x32_bf16 v[60:63], a[8:11], v[68:71], 0
    ds_write_b64 v7, v[20:21] offset:0
    v_mfma_f32_16x16x32_bf16 v[64:67], a[8:11], v[72:75], 0
    s_waitcnt lgkmcnt(3)
    v_mul_f32 v24, v24, v115
    v_mul_f32 v25, v25, v115
    v_mfma_f32_16x16x32_bf16 v[44:47], a[12:15], v[76:79], v[44:47]
    ds_read_b128 v[92:95], v5 offset:4096
    v_mul_f32 v26, v26, v115
    v_mfma_f32_16x16x32_bf16 v[48:51], a[12:15], v[80:83], v[48:51]
    v_mul_f32 v27, v27, v115
    v_cvt_pk_bf16_f32 v24, v24, v25
    v_mfma_f32_16x16x32_bf16 v[56:59], a[16:19], v[80:83], v[56:59]
    v_cvt_pk_bf16_f32 v25, v26, v27
    v_mfma_f32_16x16x32_bf16 v[52:55], a[16:19], v[76:79], v[52:55]
    ds_read_b128 v[96:99], v5 offset:6144
    v_mfma_f32_16x16x32_bf16 v[60:63], a[20:23], v[76:79], v[60:63]
    ds_write_b64 v7, v[24:25] offset:6144
    v_mfma_f32_16x16x32_bf16 v[64:67], a[20:23], v[80:83], v[64:67]
    s_waitcnt lgkmcnt(4)
    v_mul_f32 v28, v28, v114
    v_mul_f32 v29, v29, v114
    v_mfma_f32_16x16x32_bf16 v[44:47], a[24:27], v[84:87], v[44:47]
    ds_read_b128 v[68:71], v4 offset:8192
    v_mul_f32 v30, v30, v114
    v_mfma_f32_16x16x32_bf16 v[48:51], a[24:27], v[88:91], v[48:51]
    v_mul_f32 v31, v31, v114
    v_cvt_pk_bf16_f32 v28, v28, v29
    v_mfma_f32_16x16x32_bf16 v[56:59], a[28:31], v[88:91], v[56:59]
    v_cvt_pk_bf16_f32 v29, v30, v31
    v_mfma_f32_16x16x32_bf16 v[52:55], a[28:31], v[84:87], v[52:55]
    ds_read_b128 v[72:75], v4 offset:10240
    v_mfma_f32_16x16x32_bf16 v[60:63], a[32:35], v[84:87], v[60:63]
    ds_write_b64 v7, v[28:29] offset:1024
    v_mfma_f32_16x16x32_bf16 v[64:67], a[32:35], v[88:91], v[64:67]
    s_waitcnt lgkmcnt(4)
    v_mul_f32 v32, v32, v115
    v_mul_f32 v33, v33, v115
    v_mfma_f32_16x16x32_bf16 v[44:47], a[36:39], v[92:95], v[44:47]
    ds_read_b128 v[76:79], v5 offset:8192
    v_mul_f32 v34, v34, v115
    v_mfma_f32_16x16x32_bf16 v[48:51], a[36:39], v[96:99], v[48:51]
    v_mul_f32 v35, v35, v115
    v_cvt_pk_bf16_f32 v32, v32, v33
    v_mfma_f32_16x16x32_bf16 v[56:59], a[40:43], v[96:99], v[56:59]
    v_cvt_pk_bf16_f32 v33, v34, v35
    v_mfma_f32_16x16x32_bf16 v[52:55], a[40:43], v[92:95], v[52:55]
    ds_read_b128 v[80:83], v5 offset:10240
    v_mfma_f32_16x16x32_bf16 v[60:63], a[44:47], v[92:95], v[60:63]
    ds_write_b64 v7, v[32:33] offset:7168
    v_mfma_f32_16x16x32_bf16 v[64:67], a[44:47], v[96:99], v[64:67]
    s_waitcnt lgkmcnt(4)
    v_mul_f32 v36, v36, v114
    v_mul_f32 v37, v37, v114
    v_mfma_f32_16x16x32_bf16 v[44:47], a[48:51], v[68:71], v[44:47]
    s_waitcnt vmcnt(1)
    ds_read_b128 v[84:87], v4 offset:12288
    v_cmp_ne_u32 vcc, 0, v116
    v_mfma_f32_16x16x32_bf16 v[48:51], a[48:51], v[72:75], v[48:51]
    v_mul_f32 v38, v38, v114
    v_mul_f32 v39, v39, v114
    v_mfma_f32_16x16x32_bf16 v[56:59], a[52:55], v[72:75], v[56:59]
    s_cbranch_vccnz L_spin7
L_back8:
    v_cvt_pk_bf16_f32 v36, v36, v37
    v_cvt_pk_bf16_f32 v37, v38, v39
    v_mfma_f32_16x16x32_bf16 v[52:55], a[52:55], v[68:71], v[52:55]
    ds_read_b128 v[88:91], v4 offset:14336
    v_mfma_f32_16x16x32_bf16 v[60:63], a[56:59], v[68:71], v[60:63]
    ds_write_b64 v8, v[36:37] offset:2048
    v_mfma_f32_16x16x32_bf16 v[64:67], a[56:59], v[72:75], v[64:67]
    s_waitcnt lgkmcnt(4)
    v_mul_f32 v40, v40, v115
    v_mul_f32 v41, v41, v115
    v_mfma_f32_16x16x32_bf16 v[44:47], a[60:63], v[76:79], v[44:47]
    ds_read_b128 v[92:95], v5 offset:12288
    v_mul_f32 v42, v42, v115
    v_mfma_f32_16x16x32_bf16 v[48:51], a[60:63], v[80:83], v[48:51]
    v_mul_f32 v43, v43, v115
    v_cvt_pk_bf16_f32 v40, v40, v41
    v_mfma_f32_16x16x32_bf16 v[56:59], a[64:67], v[80:83], v[56:59]
    v_cvt_pk_bf16_f32 v41, v42, v43
    v_mfma_f32_16x16x32_bf16 v[52:55], a[64:67], v[76:79], v[52:55]
    ds_read_b128 v[96:99], v5 offset:14336
    v_mfma_f32_16x16x32_bf16 v[60:63], a[68:71], v[76:79], v[60:63]
    ds_write_b64 v8, v[40:41] offset:8192
    v_mfma_f32_16x16x32_bf16 v[64:67], a[68:71], v[80:83], v[64:67]
    s_waitcnt lgkmcnt(4)
    v_mfma_f32_16x16x32_bf16 v[44:47], a[72:75], v[84:87], v[44:47]
    ds_read_b128 v[68:71], v4 offset:16384
    v_mfma_f32_16x16x32_bf16 v[48:51], a[72:75], v[88:91], v[48:51]
    v_mfma_f32_16x16x32_bf16 v[56:59], a[76:79], v[88:91], v[56:59]
    s_waitcnt lgkmcnt(1)
    s_barrier
    v_mfma_f32_16x16x32_bf16 v[52:55], a[76:79], v[84:87], v[52:55]
    ds_read_b128 v[72:75], v4 offset:18432
    v_mfma_f32_16x16x32_bf16 v[60:63], a[80:83], v[84:87], v[60:63]
    ds_read_b128 v[20:23], v10 offset:0
    v_mfma_f32_16x16x32_bf16 v[64:67], a[80:83], v[88:91], v[64:67]
    s_waitcnt lgkmcnt(4)
    ds_read_b128 v[24:27], v9 offset:1024
    v_mfma_f32_16x16x32_bf16 v[44:47], a[84:87], v[92:95], v[44:47]
    ds_read_b128 v[76:79], v5 offset:16384
    v_mfma_f32_16x16x32_bf16 v[48:51], a[84:87], v[96:99], v[48:51]
    ds_read_b128 v[28:31], v10 offset:1024
    s_add_u32 m0, s43, 0
    v_mfma_f32_16x16x32_bf16 v[56:59], a[88:91], v[96:99], v[56:59]
    buffer_load_dwordx4 v6, s[8:11], s41 offen offset:0 sc1 lds
    v_mfma_f32_16x16x32_bf16 v[52:55], a[88:91], v[92:95], v[52:55]
    s_add_u32 m0, s43, 3968
    ds_read_b128 v[80:83], v5 offset:18432
    v_mfma_f32_16x16x32_bf16 v[60:63], a[92:95], v[92:95], v[60:63]
    ds_read_b64_tr_b16 v[32:33], v9 offset:2048
    v_mfma_f32_16x16x32_bf16 v[64:67], a[92:95], v[96:99], v[64:67]
    s_waitcnt lgkmcnt(6)
    ds_read_b64_tr_b16 v[34:35], v10 offset:2048
    s_waitcnt lgkmcnt(3)
    v_mfma_f32_16x16x32_bf16 v[44:47], a[96:99], v[68:71], v[44:47]
    ds_read_b128 v[84:87], v4 offset:20480
    v_mfma_f32_16x16x32_bf16 v[40:43], v[24:27], v[20:23], 0
    ds_read_b64_tr_b16 v[36:37], v9 offset:2056
    v_mfma_f32_16x16x32_bf16 v[118:121], v[28:31], v[20:23], 0
    ds_read_b64_tr_b16 v[38:39], v10 offset:2056
    v_mfma_f32_16x16x32_bf16 v[48:51], a[96:99], v[72:75], v[48:51]
    v_mfma_f32_16x16x32_bf16 v[56:59], a[100:103], v[72:75], v[56:59]
    buffer_load_dwordx4 v6, s[8:11], s41 offen offset:128 sc1 lds
    v_mfma_f32_16x16x32_bf16 v[52:55], a[100:103], v[68:71], v[52:55]
    s_add_u32 m0, s43, 7936
    ds_read_b128 v[88:91], v4 offset:22528
    v_cndmask_b32 v40, v40, v41, s[56:57]
    v_mfma_f32_16x16x32_bf16 v[60:63], a[104:107], v[68:71], v[60:63]
    v_cndmask_b32 v42, v42, v43, s[56:57]
    v_cndmask_b32 v118, v118, v119, s[56:57]
    v_mfma_f32_16x16x32_bf16 v[64:67], a[104:107], v[72:75], v[64:67]
    s_waitcnt lgkmcnt(6)
    v_cndmask_b32 v120, v120, v121, s[56:57]
    v_cndmask_b32 v40, v18, v40, s[62:63]
    v_mfma_f32_16x16x32_bf16 v[44:47], a[108:111], v[76:79], v[44:47]
    ds_read_b128 v[92:95], v5 offset:20480
    v_cndmask_b32 v42, v18, v42, s[62:63]
    v_mfma_f32_16x16x32_bf16 v[48:51], a[108:111], v[80:83], v[48:51]
    v_cndmask_b32 v22, v40, v118, s[58:59]
    v_cndmask_b32 v23, v42, v120, s[60:61]
    v_mfma_f32_16x16x32_bf16 v[56:59], a[112:115], v[80:83], v[56:59]
    buffer_load_dwordx4 v6, s[8:11], s41 offen offset:256 sc1 lds
    v_mfma_f32_16x16x32_bf16 v[52:55], a[112:115], v[76:79], v[52:55]
    s_add_u32 m0, s43, 11904
    ds_read_b128 v[96:99], v5 offset:22528
    v_max_f32 v20, v22, v23
    v_mfma_f32_16x16x32_bf16 v[60:63], a[116:119], v[76:79], v[60:63]
    v_mov_b32 v21, v20
    v_mfma_f32_16x16x32_bf16 v[64:67], a[116:119], v[80:83], v[64:67]
    s_waitcnt lgkmcnt(2)
    v_permlane16_swap_b32 v20, v21
    v_mfma_f32_16x16x32_bf16 v[44:47], a[120:123], v[84:87], v[44:47]
    ds_read_b128 v[68:71], v4 offset:24576
    v_max_f32 v20, v20, v21
    v_mfma_f32_16x16x32_bf16 v[48:51], a[120:123], v[88:91], v[48:51]
    v_mov_b32 v21, v20
    v_mfma_f32_16x16x32_bf16 v[56:59], a[124:127], v[88:91], v[56:59]
    buffer_load_dwordx4 v6, s[8:11], s41 offen offset:384 sc1 lds
    v_mfma_f32_16x16x32_bf16 v[52:55], a[124:127], v[84:87], v[52:55]
    s_add_u32 m0, s43, 15872
    ds_read_b128 v[72:75], v4 offset:26624
    v_mfma_f32_16x16x32_bf16 v[60:63], a[128:131], v[84:87], v[60:63]
    v_permlane32_swap_b32 v20, v21
    v_mfma_f32_16x16x32_bf16 v[64:67], a[128:131], v[88:91], v[64:67]
    s_waitcnt lgkmcnt(2)
    v_max_f32 v20, v20, v21
    v_mul_f32 v20, s86, v20
    v_mfma_f32_16x16x32_bf16 v[44:47], a[132:135], v[92:95], v[44:47]
    ds_read_b128 v[76:79], v5 offset:24576
    v_fma_f32 v22, v22, s86, -v20
    v_mfma_f32_16x16x32_bf16 v[48:51], a[132:135], v[96:99], v[48:51]
    v_fma_f32 v23, v23, s86, -v20
    v_mfma_f32_16x16x32_bf16 v[56:59], a[136:139], v[96:99], v[56:59]
    buffer_load_dwordx4 v6, s[8:11], s41 offen offset:512 sc1 lds
    v_mfma_f32_16x16x32_bf16 v[52:55], a[136:139], v[92:95], v[52:55]
    s_add_u32 m0, s43, 19840
    ds_read_b128 v[80:83], v5 offset:26624
    v_mfma_f32_16x16x32_bf16 v[60:63], a[140:143], v[92:95], v[60:63]
    v_exp_f32 v22, v22
    v_mfma_f32_16x16x32_bf16 v[64:67], a[140:143], v[96:99], v[64:67]
    s_waitcnt lgkmcnt(2)
    v_exp_f32 v23, v23
    v_mfma_f32_16x16x32_bf16 v[44:47], a[144:147], v[68:71], v[44:47]
    ds_read_b128 v[84:87], v4 offset:28672
    v_cvt_pk_bf16_f32 v28, v22, v23
    v_mfma_f32_16x16x32_bf16 v[48:51], a[144:147], v[72:75], v[48:51]
    v_perm_b32 v24, v28, v28, v14
    v_perm_b32 v25, v28, v28, v15
    v_mfma_f32_16x16x32_bf16 v[56:59], a[148:151], v[72:75], v[56:59]
    buffer_load_dwordx4 v6, s[8:11], s41 offen offset:640 sc1 lds
    v_mfma_f32_16x16x32_bf16 v[52:55], a[148:151], v[68:71], v[52:55]
    s_add_u32 m0, s43, 23808
    ds_read_b128 v[88:91], v4 offset:30720
    v_perm_b32 v26, v28, v28, v16
    v_mfma_f32_16x16x32_bf16 v[60:63], a[152:155], v[68:71], v[60:63]
    v_perm_b32 v27, v28, v28, v17
    v_add_f32 v20, v22, v23
    v_mfma_f32_16x16x32_bf16 v[64:67], a[152:155], v[72:75], v[64:67]
    s_waitcnt lgkmcnt(2)
    v_mov_b32 v21, v20
    s_waitcnt lgkmcnt(9)
    v_mfma_f32_16x16x32_bf16 v[44:47], a[156:159], v[76:79], v[44:47]
    ds_read_b128 v[92:95], v5 offset:28672
    v_mfma_f32_16x16x32_bf16 v[40:43], v[32:35], v[24:27], 0
    v_mfma_f32_16x16x32_bf16 v[118:121], v[36:39], v[24:27], 0
    v_permlane16_swap_b32 v20, v21
    v_mfma_f32_16x16x32_bf16 v[48:51], a[156:159], v[80:83], v[48:51]
    v_add_f32 v20, v20, v21
    v_mov_b32 v21, v20
    v_mfma_f32_16x16x32_bf16 v[56:59], a[160:163], v[80:83], v[56:59]
    buffer_load_dwordx4 v6, s[8:11], s41 offen offset:768 sc1 lds
    v_mfma_f32_16x16x32_bf16 v[52:55], a[160:163], v[76:79], v[52:55]
    s_add_u32 m0, s43, 27776
    ds_read_b128 v[96:99], v5 offset:30720
    v_mfma_f32_16x16x32_bf16 v[60:63], a[164:167], v[76:79], v[60:63]
    v_permlane32_swap_b32 v20, v21
    v_mfma_f32_16x16x32_bf16 v[64:67], a[164:167], v[80:83], v[64:67]
    s_waitcnt lgkmcnt(2)
    v_add_f32 v20, v20, v21
    v_mfma_f32_16x16x32_bf16 v[44:47], a[168:171], v[84:87], v[44:47]
    ds_read_b128 v[68:71], v4 offset:32768
    v_mfma_f32_16x16x32_bf16 v[48:51], a[168:171], v[88:91], v[48:51]
    v_rcp_f32 v20, v20
    v_mfma_f32_16x16x32_bf16 v[56:59], a[172:175], v[88:91], v[56:59]
    buffer_load_dwordx4 v6, s[8:11], s41 offen offset:896 sc1 lds
    v_mfma_f32_16x16x32_bf16 v[52:55], a[172:175], v[84:87], v[52:55]
    s_add_u32 m0, s43, 31744
    ds_read_b128 v[72:75], v4 offset:34816
    v_mul_f32 v40, v40, v20
    v_mfma_f32_16x16x32_bf16 v[60:63], a[176:179], v[84:87], v[60:63]
    v_mul_f32 v41, v41, v20
    v_mul_f32 v42, v42, v20
    v_mfma_f32_16x16x32_bf16 v[64:67], a[176:179], v[88:91], v[64:67]
    s_waitcnt lgkmcnt(2)
    v_mul_f32 v43, v43, v20
    v_cvt_pk_bf16_f32 v28, v40, v41
    v_mfma_f32_16x16x32_bf16 v[44:47], a[180:183], v[92:95], v[44:47]
    ds_read_b128 v[76:79], v5 offset:32768
    v_cvt_pk_bf16_f32 v29, v42, v43
    v_mfma_f32_16x16x32_bf16 v[48:51], a[180:183], v[96:99], v[48:51]
    v_mul_f32 v118, v118, v20
    v_mul_f32 v119, v119, v20
    v_mfma_f32_16x16x32_bf16 v[56:59], a[184:187], v[96:99], v[56:59]
    buffer_load_dwordx4 v6, s[8:11], s41 offen offset:1024 sc1 lds
    v_mfma_f32_16x16x32_bf16 v[52:55], a[184:187], v[92:95], v[52:55]
    s_add_u32 m0, s43, 35712
    ds_read_b128 v[80:83], v5 offset:34816
    v_mul_f32 v120, v120, v20
    v_mfma_f32_16x16x32_bf16 v[60:63], a[188:191], v[92:95], v[60:63]
    v_mul_f32 v121, v121, v20
    v_cvt_pk_bf16_f32 v30, v118, v119
    v_mfma_f32_16x16x32_bf16 v[64:67], a[188:191], v[96:99], v[64:67]
    s_waitcnt lgkmcnt(2)
    v_cvt_pk_bf16_f32 v31, v120, v121
    v_mfma_f32_16x16x32_bf16 v[44:47], a[192:195], v[68:71], v[44:47]
    ds_read_b128 v[84:87], v4 offset:36864
    v_mfma_f32_16x16x32_bf16 v[48:51], a[192:195], v[72:75], v[48:51]
    buffer_store_dwordx4 v[28:31], v1, s[16:19], s44 offen sc1
    v_mfma_f32_16x16x32_bf16 v[56:59], a[196:199], v[72:75], v[56:59]
    buffer_load_dwordx4 v6, s[8:11], s41 offen offset:1152 sc1 lds
    v_mfma_f32_16x16x32_bf16 v[52:55], a[196:199], v[68:71], v[52:55]
    s_add_u32 m0, s43, 39680
    ds_read_b128 v[88:91], v4 offset:38912
    s_cmp_eq_u32 s36, 17
    v_mfma_f32_16x16x32_bf16 v[60:63], a[200:203], v[68:71], v[60:63]
    s_cselect_b32 s49, s87, 0x10000
    ds_read_b64 v[32:33], v13 offset:2048
    s_add_u32 s90, s90, s49
    v_mfma_f32_16x16x32_bf16 v[64:67], a[200:203], v[72:75], v[64:67]
    s_waitcnt lgkmcnt(3)
    ds_read_b64 v[34:35], v13 offset:2176
    s_and_b32 s49, s90, 0xffffffff
    v_mfma_f32_16x16x32_bf16 v[44:47], a[204:207], v[76:79], v[44:47]
    s_bitcmp1_b64 s[24:25], s36
    ds_read_b128 v[92:95], v5 offset:36864
    s_cselect_b32 s44, s49, 0x5e00000
    v_mfma_f32_16x16x32_bf16 v[48:51], a[204:207], v[80:83], v[48:51]
    s_bitcmp1_b64 s[26:27], s36
    ds_read_b64 v[36:37], v13 offset:2304
    s_cselect_b64 s[62:63], 0, -1
    v_mfma_f32_16x16x32_bf16 v[56:59], a[208:211], v[80:83], v[56:59]
    buffer_load_dwordx4 v6, s[8:11], s41 offen offset:1280 sc1 lds
    v_mfma_f32_16x16x32_bf16 v[52:55], a[208:211], v[76:79], v[52:55]
    s_add_u32 m0, s43, 43648
    ds_read_b128 v[96:99], v5 offset:38912
    v_mfma_f32_16x16x32_bf16 v[60:63], a[212:215], v[76:79], v[60:63]
    ds_read_b64 v[38:39], v13 offset:2432
    v_mfma_f32_16x16x32_bf16 v[64:67], a[212:215], v[80:83], v[64:67]
    s_waitcnt lgkmcnt(6)
    v_mfma_f32_16x16x32_bf16 v[44:47], a[216:219], v[84:87], v[44:47]
    ds_read_b128 v[68:71], v4 offset:40960
    v_mfma_f32_16x16x32_bf16 v[48:51], a[216:219], v[88:91], v[48:51]
    v_mfma_f32_16x16x32_bf16 v[56:59], a[220:223], v[88:91], v[56:59]
    buffer_load_dwordx4 v6, s[8:11], s41 offen offset:1408 sc1 lds
    v_mfma_f32_16x16x32_bf16 v[52:55], a[220:223], v[84:87], v[52:55]
    s_add_u32 m0, s43, 47616
    ds_read_b128 v[72:75], v4 offset:43008
    s_waitcnt lgkmcnt(2)
    v_mfma_f32_16x16x32_bf16 v[60:63], a[224:227], v[84:87], v[60:63]
    v_add_f32 v40, v36, v38
    v_add_f32 v41, v37, v39
    v_mfma_f32_16x16x32_bf16 v[64:67], a[224:227], v[88:91], v[64:67]
    s_waitcnt lgkmcnt(3)
    v_add_f32 v32, v32, v34
    v_add_f32 v33, v33, v35
    v_mfma_f32_16x16x32_bf16 v[44:47], a[228:231], v[92:95], v[44:47]
    ds_read_b128 v[76:79], v5 offset:40960
    v_add_f32 v32, v32, v40
    v_mfma_f32_16x16x32_bf16 v[48:51], a[228:231], v[96:99], v[48:51]
    v_add_f32 v33, v33, v41
    v_mov_b32 v40, v32
    v_mfma_f32_16x16x32_bf16 v[56:59], a[232:235], v[96:99], v[56:59]
    buffer_load_dwordx4 v6, s[8:11], s41 offen offset:1536 sc1 lds
    v_mfma_f32_16x16x32_bf16 v[52:55], a[232:235], v[92:95], v[52:55]
    s_add_u32 m0, s43, 51584
    ds_read_b128 v[80:83], v5 offset:43008
    v_mov_b32 v41, v33
    v_mfma_f32_16x16x32_bf16 v[60:63], a[236:239], v[92:95], v[60:63]
    v_permlane32_swap_b32 v32, v40
    v_mfma_f32_16x16x32_bf16 v[64:67], a[236:239], v[96:99], v[64:67]
    s_waitcnt lgkmcnt(2)
    v_permlane32_swap_b32 v33, v41
    v_mfma_f32_16x16x32_bf16 v[44:47], a[240:243], v[68:71], v[44:47]
    ds_read_b128 v[84:87], v4 offset:45056
    v_add_f32 v32, v32, v40
    v_mfma_f32_16x16x32_bf16 v[48:51], a[240:243], v[72:75], v[48:51]
    v_add_f32 v33, v33, v41
    v_mul_f32 v112, 0xba800000, v32
    v_mfma_f32_16x16x32_bf16 v[56:59], a[244:247], v[72:75], v[56:59]
    buffer_load_dwordx4 v6, s[8:11], s41 offen offset:1664 sc1 lds
    v_mfma_f32_16x16x32_bf16 v[52:55], a[244:247], v[68:71], v[52:55]
    s_add_u32 m0, s43, 55552
    ds_read_b128 v[88:91], v4 offset:47104
    v_mul_f32 v33, 0x3a800000, v33
    v_mfma_f32_16x16x32_bf16 v[60:63], a[248:251], v[68:71], v[60:63]
    v_fma_f32 v33, -v112, v112, v33
    v_mov_b32 v113, v112
    v_mfma_f32_16x16x32_bf16 v[64:67], a[248:251], v[72:75], v[64:67]
    s_waitcnt lgkmcnt(2)
    v_max_f32 v33, 0, v33
    v_add_f32 v33, 0x3727c5ac, v33
    v_mfma_f32_16x16x32_bf16 v[44:47], a[252:255], v[76:79], v[44:47]
    ds_read_b128 v[92:95], v5 offset:45056
    v_mfma_f32_16x16x32_bf16 v[48:51], a[252:255], v[80:83], v[48:51]
    v_rsq_f32 v114, v33
    v_mfma_f32_16x16x32_bf16 v[56:59], v[128:131], v[80:83], v[56:59]
    buffer_load_dwordx4 v6, s[8:11], s41 offen offset:1792 sc1 lds
    v_mfma_f32_16x16x32_bf16 v[52:55], v[128:131], v[76:79], v[52:55]
    s_add_u32 m0, s43, 59520
    ds_read_b128 v[96:99], v5 offset:47104
    v_mfma_f32_16x16x32_bf16 v[60:63], v[132:135], v[76:79], v[60:63]
    v_permlane16_swap_b32 v112, v113
    v_mfma_f32_16x16x32_bf16 v[64:67], v[132:135], v[80:83], v[64:67]
    s_waitcnt lgkmcnt(2)
    v_mov_b32 v115, v114
    v_fmac_f32 v48, v113, v100
    v_mfma_f32_16x16x32_bf16 v[44:47], v[136:139], v[84:87], v[44:47]
    ds_read_b128 v[68:71], v4 offset:49152
    v_fmac_f32 v52, v112, v104
    v_mfma_f32_16x16x32_bf16 v[48:51], v[136:139], v[88:91], v[48:51]
    v_permlane16_swap_b32 v114, v115
    v_mfma_f32_16x16x32_bf16 v[56:59], v[140:143], v[88:91], v[56:59]
    buffer_load_dwordx4 v6, s[8:11], s41 offen offset:1920 sc1 lds
    v_mfma_f32_16x16x32_bf16 v[52:55], v[140:143], v[84:87], v[52:55]
    s_add_u32 m0, s52, 90112
    ds_read_b128 v[72:75], v4 offset:51200
    v_fmac_f32 v44, v112, v100
    v_mfma_f32_16x16x32_bf16 v[60:63], v[144:147], v[84:87], v[60:63]
    v_fmac_f32 v45, v112, v101
    v_fmac_f32 v46, v112, v102
    v_mfma_f32_16x16x32_bf16 v[64:67], v[144:147], v[88:91], v[64:67]
    s_waitcnt lgkmcnt(2)
    v_fmac_f32 v49, v113, v101
    v_fmac_f32 v50, v113, v102
    v_mfma_f32_16x16x32_bf16 v[44:47], v[148:151], v[92:95], v[44:47]
    ds_read_b128 v[76:79], v5 offset:49152
    v_fmac_f32 v53, v112, v105
    v_mfma_f32_16x16x32_bf16 v[48:51], v[148:151], v[96:99], v[48:51]
    v_fmac_f32 v54, v112, v106
    v_fmac_f32 v55, v112, v107
    v_mfma_f32_16x16x32_bf16 v[56:59], v[152:155], v[96:99], v[56:59]
    buffer_load_dwordx4 v1, s[16:19], s46 offen sc1 lds
    v_mfma_f32_16x16x32_bf16 v[52:55], v[152:155], v[92:95], v[52:55]
    s_cmp_eq_u32 s36, s97
    ds_read_b128 v[80:83], v5 offset:51200
    v_med3_i32 v117, s45, 0, v12
    v_mfma_f32_16x16x32_bf16 v[60:63], v[156:159], v[92:95], v[60:63]
    s_cselect_b32 s47, 32, -2
    v_add_u32 v117, v117, v11
    v_fmac_f32 v47, v112, v103
    v_mfma_f32_16x16x32_bf16 v[64:67], v[156:159], v[96:99], v[64:67]
    s_waitcnt lgkmcnt(2)
    v_fmac_f32 v51, v113, v103
    v_fmac_f32 v56, v113, v104
    v_mfma_f32_16x16x32_bf16 v[44:47], v[160:163], v[68:71], v[44:47]
    s_cselect_b64 s[8:9], s[88:89], s[8:9]
    ds_read_b128 v[84:87], v4 offset:53248
    v_fmac_f32 v57, v113, v105
    v_mfma_f32_16x16x32_bf16 v[48:51], v[160:163], v[72:75], v[48:51]
    s_cselect_b32 s55, 0x543fc00, s55
    v_fmac_f32 v60, v112, v108
    v_fmac_f32 v61, v112, v109
    v_mfma_f32_16x16x32_bf16 v[56:59], v[164:167], v[72:75], v[56:59]
    s_add_u32 s45, s45, 65536
    v_fmac_f32 v62, v112, v110
    v_fmac_f32 v63, v112, v111
    v_mfma_f32_16x16x32_bf16 v[52:55], v[164:167], v[68:71], v[52:55]
    s_add_u32 s50, s50, s47
    ds_read_b128 v[88:91], v4 offset:55296
    v_fmac_f32 v64, v113, v108
    v_mfma_f32_16x16x32_bf16 v[60:63], v[168:171], v[68:71], v[60:63]
    buffer_load_dword v116, v117, s[16:19], 0 offen sc1
    v_mfma_f32_16x16x32_bf16 v[64:67], v[168:171], v[72:75], v[64:67]
    s_waitcnt lgkmcnt(2)
    v_fmac_f32 v58, v113, v106
    v_fmac_f32 v59, v113, v107
    v_mfma_f32_16x16x32_bf16 v[44:47], v[172:175], v[76:79], v[44:47]
    s_max_i32 s47, s50, 0
    ds_read_b128 v[92:95], v5 offset:53248
    s_min_i32 s47, s47, s96
    v_mfma_f32_16x16x32_bf16 v[48:51], v[172:175], v[80:83], v[48:51]
    s_lshl_b32 s41, s47, 15
    v_fmac_f32 v65, v113, v109
    v_fmac_f32 v66, v113, v110
    v_mfma_f32_16x16x32_bf16 v[56:59], v[176:179], v[80:83], v[56:59]
    s_lshl_b32 s46, s47, 10
    v_fmac_f32 v67, v113, v111
    s_sub_u32 s46, s55, s46
    v_mfma_f32_16x16x32_bf16 v[52:55], v[176:179], v[76:79], v[52:55]
    ds_read_b128 v[96:99], v5 offset:55296
    v_mfma_f32_16x16x32_bf16 v[60:63], v[180:183], v[76:79], v[60:63]
    v_mfma_f32_16x16x32_bf16 v[64:67], v[180:183], v[80:83], v[64:67]
    s_waitcnt lgkmcnt(2)
    v_mfma_f32_16x16x32_bf16 v[44:47], v[184:187], v[84:87], v[44:47]
    ds_read_b128 v[68:71], v4 offset:57344
    v_mfma_f32_16x16x32_bf16 v[48:51], v[184:187], v[88:91], v[48:51]
    v_mfma_f32_16x16x32_bf16 v[56:59], v[188:191], v[88:91], v[56:59]
    v_mfma_f32_16x16x32_bf16 v[52:55], v[188:191], v[84:87], v[52:55]
    ds_read_b128 v[72:75], v4 offset:59392
    v_mfma_f32_16x16x32_bf16 v[60:63], v[192:195], v[84:87], v[60:63]
    s_waitcnt vmcnt(9)
    s_barrier
    v_mfma_f32_16x16x32_bf16 v[64:67], v[192:195], v[88:91], v[64:67]
    s_waitcnt lgkmcnt(2)
    v_mfma_f32_16x16x32_bf16 v[44:47], v[196:199], v[92:95], v[44:47]
    ds_read_b128 v[76:79], v5 offset:57344
    v_mfma_f32_16x16x32_bf16 v[48:51], v[196:199], v[96:99], v[48:51]
    buffer_store_dword v124, v124, s[16:19], s91 offen sc1
    v_mfma_f32_16x16x32_bf16 v[56:59], v[200:203], v[96:99], v[56:59]
    s_add_u32 s91, s91, 65536
    v_mfma_f32_16x16x32_bf16 v[52:55], v[200:203], v[92:95], v[52:55]
    ds_read_b128 v[80:83], v5 offset:59392
    v_mfma_f32_16x16x32_bf16 v[60:63], v[204:207], v[92:95], v[60:63]
    v_mfma_f32_16x16x32_bf16 v[64:67], v[204:207], v[96:99], v[64:67]
    s_waitcnt lgkmcnt(2)
    v_mfma_f32_16x16x32_bf16 v[44:47], v[208:211], v[68:71], v[44:47]
    ds_read_b128 v[84:87], v4 offset:61440
    v_mfma_f32_16x16x32_bf16 v[48:51], v[208:211], v[72:75], v[48:51]
    v_mfma_f32_16x16x32_bf16 v[56:59], v[212:215], v[72:75], v[56:59]
    v_mfma_f32_16x16x32_bf16 v[52:55], v[212:215], v[68:71], v[52:55]
    ds_read_b128 v[88:91], v4 offset:63488
    v_mfma_f32_16x16x32_bf16 v[60:63], v[216:219], v[68:71], v[60:63]
    v_mfma_f32_16x16x32_bf16 v[64:67], v[216:219], v[72:75], v[64:67]
    s_waitcnt lgkmcnt(2)
    v_mfma_f32_16x16x32_bf16 v[44:47], v[220:223], v[76:79], v[44:47]
    ds_read_b128 v[92:95], v5 offset:61440
    v_mfma_f32_16x16x32_bf16 v[48:51], v[220:223], v[80:83], v[48:51]
    v_mfma_f32_16x16x32_bf16 v[56:59], v[224:227], v[80:83], v[56:59]
    v_mfma_f32_16x16x32_bf16 v[52:55], v[224:227], v[76:79], v[52:55]
    ds_read_b128 v[96:99], v5 offset:63488
    v_mfma_f32_16x16x32_bf16 v[60:63], v[228:231], v[76:79], v[60:63]
    v_mfma_f32_16x16x32_bf16 v[64:67], v[228:231], v[80:83], v[64:67]
    s_waitcnt lgkmcnt(2)
    v_mfma_f32_16x16x32_bf16 v[44:47], v[232:235], v[84:87], v[44:47]
    ds_read_b128 v[68:71], v2 offset:0
    v_mfma_f32_16x16x32_bf16 v[48:51], v[232:235], v[88:91], v[48:51]
    v_mfma_f32_16x16x32_bf16 v[56:59], v[236:239], v[88:91], v[56:59]
    v_mfma_f32_16x16x32_bf16 v[52:55], v[236:239], v[84:87], v[52:55]
    ds_read_b128 v[72:75], v2 offset:2048
    v_mfma_f32_16x16x32_bf16 v[60:63], v[240:243], v[84:87], v[60:63]
    v_mfma_f32_16x16x32_bf16 v[64:67], v[240:243], v[88:91], v[64:67]
    s_waitcnt lgkmcnt(2)
    v_mfma_f32_16x16x32_bf16 v[44:47], v[244:247], v[92:95], v[44:47]
    ds_read_b128 v[76:79], v3 offset:0
    v_mfma_f32_16x16x32_bf16 v[48:51], v[244:247], v[96:99], v[48:51]
    v_mfma_f32_16x16x32_bf16 v[56:59], v[248:251], v[96:99], v[56:59]
    v_mfma_f32_16x16x32_bf16 v[52:55], v[248:251], v[92:95], v[52:55]
    ds_read_b128 v[80:83], v3 offset:2048
    v_mfma_f32_16x16x32_bf16 v[60:63], v[252:255], v[92:95], v[60:63]
    s_add_u32 s36, s36, 1
    v_mfma_f32_16x16x32_bf16 v[64:67], v[252:255], v[96:99], v[64:67]
    s_waitcnt lgkmcnt(2)
    s_cmp_lt_u32 s36, 33
    s_cbranch_scc1 L_q_b0
    s_nop 7
    v_mul_f32 v44, v44, v114
    v_mul_f32 v45, v45, v114
    v_mul_f32 v46, v46, v114
    v_mul_f32 v47, v47, v114
    v_cvt_pk_bf16_f32 v44, v44, v45
    v_cvt_pk_bf16_f32 v45, v46, v47
    ds_write_b64 v7, v[44:45] offset:12288
    v_mul_f32 v48, v48, v115
    v_mul_f32 v49, v49, v115
    v_mul_f32 v50, v50, v115
    v_mul_f32 v51, v51, v115
    v_cvt_pk_bf16_f32 v48, v48, v49
    v_cvt_pk_bf16_f32 v49, v50, v51
    ds_write_b64 v7, v[48:49] offset:18432
    v_mul_f32 v52, v52, v114
    v_mul_f32 v53, v53, v114
    v_mul_f32 v54, v54, v114
    v_mul_f32 v55, v55, v114
    v_cvt_pk_bf16_f32 v52, v52, v53
    v_cvt_pk_bf16_f32 v53, v54, v55
    ds_write_b64 v7, v[52:53] offset:13312
    v_mul_f32 v56, v56, v115
    v_mul_f32 v57, v57, v115
    v_mul_f32 v58, v58, v115
    v_mul_f32 v59, v59, v115
    v_cvt_pk_bf16_f32 v56, v56, v57
    v_cvt_pk_bf16_f32 v57, v58, v59
    ds_write_b64 v7, v[56:57] offset:19456
    v_mul_f32 v60, v60, v114
    v_mul_f32 v61, v61, v114
    v_mul_f32 v62, v62, v114
    v_mul_f32 v63, v63, v114
    v_cvt_pk_bf16_f32 v60, v60, v61
    v_cvt_pk_bf16_f32 v61, v62, v63
    ds_write_b64 v8, v[60:61] offset:14336
    v_mul_f32 v64, v64, v115
    v_mul_f32 v65, v65, v115
    v_mul_f32 v66, v66, v115
    v_mul_f32 v67, v67, v115
    v_cvt_pk_bf16_f32 v64, v64, v65
    v_cvt_pk_bf16_f32 v65, v66, v67
    ds_write_b64 v8, v[64:65] offset:20480
    s_waitcnt lgkmcnt(0)
    s_barrier
    ds_read_b128 v[44:47], v9 offset:6144
    ds_read_b128 v[48:51], v9 offset:13312
    ds_read_b128 v[52:55], v9 offset:7168
    ds_read_b64_tr_b16 v[56:57], v9 offset:14336
    ds_read_b64_tr_b16 v[58:59], v9 offset:8192
    ds_read_b64_tr_b16 v[60:61], v9 offset:14344
    ds_read_b64_tr_b16 v[62:63], v9 offset:8200
    s_waitcnt lgkmcnt(4)
    v_mfma_f32_16x16x32_bf16 v[64:67], v[48:51], v[44:47], 0
    v_mfma_f32_16x16x32_bf16 v[118:121], v[52:55], v[44:47], 0
    s_nop 5
    v_cndmask_b32 v64, v64, v65, s[56:57]
    v_cndmask_b32 v66, v66, v67, s[56:57]
    v_cndmask_b32 v118, v118, v119, s[56:57]
    v_cndmask_b32 v120, v120, v121, s[56:57]
    v_cndmask_b32 v64, v18, v64, s[62:63]
    v_cndmask_b32 v66, v18, v66, s[62:63]
    v_cndmask_b32 v46, v64, v118, s[58:59]
    v_cndmask_b32 v47, v66, v120, s[60:61]
    v_max_f32 v44, v46, v47
    v_mov_b32 v45, v44
    s_nop 1
    v_permlane16_swap_b32 v44, v45
    v_max_f32 v44, v44, v45
    v_mov_b32 v45, v44
    s_nop 1
    v_permlane32_swap_b32 v44, v45
    v_max_f32 v44, v44, v45
    v_mul_f32 v44, s86, v44
    v_fma_f32 v46, v46, s86, -v44
    v_fma_f32 v47, v47, s86, -v44
    v_exp_f32 v46, v46
    v_exp_f32 v47, v47
    s_nop 0
    v_cvt_pk_bf16_f32 v52, v46, v47
    v_perm_b32 v48, v52, v52, v14
    v_perm_b32 v49, v52, v52, v15
    v_perm_b32 v50, v52, v52, v16
    v_perm_b32 v51, v52, v52, v17
    s_waitcnt lgkmcnt(0)
    v_add_f32 v44, v46, v47
    v_mfma_f32_16x16x32_bf16 v[64:67], v[56:59], v[48:51], 0
    v_mfma_f32_16x16x32_bf16 v[118:121], v[60:63], v[48:51], 0
    v_mov_b32 v45, v44
    s_nop 1
    v_permlane16_swap_b32 v44, v45
    v_add_f32 v44, v44, v45
    v_mov_b32 v45, v44
    s_nop 1
    v_permlane32_swap_b32 v44, v45
    v_add_f32 v44, v44, v45
    v_rcp_f32 v44, v44
    s_nop 0
    v_mul_f32 v64, v64, v44
    v_mul_f32 v65, v65, v44
    v_mul_f32 v66, v66, v44
    v_mul_f32 v67, v67, v44
    v_cvt_pk_bf16_f32 v52, v64, v65
    v_cvt_pk_bf16_f32 v53, v66, v67
    v_mul_f32 v118, v118, v44
    v_mul_f32 v119, v119, v44
    v_mul_f32 v120, v120, v44
    v_mul_f32 v121, v121, v44
    v_cvt_pk_bf16_f32 v54, v118, v119
    v_cvt_pk_bf16_f32 v55, v120, v121
    buffer_store_dwordx4 v[52:55], v1, s[16:19], s44 offen sc1
    s_waitcnt vmcnt(0)
    s_barrier
    buffer_store_dword v124, v124, s[16:19], s91 offen sc1
    s_add_u32 s91, s91, 65536
    s_waitcnt vmcnt(0)
    s_endpgm
L_q_short:
    s_nop 5
    s_waitcnt lgkmcnt(2)
    v_mfma_f32_16x16x32_bf16 v[48:51], a[0:3], v[72:75], 0
    s_mov_b32 s39, 0x5e00000
    ds_read_b128 v[96:99], v5 offset:6144
    v_mul_f32 v20, v20, v114
    v_mfma_f32_16x16x32_bf16 v[56:59], a[4:7], v[72:75], 0
    ds_read_b128 v[88:91], v4 offset:6144
    v_mul_f32 v21, v21, v114
    v_mfma_f32_16x16x32_bf16 v[64:67], a[8:11], v[72:75], 0
    s_waitcnt lgkmcnt(2)
    v_mul_f32 v22, v22, v114
    v_mul_f32 v23, v23, v114
    v_mfma_f32_16x16x32_bf16 v[48:51], a[12:15], v[80:83], v[48:51]
    ds_read_b128 v[72:75], v4 offset:10240
    v_cvt_pk_bf16_f32 v20, v20, v21
    v_mfma_f32_16x16x32_bf16 v[56:59], a[16:19], v[80:83], v[56:59]
    v_cvt_pk_bf16_f32 v21, v22, v23
    ds_write_b64 v7, v[20:21] offset:0
    v_mfma_f32_16x16x32_bf16 v[64:67], a[20:23], v[80:83], v[64:67]
    s_waitcnt lgkmcnt(2)
    v_mul_f32 v24, v24, v115
    v_mul_f32 v25, v25, v115
    v_mfma_f32_16x16x32_bf16 v[48:51], a[24:27], v[88:91], v[48:51]
    ds_read_b128 v[80:83], v5 offset:10240
    v_mul_f32 v26, v26, v115
    v_mfma_f32_16x16x32_bf16 v[56:59], a[28:31], v[88:91], v[56:59]
    v_mul_f32 v27, v27, v115
    v_cvt_pk_bf16_f32 v24, v24, v25
    v_mfma_f32_16x16x32_bf16 v[64:67], a[32:35], v[88:91], v[64:67]
    s_waitcnt lgkmcnt(4)
    v_cvt_pk_bf16_f32 v25, v26, v27
    ds_write_b64 v7, v[24:25] offset:6144
    v_mfma_f32_16x16x32_bf16 v[48:51], a[36:39], v[96:99], v[48:51]
    ds_read_b128 v[88:91], v4 offset:14336
    v_mul_f32 v28, v28, v114
    v_mfma_f32_16x16x32_bf16 v[56:59], a[40:43], v[96:99], v[56:59]
    v_mul_f32 v29, v29, v114
    v_mul_f32 v30, v30, v114
    v_mfma_f32_16x16x32_bf16 v[64:67], a[44:47], v[96:99], v[64:67]
    s_waitcnt lgkmcnt(4)
    v_mul_f32 v31, v31, v114
    v_cvt_pk_bf16_f32 v28, v28, v29
    v_mfma_f32_16x16x32_bf16 v[48:51], a[48:51], v[72:75], v[48:51]
    ds_read_b128 v[96:99], v5 offset:14336
    v_cvt_pk_bf16_f32 v29, v30, v31
    v_mfma_f32_16x16x32_bf16 v[56:59], a[52:55], v[72:75], v[56:59]
    ds_write_b64 v7, v[28:29] offset:1024
    v_mfma_f32_16x16x32_bf16 v[64:67], a[56:59], v[72:75], v[64:67]
    s_waitcnt lgkmcnt(4)
    v_mul_f32 v32, v32, v115
    v_mul_f32 v33, v33, v115
    v_mfma_f32_16x16x32_bf16 v[48:51], a[60:63], v[80:83], v[48:51]
    ds_read_b128 v[72:75], v4 offset:18432
    v_mul_f32 v34, v34, v115
    v_mfma_f32_16x16x32_bf16 v[56:59], a[64:67], v[80:83], v[56:59]
    v_mul_f32 v35, v35, v115
    v_cvt_pk_bf16_f32 v32, v32, v33
    v_mfma_f32_16x16x32_bf16 v[64:67], a[68:71], v[80:83], v[64:67]
    s_waitcnt lgkmcnt(3)
    v_cvt_pk_bf16_f32 v33, v34, v35
    ds_write_b64 v7, v[32:33] offset:7168
    v_mfma_f32_16x16x32_bf16 v[48:51], a[72:75], v[88:91], v[48:51]
    ds_read_b128 v[80:83], v5 offset:18432
    v_mul_f32 v36, v36, v114
    v_mfma_f32_16x16x32_bf16 v[56:59], a[76:79], v[88:91], v[56:59]
    v_mul_f32 v37, v37, v114
    v_mul_f32 v38, v38, v114
    v_mfma_f32_16x16x32_bf16 v[64:67], a[80:83], v[88:91], v[64:67]
    s_waitcnt lgkmcnt(4)
    v_mul_f32 v39, v39, v114
    v_cvt_pk_bf16_f32 v36, v36, v37
    v_mfma_f32_16x16x32_bf16 v[48:51], a[84:87], v[96:99], v[48:51]
    s_waitcnt vmcnt(1)
    ds_read_b128 v[88:91], v4 offset:22528
    v_cmp_ne_u32 vcc, 0, v116
    v_mfma_f32_16x16x32_bf16 v[56:59], a[88:91], v[96:99], v[56:59]
    v_cvt_pk_bf16_f32 v37, v38, v39
    ds_write_b64 v8, v[36:37] offset:2048
    v_mfma_f32_16x16x32_bf16 v[64:67], a[92:95], v[96:99], v[64:67]
    s_waitcnt lgkmcnt(4)
    v_mul_f32 v40, v40, v115
    v_mul_f32 v41, v41, v115
    v_mfma_f32_16x16x32_bf16 v[48:51], a[96:99], v[72:75], v[48:51]
    s_cbranch_vccnz L_spin9
L_back10:
    ds_read_b128 v[96:99], v5 offset:22528
    v_mul_f32 v42, v42, v115
    v_mfma_f32_16x16x32_bf16 v[56:59], a[100:103], v[72:75], v[56:59]
    v_mul_f32 v43, v43, v115
    v_cvt_pk_bf16_f32 v40, v40, v41
    v_mfma_f32_16x16x32_bf16 v[64:67], a[104:107], v[72:75], v[64:67]
    s_waitcnt lgkmcnt(3)
    v_cvt_pk_bf16_f32 v41, v42, v43
    ds_write_b64 v8, v[40:41] offset:8192
    v_mfma_f32_16x16x32_bf16 v[48:51], a[108:111], v[80:83], v[48:51]
    ds_read_b128 v[72:75], v4 offset:26624
    v_mfma_f32_16x16x32_bf16 v[56:59], a[112:115], v[80:83], v[56:59]
    v_mfma_f32_16x16x32_bf16 v[64:67], a[116:119], v[80:83], v[64:67]
    s_waitcnt lgkmcnt(4)
    s_waitcnt lgkmcnt(1)
    s_barrier
    v_mfma_f32_16x16x32_bf16 v[48:51], a[120:123], v[88:91], v[48:51]
    s_add_u32 m0, s43, 0
    ds_read_b128 v[80:83], v5 offset:26624
    buffer_load_dwordx4 v6, s[8:11], s41 offen offset:0 sc1 lds
    v_mfma_f32_16x16x32_bf16 v[56:59], a[124:127], v[88:91], v[56:59]
    s_add_u32 m0, s43, 3968
    ds_read_b128 v[20:23], v10 offset:0
    ds_read_b128 v[24:27], v9 offset:1024
    v_mfma_f32_16x16x32_bf16 v[64:67], a[128:131], v[88:91], v[64:67]
    s_waitcnt lgkmcnt(5)
    ds_read_b128 v[28:31], v10 offset:1024
    ds_read_b64_tr_b16 v[32:33], v9 offset:2048
    v_mfma_f32_16x16x32_bf16 v[48:51], a[132:135], v[96:99], v[48:51]
    ds_read_b128 v[88:91], v4 offset:30720
    buffer_load_dwordx4 v6, s[8:11], s41 offen offset:128 sc1 lds
    v_mfma_f32_16x16x32_bf16 v[56:59], a[136:139], v[96:99], v[56:59]
    s_add_u32 m0, s43, 7936
    ds_read_b64_tr_b16 v[34:35], v10 offset:2048
    ds_read_b64_tr_b16 v[36:37], v9 offset:2056
    v_mfma_f32_16x16x32_bf16 v[64:67], a[140:143], v[96:99], v[64:67]
    s_waitcnt lgkmcnt(8)
    ds_read_b64_tr_b16 v[38:39], v10 offset:2056
    ds_read_b64 v[44:45], v13 offset:2048
    v_mfma_f32_16x16x32_bf16 v[48:51], a[144:147], v[72:75], v[48:51]
    s_waitcnt lgkmcnt(6)
    ds_read_b128 v[96:99], v5 offset:30720
    buffer_load_dwordx4 v6, s[8:11], s41 offen offset:256 sc1 lds
    v_mfma_f32_16x16x32_bf16 v[56:59], a[148:151], v[72:75], v[56:59]
    v_mfma_f32_16x16x32_bf16 v[40:43], v[24:27], v[20:23], 0
    v_mfma_f32_16x16x32_bf16 v[118:121], v[28:31], v[20:23], 0
    s_add_u32 m0, s43, 11904
    ds_read_b64 v[46:47], v13 offset:2176
    ds_read_b64 v[52:53], v13 offset:2304
    v_mfma_f32_16x16x32_bf16 v[64:67], a[152:155], v[72:75], v[64:67]
    s_waitcnt lgkmcnt(12)
    v_cndmask_b32 v40, v40, v41, s[56:57]
    v_cndmask_b32 v42, v42, v43, s[56:57]
    v_mfma_f32_16x16x32_bf16 v[48:51], a[156:159], v[80:83], v[48:51]
    ds_read_b128 v[72:75], v4 offset:34816
    buffer_load_dwordx4 v6, s[8:11], s41 offen offset:384 sc1 lds
    v_mfma_f32_16x16x32_bf16 v[56:59], a[160:163], v[80:83], v[56:59]
    s_add_u32 m0, s43, 15872
    v_cndmask_b32 v118, v118, v119, s[56:57]
    v_cndmask_b32 v120, v120, v121, s[56:57]
    v_mfma_f32_16x16x32_bf16 v[64:67], a[164:167], v[80:83], v[64:67]
    s_waitcnt lgkmcnt(8)
    v_cndmask_b32 v40, v18, v40, s[62:63]
    v_cndmask_b32 v42, v18, v42, s[62:63]
    v_mfma_f32_16x16x32_bf16 v[48:51], a[168:171], v[88:91], v[48:51]
    ds_read_b128 v[80:83], v5 offset:34816
    buffer_load_dwordx4 v6, s[8:11], s41 offen offset:512 sc1 lds
    v_mfma_f32_16x16x32_bf16 v[56:59], a[172:175], v[88:91], v[56:59]
    s_add_u32 m0, s43, 19840
    v_cndmask_b32 v22, v40, v118, s[58:59]
    v_cndmask_b32 v23, v42, v120, s[60:61]
    v_mfma_f32_16x16x32_bf16 v[64:67], a[176:179], v[88:91], v[64:67]
    s_waitcnt lgkmcnt(4)
    v_max_f32 v20, v22, v23
    v_mov_b32 v21, v20
    v_mfma_f32_16x16x32_bf16 v[48:51], a[180:183], v[96:99], v[48:51]
    ds_read_b128 v[88:91], v4 offset:38912
    buffer_load_dwordx4 v6, s[8:11], s41 offen offset:640 sc1 lds
    v_mfma_f32_16x16x32_bf16 v[56:59], a[184:187], v[96:99], v[56:59]
    s_add_u32 m0, s43, 23808
    v_permlane16_swap_b32 v20, v21
    v_mfma_f32_16x16x32_bf16 v[64:67], a[188:191], v[96:99], v[64:67]
    s_waitcnt lgkmcnt(2)
    v_max_f32 v20, v20, v21
    v_mov_b32 v21, v20
    v_mfma_f32_16x16x32_bf16 v[48:51], a[192:195], v[72:75], v[48:51]
    ds_read_b128 v[96:99], v5 offset:38912
    buffer_load_dwordx4 v6, s[8:11], s41 offen offset:768 sc1 lds
    v_mfma_f32_16x16x32_bf16 v[56:59], a[196:199], v[72:75], v[56:59]
    s_add_u32 m0, s43, 27776
    v_permlane32_swap_b32 v20, v21
    v_mfma_f32_16x16x32_bf16 v[64:67], a[200:203], v[72:75], v[64:67]
    s_waitcnt lgkmcnt(2)
    v_max_f32 v20, v20, v21
    v_mul_f32 v20, s86, v20
    v_mfma_f32_16x16x32_bf16 v[48:51], a[204:207], v[80:83], v[48:51]
    ds_read_b128 v[72:75], v4 offset:43008
    buffer_load_dwordx4 v6, s[8:11], s41 offen offset:896 sc1 lds
    v_mfma_f32_16x16x32_bf16 v[56:59], a[208:211], v[80:83], v[56:59]
    s_add_u32 m0, s43, 31744
    v_fma_f32 v22, v22, s86, -v20
    v_fma_f32 v23, v23, s86, -v20
    v_mfma_f32_16x16x32_bf16 v[64:67], a[212:215], v[80:83], v[64:67]
    s_waitcnt lgkmcnt(2)
    v_exp_f32 v22, v22
    v_mfma_f32_16x16x32_bf16 v[48:51], a[216:219], v[88:91], v[48:51]
    ds_read_b128 v[80:83], v5 offset:43008
    buffer_load_dwordx4 v6, s[8:11], s41 offen offset:1024 sc1 lds
    v_mfma_f32_16x16x32_bf16 v[56:59], a[220:223], v[88:91], v[56:59]
    s_add_u32 m0, s43, 35712
    v_exp_f32 v23, v23
    v_mfma_f32_16x16x32_bf16 v[64:67], a[224:227], v[88:91], v[64:67]
    s_waitcnt lgkmcnt(2)
    v_cvt_pk_bf16_f32 v28, v22, v23
    v_perm_b32 v24, v28, v28, v14
    v_mfma_f32_16x16x32_bf16 v[48:51], a[228:231], v[96:99], v[48:51]
    ds_read_b128 v[88:91], v4 offset:47104
    buffer_load_dwordx4 v6, s[8:11], s41 offen offset:1152 sc1 lds
    v_mfma_f32_16x16x32_bf16 v[56:59], a[232:235], v[96:99], v[56:59]
    s_add_u32 m0, s43, 39680
    v_perm_b32 v25, v28, v28, v15
    v_perm_b32 v26, v28, v28, v16
    v_mfma_f32_16x16x32_bf16 v[64:67], a[236:239], v[96:99], v[64:67]
    s_waitcnt lgkmcnt(2)
    v_perm_b32 v27, v28, v28, v17
    v_add_f32 v20, v22, v23
    v_mfma_f32_16x16x32_bf16 v[48:51], a[240:243], v[72:75], v[48:51]
    s_waitcnt lgkmcnt(11)
    ds_read_b128 v[96:99], v5 offset:47104
    buffer_load_dwordx4 v6, s[8:11], s41 offen offset:1280 sc1 lds
    v_mfma_f32_16x16x32_bf16 v[56:59], a[244:247], v[72:75], v[56:59]
    v_mfma_f32_16x16x32_bf16 v[40:43], v[32:35], v[24:27], 0
    v_mfma_f32_16x16x32_bf16 v[118:121], v[36:39], v[24:27], 0
    s_add_u32 m0, s43, 43648
    v_mov_b32 v21, v20
    ds_read_b64 v[54:55], v13 offset:2432
    v_mfma_f32_16x16x32_bf16 v[64:67], a[248:251], v[72:75], v[64:67]
    s_waitcnt lgkmcnt(3)
    v_permlane16_swap_b32 v20, v21
    v_mfma_f32_16x16x32_bf16 v[48:51], a[252:255], v[80:83], v[48:51]
    ds_read_b128 v[72:75], v4 offset:51200
    buffer_load_dwordx4 v6, s[8:11], s41 offen offset:1408 sc1 lds
    v_mfma_f32_16x16x32_bf16 v[56:59], v[128:131], v[80:83], v[56:59]
    s_add_u32 m0, s43, 47616
    v_add_f32 v20, v20, v21
    v_mov_b32 v21, v20
    v_mfma_f32_16x16x32_bf16 v[64:67], v[132:135], v[80:83], v[64:67]
    s_waitcnt lgkmcnt(3)
    v_permlane32_swap_b32 v20, v21
    v_mfma_f32_16x16x32_bf16 v[48:51], v[136:139], v[88:91], v[48:51]
    s_waitcnt lgkmcnt(1)
    ds_read_b128 v[80:83], v5 offset:51200
    buffer_load_dwordx4 v6, s[8:11], s41 offen offset:1536 sc1 lds
    v_mfma_f32_16x16x32_bf16 v[56:59], v[140:143], v[88:91], v[56:59]
    s_add_u32 m0, s43, 51584
    v_add_f32 v20, v20, v21
    v_rcp_f32 v20, v20
    v_mfma_f32_16x16x32_bf16 v[64:67], v[144:147], v[88:91], v[64:67]
    s_waitcnt lgkmcnt(3)
    v_mul_f32 v40, v40, v20
    v_mul_f32 v41, v41, v20
    v_mfma_f32_16x16x32_bf16 v[48:51], v[148:151], v[96:99], v[48:51]
    ds_read_b128 v[88:91], v4 offset:55296
    buffer_load_dwordx4 v6, s[8:11], s41 offen offset:1664 sc1 lds
    v_mfma_f32_16x16x32_bf16 v[56:59], v[152:155], v[96:99], v[56:59]
    s_add_u32 m0, s43, 55552
    v_mul_f32 v42, v42, v20
    v_mul_f32 v43, v43, v20
    v_mfma_f32_16x16x32_bf16 v[64:67], v[156:159], v[96:99], v[64:67]
    s_waitcnt lgkmcnt(2)
    v_cvt_pk_bf16_f32 v28, v40, v41
    v_cvt_pk_bf16_f32 v29, v42, v43
    v_mfma_f32_16x16x32_bf16 v[48:51], v[160:163], v[72:75], v[48:51]
    ds_read_b128 v[96:99], v5 offset:55296
    buffer_load_dwordx4 v6, s[8:11], s41 offen offset:1792 sc1 lds
    v_mfma_f32_16x16x32_bf16 v[56:59], v[164:167], v[72:75], v[56:59]
    s_add_u32 m0, s43, 59520
    v_mul_f32 v118, v118, v20
    v_mul_f32 v119, v119, v20
    v_mfma_f32_16x16x32_bf16 v[64:67], v[168:171], v[72:75], v[64:67]
    s_waitcnt lgkmcnt(2)
    v_mul_f32 v120, v120, v20
    v_mul_f32 v121, v121, v20
    v_mfma_f32_16x16x32_bf16 v[48:51], v[172:175], v[80:83], v[48:51]
    ds_read_b128 v[72:75], v4 offset:59392
    buffer_load_dwordx4 v6, s[8:11], s41 offen offset:1920 sc1 lds
    v_mfma_f32_16x16x32_bf16 v[56:59], v[176:179], v[80:83], v[56:59]
    s_add_u32 m0, s52, 90112
    v_cvt_pk_bf16_f32 v30, v118, v119
    v_cvt_pk_bf16_f32 v31, v120, v121
    v_mfma_f32_16x16x32_bf16 v[64:67], v[180:183], v[80:83], v[64:67]
    s_waitcnt lgkmcnt(2)
    buffer_store_dwordx4 v[28:31], v1, s[16:19], s44 offen sc1
    v_mfma_f32_16x16x32_bf16 v[48:51], v[184:187], v[88:91], v[48:51]
    s_cmp_eq_u32 s36, 17
    ds_read_b128 v[80:83], v5 offset:59392
    buffer_load_dwordx4 v1, s[16:19], s46 offen sc1 lds
    v_mfma_f32_16x16x32_bf16 v[56:59], v[188:191], v[88:91], v[56:59]
    s_cselect_b32 s49, s87, 0x10000
    v_med3_i32 v117, s45, 0, v12
    v_add_u32 v117, v117, v11
    v_mfma_f32_16x16x32_bf16 v[64:67], v[192:195], v[88:91], v[64:67]
    s_waitcnt lgkmcnt(2)
    v_add_f32 v60, v52, v54
    v_add_f32 v61, v53, v55
    v_mfma_f32_16x16x32_bf16 v[48:51], v[196:199], v[96:99], v[48:51]
    s_add_u32 s45, s45, 65536
    ds_read_b128 v[88:91], v4 offset:63488
    buffer_load_dword v116, v117, s[16:19], 0 offen sc1
    v_mfma_f32_16x16x32_bf16 v[56:59], v[200:203], v[96:99], v[56:59]
    buffer_store_dword v124, v124, s[16:19], s39 offen sc1
    v_mfma_f32_16x16x32_bf16 v[64:67], v[204:207], v[96:99], v[64:67]
    s_waitcnt lgkmcnt(2)
    v_add_f32 v44, v44, v46
    v_add_f32 v45, v45, v47
    v_mfma_f32_16x16x32_bf16 v[48:51], v[208:211], v[72:75], v[48:51]
    s_add_u32 s90, s90, s49
    ds_read_b128 v[96:99], v5 offset:63488
    v_add_f32 v44, v44, v60
    v_mfma_f32_16x16x32_bf16 v[56:59], v[212:215], v[72:75], v[56:59]
    s_and_b32 s49, s90, 0xffffffff
    v_add_f32 v45, v45, v61
    v_mov_b32 v60, v44
    v_mfma_f32_16x16x32_bf16 v[64:67], v[216:219], v[72:75], v[64:67]
    s_waitcnt lgkmcnt(2)
    v_mov_b32 v61, v45
    v_permlane32_swap_b32 v44, v60
    v_mfma_f32_16x16x32_bf16 v[48:51], v[220:223], v[80:83], v[48:51]
    s_bitcmp1_b64 s[24:25], s36
    v_permlane32_swap_b32 v45, v61
    v_mfma_f32_16x16x32_bf16 v[56:59], v[224:227], v[80:83], v[56:59]
    s_cselect_b32 s44, s49, 0x5e00000
    v_add_f32 v44, v44, v60
    v_add_f32 v45, v45, v61
    v_mfma_f32_16x16x32_bf16 v[64:67], v[228:231], v[80:83], v[64:67]
    s_waitcnt lgkmcnt(1)
    v_mul_f32 v112, 0xba800000, v44
    v_mul_f32 v45, 0x3a800000, v45
    v_mfma_f32_16x16x32_bf16 v[48:51], v[232:235], v[88:91], v[48:51]
    s_bitcmp1_b64 s[26:27], s36
    v_fma_f32 v45, -v112, v112, v45
    v_mov_b32 v113, v112
    v_mfma_f32_16x16x32_bf16 v[56:59], v[236:239], v[88:91], v[56:59]
    s_cselect_b64 s[62:63], 0, -1
    v_max_f32 v45, 0, v45
    v_add_f32 v45, 0x3727c5ac, v45
    v_mfma_f32_16x16x32_bf16 v[64:67], v[240:243], v[88:91], v[64:67]
    s_waitcnt lgkmcnt(0)
    v_rsq_f32 v114, v45
    v_mfma_f32_16x16x32_bf16 v[48:51], v[244:247], v[96:99], v[48:51]
    s_cmp_eq_u32 s36, s97
    v_permlane16_swap_b32 v112, v113
    v_mfma_f32_16x16x32_bf16 v[56:59], v[248:251], v[96:99], v[56:59]
    s_cselect_b32 s47, 32, -2
    v_mov_b32 v115, v114
    s_cselect_b64 s[8:9], s[88:89], s[8:9]
    v_mfma_f32_16x16x32_bf16 v[64:67], v[252:255], v[96:99], v[64:67]
    s_cselect_b32 s55, 0x543fc00, s55
    v_permlane16_swap_b32 v114, v115
    s_add_u32 s50, s50, s47
    s_max_i32 s47, s50, 0
    s_min_i32 s47, s47, s96
    s_lshl_b32 s41, s47, 15
    s_lshl_b32 s46, s47, 10
    s_sub_u32 s46, s55, s46
    v_fmac_f32 v48, v113, v100
    v_fmac_f32 v49, v113, v101
    v_fmac_f32 v50, v113, v102
    v_fmac_f32 v51, v113, v103
    v_fmac_f32 v56, v113, v104
    v_fmac_f32 v57, v113, v105
    v_fmac_f32 v58, v113, v106
    v_fmac_f32 v59, v113, v107
    v_fmac_f32 v64, v113, v108
    v_fmac_f32 v65, v113, v109
    v_fmac_f32 v66, v113, v110
    v_fmac_f32 v67, v113, v111
    s_waitcnt vmcnt(12)
    s_barrier
    ds_read_b128 v[68:71], v2 offset:0
    ds_read_b128 v[72:75], v2 offset:2048
    ds_read_b128 v[76:79], v3 offset:0
    ds_read_b128 v[80:83], v3 offset:2048
    s_waitcnt lgkmcnt(0)
    s_add_u32 s36, s36, 1
    s_branch L_q_b0
L_spin1:
    s_mov_b32 s40, 0x20000
L_spin1_l:
    buffer_load_dword v37, v36, s[20:23], 64 offen sc1
    s_sub_u32 s40, s40, 1
    s_waitcnt vmcnt(0)
    v_cmp_eq_u32 vcc, v36, v37
    s_cbranch_scc1 L_back2
    s_cbranch_vccz L_back2
    s_sleep 8
    s_branch L_spin1_l
L_spin3:
    s_mov_b32 s40, 0x20000
L_spin3_l:
    buffer_load_dword v117, v116, s[20:23], 0 offen sc1
    s_sub_u32 s40, s40, 1
    s_waitcnt vmcnt(0)
    v_cmp_eq_u32 vcc, v116, v117
    s_cbranch_scc1 L_back4
    s_cbranch_vccz L_back4
    s_sleep 8
    s_branch L_spin3_l
L_spin5:
    s_mov_b32 s40, 0x20000
L_spin5_l:
    buffer_load_dword v116, v117, s[16:19], 0 offen sc1
    s_sub_u32 s40, s40, 1
    s_waitcnt vmcnt(0)
    v_cmp_ne_u32 vcc, 0, v116
    s_cbranch_scc1 L_back6
    s_cbranch_vccz L_back6
    s_sleep 2
    s_branch L_spin5_l
L_spin7:
    s_mov_b32 s40, 0x20000
L_spin7_l:
    buffer_load_dword v116, v117, s[16:19], 0 offen sc1
    s_sub_u32 s40, s40, 1
    s_waitcnt vmcnt(0)
    v_cmp_ne_u32 vcc, 0, v116
    s_cbranch_scc1 L_back8
    s_cbranch_vccz L_back8
    s_sleep 2
    s_branch L_spin7_l
L_spin9:
    s_mov_b32 s40, 0x20000
L_spin9_l:
    buffer_load_dword v116, v117, s[16:19], 0 offen sc1
    s_sub_u32 s40, s40, 1
    s_waitcnt vmcnt(0)
    v_cmp_ne_u32 vcc, 0, v116
    s_cbranch_scc1 L_back10
    s_cbranch_vccz L_back10
    s_sleep 2
    s_branch L_spin9_l
L_other:
    s_lshr_b32 s48, s2, 3
    s_bitcmp1_b32 s2, 0
    s_cbranch_scc1 L_odd
    v_lshrrev_b32 v6, 2, v0
    v_and_b32 v7, 3, v0
    v_lshlrev_b32 v7, 7, v7
    v_lshl_add_u32 v6, v6, 11, v7
    s_and_b32 s48, s48, 15
    s_lshl2_add_u32 s39, s48, s32
    s_lshl_b32 s39, s39, 15
    s_lshl_b32 s37, s47, 9
    s_add_u32 s39, s39, s37
    s_lshr_b32 s37, s48, 2
    s_lshl_b32 s37, s37, 20
    s_and_b32 s38, s48, 3
    s_lshl2_add_u32 s38, s38, s32
    s_lshl_b32 s38, s38, 13
    s_add_u32 s37, s37, s38
    v_lshlrev_b32 v5, 7, v0
    s_waitcnt lgkmcnt(0)
    s_add_u32 s8, s64, 0xe0000
    s_addc_u32 s9, s65, 0
    s_mov_b32 s10, 0x320000
    s_mov_b32 s11, 0x00020000
    buffer_load_dword v251, v5, s[8:11], s37 offen
    s_mov_b32 s12, s66
    s_mov_b32 s13, s67
    s_mov_b32 s14, 0x600000
    s_mov_b32 s15, 0x00020000
    buffer_load_dword v248, v6, s[12:15], s39 offen
    s_add_u32 s39, s39, 2097152
    buffer_load_dword v249, v6, s[12:15], s39 offen
    s_add_u32 s39, s39, 2097152
    buffer_load_dword v250, v6, s[12:15], s39 offen
    s_add_u32 s39, s39, 2097152
    s_mov_b32 s16, s84
    s_mov_b32 s17, s85
    s_mov_b32 s18, 0x5e00000
    s_mov_b32 s19, 0x00020000
    v_min_u32 v124, 1, v0
    v_lshlrev_b32 v124, 30, v124
    s_lshr_b32 s33, s47, 1
    s_lshl_b32 s33, s33, 1
    s_and_b32 s37, s48, 1
    s_add_u32 s33, s33, s37
    s_and_b32 s35, s47, 1
    s_lshl_b32 s35, s35, 3
    s_lshr_b32 s37, s48, 1
    s_add_u32 s35, s35, s37
    s_add_u32 s34, s35, 24
    s_lshl_b32 s91, s33, 6
    s_add_u32 s91, s91, s34
    s_lshl_b32 s91, s91, 7
    s_add_u32 s91, s91, 0x5520000
    s_cmp_eq_u32 s32, 1
    s_cselect_b32 s91, s91, 0x5f00000
    s_mul_i32 s51, s35, 6
    s_min_u32 s51, s51, 106
    s_lshl_b32 s54, s51, 6
    s_mov_b32 s12, s72
    s_mov_b32 s13, s73
    s_mov_b32 s14, 0x700000
    s_mov_b32 s15, 0x00020000
    s_mov_b32 s39, 7168
    v_lshrrev_b32 v68, 3, v0
    v_lshlrev_b32 v69, 2, v0
    v_and_b32 v69, 64, v69
    v_and_b32 v70, 0x70, v1
    v_xor_b32 v69, v69, v70
    v_mad_u32_u24 v56, v68, s39, v69
    v_add_u32 v57, 57344, v56
    v_add_u32 v58, 128, v56
    v_add_u32 v59, 57472, v56
    v_add_u32 v60, 256, v56
    v_add_u32 v61, 57600, v56
    s_mul_i32 s38, s32, 114688
    s_add_u32 s54, s54, s38
    s_lshl_b32 s42, s32, 11
    s_add_u32 m0, s42, 0
    s_nop 0
    buffer_load_dwordx4 v56, s[12:15], s54 offen lds
    s_add_u32 m0, s42, 1024
    s_nop 0
    buffer_load_dwordx4 v57, s[12:15], s54 offen lds
    s_add_u32 m0, s42, 8192
    s_nop 0
    buffer_load_dwordx4 v58, s[12:15], s54 offen lds
    s_add_u32 m0, s42, 9216
    s_nop 0
    buffer_load_dwordx4 v59, s[12:15], s54 offen lds
    s_add_u32 m0, s42, 16384
    s_nop 0
    buffer_load_dwordx4 v60, s[12:15], s54 offen lds
    s_add_u32 m0, s42, 17408
    s_nop 0
    buffer_load_dwordx4 v61, s[12:15], s54 offen lds
    s_add_u32 s54, s54, 458752
    s_add_u32 m0, s42, 24576
    s_nop 0
    buffer_load_dwordx4 v56, s[12:15], s54 offen lds
    s_add_u32 m0, s42, 25600
    s_nop 0
    buffer_load_dwordx4 v57, s[12:15], s54 offen lds
    s_add_u32 m0, s42, 32768
    s_nop 0
    buffer_load_dwordx4 v58, s[12:15], s54 offen lds
    s_add_u32 m0, s42, 33792
    s_nop 0
    buffer_load_dwordx4 v59, s[12:15], s54 offen lds
    s_add_u32 m0, s42, 40960
    s_nop 0
    buffer_load_dwordx4 v60, s[12:15], s54 offen lds
    s_add_u32 m0, s42, 41984
    s_nop 0
    buffer_load_dwordx4 v61, s[12:15], s54 offen lds
    s_add_u32 s54, s54, 458752
    s_add_u32 m0, s42, 49152
    s_nop 0
    buffer_load_dwordx4 v56, s[12:15], s54 offen lds
    s_add_u32 m0, s42, 50176
    s_nop 0
    buffer_load_dwordx4 v57, s[12:15], s54 offen lds
    s_add_u32 m0, s42, 57344
    s_nop 0
    buffer_load_dwordx4 v58, s[12:15], s54 offen lds
    s_add_u32 m0, s42, 58368
    s_nop 0
    buffer_load_dwordx4 v59, s[12:15], s54 offen lds
    s_add_u32 m0, s42, 65536
    s_nop 0
    buffer_load_dwordx4 v60, s[12:15], s54 offen lds
    s_add_u32 m0, s42, 66560
    s_nop 0
    buffer_load_dwordx4 v61, s[12:15], s54 offen lds
    s_add_u32 s54, s54, 458752
    s_add_u32 m0, s42, 73728
    s_nop 0
    buffer_load_dwordx4 v56, s[12:15], s54 offen lds
    s_add_u32 m0, s42, 74752
    s_nop 0
    buffer_load_dwordx4 v57, s[12:15], s54 offen lds
    s_add_u32 m0, s42, 81920
    s_nop 0
    buffer_load_dwordx4 v58, s[12:15], s54 offen lds
    s_add_u32 m0, s42, 82944
    s_nop 0
    buffer_load_dwordx4 v59, s[12:15], s54 offen lds
    s_add_u32 m0, s42, 90112
    s_nop 0
    buffer_load_dwordx4 v60, s[12:15], s54 offen lds
    s_add_u32 m0, s42, 91136
    s_nop 0
    buffer_load_dwordx4 v61, s[12:15], s54 offen lds
    s_add_u32 s54, s54, 458752
    s_add_u32 m0, s42, 98304
    s_nop 0
    buffer_load_dwordx4 v56, s[12:15], s54 offen lds
    s_add_u32 m0, s42, 99328
    s_nop 0
    buffer_load_dwordx4 v57, s[12:15], s54 offen lds
    s_add_u32 m0, s42, 106496
    s_nop 0
    buffer_load_dwordx4 v58, s[12:15], s54 offen lds
    s_add_u32 m0, s42, 107520
    s_nop 0
    buffer_load_dwordx4 v59, s[12:15], s54 offen lds
    s_add_u32 m0, s42, 114688
    s_nop 0
    buffer_load_dwordx4 v60, s[12:15], s54 offen lds
    s_add_u32 m0, s42, 115712
    s_nop 0
    buffer_load_dwordx4 v61, s[12:15], s54 offen lds
    s_add_u32 s54, s54, 458752
    v_lshrrev_b32 v68, 4, v0
    v_bfe_u32 v69, v0, 2, 2
    v_lshl_add_u32 v68, v68, 3, v69
    v_lshlrev_b32 v68, 7, v68
    v_lshrrev_b32 v69, 1, v69
    v_lshl_add_u32 v68, v69, 6, v68
    v_and_b32 v69, 3, v0
    v_lshl_add_u32 v68, v69, 4, v68
    s_lshr_b32 s37, s32, 1
    s_lshl_b32 s37, s37, 13
    s_and_b32 s38, s32, 1
    s_lshl_b32 s38, s38, 6
    s_add_u32 s37, s37, s38
    s_add_u32 s37, s37, 0
    v_xor_b32 v62, s37, v68
    s_lshr_b32 s37, s32, 1
    s_lshl_b32 s37, s37, 13
    s_and_b32 s38, s32, 1
    s_lshl_b32 s38, s38, 6
    s_add_u32 s37, s37, s38
    s_add_u32 s37, s37, 8
    v_xor_b32 v63, s37, v68
    s_lshr_b32 s37, s32, 1
    s_lshl_b32 s37, s37, 6
    s_and_b32 s38, s32, 1
    s_lshl_b32 s38, s38, 3
    s_add_u32 s37, s37, s38
    s_add_u32 s37, s37, 16384
    v_xor_b32 v64, s37, v68
    v_mov_b32 v68, 0x3f803f80
    v_mov_b32 v69, 0x3f803f80
    v_mov_b32 v70, 0x3f803f80
    v_mov_b32 v71, 0x3f803f80
    v_add_u32 v2, 98304, v1
    s_lshl_b32 s37, s33, 6
    s_add_u32 s37, s37, 16
    s_lshl_b32 s37, s37, 7
    v_lshl_add_u32 v5, v0, 7, s37
    s_cmp_eq_u32 s32, 0
    s_cselect_b32 s37, 8, 0
    v_cmp_le_u32 vcc, s37, v0
    s_nop 1
    v_cndmask_b32 v5, v5, 2.0, vcc
    s_lshl_b32 s43, s32, 12
    s_mul_i32 s41, s33, 2097152
    s_add_u32 s41, s41, 0x800000
    s_add_u32 s41, s41, s43
    s_mul_i32 s90, s33, 8388608
    s_add_u32 s90, s90, 0xfc0000
    s_add_u32 s37, s51, s32
    s_lshl_b32 s37, s37, 11
    s_add_u32 s90, s90, s37
    s_lshl_b32 s37, s32, 10
    s_sub_u32 s87, 8192, s37
    s_lshl_b32 s38, s35, 1
    s_lshr_b32 s39, s32, 1
    s_add_u32 s38, s38, s39
    s_cmp_eq_u32 s38, 36
    s_cselect_b32 s88, 0x5e00000, 0
    s_and_b32 s38, s32, 1
    s_lshl_b32 s38, s38, 3
    s_and_b32 s39, s32, 2
    s_lshl_b32 s39, s39, 10
    s_add_u32 s38, s38, s39
    s_add_u32 s38, s38, 65536
    v_add_u32 v3, s38, v1
    s_add_u32 s37, s37, 65536
    v_add_u32 v4, s37, v1
    v_and_b32 v6, 15, v0
    v_lshlrev_b32 v6, 3, v6
    v_lshrrev_b32 v8, 5, v0
    v_lshl_add_u32 v6, v8, 9, v6
    v_and_b32 v8, 16, v0
    v_lshl_add_u32 v6, v8, 6, v6
    v_add_u32 v118, 73728, v6
    s_mul_i32 s46, s33, 65536
    s_add_u32 s46, s46, 0x5440000
    s_add_u32 s55, s46, 63488
    s_and_b32 s52, s32, 1
    s_lshl_b32 s52, s52, 10
    s_mov_b32 s8, s74
    s_mov_b32 s9, s75
    s_mov_b32 s10, 0x1c00
    s_mov_b32 s11, 0x00020000
    v_and_b32 v8, 0x30, v0
    s_add_u32 s37, s51, s32
    s_lshl_b32 s37, s37, 6
    buffer_load_dwordx4 v[16:19], v8, s[8:11], s37 offen
    s_lshr_b32 s37, s32, 1
    s_add_u32 s37, s37, s51
    s_lshl_b32 s37, s37, 6
    s_and_b32 s38, s32, 1
    s_lshl_b32 s38, s38, 3
    s_add_u32 s37, s37, s38
    buffer_load_dwordx2 v[20:21], v8, s[8:11], s37 offen offset:256
    v_add_u32 v65, 0, v62
    v_add_u32 v66, 0, v63
    v_add_u32 v67, 0, v64
    s_waitcnt vmcnt(26)
    s_barrier
    ds_read_b64_tr_b16 a[0:1], v65 offset:0
    ds_read_b64_tr_b16 a[2:3], v65 offset:512
    ds_read_b64_tr_b16 a[4:5], v66 offset:0
    ds_read_b64_tr_b16 a[6:7], v66 offset:512
    ds_read_b64_tr_b16 a[8:9], v67 offset:0
    ds_read_b64_tr_b16 a[10:11], v67 offset:512
    ds_read_b64_tr_b16 a[12:13], v65 offset:4096
    ds_read_b64_tr_b16 a[14:15], v65 offset:4608
    ds_read_b64_tr_b16 a[16:17], v66 offset:4096
    ds_read_b64_tr_b16 a[18:19], v66 offset:4608
    ds_read_b64_tr_b16 a[20:21], v67 offset:4096
    ds_read_b64_tr_b16 a[22:23], v67 offset:4608
    s_add_u32 m0, s42, 122880
    s_nop 0
    buffer_load_dwordx4 v56, s[12:15], s54 offen lds
    s_add_u32 m0, s42, 123904
    s_nop 0
    buffer_load_dwordx4 v57, s[12:15], s54 offen lds
    s_add_u32 m0, s42, 131072
    s_nop 0
    buffer_load_dwordx4 v58, s[12:15], s54 offen lds
    s_add_u32 m0, s42, 132096
    s_nop 0
    buffer_load_dwordx4 v59, s[12:15], s54 offen lds
    s_add_u32 m0, s42, 139264
    s_nop 0
    buffer_load_dwordx4 v60, s[12:15], s54 offen lds
    s_add_u32 m0, s42, 140288
    s_nop 0
    buffer_load_dwordx4 v61, s[12:15], s54 offen lds
    s_add_u32 s54, s54, 458752
    s_waitcnt lgkmcnt(0)
    v_mfma_f32_16x16x32_bf16 v[88:91], a[0:3], v[68:71], 0
    v_mfma_f32_16x16x32_bf16 v[92:95], a[4:7], v[68:71], 0
    v_mfma_f32_16x16x32_bf16 v[96:99], a[8:11], v[68:71], 0
    v_mfma_f32_16x16x32_bf16 v[88:91], a[12:15], v[68:71], v[88:91]
    v_mfma_f32_16x16x32_bf16 v[92:95], a[16:19], v[68:71], v[92:95]
    v_mfma_f32_16x16x32_bf16 v[96:99], a[20:23], v[68:71], v[96:99]
    v_add_u32 v65, 24576, v62
    v_add_u32 v66, 24576, v63
    v_add_u32 v67, 24576, v64
    s_waitcnt vmcnt(26)
    s_barrier
    ds_read_b64_tr_b16 a[24:25], v65 offset:0
    ds_read_b64_tr_b16 a[26:27], v65 offset:512
    ds_read_b64_tr_b16 a[28:29], v66 offset:0
    ds_read_b64_tr_b16 a[30:31], v66 offset:512
    ds_read_b64_tr_b16 a[32:33], v67 offset:0
    ds_read_b64_tr_b16 a[34:35], v67 offset:512
    ds_read_b64_tr_b16 a[36:37], v65 offset:4096
    ds_read_b64_tr_b16 a[38:39], v65 offset:4608
    ds_read_b64_tr_b16 a[40:41], v66 offset:4096
    ds_read_b64_tr_b16 a[42:43], v66 offset:4608
    ds_read_b64_tr_b16 a[44:45], v67 offset:4096
    ds_read_b64_tr_b16 a[46:47], v67 offset:4608
    s_add_u32 m0, s42, 0
    s_nop 0
    buffer_load_dwordx4 v56, s[12:15], s54 offen lds
    s_add_u32 m0, s42, 1024
    s_nop 0
    buffer_load_dwordx4 v57, s[12:15], s54 offen lds
    s_add_u32 m0, s42, 8192
    s_nop 0
    buffer_load_dwordx4 v58, s[12:15], s54 offen lds
    s_add_u32 m0, s42, 9216
    s_nop 0
    buffer_load_dwordx4 v59, s[12:15], s54 offen lds
    s_add_u32 m0, s42, 16384
    s_nop 0
    buffer_load_dwordx4 v60, s[12:15], s54 offen lds
    s_add_u32 m0, s42, 17408
    s_nop 0
    buffer_load_dwordx4 v61, s[12:15], s54 offen lds
    s_add_u32 s54, s54, 458752
    s_waitcnt lgkmcnt(0)
    v_mfma_f32_16x16x32_bf16 v[88:91], a[24:27], v[68:71], v[88:91]
    v_mfma_f32_16x16x32_bf16 v[92:95], a[28:31], v[68:71], v[92:95]
    v_mfma_f32_16x16x32_bf16 v[96:99], a[32:35], v[68:71], v[96:99]
    v_mfma_f32_16x16x32_bf16 v[88:91], a[36:39], v[68:71], v[88:91]
    v_mfma_f32_16x16x32_bf16 v[92:95], a[40:43], v[68:71], v[92:95]
    v_mfma_f32_16x16x32_bf16 v[96:99], a[44:47], v[68:71], v[96:99]
    v_add_u32 v65, 49152, v62
    v_add_u32 v66, 49152, v63
    v_add_u32 v67, 49152, v64
    s_waitcnt vmcnt(26)
    s_barrier
    ds_read_b64_tr_b16 a[48:49], v65 offset:0
    ds_read_b64_tr_b16 a[50:51], v65 offset:512
    ds_read_b64_tr_b16 a[52:53], v66 offset:0
    ds_read_b64_tr_b16 a[54:55], v66 offset:512
    ds_read_b64_tr_b16 a[56:57], v67 offset:0
    ds_read_b64_tr_b16 a[58:59], v67 offset:512
    ds_read_b64_tr_b16 a[60:61], v65 offset:4096
    ds_read_b64_tr_b16 a[62:63], v65 offset:4608
    ds_read_b64_tr_b16 a[64:65], v66 offset:4096
    ds_read_b64_tr_b16 a[66:67], v66 offset:4608
    ds_read_b64_tr_b16 a[68:69], v67 offset:4096
    ds_read_b64_tr_b16 a[70:71], v67 offset:4608
    s_add_u32 m0, s42, 24576
    s_nop 0
    buffer_load_dwordx4 v56, s[12:15], s54 offen lds
    s_add_u32 m0, s42, 25600
    s_nop 0
    buffer_load_dwordx4 v57, s[12:15], s54 offen lds
    s_add_u32 m0, s42, 32768
    s_nop 0
    buffer_load_dwordx4 v58, s[12:15], s54 offen lds
    s_add_u32 m0, s42, 33792
    s_nop 0
    buffer_load_dwordx4 v59, s[12:15], s54 offen lds
    s_add_u32 m0, s42, 40960
    s_nop 0
    buffer_load_dwordx4 v60, s[12:15], s54 offen lds
    s_add_u32 m0, s42, 41984
    s_nop 0
    buffer_load_dwordx4 v61, s[12:15], s54 offen lds
    s_add_u32 s54, s54, 458752
    s_waitcnt lgkmcnt(0)
    v_mfma_f32_16x16x32_bf16 v[88:91], a[48:51], v[68:71], v[88:91]
    v_mfma_f32_16x16x32_bf16 v[92:95], a[52:55], v[68:71], v[92:95]
    v_mfma_f32_16x16x32_bf16 v[96:99], a[56:59], v[68:71], v[96:99]
    v_mfma_f32_16x16x32_bf16 v[88:91], a[60:63], v[68:71], v[88:91]
    v_mfma_f32_16x16x32_bf16 v[92:95], a[64:67], v[68:71], v[92:95]
    v_mfma_f32_16x16x32_bf16 v[96:99], a[68:71], v[68:71], v[96:99]
    v_add_u32 v65, 73728, v62
    v_add_u32 v66, 73728, v63
    v_add_u32 v67, 73728, v64
    s_waitcnt vmcnt(26)
    s_barrier
    ds_read_b64_tr_b16 a[72:73], v65 offset:0
    ds_read_b64_tr_b16 a[74:75], v65 offset:512
    ds_read_b64_tr_b16 a[76:77], v66 offset:0
    ds_read_b64_tr_b16 a[78:79], v66 offset:512
    ds_read_b64_tr_b16 a[80:81], v67 offset:0
    ds_read_b64_tr_b16 a[82:83], v67 offset:512
    ds_read_b64_tr_b16 a[84:85], v65 offset:4096
    ds_read_b64_tr_b16 a[86:87], v65 offset:4608
    ds_read_b64_tr_b16 a[88:89], v66 offset:4096
    ds_read_b64_tr_b16 a[90:91], v66 offset:4608
    ds_read_b64_tr_b16 a[92:93], v67 offset:4096
    ds_read_b64_tr_b16 a[94:95], v67 offset:4608
    s_add_u32 m0, s42, 49152
    s_nop 0
    buffer_load_dwordx4 v56, s[12:15], s54 offen lds
    s_add_u32 m0, s42, 50176
    s_nop 0
    buffer_load_dwordx4 v57, s[12:15], s54 offen lds
    s_add_u32 m0, s42, 57344
    s_nop 0
    buffer_load_dwordx4 v58, s[12:15], s54 offen lds
    s_add_u32 m0, s42, 58368
    s_nop 0
    buffer_load_dwordx4 v59, s[12:15], s54 offen lds
    s_add_u32 m0, s42, 65536
    s_nop 0
    buffer_load_dwordx4 v60, s[12:15], s54 offen lds
    s_add_u32 m0, s42, 66560
    s_nop 0
    buffer_load_dwordx4 v61, s[12:15], s54 offen lds
    s_add_u32 s54, s54, 458752
    s_waitcnt lgkmcnt(0)
    v_mfma_f32_16x16x32_bf16 v[88:91], a[72:75], v[68:71], v[88:91]
    v_mfma_f32_16x16x32_bf16 v[92:95], a[76:79], v[68:71], v[92:95]
    v_mfma_f32_16x16x32_bf16 v[96:99], a[80:83], v[68:71], v[96:99]
    v_mfma_f32_16x16x32_bf16 v[88:91], a[84:87], v[68:71], v[88:91]
    v_mfma_f32_16x16x32_bf16 v[92:95], a[88:91], v[68:71], v[92:95]
    v_mfma_f32_16x16x32_bf16 v[96:99], a[92:95], v[68:71], v[96:99]
    v_add_u32 v65, 98304, v62
    v_add_u32 v66, 98304, v63
    v_add_u32 v67, 98304, v64
    s_waitcnt vmcnt(26)
    s_barrier
    ds_read_b64_tr_b16 a[96:97], v65 offset:0
    ds_read_b64_tr_b16 a[98:99], v65 offset:512
    ds_read_b64_tr_b16 a[100:101], v66 offset:0
    ds_read_b64_tr_b16 a[102:103], v66 offset:512
    ds_read_b64_tr_b16 a[104:105], v67 offset:0
    ds_read_b64_tr_b16 a[106:107], v67 offset:512
    ds_read_b64_tr_b16 a[108:109], v65 offset:4096
    ds_read_b64_tr_b16 a[110:111], v65 offset:4608
    ds_read_b64_tr_b16 a[112:113], v66 offset:4096
    ds_read_b64_tr_b16 a[114:115], v66 offset:4608
    ds_read_b64_tr_b16 a[116:117], v67 offset:4096
    ds_read_b64_tr_b16 a[118:119], v67 offset:4608
    s_add_u32 m0, s42, 73728
    s_nop 0
    buffer_load_dwordx4 v56, s[12:15], s54 offen lds
    s_add_u32 m0, s42, 74752
    s_nop 0
    buffer_load_dwordx4 v57, s[12:15], s54 offen lds
    s_add_u32 m0, s42, 81920
    s_nop 0
    buffer_load_dwordx4 v58, s[12:15], s54 offen lds
    s_add_u32 m0, s42, 82944
    s_nop 0
    buffer_load_dwordx4 v59, s[12:15], s54 offen lds
    s_add_u32 m0, s42, 90112
    s_nop 0
    buffer_load_dwordx4 v60, s[12:15], s54 offen lds
    s_add_u32 m0, s42, 91136
    s_nop 0
    buffer_load_dwordx4 v61, s[12:15], s54 offen lds
    s_add_u32 s54, s54, 458752
    s_waitcnt lgkmcnt(0)
    v_mfma_f32_16x16x32_bf16 v[88:91], a[96:99], v[68:71], v[88:91]
    v_mfma_f32_16x16x32_bf16 v[92:95], a[100:103], v[68:71], v[92:95]
    v_mfma_f32_16x16x32_bf16 v[96:99], a[104:107], v[68:71], v[96:99]
    v_mfma_f32_16x16x32_bf16 v[88:91], a[108:111], v[68:71], v[88:91]
    v_mfma_f32_16x16x32_bf16 v[92:95], a[112:115], v[68:71], v[92:95]
    v_mfma_f32_16x16x32_bf16 v[96:99], a[116:119], v[68:71], v[96:99]
    v_add_u32 v65, 122880, v62
    v_add_u32 v66, 122880, v63
    v_add_u32 v67, 122880, v64
    s_waitcnt vmcnt(24)
    s_barrier
    ds_read_b64_tr_b16 a[120:121], v65 offset:0
    ds_read_b64_tr_b16 a[122:123], v65 offset:512
    ds_read_b64_tr_b16 a[124:125], v66 offset:0
    ds_read_b64_tr_b16 a[126:127], v66 offset:512
    ds_read_b64_tr_b16 a[128:129], v67 offset:0
    ds_read_b64_tr_b16 a[130:131], v67 offset:512
    ds_read_b64_tr_b16 a[132:133], v65 offset:4096
    ds_read_b64_tr_b16 a[134:135], v65 offset:4608
    ds_read_b64_tr_b16 a[136:137], v66 offset:4096
    ds_read_b64_tr_b16 a[138:139], v66 offset:4608
    ds_read_b64_tr_b16 a[140:141], v67 offset:4096
    ds_read_b64_tr_b16 a[142:143], v67 offset:4608
    s_add_u32 m0, s42, 98304
    s_nop 0
    buffer_load_dwordx4 v56, s[12:15], s54 offen lds
    s_add_u32 m0, s42, 99328
    s_nop 0
    buffer_load_dwordx4 v57, s[12:15], s54 offen lds
    s_add_u32 m0, s42, 106496
    s_nop 0
    buffer_load_dwordx4 v58, s[12:15], s54 offen lds
    s_add_u32 m0, s42, 107520
    s_nop 0
    buffer_load_dwordx4 v59, s[12:15], s54 offen lds
    s_add_u32 m0, s42, 114688
    s_nop 0
    buffer_load_dwordx4 v60, s[12:15], s54 offen lds
    s_add_u32 m0, s42, 115712
    s_nop 0
    buffer_load_dwordx4 v61, s[12:15], s54 offen lds
    s_add_u32 s54, s54, 458752
    s_waitcnt lgkmcnt(0)
    v_mfma_f32_16x16x32_bf16 v[88:91], a[120:123], v[68:71], v[88:91]
    v_mfma_f32_16x16x32_bf16 v[92:95], a[124:127], v[68:71], v[92:95]
    v_mfma_f32_16x16x32_bf16 v[96:99], a[128:131], v[68:71], v[96:99]
    v_mfma_f32_16x16x32_bf16 v[88:91], a[132:135], v[68:71], v[88:91]
    v_mfma_f32_16x16x32_bf16 v[92:95], a[136:139], v[68:71], v[92:95]
    v_mfma_f32_16x16x32_bf16 v[96:99], a[140:143], v[68:71], v[96:99]
    v_add_u32 v65, 0, v62
    v_add_u32 v66, 0, v63
    v_add_u32 v67, 0, v64
    s_waitcnt vmcnt(24)
    s_barrier
    ds_read_b64_tr_b16 a[144:145], v65 offset:0
    ds_read_b64_tr_b16 a[146:147], v65 offset:512
    ds_read_b64_tr_b16 a[148:149], v66 offset:0
    ds_read_b64_tr_b16 a[150:151], v66 offset:512
    ds_read_b64_tr_b16 a[152:153], v67 offset:0
    ds_read_b64_tr_b16 a[154:155], v67 offset:512
    ds_read_b64_tr_b16 a[156:157], v65 offset:4096
    ds_read_b64_tr_b16 a[158:159], v65 offset:4608
    ds_read_b64_tr_b16 a[160:161], v66 offset:4096
    ds_read_b64_tr_b16 a[162:163], v66 offset:4608
    ds_read_b64_tr_b16 a[164:165], v67 offset:4096
    ds_read_b64_tr_b16 a[166:167], v67 offset:4608
    s_add_u32 m0, s42, 122880
    s_nop 0
    buffer_load_dwordx4 v56, s[12:15], s54 offen lds
    s_add_u32 m0, s42, 123904
    s_nop 0
    buffer_load_dwordx4 v57, s[12:15], s54 offen lds
    s_add_u32 m0, s42, 131072
    s_nop 0
    buffer_load_dwordx4 v58, s[12:15], s54 offen lds
    s_add_u32 m0, s42, 132096
    s_nop 0
    buffer_load_dwordx4 v59, s[12:15], s54 offen lds
    s_add_u32 m0, s42, 139264
    s_nop 0
    buffer_load_dwordx4 v60, s[12:15], s54 offen lds
    s_add_u32 m0, s42, 140288
    s_nop 0
    buffer_load_dwordx4 v61, s[12:15], s54 offen lds
    s_add_u32 s54, s54, 458752
    s_waitcnt lgkmcnt(0)
    v_mfma_f32_16x16x32_bf16 v[88:91], a[144:147], v[68:71], v[88:91]
    v_mfma_f32_16x16x32_bf16 v[92:95], a[148:151], v[68:71], v[92:95]
    v_mfma_f32_16x16x32_bf16 v[96:99], a[152:155], v[68:71], v[96:99]
    v_mfma_f32_16x16x32_bf16 v[88:91], a[156:159], v[68:71], v[88:91]
    v_mfma_f32_16x16x32_bf16 v[92:95], a[160:163], v[68:71], v[92:95]
    v_mfma_f32_16x16x32_bf16 v[96:99], a[164:167], v[68:71], v[96:99]
    v_add_u32 v65, 24576, v62
    v_add_u32 v66, 24576, v63
    v_add_u32 v67, 24576, v64
    s_waitcnt vmcnt(24)
    s_barrier
    ds_read_b64_tr_b16 a[168:169], v65 offset:0
    ds_read_b64_tr_b16 a[170:171], v65 offset:512
    ds_read_b64_tr_b16 a[172:173], v66 offset:0
    ds_read_b64_tr_b16 a[174:175], v66 offset:512
    ds_read_b64_tr_b16 a[176:177], v67 offset:0
    ds_read_b64_tr_b16 a[178:179], v67 offset:512
    ds_read_b64_tr_b16 a[180:181], v65 offset:4096
    ds_read_b64_tr_b16 a[182:183], v65 offset:4608
    ds_read_b64_tr_b16 a[184:185], v66 offset:4096
    ds_read_b64_tr_b16 a[186:187], v66 offset:4608
    ds_read_b64_tr_b16 a[188:189], v67 offset:4096
    ds_read_b64_tr_b16 a[190:191], v67 offset:4608
    s_add_u32 m0, s42, 0
    s_nop 0
    buffer_load_dwordx4 v56, s[12:15], s54 offen lds
    s_add_u32 m0, s42, 1024
    s_nop 0
    buffer_load_dwordx4 v57, s[12:15], s54 offen lds
    s_add_u32 m0, s42, 8192
    s_nop 0
    buffer_load_dwordx4 v58, s[12:15], s54 offen lds
    s_add_u32 m0, s42, 9216
    s_nop 0
    buffer_load_dwordx4 v59, s[12:15], s54 offen lds
    s_add_u32 m0, s42, 16384
    s_nop 0
    buffer_load_dwordx4 v60, s[12:15], s54 offen lds
    s_add_u32 m0, s42, 17408
    s_nop 0
    buffer_load_dwordx4 v61, s[12:15], s54 offen lds
    s_add_u32 s54, s54, 458752
    s_waitcnt lgkmcnt(0)
    v_mfma_f32_16x16x32_bf16 v[88:91], a[168:171], v[68:71], v[88:91]
    v_mfma_f32_16x16x32_bf16 v[92:95], a[172:175], v[68:71], v[92:95]
    v_mfma_f32_16x16x32_bf16 v[96:99], a[176:179], v[68:71], v[96:99]
    v_mfma_f32_16x16x32_bf16 v[88:91], a[180:183], v[68:71], v[88:91]
    v_mfma_f32_16x16x32_bf16 v[92:95], a[184:187], v[68:71], v[92:95]
    v_mfma_f32_16x16x32_bf16 v[96:99], a[188:191], v[68:71], v[96:99]
    v_add_u32 v65, 49152, v62
    v_add_u32 v66, 49152, v63
    v_add_u32 v67, 49152, v64
    s_waitcnt vmcnt(24)
    s_barrier
    ds_read_b64_tr_b16 a[192:193], v65 offset:0
    ds_read_b64_tr_b16 a[194:195], v65 offset:512
    ds_read_b64_tr_b16 a[196:197], v66 offset:0
    ds_read_b64_tr_b16 a[198:199], v66 offset:512
    ds_read_b64_tr_b16 a[200:201], v67 offset:0
    ds_read_b64_tr_b16 a[202:203], v67 offset:512
    ds_read_b64_tr_b16 a[204:205], v65 offset:4096
    ds_read_b64_tr_b16 a[206:207], v65 offset:4608
    ds_read_b64_tr_b16 a[208:209], v66 offset:4096
    ds_read_b64_tr_b16 a[210:211], v66 offset:4608
    ds_read_b64_tr_b16 a[212:213], v67 offset:4096
    ds_read_b64_tr_b16 a[214:215], v67 offset:4608
    s_add_u32 m0, s42, 24576
    s_nop 0
    buffer_load_dwordx4 v56, s[12:15], s54 offen lds
    s_add_u32 m0, s42, 25600
    s_nop 0
    buffer_load_dwordx4 v57, s[12:15], s54 offen lds
    s_add_u32 m0, s42, 32768
    s_nop 0
    buffer_load_dwordx4 v58, s[12:15], s54 offen lds
    s_add_u32 m0, s42, 33792
    s_nop 0
    buffer_load_dwordx4 v59, s[12:15], s54 offen lds
    s_add_u32 m0, s42, 40960
    s_nop 0
    buffer_load_dwordx4 v60, s[12:15], s54 offen lds
    s_add_u32 m0, s42, 41984
    s_nop 0
    buffer_load_dwordx4 v61, s[12:15], s54 offen lds
    s_add_u32 s54, s54, 458752
    s_waitcnt lgkmcnt(0)
    v_mfma_f32_16x16x32_bf16 v[88:91], a[192:195], v[68:71], v[88:91]
    v_mfma_f32_16x16x32_bf16 v[92:95], a[196:199], v[68:71], v[92:95]
    v_mfma_f32_16x16x32_bf16 v[96:99], a[200:203], v[68:71], v[96:99]
    v_mfma_f32_16x16x32_bf16 v[88:91], a[204:207], v[68:71], v[88:91]
    v_mfma_f32_16x16x32_bf16 v[92:95], a[208:211], v[68:71], v[92:95]
    v_mfma_f32_16x16x32_bf16 v[96:99], a[212:215], v[68:71], v[96:99]
    v_add_u32 v65, 73728, v62
    v_add_u32 v66, 73728, v63
    v_add_u32 v67, 73728, v64
    s_waitcnt vmcnt(24)
    s_barrier
    ds_read_b64_tr_b16 a[216:217], v65 offset:0
    ds_read_b64_tr_b16 a[218:219], v65 offset:512
    ds_read_b64_tr_b16 a[220:221], v66 offset:0
    ds_read_b64_tr_b16 a[222:223], v66 offset:512
    ds_read_b64_tr_b16 a[224:225], v67 offset:0
    ds_read_b64_tr_b16 a[226:227], v67 offset:512
    ds_read_b64_tr_b16 a[228:229], v65 offset:4096
    ds_read_b64_tr_b16 a[230:231], v65 offset:4608
    ds_read_b64_tr_b16 a[232:233], v66 offset:4096
    ds_read_b64_tr_b16 a[234:235], v66 offset:4608
    ds_read_b64_tr_b16 a[236:237], v67 offset:4096
    ds_read_b64_tr_b16 a[238:239], v67 offset:4608
    s_add_u32 m0, s42, 49152
    s_nop 0
    buffer_load_dwordx4 v56, s[12:15], s54 offen lds
    s_add_u32 m0, s42, 50176
    s_nop 0
    buffer_load_dwordx4 v57, s[12:15], s54 offen lds
    s_add_u32 m0, s42, 57344
    s_nop 0
    buffer_load_dwordx4 v58, s[12:15], s54 offen lds
    s_add_u32 m0, s42, 58368
    s_nop 0
    buffer_load_dwordx4 v59, s[12:15], s54 offen lds
    s_add_u32 m0, s42, 65536
    s_nop 0
    buffer_load_dwordx4 v60, s[12:15], s54 offen lds
    s_add_u32 m0, s42, 66560
    s_nop 0
    buffer_load_dwordx4 v61, s[12:15], s54 offen lds
    s_add_u32 s54, s54, 458752
    s_waitcnt lgkmcnt(0)
    v_mfma_f32_16x16x32_bf16 v[88:91], a[216:219], v[68:71], v[88:91]
    v_mfma_f32_16x16x32_bf16 v[92:95], a[220:223], v[68:71], v[92:95]
    v_mfma_f32_16x16x32_bf16 v[96:99], a[224:227], v[68:71], v[96:99]
    v_mfma_f32_16x16x32_bf16 v[88:91], a[228:231], v[68:71], v[88:91]
    v_mfma_f32_16x16x32_bf16 v[92:95], a[232:235], v[68:71], v[92:95]
    v_mfma_f32_16x16x32_bf16 v[96:99], a[236:239], v[68:71], v[96:99]
    v_add_u32 v65, 98304, v62
    v_add_u32 v66, 98304, v63
    v_add_u32 v67, 98304, v64
    s_waitcnt vmcnt(24)
    s_barrier
    ds_read_b64_tr_b16 a[240:241], v65 offset:0
    ds_read_b64_tr_b16 a[242:243], v65 offset:512
    ds_read_b64_tr_b16 a[244:245], v66 offset:0
    ds_read_b64_tr_b16 a[246:247], v66 offset:512
    ds_read_b64_tr_b16 a[248:249], v67 offset:0
    ds_read_b64_tr_b16 a[250:251], v67 offset:512
    ds_read_b64_tr_b16 a[252:253], v65 offset:4096
    ds_read_b64_tr_b16 a[254:255], v65 offset:4608
    ds_read_b64_tr_b16 v[128:129], v66 offset:4096
    ds_read_b64_tr_b16 v[130:131], v66 offset:4608
    ds_read_b64_tr_b16 v[132:133], v67 offset:4096
    ds_read_b64_tr_b16 v[134:135], v67 offset:4608
    s_add_u32 m0, s42, 73728
    s_nop 0
    buffer_load_dwordx4 v56, s[12:15], s54 offen lds
    s_add_u32 m0, s42, 74752
    s_nop 0
    buffer_load_dwordx4 v57, s[12:15], s54 offen lds
    s_add_u32 m0, s42, 81920
    s_nop 0
    buffer_load_dwordx4 v58, s[12:15], s54 offen lds
    s_add_u32 m0, s42, 82944
    s_nop 0
    buffer_load_dwordx4 v59, s[12:15], s54 offen lds
    s_add_u32 m0, s42, 90112
    s_nop 0
    buffer_load_dwordx4 v60, s[12:15], s54 offen lds
    s_add_u32 m0, s42, 91136
    s_nop 0
    buffer_load_dwordx4 v61, s[12:15], s54 offen lds
    s_add_u32 s54, s54, 458752
    s_waitcnt lgkmcnt(0)
    v_mfma_f32_16x16x32_bf16 v[88:91], a[240:243], v[68:71], v[88:91]
    v_mfma_f32_16x16x32_bf16 v[92:95], a[244:247], v[68:71], v[92:95]
    v_mfma_f32_16x16x32_bf16 v[96:99], a[248:251], v[68:71], v[96:99]
    v_mfma_f32_16x16x32_bf16 v[88:91], a[252:255], v[68:71], v[88:91]
    v_mfma_f32_16x16x32_bf16 v[92:95], v[128:131], v[68:71], v[92:95]
    v_mfma_f32_16x16x32_bf16 v[96:99], v[132:135], v[68:71], v[96:99]
    v_add_u32 v65, 122880, v62
    v_add_u32 v66, 122880, v63
    v_add_u32 v67, 122880, v64
    s_waitcnt vmcnt(24)
    s_barrier
    ds_read_b64_tr_b16 v[136:137], v65 offset:0
    ds_read_b64_tr_b16 v[138:139], v65 offset:512
    ds_read_b64_tr_b16 v[140:141], v66 offset:0
    ds_read_b64_tr_b16 v[142:143], v66 offset:512
    ds_read_b64_tr_b16 v[144:145], v67 offset:0
    ds_read_b64_tr_b16 v[146:147], v67 offset:512
    ds_read_b64_tr_b16 v[148:149], v65 offset:4096
    ds_read_b64_tr_b16 v[150:151], v65 offset:4608
    ds_read_b64_tr_b16 v[152:153], v66 offset:4096
    ds_read_b64_tr_b16 v[154:155], v66 offset:4608
    ds_read_b64_tr_b16 v[156:157], v67 offset:4096
    ds_read_b64_tr_b16 v[158:159], v67 offset:4608
    s_waitcnt lgkmcnt(0)
    v_mfma_f32_16x16x32_bf16 v[88:91], v[136:139], v[68:71], v[88:91]
    v_mfma_f32_16x16x32_bf16 v[92:95], v[140:143], v[68:71], v[92:95]
    v_mfma_f32_16x16x32_bf16 v[96:99], v[144:147], v[68:71], v[96:99]
    v_mfma_f32_16x16x32_bf16 v[88:91], v[148:151], v[68:71], v[88:91]
    v_mfma_f32_16x16x32_bf16 v[92:95], v[152:155], v[68:71], v[92:95]
    v_mfma_f32_16x16x32_bf16 v[96:99], v[156:159], v[68:71], v[96:99]
    v_add_u32 v65, 0, v62
    v_add_u32 v66, 0, v63
    v_add_u32 v67, 0, v64
    s_waitcnt vmcnt(18)
    s_barrier
    ds_read_b64_tr_b16 v[160:161], v65 offset:0
    ds_read_b64_tr_b16 v[162:163], v65 offset:512
    ds_read_b64_tr_b16 v[164:165], v66 offset:0
    ds_read_b64_tr_b16 v[166:167], v66 offset:512
    ds_read_b64_tr_b16 v[168:169], v67 offset:0
    ds_read_b64_tr_b16 v[170:171], v67 offset:512
    ds_read_b64_tr_b16 v[172:173], v65 offset:4096
    ds_read_b64_tr_b16 v[174:175], v65 offset:4608
    ds_read_b64_tr_b16 v[176:177], v66 offset:4096
    ds_read_b64_tr_b16 v[178:179], v66 offset:4608
    ds_read_b64_tr_b16 v[180:181], v67 offset:4096
    ds_read_b64_tr_b16 v[182:183], v67 offset:4608
    s_waitcnt lgkmcnt(0)
    v_mfma_f32_16x16x32_bf16 v[88:91], v[160:163], v[68:71], v[88:91]
    v_mfma_f32_16x16x32_bf16 v[92:95], v[164:167], v[68:71], v[92:95]
    v_mfma_f32_16x16x32_bf16 v[96:99], v[168:171], v[68:71], v[96:99]
    v_mfma_f32_16x16x32_bf16 v[88:91], v[172:175], v[68:71], v[88:91]
    v_mfma_f32_16x16x32_bf16 v[92:95], v[176:179], v[68:71], v[92:95]
    v_mfma_f32_16x16x32_bf16 v[96:99], v[180:183], v[68:71], v[96:99]
    v_add_u32 v65, 24576, v62
    v_add_u32 v66, 24576, v63
    v_add_u32 v67, 24576, v64
    s_waitcnt vmcnt(12)
    s_barrier
    ds_read_b64_tr_b16 v[184:185], v65 offset:0
    ds_read_b64_tr_b16 v[186:187], v65 offset:512
    ds_read_b64_tr_b16 v[188:189], v66 offset:0
    ds_read_b64_tr_b16 v[190:191], v66 offset:512
    ds_read_b64_tr_b16 v[192:193], v67 offset:0
    ds_read_b64_tr_b16 v[194:195], v67 offset:512
    ds_read_b64_tr_b16 v[196:197], v65 offset:4096
    ds_read_b64_tr_b16 v[198:199], v65 offset:4608
    ds_read_b64_tr_b16 v[200:201], v66 offset:4096
    ds_read_b64_tr_b16 v[202:203], v66 offset:4608
    ds_read_b64_tr_b16 v[204:205], v67 offset:4096
    ds_read_b64_tr_b16 v[206:207], v67 offset:4608
    s_waitcnt lgkmcnt(0)
    v_mfma_f32_16x16x32_bf16 v[88:91], v[184:187], v[68:71], v[88:91]
    v_mfma_f32_16x16x32_bf16 v[92:95], v[188:191], v[68:71], v[92:95]
    v_mfma_f32_16x16x32_bf16 v[96:99], v[192:195], v[68:71], v[96:99]
    v_mfma_f32_16x16x32_bf16 v[88:91], v[196:199], v[68:71], v[88:91]
    v_mfma_f32_16x16x32_bf16 v[92:95], v[200:203], v[68:71], v[92:95]
    v_mfma_f32_16x16x32_bf16 v[96:99], v[204:207], v[68:71], v[96:99]
    v_add_u32 v65, 49152, v62
    v_add_u32 v66, 49152, v63
    v_add_u32 v67, 49152, v64
    s_waitcnt vmcnt(6)
    s_barrier
    ds_read_b64_tr_b16 v[208:209], v65 offset:0
    ds_read_b64_tr_b16 v[210:211], v65 offset:512
    ds_read_b64_tr_b16 v[212:213], v66 offset:0
    ds_read_b64_tr_b16 v[214:215], v66 offset:512
    ds_read_b64_tr_b16 v[216:217], v67 offset:0
    ds_read_b64_tr_b16 v[218:219], v67 offset:512
    ds_read_b64_tr_b16 v[220:221], v65 offset:4096
    ds_read_b64_tr_b16 v[222:223], v65 offset:4608
    ds_read_b64_tr_b16 v[224:225], v66 offset:4096
    ds_read_b64_tr_b16 v[226:227], v66 offset:4608
    ds_read_b64_tr_b16 v[228:229], v67 offset:4096
    ds_read_b64_tr_b16 v[230:231], v67 offset:4608
    s_waitcnt lgkmcnt(0)
    v_mfma_f32_16x16x32_bf16 v[88:91], v[208:211], v[68:71], v[88:91]
    v_mfma_f32_16x16x32_bf16 v[92:95], v[212:215], v[68:71], v[92:95]
    v_mfma_f32_16x16x32_bf16 v[96:99], v[216:219], v[68:71], v[96:99]
    v_mfma_f32_16x16x32_bf16 v[88:91], v[220:223], v[68:71], v[88:91]
    v_mfma_f32_16x16x32_bf16 v[92:95], v[224:227], v[68:71], v[92:95]
    v_mfma_f32_16x16x32_bf16 v[96:99], v[228:231], v[68:71], v[96:99]
    v_add_u32 v65, 73728, v62
    v_add_u32 v66, 73728, v63
    v_add_u32 v67, 73728, v64
    s_waitcnt vmcnt(0)
    s_barrier
    ds_read_b64_tr_b16 v[232:233], v65 offset:0
    ds_read_b64_tr_b16 v[234:235], v65 offset:512
    ds_read_b64_tr_b16 v[236:237], v66 offset:0
    ds_read_b64_tr_b16 v[238:239], v66 offset:512
    ds_read_b64_tr_b16 v[240:241], v67 offset:0
    ds_read_b64_tr_b16 v[242:243], v67 offset:512
    ds_read_b64_tr_b16 v[244:245], v65 offset:4096
    ds_read_b64_tr_b16 v[246:247], v65 offset:4608
    ds_read_b64_tr_b16 v[248:249], v66 offset:4096
    ds_read_b64_tr_b16 v[250:251], v66 offset:4608
    ds_read_b64_tr_b16 v[252:253], v67 offset:4096
    ds_read_b64_tr_b16 v[254:255], v67 offset:4608
    s_waitcnt lgkmcnt(0)
    v_mfma_f32_16x16x32_bf16 v[88:91], v[232:235], v[68:71], v[88:91]
    v_mfma_f32_16x16x32_bf16 v[92:95], v[236:239], v[68:71], v[92:95]
    v_mfma_f32_16x16x32_bf16 v[96:99], v[240:243], v[68:71], v[96:99]
    v_mfma_f32_16x16x32_bf16 v[88:91], v[244:247], v[68:71], v[88:91]
    v_mfma_f32_16x16x32_bf16 v[92:95], v[248:251], v[68:71], v[92:95]
    v_mfma_f32_16x16x32_bf16 v[96:99], v[252:255], v[68:71], v[96:99]
    s_barrier
    s_mov_b32 s37, 0xffff0000
    v_lshlrev_b32 v100, 16, v16
    v_and_b32 v101, s37, v16
    v_lshlrev_b32 v102, 16, v17
    v_and_b32 v103, s37, v17
    v_lshlrev_b32 v104, 16, v18
    v_and_b32 v105, s37, v18
    v_lshlrev_b32 v106, 16, v19
    v_and_b32 v107, s37, v19
    v_lshlrev_b32 v108, 16, v20
    v_and_b32 v109, s37, v20
    v_lshlrev_b32 v110, 16, v21
    v_and_b32 v111, s37, v21
    s_cmp_lg_u32 s32, 0
    s_cbranch_scc1 L_arv11
    s_add_u32 s20, s82, 0x80
    s_addc_u32 s21, s83, 0
    s_mov_b32 s22, 0x4
    s_mov_b32 s23, 0x00020000
    buffer_load_dword v56, v124, s[20:23], 0 offen sc1
    s_waitcnt vmcnt(0)
    v_cmp_eq_u32 vcc, v124, v56
    s_cbranch_vccnz L_spin12
L_back13:
L_arv11:
    s_add_u32 s96, s41, 2031616
    s_mov_b32 s98, s41
    s_mov_b32 s45, 0x5530000
    buffer_load_dword v7, v5, s[16:19], s45 offen sc1
    s_waitcnt vmcnt(0)
    v_cmp_ne_u32 vcc, 0, v7
    s_cbranch_vccnz L_spin14
L_back15:
    s_barrier
    s_add_u32 m0, s43, 0
    s_add_u32 s42, s41, 0
    buffer_load_dwordx4 v1, s[16:19], s42 offen offset:0 sc1 lds
    buffer_load_dwordx4 v1, s[16:19], s42 offen offset:1024 sc1 lds
    buffer_load_dwordx4 v1, s[16:19], s42 offen offset:2048 sc1 lds
    buffer_load_dwordx4 v1, s[16:19], s42 offen offset:3072 sc1 lds
    s_add_u32 m0, s43, 16384
    s_add_u32 s42, s41, 16384
    buffer_load_dwordx4 v1, s[16:19], s42 offen offset:0 sc1 lds
    buffer_load_dwordx4 v1, s[16:19], s42 offen offset:1024 sc1 lds
    buffer_load_dwordx4 v1, s[16:19], s42 offen offset:2048 sc1 lds
    buffer_load_dwordx4 v1, s[16:19], s42 offen offset:3072 sc1 lds
    s_add_u32 m0, s43, 32768
    s_add_u32 s42, s41, 32768
    buffer_load_dwordx4 v1, s[16:19], s42 offen offset:0 sc1 lds
    buffer_load_dwordx4 v1, s[16:19], s42 offen offset:1024 sc1 lds
    buffer_load_dwordx4 v1, s[16:19], s42 offen offset:2048 sc1 lds
    buffer_load_dwordx4 v1, s[16:19], s42 offen offset:3072 sc1 lds
    s_add_u32 m0, s43, 49152
    s_add_u32 s42, s41, 49152
    buffer_load_dwordx4 v1, s[16:19], s42 offen offset:0 sc1 lds
    buffer_load_dwordx4 v1, s[16:19], s42 offen offset:1024 sc1 lds
    buffer_load_dwordx4 v1, s[16:19], s42 offen offset:2048 sc1 lds
    buffer_load_dwordx4 v1, s[16:19], s42 offen offset:3072 sc1 lds
    s_add_u32 s45, s45, 65536
    s_waitcnt vmcnt(0) lgkmcnt(0)
    s_barrier
    ds_read_b128 v[56:59], v1 offset:0
    ds_read_b128 v[60:63], v1 offset:1024
    ds_read_b128 v[64:67], v1 offset:2048
    ds_read_b128 v[68:71], v1 offset:3072
    s_mov_b32 s36, 0
    s_waitcnt lgkmcnt(0)
    s_nop 7
L_a_b0:
    v_mfma_f32_16x16x32_bf16 v[8:11], a[0:3], v[56:59], 0
    s_and_b32 s44, s90, 0xffffffff
    ds_read_b128 v[72:75], v1 offset:4096
    v_mul_f32 v120, v48, v116
    v_mfma_f32_16x16x32_bf16 v[16:19], a[0:3], v[60:63], 0
    s_cmp_lt_i32 s36, 1
    v_mul_f32 v121, v49, v116
    v_mul_f32 v120, v120, abs(v48)
    v_mfma_f32_16x16x32_bf16 v[20:23], a[4:7], v[60:63], 0
    s_cselect_b32 s44, 0x5e00000, s44
    v_mul_f32 v121, v121, abs(v49)
    v_cvt_pk_bf16_f32 v48, v120, v121
    v_mfma_f32_16x16x32_bf16 v[12:15], a[4:7], v[56:59], 0
    s_add_u32 s49, s44, s87
    ds_read_b128 v[76:79], v1 offset:5120
    v_pk_max_i16 v48, v48, 0
    v_mfma_f32_16x16x32_bf16 v[24:27], a[8:11], v[56:59], 0
    s_max_u32 s44, s44, s88
    v_mul_f32 v120, v50, v116
    v_mul_f32 v121, v51, v116
    v_mfma_f32_16x16x32_bf16 v[28:31], a[8:11], v[60:63], 0
    s_waitcnt lgkmcnt(2)
    v_mul_f32 v120, v120, abs(v50)
    v_mul_f32 v121, v121, abs(v51)
    v_mfma_f32_16x16x32_bf16 v[8:11], a[12:15], v[64:67], v[8:11]
    s_add_u32 s90, s90, 262144
    ds_read_b128 v[80:83], v1 offset:6144
    v_cvt_pk_bf16_f32 v49, v120, v121
    v_mfma_f32_16x16x32_bf16 v[16:19], a[12:15], v[68:71], v[16:19]
    s_add_u32 m0, s52, 73728
    v_pk_max_i16 v49, v49, 0
    s_add_u32 s42, s46, s52
    v_mfma_f32_16x16x32_bf16 v[20:23], a[16:19], v[68:71], v[20:23]
    buffer_load_dwordx4 v1, s[16:19], s42 offen sc1 lds
    v_mfma_f32_16x16x32_bf16 v[12:15], a[16:19], v[64:67], v[12:15]
    s_add_u32 s98, s98, 65536
    ds_read_b128 v[84:87], v1 offset:7168
    s_min_i32 s98, s98, s96
    v_mfma_f32_16x16x32_bf16 v[24:27], a[20:23], v[64:67], v[24:27]
    s_and_b32 s41, s98, 0xffffffff
    ds_write_b64 v3, v[48:49] offset:4096
    v_mfma_f32_16x16x32_bf16 v[28:31], a[20:23], v[68:71], v[28:31]
    s_waitcnt lgkmcnt(3)
    v_mul_f32 v120, v52, v117
    v_mul_f32 v121, v53, v117
    v_mfma_f32_16x16x32_bf16 v[8:11], a[24:27], v[72:75], v[8:11]
    ds_read_b128 v[56:59], v1 offset:8192
    v_mul_f32 v120, v120, abs(v52)
    v_mfma_f32_16x16x32_bf16 v[16:19], a[24:27], v[76:79], v[16:19]
    v_mul_f32 v121, v121, abs(v53)
    v_cvt_pk_bf16_f32 v52, v120, v121
    v_mfma_f32_16x16x32_bf16 v[20:23], a[28:31], v[76:79], v[20:23]
    v_pk_max_i16 v52, v52, 0
    v_mul_f32 v120, v54, v117
    v_mfma_f32_16x16x32_bf16 v[12:15], a[28:31], v[72:75], v[12:15]
    ds_read_b128 v[60:63], v1 offset:9216
    v_mul_f32 v121, v55, v117
    v_mfma_f32_16x16x32_bf16 v[24:27], a[32:35], v[72:75], v[24:27]
    v_mul_f32 v120, v120, abs(v54)
    v_mul_f32 v121, v121, abs(v55)
    v_mfma_f32_16x16x32_bf16 v[28:31], a[32:35], v[76:79], v[28:31]
    s_waitcnt lgkmcnt(3)
    v_cvt_pk_bf16_f32 v53, v120, v121
    v_pk_max_i16 v53, v53, 0
    v_mfma_f32_16x16x32_bf16 v[8:11], a[36:39], v[80:83], v[8:11]
    ds_read_b128 v[64:67], v1 offset:10240
    v_mfma_f32_16x16x32_bf16 v[16:19], a[36:39], v[84:87], v[16:19]
    ds_write_b64 v3, v[52:53] offset:5120
    v_mfma_f32_16x16x32_bf16 v[20:23], a[40:43], v[84:87], v[20:23]
    v_mul_f32 v120, v32, v116
    v_mul_f32 v121, v33, v116
    v_mfma_f32_16x16x32_bf16 v[12:15], a[40:43], v[80:83], v[12:15]
    ds_read_b128 v[68:71], v1 offset:11264
    v_mul_f32 v120, v120, abs(v32)
    v_mfma_f32_16x16x32_bf16 v[24:27], a[44:47], v[80:83], v[24:27]
    v_mul_f32 v121, v121, abs(v33)
    v_cvt_pk_bf16_f32 v32, v120, v121
    v_mfma_f32_16x16x32_bf16 v[28:31], a[44:47], v[84:87], v[28:31]
    s_waitcnt lgkmcnt(3)
    v_pk_max_i16 v32, v32, 0
    v_mul_f32 v120, v34, v116
    v_mfma_f32_16x16x32_bf16 v[8:11], a[48:51], v[56:59], v[8:11]
    ds_read_b128 v[72:75], v1 offset:12288
    v_mul_f32 v121, v35, v116
    v_mfma_f32_16x16x32_bf16 v[16:19], a[48:51], v[60:63], v[16:19]
    v_mul_f32 v120, v120, abs(v34)
    v_mul_f32 v121, v121, abs(v35)
    v_mfma_f32_16x16x32_bf16 v[20:23], a[52:55], v[60:63], v[20:23]
    v_cvt_pk_bf16_f32 v33, v120, v121
    v_pk_max_i16 v33, v33, 0
    v_mfma_f32_16x16x32_bf16 v[12:15], a[52:55], v[56:59], v[12:15]
    ds_read_b128 v[76:79], v1 offset:13312
    v_mul_f32 v120, v36, v116
    v_mfma_f32_16x16x32_bf16 v[24:27], a[56:59], v[56:59], v[24:27]
    v_mul_f32 v121, v37, v116
    v_mul_f32 v120, v120, abs(v36)
    v_mfma_f32_16x16x32_bf16 v[28:31], a[56:59], v[60:63], v[28:31]
    s_waitcnt vmcnt(9) lgkmcnt(2)
    s_barrier
    v_mul_f32 v121, v121, abs(v37)
    v_mfma_f32_16x16x32_bf16 v[8:11], a[60:63], v[64:67], v[8:11]
    ds_read_b128 v[80:83], v1 offset:14336
    v_cvt_pk_bf16_f32 v34, v120, v121
    v_mfma_f32_16x16x32_bf16 v[16:19], a[60:63], v[68:71], v[16:19]
    ds_read_b128 v[48:51], v4 offset:4096
    v_pk_max_i16 v34, v34, 0
    v_mfma_f32_16x16x32_bf16 v[20:23], a[64:67], v[68:71], v[20:23]
    buffer_load_dword v7, v5, s[16:19], s45 offen sc1
    v_mfma_f32_16x16x32_bf16 v[12:15], a[64:67], v[64:67], v[12:15]
    ds_read_b128 v[84:87], v1 offset:15360
    v_mul_f32 v120, v38, v116
    v_mfma_f32_16x16x32_bf16 v[24:27], a[68:71], v[64:67], v[24:27]
    v_mul_f32 v121, v39, v116
    v_mul_f32 v120, v120, abs(v38)
    v_mfma_f32_16x16x32_bf16 v[28:31], a[68:71], v[68:71], v[28:31]
    s_waitcnt lgkmcnt(3)
    v_mul_f32 v121, v121, abs(v39)
    v_cvt_pk_bf16_f32 v35, v120, v121
    v_mfma_f32_16x16x32_bf16 v[8:11], a[72:75], v[72:75], v[8:11]
    s_waitcnt lgkmcnt(1)
    ds_read_b128 v[56:59], v1 offset:16384
    v_pk_max_i16 v35, v35, 0
    v_mfma_f32_16x16x32_bf16 v[16:19], a[72:75], v[76:79], v[16:19]
    buffer_store_dwordx4 v[48:51], v1, s[16:19], s49 offen sc1
    v_mfma_f32_16x16x32_bf16 v[20:23], a[76:79], v[76:79], v[20:23]
    buffer_store_dwordx4 v[32:35], v1, s[16:19], s44 offen offset:0 sc1
    v_mfma_f32_16x16x32_bf16 v[12:15], a[76:79], v[72:75], v[12:15]
    ds_read_b128 v[60:63], v1 offset:17408
    v_mul_f32 v120, v40, v117
    v_mfma_f32_16x16x32_bf16 v[24:27], a[80:83], v[72:75], v[24:27]
    v_mul_f32 v121, v41, v117
    v_mul_f32 v120, v120, abs(v40)
    v_mfma_f32_16x16x32_bf16 v[28:31], a[80:83], v[76:79], v[28:31]
    s_waitcnt lgkmcnt(2)
    v_mul_f32 v121, v121, abs(v41)
    v_cvt_pk_bf16_f32 v40, v120, v121
    v_mfma_f32_16x16x32_bf16 v[8:11], a[84:87], v[80:83], v[8:11]
    ds_read_b128 v[64:67], v1 offset:18432
    v_pk_max_i16 v40, v40, 0
    v_mfma_f32_16x16x32_bf16 v[16:19], a[84:87], v[84:87], v[16:19]
    v_mul_f32 v120, v42, v117
    v_mul_f32 v121, v43, v117
    v_mfma_f32_16x16x32_bf16 v[20:23], a[88:91], v[84:87], v[20:23]
    v_mul_f32 v120, v120, abs(v42)
    v_mul_f32 v121, v121, abs(v43)
    v_mfma_f32_16x16x32_bf16 v[12:15], a[88:91], v[80:83], v[12:15]
    ds_read_b128 v[68:71], v1 offset:19456
    v_cvt_pk_bf16_f32 v41, v120, v121
    v_mfma_f32_16x16x32_bf16 v[24:27], a[92:95], v[80:83], v[24:27]
    v_pk_max_i16 v41, v41, 0
    v_mul_f32 v120, v44, v117
    v_mfma_f32_16x16x32_bf16 v[28:31], a[92:95], v[84:87], v[28:31]
    s_waitcnt lgkmcnt(2)
    v_mul_f32 v121, v45, v117
    v_mul_f32 v120, v120, abs(v44)
    v_mfma_f32_16x16x32_bf16 v[8:11], a[96:99], v[56:59], v[8:11]
    ds_read_b128 v[72:75], v1 offset:20480
    v_mul_f32 v121, v121, abs(v45)
    v_mfma_f32_16x16x32_bf16 v[16:19], a[96:99], v[60:63], v[16:19]
    v_cvt_pk_bf16_f32 v42, v120, v121
    v_pk_max_i16 v42, v42, 0
    v_mfma_f32_16x16x32_bf16 v[20:23], a[100:103], v[60:63], v[20:23]
    v_mul_f32 v120, v46, v117
    v_mul_f32 v121, v47, v117
    v_mfma_f32_16x16x32_bf16 v[12:15], a[100:103], v[56:59], v[12:15]
    ds_read_b128 v[76:79], v1 offset:21504
    v_mul_f32 v120, v120, abs(v46)
    v_mfma_f32_16x16x32_bf16 v[24:27], a[104:107], v[56:59], v[24:27]
    v_mul_f32 v121, v121, abs(v47)
    v_cvt_pk_bf16_f32 v43, v120, v121
    v_mfma_f32_16x16x32_bf16 v[28:31], a[104:107], v[60:63], v[28:31]
    s_waitcnt lgkmcnt(2)
    v_pk_max_i16 v43, v43, 0
    v_mfma_f32_16x16x32_bf16 v[8:11], a[108:111], v[64:67], v[8:11]
    ds_read_b128 v[80:83], v1 offset:22528
    v_mfma_f32_16x16x32_bf16 v[16:19], a[108:111], v[68:71], v[16:19]
    buffer_store_dwordx4 v[40:43], v1, s[16:19], s44 offen offset:1024 sc1
    v_mfma_f32_16x16x32_bf16 v[20:23], a[112:115], v[68:71], v[20:23]
    v_mfma_f32_16x16x32_bf16 v[12:15], a[112:115], v[64:67], v[12:15]
    ds_read_b128 v[84:87], v1 offset:23552
    v_mfma_f32_16x16x32_bf16 v[24:27], a[116:119], v[64:67], v[24:27]
    v_mfma_f32_16x16x32_bf16 v[28:31], a[116:119], v[68:71], v[28:31]
    s_waitcnt lgkmcnt(2)
    v_mfma_f32_16x16x32_bf16 v[8:11], a[120:123], v[72:75], v[8:11]
    ds_read_b128 v[56:59], v1 offset:24576
    v_mfma_f32_16x16x32_bf16 v[16:19], a[120:123], v[76:79], v[16:19]
    v_mfma_f32_16x16x32_bf16 v[20:23], a[124:127], v[76:79], v[20:23]
    v_mfma_f32_16x16x32_bf16 v[12:15], a[124:127], v[72:75], v[12:15]
    ds_read_b128 v[60:63], v1 offset:25600
    v_mfma_f32_16x16x32_bf16 v[24:27], a[128:131], v[72:75], v[24:27]
    v_mfma_f32_16x16x32_bf16 v[28:31], a[128:131], v[76:79], v[28:31]
    s_waitcnt lgkmcnt(2)
    v_mfma_f32_16x16x32_bf16 v[8:11], a[132:135], v[80:83], v[8:11]
    ds_read_b128 v[64:67], v1 offset:26624
    v_mfma_f32_16x16x32_bf16 v[16:19], a[132:135], v[84:87], v[16:19]
    v_mfma_f32_16x16x32_bf16 v[20:23], a[136:139], v[84:87], v[20:23]
    v_mfma_f32_16x16x32_bf16 v[12:15], a[136:139], v[80:83], v[12:15]
    ds_read_b128 v[68:71], v1 offset:27648
    v_mfma_f32_16x16x32_bf16 v[24:27], a[140:143], v[80:83], v[24:27]
    v_mfma_f32_16x16x32_bf16 v[28:31], a[140:143], v[84:87], v[28:31]
    s_waitcnt lgkmcnt(2)
    v_mfma_f32_16x16x32_bf16 v[8:11], a[144:147], v[56:59], v[8:11]
    ds_read_b128 v[72:75], v1 offset:28672
    v_mfma_f32_16x16x32_bf16 v[16:19], a[144:147], v[60:63], v[16:19]
    v_mfma_f32_16x16x32_bf16 v[20:23], a[148:151], v[60:63], v[20:23]
    v_mfma_f32_16x16x32_bf16 v[12:15], a[148:151], v[56:59], v[12:15]
    ds_read_b128 v[76:79], v1 offset:29696
    v_mfma_f32_16x16x32_bf16 v[24:27], a[152:155], v[56:59], v[24:27]
    v_mfma_f32_16x16x32_bf16 v[28:31], a[152:155], v[60:63], v[28:31]
    s_waitcnt lgkmcnt(2)
    v_mfma_f32_16x16x32_bf16 v[8:11], a[156:159], v[64:67], v[8:11]
    ds_read_b128 v[80:83], v1 offset:30720
    v_mfma_f32_16x16x32_bf16 v[16:19], a[156:159], v[68:71], v[16:19]
    s_waitcnt vmcnt(3)
    v_cmp_ne_u32 vcc, 0, v7
    v_mfma_f32_16x16x32_bf16 v[20:23], a[160:163], v[68:71], v[20:23]
    v_mfma_f32_16x16x32_bf16 v[12:15], a[160:163], v[64:67], v[12:15]
    s_cbranch_vccnz L_spin16
L_back17:
    ds_read_b128 v[84:87], v1 offset:31744
    v_mfma_f32_16x16x32_bf16 v[24:27], a[164:167], v[64:67], v[24:27]
    v_mfma_f32_16x16x32_bf16 v[28:31], a[164:167], v[68:71], v[28:31]
    s_waitcnt vmcnt(4) lgkmcnt(2)
    s_barrier
    v_mfma_f32_16x16x32_bf16 v[8:11], a[168:171], v[72:75], v[8:11]
    s_add_u32 m0, s43, 98304
    ds_read_b128 v[56:59], v1 offset:32768
    s_add_u32 s42, s41, 0
    v_mfma_f32_16x16x32_bf16 v[16:19], a[168:171], v[76:79], v[16:19]
    buffer_load_dwordx4 v1, s[16:19], s42 offen offset:0 sc1 lds
    v_mfma_f32_16x16x32_bf16 v[20:23], a[172:175], v[76:79], v[20:23]
    ds_read_b64 v[36:37], v118 offset:0
    v_mfma_f32_16x16x32_bf16 v[12:15], a[172:175], v[72:75], v[12:15]
    ds_read_b128 v[60:63], v1 offset:33792
    v_mfma_f32_16x16x32_bf16 v[24:27], a[176:179], v[72:75], v[24:27]
    ds_read_b64 v[38:39], v118 offset:128
    v_mfma_f32_16x16x32_bf16 v[28:31], a[176:179], v[76:79], v[28:31]
    s_waitcnt lgkmcnt(4)
    ds_read_b64 v[40:41], v118 offset:256
    v_mfma_f32_16x16x32_bf16 v[8:11], a[180:183], v[80:83], v[8:11]
    ds_read_b128 v[64:67], v1 offset:34816
    v_mfma_f32_16x16x32_bf16 v[16:19], a[180:183], v[84:87], v[16:19]
    buffer_load_dwordx4 v1, s[16:19], s42 offen offset:1024 sc1 lds
    v_mfma_f32_16x16x32_bf16 v[20:23], a[184:187], v[84:87], v[20:23]
    ds_read_b64 v[42:43], v118 offset:384
    v_mfma_f32_16x16x32_bf16 v[12:15], a[184:187], v[80:83], v[12:15]
    ds_read_b128 v[68:71], v1 offset:35840
    v_mfma_f32_16x16x32_bf16 v[24:27], a[188:191], v[80:83], v[24:27]
    v_mfma_f32_16x16x32_bf16 v[28:31], a[188:191], v[84:87], v[28:31]
    s_waitcnt lgkmcnt(5)
    v_mfma_f32_16x16x32_bf16 v[8:11], a[192:195], v[56:59], v[8:11]
    ds_read_b128 v[72:75], v1 offset:36864
    v_mfma_f32_16x16x32_bf16 v[16:19], a[192:195], v[60:63], v[16:19]
    buffer_load_dwordx4 v1, s[16:19], s42 offen offset:2048 sc1 lds
    v_mfma_f32_16x16x32_bf16 v[20:23], a[196:199], v[60:63], v[20:23]
    s_waitcnt lgkmcnt(2)
    v_max3_u32 v44, v36, v37, v38
    v_max3_u32 v45, v39, v40, v41
    v_mfma_f32_16x16x32_bf16 v[12:15], a[196:199], v[56:59], v[12:15]
    ds_read_b128 v[76:79], v1 offset:37888
    v_max3_u32 v44, v44, v42, v43
    v_mfma_f32_16x16x32_bf16 v[24:27], a[200:203], v[56:59], v[24:27]
    v_max_u32 v44, v44, v45
    v_cmp_eq_u32 vcc, -1, v44
    v_mfma_f32_16x16x32_bf16 v[28:31], a[200:203], v[60:63], v[28:31]
    s_waitcnt lgkmcnt(2)
    v_mfma_f32_16x16x32_bf16 v[8:11], a[204:207], v[64:67], v[8:11]
    s_cbranch_vccnz L_sspin18
L_sback19:
    ds_read_b128 v[80:83], v1 offset:38912
    v_add_f32 v44, v40, v42
    v_mfma_f32_16x16x32_bf16 v[16:19], a[204:207], v[68:71], v[16:19]
    buffer_load_dwordx4 v1, s[16:19], s42 offen offset:3072 sc1 lds
    v_mfma_f32_16x16x32_bf16 v[20:23], a[208:211], v[68:71], v[20:23]
    s_add_u32 m0, s43, 114688
    v_add_f32 v45, v41, v43
    v_add_f32 v36, v36, v38
    v_mfma_f32_16x16x32_bf16 v[12:15], a[208:211], v[64:67], v[12:15]
    s_add_u32 s42, s41, 16384
    ds_read_b128 v[84:87], v1 offset:39936
    v_add_f32 v37, v37, v39
    v_mfma_f32_16x16x32_bf16 v[24:27], a[212:215], v[64:67], v[24:27]
    v_add_f32 v36, v36, v44
    v_add_f32 v37, v37, v45
    v_mfma_f32_16x16x32_bf16 v[28:31], a[212:215], v[68:71], v[28:31]
    s_waitcnt lgkmcnt(2)
    v_mov_b32 v44, v36
    v_mov_b32 v45, v37
    v_mfma_f32_16x16x32_bf16 v[8:11], a[216:219], v[72:75], v[8:11]
    ds_read_b128 v[56:59], v1 offset:40960
    v_mfma_f32_16x16x32_bf16 v[16:19], a[216:219], v[76:79], v[16:19]
    buffer_load_dwordx4 v1, s[16:19], s42 offen offset:0 sc1 lds
    v_mfma_f32_16x16x32_bf16 v[20:23], a[220:223], v[76:79], v[20:23]
    v_permlane32_swap_b32 v36, v44
    v_mfma_f32_16x16x32_bf16 v[12:15], a[220:223], v[72:75], v[12:15]
    ds_read_b128 v[60:63], v1 offset:41984
    v_mfma_f32_16x16x32_bf16 v[24:27], a[224:227], v[72:75], v[24:27]
    v_permlane32_swap_b32 v37, v45
    v_mfma_f32_16x16x32_bf16 v[28:31], a[224:227], v[76:79], v[28:31]
    s_waitcnt lgkmcnt(2)
    v_add_f32 v36, v36, v44
    v_add_f32 v37, v37, v45
    v_mfma_f32_16x16x32_bf16 v[8:11], a[228:231], v[80:83], v[8:11]
    ds_read_b128 v[64:67], v1 offset:43008
    v_mul_f32 v112, 0xba800000, v36
    v_mfma_f32_16x16x32_bf16 v[16:19], a[228:231], v[84:87], v[16:19]
    buffer_load_dwordx4 v1, s[16:19], s42 offen offset:1024 sc1 lds
    v_mfma_f32_16x16x32_bf16 v[20:23], a[232:235], v[84:87], v[20:23]
    v_mul_f32 v37, 0x3a800000, v37
    v_fma_f32 v37, -v112, v112, v37
    v_mfma_f32_16x16x32_bf16 v[12:15], a[232:235], v[80:83], v[12:15]
    ds_read_b128 v[68:71], v1 offset:44032
    v_mov_b32 v113, v112
    v_mfma_f32_16x16x32_bf16 v[24:27], a[236:239], v[80:83], v[24:27]
    s_waitcnt vmcnt(6)
    v_max_f32 v37, 0, v37
    v_add_f32 v37, 0x3727c5ac, v37
    v_mfma_f32_16x16x32_bf16 v[28:31], a[236:239], v[84:87], v[28:31]
    s_waitcnt lgkmcnt(2)
    v_rsq_f32 v116, v37
    v_mfma_f32_16x16x32_bf16 v[8:11], a[240:243], v[56:59], v[8:11]
    s_barrier
    ds_read_b128 v[72:75], v1 offset:45056
    v_mfma_f32_16x16x32_bf16 v[16:19], a[240:243], v[60:63], v[16:19]
    buffer_store_dword v124, v124, s[16:19], s91 offen sc1
    v_mfma_f32_16x16x32_bf16 v[20:23], a[244:247], v[60:63], v[20:23]
    buffer_load_dwordx4 v1, s[16:19], s42 offen offset:2048 sc1 lds
    v_mfma_f32_16x16x32_bf16 v[12:15], a[244:247], v[56:59], v[12:15]
    s_add_u32 s91, s91, 65536
    ds_read_b128 v[76:79], v1 offset:46080
    v_mfma_f32_16x16x32_bf16 v[24:27], a[248:251], v[56:59], v[24:27]
    v_permlane16_swap_b32 v112, v113
    v_mfma_f32_16x16x32_bf16 v[28:31], a[248:251], v[60:63], v[28:31]
    s_waitcnt lgkmcnt(2)
    v_mul_f32 v114, v37, v116
    v_mul_f32 v116, v116, v116
    v_mfma_f32_16x16x32_bf16 v[8:11], a[252:255], v[64:67], v[8:11]
    ds_read_b128 v[80:83], v1 offset:47104
    v_mov_b32 v115, v114
    v_mfma_f32_16x16x32_bf16 v[16:19], a[252:255], v[68:71], v[16:19]
    v_mov_b32 v117, v116
    v_fmac_f32 v12, v112, v92
    v_mfma_f32_16x16x32_bf16 v[20:23], v[128:131], v[68:71], v[20:23]
    buffer_load_dwordx4 v1, s[16:19], s42 offen offset:3072 sc1 lds
    v_mfma_f32_16x16x32_bf16 v[12:15], v[128:131], v[64:67], v[12:15]
    s_add_u32 m0, s43, 131072
    ds_read_b128 v[84:87], v1 offset:48128
    v_fmac_f32 v8, v112, v88
    v_mfma_f32_16x16x32_bf16 v[24:27], v[132:135], v[64:67], v[24:27]
    s_add_u32 s42, s41, 32768
    v_permlane16_swap_b32 v114, v115
    v_mfma_f32_16x16x32_bf16 v[28:31], v[132:135], v[68:71], v[28:31]
    s_waitcnt lgkmcnt(2)
    v_permlane16_swap_b32 v116, v117
    v_mfma_f32_16x16x32_bf16 v[8:11], v[136:139], v[72:75], v[8:11]
    s_add_u32 s46, s46, 2048
    ds_read_b128 v[56:59], v1 offset:49152
    v_fmac_f32 v13, v112, v93
    v_mfma_f32_16x16x32_bf16 v[16:19], v[136:139], v[76:79], v[16:19]
    s_min_u32 s46, s46, s55
    v_fmac_f32 v14, v112, v94
    v_fmac_f32 v15, v112, v95
    v_mfma_f32_16x16x32_bf16 v[20:23], v[140:143], v[76:79], v[20:23]
    buffer_load_dwordx4 v1, s[16:19], s42 offen offset:0 sc1 lds
    v_mfma_f32_16x16x32_bf16 v[12:15], v[140:143], v[72:75], v[12:15]
    ds_read_b128 v[60:63], v1 offset:50176
    v_fmac_f32 v9, v112, v89
    v_mfma_f32_16x16x32_bf16 v[24:27], v[144:147], v[72:75], v[24:27]
    v_fmac_f32 v10, v112, v90
    v_fmac_f32 v11, v112, v91
    v_mfma_f32_16x16x32_bf16 v[28:31], v[144:147], v[76:79], v[28:31]
    s_waitcnt lgkmcnt(2)
    v_fmac_f32 v16, v113, v88
    v_fmac_f32 v17, v113, v89
    v_mfma_f32_16x16x32_bf16 v[8:11], v[148:151], v[80:83], v[8:11]
    ds_read_b128 v[64:67], v1 offset:51200
    v_fmac_f32 v12, v114, v104
    v_mfma_f32_16x16x32_bf16 v[16:19], v[148:151], v[84:87], v[16:19]
    v_fmac_f32 v13, v114, v105
    v_fmac_f32 v14, v114, v106
    v_mfma_f32_16x16x32_bf16 v[20:23], v[152:155], v[84:87], v[20:23]
    buffer_load_dwordx4 v1, s[16:19], s42 offen offset:1024 sc1 lds
    v_mfma_f32_16x16x32_bf16 v[12:15], v[152:155], v[80:83], v[12:15]
    ds_read_b128 v[68:71], v1 offset:52224
    v_fmac_f32 v8, v114, v100
    v_mfma_f32_16x16x32_bf16 v[24:27], v[156:159], v[80:83], v[24:27]
    v_fmac_f32 v9, v114, v101
    v_fmac_f32 v10, v114, v102
    v_mfma_f32_16x16x32_bf16 v[28:31], v[156:159], v[84:87], v[28:31]
    s_waitcnt lgkmcnt(2)
    v_fmac_f32 v18, v113, v90
    v_fmac_f32 v19, v113, v91
    v_mfma_f32_16x16x32_bf16 v[8:11], v[160:163], v[56:59], v[8:11]
    ds_read_b128 v[72:75], v1 offset:53248
    v_fmac_f32 v15, v114, v107
    v_mfma_f32_16x16x32_bf16 v[16:19], v[160:163], v[60:63], v[16:19]
    v_fmac_f32 v24, v112, v96
    v_fmac_f32 v25, v112, v97
    v_mfma_f32_16x16x32_bf16 v[20:23], v[164:167], v[60:63], v[20:23]
    buffer_load_dwordx4 v1, s[16:19], s42 offen offset:2048 sc1 lds
    v_mfma_f32_16x16x32_bf16 v[12:15], v[164:167], v[56:59], v[12:15]
    ds_read_b128 v[76:79], v1 offset:54272
    v_fmac_f32 v11, v114, v103
    v_mfma_f32_16x16x32_bf16 v[24:27], v[168:171], v[56:59], v[24:27]
    v_fmac_f32 v16, v115, v100
    v_fmac_f32 v17, v115, v101
    v_mfma_f32_16x16x32_bf16 v[28:31], v[168:171], v[60:63], v[28:31]
    s_waitcnt lgkmcnt(2)
    v_fmac_f32 v18, v115, v102
    v_fmac_f32 v19, v115, v103
    v_mfma_f32_16x16x32_bf16 v[8:11], v[172:175], v[64:67], v[8:11]
    ds_read_b128 v[80:83], v1 offset:55296
    v_fmac_f32 v20, v113, v92
    v_mfma_f32_16x16x32_bf16 v[16:19], v[172:175], v[68:71], v[16:19]
    v_fmac_f32 v26, v112, v98
    v_fmac_f32 v27, v112, v99
    v_mfma_f32_16x16x32_bf16 v[20:23], v[176:179], v[68:71], v[20:23]
    buffer_load_dwordx4 v1, s[16:19], s42 offen offset:3072 sc1 lds
    v_mfma_f32_16x16x32_bf16 v[12:15], v[176:179], v[64:67], v[12:15]
    s_add_u32 m0, s43, 147456
    ds_read_b128 v[84:87], v1 offset:56320
    v_fmac_f32 v28, v113, v96
    v_mfma_f32_16x16x32_bf16 v[24:27], v[180:183], v[64:67], v[24:27]
    s_add_u32 s42, s41, 49152
    v_fmac_f32 v21, v113, v93
    v_fmac_f32 v22, v113, v94
    v_mfma_f32_16x16x32_bf16 v[28:31], v[180:183], v[68:71], v[28:31]
    s_waitcnt lgkmcnt(2)
    v_fmac_f32 v23, v113, v95
    v_fmac_f32 v20, v115, v104
    v_mfma_f32_16x16x32_bf16 v[8:11], v[184:187], v[72:75], v[8:11]
    ds_read_b128 v[56:59], v1 offset:57344
    v_fmac_f32 v21, v115, v105
    v_mfma_f32_16x16x32_bf16 v[16:19], v[184:187], v[76:79], v[16:19]
    v_fmac_f32 v24, v114, v108
    v_fmac_f32 v25, v114, v109
    v_mfma_f32_16x16x32_bf16 v[20:23], v[188:191], v[76:79], v[20:23]
    buffer_load_dwordx4 v1, s[16:19], s42 offen offset:0 sc1 lds
    v_mfma_f32_16x16x32_bf16 v[12:15], v[188:191], v[72:75], v[12:15]
    ds_read_b128 v[60:63], v1 offset:58368
    v_fmac_f32 v29, v113, v97
    v_mfma_f32_16x16x32_bf16 v[24:27], v[192:195], v[72:75], v[24:27]
    s_nop 0
    v_fmac_f32 v22, v115, v106
    v_fmac_f32 v23, v115, v107
    v_mfma_f32_16x16x32_bf16 v[28:31], v[192:195], v[76:79], v[28:31]
    s_waitcnt lgkmcnt(2)
    v_mfma_f32_16x16x32_bf16 v[8:11], v[196:199], v[80:83], v[8:11]
    ds_read_b128 v[64:67], v1 offset:59392
    v_fmac_f32 v26, v114, v110
    v_mfma_f32_16x16x32_bf16 v[16:19], v[196:199], v[84:87], v[16:19]
    v_fmac_f32 v27, v114, v111
    v_fmac_f32 v30, v113, v98
    v_mfma_f32_16x16x32_bf16 v[20:23], v[200:203], v[84:87], v[20:23]
    buffer_load_dwordx4 v1, s[16:19], s42 offen offset:1024 sc1 lds
    v_mfma_f32_16x16x32_bf16 v[12:15], v[200:203], v[80:83], v[12:15]
    ds_read_b128 v[68:71], v1 offset:60416
    v_fmac_f32 v31, v113, v99
    v_mfma_f32_16x16x32_bf16 v[24:27], v[204:207], v[80:83], v[24:27]
    v_mfma_f32_16x16x32_bf16 v[28:31], v[204:207], v[84:87], v[28:31]
    s_waitcnt lgkmcnt(2)
    v_mfma_f32_16x16x32_bf16 v[8:11], v[208:211], v[56:59], v[8:11]
    ds_read_b128 v[72:75], v1 offset:61440
    v_mfma_f32_16x16x32_bf16 v[16:19], v[208:211], v[60:63], v[16:19]
    v_mfma_f32_16x16x32_bf16 v[20:23], v[212:215], v[60:63], v[20:23]
    buffer_load_dwordx4 v1, s[16:19], s42 offen offset:2048 sc1 lds
    v_mfma_f32_16x16x32_bf16 v[12:15], v[212:215], v[56:59], v[12:15]
    ds_read_b128 v[76:79], v1 offset:62464
    v_fmac_f32 v28, v115, v108
    v_mfma_f32_16x16x32_bf16 v[24:27], v[216:219], v[56:59], v[24:27]
    v_mfma_f32_16x16x32_bf16 v[28:31], v[216:219], v[60:63], v[28:31]
    s_waitcnt lgkmcnt(2)
    v_mfma_f32_16x16x32_bf16 v[8:11], v[220:223], v[64:67], v[8:11]
    ds_read_b128 v[80:83], v1 offset:63488
    v_mfma_f32_16x16x32_bf16 v[16:19], v[220:223], v[68:71], v[16:19]
    v_mfma_f32_16x16x32_bf16 v[20:23], v[224:227], v[68:71], v[20:23]
    buffer_load_dwordx4 v1, s[16:19], s42 offen offset:3072 sc1 lds
    v_mfma_f32_16x16x32_bf16 v[12:15], v[224:227], v[64:67], v[12:15]
    s_add_u32 s45, s45, 65536
    ds_read_b128 v[84:87], v1 offset:64512
    v_fmac_f32 v29, v115, v109
    v_mfma_f32_16x16x32_bf16 v[24:27], v[228:231], v[64:67], v[24:27]
    v_mfma_f32_16x16x32_bf16 v[28:31], v[228:231], v[68:71], v[28:31]
    s_waitcnt vmcnt(13) lgkmcnt(2)
    s_barrier
    v_mfma_f32_16x16x32_bf16 v[8:11], v[232:235], v[72:75], v[8:11]
    ds_read_b128 v[56:59], v2 offset:0
    v_mfma_f32_16x16x32_bf16 v[16:19], v[232:235], v[76:79], v[16:19]
    s_nop 0
    v_fmac_f32 v30, v115, v110
    v_fmac_f32 v31, v115, v111
    v_mfma_f32_16x16x32_bf16 v[20:23], v[236:239], v[76:79], v[20:23]
    v_mfma_f32_16x16x32_bf16 v[12:15], v[236:239], v[72:75], v[12:15]
    ds_read_b128 v[60:63], v2 offset:1024
    v_mfma_f32_16x16x32_bf16 v[24:27], v[240:243], v[72:75], v[24:27]
    v_mfma_f32_16x16x32_bf16 v[28:31], v[240:243], v[76:79], v[28:31]
    s_waitcnt lgkmcnt(2)
    v_mfma_f32_16x16x32_bf16 v[8:11], v[244:247], v[80:83], v[8:11]
    ds_read_b128 v[64:67], v2 offset:2048
    v_mfma_f32_16x16x32_bf16 v[16:19], v[244:247], v[84:87], v[16:19]
    v_mfma_f32_16x16x32_bf16 v[20:23], v[248:251], v[84:87], v[20:23]
    v_mfma_f32_16x16x32_bf16 v[12:15], v[248:251], v[80:83], v[12:15]
    ds_read_b128 v[68:71], v2 offset:3072
    v_mfma_f32_16x16x32_bf16 v[24:27], v[252:255], v[80:83], v[24:27]
    s_add_u32 s36, s36, 1
    v_mfma_f32_16x16x32_bf16 v[28:31], v[252:255], v[84:87], v[28:31]
    s_waitcnt lgkmcnt(2)
L_a_b1:
    v_mfma_f32_16x16x32_bf16 v[32:35], a[0:3], v[56:59], 0
    s_and_b32 s44, s90, 0xffffffff
    ds_read_b128 v[72:75], v2 offset:4096
    v_mul_f32 v120, v24, v116
    v_mfma_f32_16x16x32_bf16 v[40:43], a[0:3], v[60:63], 0
    s_cmp_lt_i32 s36, 1
    v_mul_f32 v121, v25, v116
    v_mul_f32 v120, v120, abs(v24)
    v_mfma_f32_16x16x32_bf16 v[44:47], a[4:7], v[60:63], 0
    s_cselect_b32 s44, 0x5e00000, s44
    v_mul_f32 v121, v121, abs(v25)
    v_cvt_pk_bf16_f32 v24, v120, v121
    v_mfma_f32_16x16x32_bf16 v[36:39], a[4:7], v[56:59], 0
    s_add_u32 s49, s44, s87
    ds_read_b128 v[76:79], v2 offset:5120
    v_pk_max_i16 v24, v24, 0
    v_mfma_f32_16x16x32_bf16 v[48:51], a[8:11], v[56:59], 0
    s_max_u32 s44, s44, s88
    v_mul_f32 v120, v26, v116
    v_mul_f32 v121, v27, v116
    v_mfma_f32_16x16x32_bf16 v[52:55], a[8:11], v[60:63], 0
    s_waitcnt lgkmcnt(2)
    v_mul_f32 v120, v120, abs(v26)
    v_mul_f32 v121, v121, abs(v27)
    v_mfma_f32_16x16x32_bf16 v[32:35], a[12:15], v[64:67], v[32:35]
    s_add_u32 s90, s90, 262144
    ds_read_b128 v[80:83], v2 offset:6144
    v_cvt_pk_bf16_f32 v25, v120, v121
    v_mfma_f32_16x16x32_bf16 v[40:43], a[12:15], v[68:71], v[40:43]
    s_add_u32 m0, s52, 73728
    v_pk_max_i16 v25, v25, 0
    s_add_u32 s42, s46, s52
    v_mfma_f32_16x16x32_bf16 v[44:47], a[16:19], v[68:71], v[44:47]
    buffer_load_dwordx4 v1, s[16:19], s42 offen sc1 lds
    v_mfma_f32_16x16x32_bf16 v[36:39], a[16:19], v[64:67], v[36:39]
    s_add_u32 s98, s98, 65536
    ds_read_b128 v[84:87], v2 offset:7168
    s_min_i32 s98, s98, s96
    v_mfma_f32_16x16x32_bf16 v[48:51], a[20:23], v[64:67], v[48:51]
    s_and_b32 s41, s98, 0xffffffff
    ds_write_b64 v3, v[24:25] offset:0
    v_mfma_f32_16x16x32_bf16 v[52:55], a[20:23], v[68:71], v[52:55]
    s_waitcnt lgkmcnt(3)
    v_mul_f32 v120, v28, v117
    v_mul_f32 v121, v29, v117
    v_mfma_f32_16x16x32_bf16 v[32:35], a[24:27], v[72:75], v[32:35]
    ds_read_b128 v[56:59], v2 offset:8192
    v_mul_f32 v120, v120, abs(v28)
    v_mfma_f32_16x16x32_bf16 v[40:43], a[24:27], v[76:79], v[40:43]
    v_mul_f32 v121, v121, abs(v29)
    v_cvt_pk_bf16_f32 v28, v120, v121
    v_mfma_f32_16x16x32_bf16 v[44:47], a[28:31], v[76:79], v[44:47]
    v_pk_max_i16 v28, v28, 0
    v_mul_f32 v120, v30, v117
    v_mfma_f32_16x16x32_bf16 v[36:39], a[28:31], v[72:75], v[36:39]
    ds_read_b128 v[60:63], v2 offset:9216
    v_mul_f32 v121, v31, v117
    v_mfma_f32_16x16x32_bf16 v[48:51], a[32:35], v[72:75], v[48:51]
    v_mul_f32 v120, v120, abs(v30)
    v_mul_f32 v121, v121, abs(v31)
    v_mfma_f32_16x16x32_bf16 v[52:55], a[32:35], v[76:79], v[52:55]
    s_waitcnt lgkmcnt(3)
    v_cvt_pk_bf16_f32 v29, v120, v121
    v_pk_max_i16 v29, v29, 0
    v_mfma_f32_16x16x32_bf16 v[32:35], a[36:39], v[80:83], v[32:35]
    ds_read_b128 v[64:67], v2 offset:10240
    v_mfma_f32_16x16x32_bf16 v[40:43], a[36:39], v[84:87], v[40:43]
    ds_write_b64 v3, v[28:29] offset:1024
    v_mfma_f32_16x16x32_bf16 v[44:47], a[40:43], v[84:87], v[44:47]
    v_mul_f32 v120, v8, v116
    v_mul_f32 v121, v9, v116
    v_mfma_f32_16x16x32_bf16 v[36:39], a[40:43], v[80:83], v[36:39]
    ds_read_b128 v[68:71], v2 offset:11264
    v_mul_f32 v120, v120, abs(v8)
    v_mfma_f32_16x16x32_bf16 v[48:51], a[44:47], v[80:83], v[48:51]
    v_mul_f32 v121, v121, abs(v9)
    v_cvt_pk_bf16_f32 v8, v120, v121
    v_mfma_f32_16x16x32_bf16 v[52:55], a[44:47], v[84:87], v[52:55]
    s_waitcnt lgkmcnt(3)
    v_pk_max_i16 v8, v8, 0
    v_mul_f32 v120, v10, v116
    v_mfma_f32_16x16x32_bf16 v[32:35], a[48:51], v[56:59], v[32:35]
    ds_read_b128 v[72:75], v2 offset:12288
    v_mul_f32 v121, v11, v116
    v_mfma_f32_16x16x32_bf16 v[40:43], a[48:51], v[60:63], v[40:43]
    v_mul_f32 v120, v120, abs(v10)
    v_mul_f32 v121, v121, abs(v11)
    v_mfma_f32_16x16x32_bf16 v[44:47], a[52:55], v[60:63], v[44:47]
    v_cvt_pk_bf16_f32 v9, v120, v121
    v_pk_max_i16 v9, v9, 0
    v_mfma_f32_16x16x32_bf16 v[36:39], a[52:55], v[56:59], v[36:39]
    ds_read_b128 v[76:79], v2 offset:13312
    v_mul_f32 v120, v12, v116
    v_mfma_f32_16x16x32_bf16 v[48:51], a[56:59], v[56:59], v[48:51]
    v_mul_f32 v121, v13, v116
    v_mul_f32 v120, v120, abs(v12)
    v_mfma_f32_16x16x32_bf16 v[52:55], a[56:59], v[60:63], v[52:55]
    s_waitcnt vmcnt(9) lgkmcnt(2)
    s_barrier
    v_mul_f32 v121, v121, abs(v13)
    v_mfma_f32_16x16x32_bf16 v[32:35], a[60:63], v[64:67], v[32:35]
    ds_read_b128 v[80:83], v2 offset:14336
    v_cvt_pk_bf16_f32 v10, v120, v121
    v_mfma_f32_16x16x32_bf16 v[40:43], a[60:63], v[68:71], v[40:43]
    ds_read_b128 v[24:27], v4 offset:0
    v_pk_max_i16 v10, v10, 0
    v_mfma_f32_16x16x32_bf16 v[44:47], a[64:67], v[68:71], v[44:47]
    buffer_load_dword v7, v5, s[16:19], s45 offen sc1
    v_mfma_f32_16x16x32_bf16 v[36:39], a[64:67], v[64:67], v[36:39]
    ds_read_b128 v[84:87], v2 offset:15360
    v_mul_f32 v120, v14, v116
    v_mfma_f32_16x16x32_bf16 v[48:51], a[68:71], v[64:67], v[48:51]
    v_mul_f32 v121, v15, v116
    v_mul_f32 v120, v120, abs(v14)
    v_mfma_f32_16x16x32_bf16 v[52:55], a[68:71], v[68:71], v[52:55]
    s_waitcnt lgkmcnt(3)
    v_mul_f32 v121, v121, abs(v15)
    v_cvt_pk_bf16_f32 v11, v120, v121
    v_mfma_f32_16x16x32_bf16 v[32:35], a[72:75], v[72:75], v[32:35]
    s_waitcnt lgkmcnt(1)
    ds_read_b128 v[56:59], v2 offset:16384
    v_pk_max_i16 v11, v11, 0
    v_mfma_f32_16x16x32_bf16 v[40:43], a[72:75], v[76:79], v[40:43]
    buffer_store_dwordx4 v[24:27], v1, s[16:19], s49 offen sc1
    v_mfma_f32_16x16x32_bf16 v[44:47], a[76:79], v[76:79], v[44:47]
    buffer_store_dwordx4 v[8:11], v1, s[16:19], s44 offen offset:0 sc1
    v_mfma_f32_16x16x32_bf16 v[36:39], a[76:79], v[72:75], v[36:39]
    ds_read_b128 v[60:63], v2 offset:17408
    v_mul_f32 v120, v16, v117
    v_mfma_f32_16x16x32_bf16 v[48:51], a[80:83], v[72:75], v[48:51]
    v_mul_f32 v121, v17, v117
    v_mul_f32 v120, v120, abs(v16)
    v_mfma_f32_16x16x32_bf16 v[52:55], a[80:83], v[76:79], v[52:55]
    s_waitcnt lgkmcnt(2)
    v_mul_f32 v121, v121, abs(v17)
    v_cvt_pk_bf16_f32 v16, v120, v121
    v_mfma_f32_16x16x32_bf16 v[32:35], a[84:87], v[80:83], v[32:35]
    ds_read_b128 v[64:67], v2 offset:18432
    v_pk_max_i16 v16, v16, 0
    v_mfma_f32_16x16x32_bf16 v[40:43], a[84:87], v[84:87], v[40:43]
    v_mul_f32 v120, v18, v117
    v_mul_f32 v121, v19, v117
    v_mfma_f32_16x16x32_bf16 v[44:47], a[88:91], v[84:87], v[44:47]
    v_mul_f32 v120, v120, abs(v18)
    v_mul_f32 v121, v121, abs(v19)
    v_mfma_f32_16x16x32_bf16 v[36:39], a[88:91], v[80:83], v[36:39]
    ds_read_b128 v[68:71], v2 offset:19456
    v_cvt_pk_bf16_f32 v17, v120, v121
    v_mfma_f32_16x16x32_bf16 v[48:51], a[92:95], v[80:83], v[48:51]
    v_pk_max_i16 v17, v17, 0
    v_mul_f32 v120, v20, v117
    v_mfma_f32_16x16x32_bf16 v[52:55], a[92:95], v[84:87], v[52:55]
    s_waitcnt lgkmcnt(2)
    v_mul_f32 v121, v21, v117
    v_mul_f32 v120, v120, abs(v20)
    v_mfma_f32_16x16x32_bf16 v[32:35], a[96:99], v[56:59], v[32:35]
    ds_read_b128 v[72:75], v2 offset:20480
    v_mul_f32 v121, v121, abs(v21)
    v_mfma_f32_16x16x32_bf16 v[40:43], a[96:99], v[60:63], v[40:43]
    v_cvt_pk_bf16_f32 v18, v120, v121
    v_pk_max_i16 v18, v18, 0
    v_mfma_f32_16x16x32_bf16 v[44:47], a[100:103], v[60:63], v[44:47]
    v_mul_f32 v120, v22, v117
    v_mul_f32 v121, v23, v117
    v_mfma_f32_16x16x32_bf16 v[36:39], a[100:103], v[56:59], v[36:39]
    ds_read_b128 v[76:79], v2 offset:21504
    v_mul_f32 v120, v120, abs(v22)
    v_mfma_f32_16x16x32_bf16 v[48:51], a[104:107], v[56:59], v[48:51]
    v_mul_f32 v121, v121, abs(v23)
    v_cvt_pk_bf16_f32 v19, v120, v121
    v_mfma_f32_16x16x32_bf16 v[52:55], a[104:107], v[60:63], v[52:55]
    s_waitcnt lgkmcnt(2)
    v_pk_max_i16 v19, v19, 0
    v_mfma_f32_16x16x32_bf16 v[32:35], a[108:111], v[64:67], v[32:35]
    ds_read_b128 v[80:83], v2 offset:22528
    v_mfma_f32_16x16x32_bf16 v[40:43], a[108:111], v[68:71], v[40:43]
    buffer_store_dwordx4 v[16:19], v1, s[16:19], s44 offen offset:1024 sc1
    v_mfma_f32_16x16x32_bf16 v[44:47], a[112:115], v[68:71], v[44:47]
    v_mfma_f32_16x16x32_bf16 v[36:39], a[112:115], v[64:67], v[36:39]
    ds_read_b128 v[84:87], v2 offset:23552
    v_mfma_f32_16x16x32_bf16 v[48:51], a[116:119], v[64:67], v[48:51]
    v_mfma_f32_16x16x32_bf16 v[52:55], a[116:119], v[68:71], v[52:55]
    s_waitcnt lgkmcnt(2)
    v_mfma_f32_16x16x32_bf16 v[32:35], a[120:123], v[72:75], v[32:35]
    ds_read_b128 v[56:59], v2 offset:24576
    v_mfma_f32_16x16x32_bf16 v[40:43], a[120:123], v[76:79], v[40:43]
    v_mfma_f32_16x16x32_bf16 v[44:47], a[124:127], v[76:79], v[44:47]
    v_mfma_f32_16x16x32_bf16 v[36:39], a[124:127], v[72:75], v[36:39]
    ds_read_b128 v[60:63], v2 offset:25600
    v_mfma_f32_16x16x32_bf16 v[48:51], a[128:131], v[72:75], v[48:51]
    v_mfma_f32_16x16x32_bf16 v[52:55], a[128:131], v[76:79], v[52:55]
    s_waitcnt lgkmcnt(2)
    v_mfma_f32_16x16x32_bf16 v[32:35], a[132:135], v[80:83], v[32:35]
    ds_read_b128 v[64:67], v2 offset:26624
    v_mfma_f32_16x16x32_bf16 v[40:43], a[132:135], v[84:87], v[40:43]
    v_mfma_f32_16x16x32_bf16 v[44:47], a[136:139], v[84:87], v[44:47]
    v_mfma_f32_16x16x32_bf16 v[36:39], a[136:139], v[80:83], v[36:39]
    ds_read_b128 v[68:71], v2 offset:27648
    v_mfma_f32_16x16x32_bf16 v[48:51], a[140:143], v[80:83], v[48:51]
    v_mfma_f32_16x16x32_bf16 v[52:55], a[140:143], v[84:87], v[52:55]
    s_waitcnt lgkmcnt(2)
    v_mfma_f32_16x16x32_bf16 v[32:35], a[144:147], v[56:59], v[32:35]
    ds_read_b128 v[72:75], v2 offset:28672
    v_mfma_f32_16x16x32_bf16 v[40:43], a[144:147], v[60:63], v[40:43]
    v_mfma_f32_16x16x32_bf16 v[44:47], a[148:151], v[60:63], v[44:47]
    v_mfma_f32_16x16x32_bf16 v[36:39], a[148:151], v[56:59], v[36:39]
    ds_read_b128 v[76:79], v2 offset:29696
    v_mfma_f32_16x16x32_bf16 v[48:51], a[152:155], v[56:59], v[48:51]
    v_mfma_f32_16x16x32_bf16 v[52:55], a[152:155], v[60:63], v[52:55]
    s_waitcnt lgkmcnt(2)
    v_mfma_f32_16x16x32_bf16 v[32:35], a[156:159], v[64:67], v[32:35]
    ds_read_b128 v[80:83], v2 offset:30720
    v_mfma_f32_16x16x32_bf16 v[40:43], a[156:159], v[68:71], v[40:43]
    s_waitcnt vmcnt(3)
    v_cmp_ne_u32 vcc, 0, v7
    v_mfma_f32_16x16x32_bf16 v[44:47], a[160:163], v[68:71], v[44:47]
    v_mfma_f32_16x16x32_bf16 v[36:39], a[160:163], v[64:67], v[36:39]
    s_cbranch_vccnz L_spin20
L_back21:
    ds_read_b128 v[84:87], v2 offset:31744
    v_mfma_f32_16x16x32_bf16 v[48:51], a[164:167], v[64:67], v[48:51]
    v_mfma_f32_16x16x32_bf16 v[52:55], a[164:167], v[68:71], v[52:55]
    s_waitcnt vmcnt(4) lgkmcnt(2)
    s_barrier
    v_mfma_f32_16x16x32_bf16 v[32:35], a[168:171], v[72:75], v[32:35]
    s_add_u32 m0, s43, 0
    ds_read_b128 v[56:59], v2 offset:32768
    s_add_u32 s42, s41, 0
    v_mfma_f32_16x16x32_bf16 v[40:43], a[168:171], v[76:79], v[40:43]
    buffer_load_dwordx4 v1, s[16:19], s42 offen offset:0 sc1 lds
    v_mfma_f32_16x16x32_bf16 v[44:47], a[172:175], v[76:79], v[44:47]
    ds_read_b64 v[12:13], v118 offset:0
    v_mfma_f32_16x16x32_bf16 v[36:39], a[172:175], v[72:75], v[36:39]
    ds_read_b128 v[60:63], v2 offset:33792
    v_mfma_f32_16x16x32_bf16 v[48:51], a[176:179], v[72:75], v[48:51]
    ds_read_b64 v[14:15], v118 offset:128
    v_mfma_f32_16x16x32_bf16 v[52:55], a[176:179], v[76:79], v[52:55]
    s_waitcnt lgkmcnt(4)
    ds_read_b64 v[16:17], v118 offset:256
    v_mfma_f32_16x16x32_bf16 v[32:35], a[180:183], v[80:83], v[32:35]
    ds_read_b128 v[64:67], v2 offset:34816
    v_mfma_f32_16x16x32_bf16 v[40:43], a[180:183], v[84:87], v[40:43]
    buffer_load_dwordx4 v1, s[16:19], s42 offen offset:1024 sc1 lds
    v_mfma_f32_16x16x32_bf16 v[44:47], a[184:187], v[84:87], v[44:47]
    ds_read_b64 v[18:19], v118 offset:384
    v_mfma_f32_16x16x32_bf16 v[36:39], a[184:187], v[80:83], v[36:39]
    ds_read_b128 v[68:71], v2 offset:35840
    v_mfma_f32_16x16x32_bf16 v[48:51], a[188:191], v[80:83], v[48:51]
    v_mfma_f32_16x16x32_bf16 v[52:55], a[188:191], v[84:87], v[52:55]
    s_waitcnt lgkmcnt(5)
    v_mfma_f32_16x16x32_bf16 v[32:35], a[192:195], v[56:59], v[32:35]
    ds_read_b128 v[72:75], v2 offset:36864
    v_mfma_f32_16x16x32_bf16 v[40:43], a[192:195], v[60:63], v[40:43]
    buffer_load_dwordx4 v1, s[16:19], s42 offen offset:2048 sc1 lds
    v_mfma_f32_16x16x32_bf16 v[44:47], a[196:199], v[60:63], v[44:47]
    s_waitcnt lgkmcnt(2)
    v_max3_u32 v20, v12, v13, v14
    v_max3_u32 v21, v15, v16, v17
    v_mfma_f32_16x16x32_bf16 v[36:39], a[196:199], v[56:59], v[36:39]
    ds_read_b128 v[76:79], v2 offset:37888
    v_max3_u32 v20, v20, v18, v19
    v_mfma_f32_16x16x32_bf16 v[48:51], a[200:203], v[56:59], v[48:51]
    v_max_u32 v20, v20, v21
    v_cmp_eq_u32 vcc, -1, v20
    v_mfma_f32_16x16x32_bf16 v[52:55], a[200:203], v[60:63], v[52:55]
    s_waitcnt lgkmcnt(2)
    v_mfma_f32_16x16x32_bf16 v[32:35], a[204:207], v[64:67], v[32:35]
    s_cbranch_vccnz L_sspin22
L_sback23:
    ds_read_b128 v[80:83], v2 offset:38912
    v_add_f32 v20, v16, v18
    v_mfma_f32_16x16x32_bf16 v[40:43], a[204:207], v[68:71], v[40:43]
    buffer_load_dwordx4 v1, s[16:19], s42 offen offset:3072 sc1 lds
    v_mfma_f32_16x16x32_bf16 v[44:47], a[208:211], v[68:71], v[44:47]
    s_add_u32 m0, s43, 16384
    v_add_f32 v21, v17, v19
    v_add_f32 v12, v12, v14
    v_mfma_f32_16x16x32_bf16 v[36:39], a[208:211], v[64:67], v[36:39]
    s_add_u32 s42, s41, 16384
    ds_read_b128 v[84:87], v2 offset:39936
    v_add_f32 v13, v13, v15
    v_mfma_f32_16x16x32_bf16 v[48:51], a[212:215], v[64:67], v[48:51]
    v_add_f32 v12, v12, v20
    v_add_f32 v13, v13, v21
    v_mfma_f32_16x16x32_bf16 v[52:55], a[212:215], v[68:71], v[52:55]
    s_waitcnt lgkmcnt(2)
    v_mov_b32 v20, v12
    v_mov_b32 v21, v13
    v_mfma_f32_16x16x32_bf16 v[32:35], a[216:219], v[72:75], v[32:35]
    ds_read_b128 v[56:59], v2 offset:40960
    v_mfma_f32_16x16x32_bf16 v[40:43], a[216:219], v[76:79], v[40:43]
    buffer_load_dwordx4 v1, s[16:19], s42 offen offset:0 sc1 lds
    v_mfma_f32_16x16x32_bf16 v[44:47], a[220:223], v[76:79], v[44:47]
    v_permlane32_swap_b32 v12, v20
    v_mfma_f32_16x16x32_bf16 v[36:39], a[220:223], v[72:75], v[36:39]
    ds_read_b128 v[60:63], v2 offset:41984
    v_mfma_f32_16x16x32_bf16 v[48:51], a[224:227], v[72:75], v[48:51]
    v_permlane32_swap_b32 v13, v21
    v_mfma_f32_16x16x32_bf16 v[52:55], a[224:227], v[76:79], v[52:55]
    s_waitcnt lgkmcnt(2)
    v_add_f32 v12, v12, v20
    v_add_f32 v13, v13, v21
    v_mfma_f32_16x16x32_bf16 v[32:35], a[228:231], v[80:83], v[32:35]
    ds_read_b128 v[64:67], v2 offset:43008
    v_mul_f32 v112, 0xba800000, v12
    v_mfma_f32_16x16x32_bf16 v[40:43], a[228:231], v[84:87], v[40:43]
    buffer_load_dwordx4 v1, s[16:19], s42 offen offset:1024 sc1 lds
    v_mfma_f32_16x16x32_bf16 v[44:47], a[232:235], v[84:87], v[44:47]
    v_mul_f32 v13, 0x3a800000, v13
    v_fma_f32 v13, -v112, v112, v13
    v_mfma_f32_16x16x32_bf16 v[36:39], a[232:235], v[80:83], v[36:39]
    ds_read_b128 v[68:71], v2 offset:44032
    v_mov_b32 v113, v112
    v_mfma_f32_16x16x32_bf16 v[48:51], a[236:239], v[80:83], v[48:51]
    s_waitcnt vmcnt(6)
    v_max_f32 v13, 0, v13
    v_add_f32 v13, 0x3727c5ac, v13
    v_mfma_f32_16x16x32_bf16 v[52:55], a[236:239], v[84:87], v[52:55]
    s_waitcnt lgkmcnt(2)
    v_rsq_f32 v116, v13
    v_mfma_f32_16x16x32_bf16 v[32:35], a[240:243], v[56:59], v[32:35]
    s_barrier
    ds_read_b128 v[72:75], v2 offset:45056
    v_mfma_f32_16x16x32_bf16 v[40:43], a[240:243], v[60:63], v[40:43]
    buffer_store_dword v124, v124, s[16:19], s91 offen sc1
    v_mfma_f32_16x16x32_bf16 v[44:47], a[244:247], v[60:63], v[44:47]
    buffer_load_dwordx4 v1, s[16:19], s42 offen offset:2048 sc1 lds
    v_mfma_f32_16x16x32_bf16 v[36:39], a[244:247], v[56:59], v[36:39]
    s_add_u32 s91, s91, 65536
    ds_read_b128 v[76:79], v2 offset:46080
    v_mfma_f32_16x16x32_bf16 v[48:51], a[248:251], v[56:59], v[48:51]
    v_permlane16_swap_b32 v112, v113
    v_mfma_f32_16x16x32_bf16 v[52:55], a[248:251], v[60:63], v[52:55]
    s_waitcnt lgkmcnt(2)
    v_mul_f32 v114, v13, v116
    v_mul_f32 v116, v116, v116
    v_mfma_f32_16x16x32_bf16 v[32:35], a[252:255], v[64:67], v[32:35]
    ds_read_b128 v[80:83], v2 offset:47104
    v_mov_b32 v115, v114
    v_mfma_f32_16x16x32_bf16 v[40:43], a[252:255], v[68:71], v[40:43]
    v_mov_b32 v117, v116
    v_fmac_f32 v36, v112, v92
    v_mfma_f32_16x16x32_bf16 v[44:47], v[128:131], v[68:71], v[44:47]
    buffer_load_dwordx4 v1, s[16:19], s42 offen offset:3072 sc1 lds
    v_mfma_f32_16x16x32_bf16 v[36:39], v[128:131], v[64:67], v[36:39]
    s_add_u32 m0, s43, 32768
    ds_read_b128 v[84:87], v2 offset:48128
    v_fmac_f32 v32, v112, v88
    v_mfma_f32_16x16x32_bf16 v[48:51], v[132:135], v[64:67], v[48:51]
    s_add_u32 s42, s41, 32768
    v_permlane16_swap_b32 v114, v115
    v_mfma_f32_16x16x32_bf16 v[52:55], v[132:135], v[68:71], v[52:55]
    s_waitcnt lgkmcnt(2)
    v_permlane16_swap_b32 v116, v117
    v_mfma_f32_16x16x32_bf16 v[32:35], v[136:139], v[72:75], v[32:35]
    s_add_u32 s46, s46, 2048
    ds_read_b128 v[56:59], v2 offset:49152
    v_fmac_f32 v37, v112, v93
    v_mfma_f32_16x16x32_bf16 v[40:43], v[136:139], v[76:79], v[40:43]
    s_min_u32 s46, s46, s55
    v_fmac_f32 v38, v112, v94
    v_fmac_f32 v39, v112, v95
    v_mfma_f32_16x16x32_bf16 v[44:47], v[140:143], v[76:79], v[44:47]
    buffer_load_dwordx4 v1, s[16:19], s42 offen offset:0 sc1 lds
    v_mfma_f32_16x16x32_bf16 v[36:39], v[140:143], v[72:75], v[36:39]
    ds_read_b128 v[60:63], v2 offset:50176
    v_fmac_f32 v33, v112, v89
    v_mfma_f32_16x16x32_bf16 v[48:51], v[144:147], v[72:75], v[48:51]
    v_fmac_f32 v34, v112, v90
    v_fmac_f32 v35, v112, v91
    v_mfma_f32_16x16x32_bf16 v[52:55], v[144:147], v[76:79], v[52:55]
    s_waitcnt lgkmcnt(2)
    v_fmac_f32 v40, v113, v88
    v_fmac_f32 v41, v113, v89
    v_mfma_f32_16x16x32_bf16 v[32:35], v[148:151], v[80:83], v[32:35]
    ds_read_b128 v[64:67], v2 offset:51200
    v_fmac_f32 v36, v114, v104
    v_mfma_f32_16x16x32_bf16 v[40:43], v[148:151], v[84:87], v[40:43]
    v_fmac_f32 v37, v114, v105
    v_fmac_f32 v38, v114, v106
    v_mfma_f32_16x16x32_bf16 v[44:47], v[152:155], v[84:87], v[44:47]
    buffer_load_dwordx4 v1, s[16:19], s42 offen offset:1024 sc1 lds
    v_mfma_f32_16x16x32_bf16 v[36:39], v[152:155], v[80:83], v[36:39]
    ds_read_b128 v[68:71], v2 offset:52224
    v_fmac_f32 v32, v114, v100
    v_mfma_f32_16x16x32_bf16 v[48:51], v[156:159], v[80:83], v[48:51]
    v_fmac_f32 v33, v114, v101
    v_fmac_f32 v34, v114, v102
    v_mfma_f32_16x16x32_bf16 v[52:55], v[156:159], v[84:87], v[52:55]
    s_waitcnt lgkmcnt(2)
    v_fmac_f32 v42, v113, v90
    v_fmac_f32 v43, v113, v91
    v_mfma_f32_16x16x32_bf16 v[32:35], v[160:163], v[56:59], v[32:35]
    ds_read_b128 v[72:75], v2 offset:53248
    v_fmac_f32 v39, v114, v107
    v_mfma_f32_16x16x32_bf16 v[40:43], v[160:163], v[60:63], v[40:43]
    v_fmac_f32 v48, v112, v96
    v_fmac_f32 v49, v112, v97
    v_mfma_f32_16x16x32_bf16 v[44:47], v[164:167], v[60:63], v[44:47]
    buffer_load_dwordx4 v1, s[16:19], s42 offen offset:2048 sc1 lds
    v_mfma_f32_16x16x32_bf16 v[36:39], v[164:167], v[56:59], v[36:39]
    ds_read_b128 v[76:79], v2 offset:54272
    v_fmac_f32 v35, v114, v103
    v_mfma_f32_16x16x32_bf16 v[48:51], v[168:171], v[56:59], v[48:51]
    v_fmac_f32 v40, v115, v100
    v_fmac_f32 v41, v115, v101
    v_mfma_f32_16x16x32_bf16 v[52:55], v[168:171], v[60:63], v[52:55]
    s_waitcnt lgkmcnt(2)
    v_fmac_f32 v42, v115, v102
    v_fmac_f32 v43, v115, v103
    v_mfma_f32_16x16x32_bf16 v[32:35], v[172:175], v[64:67], v[32:35]
    ds_read_b128 v[80:83], v2 offset:55296
    v_fmac_f32 v44, v113, v92
    v_mfma_f32_16x16x32_bf16 v[40:43], v[172:175], v[68:71], v[40:43]
    v_fmac_f32 v50, v112, v98
    v_fmac_f32 v51, v112, v99
    v_mfma_f32_16x16x32_bf16 v[44:47], v[176:179], v[68:71], v[44:47]
    buffer_load_dwordx4 v1, s[16:19], s42 offen offset:3072 sc1 lds
    v_mfma_f32_16x16x32_bf16 v[36:39], v[176:179], v[64:67], v[36:39]
    s_add_u32 m0, s43, 49152
    ds_read_b128 v[84:87], v2 offset:56320
    v_fmac_f32 v52, v113, v96
    v_mfma_f32_16x16x32_bf16 v[48:51], v[180:183], v[64:67], v[48:51]
    s_add_u32 s42, s41, 49152
    v_fmac_f32 v45, v113, v93
    v_fmac_f32 v46, v113, v94
    v_mfma_f32_16x16x32_bf16 v[52:55], v[180:183], v[68:71], v[52:55]
    s_waitcnt lgkmcnt(2)
    v_fmac_f32 v47, v113, v95
    v_fmac_f32 v44, v115, v104
    v_mfma_f32_16x16x32_bf16 v[32:35], v[184:187], v[72:75], v[32:35]
    ds_read_b128 v[56:59], v2 offset:57344
    v_fmac_f32 v45, v115, v105
    v_mfma_f32_16x16x32_bf16 v[40:43], v[184:187], v[76:79], v[40:43]
    v_fmac_f32 v48, v114, v108
    v_fmac_f32 v49, v114, v109
    v_mfma_f32_16x16x32_bf16 v[44:47], v[188:191], v[76:79], v[44:47]
    buffer_load_dwordx4 v1, s[16:19], s42 offen offset:0 sc1 lds
    v_mfma_f32_16x16x32_bf16 v[36:39], v[188:191], v[72:75], v[36:39]
    ds_read_b128 v[60:63], v2 offset:58368
    v_fmac_f32 v53, v113, v97
    v_mfma_f32_16x16x32_bf16 v[48:51], v[192:195], v[72:75], v[48:51]
    s_nop 0
    v_fmac_f32 v46, v115, v106
    v_fmac_f32 v47, v115, v107
    v_mfma_f32_16x16x32_bf16 v[52:55], v[192:195], v[76:79], v[52:55]
    s_waitcnt lgkmcnt(2)
    v_mfma_f32_16x16x32_bf16 v[32:35], v[196:199], v[80:83], v[32:35]
    ds_read_b128 v[64:67], v2 offset:59392
    v_fmac_f32 v50, v114, v110
    v_mfma_f32_16x16x32_bf16 v[40:43], v[196:199], v[84:87], v[40:43]
    v_fmac_f32 v51, v114, v111
    v_fmac_f32 v54, v113, v98
    v_mfma_f32_16x16x32_bf16 v[44:47], v[200:203], v[84:87], v[44:47]
    buffer_load_dwordx4 v1, s[16:19], s42 offen offset:1024 sc1 lds
    v_mfma_f32_16x16x32_bf16 v[36:39], v[200:203], v[80:83], v[36:39]
    ds_read_b128 v[68:71], v2 offset:60416
    v_fmac_f32 v55, v113, v99
    v_mfma_f32_16x16x32_bf16 v[48:51], v[204:207], v[80:83], v[48:51]
    v_mfma_f32_16x16x32_bf16 v[52:55], v[204:207], v[84:87], v[52:55]
    s_waitcnt lgkmcnt(2)
    v_mfma_f32_16x16x32_bf16 v[32:35], v[208:211], v[56:59], v[32:35]
    ds_read_b128 v[72:75], v2 offset:61440
    v_mfma_f32_16x16x32_bf16 v[40:43], v[208:211], v[60:63], v[40:43]
    v_mfma_f32_16x16x32_bf16 v[44:47], v[212:215], v[60:63], v[44:47]
    buffer_load_dwordx4 v1, s[16:19], s42 offen offset:2048 sc1 lds
    v_mfma_f32_16x16x32_bf16 v[36:39], v[212:215], v[56:59], v[36:39]
    ds_read_b128 v[76:79], v2 offset:62464
    v_fmac_f32 v52, v115, v108
    v_mfma_f32_16x16x32_bf16 v[48:51], v[216:219], v[56:59], v[48:51]
    v_mfma_f32_16x16x32_bf16 v[52:55], v[216:219], v[60:63], v[52:55]
    s_waitcnt lgkmcnt(2)
    v_mfma_f32_16x16x32_bf16 v[32:35], v[220:223], v[64:67], v[32:35]
    ds_read_b128 v[80:83], v2 offset:63488
    v_mfma_f32_16x16x32_bf16 v[40:43], v[220:223], v[68:71], v[40:43]
    v_mfma_f32_16x16x32_bf16 v[44:47], v[224:227], v[68:71], v[44:47]
    buffer_load_dwordx4 v1, s[16:19], s42 offen offset:3072 sc1 lds
    v_mfma_f32_16x16x32_bf16 v[36:39], v[224:227], v[64:67], v[36:39]
    s_add_u32 s45, s45, 65536
    ds_read_b128 v[84:87], v2 offset:64512
    v_fmac_f32 v53, v115, v109
    v_mfma_f32_16x16x32_bf16 v[48:51], v[228:231], v[64:67], v[48:51]
    v_mfma_f32_16x16x32_bf16 v[52:55], v[228:231], v[68:71], v[52:55]
    s_waitcnt vmcnt(13) lgkmcnt(2)
    s_barrier
    v_mfma_f32_16x16x32_bf16 v[32:35], v[232:235], v[72:75], v[32:35]
    ds_read_b128 v[56:59], v1 offset:0
    v_mfma_f32_16x16x32_bf16 v[40:43], v[232:235], v[76:79], v[40:43]
    s_nop 0
    v_fmac_f32 v54, v115, v110
    v_fmac_f32 v55, v115, v111
    v_mfma_f32_16x16x32_bf16 v[44:47], v[236:239], v[76:79], v[44:47]
    v_mfma_f32_16x16x32_bf16 v[36:39], v[236:239], v[72:75], v[36:39]
    ds_read_b128 v[60:63], v1 offset:1024
    v_mfma_f32_16x16x32_bf16 v[48:51], v[240:243], v[72:75], v[48:51]
    v_mfma_f32_16x16x32_bf16 v[52:55], v[240:243], v[76:79], v[52:55]
    s_waitcnt lgkmcnt(2)
    v_mfma_f32_16x16x32_bf16 v[32:35], v[244:247], v[80:83], v[32:35]
    ds_read_b128 v[64:67], v1 offset:2048
    v_mfma_f32_16x16x32_bf16 v[40:43], v[244:247], v[84:87], v[40:43]
    v_mfma_f32_16x16x32_bf16 v[44:47], v[248:251], v[84:87], v[44:47]
    v_mfma_f32_16x16x32_bf16 v[36:39], v[248:251], v[80:83], v[36:39]
    ds_read_b128 v[68:71], v1 offset:3072
    v_mfma_f32_16x16x32_bf16 v[48:51], v[252:255], v[80:83], v[48:51]
    s_add_u32 s36, s36, 1
    v_mfma_f32_16x16x32_bf16 v[52:55], v[252:255], v[84:87], v[52:55]
    s_waitcnt lgkmcnt(2)
    s_cmp_lt_u32 s36, 32
    s_cbranch_scc1 L_a_b0
    s_nop 7
    s_and_b32 s44, s90, 0xffffffff
    s_cmp_lt_i32 s36, 1
    s_cselect_b32 s44, 0x5e00000, s44
    s_add_u32 s49, s44, s87
    s_max_u32 s44, s44, s88
    s_add_u32 s90, s90, 262144
    v_mul_f32 v120, v48, v116
    v_mul_f32 v121, v49, v116
    v_mul_f32 v120, v120, abs(v48)
    v_mul_f32 v121, v121, abs(v49)
    v_cvt_pk_bf16_f32 v48, v120, v121
    v_pk_max_i16 v48, v48, 0
    v_mul_f32 v120, v50, v116
    v_mul_f32 v121, v51, v116
    v_mul_f32 v120, v120, abs(v50)
    v_mul_f32 v121, v121, abs(v51)
    v_cvt_pk_bf16_f32 v49, v120, v121
    v_pk_max_i16 v49, v49, 0
    ds_write_b64 v3, v[48:49] offset:4096
    v_mul_f32 v120, v52, v117
    v_mul_f32 v121, v53, v117
    v_mul_f32 v120, v120, abs(v52)
    v_mul_f32 v121, v121, abs(v53)
    v_cvt_pk_bf16_f32 v52, v120, v121
    v_pk_max_i16 v52, v52, 0
    v_mul_f32 v120, v54, v117
    v_mul_f32 v121, v55, v117
    v_mul_f32 v120, v120, abs(v54)
    v_mul_f32 v121, v121, abs(v55)
    v_cvt_pk_bf16_f32 v53, v120, v121
    v_pk_max_i16 v53, v53, 0
    ds_write_b64 v3, v[52:53] offset:5120
    v_mul_f32 v120, v32, v116
    v_mul_f32 v121, v33, v116
    v_mul_f32 v120, v120, abs(v32)
    v_mul_f32 v121, v121, abs(v33)
    v_cvt_pk_bf16_f32 v32, v120, v121
    v_pk_max_i16 v32, v32, 0
    v_mul_f32 v120, v34, v116
    v_mul_f32 v121, v35, v116
    v_mul_f32 v120, v120, abs(v34)
    v_mul_f32 v121, v121, abs(v35)
    v_cvt_pk_bf16_f32 v33, v120, v121
    v_pk_max_i16 v33, v33, 0
    v_mul_f32 v120, v36, v116
    v_mul_f32 v121, v37, v116
    v_mul_f32 v120, v120, abs(v36)
    v_mul_f32 v121, v121, abs(v37)
    v_cvt_pk_bf16_f32 v34, v120, v121
    v_pk_max_i16 v34, v34, 0
    v_mul_f32 v120, v38, v116
    v_mul_f32 v121, v39, v116
    v_mul_f32 v120, v120, abs(v38)
    v_mul_f32 v121, v121, abs(v39)
    v_cvt_pk_bf16_f32 v35, v120, v121
    v_pk_max_i16 v35, v35, 0
    buffer_store_dwordx4 v[32:35], v1, s[16:19], s44 offen offset:0 sc1
    v_mul_f32 v120, v40, v117
    v_mul_f32 v121, v41, v117
    v_mul_f32 v120, v120, abs(v40)
    s_waitcnt lgkmcnt(0)
    s_barrier
    ds_read_b128 v[48:51], v4 offset:4096
    v_mul_f32 v121, v121, abs(v41)
    v_cvt_pk_bf16_f32 v40, v120, v121
    v_pk_max_i16 v40, v40, 0
    v_mul_f32 v120, v42, v117
    v_mul_f32 v121, v43, v117
    v_mul_f32 v120, v120, abs(v42)
    v_mul_f32 v121, v121, abs(v43)
    v_cvt_pk_bf16_f32 v41, v120, v121
    v_pk_max_i16 v41, v41, 0
    s_waitcnt lgkmcnt(0)
    buffer_store_dwordx4 v[48:51], v1, s[16:19], s49 offen sc1
    v_mul_f32 v120, v44, v117
    v_mul_f32 v121, v45, v117
    v_mul_f32 v120, v120, abs(v44)
    v_mul_f32 v121, v121, abs(v45)
    v_cvt_pk_bf16_f32 v42, v120, v121
    v_pk_max_i16 v42, v42, 0
    v_mul_f32 v120, v46, v117
    v_mul_f32 v121, v47, v117
    v_mul_f32 v120, v120, abs(v46)
    v_mul_f32 v121, v121, abs(v47)
    v_cvt_pk_bf16_f32 v43, v120, v121
    v_pk_max_i16 v43, v43, 0
    buffer_store_dwordx4 v[40:43], v1, s[16:19], s44 offen offset:1024 sc1
    s_waitcnt vmcnt(0)
    s_barrier
    buffer_store_dword v124, v124, s[16:19], s91 offen sc1
    s_add_u32 s91, s91, 65536
    s_waitcnt vmcnt(0)
    s_endpgm
L_spin12:
    s_mov_b32 s40, 0x20000
L_spin12_l:
    buffer_load_dword v56, v124, s[20:23], 0 offen sc1
    s_sub_u32 s40, s40, 1
    s_waitcnt vmcnt(0)
    v_cmp_eq_u32 vcc, v124, v56
    s_cbranch_scc1 L_back13
    s_cbranch_vccz L_back13
    s_sleep 8
    s_branch L_spin12_l
L_spin14:
    s_mov_b32 s40, 0x20000
L_spin14_l:
    buffer_load_dword v7, v5, s[16:19], s45 offen sc1
    s_sub_u32 s40, s40, 1
    s_waitcnt vmcnt(0)
    v_cmp_ne_u32 vcc, 0, v7
    s_cbranch_scc1 L_back15
    s_cbranch_vccz L_back15
    s_sleep 2
    s_branch L_spin14_l
L_spin16:
    s_mov_b32 s40, 0x20000
L_spin16_l:
    buffer_load_dword v7, v5, s[16:19], s45 offen sc1
    s_sub_u32 s40, s40, 1
    s_waitcnt vmcnt(0)
    v_cmp_ne_u32 vcc, 0, v7
    s_cbranch_scc1 L_back17
    s_cbranch_vccz L_back17
    s_sleep 2
    s_branch L_spin16_l
L_sspin18:
    s_mov_b32 s40, 0x20000
L_sspin18_l:
    buffer_load_dwordx2 v[36:37], v6, s[16:19], s46 offen offset:0 sc1
    buffer_load_dwordx2 v[38:39], v6, s[16:19], s46 offen offset:128 sc1
    buffer_load_dwordx2 v[40:41], v6, s[16:19], s46 offen offset:256 sc1
    buffer_load_dwordx2 v[42:43], v6, s[16:19], s46 offen offset:384 sc1
    s_sub_u32 s40, s40, 1
    s_waitcnt vmcnt(0)
    v_max3_u32 v44, v36, v37, v38
    v_max3_u32 v45, v39, v40, v41
    v_max3_u32 v44, v44, v42, v43
    v_max_u32 v44, v44, v45
    v_cmp_eq_u32 vcc, -1, v44
    s_cbranch_scc1 L_sback19
    s_cbranch_vccz L_sback19
    s_sleep 4
    s_branch L_sspin18_l
L_spin20:
    s_mov_b32 s40, 0x20000
L_spin20_l:
    buffer_load_dword v7, v5, s[16:19], s45 offen sc1
    s_sub_u32 s40, s40, 1
    s_waitcnt vmcnt(0)
    v_cmp_ne_u32 vcc, 0, v7
    s_cbranch_scc1 L_back21
    s_cbranch_vccz L_back21
    s_sleep 2
    s_branch L_spin20_l
L_sspin22:
    s_mov_b32 s40, 0x20000
L_sspin22_l:
    buffer_load_dwordx2 v[12:13], v6, s[16:19], s46 offen offset:0 sc1
    buffer_load_dwordx2 v[14:15], v6, s[16:19], s46 offen offset:128 sc1
    buffer_load_dwordx2 v[16:17], v6, s[16:19], s46 offen offset:256 sc1
    buffer_load_dwordx2 v[18:19], v6, s[16:19], s46 offen offset:384 sc1
    s_sub_u32 s40, s40, 1
    s_waitcnt vmcnt(0)
    v_max3_u32 v20, v12, v13, v14
    v_max3_u32 v21, v15, v16, v17
    v_max3_u32 v20, v20, v18, v19
    v_max_u32 v20, v20, v21
    v_cmp_eq_u32 vcc, -1, v20
    s_cbranch_scc1 L_sback23
    s_cbranch_vccz L_sback23
    s_sleep 4
    s_branch L_sspin22_l
L_odd:
    s_mov_b32 s33, s47
    s_lshl2_add_u32 s53, s48, s47
    s_cmp_lt_u32 s48, 8
    s_cselect_b32 s34, 16, 32
    s_add_u32 s34, s34, s48
    s_sub_u32 s37, s48, 8
    s_cmp_lt_u32 s37, 20
    s_cselect_b32 s44, -16, 0
    s_cmp_lt_u32 s37, 4
    s_cselect_b32 s44, 64, s44
    s_add_u32 s44, s44, s53
    s_lshl2_add_u32 s44, s44, s32
    s_lshl_b32 s44, s44, 13
    v_lshlrev_b32 v6, 7, v0
    s_waitcnt lgkmcnt(0)
    s_mov_b32 s12, s66
    s_mov_b32 s13, s67
    s_mov_b32 s14, 0x400000
    s_mov_b32 s15, 0x00020000
    s_mov_b32 s16, s84
    s_mov_b32 s17, s85
    s_mov_b32 s18, 0x5e00000
    s_mov_b32 s19, 0x00020000
    v_min_u32 v124, 1, v0
    v_lshlrev_b32 v124, 30, v124
    s_cmp_lt_u32 s48, 8
    s_cbranch_scc1 L_touch
    s_sub_u32 s37, s48, 12
    s_cmp_lt_u32 s37, 16
    s_cbranch_scc1 L_lines
    s_lshl_b32 s50, s33, 5
    s_or_b32 s37, s48, 16
    s_add_u32 s50, s50, s37
    s_lshl_b32 s46, s50, 15
    s_lshl_b32 s37, s32, 9
    s_add_u32 s46, s46, s37
    v_lshrrev_b32 v48, 3, v0
    v_and_b32 v49, 0x70, v1
    v_lshl_add_u32 v48, v48, 11, v49
    v_add_u32 v49, 16384, v48
    s_mov_b32 s8, s64
    s_mov_b32 s9, s65
    s_mov_b32 s10, 0x400000
    s_mov_b32 s11, 0x00020000
    buffer_load_dwordx4 v[16:19], v48, s[8:11], s46 offen offset:0
    buffer_load_dwordx4 v[20:23], v48, s[8:11], s46 offen offset:128
    buffer_load_dwordx4 v[24:27], v48, s[8:11], s46 offen offset:256
    buffer_load_dwordx4 v[28:31], v48, s[8:11], s46 offen offset:384
    buffer_load_dwordx4 v[32:35], v49, s[8:11], s46 offen offset:0
    buffer_load_dwordx4 v[36:39], v49, s[8:11], s46 offen offset:128
    buffer_load_dwordx4 v[40:43], v49, s[8:11], s46 offen offset:256
    buffer_load_dwordx4 v[44:47], v49, s[8:11], s46 offen offset:384
    s_mov_b32 s86, 0x3f803f80
    v_and_b32 v56, 1, v0
    v_lshlrev_b32 v56, 7, v56
    v_bfe_u32 v57, v0, 1, 1
    v_lshl_add_u32 v56, v57, 6, v56
    v_and_b32 v57, 0x38, v0
    v_add_u32 v56, v57, v56
    s_sub_u32 s46, 127, s50
    s_lshl_b32 s46, s46, 10
    s_lshl_b32 s37, s32, 8
    s_add_u32 s46, s46, s37
    s_add_u32 s46, s46, 0x5400000
    s_waitcnt vmcnt(0)
    v_dot2_f32_bf16 v48, v16, s86, 0
    v_dot2_f32_bf16 v49, v16, v16, 0
    v_dot2_f32_bf16 v50, v24, s86, 0
    v_dot2_f32_bf16 v51, v24, v24, 0
    v_dot2_f32_bf16 v52, v32, s86, 0
    v_dot2_f32_bf16 v53, v32, v32, 0
    v_dot2_f32_bf16 v54, v40, s86, 0
    v_dot2_f32_bf16 v55, v40, v40, 0
    v_dot2_f32_bf16 v48, v17, s86, v48
    v_dot2_f32_bf16 v49, v17, v17, v49
    v_dot2_f32_bf16 v50, v25, s86, v50
    v_dot2_f32_bf16 v51, v25, v25, v51
    v_dot2_f32_bf16 v52, v33, s86, v52
    v_dot2_f32_bf16 v53, v33, v33, v53
    v_dot2_f32_bf16 v54, v41, s86, v54
    v_dot2_f32_bf16 v55, v41, v41, v55
    v_dot2_f32_bf16 v48, v18, s86, v48
    v_dot2_f32_bf16 v49, v18, v18, v49
    v_dot2_f32_bf16 v50, v26, s86, v50
    v_dot2_f32_bf16 v51, v26, v26, v51
    v_dot2_f32_bf16 v52, v34, s86, v52
    v_dot2_f32_bf16 v53, v34, v34, v53
    v_dot2_f32_bf16 v54, v42, s86, v54
    v_dot2_f32_bf16 v55, v42, v42, v55
    v_dot2_f32_bf16 v48, v19, s86, v48
    v_dot2_f32_bf16 v49, v19, v19, v49
    v_dot2_f32_bf16 v50, v27, s86, v50
    v_dot2_f32_bf16 v51, v27, v27, v51
    v_dot2_f32_bf16 v52, v35, s86, v52
    v_dot2_f32_bf16 v53, v35, v35, v53
    v_dot2_f32_bf16 v54, v43, s86, v54
    v_dot2_f32_bf16 v55, v43, v43, v55
    v_dot2_f32_bf16 v48, v20, s86, v48
    v_dot2_f32_bf16 v49, v20, v20, v49
    v_dot2_f32_bf16 v50, v28, s86, v50
    v_dot2_f32_bf16 v51, v28, v28, v51
    v_dot2_f32_bf16 v52, v36, s86, v52
    v_dot2_f32_bf16 v53, v36, v36, v53
    v_dot2_f32_bf16 v54, v44, s86, v54
    v_dot2_f32_bf16 v55, v44, v44, v55
    v_dot2_f32_bf16 v48, v21, s86, v48
    v_dot2_f32_bf16 v49, v21, v21, v49
    v_dot2_f32_bf16 v50, v29, s86, v50
    v_dot2_f32_bf16 v51, v29, v29, v51
    v_dot2_f32_bf16 v52, v37, s86, v52
    v_dot2_f32_bf16 v53, v37, v37, v53
    v_dot2_f32_bf16 v54, v45, s86, v54
    v_dot2_f32_bf16 v55, v45, v45, v55
    v_dot2_f32_bf16 v48, v22, s86, v48
    v_dot2_f32_bf16 v49, v22, v22, v49
    v_dot2_f32_bf16 v50, v30, s86, v50
    v_dot2_f32_bf16 v51, v30, v30, v51
    v_dot2_f32_bf16 v52, v38, s86, v52
    v_dot2_f32_bf16 v53, v38, v38, v53
    v_dot2_f32_bf16 v54, v46, s86, v54
    v_dot2_f32_bf16 v55, v46, v46, v55
    v_dot2_f32_bf16 v48, v23, s86, v48
    v_dot2_f32_bf16 v49, v23, v23, v49
    v_dot2_f32_bf16 v50, v31, s86, v50
    v_dot2_f32_bf16 v51, v31, v31, v51
    v_dot2_f32_bf16 v52, v39, s86, v52
    v_dot2_f32_bf16 v53, v39, v39, v53
    v_dot2_f32_bf16 v54, v47, s86, v54
    v_dot2_f32_bf16 v55, v47, v47, v55
    v_add_f32_dpp v48, v48, v48 quad_perm:[1,0,3,2] row_mask:0xf bank_mask:0xf
    v_add_f32_dpp v49, v49, v49 quad_perm:[1,0,3,2] row_mask:0xf bank_mask:0xf
    v_add_f32_dpp v50, v50, v50 quad_perm:[1,0,3,2] row_mask:0xf bank_mask:0xf
    v_add_f32_dpp v51, v51, v51 quad_perm:[1,0,3,2] row_mask:0xf bank_mask:0xf
    v_add_f32_dpp v52, v52, v52 quad_perm:[1,0,3,2] row_mask:0xf bank_mask:0xf
    v_add_f32_dpp v53, v53, v53 quad_perm:[1,0,3,2] row_mask:0xf bank_mask:0xf
    v_add_f32_dpp v54, v54, v54 quad_perm:[1,0,3,2] row_mask:0xf bank_mask:0xf
    v_add_f32_dpp v55, v55, v55 quad_perm:[1,0,3,2] row_mask:0xf bank_mask:0xf
    v_add_f32_dpp v48, v48, v48 quad_perm:[2,3,0,1] row_mask:0xf bank_mask:0xf
    v_add_f32_dpp v49, v49, v49 quad_perm:[2,3,0,1] row_mask:0xf bank_mask:0xf
    v_add_f32_dpp v50, v50, v50 quad_perm:[2,3,0,1] row_mask:0xf bank_mask:0xf
    v_add_f32_dpp v51, v51, v51 quad_perm:[2,3,0,1] row_mask:0xf bank_mask:0xf
    v_add_f32_dpp v52, v52, v52 quad_perm:[2,3,0,1] row_mask:0xf bank_mask:0xf
    v_add_f32_dpp v53, v53, v53 quad_perm:[2,3,0,1] row_mask:0xf bank_mask:0xf
    v_add_f32_dpp v54, v54, v54 quad_perm:[2,3,0,1] row_mask:0xf bank_mask:0xf
    v_add_f32_dpp v55, v55, v55 quad_perm:[2,3,0,1] row_mask:0xf bank_mask:0xf
    v_add_f32_dpp v48, v48, v48 row_half_mirror row_mask:0xf bank_mask:0xf
    v_add_f32_dpp v49, v49, v49 row_half_mirror row_mask:0xf bank_mask:0xf
    v_add_f32_dpp v50, v50, v50 row_half_mirror row_mask:0xf bank_mask:0xf
    v_add_f32_dpp v51, v51, v51 row_half_mirror row_mask:0xf bank_mask:0xf
    v_add_f32_dpp v52, v52, v52 row_half_mirror row_mask:0xf bank_mask:0xf
    v_add_f32_dpp v53, v53, v53 row_half_mirror row_mask:0xf bank_mask:0xf
    v_add_f32_dpp v54, v54, v54 row_half_mirror row_mask:0xf bank_mask:0xf
    v_add_f32_dpp v55, v55, v55 row_half_mirror row_mask:0xf bank_mask:0xf
    s_mov_b32 exec_lo, 0x2020202
    s_mov_b32 exec_hi, 0x2020202
    v_mov_b32 v48, v50
    v_mov_b32 v49, v51
    s_mov_b32 exec_lo, 0x4040404
    s_mov_b32 exec_hi, 0x4040404
    v_mov_b32 v48, v52
    v_mov_b32 v49, v53
    s_mov_b32 exec_lo, 0x8080808
    s_mov_b32 exec_hi, 0x8080808
    v_mov_b32 v48, v54
    v_mov_b32 v49, v55
    s_mov_b32 exec_lo, 0x0f0f0f0f
    s_mov_b32 exec_hi, 0x0f0f0f0f
    buffer_store_dwordx2 v[48:49], v56, s[16:19], s46 offen sc1
    s_mov_b64 exec, -1
    s_mov_b32 s38, 64
    s_mov_b32 s39, 31
    s_waitcnt vmcnt(0)
    s_branch L_job_end
L_lines:
    buffer_load_dword v248, v6, s[12:15], s44 offen
    s_mov_b32 s12, s68
    s_mov_b32 s13, s69
    s_mov_b32 s14, 0x200000
    s_mov_b32 s15, 0x00020000
    s_sub_u32 s39, 0x180, s12
    s_and_b32 s39, s39, 0x380
    s_sub_u32 s37, s48, 12
    s_lshl2_add_u32 s37, s37, s32
    s_lshl_b32 s37, s37, 15
    s_add_u32 s39, s39, s37
    v_and_b32 v7, 31, v0
    v_lshlrev_b32 v7, 10, v7
    buffer_load_dword v247, v7, s[12:15], s39 offen
    s_mov_b32 s14, 0
    s_sub_u32 s53, s53, 48
    s_and_b32 s37, s53, 7
    s_cmp_lt_u32 s37, 2
    s_cselect_b32 s87, 2, 3
    s_cselect_b32 s36, 34, 32
    s_cmp_ge_u32 s53, 32
    s_cselect_b32 s87, 2, s87
    s_cselect_b32 s36, 35, s36
    s_cselect_b32 s38, 5, 0
    s_cmp_lt_u32 s37, s38
    s_cselect_b32 s37, 0x5e00000, 0
    s_lshl_b32 s38, s53, 10
    s_add_u32 s37, s37, s38
    s_lshl_b32 s38, s32, 16
    s_add_u32 s37, s37, s38
    s_add_u32 s37, s37, 0x5500000
    s_sub_u32 s87, s32, s87
    s_cmp_lt_u32 s87, s36
    s_cselect_b32 s38, -1, 0
    v_mov_b32 v16, s38
    s_add_u32 s87, s87, 4
    buffer_store_dwordx4 v[16:19], v1, s[16:19], s37 offen sc1
    s_add_u32 s37, s37, 262144
    s_cmp_lt_u32 s87, s36
    s_cselect_b32 s38, -1, 0
    v_mov_b32 v20, s38
    s_add_u32 s87, s87, 4
    buffer_store_dwordx4 v[20:23], v1, s[16:19], s37 offen sc1
    s_add_u32 s37, s37, 262144
    s_cmp_lt_u32 s87, s36
    s_cselect_b32 s38, -1, 0
    v_mov_b32 v24, s38
    s_add_u32 s87, s87, 4
    buffer_store_dwordx4 v[24:27], v1, s[16:19], s37 offen sc1
    s_add_u32 s37, s37, 262144
    s_cmp_lt_u32 s87, s36
    s_cselect_b32 s38, -1, 0
    v_mov_b32 v28, s38
    s_add_u32 s87, s87, 4
    buffer_store_dwordx4 v[28:31], v1, s[16:19], s37 offen sc1
    s_add_u32 s37, s37, 262144
    s_cmp_lt_u32 s87, s36
    s_cselect_b32 s38, -1, 0
    v_mov_b32 v32, s38
    s_add_u32 s87, s87, 4
    buffer_store_dwordx4 v[32:35], v1, s[16:19], s37 offen sc1
    s_add_u32 s37, s37, 262144
    s_cmp_lt_u32 s87, s36
    s_cselect_b32 s38, -1, 0
    v_mov_b32 v36, s38
    s_add_u32 s87, s87, 4
    buffer_store_dwordx4 v[36:39], v1, s[16:19], s37 offen sc1
    s_add_u32 s37, s37, 262144
    s_cmp_lt_u32 s87, s36
    s_cselect_b32 s38, -1, 0
    v_mov_b32 v40, s38
    s_add_u32 s87, s87, 4
    buffer_store_dwordx4 v[40:43], v1, s[16:19], s37 offen sc1
    s_add_u32 s37, s37, 262144
    s_cmp_lt_u32 s87, s36
    s_cselect_b32 s38, -1, 0
    v_mov_b32 v44, s38
    s_add_u32 s87, s87, 4
    buffer_store_dwordx4 v[44:47], v1, s[16:19], s37 offen sc1
    s_add_u32 s37, s37, 262144
    s_cmp_lt_u32 s87, s36
    s_cselect_b32 s38, -1, 0
    v_mov_b32 v48, s38
    s_add_u32 s87, s87, 4
    buffer_store_dwordx4 v[48:51], v1, s[16:19], s37 offen sc1
    s_add_u32 s37, s37, 262144
    s_cmp_lt_u32 s87, s36
    s_cselect_b32 s38, -1, 0
    v_mov_b32 v52, s38
    s_add_u32 s87, s87, 4
    buffer_store_dwordx4 v[52:55], v1, s[16:19], s37 offen sc1
    s_add_u32 s37, s37, 262144
    v_mov_b32 v8, -1
    v_mov_b32 v9, -1
    v_mov_b32 v10, -1
    v_mov_b32 v11, -1
    s_lshl2_add_u32 s38, s53, s32
    s_lshl_b32 s38, s38, 10
    s_add_u32 s38, s38, 0x5440000
    buffer_store_dwordx4 v[8:11], v1, s[16:19], s38 offen sc1
    s_mov_b32 s38, 0
    s_mov_b32 s39, 63
    s_waitcnt vmcnt(0)
L_job_end:
    s_mov_b32 s8, s82
    s_mov_b32 s9, s83
    s_mov_b32 s10, 0x100
    s_mov_b32 s11, 0x00020000
    v_mov_b32 v123, 1
    s_barrier
    s_cmp_lg_u32 s32, 3
    s_cbranch_scc1 L_arr24
    buffer_atomic_add v123, v124, s[8:11], s38 offen sc0
    s_waitcnt vmcnt(0)
    v_readfirstlane_b32 s37, v123
    s_nop 0
    s_cmp_lg_u32 s37, s39
    s_cbranch_scc1 L_arr24
    buffer_store_dword v123, v124, s[8:11], s38 offen offset:128 sc1
L_arr24:
L_touch:
    buffer_load_dword v248, v6, s[12:15], s44 offen
    s_lshl_b32 s91, s33, 6
    s_add_u32 s91, s91, s34
    s_lshl_b32 s91, s91, 7
    s_add_u32 s91, s91, 0x5520000
    s_cmp_eq_u32 s32, 1
    s_cselect_b32 s91, s91, 0x5f00000
    s_cmp_ge_u32 s34, 60
    s_cbranch_scc1 L_role_60
    s_cmp_ge_u32 s34, 44
    s_cbranch_scc1 L_role_44
    s_cmp_ge_u32 s34, 40
    s_cbranch_scc1 L_role_40
L_role_16:
    s_sub_u32 s35, s34, 16
    s_lshl_b32 s54, s35, 8
    s_mov_b32 s12, s68
    s_mov_b32 s13, s69
    s_mov_b32 s14, 0x200000
    s_mov_b32 s15, 0x00020000
    s_mov_b32 s39, 2048
    v_lshrrev_b32 v52, 3, v0
    v_lshlrev_b32 v53, 2, v0
    v_and_b32 v53, 64, v53
    v_and_b32 v54, 0x70, v1
    v_xor_b32 v53, v53, v54
    v_mad_u32_u24 v44, v52, s39, v53
    v_add_u32 v45, 16384, v44
    v_add_u32 v46, 128, v44
    v_add_u32 v47, 16512, v44
    s_mul_i32 s38, s32, 32768
    s_add_u32 s54, s54, s38
    s_lshl_b32 s42, s32, 11
    s_add_u32 m0, s42, 0
    s_nop 0
    buffer_load_dwordx4 v44, s[12:15], s54 offen lds
    s_add_u32 m0, s42, 1024
    s_nop 0
    buffer_load_dwordx4 v45, s[12:15], s54 offen lds
    s_add_u32 m0, s42, 8192
    s_nop 0
    buffer_load_dwordx4 v46, s[12:15], s54 offen lds
    s_add_u32 m0, s42, 9216
    s_nop 0
    buffer_load_dwordx4 v47, s[12:15], s54 offen lds
    s_add_u32 s54, s54, 131072
    s_add_u32 m0, s42, 16384
    s_nop 0
    buffer_load_dwordx4 v44, s[12:15], s54 offen lds
    s_add_u32 m0, s42, 17408
    s_nop 0
    buffer_load_dwordx4 v45, s[12:15], s54 offen lds
    s_add_u32 m0, s42, 24576
    s_nop 0
    buffer_load_dwordx4 v46, s[12:15], s54 offen lds
    s_add_u32 m0, s42, 25600
    s_nop 0
    buffer_load_dwordx4 v47, s[12:15], s54 offen lds
    s_add_u32 s54, s54, 131072
    s_add_u32 m0, s42, 32768
    s_nop 0
    buffer_load_dwordx4 v44, s[12:15], s54 offen lds
    s_add_u32 m0, s42, 33792
    s_nop 0
    buffer_load_dwordx4 v45, s[12:15], s54 offen lds
    s_add_u32 m0, s42, 40960
    s_nop 0
    buffer_load_dwordx4 v46, s[12:15], s54 offen lds
    s_add_u32 m0, s42, 41984
    s_nop 0
    buffer_load_dwordx4 v47, s[12:15], s54 offen lds
    s_add_u32 s54, s54, 131072
    s_add_u32 m0, s42, 49152
    s_nop 0
    buffer_load_dwordx4 v44, s[12:15], s54 offen lds
    s_add_u32 m0, s42, 50176
    s_nop 0
    buffer_load_dwordx4 v45, s[12:15], s54 offen lds
    s_add_u32 m0, s42, 57344
    s_nop 0
    buffer_load_dwordx4 v46, s[12:15], s54 offen lds
    s_add_u32 m0, s42, 58368
    s_nop 0
    buffer_load_dwordx4 v47, s[12:15], s54 offen lds
    s_add_u32 s54, s54, 131072
    s_add_u32 m0, s42, 65536
    s_nop 0
    buffer_load_dwordx4 v44, s[12:15], s54 offen lds
    s_add_u32 m0, s42, 66560
    s_nop 0
    buffer_load_dwordx4 v45, s[12:15], s54 offen lds
    s_add_u32 m0, s42, 73728
    s_nop 0
    buffer_load_dwordx4 v46, s[12:15], s54 offen lds
    s_add_u32 m0, s42, 74752
    s_nop 0
    buffer_load_dwordx4 v47, s[12:15], s54 offen lds
    s_add_u32 s54, s54, 131072
    v_lshrrev_b32 v52, 4, v0
    v_bfe_u32 v53, v0, 2, 2
    v_lshl_add_u32 v52, v52, 3, v53
    v_lshlrev_b32 v52, 7, v52
    v_lshrrev_b32 v53, 1, v53
    v_lshl_add_u32 v52, v53, 6, v52
    v_and_b32 v53, 3, v0
    v_lshl_add_u32 v52, v53, 4, v52
    s_lshr_b32 s37, s32, 1
    s_lshl_b32 s37, s37, 13
    s_and_b32 s38, s32, 1
    s_lshl_b32 s38, s38, 6
    s_add_u32 s37, s37, s38
    s_add_u32 s37, s37, 0
    v_xor_b32 v48, s37, v52
    s_lshr_b32 s37, s32, 1
    s_lshl_b32 s37, s37, 13
    s_and_b32 s38, s32, 1
    s_lshl_b32 s38, s38, 6
    s_add_u32 s37, s37, s38
    s_add_u32 s37, s37, 8
    v_xor_b32 v49, s37, v52
    v_add_u32 v2, 98304, v1
    v_mov_b32 v108, 0
    v_mov_b32 v109, 0
    v_mov_b32 v110, 0
    v_mov_b32 v111, 0
    v_mov_b32 v112, 0
    v_mov_b32 v113, 0
    v_mov_b32 v114, 0
    v_mov_b32 v115, 0
    v_mov_b32 v13, 0x3f80
    v_and_b32 v12, 1, v0
    v_lshlrev_b32 v12, 4, v12
    v_lshlrev_b32 v12, v12, v13
    s_mov_b32 exec_lo, 0x300003
    s_mov_b32 exec_hi, 0x30000300
    v_mov_b32 v108, v12
    v_mov_b32 v114, v12
    s_mov_b32 exec_lo, 0xc0000c
    s_mov_b32 exec_hi, 0xc0000c00
    v_mov_b32 v109, v12
    v_mov_b32 v115, v12
    s_mov_b64 exec, -1
    s_lshl_b32 s37, s33, 6
    s_add_u32 s37, s37, 0
    s_lshl_b32 s37, s37, 7
    v_lshl_add_u32 v4, v0, 7, s37
    s_cmp_eq_u32 s32, 0
    s_cselect_b32 s37, 16, 0
    v_cmp_le_u32 vcc, s37, v0
    s_nop 1
    v_cndmask_b32 v4, v4, 2.0, vcc
    s_mov_b32 s86, 0x3f803f80
    s_lshl_b32 s43, s32, 12
    s_mul_i32 s41, s33, 2097152
    s_add_u32 s41, s41, 0x0
    s_add_u32 s41, s41, s43
    s_lshl_b32 s38, s35, 2
    s_add_u32 s38, s38, s32
    s_mul_i32 s90, s33, 2097152
    s_add_u32 s90, s90, 0x7f0000
    s_lshl_b32 s37, s38, 11
    s_add_u32 s90, s90, s37
    v_and_b32 v12, 15, v0
    v_and_b32 v13, 0x30, v0
    v_lshl_add_u32 v3, v12, 11, v13
    s_lshl_b32 s37, s38, 6
    v_add_u32 v3, s37, v3
    s_lshl_b32 s50, s33, 20
    s_add_u32 s50, s50, 983040
    s_add_u32 s88, s84, 0x5000000
    s_addc_u32 s89, s85, 0
    s_mov_b32 s8, s64
    s_mov_b32 s9, s65
    s_mov_b32 s10, 0x400000
    s_mov_b32 s11, 0x00020000
    v_bfe_u32 v13, v0, 4, 1
    v_lshl_add_u32 v12, v12, 1, v13
    s_lshl_b32 s37, s32, 2
    s_add_u32 s37, s37, 65536
    v_lshl_add_u32 v6, v12, 4, s37
    v_add_u32 v7, 65536, v1
    v_and_b32 v12, 31, v0
    v_lshrrev_b32 v13, 5, v0
    v_lshlrev_b32 v12, 2, v12
    v_lshl_add_u32 v8, v13, 10, v12
    s_mul_i32 s46, s33, 65536
    s_add_u32 s46, s46, 0x543f800
    s_lshl_b32 s37, s35, 7
    s_add_u32 s46, s46, s37
    s_cmp_eq_u32 s32, 2
    s_cselect_b32 s46, s46, 0x5f00000
    s_mov_b32 s36, -1
    v_add_u32 v50, 0, v48
    v_add_u32 v51, 0, v49
    s_waitcnt vmcnt(16)
    s_barrier
    ds_read_b64_tr_b16 a[0:1], v50 offset:0
    ds_read_b64_tr_b16 a[2:3], v50 offset:512
    ds_read_b64_tr_b16 a[4:5], v51 offset:0
    ds_read_b64_tr_b16 a[6:7], v51 offset:512
    ds_read_b64_tr_b16 a[8:9], v50 offset:4096
    ds_read_b64_tr_b16 a[10:11], v50 offset:4608
    ds_read_b64_tr_b16 a[12:13], v51 offset:4096
    ds_read_b64_tr_b16 a[14:15], v51 offset:4608
    s_add_u32 m0, s42, 81920
    s_nop 0
    buffer_load_dwordx4 v44, s[12:15], s54 offen lds
    s_add_u32 m0, s42, 82944
    s_nop 0
    buffer_load_dwordx4 v45, s[12:15], s54 offen lds
    s_add_u32 m0, s42, 90112
    s_nop 0
    buffer_load_dwordx4 v46, s[12:15], s54 offen lds
    s_add_u32 m0, s42, 91136
    s_nop 0
    buffer_load_dwordx4 v47, s[12:15], s54 offen lds
    s_add_u32 s54, s54, 131072
    s_waitcnt lgkmcnt(0)
    v_add_u32 v50, 16384, v48
    v_add_u32 v51, 16384, v49
    s_waitcnt vmcnt(16)
    s_barrier
    ds_read_b64_tr_b16 a[16:17], v50 offset:0
    ds_read_b64_tr_b16 a[18:19], v50 offset:512
    ds_read_b64_tr_b16 a[20:21], v51 offset:0
    ds_read_b64_tr_b16 a[22:23], v51 offset:512
    ds_read_b64_tr_b16 a[24:25], v50 offset:4096
    ds_read_b64_tr_b16 a[26:27], v50 offset:4608
    ds_read_b64_tr_b16 a[28:29], v51 offset:4096
    ds_read_b64_tr_b16 a[30:31], v51 offset:4608
    s_add_u32 m0, s42, 0
    s_nop 0
    buffer_load_dwordx4 v44, s[12:15], s54 offen lds
    s_add_u32 m0, s42, 1024
    s_nop 0
    buffer_load_dwordx4 v45, s[12:15], s54 offen lds
    s_add_u32 m0, s42, 8192
    s_nop 0
    buffer_load_dwordx4 v46, s[12:15], s54 offen lds
    s_add_u32 m0, s42, 9216
    s_nop 0
    buffer_load_dwordx4 v47, s[12:15], s54 offen lds
    s_add_u32 s54, s54, 131072
    s_waitcnt lgkmcnt(0)
    v_add_u32 v50, 32768, v48
    v_add_u32 v51, 32768, v49
    s_waitcnt vmcnt(16)
    s_barrier
    ds_read_b64_tr_b16 a[32:33], v50 offset:0
    ds_read_b64_tr_b16 a[34:35], v50 offset:512
    ds_read_b64_tr_b16 a[36:37], v51 offset:0
    ds_read_b64_tr_b16 a[38:39], v51 offset:512
    ds_read_b64_tr_b16 a[40:41], v50 offset:4096
    ds_read_b64_tr_b16 a[42:43], v50 offset:4608
    ds_read_b64_tr_b16 a[44:45], v51 offset:4096
    ds_read_b64_tr_b16 a[46:47], v51 offset:4608
    s_add_u32 m0, s42, 16384
    s_nop 0
    buffer_load_dwordx4 v44, s[12:15], s54 offen lds
    s_add_u32 m0, s42, 17408
    s_nop 0
    buffer_load_dwordx4 v45, s[12:15], s54 offen lds
    s_add_u32 m0, s42, 24576
    s_nop 0
    buffer_load_dwordx4 v46, s[12:15], s54 offen lds
    s_add_u32 m0, s42, 25600
    s_nop 0
    buffer_load_dwordx4 v47, s[12:15], s54 offen lds
    s_add_u32 s54, s54, 131072
    s_waitcnt lgkmcnt(0)
    v_add_u32 v50, 49152, v48
    v_add_u32 v51, 49152, v49
    s_waitcnt vmcnt(16)
    s_barrier
    ds_read_b64_tr_b16 a[48:49], v50 offset:0
    ds_read_b64_tr_b16 a[50:51], v50 offset:512
    ds_read_b64_tr_b16 a[52:53], v51 offset:0
    ds_read_b64_tr_b16 a[54:55], v51 offset:512
    ds_read_b64_tr_b16 a[56:57], v50 offset:4096
    ds_read_b64_tr_b16 a[58:59], v50 offset:4608
    ds_read_b64_tr_b16 a[60:61], v51 offset:4096
    ds_read_b64_tr_b16 a[62:63], v51 offset:4608
    s_add_u32 m0, s42, 32768
    s_nop 0
    buffer_load_dwordx4 v44, s[12:15], s54 offen lds
    s_add_u32 m0, s42, 33792
    s_nop 0
    buffer_load_dwordx4 v45, s[12:15], s54 offen lds
    s_add_u32 m0, s42, 40960
    s_nop 0
    buffer_load_dwordx4 v46, s[12:15], s54 offen lds
    s_add_u32 m0, s42, 41984
    s_nop 0
    buffer_load_dwordx4 v47, s[12:15], s54 offen lds
    s_add_u32 s54, s54, 131072
    s_waitcnt lgkmcnt(0)
    v_add_u32 v50, 65536, v48
    v_add_u32 v51, 65536, v49
    s_waitcnt vmcnt(16)
    s_barrier
    ds_read_b64_tr_b16 a[64:65], v50 offset:0
    ds_read_b64_tr_b16 a[66:67], v50 offset:512
    ds_read_b64_tr_b16 a[68:69], v51 offset:0
    ds_read_b64_tr_b16 a[70:71], v51 offset:512
    ds_read_b64_tr_b16 a[72:73], v50 offset:4096
    ds_read_b64_tr_b16 a[74:75], v50 offset:4608
    ds_read_b64_tr_b16 a[76:77], v51 offset:4096
    ds_read_b64_tr_b16 a[78:79], v51 offset:4608
    s_add_u32 m0, s42, 49152
    s_nop 0
    buffer_load_dwordx4 v44, s[12:15], s54 offen lds
    s_add_u32 m0, s42, 50176
    s_nop 0
    buffer_load_dwordx4 v45, s[12:15], s54 offen lds
    s_add_u32 m0, s42, 57344
    s_nop 0
    buffer_load_dwordx4 v46, s[12:15], s54 offen lds
    s_add_u32 m0, s42, 58368
    s_nop 0
    buffer_load_dwordx4 v47, s[12:15], s54 offen lds
    s_add_u32 s54, s54, 131072
    s_waitcnt lgkmcnt(0)
    v_add_u32 v50, 81920, v48
    v_add_u32 v51, 81920, v49
    s_waitcnt vmcnt(16)
    s_barrier
    ds_read_b64_tr_b16 a[80:81], v50 offset:0
    ds_read_b64_tr_b16 a[82:83], v50 offset:512
    ds_read_b64_tr_b16 a[84:85], v51 offset:0
    ds_read_b64_tr_b16 a[86:87], v51 offset:512
    ds_read_b64_tr_b16 a[88:89], v50 offset:4096
    ds_read_b64_tr_b16 a[90:91], v50 offset:4608
    ds_read_b64_tr_b16 a[92:93], v51 offset:4096
    ds_read_b64_tr_b16 a[94:95], v51 offset:4608
    s_add_u32 m0, s42, 65536
    s_nop 0
    buffer_load_dwordx4 v44, s[12:15], s54 offen lds
    s_add_u32 m0, s42, 66560
    s_nop 0
    buffer_load_dwordx4 v45, s[12:15], s54 offen lds
    s_add_u32 m0, s42, 73728
    s_nop 0
    buffer_load_dwordx4 v46, s[12:15], s54 offen lds
    s_add_u32 m0, s42, 74752
    s_nop 0
    buffer_load_dwordx4 v47, s[12:15], s54 offen lds
    s_add_u32 s54, s54, 131072
    s_waitcnt lgkmcnt(0)
    v_add_u32 v50, 0, v48
    v_add_u32 v51, 0, v49
    s_waitcnt vmcnt(16)
    s_barrier
    ds_read_b64_tr_b16 a[96:97], v50 offset:0
    ds_read_b64_tr_b16 a[98:99], v50 offset:512
    ds_read_b64_tr_b16 a[100:101], v51 offset:0
    ds_read_b64_tr_b16 a[102:103], v51 offset:512
    ds_read_b64_tr_b16 a[104:105], v50 offset:4096
    ds_read_b64_tr_b16 a[106:107], v50 offset:4608
    ds_read_b64_tr_b16 a[108:109], v51 offset:4096
    ds_read_b64_tr_b16 a[110:111], v51 offset:4608
    s_add_u32 m0, s42, 81920
    s_nop 0
    buffer_load_dwordx4 v44, s[12:15], s54 offen lds
    s_add_u32 m0, s42, 82944
    s_nop 0
    buffer_load_dwordx4 v45, s[12:15], s54 offen lds
    s_add_u32 m0, s42, 90112
    s_nop 0
    buffer_load_dwordx4 v46, s[12:15], s54 offen lds
    s_add_u32 m0, s42, 91136
    s_nop 0
    buffer_load_dwordx4 v47, s[12:15], s54 offen lds
    s_add_u32 s54, s54, 131072
    s_waitcnt lgkmcnt(0)
    v_add_u32 v50, 16384, v48
    v_add_u32 v51, 16384, v49
    s_waitcnt vmcnt(16)
    s_barrier
    ds_read_b64_tr_b16 a[112:113], v50 offset:0
    ds_read_b64_tr_b16 a[114:115], v50 offset:512
    ds_read_b64_tr_b16 a[116:117], v51 offset:0
    ds_read_b64_tr_b16 a[118:119], v51 offset:512
    ds_read_b64_tr_b16 a[120:121], v50 offset:4096
    ds_read_b64_tr_b16 a[122:123], v50 offset:4608
    ds_read_b64_tr_b16 a[124:125], v51 offset:4096
    ds_read_b64_tr_b16 a[126:127], v51 offset:4608
    s_add_u32 m0, s42, 0
    s_nop 0
    buffer_load_dwordx4 v44, s[12:15], s54 offen lds
    s_add_u32 m0, s42, 1024
    s_nop 0
    buffer_load_dwordx4 v45, s[12:15], s54 offen lds
    s_add_u32 m0, s42, 8192
    s_nop 0
    buffer_load_dwordx4 v46, s[12:15], s54 offen lds
    s_add_u32 m0, s42, 9216
    s_nop 0
    buffer_load_dwordx4 v47, s[12:15], s54 offen lds
    s_add_u32 s54, s54, 131072
    s_waitcnt lgkmcnt(0)
    v_add_u32 v50, 32768, v48
    v_add_u32 v51, 32768, v49
    s_waitcnt vmcnt(16)
    s_barrier
    ds_read_b64_tr_b16 a[128:129], v50 offset:0
    ds_read_b64_tr_b16 a[130:131], v50 offset:512
    ds_read_b64_tr_b16 a[132:133], v51 offset:0
    ds_read_b64_tr_b16 a[134:135], v51 offset:512
    ds_read_b64_tr_b16 a[136:137], v50 offset:4096
    ds_read_b64_tr_b16 a[138:139], v50 offset:4608
    ds_read_b64_tr_b16 a[140:141], v51 offset:4096
    ds_read_b64_tr_b16 a[142:143], v51 offset:4608
    s_add_u32 m0, s42, 16384
    s_nop 0
    buffer_load_dwordx4 v44, s[12:15], s54 offen lds
    s_add_u32 m0, s42, 17408
    s_nop 0
    buffer_load_dwordx4 v45, s[12:15], s54 offen lds
    s_add_u32 m0, s42, 24576
    s_nop 0
    buffer_load_dwordx4 v46, s[12:15], s54 offen lds
    s_add_u32 m0, s42, 25600
    s_nop 0
    buffer_load_dwordx4 v47, s[12:15], s54 offen lds
    s_add_u32 s54, s54, 131072
    s_waitcnt lgkmcnt(0)
    v_add_u32 v50, 49152, v48
    v_add_u32 v51, 49152, v49
    s_waitcnt vmcnt(16)
    s_barrier
    ds_read_b64_tr_b16 a[144:145], v50 offset:0
    ds_read_b64_tr_b16 a[146:147], v50 offset:512
    ds_read_b64_tr_b16 a[148:149], v51 offset:0
    ds_read_b64_tr_b16 a[150:151], v51 offset:512
    ds_read_b64_tr_b16 a[152:153], v50 offset:4096
    ds_read_b64_tr_b16 a[154:155], v50 offset:4608
    ds_read_b64_tr_b16 a[156:157], v51 offset:4096
    ds_read_b64_tr_b16 a[158:159], v51 offset:4608
    s_add_u32 m0, s42, 32768
    s_nop 0
    buffer_load_dwordx4 v44, s[12:15], s54 offen lds
    s_add_u32 m0, s42, 33792
    s_nop 0
    buffer_load_dwordx4 v45, s[12:15], s54 offen lds
    s_add_u32 m0, s42, 40960
    s_nop 0
    buffer_load_dwordx4 v46, s[12:15], s54 offen lds
    s_add_u32 m0, s42, 41984
    s_nop 0
    buffer_load_dwordx4 v47, s[12:15], s54 offen lds
    s_add_u32 s54, s54, 131072
    s_waitcnt lgkmcnt(0)
    v_add_u32 v50, 65536, v48
    v_add_u32 v51, 65536, v49
    s_waitcnt vmcnt(16)
    s_barrier
    ds_read_b64_tr_b16 a[160:161], v50 offset:0
    ds_read_b64_tr_b16 a[162:163], v50 offset:512
    ds_read_b64_tr_b16 a[164:165], v51 offset:0
    ds_read_b64_tr_b16 a[166:167], v51 offset:512
    ds_read_b64_tr_b16 a[168:169], v50 offset:4096
    ds_read_b64_tr_b16 a[170:171], v50 offset:4608
    ds_read_b64_tr_b16 a[172:173], v51 offset:4096
    ds_read_b64_tr_b16 a[174:175], v51 offset:4608
    s_add_u32 m0, s42, 49152
    s_nop 0
    buffer_load_dwordx4 v44, s[12:15], s54 offen lds
    s_add_u32 m0, s42, 50176
    s_nop 0
    buffer_load_dwordx4 v45, s[12:15], s54 offen lds
    s_add_u32 m0, s42, 57344
    s_nop 0
    buffer_load_dwordx4 v46, s[12:15], s54 offen lds
    s_add_u32 m0, s42, 58368
    s_nop 0
    buffer_load_dwordx4 v47, s[12:15], s54 offen lds
    s_add_u32 s54, s54, 131072
    s_waitcnt lgkmcnt(0)
    v_add_u32 v50, 81920, v48
    v_add_u32 v51, 81920, v49
    s_waitcnt vmcnt(16)
    s_barrier
    ds_read_b64_tr_b16 a[176:177], v50 offset:0
    ds_read_b64_tr_b16 a[178:179], v50 offset:512
    ds_read_b64_tr_b16 a[180:181], v51 offset:0
    ds_read_b64_tr_b16 a[182:183], v51 offset:512
    ds_read_b64_tr_b16 a[184:185], v50 offset:4096
    ds_read_b64_tr_b16 a[186:187], v50 offset:4608
    ds_read_b64_tr_b16 a[188:189], v51 offset:4096
    ds_read_b64_tr_b16 a[190:191], v51 offset:4608
    s_waitcnt lgkmcnt(0)
    v_add_u32 v50, 0, v48
    v_add_u32 v51, 0, v49
    s_waitcnt vmcnt(12)
    s_barrier
    ds_read_b64_tr_b16 a[192:193], v50 offset:0
    ds_read_b64_tr_b16 a[194:195], v50 offset:512
    ds_read_b64_tr_b16 a[196:197], v51 offset:0
    ds_read_b64_tr_b16 a[198:199], v51 offset:512
    ds_read_b64_tr_b16 a[200:201], v50 offset:4096
    ds_read_b64_tr_b16 a[202:203], v50 offset:4608
    ds_read_b64_tr_b16 a[204:205], v51 offset:4096
    ds_read_b64_tr_b16 a[206:207], v51 offset:4608
    s_waitcnt lgkmcnt(0)
    v_add_u32 v50, 16384, v48
    v_add_u32 v51, 16384, v49
    s_waitcnt vmcnt(8)
    s_barrier
    ds_read_b64_tr_b16 a[208:209], v50 offset:0
    ds_read_b64_tr_b16 a[210:211], v50 offset:512
    ds_read_b64_tr_b16 a[212:213], v51 offset:0
    ds_read_b64_tr_b16 a[214:215], v51 offset:512
    ds_read_b64_tr_b16 a[216:217], v50 offset:4096
    ds_read_b64_tr_b16 a[218:219], v50 offset:4608
    ds_read_b64_tr_b16 a[220:221], v51 offset:4096
    ds_read_b64_tr_b16 a[222:223], v51 offset:4608
    s_waitcnt lgkmcnt(0)
    v_add_u32 v50, 32768, v48
    v_add_u32 v51, 32768, v49
    s_waitcnt vmcnt(4)
    s_barrier
    ds_read_b64_tr_b16 a[224:225], v50 offset:0
    ds_read_b64_tr_b16 a[226:227], v50 offset:512
    ds_read_b64_tr_b16 a[228:229], v51 offset:0
    ds_read_b64_tr_b16 a[230:231], v51 offset:512
    ds_read_b64_tr_b16 a[232:233], v50 offset:4096
    ds_read_b64_tr_b16 a[234:235], v50 offset:4608
    ds_read_b64_tr_b16 a[236:237], v51 offset:4096
    ds_read_b64_tr_b16 a[238:239], v51 offset:4608
    s_waitcnt lgkmcnt(0)
    v_add_u32 v50, 49152, v48
    v_add_u32 v51, 49152, v49
    s_waitcnt vmcnt(0)
    s_barrier
    ds_read_b64_tr_b16 a[240:241], v50 offset:0
    ds_read_b64_tr_b16 a[242:243], v50 offset:512
    ds_read_b64_tr_b16 a[244:245], v51 offset:0
    ds_read_b64_tr_b16 a[246:247], v51 offset:512
    ds_read_b64_tr_b16 a[248:249], v50 offset:4096
    ds_read_b64_tr_b16 a[250:251], v50 offset:4608
    ds_read_b64_tr_b16 a[252:253], v51 offset:4096
    ds_read_b64_tr_b16 a[254:255], v51 offset:4608
    s_waitcnt lgkmcnt(0)
    s_barrier
    s_cmp_lg_u32 s32, 0
    s_cbranch_scc1 L_arv25
    s_add_u32 s20, s82, 0x80
    s_addc_u32 s21, s83, 0
    s_mov_b32 s22, 0x4
    s_mov_b32 s23, 0x00020000
    buffer_load_dword v12, v124, s[20:23], 0 offen sc1
    s_waitcnt vmcnt(0)
    v_cmp_eq_u32 vcc, v124, v12
    s_cbranch_vccnz L_spin26
L_back27:
L_arv25:
    s_add_u32 s47, s36, 1
    s_min_i32 s47, s47, 31
    s_max_i32 s47, s47, 0
    s_cmp_ge_u32 s47, 16
    s_cselect_b32 s8, s88, s64
    s_cselect_b32 s9, s89, s65
    s_and_b32 s47, s47, 15
    s_lshl_b32 s47, s47, 16
    s_sub_u32 s47, s50, s47
    s_add_u32 s48, s47, 32768
    buffer_load_dwordx4 v[128:131], v3, s[8:11], s48 offen sc1
    buffer_load_dwordx4 v[132:135], v3, s[8:11], s47 offen sc1
    s_add_u32 s96, s41, 2031616
    s_mov_b32 s98, s41
    s_mov_b32 s45, 0x5540000
    buffer_load_dword v136, v4, s[16:19], s45 offen sc1
    s_waitcnt vmcnt(0)
    v_cmp_ne_u32 vcc, 0, v136
    s_cbranch_vccnz L_spin28
L_back29:
    s_barrier
    s_add_u32 m0, s43, 0
    s_add_u32 s42, s41, 0
    buffer_load_dwordx4 v1, s[16:19], s42 offen offset:0 sc1 lds
    buffer_load_dwordx4 v1, s[16:19], s42 offen offset:1024 sc1 lds
    buffer_load_dwordx4 v1, s[16:19], s42 offen offset:2048 sc1 lds
    buffer_load_dwordx4 v1, s[16:19], s42 offen offset:3072 sc1 lds
    s_add_u32 m0, s43, 16384
    s_add_u32 s42, s41, 16384
    buffer_load_dwordx4 v1, s[16:19], s42 offen offset:0 sc1 lds
    buffer_load_dwordx4 v1, s[16:19], s42 offen offset:1024 sc1 lds
    buffer_load_dwordx4 v1, s[16:19], s42 offen offset:2048 sc1 lds
    buffer_load_dwordx4 v1, s[16:19], s42 offen offset:3072 sc1 lds
    s_add_u32 m0, s43, 32768
    s_add_u32 s42, s41, 32768
    buffer_load_dwordx4 v1, s[16:19], s42 offen offset:0 sc1 lds
    buffer_load_dwordx4 v1, s[16:19], s42 offen offset:1024 sc1 lds
    buffer_load_dwordx4 v1, s[16:19], s42 offen offset:2048 sc1 lds
    buffer_load_dwordx4 v1, s[16:19], s42 offen offset:3072 sc1 lds
    s_add_u32 s45, s45, 65536
    s_waitcnt vmcnt(0) lgkmcnt(0)
    s_barrier
    v_mfma_f32_16x16x32_bf16 v[12:15], v[108:111], v[128:131], 0
    v_mfma_f32_16x16x32_bf16 v[16:19], v[112:115], v[128:131], 0
    v_mfma_f32_16x16x32_bf16 v[20:23], v[108:111], v[132:135], 0
    v_mfma_f32_16x16x32_bf16 v[24:27], v[112:115], v[132:135], 0
    ds_read_b128 v[44:47], v1 offset:0
    ds_read_b128 v[48:51], v1 offset:1024
    ds_read_b128 v[52:55], v1 offset:2048
    ds_read_b128 v[56:59], v1 offset:3072
    s_mov_b32 s36, 0
    s_waitcnt lgkmcnt(0)
    s_nop 7
L_o_b0:
    s_waitcnt lgkmcnt(2)
    v_mfma_f32_16x16x32_bf16 v[12:15], a[0:3], v[44:47], v[12:15]
    ds_read_b128 v[60:63], v1 offset:4096
    ds_read_b128 v[140:143], v7
    v_mfma_f32_16x16x32_bf16 v[20:23], a[0:3], v[48:51], v[20:23]
    s_cmp_eq_u32 s36, 0
    s_cselect_b32 s49, 0x5e00000, s46
    v_mfma_f32_16x16x32_bf16 v[24:27], a[4:7], v[48:51], v[24:27]
    ds_read_b128 v[64:67], v1 offset:5120
    v_mfma_f32_16x16x32_bf16 v[16:19], a[4:7], v[44:47], v[16:19]
    s_waitcnt lgkmcnt(3)
    v_mfma_f32_16x16x32_bf16 v[12:15], a[8:11], v[52:55], v[12:15]
    s_waitcnt lgkmcnt(1)
    ds_read_b128 v[68:71], v1 offset:6144
    v_add_f32 v140, v140, v141
    v_mfma_f32_16x16x32_bf16 v[20:23], a[8:11], v[56:59], v[20:23]
    v_add_f32 v142, v142, v143
    v_add_f32 v140, v140, v142
    v_mfma_f32_16x16x32_bf16 v[24:27], a[12:15], v[56:59], v[24:27]
    ds_read_b128 v[72:75], v1 offset:7168
    v_min_u32 v140, -2, v140
    v_mfma_f32_16x16x32_bf16 v[16:19], a[12:15], v[52:55], v[16:19]
    s_waitcnt lgkmcnt(2)
    buffer_store_dword v140, v8, s[16:19], s49 offen sc1
    v_mfma_f32_16x16x32_bf16 v[12:15], a[16:19], v[60:63], v[12:15]
    ds_read_b128 v[44:47], v1 offset:8192
    v_mfma_f32_16x16x32_bf16 v[20:23], a[16:19], v[64:67], v[20:23]
    v_mfma_f32_16x16x32_bf16 v[24:27], a[20:23], v[64:67], v[24:27]
    s_add_u32 m0, s43, 49152
    ds_read_b128 v[48:51], v1 offset:9216
    s_add_u32 s42, s41, 49152
    v_mfma_f32_16x16x32_bf16 v[16:19], a[20:23], v[60:63], v[16:19]
    s_waitcnt lgkmcnt(2)
    buffer_load_dwordx4 v1, s[16:19], s42 offen offset:0 sc1 lds
    v_mfma_f32_16x16x32_bf16 v[12:15], a[24:27], v[68:71], v[12:15]
    ds_read_b128 v[52:55], v1 offset:10240
    v_mfma_f32_16x16x32_bf16 v[20:23], a[24:27], v[72:75], v[20:23]
    v_mfma_f32_16x16x32_bf16 v[24:27], a[28:31], v[72:75], v[24:27]
    ds_read_b128 v[56:59], v1 offset:11264
    buffer_load_dwordx4 v1, s[16:19], s42 offen offset:1024 sc1 lds
    v_mfma_f32_16x16x32_bf16 v[16:19], a[28:31], v[68:71], v[16:19]
    s_waitcnt lgkmcnt(2)
    v_mfma_f32_16x16x32_bf16 v[12:15], a[32:35], v[44:47], v[12:15]
    ds_read_b128 v[60:63], v1 offset:12288
    v_mfma_f32_16x16x32_bf16 v[20:23], a[32:35], v[48:51], v[20:23]
    buffer_load_dwordx4 v1, s[16:19], s42 offen offset:2048 sc1 lds
    v_mfma_f32_16x16x32_bf16 v[24:27], a[36:39], v[48:51], v[24:27]
    ds_read_b128 v[64:67], v1 offset:13312
    v_mfma_f32_16x16x32_bf16 v[16:19], a[36:39], v[44:47], v[16:19]
    s_waitcnt lgkmcnt(2)
    v_mfma_f32_16x16x32_bf16 v[12:15], a[40:43], v[52:55], v[12:15]
    ds_read_b128 v[68:71], v1 offset:14336
    buffer_load_dwordx4 v1, s[16:19], s42 offen offset:3072 sc1 lds
    v_mfma_f32_16x16x32_bf16 v[20:23], a[40:43], v[56:59], v[20:23]
    s_add_u32 s98, s98, 65536
    s_min_i32 s98, s98, s96
    s_and_b32 s41, s98, 0xffffffff
    v_mfma_f32_16x16x32_bf16 v[24:27], a[44:47], v[56:59], v[24:27]
    s_add_u32 m0, s43, 98304
    ds_read_b128 v[72:75], v1 offset:15360
    s_add_u32 s42, s41, 0
    v_mfma_f32_16x16x32_bf16 v[16:19], a[44:47], v[52:55], v[16:19]
    s_waitcnt vmcnt(11) lgkmcnt(2)
    s_barrier
    v_mfma_f32_16x16x32_bf16 v[12:15], a[48:51], v[60:63], v[12:15]
    ds_read_b128 v[44:47], v1 offset:16384
    v_mfma_f32_16x16x32_bf16 v[20:23], a[48:51], v[64:67], v[20:23]
    v_mfma_f32_16x16x32_bf16 v[24:27], a[52:55], v[64:67], v[24:27]
    s_add_u32 s47, s36, 1
    ds_read_b128 v[48:51], v1 offset:17408
    s_min_i32 s47, s47, 31
    v_mfma_f32_16x16x32_bf16 v[16:19], a[52:55], v[60:63], v[16:19]
    s_waitcnt lgkmcnt(2)
    s_max_i32 s47, s47, 0
    s_cmp_ge_u32 s47, 16
    v_mfma_f32_16x16x32_bf16 v[12:15], a[56:59], v[68:71], v[12:15]
    s_cselect_b32 s8, s88, s64
    ds_read_b128 v[52:55], v1 offset:18432
    s_cselect_b32 s9, s89, s65
    v_mfma_f32_16x16x32_bf16 v[20:23], a[56:59], v[72:75], v[20:23]
    s_and_b32 s47, s47, 15
    s_lshl_b32 s47, s47, 16
    s_sub_u32 s47, s50, s47
    v_mfma_f32_16x16x32_bf16 v[24:27], a[60:63], v[72:75], v[24:27]
    s_add_u32 s48, s47, 32768
    ds_read_b128 v[56:59], v1 offset:19456
    buffer_load_dwordx4 v[128:131], v3, s[8:11], s48 offen sc1
    v_mfma_f32_16x16x32_bf16 v[16:19], a[60:63], v[68:71], v[16:19]
    s_waitcnt lgkmcnt(2)
    buffer_load_dwordx4 v[132:135], v3, s[8:11], s47 offen sc1
    v_mfma_f32_16x16x32_bf16 v[12:15], a[64:67], v[44:47], v[12:15]
    s_add_u32 s90, s90, 65536
    ds_read_b128 v[60:63], v1 offset:20480
    s_add_u32 s46, s46, 2048
    v_mfma_f32_16x16x32_bf16 v[20:23], a[64:67], v[48:51], v[20:23]
    s_and_b32 s44, s90, 0xffffffff
    v_mfma_f32_16x16x32_bf16 v[24:27], a[68:71], v[48:51], v[24:27]
    ds_read_b128 v[64:67], v1 offset:21504
    buffer_load_dword v136, v4, s[16:19], s45 offen sc1
    v_mfma_f32_16x16x32_bf16 v[16:19], a[68:71], v[44:47], v[16:19]
    s_waitcnt lgkmcnt(2)
    v_mfma_f32_16x16x32_bf16 v[12:15], a[72:75], v[52:55], v[12:15]
    ds_read_b128 v[68:71], v1 offset:22528
    v_mfma_f32_16x16x32_bf16 v[20:23], a[72:75], v[56:59], v[20:23]
    v_mfma_f32_16x16x32_bf16 v[24:27], a[76:79], v[56:59], v[24:27]
    ds_read_b128 v[72:75], v1 offset:23552
    v_mfma_f32_16x16x32_bf16 v[16:19], a[76:79], v[52:55], v[16:19]
    s_waitcnt lgkmcnt(2)
    v_mfma_f32_16x16x32_bf16 v[12:15], a[80:83], v[60:63], v[12:15]
    s_waitcnt vmcnt(12)
    ds_read_b128 v[44:47], v1 offset:24576
    s_barrier
    v_mfma_f32_16x16x32_bf16 v[20:23], a[80:83], v[64:67], v[20:23]
    buffer_store_dword v124, v124, s[16:19], s91 offen sc1
    v_mfma_f32_16x16x32_bf16 v[24:27], a[84:87], v[64:67], v[24:27]
    s_add_u32 s91, s91, 65536
    ds_read_b128 v[48:51], v1 offset:25600
    v_mfma_f32_16x16x32_bf16 v[16:19], a[84:87], v[60:63], v[16:19]
    s_waitcnt lgkmcnt(2)
    v_mfma_f32_16x16x32_bf16 v[12:15], a[88:91], v[68:71], v[12:15]
    ds_read_b128 v[52:55], v1 offset:26624
    v_mfma_f32_16x16x32_bf16 v[20:23], a[88:91], v[72:75], v[20:23]
    v_mfma_f32_16x16x32_bf16 v[24:27], a[92:95], v[72:75], v[24:27]
    ds_read_b128 v[56:59], v1 offset:27648
    v_mfma_f32_16x16x32_bf16 v[16:19], a[92:95], v[68:71], v[16:19]
    s_waitcnt lgkmcnt(2)
    v_mfma_f32_16x16x32_bf16 v[12:15], a[96:99], v[44:47], v[12:15]
    ds_read_b128 v[60:63], v1 offset:28672
    v_mfma_f32_16x16x32_bf16 v[20:23], a[96:99], v[48:51], v[20:23]
    v_mfma_f32_16x16x32_bf16 v[24:27], a[100:103], v[48:51], v[24:27]
    ds_read_b128 v[64:67], v1 offset:29696
    v_mfma_f32_16x16x32_bf16 v[16:19], a[100:103], v[44:47], v[16:19]
    s_waitcnt lgkmcnt(2)
    v_mfma_f32_16x16x32_bf16 v[12:15], a[104:107], v[52:55], v[12:15]
    ds_read_b128 v[68:71], v1 offset:30720
    v_mfma_f32_16x16x32_bf16 v[20:23], a[104:107], v[56:59], v[20:23]
    v_mfma_f32_16x16x32_bf16 v[24:27], a[108:111], v[56:59], v[24:27]
    ds_read_b128 v[72:75], v1 offset:31744
    v_mfma_f32_16x16x32_bf16 v[16:19], a[108:111], v[52:55], v[16:19]
    s_waitcnt vmcnt(9) lgkmcnt(2)
    s_barrier
    v_mfma_f32_16x16x32_bf16 v[12:15], a[112:115], v[60:63], v[12:15]
    ds_read_b128 v[44:47], v1 offset:32768
    v_mfma_f32_16x16x32_bf16 v[20:23], a[112:115], v[64:67], v[20:23]
    v_mfma_f32_16x16x32_bf16 v[24:27], a[116:119], v[64:67], v[24:27]
    ds_read_b128 v[48:51], v1 offset:33792
    v_mfma_f32_16x16x32_bf16 v[16:19], a[116:119], v[60:63], v[16:19]
    s_waitcnt lgkmcnt(2)
    v_mfma_f32_16x16x32_bf16 v[12:15], a[120:123], v[68:71], v[12:15]
    ds_read_b128 v[52:55], v1 offset:34816
    v_mfma_f32_16x16x32_bf16 v[20:23], a[120:123], v[72:75], v[20:23]
    v_mfma_f32_16x16x32_bf16 v[24:27], a[124:127], v[72:75], v[24:27]
    ds_read_b128 v[56:59], v1 offset:35840
    v_mfma_f32_16x16x32_bf16 v[16:19], a[124:127], v[68:71], v[16:19]
    s_waitcnt lgkmcnt(2)
    v_mfma_f32_16x16x32_bf16 v[12:15], a[128:131], v[44:47], v[12:15]
    ds_read_b128 v[60:63], v1 offset:36864
    v_mfma_f32_16x16x32_bf16 v[20:23], a[128:131], v[48:51], v[20:23]
    v_mfma_f32_16x16x32_bf16 v[24:27], a[132:135], v[48:51], v[24:27]
    ds_read_b128 v[64:67], v1 offset:37888
    v_mfma_f32_16x16x32_bf16 v[16:19], a[132:135], v[44:47], v[16:19]
    s_waitcnt lgkmcnt(2)
    v_mfma_f32_16x16x32_bf16 v[12:15], a[136:139], v[52:55], v[12:15]
    ds_read_b128 v[68:71], v1 offset:38912
    v_mfma_f32_16x16x32_bf16 v[20:23], a[136:139], v[56:59], v[20:23]
    v_mfma_f32_16x16x32_bf16 v[24:27], a[140:143], v[56:59], v[24:27]
    ds_read_b128 v[72:75], v1 offset:39936
    v_mfma_f32_16x16x32_bf16 v[16:19], a[140:143], v[52:55], v[16:19]
    s_waitcnt lgkmcnt(2)
    v_mfma_f32_16x16x32_bf16 v[12:15], a[144:147], v[60:63], v[12:15]
    ds_read_b128 v[44:47], v1 offset:40960
    v_mfma_f32_16x16x32_bf16 v[20:23], a[144:147], v[64:67], v[20:23]
    v_mfma_f32_16x16x32_bf16 v[24:27], a[148:151], v[64:67], v[24:27]
    ds_read_b128 v[48:51], v1 offset:41984
    v_mfma_f32_16x16x32_bf16 v[16:19], a[148:151], v[60:63], v[16:19]
    s_waitcnt lgkmcnt(2)
    v_mfma_f32_16x16x32_bf16 v[12:15], a[152:155], v[68:71], v[12:15]
    ds_read_b128 v[52:55], v1 offset:43008
    v_mfma_f32_16x16x32_bf16 v[20:23], a[152:155], v[72:75], v[20:23]
    v_mfma_f32_16x16x32_bf16 v[24:27], a[156:159], v[72:75], v[24:27]
    ds_read_b128 v[56:59], v1 offset:44032
    v_mfma_f32_16x16x32_bf16 v[16:19], a[156:159], v[68:71], v[16:19]
    s_waitcnt lgkmcnt(2)
    v_mfma_f32_16x16x32_bf16 v[12:15], a[160:163], v[44:47], v[12:15]
    ds_read_b128 v[60:63], v1 offset:45056
    v_mfma_f32_16x16x32_bf16 v[20:23], a[160:163], v[48:51], v[20:23]
    v_mfma_f32_16x16x32_bf16 v[24:27], a[164:167], v[48:51], v[24:27]
    ds_read_b128 v[64:67], v1 offset:46080
    v_mfma_f32_16x16x32_bf16 v[16:19], a[164:167], v[44:47], v[16:19]
    s_waitcnt lgkmcnt(2)
    v_mfma_f32_16x16x32_bf16 v[12:15], a[168:171], v[52:55], v[12:15]
    ds_read_b128 v[68:71], v1 offset:47104
    v_mfma_f32_16x16x32_bf16 v[20:23], a[168:171], v[56:59], v[20:23]
    v_mfma_f32_16x16x32_bf16 v[24:27], a[172:175], v[56:59], v[24:27]
    ds_read_b128 v[72:75], v1 offset:48128
    v_mfma_f32_16x16x32_bf16 v[16:19], a[172:175], v[52:55], v[16:19]
    s_waitcnt vmcnt(4) lgkmcnt(2)
    s_barrier
    v_mfma_f32_16x16x32_bf16 v[12:15], a[176:179], v[60:63], v[12:15]
    ds_read_b128 v[44:47], v1 offset:49152
    v_mfma_f32_16x16x32_bf16 v[20:23], a[176:179], v[64:67], v[20:23]
    v_mfma_f32_16x16x32_bf16 v[24:27], a[180:183], v[64:67], v[24:27]
    ds_read_b128 v[48:51], v1 offset:50176
    v_mfma_f32_16x16x32_bf16 v[16:19], a[180:183], v[60:63], v[16:19]
    s_waitcnt lgkmcnt(2)
    v_mfma_f32_16x16x32_bf16 v[12:15], a[184:187], v[68:71], v[12:15]
    s_waitcnt vmcnt(1)
    ds_read_b128 v[52:55], v1 offset:51200
    v_cmp_ne_u32 vcc, 0, v136
    v_mfma_f32_16x16x32_bf16 v[20:23], a[184:187], v[72:75], v[20:23]
    v_mfma_f32_16x16x32_bf16 v[24:27], a[188:191], v[72:75], v[24:27]
    s_cbranch_vccnz L_spin30
L_back31:
    ds_read_b128 v[56:59], v1 offset:52224
    s_barrier
    v_mfma_f32_16x16x32_bf16 v[16:19], a[188:191], v[68:71], v[16:19]
    s_waitcnt lgkmcnt(2)
    s_add_u32 s45, s45, 65536
    buffer_load_dwordx4 v1, s[16:19], s42 offen offset:0 sc1 lds
    v_mfma_f32_16x16x32_bf16 v[12:15], a[192:195], v[44:47], v[12:15]
    s_waitcnt vmcnt(3)
    ds_read_b128 v[60:63], v1 offset:53248
    v_mfma_f32_16x16x32_bf16 v[28:31], v[108:111], v[128:131], 0
    v_mfma_f32_16x16x32_bf16 v[32:35], v[112:115], v[128:131], 0
    v_mfma_f32_16x16x32_bf16 v[36:39], v[108:111], v[132:135], 0
    v_mfma_f32_16x16x32_bf16 v[40:43], v[112:115], v[132:135], 0
    v_mfma_f32_16x16x32_bf16 v[20:23], a[192:195], v[48:51], v[20:23]
    v_mfma_f32_16x16x32_bf16 v[24:27], a[196:199], v[48:51], v[24:27]
    ds_read_b128 v[64:67], v1 offset:54272
    v_mfma_f32_16x16x32_bf16 v[16:19], a[196:199], v[44:47], v[16:19]
    s_waitcnt lgkmcnt(2)
    buffer_load_dwordx4 v1, s[16:19], s42 offen offset:1024 sc1 lds
    v_mfma_f32_16x16x32_bf16 v[12:15], a[200:203], v[52:55], v[12:15]
    ds_read_b128 v[68:71], v1 offset:55296
    v_mfma_f32_16x16x32_bf16 v[20:23], a[200:203], v[56:59], v[20:23]
    v_mfma_f32_16x16x32_bf16 v[24:27], a[204:207], v[56:59], v[24:27]
    ds_read_b128 v[72:75], v1 offset:56320
    v_mfma_f32_16x16x32_bf16 v[16:19], a[204:207], v[52:55], v[16:19]
    s_waitcnt lgkmcnt(2)
    buffer_load_dwordx4 v1, s[16:19], s42 offen offset:2048 sc1 lds
    v_mfma_f32_16x16x32_bf16 v[12:15], a[208:211], v[60:63], v[12:15]
    ds_read_b128 v[44:47], v1 offset:57344
    v_mfma_f32_16x16x32_bf16 v[20:23], a[208:211], v[64:67], v[20:23]
    v_mfma_f32_16x16x32_bf16 v[24:27], a[212:215], v[64:67], v[24:27]
    ds_read_b128 v[48:51], v1 offset:58368
    v_mfma_f32_16x16x32_bf16 v[16:19], a[212:215], v[60:63], v[16:19]
    s_waitcnt lgkmcnt(2)
    buffer_load_dwordx4 v1, s[16:19], s42 offen offset:3072 sc1 lds
    v_mfma_f32_16x16x32_bf16 v[12:15], a[216:219], v[68:71], v[12:15]
    s_add_u32 m0, s43, 114688
    ds_read_b128 v[52:55], v1 offset:59392
    s_add_u32 s42, s41, 16384
    v_mfma_f32_16x16x32_bf16 v[20:23], a[216:219], v[72:75], v[20:23]
    v_mfma_f32_16x16x32_bf16 v[24:27], a[220:223], v[72:75], v[24:27]
    ds_read_b128 v[56:59], v1 offset:60416
    v_mfma_f32_16x16x32_bf16 v[16:19], a[220:223], v[68:71], v[16:19]
    s_waitcnt lgkmcnt(2)
    buffer_load_dwordx4 v1, s[16:19], s42 offen offset:0 sc1 lds
    v_mfma_f32_16x16x32_bf16 v[12:15], a[224:227], v[44:47], v[12:15]
    ds_read_b128 v[60:63], v1 offset:61440
    v_mfma_f32_16x16x32_bf16 v[20:23], a[224:227], v[48:51], v[20:23]
    v_mfma_f32_16x16x32_bf16 v[24:27], a[228:231], v[48:51], v[24:27]
    ds_read_b128 v[64:67], v1 offset:62464
    v_mfma_f32_16x16x32_bf16 v[16:19], a[228:231], v[44:47], v[16:19]
    s_waitcnt lgkmcnt(2)
    buffer_load_dwordx4 v1, s[16:19], s42 offen offset:1024 sc1 lds
    v_mfma_f32_16x16x32_bf16 v[12:15], a[232:235], v[52:55], v[12:15]
    ds_read_b128 v[68:71], v1 offset:63488
    v_mfma_f32_16x16x32_bf16 v[20:23], a[232:235], v[56:59], v[20:23]
    v_mfma_f32_16x16x32_bf16 v[24:27], a[236:239], v[56:59], v[24:27]
    ds_read_b128 v[72:75], v1 offset:64512
    v_mfma_f32_16x16x32_bf16 v[16:19], a[236:239], v[52:55], v[16:19]
    s_waitcnt lgkmcnt(2)
    buffer_load_dwordx4 v1, s[16:19], s42 offen offset:2048 sc1 lds
    v_mfma_f32_16x16x32_bf16 v[12:15], a[240:243], v[60:63], v[12:15]
    v_mfma_f32_16x16x32_bf16 v[20:23], a[240:243], v[64:67], v[20:23]
    v_mfma_f32_16x16x32_bf16 v[24:27], a[244:247], v[64:67], v[24:27]
    v_mfma_f32_16x16x32_bf16 v[16:19], a[244:247], v[60:63], v[16:19]
    s_waitcnt lgkmcnt(0)
    buffer_load_dwordx4 v1, s[16:19], s42 offen offset:3072 sc1 lds
    v_mfma_f32_16x16x32_bf16 v[12:15], a[248:251], v[68:71], v[12:15]
    v_mfma_f32_16x16x32_bf16 v[20:23], a[248:251], v[72:75], v[20:23]
    v_mfma_f32_16x16x32_bf16 v[24:27], a[252:255], v[72:75], v[24:27]
    v_mfma_f32_16x16x32_bf16 v[16:19], a[252:255], v[68:71], v[16:19]
    s_nop 1
    v_cvt_pk_bf16_f32 v148, v12, v13
    v_cvt_pk_bf16_f32 v149, v14, v15
    s_nop 3
    v_cvt_pk_bf16_f32 v150, v16, v17
    v_cvt_pk_bf16_f32 v151, v18, v19
    buffer_store_dwordx4 v[148:151], v1, s[16:19], s44 offen offset:0 sc1
    v_cvt_pk_bf16_f32 v152, v20, v21
    v_cvt_pk_bf16_f32 v153, v22, v23
    v_cvt_pk_bf16_f32 v154, v24, v25
    v_cvt_pk_bf16_f32 v155, v26, v27
    buffer_store_dwordx4 v[152:155], v1, s[16:19], s44 offen offset:1024 sc1
    s_add_u32 m0, s43, 131072
    s_add_u32 s42, s41, 32768
    v_add_f32 v140, v12, v13
    v_add_f32 v144, v20, v21
    v_mul_f32 v141, v12, v12
    v_mul_f32 v145, v20, v20
    buffer_load_dwordx4 v1, s[16:19], s42 offen offset:0 sc1 lds
    v_fmac_f32 v141, v13, v13
    v_fmac_f32 v145, v21, v21
    v_add_f32 v140, v140, v14
    v_add_f32 v144, v144, v22
    v_fmac_f32 v141, v14, v14
    v_fmac_f32 v145, v22, v22
    v_add_f32 v140, v140, v15
    v_add_f32 v144, v144, v23
    buffer_load_dwordx4 v1, s[16:19], s42 offen offset:1024 sc1 lds
    v_fmac_f32 v141, v15, v15
    v_fmac_f32 v145, v23, v23
    v_add_f32 v140, v140, v16
    v_add_f32 v144, v144, v24
    v_fmac_f32 v141, v16, v16
    v_fmac_f32 v145, v24, v24
    v_add_f32 v140, v140, v17
    v_add_f32 v144, v144, v25
    buffer_load_dwordx4 v1, s[16:19], s42 offen offset:2048 sc1 lds
    v_fmac_f32 v141, v17, v17
    v_fmac_f32 v145, v25, v25
    v_add_f32 v140, v140, v18
    v_add_f32 v144, v144, v26
    v_fmac_f32 v141, v18, v18
    v_fmac_f32 v145, v26, v26
    v_add_f32 v140, v140, v19
    v_add_f32 v144, v144, v27
    buffer_load_dwordx4 v1, s[16:19], s42 offen offset:3072 sc1 lds
    v_fmac_f32 v141, v19, v19
    v_fmac_f32 v145, v27, v27
    s_nop 0
    v_permlane16_swap_b32 v140, v141
    v_permlane16_swap_b32 v144, v145
    v_add_f32 v140, v140, v141
    v_add_f32 v144, v144, v145
    v_mov_b32 v142, v140
    v_mov_b32 v146, v144
    s_nop 0
    v_permlane32_swap_b32 v140, v142
    v_permlane32_swap_b32 v144, v146
    v_add_f32 v140, v140, v142
    v_add_f32 v144, v144, v146
    ds_write_b32 v6, v140 offset:0
    ds_write_b32 v6, v144 offset:512
    s_waitcnt vmcnt(10) lgkmcnt(0)
    s_barrier
    ds_read_b128 v[44:47], v2 offset:0
    ds_read_b128 v[48:51], v2 offset:1024
    ds_read_b128 v[52:55], v2 offset:2048
    ds_read_b128 v[56:59], v2 offset:3072
    s_add_u32 s36, s36, 1
L_o_b1:
    s_waitcnt lgkmcnt(2)
    v_mfma_f32_16x16x32_bf16 v[28:31], a[0:3], v[44:47], v[28:31]
    ds_read_b128 v[60:63], v2 offset:4096
    ds_read_b128 v[140:143], v7
    v_mfma_f32_16x16x32_bf16 v[36:39], a[0:3], v[48:51], v[36:39]
    s_cmp_eq_u32 s36, 0
    s_cselect_b32 s49, 0x5e00000, s46
    v_mfma_f32_16x16x32_bf16 v[40:43], a[4:7], v[48:51], v[40:43]
    ds_read_b128 v[64:67], v2 offset:5120
    v_mfma_f32_16x16x32_bf16 v[32:35], a[4:7], v[44:47], v[32:35]
    s_waitcnt lgkmcnt(3)
    v_mfma_f32_16x16x32_bf16 v[28:31], a[8:11], v[52:55], v[28:31]
    s_waitcnt lgkmcnt(1)
    ds_read_b128 v[68:71], v2 offset:6144
    v_add_f32 v140, v140, v141
    v_mfma_f32_16x16x32_bf16 v[36:39], a[8:11], v[56:59], v[36:39]
    v_add_f32 v142, v142, v143
    v_add_f32 v140, v140, v142
    v_mfma_f32_16x16x32_bf16 v[40:43], a[12:15], v[56:59], v[40:43]
    ds_read_b128 v[72:75], v2 offset:7168
    v_min_u32 v140, -2, v140
    v_mfma_f32_16x16x32_bf16 v[32:35], a[12:15], v[52:55], v[32:35]
    s_waitcnt lgkmcnt(2)
    buffer_store_dword v140, v8, s[16:19], s49 offen sc1
    v_mfma_f32_16x16x32_bf16 v[28:31], a[16:19], v[60:63], v[28:31]
    ds_read_b128 v[44:47], v2 offset:8192
    v_mfma_f32_16x16x32_bf16 v[36:39], a[16:19], v[64:67], v[36:39]
    v_mfma_f32_16x16x32_bf16 v[40:43], a[20:23], v[64:67], v[40:43]
    s_add_u32 m0, s43, 147456
    ds_read_b128 v[48:51], v2 offset:9216
    s_add_u32 s42, s41, 49152
    v_mfma_f32_16x16x32_bf16 v[32:35], a[20:23], v[60:63], v[32:35]
    s_waitcnt lgkmcnt(2)
    buffer_load_dwordx4 v1, s[16:19], s42 offen offset:0 sc1 lds
    v_mfma_f32_16x16x32_bf16 v[28:31], a[24:27], v[68:71], v[28:31]
    ds_read_b128 v[52:55], v2 offset:10240
    v_mfma_f32_16x16x32_bf16 v[36:39], a[24:27], v[72:75], v[36:39]
    v_mfma_f32_16x16x32_bf16 v[40:43], a[28:31], v[72:75], v[40:43]
    ds_read_b128 v[56:59], v2 offset:11264
    buffer_load_dwordx4 v1, s[16:19], s42 offen offset:1024 sc1 lds
    v_mfma_f32_16x16x32_bf16 v[32:35], a[28:31], v[68:71], v[32:35]
    s_waitcnt lgkmcnt(2)
    v_mfma_f32_16x16x32_bf16 v[28:31], a[32:35], v[44:47], v[28:31]
    ds_read_b128 v[60:63], v2 offset:12288
    v_mfma_f32_16x16x32_bf16 v[36:39], a[32:35], v[48:51], v[36:39]
    buffer_load_dwordx4 v1, s[16:19], s42 offen offset:2048 sc1 lds
    v_mfma_f32_16x16x32_bf16 v[40:43], a[36:39], v[48:51], v[40:43]
    ds_read_b128 v[64:67], v2 offset:13312
    v_mfma_f32_16x16x32_bf16 v[32:35], a[36:39], v[44:47], v[32:35]
    s_waitcnt lgkmcnt(2)
    v_mfma_f32_16x16x32_bf16 v[28:31], a[40:43], v[52:55], v[28:31]
    ds_read_b128 v[68:71], v2 offset:14336
    buffer_load_dwordx4 v1, s[16:19], s42 offen offset:3072 sc1 lds
    v_mfma_f32_16x16x32_bf16 v[36:39], a[40:43], v[56:59], v[36:39]
    s_add_u32 s98, s98, 65536
    s_min_i32 s98, s98, s96
    s_and_b32 s41, s98, 0xffffffff
    v_mfma_f32_16x16x32_bf16 v[40:43], a[44:47], v[56:59], v[40:43]
    s_add_u32 m0, s43, 0
    ds_read_b128 v[72:75], v2 offset:15360
    s_add_u32 s42, s41, 0
    v_mfma_f32_16x16x32_bf16 v[32:35], a[44:47], v[52:55], v[32:35]
    s_waitcnt vmcnt(11) lgkmcnt(2)
    s_barrier
    v_mfma_f32_16x16x32_bf16 v[28:31], a[48:51], v[60:63], v[28:31]
    ds_read_b128 v[44:47], v2 offset:16384
    v_mfma_f32_16x16x32_bf16 v[36:39], a[48:51], v[64:67], v[36:39]
    v_mfma_f32_16x16x32_bf16 v[40:43], a[52:55], v[64:67], v[40:43]
    s_add_u32 s47, s36, 1
    ds_read_b128 v[48:51], v2 offset:17408
    s_min_i32 s47, s47, 31
    v_mfma_f32_16x16x32_bf16 v[32:35], a[52:55], v[60:63], v[32:35]
    s_waitcnt lgkmcnt(2)
    s_max_i32 s47, s47, 0
    s_cmp_ge_u32 s47, 16
    v_mfma_f32_16x16x32_bf16 v[28:31], a[56:59], v[68:71], v[28:31]
    s_cselect_b32 s8, s88, s64
    ds_read_b128 v[52:55], v2 offset:18432
    s_cselect_b32 s9, s89, s65
    v_mfma_f32_16x16x32_bf16 v[36:39], a[56:59], v[72:75], v[36:39]
    s_and_b32 s47, s47, 15
    s_lshl_b32 s47, s47, 16
    s_sub_u32 s47, s50, s47
    v_mfma_f32_16x16x32_bf16 v[40:43], a[60:63], v[72:75], v[40:43]
    s_add_u32 s48, s47, 32768
    ds_read_b128 v[56:59], v2 offset:19456
    buffer_load_dwordx4 v[128:131], v3, s[8:11], s48 offen sc1
    v_mfma_f32_16x16x32_bf16 v[32:35], a[60:63], v[68:71], v[32:35]
    s_waitcnt lgkmcnt(2)
    buffer_load_dwordx4 v[132:135], v3, s[8:11], s47 offen sc1
    v_mfma_f32_16x16x32_bf16 v[28:31], a[64:67], v[44:47], v[28:31]
    s_add_u32 s90, s90, 65536
    ds_read_b128 v[60:63], v2 offset:20480
    s_add_u32 s46, s46, 2048
    v_mfma_f32_16x16x32_bf16 v[36:39], a[64:67], v[48:51], v[36:39]
    s_and_b32 s44, s90, 0xffffffff
    v_mfma_f32_16x16x32_bf16 v[40:43], a[68:71], v[48:51], v[40:43]
    ds_read_b128 v[64:67], v2 offset:21504
    buffer_load_dword v136, v4, s[16:19], s45 offen sc1
    v_mfma_f32_16x16x32_bf16 v[32:35], a[68:71], v[44:47], v[32:35]
    s_waitcnt lgkmcnt(2)
    v_mfma_f32_16x16x32_bf16 v[28:31], a[72:75], v[52:55], v[28:31]
    ds_read_b128 v[68:71], v2 offset:22528
    v_mfma_f32_16x16x32_bf16 v[36:39], a[72:75], v[56:59], v[36:39]
    v_mfma_f32_16x16x32_bf16 v[40:43], a[76:79], v[56:59], v[40:43]
    ds_read_b128 v[72:75], v2 offset:23552
    v_mfma_f32_16x16x32_bf16 v[32:35], a[76:79], v[52:55], v[32:35]
    s_waitcnt lgkmcnt(2)
    v_mfma_f32_16x16x32_bf16 v[28:31], a[80:83], v[60:63], v[28:31]
    s_waitcnt vmcnt(12)
    ds_read_b128 v[44:47], v2 offset:24576
    s_barrier
    v_mfma_f32_16x16x32_bf16 v[36:39], a[80:83], v[64:67], v[36:39]
    buffer_store_dword v124, v124, s[16:19], s91 offen sc1
    v_mfma_f32_16x16x32_bf16 v[40:43], a[84:87], v[64:67], v[40:43]
    s_add_u32 s91, s91, 65536
    ds_read_b128 v[48:51], v2 offset:25600
    v_mfma_f32_16x16x32_bf16 v[32:35], a[84:87], v[60:63], v[32:35]
    s_waitcnt lgkmcnt(2)
    v_mfma_f32_16x16x32_bf16 v[28:31], a[88:91], v[68:71], v[28:31]
    ds_read_b128 v[52:55], v2 offset:26624
    v_mfma_f32_16x16x32_bf16 v[36:39], a[88:91], v[72:75], v[36:39]
    v_mfma_f32_16x16x32_bf16 v[40:43], a[92:95], v[72:75], v[40:43]
    ds_read_b128 v[56:59], v2 offset:27648
    v_mfma_f32_16x16x32_bf16 v[32:35], a[92:95], v[68:71], v[32:35]
    s_waitcnt lgkmcnt(2)
    v_mfma_f32_16x16x32_bf16 v[28:31], a[96:99], v[44:47], v[28:31]
    ds_read_b128 v[60:63], v2 offset:28672
    v_mfma_f32_16x16x32_bf16 v[36:39], a[96:99], v[48:51], v[36:39]
    v_mfma_f32_16x16x32_bf16 v[40:43], a[100:103], v[48:51], v[40:43]
    ds_read_b128 v[64:67], v2 offset:29696
    v_mfma_f32_16x16x32_bf16 v[32:35], a[100:103], v[44:47], v[32:35]
    s_waitcnt lgkmcnt(2)
    v_mfma_f32_16x16x32_bf16 v[28:31], a[104:107], v[52:55], v[28:31]
    ds_read_b128 v[68:71], v2 offset:30720
    v_mfma_f32_16x16x32_bf16 v[36:39], a[104:107], v[56:59], v[36:39]
    v_mfma_f32_16x16x32_bf16 v[40:43], a[108:111], v[56:59], v[40:43]
    ds_read_b128 v[72:75], v2 offset:31744
    v_mfma_f32_16x16x32_bf16 v[32:35], a[108:111], v[52:55], v[32:35]
    s_waitcnt vmcnt(9) lgkmcnt(2)
    s_barrier
    v_mfma_f32_16x16x32_bf16 v[28:31], a[112:115], v[60:63], v[28:31]
    ds_read_b128 v[44:47], v2 offset:32768
    v_mfma_f32_16x16x32_bf16 v[36:39], a[112:115], v[64:67], v[36:39]
    v_mfma_f32_16x16x32_bf16 v[40:43], a[116:119], v[64:67], v[40:43]
    ds_read_b128 v[48:51], v2 offset:33792
    v_mfma_f32_16x16x32_bf16 v[32:35], a[116:119], v[60:63], v[32:35]
    s_waitcnt lgkmcnt(2)
    v_mfma_f32_16x16x32_bf16 v[28:31], a[120:123], v[68:71], v[28:31]
    ds_read_b128 v[52:55], v2 offset:34816
    v_mfma_f32_16x16x32_bf16 v[36:39], a[120:123], v[72:75], v[36:39]
    v_mfma_f32_16x16x32_bf16 v[40:43], a[124:127], v[72:75], v[40:43]
    ds_read_b128 v[56:59], v2 offset:35840
    v_mfma_f32_16x16x32_bf16 v[32:35], a[124:127], v[68:71], v[32:35]
    s_waitcnt lgkmcnt(2)
    v_mfma_f32_16x16x32_bf16 v[28:31], a[128:131], v[44:47], v[28:31]
    ds_read_b128 v[60:63], v2 offset:36864
    v_mfma_f32_16x16x32_bf16 v[36:39], a[128:131], v[48:51], v[36:39]
    v_mfma_f32_16x16x32_bf16 v[40:43], a[132:135], v[48:51], v[40:43]
    ds_read_b128 v[64:67], v2 offset:37888
    v_mfma_f32_16x16x32_bf16 v[32:35], a[132:135], v[44:47], v[32:35]
    s_waitcnt lgkmcnt(2)
    v_mfma_f32_16x16x32_bf16 v[28:31], a[136:139], v[52:55], v[28:31]
    ds_read_b128 v[68:71], v2 offset:38912
    v_mfma_f32_16x16x32_bf16 v[36:39], a[136:139], v[56:59], v[36:39]
    v_mfma_f32_16x16x32_bf16 v[40:43], a[140:143], v[56:59], v[40:43]
    ds_read_b128 v[72:75], v2 offset:39936
    v_mfma_f32_16x16x32_bf16 v[32:35], a[140:143], v[52:55], v[32:35]
    s_waitcnt lgkmcnt(2)
    v_mfma_f32_16x16x32_bf16 v[28:31], a[144:147], v[60:63], v[28:31]
    ds_read_b128 v[44:47], v2 offset:40960
    v_mfma_f32_16x16x32_bf16 v[36:39], a[144:147], v[64:67], v[36:39]
    v_mfma_f32_16x16x32_bf16 v[40:43], a[148:151], v[64:67], v[40:43]
    ds_read_b128 v[48:51], v2 offset:41984
    v_mfma_f32_16x16x32_bf16 v[32:35], a[148:151], v[60:63], v[32:35]
    s_waitcnt lgkmcnt(2)
    v_mfma_f32_16x16x32_bf16 v[28:31], a[152:155], v[68:71], v[28:31]
    ds_read_b128 v[52:55], v2 offset:43008
    v_mfma_f32_16x16x32_bf16 v[36:39], a[152:155], v[72:75], v[36:39]
    v_mfma_f32_16x16x32_bf16 v[40:43], a[156:159], v[72:75], v[40:43]
    ds_read_b128 v[56:59], v2 offset:44032
    v_mfma_f32_16x16x32_bf16 v[32:35], a[156:159], v[68:71], v[32:35]
    s_waitcnt lgkmcnt(2)
    v_mfma_f32_16x16x32_bf16 v[28:31], a[160:163], v[44:47], v[28:31]
    ds_read_b128 v[60:63], v2 offset:45056
    v_mfma_f32_16x16x32_bf16 v[36:39], a[160:163], v[48:51], v[36:39]
    v_mfma_f32_16x16x32_bf16 v[40:43], a[164:167], v[48:51], v[40:43]
    ds_read_b128 v[64:67], v2 offset:46080
    v_mfma_f32_16x16x32_bf16 v[32:35], a[164:167], v[44:47], v[32:35]
    s_waitcnt lgkmcnt(2)
    v_mfma_f32_16x16x32_bf16 v[28:31], a[168:171], v[52:55], v[28:31]
    ds_read_b128 v[68:71], v2 offset:47104
    v_mfma_f32_16x16x32_bf16 v[36:39], a[168:171], v[56:59], v[36:39]
    v_mfma_f32_16x16x32_bf16 v[40:43], a[172:175], v[56:59], v[40:43]
    ds_read_b128 v[72:75], v2 offset:48128
    v_mfma_f32_16x16x32_bf16 v[32:35], a[172:175], v[52:55], v[32:35]
    s_waitcnt vmcnt(4) lgkmcnt(2)
    s_barrier
    v_mfma_f32_16x16x32_bf16 v[28:31], a[176:179], v[60:63], v[28:31]
    ds_read_b128 v[44:47], v2 offset:49152
    v_mfma_f32_16x16x32_bf16 v[36:39], a[176:179], v[64:67], v[36:39]
    v_mfma_f32_16x16x32_bf16 v[40:43], a[180:183], v[64:67], v[40:43]
    ds_read_b128 v[48:51], v2 offset:50176
    v_mfma_f32_16x16x32_bf16 v[32:35], a[180:183], v[60:63], v[32:35]
    s_waitcnt lgkmcnt(2)
    v_mfma_f32_16x16x32_bf16 v[28:31], a[184:187], v[68:71], v[28:31]
    s_waitcnt vmcnt(1)
    ds_read_b128 v[52:55], v2 offset:51200
    v_cmp_ne_u32 vcc, 0, v136
    v_mfma_f32_16x16x32_bf16 v[36:39], a[184:187], v[72:75], v[36:39]
    v_mfma_f32_16x16x32_bf16 v[40:43], a[188:191], v[72:75], v[40:43]
    s_cbranch_vccnz L_spin32
L_back33:
    ds_read_b128 v[56:59], v2 offset:52224
    s_barrier
    v_mfma_f32_16x16x32_bf16 v[32:35], a[188:191], v[68:71], v[32:35]
    s_waitcnt lgkmcnt(2)
    s_add_u32 s45, s45, 65536
    buffer_load_dwordx4 v1, s[16:19], s42 offen offset:0 sc1 lds
    v_mfma_f32_16x16x32_bf16 v[28:31], a[192:195], v[44:47], v[28:31]
    s_waitcnt vmcnt(3)
    ds_read_b128 v[60:63], v2 offset:53248
    v_mfma_f32_16x16x32_bf16 v[12:15], v[108:111], v[128:131], 0
    v_mfma_f32_16x16x32_bf16 v[16:19], v[112:115], v[128:131], 0
    v_mfma_f32_16x16x32_bf16 v[20:23], v[108:111], v[132:135], 0
    v_mfma_f32_16x16x32_bf16 v[24:27], v[112:115], v[132:135], 0
    v_mfma_f32_16x16x32_bf16 v[36:39], a[192:195], v[48:51], v[36:39]
    v_mfma_f32_16x16x32_bf16 v[40:43], a[196:199], v[48:51], v[40:43]
    ds_read_b128 v[64:67], v2 offset:54272
    v_mfma_f32_16x16x32_bf16 v[32:35], a[196:199], v[44:47], v[32:35]
    s_waitcnt lgkmcnt(2)
    buffer_load_dwordx4 v1, s[16:19], s42 offen offset:1024 sc1 lds
    v_mfma_f32_16x16x32_bf16 v[28:31], a[200:203], v[52:55], v[28:31]
    ds_read_b128 v[68:71], v2 offset:55296
    v_mfma_f32_16x16x32_bf16 v[36:39], a[200:203], v[56:59], v[36:39]
    v_mfma_f32_16x16x32_bf16 v[40:43], a[204:207], v[56:59], v[40:43]
    ds_read_b128 v[72:75], v2 offset:56320
    v_mfma_f32_16x16x32_bf16 v[32:35], a[204:207], v[52:55], v[32:35]
    s_waitcnt lgkmcnt(2)
    buffer_load_dwordx4 v1, s[16:19], s42 offen offset:2048 sc1 lds
    v_mfma_f32_16x16x32_bf16 v[28:31], a[208:211], v[60:63], v[28:31]
    ds_read_b128 v[44:47], v2 offset:57344
    v_mfma_f32_16x16x32_bf16 v[36:39], a[208:211], v[64:67], v[36:39]
    v_mfma_f32_16x16x32_bf16 v[40:43], a[212:215], v[64:67], v[40:43]
    ds_read_b128 v[48:51], v2 offset:58368
    v_mfma_f32_16x16x32_bf16 v[32:35], a[212:215], v[60:63], v[32:35]
    s_waitcnt lgkmcnt(2)
    buffer_load_dwordx4 v1, s[16:19], s42 offen offset:3072 sc1 lds
    v_mfma_f32_16x16x32_bf16 v[28:31], a[216:219], v[68:71], v[28:31]
    s_add_u32 m0, s43, 16384
    ds_read_b128 v[52:55], v2 offset:59392
    s_add_u32 s42, s41, 16384
    v_mfma_f32_16x16x32_bf16 v[36:39], a[216:219], v[72:75], v[36:39]
    v_mfma_f32_16x16x32_bf16 v[40:43], a[220:223], v[72:75], v[40:43]
    ds_read_b128 v[56:59], v2 offset:60416
    v_mfma_f32_16x16x32_bf16 v[32:35], a[220:223], v[68:71], v[32:35]
    s_waitcnt lgkmcnt(2)
    buffer_load_dwordx4 v1, s[16:19], s42 offen offset:0 sc1 lds
    v_mfma_f32_16x16x32_bf16 v[28:31], a[224:227], v[44:47], v[28:31]
    ds_read_b128 v[60:63], v2 offset:61440
    v_mfma_f32_16x16x32_bf16 v[36:39], a[224:227], v[48:51], v[36:39]
    v_mfma_f32_16x16x32_bf16 v[40:43], a[228:231], v[48:51], v[40:43]
    ds_read_b128 v[64:67], v2 offset:62464
    v_mfma_f32_16x16x32_bf16 v[32:35], a[228:231], v[44:47], v[32:35]
    s_waitcnt lgkmcnt(2)
    buffer_load_dwordx4 v1, s[16:19], s42 offen offset:1024 sc1 lds
    v_mfma_f32_16x16x32_bf16 v[28:31], a[232:235], v[52:55], v[28:31]
    ds_read_b128 v[68:71], v2 offset:63488
    v_mfma_f32_16x16x32_bf16 v[36:39], a[232:235], v[56:59], v[36:39]
    v_mfma_f32_16x16x32_bf16 v[40:43], a[236:239], v[56:59], v[40:43]
    ds_read_b128 v[72:75], v2 offset:64512
    v_mfma_f32_16x16x32_bf16 v[32:35], a[236:239], v[52:55], v[32:35]
    s_waitcnt lgkmcnt(2)
    buffer_load_dwordx4 v1, s[16:19], s42 offen offset:2048 sc1 lds
    v_mfma_f32_16x16x32_bf16 v[28:31], a[240:243], v[60:63], v[28:31]
    v_mfma_f32_16x16x32_bf16 v[36:39], a[240:243], v[64:67], v[36:39]
    v_mfma_f32_16x16x32_bf16 v[40:43], a[244:247], v[64:67], v[40:43]
    v_mfma_f32_16x16x32_bf16 v[32:35], a[244:247], v[60:63], v[32:35]
    s_waitcnt lgkmcnt(0)
    buffer_load_dwordx4 v1, s[16:19], s42 offen offset:3072 sc1 lds
    v_mfma_f32_16x16x32_bf16 v[28:31], a[248:251], v[68:71], v[28:31]
    v_mfma_f32_16x16x32_bf16 v[36:39], a[248:251], v[72:75], v[36:39]
    v_mfma_f32_16x16x32_bf16 v[40:43], a[252:255], v[72:75], v[40:43]
    v_mfma_f32_16x16x32_bf16 v[32:35], a[252:255], v[68:71], v[32:35]
    s_nop 1
    v_cvt_pk_bf16_f32 v148, v28, v29
    v_cvt_pk_bf16_f32 v149, v30, v31
    s_nop 3
    v_cvt_pk_bf16_f32 v150, v32, v33
    v_cvt_pk_bf16_f32 v151, v34, v35
    buffer_store_dwordx4 v[148:151], v1, s[16:19], s44 offen offset:0 sc1
    v_cvt_pk_bf16_f32 v152, v36, v37
    v_cvt_pk_bf16_f32 v153, v38, v39
    v_cvt_pk_bf16_f32 v154, v40, v41
    v_cvt_pk_bf16_f32 v155, v42, v43
    buffer_store_dwordx4 v[152:155], v1, s[16:19], s44 offen offset:1024 sc1
    s_add_u32 m0, s43, 32768
    s_add_u32 s42, s41, 32768
    v_add_f32 v140, v28, v29
    v_add_f32 v144, v36, v37
    v_mul_f32 v141, v28, v28
    v_mul_f32 v145, v36, v36
    buffer_load_dwordx4 v1, s[16:19], s42 offen offset:0 sc1 lds
    v_fmac_f32 v141, v29, v29
    v_fmac_f32 v145, v37, v37
    v_add_f32 v140, v140, v30
    v_add_f32 v144, v144, v38
    v_fmac_f32 v141, v30, v30
    v_fmac_f32 v145, v38, v38
    v_add_f32 v140, v140, v31
    v_add_f32 v144, v144, v39
    buffer_load_dwordx4 v1, s[16:19], s42 offen offset:1024 sc1 lds
    v_fmac_f32 v141, v31, v31
    v_fmac_f32 v145, v39, v39
    v_add_f32 v140, v140, v32
    v_add_f32 v144, v144, v40
    v_fmac_f32 v141, v32, v32
    v_fmac_f32 v145, v40, v40
    v_add_f32 v140, v140, v33
    v_add_f32 v144, v144, v41
    buffer_load_dwordx4 v1, s[16:19], s42 offen offset:2048 sc1 lds
    v_fmac_f32 v141, v33, v33
    v_fmac_f32 v145, v41, v41
    v_add_f32 v140, v140, v34
    v_add_f32 v144, v144, v42
    v_fmac_f32 v141, v34, v34
    v_fmac_f32 v145, v42, v42
    v_add_f32 v140, v140, v35
    v_add_f32 v144, v144, v43
    buffer_load_dwordx4 v1, s[16:19], s42 offen offset:3072 sc1 lds
    v_fmac_f32 v141, v35, v35
    v_fmac_f32 v145, v43, v43
    s_nop 0
    v_permlane16_swap_b32 v140, v141
    v_permlane16_swap_b32 v144, v145
    v_add_f32 v140, v140, v141
    v_add_f32 v144, v144, v145
    v_mov_b32 v142, v140
    v_mov_b32 v146, v144
    s_nop 0
    v_permlane32_swap_b32 v140, v142
    v_permlane32_swap_b32 v144, v146
    v_add_f32 v140, v140, v142
    v_add_f32 v144, v144, v146
    ds_write_b32 v6, v140 offset:0
    ds_write_b32 v6, v144 offset:512
    s_waitcnt vmcnt(10) lgkmcnt(0)
    s_barrier
    ds_read_b128 v[44:47], v1 offset:0
    ds_read_b128 v[48:51], v1 offset:1024
    ds_read_b128 v[52:55], v1 offset:2048
    ds_read_b128 v[56:59], v1 offset:3072
    s_add_u32 s36, s36, 1
    s_cmp_lt_u32 s36, 32
    s_cbranch_scc1 L_o_b0
    s_nop 7
    ds_read_b128 v[140:143], v7
    s_cmp_eq_u32 s36, 0
    s_cselect_b32 s49, 0x5e00000, s46
    s_waitcnt lgkmcnt(0)
    v_add_f32 v140, v140, v141
    v_add_f32 v142, v142, v143
    v_add_f32 v140, v140, v142
    v_min_u32 v140, -2, v140
    buffer_store_dword v140, v8, s[16:19], s49 offen sc1
    s_waitcnt vmcnt(5)
    s_barrier
    buffer_store_dword v124, v124, s[16:19], s91 offen sc1
    s_add_u32 s91, s91, 65536
    s_waitcnt vmcnt(0)
    s_endpgm
L_spin26:
    s_mov_b32 s40, 0x20000
L_spin26_l:
    buffer_load_dword v12, v124, s[20:23], 0 offen sc1
    s_sub_u32 s40, s40, 1
    s_waitcnt vmcnt(0)
    v_cmp_eq_u32 vcc, v124, v12
    s_cbranch_scc1 L_back27
    s_cbranch_vccz L_back27
    s_sleep 8
    s_branch L_spin26_l
L_spin28:
    s_mov_b32 s40, 0x20000
L_spin28_l:
    buffer_load_dword v136, v4, s[16:19], s45 offen sc1
    s_sub_u32 s40, s40, 1
    s_waitcnt vmcnt(0)
    v_cmp_ne_u32 vcc, 0, v136
    s_cbranch_scc1 L_back29
    s_cbranch_vccz L_back29
    s_sleep 2
    s_branch L_spin28_l
L_spin30:
    s_mov_b32 s40, 0x20000
L_spin30_l:
    buffer_load_dword v136, v4, s[16:19], s45 offen sc1
    s_sub_u32 s40, s40, 1
    s_waitcnt vmcnt(0)
    v_cmp_ne_u32 vcc, 0, v136
    s_cbranch_scc1 L_back31
    s_cbranch_vccz L_back31
    s_sleep 2
    s_branch L_spin30_l
L_spin32:
    s_mov_b32 s40, 0x20000
L_spin32_l:
    buffer_load_dword v136, v4, s[16:19], s45 offen sc1
    s_sub_u32 s40, s40, 1
    s_waitcnt vmcnt(0)
    v_cmp_ne_u32 vcc, 0, v136
    s_cbranch_scc1 L_back33
    s_cbranch_vccz L_back33
    s_sleep 2
    s_branch L_spin32_l
L_role_40:
    s_sub_u32 s35, s34, 40
    s_lshl_b32 s51, s35, 2
    s_add_u32 s51, s51, 96
    s_lshl_b32 s54, s51, 6
    s_mov_b32 s12, s72
    s_mov_b32 s13, s73
    s_mov_b32 s14, 0x700000
    s_mov_b32 s15, 0x00020000
    s_mov_b32 s39, 7168
    v_lshrrev_b32 v64, 3, v0
    v_lshlrev_b32 v65, 2, v0
    v_and_b32 v65, 64, v65
    v_and_b32 v66, 0x70, v1
    v_xor_b32 v65, v65, v66
    v_mad_u32_u24 v56, v64, s39, v65
    v_add_u32 v57, 57344, v56
    v_add_u32 v58, 128, v56
    v_add_u32 v59, 57472, v56
    s_mul_i32 s38, s32, 114688
    s_add_u32 s54, s54, s38
    s_lshl_b32 s42, s32, 11
    s_add_u32 m0, s42, 0
    s_nop 0
    buffer_load_dwordx4 v56, s[12:15], s54 offen lds
    s_add_u32 m0, s42, 1024
    s_nop 0
    buffer_load_dwordx4 v57, s[12:15], s54 offen lds
    s_add_u32 m0, s42, 8192
    s_nop 0
    buffer_load_dwordx4 v58, s[12:15], s54 offen lds
    s_add_u32 m0, s42, 9216
    s_nop 0
    buffer_load_dwordx4 v59, s[12:15], s54 offen lds
    s_add_u32 s54, s54, 458752
    s_add_u32 m0, s42, 16384
    s_nop 0
    buffer_load_dwordx4 v56, s[12:15], s54 offen lds
    s_add_u32 m0, s42, 17408
    s_nop 0
    buffer_load_dwordx4 v57, s[12:15], s54 offen lds
    s_add_u32 m0, s42, 24576
    s_nop 0
    buffer_load_dwordx4 v58, s[12:15], s54 offen lds
    s_add_u32 m0, s42, 25600
    s_nop 0
    buffer_load_dwordx4 v59, s[12:15], s54 offen lds
    s_add_u32 s54, s54, 458752
    s_add_u32 m0, s42, 32768
    s_nop 0
    buffer_load_dwordx4 v56, s[12:15], s54 offen lds
    s_add_u32 m0, s42, 33792
    s_nop 0
    buffer_load_dwordx4 v57, s[12:15], s54 offen lds
    s_add_u32 m0, s42, 40960
    s_nop 0
    buffer_load_dwordx4 v58, s[12:15], s54 offen lds
    s_add_u32 m0, s42, 41984
    s_nop 0
    buffer_load_dwordx4 v59, s[12:15], s54 offen lds
    s_add_u32 s54, s54, 458752
    s_add_u32 m0, s42, 49152
    s_nop 0
    buffer_load_dwordx4 v56, s[12:15], s54 offen lds
    s_add_u32 m0, s42, 50176
    s_nop 0
    buffer_load_dwordx4 v57, s[12:15], s54 offen lds
    s_add_u32 m0, s42, 57344
    s_nop 0
    buffer_load_dwordx4 v58, s[12:15], s54 offen lds
    s_add_u32 m0, s42, 58368
    s_nop 0
    buffer_load_dwordx4 v59, s[12:15], s54 offen lds
    s_add_u32 s54, s54, 458752
    s_add_u32 m0, s42, 65536
    s_nop 0
    buffer_load_dwordx4 v56, s[12:15], s54 offen lds
    s_add_u32 m0, s42, 66560
    s_nop 0
    buffer_load_dwordx4 v57, s[12:15], s54 offen lds
    s_add_u32 m0, s42, 73728
    s_nop 0
    buffer_load_dwordx4 v58, s[12:15], s54 offen lds
    s_add_u32 m0, s42, 74752
    s_nop 0
    buffer_load_dwordx4 v59, s[12:15], s54 offen lds
    s_add_u32 s54, s54, 458752
    v_lshrrev_b32 v64, 4, v0
    v_bfe_u32 v65, v0, 2, 2
    v_lshl_add_u32 v64, v64, 3, v65
    v_lshlrev_b32 v64, 7, v64
    v_lshrrev_b32 v65, 1, v65
    v_lshl_add_u32 v64, v65, 6, v64
    v_and_b32 v65, 3, v0
    v_lshl_add_u32 v64, v65, 4, v64
    s_lshr_b32 s37, s32, 1
    s_lshl_b32 s37, s37, 13
    s_and_b32 s38, s32, 1
    s_lshl_b32 s38, s38, 6
    s_add_u32 s37, s37, s38
    s_add_u32 s37, s37, 0
    v_xor_b32 v60, s37, v64
    s_lshr_b32 s37, s32, 1
    s_lshl_b32 s37, s37, 13
    s_and_b32 s38, s32, 1
    s_lshl_b32 s38, s38, 6
    s_add_u32 s37, s37, s38
    s_add_u32 s37, s37, 8
    v_xor_b32 v61, s37, v64
    v_mov_b32 v64, 0x3f803f80
    v_mov_b32 v65, 0x3f803f80
    v_mov_b32 v66, 0x3f803f80
    v_mov_b32 v67, 0x3f803f80
    v_add_u32 v2, 98304, v1
    s_lshl_b32 s37, s33, 6
    s_add_u32 s37, s37, 16
    s_lshl_b32 s37, s37, 7
    v_lshl_add_u32 v5, v0, 7, s37
    s_cmp_eq_u32 s32, 0
    s_cselect_b32 s37, 8, 0
    v_cmp_le_u32 vcc, s37, v0
    s_nop 1
    v_cndmask_b32 v5, v5, 2.0, vcc
    s_lshl_b32 s43, s32, 12
    s_mul_i32 s41, s33, 2097152
    s_add_u32 s41, s41, 0x800000
    s_add_u32 s41, s41, s43
    s_mul_i32 s90, s33, 8388608
    s_add_u32 s90, s90, 0xfc0000
    s_add_u32 s37, s51, s32
    s_lshl_b32 s37, s37, 11
    s_add_u32 s90, s90, s37
    s_lshl_b32 s37, s32, 10
    s_sub_u32 s87, 8192, s37
    s_lshl_b32 s38, s35, 1
    s_lshr_b32 s39, s32, 1
    s_add_u32 s38, s38, s39
    s_cmp_eq_u32 s38, 36
    s_cselect_b32 s88, 0x5e00000, 0
    s_and_b32 s38, s32, 1
    s_lshl_b32 s38, s38, 3
    s_and_b32 s39, s32, 2
    s_lshl_b32 s39, s39, 10
    s_add_u32 s38, s38, s39
    s_add_u32 s38, s38, 65536
    v_add_u32 v3, s38, v1
    s_add_u32 s37, s37, 65536
    v_add_u32 v4, s37, v1
    v_and_b32 v6, 15, v0
    v_lshlrev_b32 v6, 3, v6
    v_lshrrev_b32 v8, 5, v0
    v_lshl_add_u32 v6, v8, 9, v6
    v_and_b32 v8, 16, v0
    v_lshl_add_u32 v6, v8, 6, v6
    v_add_u32 v118, 73728, v6
    s_mul_i32 s46, s33, 65536
    s_add_u32 s46, s46, 0x5440000
    s_add_u32 s55, s46, 63488
    s_and_b32 s52, s32, 1
    s_lshl_b32 s52, s52, 10
    s_mov_b32 s8, s74
    s_mov_b32 s9, s75
    s_mov_b32 s10, 0x1c00
    s_mov_b32 s11, 0x00020000
    v_and_b32 v8, 0x30, v0
    s_add_u32 s37, s51, s32
    s_lshl_b32 s37, s37, 6
    buffer_load_dwordx4 v[16:19], v8, s[8:11], s37 offen
    s_lshr_b32 s37, s32, 1
    s_add_u32 s37, s37, s51
    s_lshl_b32 s37, s37, 6
    s_and_b32 s38, s32, 1
    s_lshl_b32 s38, s38, 3
    s_add_u32 s37, s37, s38
    buffer_load_dwordx2 v[20:21], v8, s[8:11], s37 offen offset:256
    v_add_u32 v62, 0, v60
    v_add_u32 v63, 0, v61
    s_waitcnt vmcnt(18)
    s_barrier
    ds_read_b64_tr_b16 a[0:1], v62 offset:0
    ds_read_b64_tr_b16 a[2:3], v62 offset:512
    ds_read_b64_tr_b16 a[4:5], v63 offset:0
    ds_read_b64_tr_b16 a[6:7], v63 offset:512
    ds_read_b64_tr_b16 a[8:9], v62 offset:4096
    ds_read_b64_tr_b16 a[10:11], v62 offset:4608
    ds_read_b64_tr_b16 a[12:13], v63 offset:4096
    ds_read_b64_tr_b16 a[14:15], v63 offset:4608
    s_add_u32 m0, s42, 81920
    s_nop 0
    buffer_load_dwordx4 v56, s[12:15], s54 offen lds
    s_add_u32 m0, s42, 82944
    s_nop 0
    buffer_load_dwordx4 v57, s[12:15], s54 offen lds
    s_add_u32 m0, s42, 90112
    s_nop 0
    buffer_load_dwordx4 v58, s[12:15], s54 offen lds
    s_add_u32 m0, s42, 91136
    s_nop 0
    buffer_load_dwordx4 v59, s[12:15], s54 offen lds
    s_add_u32 s54, s54, 458752
    s_waitcnt lgkmcnt(0)
    v_mfma_f32_16x16x32_bf16 v[88:91], a[0:3], v[64:67], 0
    v_mfma_f32_16x16x32_bf16 v[92:95], a[4:7], v[64:67], 0
    v_mfma_f32_16x16x32_bf16 v[88:91], a[8:11], v[64:67], v[88:91]
    v_mfma_f32_16x16x32_bf16 v[92:95], a[12:15], v[64:67], v[92:95]
    v_add_u32 v62, 16384, v60
    v_add_u32 v63, 16384, v61
    s_waitcnt vmcnt(18)
    s_barrier
    ds_read_b64_tr_b16 a[16:17], v62 offset:0
    ds_read_b64_tr_b16 a[18:19], v62 offset:512
    ds_read_b64_tr_b16 a[20:21], v63 offset:0
    ds_read_b64_tr_b16 a[22:23], v63 offset:512
    ds_read_b64_tr_b16 a[24:25], v62 offset:4096
    ds_read_b64_tr_b16 a[26:27], v62 offset:4608
    ds_read_b64_tr_b16 a[28:29], v63 offset:4096
    ds_read_b64_tr_b16 a[30:31], v63 offset:4608
    s_add_u32 m0, s42, 0
    s_nop 0
    buffer_load_dwordx4 v56, s[12:15], s54 offen lds
    s_add_u32 m0, s42, 1024
    s_nop 0
    buffer_load_dwordx4 v57, s[12:15], s54 offen lds
    s_add_u32 m0, s42, 8192
    s_nop 0
    buffer_load_dwordx4 v58, s[12:15], s54 offen lds
    s_add_u32 m0, s42, 9216
    s_nop 0
    buffer_load_dwordx4 v59, s[12:15], s54 offen lds
    s_add_u32 s54, s54, 458752
    s_waitcnt lgkmcnt(0)
    v_mfma_f32_16x16x32_bf16 v[88:91], a[16:19], v[64:67], v[88:91]
    v_mfma_f32_16x16x32_bf16 v[92:95], a[20:23], v[64:67], v[92:95]
    v_mfma_f32_16x16x32_bf16 v[88:91], a[24:27], v[64:67], v[88:91]
    v_mfma_f32_16x16x32_bf16 v[92:95], a[28:31], v[64:67], v[92:95]
    v_add_u32 v62, 32768, v60
    v_add_u32 v63, 32768, v61
    s_waitcnt vmcnt(18)
    s_barrier
    ds_read_b64_tr_b16 a[32:33], v62 offset:0
    ds_read_b64_tr_b16 a[34:35], v62 offset:512
    ds_read_b64_tr_b16 a[36:37], v63 offset:0
    ds_read_b64_tr_b16 a[38:39], v63 offset:512
    ds_read_b64_tr_b16 a[40:41], v62 offset:4096
    ds_read_b64_tr_b16 a[42:43], v62 offset:4608
    ds_read_b64_tr_b16 a[44:45], v63 offset:4096
    ds_read_b64_tr_b16 a[46:47], v63 offset:4608
    s_add_u32 m0, s42, 16384
    s_nop 0
    buffer_load_dwordx4 v56, s[12:15], s54 offen lds
    s_add_u32 m0, s42, 17408
    s_nop 0
    buffer_load_dwordx4 v57, s[12:15], s54 offen lds
    s_add_u32 m0, s42, 24576
    s_nop 0
    buffer_load_dwordx4 v58, s[12:15], s54 offen lds
    s_add_u32 m0, s42, 25600
    s_nop 0
    buffer_load_dwordx4 v59, s[12:15], s54 offen lds
    s_add_u32 s54, s54, 458752
    s_waitcnt lgkmcnt(0)
    v_mfma_f32_16x16x32_bf16 v[88:91], a[32:35], v[64:67], v[88:91]
    v_mfma_f32_16x16x32_bf16 v[92:95], a[36:39], v[64:67], v[92:95]
    v_mfma_f32_16x16x32_bf16 v[88:91], a[40:43], v[64:67], v[88:91]
    v_mfma_f32_16x16x32_bf16 v[92:95], a[44:47], v[64:67], v[92:95]
    v_add_u32 v62, 49152, v60
    v_add_u32 v63, 49152, v61
    s_waitcnt vmcnt(18)
    s_barrier
    ds_read_b64_tr_b16 a[48:49], v62 offset:0
    ds_read_b64_tr_b16 a[50:51], v62 offset:512
    ds_read_b64_tr_b16 a[52:53], v63 offset:0
    ds_read_b64_tr_b16 a[54:55], v63 offset:512
    ds_read_b64_tr_b16 a[56:57], v62 offset:4096
    ds_read_b64_tr_b16 a[58:59], v62 offset:4608
    ds_read_b64_tr_b16 a[60:61], v63 offset:4096
    ds_read_b64_tr_b16 a[62:63], v63 offset:4608
    s_add_u32 m0, s42, 32768
    s_nop 0
    buffer_load_dwordx4 v56, s[12:15], s54 offen lds
    s_add_u32 m0, s42, 33792
    s_nop 0
    buffer_load_dwordx4 v57, s[12:15], s54 offen lds
    s_add_u32 m0, s42, 40960
    s_nop 0
    buffer_load_dwordx4 v58, s[12:15], s54 offen lds
    s_add_u32 m0, s42, 41984
    s_nop 0
    buffer_load_dwordx4 v59, s[12:15], s54 offen lds
    s_add_u32 s54, s54, 458752
    s_waitcnt lgkmcnt(0)
    v_mfma_f32_16x16x32_bf16 v[88:91], a[48:51], v[64:67], v[88:91]
    v_mfma_f32_16x16x32_bf16 v[92:95], a[52:55], v[64:67], v[92:95]
    v_mfma_f32_16x16x32_bf16 v[88:91], a[56:59], v[64:67], v[88:91]
    v_mfma_f32_16x16x32_bf16 v[92:95], a[60:63], v[64:67], v[92:95]
    v_add_u32 v62, 65536, v60
    v_add_u32 v63, 65536, v61
    s_waitcnt vmcnt(18)
    s_barrier
    ds_read_b64_tr_b16 a[64:65], v62 offset:0
    ds_read_b64_tr_b16 a[66:67], v62 offset:512
    ds_read_b64_tr_b16 a[68:69], v63 offset:0
    ds_read_b64_tr_b16 a[70:71], v63 offset:512
    ds_read_b64_tr_b16 a[72:73], v62 offset:4096
    ds_read_b64_tr_b16 a[74:75], v62 offset:4608
    ds_read_b64_tr_b16 a[76:77], v63 offset:4096
    ds_read_b64_tr_b16 a[78:79], v63 offset:4608
    s_add_u32 m0, s42, 49152
    s_nop 0
    buffer_load_dwordx4 v56, s[12:15], s54 offen lds
    s_add_u32 m0, s42, 50176
    s_nop 0
    buffer_load_dwordx4 v57, s[12:15], s54 offen lds
    s_add_u32 m0, s42, 57344
    s_nop 0
    buffer_load_dwordx4 v58, s[12:15], s54 offen lds
    s_add_u32 m0, s42, 58368
    s_nop 0
    buffer_load_dwordx4 v59, s[12:15], s54 offen lds
    s_add_u32 s54, s54, 458752
    s_waitcnt lgkmcnt(0)
    v_mfma_f32_16x16x32_bf16 v[88:91], a[64:67], v[64:67], v[88:91]
    v_mfma_f32_16x16x32_bf16 v[92:95], a[68:71], v[64:67], v[92:95]
    v_mfma_f32_16x16x32_bf16 v[88:91], a[72:75], v[64:67], v[88:91]
    v_mfma_f32_16x16x32_bf16 v[92:95], a[76:79], v[64:67], v[92:95]
    v_add_u32 v62, 81920, v60
    v_add_u32 v63, 81920, v61
    s_waitcnt vmcnt(16)
    s_barrier
    ds_read_b64_tr_b16 a[80:81], v62 offset:0
    ds_read_b64_tr_b16 a[82:83], v62 offset:512
    ds_read_b64_tr_b16 a[84:85], v63 offset:0
    ds_read_b64_tr_b16 a[86:87], v63 offset:512
    ds_read_b64_tr_b16 a[88:89], v62 offset:4096
    ds_read_b64_tr_b16 a[90:91], v62 offset:4608
    ds_read_b64_tr_b16 a[92:93], v63 offset:4096
    ds_read_b64_tr_b16 a[94:95], v63 offset:4608
    s_add_u32 m0, s42, 65536
    s_nop 0
    buffer_load_dwordx4 v56, s[12:15], s54 offen lds
    s_add_u32 m0, s42, 66560
    s_nop 0
    buffer_load_dwordx4 v57, s[12:15], s54 offen lds
    s_add_u32 m0, s42, 73728
    s_nop 0
    buffer_load_dwordx4 v58, s[12:15], s54 offen lds
    s_add_u32 m0, s42, 74752
    s_nop 0
    buffer_load_dwordx4 v59, s[12:15], s54 offen lds
    s_add_u32 s54, s54, 458752
    s_waitcnt lgkmcnt(0)
    v_mfma_f32_16x16x32_bf16 v[88:91], a[80:83], v[64:67], v[88:91]
    v_mfma_f32_16x16x32_bf16 v[92:95], a[84:87], v[64:67], v[92:95]
    v_mfma_f32_16x16x32_bf16 v[88:91], a[88:91], v[64:67], v[88:91]
    v_mfma_f32_16x16x32_bf16 v[92:95], a[92:95], v[64:67], v[92:95]
    v_add_u32 v62, 0, v60
    v_add_u32 v63, 0, v61
    s_waitcnt vmcnt(16)
    s_barrier
    ds_read_b64_tr_b16 a[96:97], v62 offset:0
    ds_read_b64_tr_b16 a[98:99], v62 offset:512
    ds_read_b64_tr_b16 a[100:101], v63 offset:0
    ds_read_b64_tr_b16 a[102:103], v63 offset:512
    ds_read_b64_tr_b16 a[104:105], v62 offset:4096
    ds_read_b64_tr_b16 a[106:107], v62 offset:4608
    ds_read_b64_tr_b16 a[108:109], v63 offset:4096
    ds_read_b64_tr_b16 a[110:111], v63 offset:4608
    s_add_u32 m0, s42, 81920
    s_nop 0
    buffer_load_dwordx4 v56, s[12:15], s54 offen lds
    s_add_u32 m0, s42, 82944
    s_nop 0
    buffer_load_dwordx4 v57, s[12:15], s54 offen lds
    s_add_u32 m0, s42, 90112
    s_nop 0
    buffer_load_dwordx4 v58, s[12:15], s54 offen lds
    s_add_u32 m0, s42, 91136
    s_nop 0
    buffer_load_dwordx4 v59, s[12:15], s54 offen lds
    s_add_u32 s54, s54, 458752
    s_waitcnt lgkmcnt(0)
    v_mfma_f32_16x16x32_bf16 v[88:91], a[96:99], v[64:67], v[88:91]
    v_mfma_f32_16x16x32_bf16 v[92:95], a[100:103], v[64:67], v[92:95]
    v_mfma_f32_16x16x32_bf16 v[88:91], a[104:107], v[64:67], v[88:91]
    v_mfma_f32_16x16x32_bf16 v[92:95], a[108:111], v[64:67], v[92:95]
    v_add_u32 v62, 16384, v60
    v_add_u32 v63, 16384, v61
    s_waitcnt vmcnt(16)
    s_barrier
    ds_read_b64_tr_b16 a[112:113], v62 offset:0
    ds_read_b64_tr_b16 a[114:115], v62 offset:512
    ds_read_b64_tr_b16 a[116:117], v63 offset:0
    ds_read_b64_tr_b16 a[118:119], v63 offset:512
    ds_read_b64_tr_b16 a[120:121], v62 offset:4096
    ds_read_b64_tr_b16 a[122:123], v62 offset:4608
    ds_read_b64_tr_b16 a[124:125], v63 offset:4096
    ds_read_b64_tr_b16 a[126:127], v63 offset:4608
    s_add_u32 m0, s42, 0
    s_nop 0
    buffer_load_dwordx4 v56, s[12:15], s54 offen lds
    s_add_u32 m0, s42, 1024
    s_nop 0
    buffer_load_dwordx4 v57, s[12:15], s54 offen lds
    s_add_u32 m0, s42, 8192
    s_nop 0
    buffer_load_dwordx4 v58, s[12:15], s54 offen lds
    s_add_u32 m0, s42, 9216
    s_nop 0
    buffer_load_dwordx4 v59, s[12:15], s54 offen lds
    s_add_u32 s54, s54, 458752
    s_waitcnt lgkmcnt(0)
    v_mfma_f32_16x16x32_bf16 v[88:91], a[112:115], v[64:67], v[88:91]
    v_mfma_f32_16x16x32_bf16 v[92:95], a[116:119], v[64:67], v[92:95]
    v_mfma_f32_16x16x32_bf16 v[88:91], a[120:123], v[64:67], v[88:91]
    v_mfma_f32_16x16x32_bf16 v[92:95], a[124:127], v[64:67], v[92:95]
    v_add_u32 v62, 32768, v60
    v_add_u32 v63, 32768, v61
    s_waitcnt vmcnt(16)
    s_barrier
    ds_read_b64_tr_b16 a[128:129], v62 offset:0
    ds_read_b64_tr_b16 a[130:131], v62 offset:512
    ds_read_b64_tr_b16 a[132:133], v63 offset:0
    ds_read_b64_tr_b16 a[134:135], v63 offset:512
    ds_read_b64_tr_b16 a[136:137], v62 offset:4096
    ds_read_b64_tr_b16 a[138:139], v62 offset:4608
    ds_read_b64_tr_b16 a[140:141], v63 offset:4096
    ds_read_b64_tr_b16 a[142:143], v63 offset:4608
    s_add_u32 m0, s42, 16384
    s_nop 0
    buffer_load_dwordx4 v56, s[12:15], s54 offen lds
    s_add_u32 m0, s42, 17408
    s_nop 0
    buffer_load_dwordx4 v57, s[12:15], s54 offen lds
    s_add_u32 m0, s42, 24576
    s_nop 0
    buffer_load_dwordx4 v58, s[12:15], s54 offen lds
    s_add_u32 m0, s42, 25600
    s_nop 0
    buffer_load_dwordx4 v59, s[12:15], s54 offen lds
    s_add_u32 s54, s54, 458752
    s_waitcnt lgkmcnt(0)
    v_mfma_f32_16x16x32_bf16 v[88:91], a[128:131], v[64:67], v[88:91]
    v_mfma_f32_16x16x32_bf16 v[92:95], a[132:135], v[64:67], v[92:95]
    v_mfma_f32_16x16x32_bf16 v[88:91], a[136:139], v[64:67], v[88:91]
    v_mfma_f32_16x16x32_bf16 v[92:95], a[140:143], v[64:67], v[92:95]
    v_add_u32 v62, 49152, v60
    v_add_u32 v63, 49152, v61
    s_waitcnt vmcnt(16)
    s_barrier
    ds_read_b64_tr_b16 a[144:145], v62 offset:0
    ds_read_b64_tr_b16 a[146:147], v62 offset:512
    ds_read_b64_tr_b16 a[148:149], v63 offset:0
    ds_read_b64_tr_b16 a[150:151], v63 offset:512
    ds_read_b64_tr_b16 a[152:153], v62 offset:4096
    ds_read_b64_tr_b16 a[154:155], v62 offset:4608
    ds_read_b64_tr_b16 a[156:157], v63 offset:4096
    ds_read_b64_tr_b16 a[158:159], v63 offset:4608
    s_add_u32 m0, s42, 32768
    s_nop 0
    buffer_load_dwordx4 v56, s[12:15], s54 offen lds
    s_add_u32 m0, s42, 33792
    s_nop 0
    buffer_load_dwordx4 v57, s[12:15], s54 offen lds
    s_add_u32 m0, s42, 40960
    s_nop 0
    buffer_load_dwordx4 v58, s[12:15], s54 offen lds
    s_add_u32 m0, s42, 41984
    s_nop 0
    buffer_load_dwordx4 v59, s[12:15], s54 offen lds
    s_add_u32 s54, s54, 458752
    s_waitcnt lgkmcnt(0)
    v_mfma_f32_16x16x32_bf16 v[88:91], a[144:147], v[64:67], v[88:91]
    v_mfma_f32_16x16x32_bf16 v[92:95], a[148:151], v[64:67], v[92:95]
    v_mfma_f32_16x16x32_bf16 v[88:91], a[152:155], v[64:67], v[88:91]
    v_mfma_f32_16x16x32_bf16 v[92:95], a[156:159], v[64:67], v[92:95]
    v_add_u32 v62, 65536, v60
    v_add_u32 v63, 65536, v61
    s_waitcnt vmcnt(16)
    s_barrier
    ds_read_b64_tr_b16 a[160:161], v62 offset:0
    ds_read_b64_tr_b16 a[162:163], v62 offset:512
    ds_read_b64_tr_b16 a[164:165], v63 offset:0
    ds_read_b64_tr_b16 a[166:167], v63 offset:512
    ds_read_b64_tr_b16 a[168:169], v62 offset:4096
    ds_read_b64_tr_b16 a[170:171], v62 offset:4608
    ds_read_b64_tr_b16 a[172:173], v63 offset:4096
    ds_read_b64_tr_b16 a[174:175], v63 offset:4608
    s_add_u32 m0, s42, 49152
    s_nop 0
    buffer_load_dwordx4 v56, s[12:15], s54 offen lds
    s_add_u32 m0, s42, 50176
    s_nop 0
    buffer_load_dwordx4 v57, s[12:15], s54 offen lds
    s_add_u32 m0, s42, 57344
    s_nop 0
    buffer_load_dwordx4 v58, s[12:15], s54 offen lds
    s_add_u32 m0, s42, 58368
    s_nop 0
    buffer_load_dwordx4 v59, s[12:15], s54 offen lds
    s_add_u32 s54, s54, 458752
    s_waitcnt lgkmcnt(0)
    v_mfma_f32_16x16x32_bf16 v[88:91], a[160:163], v[64:67], v[88:91]
    v_mfma_f32_16x16x32_bf16 v[92:95], a[164:167], v[64:67], v[92:95]
    v_mfma_f32_16x16x32_bf16 v[88:91], a[168:171], v[64:67], v[88:91]
    v_mfma_f32_16x16x32_bf16 v[92:95], a[172:175], v[64:67], v[92:95]
    v_add_u32 v62, 81920, v60
    v_add_u32 v63, 81920, v61
    s_waitcnt vmcnt(16)
    s_barrier
    ds_read_b64_tr_b16 a[176:177], v62 offset:0
    ds_read_b64_tr_b16 a[178:179], v62 offset:512
    ds_read_b64_tr_b16 a[180:181], v63 offset:0
    ds_read_b64_tr_b16 a[182:183], v63 offset:512
    ds_read_b64_tr_b16 a[184:185], v62 offset:4096
    ds_read_b64_tr_b16 a[186:187], v62 offset:4608
    ds_read_b64_tr_b16 a[188:189], v63 offset:4096
    ds_read_b64_tr_b16 a[190:191], v63 offset:4608
    s_waitcnt lgkmcnt(0)
    v_mfma_f32_16x16x32_bf16 v[88:91], a[176:179], v[64:67], v[88:91]
    v_mfma_f32_16x16x32_bf16 v[92:95], a[180:183], v[64:67], v[92:95]
    v_mfma_f32_16x16x32_bf16 v[88:91], a[184:187], v[64:67], v[88:91]
    v_mfma_f32_16x16x32_bf16 v[92:95], a[188:191], v[64:67], v[92:95]
    v_add_u32 v62, 0, v60
    v_add_u32 v63, 0, v61
    s_waitcnt vmcnt(12)
    s_barrier
    ds_read_b64_tr_b16 a[192:193], v62 offset:0
    ds_read_b64_tr_b16 a[194:195], v62 offset:512
    ds_read_b64_tr_b16 a[196:197], v63 offset:0
    ds_read_b64_tr_b16 a[198:199], v63 offset:512
    ds_read_b64_tr_b16 a[200:201], v62 offset:4096
    ds_read_b64_tr_b16 a[202:203], v62 offset:4608
    ds_read_b64_tr_b16 a[204:205], v63 offset:4096
    ds_read_b64_tr_b16 a[206:207], v63 offset:4608
    s_waitcnt lgkmcnt(0)
    v_mfma_f32_16x16x32_bf16 v[88:91], a[192:195], v[64:67], v[88:91]
    v_mfma_f32_16x16x32_bf16 v[92:95], a[196:199], v[64:67], v[92:95]
    v_mfma_f32_16x16x32_bf16 v[88:91], a[200:203], v[64:67], v[88:91]
    v_mfma_f32_16x16x32_bf16 v[92:95], a[204:207], v[64:67], v[92:95]
    v_add_u32 v62, 16384, v60
    v_add_u32 v63, 16384, v61
    s_waitcnt vmcnt(8)
    s_barrier
    ds_read_b64_tr_b16 a[208:209], v62 offset:0
    ds_read_b64_tr_b16 a[210:211], v62 offset:512
    ds_read_b64_tr_b16 a[212:213], v63 offset:0
    ds_read_b64_tr_b16 a[214:215], v63 offset:512
    ds_read_b64_tr_b16 a[216:217], v62 offset:4096
    ds_read_b64_tr_b16 a[218:219], v62 offset:4608
    ds_read_b64_tr_b16 a[220:221], v63 offset:4096
    ds_read_b64_tr_b16 a[222:223], v63 offset:4608
    s_waitcnt lgkmcnt(0)
    v_mfma_f32_16x16x32_bf16 v[88:91], a[208:211], v[64:67], v[88:91]
    v_mfma_f32_16x16x32_bf16 v[92:95], a[212:215], v[64:67], v[92:95]
    v_mfma_f32_16x16x32_bf16 v[88:91], a[216:219], v[64:67], v[88:91]
    v_mfma_f32_16x16x32_bf16 v[92:95], a[220:223], v[64:67], v[92:95]
    v_add_u32 v62, 32768, v60
    v_add_u32 v63, 32768, v61
    s_waitcnt vmcnt(4)
    s_barrier
    ds_read_b64_tr_b16 a[224:225], v62 offset:0
    ds_read_b64_tr_b16 a[226:227], v62 offset:512
    ds_read_b64_tr_b16 a[228:229], v63 offset:0
    ds_read_b64_tr_b16 a[230:231], v63 offset:512
    ds_read_b64_tr_b16 a[232:233], v62 offset:4096
    ds_read_b64_tr_b16 a[234:235], v62 offset:4608
    ds_read_b64_tr_b16 a[236:237], v63 offset:4096
    ds_read_b64_tr_b16 a[238:239], v63 offset:4608
    s_waitcnt lgkmcnt(0)
    v_mfma_f32_16x16x32_bf16 v[88:91], a[224:227], v[64:67], v[88:91]
    v_mfma_f32_16x16x32_bf16 v[92:95], a[228:231], v[64:67], v[92:95]
    v_mfma_f32_16x16x32_bf16 v[88:91], a[232:235], v[64:67], v[88:91]
    v_mfma_f32_16x16x32_bf16 v[92:95], a[236:239], v[64:67], v[92:95]
    v_add_u32 v62, 49152, v60
    v_add_u32 v63, 49152, v61
    s_waitcnt vmcnt(0)
    s_barrier
    ds_read_b64_tr_b16 a[240:241], v62 offset:0
    ds_read_b64_tr_b16 a[242:243], v62 offset:512
    ds_read_b64_tr_b16 a[244:245], v63 offset:0
    ds_read_b64_tr_b16 a[246:247], v63 offset:512
    ds_read_b64_tr_b16 a[248:249], v62 offset:4096
    ds_read_b64_tr_b16 a[250:251], v62 offset:4608
    ds_read_b64_tr_b16 a[252:253], v63 offset:4096
    ds_read_b64_tr_b16 a[254:255], v63 offset:4608
    s_waitcnt lgkmcnt(0)
    v_mfma_f32_16x16x32_bf16 v[88:91], a[240:243], v[64:67], v[88:91]
    v_mfma_f32_16x16x32_bf16 v[92:95], a[244:247], v[64:67], v[92:95]
    v_mfma_f32_16x16x32_bf16 v[88:91], a[248:251], v[64:67], v[88:91]
    v_mfma_f32_16x16x32_bf16 v[92:95], a[252:255], v[64:67], v[92:95]
    s_barrier
    s_mov_b32 s37, 0xffff0000
    v_lshlrev_b32 v100, 16, v16
    v_and_b32 v101, s37, v16
    v_lshlrev_b32 v102, 16, v17
    v_and_b32 v103, s37, v17
    v_lshlrev_b32 v104, 16, v18
    v_and_b32 v105, s37, v18
    v_lshlrev_b32 v106, 16, v19
    v_and_b32 v107, s37, v19
    v_lshlrev_b32 v108, 16, v20
    v_and_b32 v109, s37, v20
    v_lshlrev_b32 v110, 16, v21
    v_and_b32 v111, s37, v21
    s_cmp_lg_u32 s32, 0
    s_cbranch_scc1 L_arv34
    s_add_u32 s20, s82, 0x80
    s_addc_u32 s21, s83, 0
    s_mov_b32 s22, 0x4
    s_mov_b32 s23, 0x00020000
    buffer_load_dword v56, v124, s[20:23], 0 offen sc1
    s_waitcnt vmcnt(0)
    v_cmp_eq_u32 vcc, v124, v56
    s_cbranch_vccnz L_spin35
L_back36:
L_arv34:
    s_add_u32 s96, s41, 2031616
    s_mov_b32 s98, s41
    s_mov_b32 s45, 0x5530000
    buffer_load_dword v7, v5, s[16:19], s45 offen sc1
    s_waitcnt vmcnt(0)
    v_cmp_ne_u32 vcc, 0, v7
    s_cbranch_vccnz L_spin37
L_back38:
    s_barrier
    s_add_u32 m0, s43, 0
    s_add_u32 s42, s41, 0
    buffer_load_dwordx4 v1, s[16:19], s42 offen offset:0 sc1 lds
    buffer_load_dwordx4 v1, s[16:19], s42 offen offset:1024 sc1 lds
    buffer_load_dwordx4 v1, s[16:19], s42 offen offset:2048 sc1 lds
    buffer_load_dwordx4 v1, s[16:19], s42 offen offset:3072 sc1 lds
    s_add_u32 m0, s43, 16384
    s_add_u32 s42, s41, 16384
    buffer_load_dwordx4 v1, s[16:19], s42 offen offset:0 sc1 lds
    buffer_load_dwordx4 v1, s[16:19], s42 offen offset:1024 sc1 lds
    buffer_load_dwordx4 v1, s[16:19], s42 offen offset:2048 sc1 lds
    buffer_load_dwordx4 v1, s[16:19], s42 offen offset:3072 sc1 lds
    s_add_u32 s45, s45, 65536
    s_waitcnt vmcnt(0) lgkmcnt(0)
    s_barrier
    ds_read_b128 v[56:59], v1 offset:0
    ds_read_b128 v[60:63], v1 offset:1024
    ds_read_b128 v[64:67], v1 offset:2048
    ds_read_b128 v[68:71], v1 offset:3072
    s_mov_b32 s36, 0
    s_waitcnt lgkmcnt(0)
    s_nop 7
L_l_b0:
    s_waitcnt lgkmcnt(2)
    v_mfma_f32_16x16x32_bf16 v[8:11], a[0:3], v[56:59], 0
    s_add_u32 m0, s52, 73728
    ds_read_b128 v[72:75], v1 offset:4096
    s_add_u32 s42, s46, s52
    v_mfma_f32_16x16x32_bf16 v[16:19], a[0:3], v[60:63], 0
    buffer_load_dwordx4 v1, s[16:19], s42 offen sc1 lds
    v_mfma_f32_16x16x32_bf16 v[20:23], a[4:7], v[60:63], 0
    s_add_u32 m0, s43, 32768
    ds_read_b128 v[76:79], v1 offset:5120
    s_add_u32 s42, s41, 32768
    v_mfma_f32_16x16x32_bf16 v[12:15], a[4:7], v[56:59], 0
    s_waitcnt lgkmcnt(2)
    buffer_load_dwordx4 v1, s[16:19], s42 offen offset:0 sc1 lds
    v_mfma_f32_16x16x32_bf16 v[8:11], a[8:11], v[64:67], v[8:11]
    s_and_b32 s44, s90, 0xffffffff
    ds_read_b128 v[80:83], v1 offset:6144
    s_cmp_lt_i32 s36, 1
    v_mfma_f32_16x16x32_bf16 v[16:19], a[8:11], v[68:71], v[16:19]
    buffer_load_dwordx4 v1, s[16:19], s42 offen offset:1024 sc1 lds
    v_mfma_f32_16x16x32_bf16 v[20:23], a[12:15], v[68:71], v[20:23]
    s_cselect_b32 s44, 0x5e00000, s44
    ds_read_b128 v[84:87], v1 offset:7168
    s_add_u32 s90, s90, 262144
    v_mfma_f32_16x16x32_bf16 v[12:15], a[12:15], v[64:67], v[12:15]
    s_waitcnt lgkmcnt(2)
    buffer_load_dwordx4 v1, s[16:19], s42 offen offset:2048 sc1 lds
    v_mfma_f32_16x16x32_bf16 v[8:11], a[16:19], v[72:75], v[8:11]
    ds_read_b128 v[56:59], v1 offset:8192
    v_add_f32 v32, v32, v128
    v_mfma_f32_16x16x32_bf16 v[16:19], a[16:19], v[76:79], v[16:19]
    buffer_load_dwordx4 v1, s[16:19], s42 offen offset:3072 sc1 lds
    v_mfma_f32_16x16x32_bf16 v[20:23], a[20:23], v[76:79], v[20:23]
    s_add_u32 m0, s43, 49152
    ds_read_b128 v[60:63], v1 offset:9216
    v_add_f32 v33, v33, v129
    v_mfma_f32_16x16x32_bf16 v[12:15], a[20:23], v[72:75], v[12:15]
    s_waitcnt lgkmcnt(2)
    v_mul_f32 v120, v32, v116
    v_mul_f32 v121, v33, v116
    v_mfma_f32_16x16x32_bf16 v[8:11], a[24:27], v[80:83], v[8:11]
    s_add_u32 s42, s41, 49152
    ds_read_b128 v[64:67], v1 offset:10240
    buffer_load_dwordx4 v1, s[16:19], s42 offen offset:0 sc1 lds
    v_mfma_f32_16x16x32_bf16 v[16:19], a[24:27], v[84:87], v[16:19]
    v_mul_f32 v120, v120, abs(v32)
    v_mul_f32 v121, v121, abs(v33)
    v_mfma_f32_16x16x32_bf16 v[20:23], a[28:31], v[84:87], v[20:23]
    ds_read_b128 v[68:71], v1 offset:11264
    buffer_load_dwordx4 v1, s[16:19], s42 offen offset:1024 sc1 lds
    v_mfma_f32_16x16x32_bf16 v[12:15], a[28:31], v[80:83], v[12:15]
    s_waitcnt lgkmcnt(2)
    v_cvt_pk_bf16_f32 v32, v120, v121
    v_pk_max_i16 v32, v32, 0
    v_mfma_f32_16x16x32_bf16 v[8:11], a[32:35], v[56:59], v[8:11]
    ds_read_b128 v[72:75], v1 offset:12288
    buffer_load_dwordx4 v1, s[16:19], s42 offen offset:2048 sc1 lds
    v_mfma_f32_16x16x32_bf16 v[16:19], a[32:35], v[60:63], v[16:19]
    v_add_f32 v34, v34, v130
    v_add_f32 v35, v35, v131
    v_mfma_f32_16x16x32_bf16 v[20:23], a[36:39], v[60:63], v[20:23]
    ds_read_b128 v[76:79], v1 offset:13312
    buffer_load_dwordx4 v1, s[16:19], s42 offen offset:3072 sc1 lds
    v_mfma_f32_16x16x32_bf16 v[12:15], a[36:39], v[56:59], v[12:15]
    s_waitcnt lgkmcnt(2)
    v_mul_f32 v120, v34, v116
    v_mul_f32 v121, v35, v116
    v_mfma_f32_16x16x32_bf16 v[8:11], a[40:43], v[64:67], v[8:11]
    s_add_u32 s98, s98, 65536
    ds_read_b128 v[80:83], v1 offset:14336
    v_mul_f32 v120, v120, abs(v34)
    v_mfma_f32_16x16x32_bf16 v[16:19], a[40:43], v[68:71], v[16:19]
    s_min_i32 s98, s98, s96
    v_mul_f32 v121, v121, abs(v35)
    v_cvt_pk_bf16_f32 v33, v120, v121
    v_mfma_f32_16x16x32_bf16 v[20:23], a[44:47], v[68:71], v[20:23]
    s_and_b32 s41, s98, 0xffffffff
    ds_read_b128 v[84:87], v1 offset:15360
    v_pk_max_i16 v33, v33, 0
    v_mfma_f32_16x16x32_bf16 v[12:15], a[44:47], v[64:67], v[12:15]
    s_waitcnt vmcnt(9) lgkmcnt(2)
    s_barrier
    v_add_f32 v36, v36, v132
    v_mfma_f32_16x16x32_bf16 v[8:11], a[48:51], v[72:75], v[8:11]
    ds_read_b128 v[56:59], v1 offset:16384
    v_add_f32 v37, v37, v133
    v_mfma_f32_16x16x32_bf16 v[16:19], a[48:51], v[76:79], v[16:19]
    v_mul_f32 v120, v36, v116
    v_mul_f32 v121, v37, v116
    v_mfma_f32_16x16x32_bf16 v[20:23], a[52:55], v[76:79], v[20:23]
    ds_read_b128 v[60:63], v1 offset:17408
    v_mul_f32 v120, v120, abs(v36)
    v_mfma_f32_16x16x32_bf16 v[12:15], a[52:55], v[72:75], v[12:15]
    s_waitcnt lgkmcnt(2)
    v_mul_f32 v121, v121, abs(v37)
    v_cvt_pk_bf16_f32 v34, v120, v121
    v_mfma_f32_16x16x32_bf16 v[8:11], a[56:59], v[80:83], v[8:11]
    ds_read_b128 v[64:67], v1 offset:18432
    v_pk_max_i16 v34, v34, 0
    v_mfma_f32_16x16x32_bf16 v[16:19], a[56:59], v[84:87], v[16:19]
    v_add_f32 v38, v38, v134
    v_add_f32 v39, v39, v135
    v_mfma_f32_16x16x32_bf16 v[20:23], a[60:63], v[84:87], v[20:23]
    ds_read_b128 v[68:71], v1 offset:19456
    v_mul_f32 v120, v38, v116
    v_mfma_f32_16x16x32_bf16 v[12:15], a[60:63], v[80:83], v[12:15]
    s_waitcnt lgkmcnt(2)
    v_mul_f32 v121, v39, v116
    v_mul_f32 v120, v120, abs(v38)
    v_mfma_f32_16x16x32_bf16 v[8:11], a[64:67], v[56:59], v[8:11]
    ds_read_b128 v[72:75], v1 offset:20480
    v_mul_f32 v121, v121, abs(v39)
    v_mfma_f32_16x16x32_bf16 v[16:19], a[64:67], v[60:63], v[16:19]
    v_cvt_pk_bf16_f32 v35, v120, v121
    v_pk_max_i16 v35, v35, 0
    v_mfma_f32_16x16x32_bf16 v[20:23], a[68:71], v[60:63], v[20:23]
    ds_read_b128 v[76:79], v1 offset:21504
    buffer_store_dwordx4 v[32:35], v1, s[16:19], s44 offen offset:0 sc1
    v_mfma_f32_16x16x32_bf16 v[12:15], a[68:71], v[56:59], v[12:15]
    s_waitcnt lgkmcnt(2)
    v_add_f32 v40, v40, v136
    v_add_f32 v41, v41, v137
    v_mfma_f32_16x16x32_bf16 v[8:11], a[72:75], v[64:67], v[8:11]
    ds_read_b128 v[80:83], v1 offset:22528
    v_mul_f32 v120, v40, v117
    v_mfma_f32_16x16x32_bf16 v[16:19], a[72:75], v[68:71], v[16:19]
    v_mul_f32 v121, v41, v117
    v_mul_f32 v120, v120, abs(v40)
    v_mfma_f32_16x16x32_bf16 v[20:23], a[76:79], v[68:71], v[20:23]
    ds_read_b128 v[84:87], v1 offset:23552
    v_mul_f32 v121, v121, abs(v41)
    v_mfma_f32_16x16x32_bf16 v[12:15], a[76:79], v[64:67], v[12:15]
    s_waitcnt lgkmcnt(2)
    v_cvt_pk_bf16_f32 v40, v120, v121
    v_pk_max_i16 v40, v40, 0
    v_mfma_f32_16x16x32_bf16 v[8:11], a[80:83], v[72:75], v[8:11]
    ds_read_b128 v[56:59], v1 offset:24576
    v_add_f32 v42, v42, v138
    v_mfma_f32_16x16x32_bf16 v[16:19], a[80:83], v[76:79], v[16:19]
    v_add_f32 v43, v43, v139
    v_mul_f32 v120, v42, v117
    v_mfma_f32_16x16x32_bf16 v[20:23], a[84:87], v[76:79], v[20:23]
    ds_read_b128 v[60:63], v1 offset:25600
    v_mul_f32 v121, v43, v117
    v_mfma_f32_16x16x32_bf16 v[12:15], a[84:87], v[72:75], v[12:15]
    s_waitcnt lgkmcnt(2)
    v_mul_f32 v120, v120, abs(v42)
    v_mul_f32 v121, v121, abs(v43)
    v_mfma_f32_16x16x32_bf16 v[8:11], a[88:91], v[80:83], v[8:11]
    ds_read_b128 v[64:67], v1 offset:26624
    v_cvt_pk_bf16_f32 v41, v120, v121
    v_mfma_f32_16x16x32_bf16 v[16:19], a[88:91], v[84:87], v[16:19]
    v_pk_max_i16 v41, v41, 0
    v_add_f32 v44, v44, v140
    v_mfma_f32_16x16x32_bf16 v[20:23], a[92:95], v[84:87], v[20:23]
    ds_read_b128 v[68:71], v1 offset:27648
    v_add_f32 v45, v45, v141
    v_mfma_f32_16x16x32_bf16 v[12:15], a[92:95], v[80:83], v[12:15]
    s_waitcnt lgkmcnt(2)
    v_mul_f32 v120, v44, v117
    v_mul_f32 v121, v45, v117
    v_mfma_f32_16x16x32_bf16 v[8:11], a[96:99], v[56:59], v[8:11]
    ds_read_b128 v[72:75], v1 offset:28672
    v_mul_f32 v120, v120, abs(v44)
    v_mfma_f32_16x16x32_bf16 v[16:19], a[96:99], v[60:63], v[16:19]
    v_mul_f32 v121, v121, abs(v45)
    v_cvt_pk_bf16_f32 v42, v120, v121
    v_mfma_f32_16x16x32_bf16 v[20:23], a[100:103], v[60:63], v[20:23]
    ds_read_b128 v[76:79], v1 offset:29696
    buffer_load_dword v7, v5, s[16:19], s45 offen sc1
    v_mfma_f32_16x16x32_bf16 v[12:15], a[100:103], v[56:59], v[12:15]
    s_waitcnt lgkmcnt(2)
    v_pk_max_i16 v42, v42, 0
    v_add_f32 v46, v46, v142
    v_mfma_f32_16x16x32_bf16 v[8:11], a[104:107], v[64:67], v[8:11]
    ds_read_b128 v[80:83], v1 offset:30720
    v_add_f32 v47, v47, v143
    v_mfma_f32_16x16x32_bf16 v[16:19], a[104:107], v[68:71], v[16:19]
    v_mul_f32 v120, v46, v117
    v_mul_f32 v121, v47, v117
    v_mfma_f32_16x16x32_bf16 v[20:23], a[108:111], v[68:71], v[20:23]
    ds_read_b128 v[84:87], v1 offset:31744
    v_mul_f32 v120, v120, abs(v46)
    v_mfma_f32_16x16x32_bf16 v[12:15], a[108:111], v[64:67], v[12:15]
    s_waitcnt vmcnt(6) lgkmcnt(2)
    s_barrier
    v_mul_f32 v121, v121, abs(v47)
    v_mfma_f32_16x16x32_bf16 v[8:11], a[112:115], v[72:75], v[8:11]
    ds_read_b128 v[56:59], v1 offset:32768
    v_cvt_pk_bf16_f32 v43, v120, v121
    v_mfma_f32_16x16x32_bf16 v[16:19], a[112:115], v[76:79], v[16:19]
    v_pk_max_i16 v43, v43, 0
    buffer_store_dwordx4 v[40:43], v1, s[16:19], s44 offen offset:1024 sc1
    v_mfma_f32_16x16x32_bf16 v[20:23], a[116:119], v[76:79], v[20:23]
    s_add_u32 m0, s43, 98304
    ds_read_b128 v[60:63], v1 offset:33792
    ds_read_b64 v[144:145], v118 offset:0
    v_mfma_f32_16x16x32_bf16 v[12:15], a[116:119], v[72:75], v[12:15]
    s_waitcnt lgkmcnt(3)
    ds_read_b64 v[146:147], v118 offset:128
    ds_read_b64 v[148:149], v118 offset:256
    v_mfma_f32_16x16x32_bf16 v[8:11], a[120:123], v[80:83], v[8:11]
    s_add_u32 s42, s41, 0
    ds_read_b128 v[64:67], v1 offset:34816
    ds_read_b64 v[150:151], v118 offset:384
    v_mfma_f32_16x16x32_bf16 v[16:19], a[120:123], v[84:87], v[16:19]
    v_mfma_f32_16x16x32_bf16 v[20:23], a[124:127], v[84:87], v[20:23]
    ds_read_b128 v[68:71], v1 offset:35840
    v_mfma_f32_16x16x32_bf16 v[12:15], a[124:127], v[80:83], v[12:15]
    s_waitcnt lgkmcnt(6)
    v_mfma_f32_16x16x32_bf16 v[8:11], a[128:131], v[56:59], v[8:11]
    ds_read_b128 v[72:75], v1 offset:36864
    v_mfma_f32_16x16x32_bf16 v[16:19], a[128:131], v[60:63], v[16:19]
    s_waitcnt lgkmcnt(2)
    v_max3_u32 v152, v144, v145, v146
    v_max3_u32 v153, v147, v148, v149
    v_mfma_f32_16x16x32_bf16 v[20:23], a[132:135], v[60:63], v[20:23]
    ds_read_b128 v[76:79], v1 offset:37888
    v_max3_u32 v152, v152, v150, v151
    v_mfma_f32_16x16x32_bf16 v[12:15], a[132:135], v[56:59], v[12:15]
    s_waitcnt lgkmcnt(2)
    v_max_u32 v152, v152, v153
    v_cmp_eq_u32 vcc, -1, v152
    v_mfma_f32_16x16x32_bf16 v[8:11], a[136:139], v[64:67], v[8:11]
    ds_read_b128 v[80:83], v1 offset:38912
    v_mfma_f32_16x16x32_bf16 v[16:19], a[136:139], v[68:71], v[16:19]
    s_cbranch_vccnz L_sspin41
L_sback42:
    v_add_f32 v152, v148, v150
    v_add_f32 v153, v149, v151
    v_mfma_f32_16x16x32_bf16 v[20:23], a[140:143], v[68:71], v[20:23]
    ds_read_b128 v[84:87], v1 offset:39936
    v_add_f32 v144, v144, v146
    v_mfma_f32_16x16x32_bf16 v[12:15], a[140:143], v[64:67], v[12:15]
    s_waitcnt lgkmcnt(2)
    v_add_f32 v145, v145, v147
    v_add_f32 v144, v144, v152
    v_mfma_f32_16x16x32_bf16 v[8:11], a[144:147], v[72:75], v[8:11]
    ds_read_b128 v[56:59], v1 offset:40960
    v_add_f32 v145, v145, v153
    v_mfma_f32_16x16x32_bf16 v[16:19], a[144:147], v[76:79], v[16:19]
    v_mov_b32 v152, v144
    v_mov_b32 v153, v145
    v_mfma_f32_16x16x32_bf16 v[20:23], a[148:151], v[76:79], v[20:23]
    ds_read_b128 v[60:63], v1 offset:41984
    v_permlane32_swap_b32 v144, v152
    v_mfma_f32_16x16x32_bf16 v[12:15], a[148:151], v[72:75], v[12:15]
    s_waitcnt lgkmcnt(2)
    v_permlane32_swap_b32 v145, v153
    v_mfma_f32_16x16x32_bf16 v[8:11], a[152:155], v[80:83], v[8:11]
    ds_read_b128 v[64:67], v1 offset:43008
    v_add_f32 v144, v144, v152
    v_mfma_f32_16x16x32_bf16 v[16:19], a[152:155], v[84:87], v[16:19]
    v_add_f32 v145, v145, v153
    v_mul_f32 v112, 0xba800000, v144
    v_mfma_f32_16x16x32_bf16 v[20:23], a[156:159], v[84:87], v[20:23]
    ds_read_b128 v[68:71], v1 offset:44032
    v_mul_f32 v145, 0x3a800000, v145
    v_mfma_f32_16x16x32_bf16 v[12:15], a[156:159], v[80:83], v[12:15]
    s_waitcnt lgkmcnt(2)
    v_fma_f32 v145, -v112, v112, v145
    v_mov_b32 v113, v112
    v_mfma_f32_16x16x32_bf16 v[8:11], a[160:163], v[56:59], v[8:11]
    ds_read_b128 v[72:75], v1 offset:45056
    v_max_f32 v145, 0, v145
    v_mfma_f32_16x16x32_bf16 v[16:19], a[160:163], v[60:63], v[16:19]
    v_add_f32 v145, 0x3727c5ac, v145
    v_rsq_f32 v116, v145
    v_mfma_f32_16x16x32_bf16 v[20:23], a[164:167], v[60:63], v[20:23]
    ds_read_b128 v[76:79], v1 offset:46080
    v_permlane16_swap_b32 v112, v113
    v_mfma_f32_16x16x32_bf16 v[12:15], a[164:167], v[56:59], v[12:15]
    s_waitcnt lgkmcnt(2)
    v_mul_f32 v114, v145, v116
    v_mul_f32 v116, v116, v116
    v_mfma_f32_16x16x32_bf16 v[8:11], a[168:171], v[64:67], v[8:11]
    s_waitcnt vmcnt(0)
    ds_read_b128 v[80:83], v1 offset:47104
    v_mov_b32 v115, v114
    v_mfma_f32_16x16x32_bf16 v[16:19], a[168:171], v[68:71], v[16:19]
    s_barrier
    buffer_store_dword v124, v124, s[16:19], s91 offen sc1
    v_mfma_f32_16x16x32_bf16 v[20:23], a[172:175], v[68:71], v[20:23]
    s_add_u32 s91, s91, 65536
    ds_read_b128 v[84:87], v1 offset:48128
    v_cmp_ne_u32 vcc, 0, v7
    v_mfma_f32_16x16x32_bf16 v[12:15], a[172:175], v[64:67], v[12:15]
    s_waitcnt lgkmcnt(2)
    v_mov_b32 v117, v116
    v_permlane16_swap_b32 v114, v115
    v_mfma_f32_16x16x32_bf16 v[8:11], a[176:179], v[72:75], v[8:11]
    s_cbranch_vccnz L_spin39
L_back40:
    ds_read_b128 v[56:59], v1 offset:49152
    v_permlane16_swap_b32 v116, v117
    v_mfma_f32_16x16x32_bf16 v[16:19], a[176:179], v[76:79], v[16:19]
    s_barrier
    buffer_load_dwordx4 v1, s[16:19], s42 offen offset:0 sc1 lds
    v_mfma_f32_16x16x32_bf16 v[20:23], a[180:183], v[76:79], v[20:23]
    s_add_u32 s46, s46, 2048
    ds_read_b128 v[60:63], v1 offset:50176
    buffer_load_dwordx4 v1, s[16:19], s42 offen offset:1024 sc1 lds
    v_mfma_f32_16x16x32_bf16 v[12:15], a[180:183], v[72:75], v[12:15]
    s_waitcnt lgkmcnt(2)
    buffer_load_dwordx4 v1, s[16:19], s42 offen offset:2048 sc1 lds
    v_mfma_f32_16x16x32_bf16 v[8:11], a[184:187], v[80:83], v[8:11]
    ds_read_b128 v[64:67], v1 offset:51200
    buffer_load_dwordx4 v1, s[16:19], s42 offen offset:3072 sc1 lds
    v_mfma_f32_16x16x32_bf16 v[16:19], a[184:187], v[84:87], v[16:19]
    s_add_u32 m0, s43, 114688
    v_mul_f32 v128, v112, v88
    v_fmac_f32 v128, v114, v100
    v_mfma_f32_16x16x32_bf16 v[20:23], a[188:191], v[84:87], v[20:23]
    s_add_u32 s42, s41, 16384
    ds_read_b128 v[68:71], v1 offset:52224
    v_mul_f32 v129, v112, v89
    v_mfma_f32_16x16x32_bf16 v[12:15], a[188:191], v[80:83], v[12:15]
    s_waitcnt lgkmcnt(2)
    v_fmac_f32 v129, v114, v101
    v_mul_f32 v130, v112, v90
    v_mfma_f32_16x16x32_bf16 v[8:11], a[192:195], v[56:59], v[8:11]
    ds_read_b128 v[72:75], v1 offset:53248
    buffer_load_dwordx4 v1, s[16:19], s42 offen offset:0 sc1 lds
    v_mfma_f32_16x16x32_bf16 v[16:19], a[192:195], v[60:63], v[16:19]
    v_fmac_f32 v130, v114, v102
    v_mul_f32 v131, v112, v91
    v_mfma_f32_16x16x32_bf16 v[20:23], a[196:199], v[60:63], v[20:23]
    ds_read_b128 v[76:79], v1 offset:54272
    v_fmac_f32 v131, v114, v103
    v_mfma_f32_16x16x32_bf16 v[12:15], a[196:199], v[56:59], v[12:15]
    s_waitcnt lgkmcnt(2)
    v_mul_f32 v132, v112, v92
    v_fmac_f32 v132, v114, v104
    v_mfma_f32_16x16x32_bf16 v[8:11], a[200:203], v[64:67], v[8:11]
    ds_read_b128 v[80:83], v1 offset:55296
    buffer_load_dwordx4 v1, s[16:19], s42 offen offset:1024 sc1 lds
    v_mfma_f32_16x16x32_bf16 v[16:19], a[200:203], v[68:71], v[16:19]
    v_mul_f32 v133, v112, v93
    v_fmac_f32 v133, v114, v105
    v_mfma_f32_16x16x32_bf16 v[20:23], a[204:207], v[68:71], v[20:23]
    ds_read_b128 v[84:87], v1 offset:56320
    v_mul_f32 v134, v112, v94
    v_mfma_f32_16x16x32_bf16 v[12:15], a[204:207], v[64:67], v[12:15]
    s_waitcnt lgkmcnt(2)
    v_fmac_f32 v134, v114, v106
    v_mul_f32 v135, v112, v95
    v_mfma_f32_16x16x32_bf16 v[8:11], a[208:211], v[72:75], v[8:11]
    ds_read_b128 v[56:59], v1 offset:57344
    buffer_load_dwordx4 v1, s[16:19], s42 offen offset:2048 sc1 lds
    v_mfma_f32_16x16x32_bf16 v[16:19], a[208:211], v[76:79], v[16:19]
    v_fmac_f32 v135, v114, v107
    v_mul_f32 v136, v113, v88
    v_mfma_f32_16x16x32_bf16 v[20:23], a[212:215], v[76:79], v[20:23]
    ds_read_b128 v[60:63], v1 offset:58368
    v_fmac_f32 v136, v115, v100
    v_mfma_f32_16x16x32_bf16 v[12:15], a[212:215], v[72:75], v[12:15]
    s_waitcnt lgkmcnt(2)
    v_mul_f32 v137, v113, v89
    v_fmac_f32 v137, v115, v101
    v_mfma_f32_16x16x32_bf16 v[8:11], a[216:219], v[80:83], v[8:11]
    ds_read_b128 v[64:67], v1 offset:59392
    buffer_load_dwordx4 v1, s[16:19], s42 offen offset:3072 sc1 lds
    v_mfma_f32_16x16x32_bf16 v[16:19], a[216:219], v[84:87], v[16:19]
    s_add_u32 s45, s45, 65536
    v_mul_f32 v138, v113, v90
    v_fmac_f32 v138, v115, v102
    v_mfma_f32_16x16x32_bf16 v[20:23], a[220:223], v[84:87], v[20:23]
    ds_read_b128 v[68:71], v1 offset:60416
    v_mul_f32 v139, v113, v91
    v_mfma_f32_16x16x32_bf16 v[12:15], a[220:223], v[80:83], v[12:15]
    s_waitcnt lgkmcnt(2)
    v_fmac_f32 v139, v115, v103
    v_mul_f32 v140, v113, v92
    v_mfma_f32_16x16x32_bf16 v[8:11], a[224:227], v[56:59], v[8:11]
    ds_read_b128 v[72:75], v1 offset:61440
    v_fmac_f32 v140, v115, v104
    v_mfma_f32_16x16x32_bf16 v[16:19], a[224:227], v[60:63], v[16:19]
    v_mul_f32 v141, v113, v93
    v_fmac_f32 v141, v115, v105
    v_mfma_f32_16x16x32_bf16 v[20:23], a[228:231], v[60:63], v[20:23]
    ds_read_b128 v[76:79], v1 offset:62464
    v_mul_f32 v142, v113, v94
    v_mfma_f32_16x16x32_bf16 v[12:15], a[228:231], v[56:59], v[12:15]
    s_waitcnt lgkmcnt(2)
    v_fmac_f32 v142, v115, v106
    v_mul_f32 v143, v113, v95
    v_mfma_f32_16x16x32_bf16 v[8:11], a[232:235], v[64:67], v[8:11]
    ds_read_b128 v[80:83], v1 offset:63488
    v_fmac_f32 v143, v115, v107
    v_mfma_f32_16x16x32_bf16 v[16:19], a[232:235], v[68:71], v[16:19]
    v_mfma_f32_16x16x32_bf16 v[20:23], a[236:239], v[68:71], v[20:23]
    ds_read_b128 v[84:87], v1 offset:64512
    v_mfma_f32_16x16x32_bf16 v[12:15], a[236:239], v[64:67], v[12:15]
    s_waitcnt vmcnt(4) lgkmcnt(2)
    s_barrier
    v_mfma_f32_16x16x32_bf16 v[8:11], a[240:243], v[72:75], v[8:11]
    ds_read_b128 v[56:59], v2 offset:0
    v_mfma_f32_16x16x32_bf16 v[16:19], a[240:243], v[76:79], v[16:19]
    v_mfma_f32_16x16x32_bf16 v[20:23], a[244:247], v[76:79], v[20:23]
    ds_read_b128 v[60:63], v2 offset:1024
    v_mfma_f32_16x16x32_bf16 v[12:15], a[244:247], v[72:75], v[12:15]
    s_waitcnt lgkmcnt(2)
    v_mfma_f32_16x16x32_bf16 v[8:11], a[248:251], v[80:83], v[8:11]
    ds_read_b128 v[64:67], v2 offset:2048
    v_mfma_f32_16x16x32_bf16 v[16:19], a[248:251], v[84:87], v[16:19]
    v_mfma_f32_16x16x32_bf16 v[20:23], a[252:255], v[84:87], v[20:23]
    ds_read_b128 v[68:71], v2 offset:3072
    v_mfma_f32_16x16x32_bf16 v[12:15], a[252:255], v[80:83], v[12:15]
    s_add_u32 s36, s36, 1
L_l_b1:
    s_waitcnt lgkmcnt(2)
    v_mfma_f32_16x16x32_bf16 v[32:35], a[0:3], v[56:59], 0
    s_add_u32 m0, s52, 73728
    ds_read_b128 v[72:75], v2 offset:4096
    s_add_u32 s42, s46, s52
    v_mfma_f32_16x16x32_bf16 v[40:43], a[0:3], v[60:63], 0
    buffer_load_dwordx4 v1, s[16:19], s42 offen sc1 lds
    v_mfma_f32_16x16x32_bf16 v[44:47], a[4:7], v[60:63], 0
    s_add_u32 m0, s43, 131072
    ds_read_b128 v[76:79], v2 offset:5120
    s_add_u32 s42, s41, 32768
    v_mfma_f32_16x16x32_bf16 v[36:39], a[4:7], v[56:59], 0
    s_waitcnt lgkmcnt(2)
    buffer_load_dwordx4 v1, s[16:19], s42 offen offset:0 sc1 lds
    v_mfma_f32_16x16x32_bf16 v[32:35], a[8:11], v[64:67], v[32:35]
    s_and_b32 s44, s90, 0xffffffff
    ds_read_b128 v[80:83], v2 offset:6144
    s_cmp_lt_i32 s36, 1
    v_mfma_f32_16x16x32_bf16 v[40:43], a[8:11], v[68:71], v[40:43]
    buffer_load_dwordx4 v1, s[16:19], s42 offen offset:1024 sc1 lds
    v_mfma_f32_16x16x32_bf16 v[44:47], a[12:15], v[68:71], v[44:47]
    s_cselect_b32 s44, 0x5e00000, s44
    ds_read_b128 v[84:87], v2 offset:7168
    s_add_u32 s90, s90, 262144
    v_mfma_f32_16x16x32_bf16 v[36:39], a[12:15], v[64:67], v[36:39]
    s_waitcnt lgkmcnt(2)
    buffer_load_dwordx4 v1, s[16:19], s42 offen offset:2048 sc1 lds
    v_mfma_f32_16x16x32_bf16 v[32:35], a[16:19], v[72:75], v[32:35]
    ds_read_b128 v[56:59], v2 offset:8192
    v_add_f32 v8, v8, v128
    v_mfma_f32_16x16x32_bf16 v[40:43], a[16:19], v[76:79], v[40:43]
    buffer_load_dwordx4 v1, s[16:19], s42 offen offset:3072 sc1 lds
    v_mfma_f32_16x16x32_bf16 v[44:47], a[20:23], v[76:79], v[44:47]
    s_add_u32 m0, s43, 147456
    ds_read_b128 v[60:63], v2 offset:9216
    v_add_f32 v9, v9, v129
    v_mfma_f32_16x16x32_bf16 v[36:39], a[20:23], v[72:75], v[36:39]
    s_waitcnt lgkmcnt(2)
    v_mul_f32 v120, v8, v116
    v_mul_f32 v121, v9, v116
    v_mfma_f32_16x16x32_bf16 v[32:35], a[24:27], v[80:83], v[32:35]
    s_add_u32 s42, s41, 49152
    ds_read_b128 v[64:67], v2 offset:10240
    buffer_load_dwordx4 v1, s[16:19], s42 offen offset:0 sc1 lds
    v_mfma_f32_16x16x32_bf16 v[40:43], a[24:27], v[84:87], v[40:43]
    v_mul_f32 v120, v120, abs(v8)
    v_mul_f32 v121, v121, abs(v9)
    v_mfma_f32_16x16x32_bf16 v[44:47], a[28:31], v[84:87], v[44:47]
    ds_read_b128 v[68:71], v2 offset:11264
    buffer_load_dwordx4 v1, s[16:19], s42 offen offset:1024 sc1 lds
    v_mfma_f32_16x16x32_bf16 v[36:39], a[28:31], v[80:83], v[36:39]
    s_waitcnt lgkmcnt(2)
    v_cvt_pk_bf16_f32 v8, v120, v121
    v_pk_max_i16 v8, v8, 0
    v_mfma_f32_16x16x32_bf16 v[32:35], a[32:35], v[56:59], v[32:35]
    ds_read_b128 v[72:75], v2 offset:12288
    buffer_load_dwordx4 v1, s[16:19], s42 offen offset:2048 sc1 lds
    v_mfma_f32_16x16x32_bf16 v[40:43], a[32:35], v[60:63], v[40:43]
    v_add_f32 v10, v10, v130
    v_add_f32 v11, v11, v131
    v_mfma_f32_16x16x32_bf16 v[44:47], a[36:39], v[60:63], v[44:47]
    ds_read_b128 v[76:79], v2 offset:13312
    buffer_load_dwordx4 v1, s[16:19], s42 offen offset:3072 sc1 lds
    v_mfma_f32_16x16x32_bf16 v[36:39], a[36:39], v[56:59], v[36:39]
    s_waitcnt lgkmcnt(2)
    v_mul_f32 v120, v10, v116
    v_mul_f32 v121, v11, v116
    v_mfma_f32_16x16x32_bf16 v[32:35], a[40:43], v[64:67], v[32:35]
    s_add_u32 s98, s98, 65536
    ds_read_b128 v[80:83], v2 offset:14336
    v_mul_f32 v120, v120, abs(v10)
    v_mfma_f32_16x16x32_bf16 v[40:43], a[40:43], v[68:71], v[40:43]
    s_min_i32 s98, s98, s96
    v_mul_f32 v121, v121, abs(v11)
    v_cvt_pk_bf16_f32 v9, v120, v121
    v_mfma_f32_16x16x32_bf16 v[44:47], a[44:47], v[68:71], v[44:47]
    s_and_b32 s41, s98, 0xffffffff
    ds_read_b128 v[84:87], v2 offset:15360
    v_pk_max_i16 v9, v9, 0
    v_mfma_f32_16x16x32_bf16 v[36:39], a[44:47], v[64:67], v[36:39]
    s_waitcnt vmcnt(9) lgkmcnt(2)
    s_barrier
    v_add_f32 v12, v12, v132
    v_mfma_f32_16x16x32_bf16 v[32:35], a[48:51], v[72:75], v[32:35]
    ds_read_b128 v[56:59], v2 offset:16384
    v_add_f32 v13, v13, v133
    v_mfma_f32_16x16x32_bf16 v[40:43], a[48:51], v[76:79], v[40:43]
    v_mul_f32 v120, v12, v116
    v_mul_f32 v121, v13, v116
    v_mfma_f32_16x16x32_bf16 v[44:47], a[52:55], v[76:79], v[44:47]
    ds_read_b128 v[60:63], v2 offset:17408
    v_mul_f32 v120, v120, abs(v12)
    v_mfma_f32_16x16x32_bf16 v[36:39], a[52:55], v[72:75], v[36:39]
    s_waitcnt lgkmcnt(2)
    v_mul_f32 v121, v121, abs(v13)
    v_cvt_pk_bf16_f32 v10, v120, v121
    v_mfma_f32_16x16x32_bf16 v[32:35], a[56:59], v[80:83], v[32:35]
    ds_read_b128 v[64:67], v2 offset:18432
    v_pk_max_i16 v10, v10, 0
    v_mfma_f32_16x16x32_bf16 v[40:43], a[56:59], v[84:87], v[40:43]
    v_add_f32 v14, v14, v134
    v_add_f32 v15, v15, v135
    v_mfma_f32_16x16x32_bf16 v[44:47], a[60:63], v[84:87], v[44:47]
    ds_read_b128 v[68:71], v2 offset:19456
    v_mul_f32 v120, v14, v116
    v_mfma_f32_16x16x32_bf16 v[36:39], a[60:63], v[80:83], v[36:39]
    s_waitcnt lgkmcnt(2)
    v_mul_f32 v121, v15, v116
    v_mul_f32 v120, v120, abs(v14)
    v_mfma_f32_16x16x32_bf16 v[32:35], a[64:67], v[56:59], v[32:35]
    ds_read_b128 v[72:75], v2 offset:20480
    v_mul_f32 v121, v121, abs(v15)
    v_mfma_f32_16x16x32_bf16 v[40:43], a[64:67], v[60:63], v[40:43]
    v_cvt_pk_bf16_f32 v11, v120, v121
    v_pk_max_i16 v11, v11, 0
    v_mfma_f32_16x16x32_bf16 v[44:47], a[68:71], v[60:63], v[44:47]
    ds_read_b128 v[76:79], v2 offset:21504
    buffer_store_dwordx4 v[8:11], v1, s[16:19], s44 offen offset:0 sc1
    v_mfma_f32_16x16x32_bf16 v[36:39], a[68:71], v[56:59], v[36:39]
    s_waitcnt lgkmcnt(2)
    v_add_f32 v16, v16, v136
    v_add_f32 v17, v17, v137
    v_mfma_f32_16x16x32_bf16 v[32:35], a[72:75], v[64:67], v[32:35]
    ds_read_b128 v[80:83], v2 offset:22528
    v_mul_f32 v120, v16, v117
    v_mfma_f32_16x16x32_bf16 v[40:43], a[72:75], v[68:71], v[40:43]
    v_mul_f32 v121, v17, v117
    v_mul_f32 v120, v120, abs(v16)
    v_mfma_f32_16x16x32_bf16 v[44:47], a[76:79], v[68:71], v[44:47]
    ds_read_b128 v[84:87], v2 offset:23552
    v_mul_f32 v121, v121, abs(v17)
    v_mfma_f32_16x16x32_bf16 v[36:39], a[76:79], v[64:67], v[36:39]
    s_waitcnt lgkmcnt(2)
    v_cvt_pk_bf16_f32 v16, v120, v121
    v_pk_max_i16 v16, v16, 0
    v_mfma_f32_16x16x32_bf16 v[32:35], a[80:83], v[72:75], v[32:35]
    ds_read_b128 v[56:59], v2 offset:24576
    v_add_f32 v18, v18, v138
    v_mfma_f32_16x16x32_bf16 v[40:43], a[80:83], v[76:79], v[40:43]
    v_add_f32 v19, v19, v139
    v_mul_f32 v120, v18, v117
    v_mfma_f32_16x16x32_bf16 v[44:47], a[84:87], v[76:79], v[44:47]
    ds_read_b128 v[60:63], v2 offset:25600
    v_mul_f32 v121, v19, v117
    v_mfma_f32_16x16x32_bf16 v[36:39], a[84:87], v[72:75], v[36:39]
    s_waitcnt lgkmcnt(2)
    v_mul_f32 v120, v120, abs(v18)
    v_mul_f32 v121, v121, abs(v19)
    v_mfma_f32_16x16x32_bf16 v[32:35], a[88:91], v[80:83], v[32:35]
    ds_read_b128 v[64:67], v2 offset:26624
    v_cvt_pk_bf16_f32 v17, v120, v121
    v_mfma_f32_16x16x32_bf16 v[40:43], a[88:91], v[84:87], v[40:43]
    v_pk_max_i16 v17, v17, 0
    v_add_f32 v20, v20, v140
    v_mfma_f32_16x16x32_bf16 v[44:47], a[92:95], v[84:87], v[44:47]
    ds_read_b128 v[68:71], v2 offset:27648
    v_add_f32 v21, v21, v141
    v_mfma_f32_16x16x32_bf16 v[36:39], a[92:95], v[80:83], v[36:39]
    s_waitcnt lgkmcnt(2)
    v_mul_f32 v120, v20, v117
    v_mul_f32 v121, v21, v117
    v_mfma_f32_16x16x32_bf16 v[32:35], a[96:99], v[56:59], v[32:35]
    ds_read_b128 v[72:75], v2 offset:28672
    v_mul_f32 v120, v120, abs(v20)
    v_mfma_f32_16x16x32_bf16 v[40:43], a[96:99], v[60:63], v[40:43]
    v_mul_f32 v121, v121, abs(v21)
    v_cvt_pk_bf16_f32 v18, v120, v121
    v_mfma_f32_16x16x32_bf16 v[44:47], a[100:103], v[60:63], v[44:47]
    ds_read_b128 v[76:79], v2 offset:29696
    buffer_load_dword v7, v5, s[16:19], s45 offen sc1
    v_mfma_f32_16x16x32_bf16 v[36:39], a[100:103], v[56:59], v[36:39]
    s_waitcnt lgkmcnt(2)
    v_pk_max_i16 v18, v18, 0
    v_add_f32 v22, v22, v142
    v_mfma_f32_16x16x32_bf16 v[32:35], a[104:107], v[64:67], v[32:35]
    ds_read_b128 v[80:83], v2 offset:30720
    v_add_f32 v23, v23, v143
    v_mfma_f32_16x16x32_bf16 v[40:43], a[104:107], v[68:71], v[40:43]
    v_mul_f32 v120, v22, v117
    v_mul_f32 v121, v23, v117
    v_mfma_f32_16x16x32_bf16 v[44:47], a[108:111], v[68:71], v[44:47]
    ds_read_b128 v[84:87], v2 offset:31744
    v_mul_f32 v120, v120, abs(v22)
    v_mfma_f32_16x16x32_bf16 v[36:39], a[108:111], v[64:67], v[36:39]
    s_waitcnt vmcnt(6) lgkmcnt(2)
    s_barrier
    v_mul_f32 v121, v121, abs(v23)
    v_mfma_f32_16x16x32_bf16 v[32:35], a[112:115], v[72:75], v[32:35]
    ds_read_b128 v[56:59], v2 offset:32768
    v_cvt_pk_bf16_f32 v19, v120, v121
    v_mfma_f32_16x16x32_bf16 v[40:43], a[112:115], v[76:79], v[40:43]
    v_pk_max_i16 v19, v19, 0
    buffer_store_dwordx4 v[16:19], v1, s[16:19], s44 offen offset:1024 sc1
    v_mfma_f32_16x16x32_bf16 v[44:47], a[116:119], v[76:79], v[44:47]
    s_add_u32 m0, s43, 0
    ds_read_b128 v[60:63], v2 offset:33792
    ds_read_b64 v[144:145], v118 offset:0
    v_mfma_f32_16x16x32_bf16 v[36:39], a[116:119], v[72:75], v[36:39]
    s_waitcnt lgkmcnt(3)
    ds_read_b64 v[146:147], v118 offset:128
    ds_read_b64 v[148:149], v118 offset:256
    v_mfma_f32_16x16x32_bf16 v[32:35], a[120:123], v[80:83], v[32:35]
    s_add_u32 s42, s41, 0
    ds_read_b128 v[64:67], v2 offset:34816
    ds_read_b64 v[150:151], v118 offset:384
    v_mfma_f32_16x16x32_bf16 v[40:43], a[120:123], v[84:87], v[40:43]
    v_mfma_f32_16x16x32_bf16 v[44:47], a[124:127], v[84:87], v[44:47]
    ds_read_b128 v[68:71], v2 offset:35840
    v_mfma_f32_16x16x32_bf16 v[36:39], a[124:127], v[80:83], v[36:39]
    s_waitcnt lgkmcnt(6)
    v_mfma_f32_16x16x32_bf16 v[32:35], a[128:131], v[56:59], v[32:35]
    ds_read_b128 v[72:75], v2 offset:36864
    v_mfma_f32_16x16x32_bf16 v[40:43], a[128:131], v[60:63], v[40:43]
    s_waitcnt lgkmcnt(2)
    v_max3_u32 v152, v144, v145, v146
    v_max3_u32 v153, v147, v148, v149
    v_mfma_f32_16x16x32_bf16 v[44:47], a[132:135], v[60:63], v[44:47]
    ds_read_b128 v[76:79], v2 offset:37888
    v_max3_u32 v152, v152, v150, v151
    v_mfma_f32_16x16x32_bf16 v[36:39], a[132:135], v[56:59], v[36:39]
    s_waitcnt lgkmcnt(2)
    v_max_u32 v152, v152, v153
    v_cmp_eq_u32 vcc, -1, v152
    v_mfma_f32_16x16x32_bf16 v[32:35], a[136:139], v[64:67], v[32:35]
    ds_read_b128 v[80:83], v2 offset:38912
    v_mfma_f32_16x16x32_bf16 v[40:43], a[136:139], v[68:71], v[40:43]
    s_cbranch_vccnz L_sspin45
L_sback46:
    v_add_f32 v152, v148, v150
    v_add_f32 v153, v149, v151
    v_mfma_f32_16x16x32_bf16 v[44:47], a[140:143], v[68:71], v[44:47]
    ds_read_b128 v[84:87], v2 offset:39936
    v_add_f32 v144, v144, v146
    v_mfma_f32_16x16x32_bf16 v[36:39], a[140:143], v[64:67], v[36:39]
    s_waitcnt lgkmcnt(2)
    v_add_f32 v145, v145, v147
    v_add_f32 v144, v144, v152
    v_mfma_f32_16x16x32_bf16 v[32:35], a[144:147], v[72:75], v[32:35]
    ds_read_b128 v[56:59], v2 offset:40960
    v_add_f32 v145, v145, v153
    v_mfma_f32_16x16x32_bf16 v[40:43], a[144:147], v[76:79], v[40:43]
    v_mov_b32 v152, v144
    v_mov_b32 v153, v145
    v_mfma_f32_16x16x32_bf16 v[44:47], a[148:151], v[76:79], v[44:47]
    ds_read_b128 v[60:63], v2 offset:41984
    v_permlane32_swap_b32 v144, v152
    v_mfma_f32_16x16x32_bf16 v[36:39], a[148:151], v[72:75], v[36:39]
    s_waitcnt lgkmcnt(2)
    v_permlane32_swap_b32 v145, v153
    v_mfma_f32_16x16x32_bf16 v[32:35], a[152:155], v[80:83], v[32:35]
    ds_read_b128 v[64:67], v2 offset:43008
    v_add_f32 v144, v144, v152
    v_mfma_f32_16x16x32_bf16 v[40:43], a[152:155], v[84:87], v[40:43]
    v_add_f32 v145, v145, v153
    v_mul_f32 v112, 0xba800000, v144
    v_mfma_f32_16x16x32_bf16 v[44:47], a[156:159], v[84:87], v[44:47]
    ds_read_b128 v[68:71], v2 offset:44032
    v_mul_f32 v145, 0x3a800000, v145
    v_mfma_f32_16x16x32_bf16 v[36:39], a[156:159], v[80:83], v[36:39]
    s_waitcnt lgkmcnt(2)
    v_fma_f32 v145, -v112, v112, v145
    v_mov_b32 v113, v112
    v_mfma_f32_16x16x32_bf16 v[32:35], a[160:163], v[56:59], v[32:35]
    ds_read_b128 v[72:75], v2 offset:45056
    v_max_f32 v145, 0, v145
    v_mfma_f32_16x16x32_bf16 v[40:43], a[160:163], v[60:63], v[40:43]
    v_add_f32 v145, 0x3727c5ac, v145
    v_rsq_f32 v116, v145
    v_mfma_f32_16x16x32_bf16 v[44:47], a[164:167], v[60:63], v[44:47]
    ds_read_b128 v[76:79], v2 offset:46080
    v_permlane16_swap_b32 v112, v113
    v_mfma_f32_16x16x32_bf16 v[36:39], a[164:167], v[56:59], v[36:39]
    s_waitcnt lgkmcnt(2)
    v_mul_f32 v114, v145, v116
    v_mul_f32 v116, v116, v116
    v_mfma_f32_16x16x32_bf16 v[32:35], a[168:171], v[64:67], v[32:35]
    s_waitcnt vmcnt(0)
    ds_read_b128 v[80:83], v2 offset:47104
    v_mov_b32 v115, v114
    v_mfma_f32_16x16x32_bf16 v[40:43], a[168:171], v[68:71], v[40:43]
    s_barrier
    buffer_store_dword v124, v124, s[16:19], s91 offen sc1
    v_mfma_f32_16x16x32_bf16 v[44:47], a[172:175], v[68:71], v[44:47]
    s_add_u32 s91, s91, 65536
    ds_read_b128 v[84:87], v2 offset:48128
    v_cmp_ne_u32 vcc, 0, v7
    v_mfma_f32_16x16x32_bf16 v[36:39], a[172:175], v[64:67], v[36:39]
    s_waitcnt lgkmcnt(2)
    v_mov_b32 v117, v116
    v_permlane16_swap_b32 v114, v115
    v_mfma_f32_16x16x32_bf16 v[32:35], a[176:179], v[72:75], v[32:35]
    s_cbranch_vccnz L_spin43
L_back44:
    ds_read_b128 v[56:59], v2 offset:49152
    v_permlane16_swap_b32 v116, v117
    v_mfma_f32_16x16x32_bf16 v[40:43], a[176:179], v[76:79], v[40:43]
    s_barrier
    buffer_load_dwordx4 v1, s[16:19], s42 offen offset:0 sc1 lds
    v_mfma_f32_16x16x32_bf16 v[44:47], a[180:183], v[76:79], v[44:47]
    s_add_u32 s46, s46, 2048
    ds_read_b128 v[60:63], v2 offset:50176
    buffer_load_dwordx4 v1, s[16:19], s42 offen offset:1024 sc1 lds
    v_mfma_f32_16x16x32_bf16 v[36:39], a[180:183], v[72:75], v[36:39]
    s_waitcnt lgkmcnt(2)
    buffer_load_dwordx4 v1, s[16:19], s42 offen offset:2048 sc1 lds
    v_mfma_f32_16x16x32_bf16 v[32:35], a[184:187], v[80:83], v[32:35]
    ds_read_b128 v[64:67], v2 offset:51200
    buffer_load_dwordx4 v1, s[16:19], s42 offen offset:3072 sc1 lds
    v_mfma_f32_16x16x32_bf16 v[40:43], a[184:187], v[84:87], v[40:43]
    s_add_u32 m0, s43, 16384
    v_mul_f32 v128, v112, v88
    v_fmac_f32 v128, v114, v100
    v_mfma_f32_16x16x32_bf16 v[44:47], a[188:191], v[84:87], v[44:47]
    s_add_u32 s42, s41, 16384
    ds_read_b128 v[68:71], v2 offset:52224
    v_mul_f32 v129, v112, v89
    v_mfma_f32_16x16x32_bf16 v[36:39], a[188:191], v[80:83], v[36:39]
    s_waitcnt lgkmcnt(2)
    v_fmac_f32 v129, v114, v101
    v_mul_f32 v130, v112, v90
    v_mfma_f32_16x16x32_bf16 v[32:35], a[192:195], v[56:59], v[32:35]
    ds_read_b128 v[72:75], v2 offset:53248
    buffer_load_dwordx4 v1, s[16:19], s42 offen offset:0 sc1 lds
    v_mfma_f32_16x16x32_bf16 v[40:43], a[192:195], v[60:63], v[40:43]
    v_fmac_f32 v130, v114, v102
    v_mul_f32 v131, v112, v91
    v_mfma_f32_16x16x32_bf16 v[44:47], a[196:199], v[60:63], v[44:47]
    ds_read_b128 v[76:79], v2 offset:54272
    v_fmac_f32 v131, v114, v103
    v_mfma_f32_16x16x32_bf16 v[36:39], a[196:199], v[56:59], v[36:39]
    s_waitcnt lgkmcnt(2)
    v_mul_f32 v132, v112, v92
    v_fmac_f32 v132, v114, v104
    v_mfma_f32_16x16x32_bf16 v[32:35], a[200:203], v[64:67], v[32:35]
    ds_read_b128 v[80:83], v2 offset:55296
    buffer_load_dwordx4 v1, s[16:19], s42 offen offset:1024 sc1 lds
    v_mfma_f32_16x16x32_bf16 v[40:43], a[200:203], v[68:71], v[40:43]
    v_mul_f32 v133, v112, v93
    v_fmac_f32 v133, v114, v105
    v_mfma_f32_16x16x32_bf16 v[44:47], a[204:207], v[68:71], v[44:47]
    ds_read_b128 v[84:87], v2 offset:56320
    v_mul_f32 v134, v112, v94
    v_mfma_f32_16x16x32_bf16 v[36:39], a[204:207], v[64:67], v[36:39]
    s_waitcnt lgkmcnt(2)
    v_fmac_f32 v134, v114, v106
    v_mul_f32 v135, v112, v95
    v_mfma_f32_16x16x32_bf16 v[32:35], a[208:211], v[72:75], v[32:35]
    ds_read_b128 v[56:59], v2 offset:57344
    buffer_load_dwordx4 v1, s[16:19], s42 offen offset:2048 sc1 lds
    v_mfma_f32_16x16x32_bf16 v[40:43], a[208:211], v[76:79], v[40:43]
    v_fmac_f32 v135, v114, v107
    v_mul_f32 v136, v113, v88
    v_mfma_f32_16x16x32_bf16 v[44:47], a[212:215], v[76:79], v[44:47]
    ds_read_b128 v[60:63], v2 offset:58368
    v_fmac_f32 v136, v115, v100
    v_mfma_f32_16x16x32_bf16 v[36:39], a[212:215], v[72:75], v[36:39]
    s_waitcnt lgkmcnt(2)
    v_mul_f32 v137, v113, v89
    v_fmac_f32 v137, v115, v101
    v_mfma_f32_16x16x32_bf16 v[32:35], a[216:219], v[80:83], v[32:35]
    ds_read_b128 v[64:67], v2 offset:59392
    buffer_load_dwordx4 v1, s[16:19], s42 offen offset:3072 sc1 lds
    v_mfma_f32_16x16x32_bf16 v[40:43], a[216:219], v[84:87], v[40:43]
    s_add_u32 s45, s45, 65536
    v_mul_f32 v138, v113, v90
    v_fmac_f32 v138, v115, v102
    v_mfma_f32_16x16x32_bf16 v[44:47], a[220:223], v[84:87], v[44:47]
    ds_read_b128 v[68:71], v2 offset:60416
    v_mul_f32 v139, v113, v91
    v_mfma_f32_16x16x32_bf16 v[36:39], a[220:223], v[80:83], v[36:39]
    s_waitcnt lgkmcnt(2)
    v_fmac_f32 v139, v115, v103
    v_mul_f32 v140, v113, v92
    v_mfma_f32_16x16x32_bf16 v[32:35], a[224:227], v[56:59], v[32:35]
    ds_read_b128 v[72:75], v2 offset:61440
    v_fmac_f32 v140, v115, v104
    v_mfma_f32_16x16x32_bf16 v[40:43], a[224:227], v[60:63], v[40:43]
    v_mul_f32 v141, v113, v93
    v_fmac_f32 v141, v115, v105
    v_mfma_f32_16x16x32_bf16 v[44:47], a[228:231], v[60:63], v[44:47]
    ds_read_b128 v[76:79], v2 offset:62464
    v_mul_f32 v142, v113, v94
    v_mfma_f32_16x16x32_bf16 v[36:39], a[228:231], v[56:59], v[36:39]
    s_waitcnt lgkmcnt(2)
    v_fmac_f32 v142, v115, v106
    v_mul_f32 v143, v113, v95
    v_mfma_f32_16x16x32_bf16 v[32:35], a[232:235], v[64:67], v[32:35]
    ds_read_b128 v[80:83], v2 offset:63488
    v_fmac_f32 v143, v115, v107
    v_mfma_f32_16x16x32_bf16 v[40:43], a[232:235], v[68:71], v[40:43]
    v_mfma_f32_16x16x32_bf16 v[44:47], a[236:239], v[68:71], v[44:47]
    ds_read_b128 v[84:87], v2 offset:64512
    v_mfma_f32_16x16x32_bf16 v[36:39], a[236:239], v[64:67], v[36:39]
    s_waitcnt vmcnt(4) lgkmcnt(2)
    s_barrier
    v_mfma_f32_16x16x32_bf16 v[32:35], a[240:243], v[72:75], v[32:35]
    ds_read_b128 v[56:59], v1 offset:0
    v_mfma_f32_16x16x32_bf16 v[40:43], a[240:243], v[76:79], v[40:43]
    v_mfma_f32_16x16x32_bf16 v[44:47], a[244:247], v[76:79], v[44:47]
    ds_read_b128 v[60:63], v1 offset:1024
    v_mfma_f32_16x16x32_bf16 v[36:39], a[244:247], v[72:75], v[36:39]
    s_waitcnt lgkmcnt(2)
    v_mfma_f32_16x16x32_bf16 v[32:35], a[248:251], v[80:83], v[32:35]
    ds_read_b128 v[64:67], v1 offset:2048
    v_mfma_f32_16x16x32_bf16 v[40:43], a[248:251], v[84:87], v[40:43]
    v_mfma_f32_16x16x32_bf16 v[44:47], a[252:255], v[84:87], v[44:47]
    ds_read_b128 v[68:71], v1 offset:3072
    v_mfma_f32_16x16x32_bf16 v[36:39], a[252:255], v[80:83], v[36:39]
    s_add_u32 s36, s36, 1
    s_cmp_lt_u32 s36, 32
    s_cbranch_scc1 L_l_b0
    s_nop 7
    s_and_b32 s44, s90, 0xffffffff
    s_cmp_lt_i32 s36, 1
    s_cselect_b32 s44, 0x5e00000, s44
    s_add_u32 s90, s90, 262144
    v_add_f32 v32, v32, v128
    v_add_f32 v33, v33, v129
    v_mul_f32 v120, v32, v116
    v_mul_f32 v121, v33, v116
    v_mul_f32 v120, v120, abs(v32)
    v_mul_f32 v121, v121, abs(v33)
    v_cvt_pk_bf16_f32 v32, v120, v121
    v_pk_max_i16 v32, v32, 0
    v_add_f32 v34, v34, v130
    v_add_f32 v35, v35, v131
    v_mul_f32 v120, v34, v116
    v_mul_f32 v121, v35, v116
    v_mul_f32 v120, v120, abs(v34)
    v_mul_f32 v121, v121, abs(v35)
    v_cvt_pk_bf16_f32 v33, v120, v121
    v_pk_max_i16 v33, v33, 0
    v_add_f32 v36, v36, v132
    v_add_f32 v37, v37, v133
    v_mul_f32 v120, v36, v116
    v_mul_f32 v121, v37, v116
    v_mul_f32 v120, v120, abs(v36)
    v_mul_f32 v121, v121, abs(v37)
    v_cvt_pk_bf16_f32 v34, v120, v121
    v_pk_max_i16 v34, v34, 0
    v_add_f32 v38, v38, v134
    v_add_f32 v39, v39, v135
    v_mul_f32 v120, v38, v116
    v_mul_f32 v121, v39, v116
    v_mul_f32 v120, v120, abs(v38)
    v_mul_f32 v121, v121, abs(v39)
    v_cvt_pk_bf16_f32 v35, v120, v121
    v_pk_max_i16 v35, v35, 0
    buffer_store_dwordx4 v[32:35], v1, s[16:19], s44 offen offset:0 sc1
    v_add_f32 v40, v40, v136
    v_add_f32 v41, v41, v137
    v_mul_f32 v120, v40, v117
    v_mul_f32 v121, v41, v117
    v_mul_f32 v120, v120, abs(v40)
    v_mul_f32 v121, v121, abs(v41)
    v_cvt_pk_bf16_f32 v40, v120, v121
    v_pk_max_i16 v40, v40, 0
    v_add_f32 v42, v42, v138
    v_add_f32 v43, v43, v139
    v_mul_f32 v120, v42, v117
    v_mul_f32 v121, v43, v117
    v_mul_f32 v120, v120, abs(v42)
    v_mul_f32 v121, v121, abs(v43)
    v_cvt_pk_bf16_f32 v41, v120, v121
    v_pk_max_i16 v41, v41, 0
    v_add_f32 v44, v44, v140
    v_add_f32 v45, v45, v141
    v_mul_f32 v120, v44, v117
    v_mul_f32 v121, v45, v117
    v_mul_f32 v120, v120, abs(v44)
    v_mul_f32 v121, v121, abs(v45)
    v_cvt_pk_bf16_f32 v42, v120, v121
    v_pk_max_i16 v42, v42, 0
    v_add_f32 v46, v46, v142
    v_add_f32 v47, v47, v143
    v_mul_f32 v120, v46, v117
    v_mul_f32 v121, v47, v117
    v_mul_f32 v120, v120, abs(v46)
    v_mul_f32 v121, v121, abs(v47)
    v_cvt_pk_bf16_f32 v43, v120, v121
    v_pk_max_i16 v43, v43, 0
    buffer_store_dwordx4 v[40:43], v1, s[16:19], s44 offen offset:1024 sc1
    s_waitcnt vmcnt(0)
    s_barrier
    buffer_store_dword v124, v124, s[16:19], s91 offen sc1
    s_add_u32 s91, s91, 65536
    s_waitcnt vmcnt(0)
    s_endpgm
L_spin35:
    s_mov_b32 s40, 0x20000
L_spin35_l:
    buffer_load_dword v56, v124, s[20:23], 0 offen sc1
    s_sub_u32 s40, s40, 1
    s_waitcnt vmcnt(0)
    v_cmp_eq_u32 vcc, v124, v56
    s_cbranch_scc1 L_back36
    s_cbranch_vccz L_back36
    s_sleep 8
    s_branch L_spin35_l
L_spin37:
    s_mov_b32 s40, 0x20000
L_spin37_l:
    buffer_load_dword v7, v5, s[16:19], s45 offen sc1
    s_sub_u32 s40, s40, 1
    s_waitcnt vmcnt(0)
    v_cmp_ne_u32 vcc, 0, v7
    s_cbranch_scc1 L_back38
    s_cbranch_vccz L_back38
    s_sleep 2
    s_branch L_spin37_l
L_spin39:
    s_mov_b32 s40, 0x20000
L_spin39_l:
    buffer_load_dword v7, v5, s[16:19], s45 offen sc1
    s_sub_u32 s40, s40, 1
    s_waitcnt vmcnt(0)
    v_cmp_ne_u32 vcc, 0, v7
    s_cbranch_scc1 L_back40
    s_cbranch_vccz L_back40
    s_sleep 2
    s_branch L_spin39_l
L_sspin41:
    s_mov_b32 s40, 0x20000
L_sspin41_l:
    buffer_load_dwordx2 v[144:145], v6, s[16:19], s46 offen offset:0 sc1
    buffer_load_dwordx2 v[146:147], v6, s[16:19], s46 offen offset:128 sc1
    buffer_load_dwordx2 v[148:149], v6, s[16:19], s46 offen offset:256 sc1
    buffer_load_dwordx2 v[150:151], v6, s[16:19], s46 offen offset:384 sc1
    s_sub_u32 s40, s40, 1
    s_waitcnt vmcnt(0)
    v_max3_u32 v152, v144, v145, v146
    v_max3_u32 v153, v147, v148, v149
    v_max3_u32 v152, v152, v150, v151
    v_max_u32 v152, v152, v153
    v_cmp_eq_u32 vcc, -1, v152
    s_cbranch_scc1 L_sback42
    s_cbranch_vccz L_sback42
    s_sleep 4
    s_branch L_sspin41_l
L_spin43:
    s_mov_b32 s40, 0x20000
L_spin43_l:
    buffer_load_dword v7, v5, s[16:19], s45 offen sc1
    s_sub_u32 s40, s40, 1
    s_waitcnt vmcnt(0)
    v_cmp_ne_u32 vcc, 0, v7
    s_cbranch_scc1 L_back44
    s_cbranch_vccz L_back44
    s_sleep 2
    s_branch L_spin43_l
L_sspin45:
    s_mov_b32 s40, 0x20000
L_sspin45_l:
    buffer_load_dwordx2 v[144:145], v6, s[16:19], s46 offen offset:0 sc1
    buffer_load_dwordx2 v[146:147], v6, s[16:19], s46 offen offset:128 sc1
    buffer_load_dwordx2 v[148:149], v6, s[16:19], s46 offen offset:256 sc1
    buffer_load_dwordx2 v[150:151], v6, s[16:19], s46 offen offset:384 sc1
    s_sub_u32 s40, s40, 1
    s_waitcnt vmcnt(0)
    v_max3_u32 v152, v144, v145, v146
    v_max3_u32 v153, v147, v148, v149
    v_max3_u32 v152, v152, v150, v151
    v_max_u32 v152, v152, v153
    v_cmp_eq_u32 vcc, -1, v152
    s_cbranch_scc1 L_sback46
    s_cbranch_vccz L_sback46
    s_sleep 4
    s_branch L_sspin45_l
L_role_44:
    s_sub_u32 s35, s34, 44
    s_cmp_ge_u32 s35, 12
    s_cbranch_scc1 L_bf_nost
    s_lshl_b32 s50, s33, 4
    s_add_u32 s50, s50, s35
    s_lshl_b32 s50, s50, 1
    s_lshl_b32 s46, s50, 15
    s_lshl_b32 s37, s32, 9
    s_add_u32 s46, s46, s37
    v_lshrrev_b32 v48, 3, v0
    v_and_b32 v49, 0x70, v1
    v_lshl_add_u32 v48, v48, 11, v49
    v_add_u32 v49, 16384, v48
    s_mov_b32 s8, s64
    s_mov_b32 s9, s65
    s_mov_b32 s10, 0x400000
    s_mov_b32 s11, 0x00020000
    buffer_load_dwordx4 v[16:19], v48, s[8:11], s46 offen offset:0
    buffer_load_dwordx4 v[20:23], v48, s[8:11], s46 offen offset:128
    buffer_load_dwordx4 v[24:27], v48, s[8:11], s46 offen offset:256
    buffer_load_dwordx4 v[28:31], v48, s[8:11], s46 offen offset:384
    buffer_load_dwordx4 v[32:35], v49, s[8:11], s46 offen offset:0
    buffer_load_dwordx4 v[36:39], v49, s[8:11], s46 offen offset:128
    buffer_load_dwordx4 v[40:43], v49, s[8:11], s46 offen offset:256
    buffer_load_dwordx4 v[44:47], v49, s[8:11], s46 offen offset:384
    s_xor_b32 s50, s50, 1
    s_lshl_b32 s46, s50, 15
    s_lshl_b32 s37, s32, 9
    s_add_u32 s46, s46, s37
    v_lshrrev_b32 v96, 3, v0
    v_and_b32 v97, 0x70, v1
    v_lshl_add_u32 v96, v96, 11, v97
    v_add_u32 v97, 16384, v96
    s_mov_b32 s8, s64
    s_mov_b32 s9, s65
    s_mov_b32 s10, 0x400000
    s_mov_b32 s11, 0x00020000
    buffer_load_dwordx4 v[64:67], v96, s[8:11], s46 offen offset:0
    buffer_load_dwordx4 v[68:71], v96, s[8:11], s46 offen offset:128
    buffer_load_dwordx4 v[72:75], v96, s[8:11], s46 offen offset:256
    buffer_load_dwordx4 v[76:79], v96, s[8:11], s46 offen offset:384
    buffer_load_dwordx4 v[80:83], v97, s[8:11], s46 offen offset:0
    buffer_load_dwordx4 v[84:87], v97, s[8:11], s46 offen offset:128
    buffer_load_dwordx4 v[88:91], v97, s[8:11], s46 offen offset:256
    buffer_load_dwordx4 v[92:95], v97, s[8:11], s46 offen offset:384
    s_xor_b32 s50, s50, 1
    s_mov_b32 s86, 0x3f803f80
    v_and_b32 v56, 1, v0
    v_lshlrev_b32 v56, 7, v56
    v_bfe_u32 v57, v0, 1, 1
    v_lshl_add_u32 v56, v57, 6, v56
    v_and_b32 v57, 0x38, v0
    v_add_u32 v56, v57, v56
    s_sub_u32 s46, 127, s50
    s_lshl_b32 s46, s46, 10
    s_lshl_b32 s37, s32, 8
    s_add_u32 s46, s46, s37
    s_add_u32 s46, s46, 0x5400000
    s_waitcnt vmcnt(8)
    v_dot2_f32_bf16 v48, v16, s86, 0
    v_dot2_f32_bf16 v49, v16, v16, 0
    v_dot2_f32_bf16 v50, v24, s86, 0
    v_dot2_f32_bf16 v51, v24, v24, 0
    v_dot2_f32_bf16 v52, v32, s86, 0
    v_dot2_f32_bf16 v53, v32, v32, 0
    v_dot2_f32_bf16 v54, v40, s86, 0
    v_dot2_f32_bf16 v55, v40, v40, 0
    v_dot2_f32_bf16 v48, v17, s86, v48
    v_dot2_f32_bf16 v49, v17, v17, v49
    v_dot2_f32_bf16 v50, v25, s86, v50
    v_dot2_f32_bf16 v51, v25, v25, v51
    v_dot2_f32_bf16 v52, v33, s86, v52
    v_dot2_f32_bf16 v53, v33, v33, v53
    v_dot2_f32_bf16 v54, v41, s86, v54
    v_dot2_f32_bf16 v55, v41, v41, v55
    v_dot2_f32_bf16 v48, v18, s86, v48
    v_dot2_f32_bf16 v49, v18, v18, v49
    v_dot2_f32_bf16 v50, v26, s86, v50
    v_dot2_f32_bf16 v51, v26, v26, v51
    v_dot2_f32_bf16 v52, v34, s86, v52
    v_dot2_f32_bf16 v53, v34, v34, v53
    v_dot2_f32_bf16 v54, v42, s86, v54
    v_dot2_f32_bf16 v55, v42, v42, v55
    v_dot2_f32_bf16 v48, v19, s86, v48
    v_dot2_f32_bf16 v49, v19, v19, v49
    v_dot2_f32_bf16 v50, v27, s86, v50
    v_dot2_f32_bf16 v51, v27, v27, v51
    v_dot2_f32_bf16 v52, v35, s86, v52
    v_dot2_f32_bf16 v53, v35, v35, v53
    v_dot2_f32_bf16 v54, v43, s86, v54
    v_dot2_f32_bf16 v55, v43, v43, v55
    v_dot2_f32_bf16 v48, v20, s86, v48
    v_dot2_f32_bf16 v49, v20, v20, v49
    v_dot2_f32_bf16 v50, v28, s86, v50
    v_dot2_f32_bf16 v51, v28, v28, v51
    v_dot2_f32_bf16 v52, v36, s86, v52
    v_dot2_f32_bf16 v53, v36, v36, v53
    v_dot2_f32_bf16 v54, v44, s86, v54
    v_dot2_f32_bf16 v55, v44, v44, v55
    v_dot2_f32_bf16 v48, v21, s86, v48
    v_dot2_f32_bf16 v49, v21, v21, v49
    v_dot2_f32_bf16 v50, v29, s86, v50
    v_dot2_f32_bf16 v51, v29, v29, v51
    v_dot2_f32_bf16 v52, v37, s86, v52
    v_dot2_f32_bf16 v53, v37, v37, v53
    v_dot2_f32_bf16 v54, v45, s86, v54
    v_dot2_f32_bf16 v55, v45, v45, v55
    v_dot2_f32_bf16 v48, v22, s86, v48
    v_dot2_f32_bf16 v49, v22, v22, v49
    v_dot2_f32_bf16 v50, v30, s86, v50
    v_dot2_f32_bf16 v51, v30, v30, v51
    v_dot2_f32_bf16 v52, v38, s86, v52
    v_dot2_f32_bf16 v53, v38, v38, v53
    v_dot2_f32_bf16 v54, v46, s86, v54
    v_dot2_f32_bf16 v55, v46, v46, v55
    v_dot2_f32_bf16 v48, v23, s86, v48
    v_dot2_f32_bf16 v49, v23, v23, v49
    v_dot2_f32_bf16 v50, v31, s86, v50
    v_dot2_f32_bf16 v51, v31, v31, v51
    v_dot2_f32_bf16 v52, v39, s86, v52
    v_dot2_f32_bf16 v53, v39, v39, v53
    v_dot2_f32_bf16 v54, v47, s86, v54
    v_dot2_f32_bf16 v55, v47, v47, v55
    v_add_f32_dpp v48, v48, v48 quad_perm:[1,0,3,2] row_mask:0xf bank_mask:0xf
    v_add_f32_dpp v49, v49, v49 quad_perm:[1,0,3,2] row_mask:0xf bank_mask:0xf
    v_add_f32_dpp v50, v50, v50 quad_perm:[1,0,3,2] row_mask:0xf bank_mask:0xf
    v_add_f32_dpp v51, v51, v51 quad_perm:[1,0,3,2] row_mask:0xf bank_mask:0xf
    v_add_f32_dpp v52, v52, v52 quad_perm:[1,0,3,2] row_mask:0xf bank_mask:0xf
    v_add_f32_dpp v53, v53, v53 quad_perm:[1,0,3,2] row_mask:0xf bank_mask:0xf
    v_add_f32_dpp v54, v54, v54 quad_perm:[1,0,3,2] row_mask:0xf bank_mask:0xf
    v_add_f32_dpp v55, v55, v55 quad_perm:[1,0,3,2] row_mask:0xf bank_mask:0xf
    v_add_f32_dpp v48, v48, v48 quad_perm:[2,3,0,1] row_mask:0xf bank_mask:0xf
    v_add_f32_dpp v49, v49, v49 quad_perm:[2,3,0,1] row_mask:0xf bank_mask:0xf
    v_add_f32_dpp v50, v50, v50 quad_perm:[2,3,0,1] row_mask:0xf bank_mask:0xf
    v_add_f32_dpp v51, v51, v51 quad_perm:[2,3,0,1] row_mask:0xf bank_mask:0xf
    v_add_f32_dpp v52, v52, v52 quad_perm:[2,3,0,1] row_mask:0xf bank_mask:0xf
    v_add_f32_dpp v53, v53, v53 quad_perm:[2,3,0,1] row_mask:0xf bank_mask:0xf
    v_add_f32_dpp v54, v54, v54 quad_perm:[2,3,0,1] row_mask:0xf bank_mask:0xf
    v_add_f32_dpp v55, v55, v55 quad_perm:[2,3,0,1] row_mask:0xf bank_mask:0xf
    v_add_f32_dpp v48, v48, v48 row_half_mirror row_mask:0xf bank_mask:0xf
    v_add_f32_dpp v49, v49, v49 row_half_mirror row_mask:0xf bank_mask:0xf
    v_add_f32_dpp v50, v50, v50 row_half_mirror row_mask:0xf bank_mask:0xf
    v_add_f32_dpp v51, v51, v51 row_half_mirror row_mask:0xf bank_mask:0xf
    v_add_f32_dpp v52, v52, v52 row_half_mirror row_mask:0xf bank_mask:0xf
    v_add_f32_dpp v53, v53, v53 row_half_mirror row_mask:0xf bank_mask:0xf
    v_add_f32_dpp v54, v54, v54 row_half_mirror row_mask:0xf bank_mask:0xf
    v_add_f32_dpp v55, v55, v55 row_half_mirror row_mask:0xf bank_mask:0xf
    s_mov_b32 exec_lo, 0x2020202
    s_mov_b32 exec_hi, 0x2020202
    v_mov_b32 v48, v50
    v_mov_b32 v49, v51
    s_mov_b32 exec_lo, 0x4040404
    s_mov_b32 exec_hi, 0x4040404
    v_mov_b32 v48, v52
    v_mov_b32 v49, v53
    s_mov_b32 exec_lo, 0x8080808
    s_mov_b32 exec_hi, 0x8080808
    v_mov_b32 v48, v54
    v_mov_b32 v49, v55
    s_mov_b32 exec_lo, 0x0f0f0f0f
    s_mov_b32 exec_hi, 0x0f0f0f0f
    buffer_store_dwordx2 v[48:49], v56, s[16:19], s46 offen sc1
    s_mov_b64 exec, -1
    s_xor_b32 s50, s50, 1
    s_mov_b32 s86, 0x3f803f80
    v_and_b32 v104, 1, v0
    v_lshlrev_b32 v104, 7, v104
    v_bfe_u32 v105, v0, 1, 1
    v_lshl_add_u32 v104, v105, 6, v104
    v_and_b32 v105, 0x38, v0
    v_add_u32 v104, v105, v104
    s_sub_u32 s46, 127, s50
    s_lshl_b32 s46, s46, 10
    s_lshl_b32 s37, s32, 8
    s_add_u32 s46, s46, s37
    s_add_u32 s46, s46, 0x5400000
    s_waitcnt vmcnt(1)
    v_dot2_f32_bf16 v96, v64, s86, 0
    v_dot2_f32_bf16 v97, v64, v64, 0
    v_dot2_f32_bf16 v98, v72, s86, 0
    v_dot2_f32_bf16 v99, v72, v72, 0
    v_dot2_f32_bf16 v100, v80, s86, 0
    v_dot2_f32_bf16 v101, v80, v80, 0
    v_dot2_f32_bf16 v102, v88, s86, 0
    v_dot2_f32_bf16 v103, v88, v88, 0
    v_dot2_f32_bf16 v96, v65, s86, v96
    v_dot2_f32_bf16 v97, v65, v65, v97
    v_dot2_f32_bf16 v98, v73, s86, v98
    v_dot2_f32_bf16 v99, v73, v73, v99
    v_dot2_f32_bf16 v100, v81, s86, v100
    v_dot2_f32_bf16 v101, v81, v81, v101
    v_dot2_f32_bf16 v102, v89, s86, v102
    v_dot2_f32_bf16 v103, v89, v89, v103
    v_dot2_f32_bf16 v96, v66, s86, v96
    v_dot2_f32_bf16 v97, v66, v66, v97
    v_dot2_f32_bf16 v98, v74, s86, v98
    v_dot2_f32_bf16 v99, v74, v74, v99
    v_dot2_f32_bf16 v100, v82, s86, v100
    v_dot2_f32_bf16 v101, v82, v82, v101
    v_dot2_f32_bf16 v102, v90, s86, v102
    v_dot2_f32_bf16 v103, v90, v90, v103
    v_dot2_f32_bf16 v96, v67, s86, v96
    v_dot2_f32_bf16 v97, v67, v67, v97
    v_dot2_f32_bf16 v98, v75, s86, v98
    v_dot2_f32_bf16 v99, v75, v75, v99
    v_dot2_f32_bf16 v100, v83, s86, v100
    v_dot2_f32_bf16 v101, v83, v83, v101
    v_dot2_f32_bf16 v102, v91, s86, v102
    v_dot2_f32_bf16 v103, v91, v91, v103
    v_dot2_f32_bf16 v96, v68, s86, v96
    v_dot2_f32_bf16 v97, v68, v68, v97
    v_dot2_f32_bf16 v98, v76, s86, v98
    v_dot2_f32_bf16 v99, v76, v76, v99
    v_dot2_f32_bf16 v100, v84, s86, v100
    v_dot2_f32_bf16 v101, v84, v84, v101
    v_dot2_f32_bf16 v102, v92, s86, v102
    v_dot2_f32_bf16 v103, v92, v92, v103
    v_dot2_f32_bf16 v96, v69, s86, v96
    v_dot2_f32_bf16 v97, v69, v69, v97
    v_dot2_f32_bf16 v98, v77, s86, v98
    v_dot2_f32_bf16 v99, v77, v77, v99
    v_dot2_f32_bf16 v100, v85, s86, v100
    v_dot2_f32_bf16 v101, v85, v85, v101
    v_dot2_f32_bf16 v102, v93, s86, v102
    v_dot2_f32_bf16 v103, v93, v93, v103
    v_dot2_f32_bf16 v96, v70, s86, v96
    v_dot2_f32_bf16 v97, v70, v70, v97
    v_dot2_f32_bf16 v98, v78, s86, v98
    v_dot2_f32_bf16 v99, v78, v78, v99
    v_dot2_f32_bf16 v100, v86, s86, v100
    v_dot2_f32_bf16 v101, v86, v86, v101
    v_dot2_f32_bf16 v102, v94, s86, v102
    v_dot2_f32_bf16 v103, v94, v94, v103
    v_dot2_f32_bf16 v96, v71, s86, v96
    v_dot2_f32_bf16 v97, v71, v71, v97
    v_dot2_f32_bf16 v98, v79, s86, v98
    v_dot2_f32_bf16 v99, v79, v79, v99
    v_dot2_f32_bf16 v100, v87, s86, v100
    v_dot2_f32_bf16 v101, v87, v87, v101
    v_dot2_f32_bf16 v102, v95, s86, v102
    v_dot2_f32_bf16 v103, v95, v95, v103
    v_add_f32_dpp v96, v96, v96 quad_perm:[1,0,3,2] row_mask:0xf bank_mask:0xf
    v_add_f32_dpp v97, v97, v97 quad_perm:[1,0,3,2] row_mask:0xf bank_mask:0xf
    v_add_f32_dpp v98, v98, v98 quad_perm:[1,0,3,2] row_mask:0xf bank_mask:0xf
    v_add_f32_dpp v99, v99, v99 quad_perm:[1,0,3,2] row_mask:0xf bank_mask:0xf
    v_add_f32_dpp v100, v100, v100 quad_perm:[1,0,3,2] row_mask:0xf bank_mask:0xf
    v_add_f32_dpp v101, v101, v101 quad_perm:[1,0,3,2] row_mask:0xf bank_mask:0xf
    v_add_f32_dpp v102, v102, v102 quad_perm:[1,0,3,2] row_mask:0xf bank_mask:0xf
    v_add_f32_dpp v103, v103, v103 quad_perm:[1,0,3,2] row_mask:0xf bank_mask:0xf
    v_add_f32_dpp v96, v96, v96 quad_perm:[2,3,0,1] row_mask:0xf bank_mask:0xf
    v_add_f32_dpp v97, v97, v97 quad_perm:[2,3,0,1] row_mask:0xf bank_mask:0xf
    v_add_f32_dpp v98, v98, v98 quad_perm:[2,3,0,1] row_mask:0xf bank_mask:0xf
    v_add_f32_dpp v99, v99, v99 quad_perm:[2,3,0,1] row_mask:0xf bank_mask:0xf
    v_add_f32_dpp v100, v100, v100 quad_perm:[2,3,0,1] row_mask:0xf bank_mask:0xf
    v_add_f32_dpp v101, v101, v101 quad_perm:[2,3,0,1] row_mask:0xf bank_mask:0xf
    v_add_f32_dpp v102, v102, v102 quad_perm:[2,3,0,1] row_mask:0xf bank_mask:0xf
    v_add_f32_dpp v103, v103, v103 quad_perm:[2,3,0,1] row_mask:0xf bank_mask:0xf
    v_add_f32_dpp v96, v96, v96 row_half_mirror row_mask:0xf bank_mask:0xf
    v_add_f32_dpp v97, v97, v97 row_half_mirror row_mask:0xf bank_mask:0xf
    v_add_f32_dpp v98, v98, v98 row_half_mirror row_mask:0xf bank_mask:0xf
    v_add_f32_dpp v99, v99, v99 row_half_mirror row_mask:0xf bank_mask:0xf
    v_add_f32_dpp v100, v100, v100 row_half_mirror row_mask:0xf bank_mask:0xf
    v_add_f32_dpp v101, v101, v101 row_half_mirror row_mask:0xf bank_mask:0xf
    v_add_f32_dpp v102, v102, v102 row_half_mirror row_mask:0xf bank_mask:0xf
    v_add_f32_dpp v103, v103, v103 row_half_mirror row_mask:0xf bank_mask:0xf
    s_mov_b32 exec_lo, 0x2020202
    s_mov_b32 exec_hi, 0x2020202
    v_mov_b32 v96, v98
    v_mov_b32 v97, v99
    s_mov_b32 exec_lo, 0x4040404
    s_mov_b32 exec_hi, 0x4040404
    v_mov_b32 v96, v100
    v_mov_b32 v97, v101
    s_mov_b32 exec_lo, 0x8080808
    s_mov_b32 exec_hi, 0x8080808
    v_mov_b32 v96, v102
    v_mov_b32 v97, v103
    s_mov_b32 exec_lo, 0x0f0f0f0f
    s_mov_b32 exec_hi, 0x0f0f0f0f
    buffer_store_dwordx2 v[96:97], v104, s[16:19], s46 offen sc1
    s_mov_b64 exec, -1
    s_xor_b32 s50, s50, 1
L_bf_nost:
    s_cmp_lg_u32 s32, 0
    s_cbranch_scc1 L_arv47
    s_add_u32 s20, s82, 0x80
    s_addc_u32 s21, s83, 0
    s_mov_b32 s22, 0x4
    s_mov_b32 s23, 0x00020000
    buffer_load_dword v8, v124, s[20:23], 0 offen sc1
    s_waitcnt vmcnt(0)
    v_cmp_eq_u32 vcc, v124, v8
    s_cbranch_vccnz L_spin48
L_back49:
L_arv47:
    s_waitcnt vmcnt(0)
    s_barrier
    s_add_u32 s39, s91, 32768
    buffer_store_dword v124, v124, s[16:19], s39 offen sc1
    s_cmp_lt_u32 s35, 12
    s_cbranch_scc1 L_bf_nopf
    s_add_u32 s12, s72, 0x400000
    s_addc_u32 s13, s73, 0
    s_mov_b32 s14, 0x300000
    s_mov_b32 s15, 0x00020000
    s_sub_u32 s37, s35, 12
    s_lshl2_add_u32 s37, s37, s33
    s_lshl2_add_u32 s37, s37, s32
    s_lshl_b32 s37, s37, 13
    v_lshlrev_b32 v6, 7, v0
    buffer_load_dword v240, v6, s[12:15], s37 offen
    s_add_u32 s37, s37, 1048576
    buffer_load_dword v241, v6, s[12:15], s37 offen
    s_add_u32 s37, s37, 1048576
    buffer_load_dword v242, v6, s[12:15], s37 offen
    s_add_u32 s37, s37, 1048576
L_bf_nopf:
    s_lshr_b32 s51, s35, 2
    s_and_b32 s87, s35, 3
    s_mul_i32 s54, s51, 1441792
    s_lshl_b32 s37, s87, 9
    s_add_u32 s54, s54, s37
    s_mov_b32 s12, s76
    s_mov_b32 s13, s77
    s_mov_b32 s14, 0x700000
    s_mov_b32 s15, 0x00020000
    s_mov_b32 s39, 2048
    v_lshrrev_b32 v64, 3, v0
    v_lshlrev_b32 v65, 2, v0
    v_and_b32 v65, 64, v65
    v_and_b32 v66, 0x70, v1
    v_xor_b32 v65, v65, v66
    v_mad_u32_u24 v48, v64, s39, v65
    v_add_u32 v49, 16384, v48
    v_add_u32 v50, 128, v48
    v_add_u32 v51, 16512, v48
    v_add_u32 v52, 256, v48
    v_add_u32 v53, 16640, v48
    v_add_u32 v54, 384, v48
    v_add_u32 v55, 16768, v48
    s_mul_i32 s38, s32, 32768
    s_add_u32 s54, s54, s38
    s_lshl_b32 s42, s32, 11
    s_add_u32 m0, s42, 0
    s_nop 0
    buffer_load_dwordx4 v48, s[12:15], s54 offen lds
    s_add_u32 m0, s42, 1024
    s_nop 0
    buffer_load_dwordx4 v49, s[12:15], s54 offen lds
    s_add_u32 m0, s42, 8192
    s_nop 0
    buffer_load_dwordx4 v50, s[12:15], s54 offen lds
    s_add_u32 m0, s42, 9216
    s_nop 0
    buffer_load_dwordx4 v51, s[12:15], s54 offen lds
    s_add_u32 m0, s42, 16384
    s_nop 0
    buffer_load_dwordx4 v52, s[12:15], s54 offen lds
    s_add_u32 m0, s42, 17408
    s_nop 0
    buffer_load_dwordx4 v53, s[12:15], s54 offen lds
    s_add_u32 m0, s42, 24576
    s_nop 0
    buffer_load_dwordx4 v54, s[12:15], s54 offen lds
    s_add_u32 m0, s42, 25600
    s_nop 0
    buffer_load_dwordx4 v55, s[12:15], s54 offen lds
    s_add_u32 s54, s54, 131072
    s_add_u32 m0, s42, 32768
    s_nop 0
    buffer_load_dwordx4 v48, s[12:15], s54 offen lds
    s_add_u32 m0, s42, 33792
    s_nop 0
    buffer_load_dwordx4 v49, s[12:15], s54 offen lds
    s_add_u32 m0, s42, 40960
    s_nop 0
    buffer_load_dwordx4 v50, s[12:15], s54 offen lds
    s_add_u32 m0, s42, 41984
    s_nop 0
    buffer_load_dwordx4 v51, s[12:15], s54 offen lds
    s_add_u32 m0, s42, 49152
    s_nop 0
    buffer_load_dwordx4 v52, s[12:15], s54 offen lds
    s_add_u32 m0, s42, 50176
    s_nop 0
    buffer_load_dwordx4 v53, s[12:15], s54 offen lds
    s_add_u32 m0, s42, 57344
    s_nop 0
    buffer_load_dwordx4 v54, s[12:15], s54 offen lds
    s_add_u32 m0, s42, 58368
    s_nop 0
    buffer_load_dwordx4 v55, s[12:15], s54 offen lds
    s_add_u32 s54, s54, 131072
    s_add_u32 m0, s42, 65536
    s_nop 0
    buffer_load_dwordx4 v48, s[12:15], s54 offen lds
    s_add_u32 m0, s42, 66560
    s_nop 0
    buffer_load_dwordx4 v49, s[12:15], s54 offen lds
    s_add_u32 m0, s42, 73728
    s_nop 0
    buffer_load_dwordx4 v50, s[12:15], s54 offen lds
    s_add_u32 m0, s42, 74752
    s_nop 0
    buffer_load_dwordx4 v51, s[12:15], s54 offen lds
    s_add_u32 m0, s42, 81920
    s_nop 0
    buffer_load_dwordx4 v52, s[12:15], s54 offen lds
    s_add_u32 m0, s42, 82944
    s_nop 0
    buffer_load_dwordx4 v53, s[12:15], s54 offen lds
    s_add_u32 m0, s42, 90112
    s_nop 0
    buffer_load_dwordx4 v54, s[12:15], s54 offen lds
    s_add_u32 m0, s42, 91136
    s_nop 0
    buffer_load_dwordx4 v55, s[12:15], s54 offen lds
    s_add_u32 s54, s54, 131072
    s_add_u32 m0, s42, 98304
    s_nop 0
    buffer_load_dwordx4 v48, s[12:15], s54 offen lds
    s_add_u32 m0, s42, 99328
    s_nop 0
    buffer_load_dwordx4 v49, s[12:15], s54 offen lds
    s_add_u32 m0, s42, 106496
    s_nop 0
    buffer_load_dwordx4 v50, s[12:15], s54 offen lds
    s_add_u32 m0, s42, 107520
    s_nop 0
    buffer_load_dwordx4 v51, s[12:15], s54 offen lds
    s_add_u32 m0, s42, 114688
    s_nop 0
    buffer_load_dwordx4 v52, s[12:15], s54 offen lds
    s_add_u32 m0, s42, 115712
    s_nop 0
    buffer_load_dwordx4 v53, s[12:15], s54 offen lds
    s_add_u32 m0, s42, 122880
    s_nop 0
    buffer_load_dwordx4 v54, s[12:15], s54 offen lds
    s_add_u32 m0, s42, 123904
    s_nop 0
    buffer_load_dwordx4 v55, s[12:15], s54 offen lds
    s_add_u32 s54, s54, 131072
    v_lshrrev_b32 v64, 4, v0
    v_bfe_u32 v65, v0, 2, 2
    v_lshl_add_u32 v64, v64, 3, v65
    v_lshlrev_b32 v64, 7, v64
    v_lshrrev_b32 v65, 1, v65
    v_lshl_add_u32 v64, v65, 6, v64
    v_and_b32 v65, 3, v0
    v_lshl_add_u32 v64, v65, 4, v64
    s_lshl_b32 s37, s32, 13
    s_and_b32 s38, s51, 2
    s_lshl_b32 s38, s38, 5
    s_xor_b32 s38, s38, 0
    s_add_u32 s37, s37, s38
    v_xor_b32 v56, s37, v64
    s_lshl_b32 s37, s32, 13
    s_and_b32 s38, s51, 2
    s_lshl_b32 s38, s38, 5
    s_xor_b32 s38, s38, 8
    s_add_u32 s37, s37, s38
    v_xor_b32 v57, s37, v64
    s_lshl_b32 s37, s32, 13
    s_and_b32 s38, s51, 2
    s_lshl_b32 s38, s38, 5
    s_xor_b32 s38, s38, 64
    s_add_u32 s37, s37, s38
    v_xor_b32 v58, s37, v64
    s_lshl_b32 s37, s32, 13
    s_and_b32 s38, s51, 2
    s_lshl_b32 s38, s38, 5
    s_xor_b32 s38, s38, 72
    s_add_u32 s37, s37, s38
    v_xor_b32 v59, s37, v64
    s_and_b32 s39, s51, 1
    s_lshl_b32 s37, s39, 10
    v_add_u32 v2, s37, v1
    v_xor_b32 v3, 1024, v2
    v_add_u32 v4, 98304, v2
    v_add_u32 v5, 98304, v3
    s_mul_i32 s38, s51, 11*43
    s_lshr_b32 s38, s38, 7
    s_add_u32 s38, s38, 24
    s_lshl_b32 s37, s33, 6
    s_add_u32 s37, s37, s38
    s_lshl_b32 s37, s37, 7
    v_lshl_add_u32 v6, v0, 7, s37
    s_cmp_eq_u32 s32, 0
    s_cselect_b32 s37, 5, 0
    v_cmp_le_u32 vcc, s37, v0
    s_nop 1
    v_cndmask_b32 v6, v6, 2.0, vcc
    s_mul_i32 s43, s32, 4096
    s_mul_i32 s88, s32, 3072
    s_sub_u32 s89, s88, s43
    s_mul_i32 s41, s33, 8388608
    s_add_u32 s41, s41, 0x1000000
    s_mul_i32 s37, s51, 45056
    s_add_u32 s41, s41, s37
    s_add_u32 s41, s41, s43
    s_mul_i32 s90, s33, 8388608
    s_add_u32 s90, s90, 0x2fc0000
    s_lshl_b32 s37, s87, 16
    s_add_u32 s90, s90, s37
    s_lshl_b32 s37, s32, 12
    s_add_u32 s90, s90, s37
    s_and_b32 s37, s51, 3
    s_lshl_b32 s37, s37, 14
    s_add_u32 s90, s90, s37
    v_mov_b32 v104, 0
    v_mov_b32 v105, 0
    v_mov_b32 v106, 0
    v_mov_b32 v107, 0
    v_mov_b32 v108, 0
    v_mov_b32 v109, 0
    v_mov_b32 v110, 0
    v_mov_b32 v111, 0
    v_mov_b32 v17, 0x3f80
    v_and_b32 v16, 1, v0
    v_lshlrev_b32 v16, 4, v16
    v_lshlrev_b32 v16, v16, v17
    s_mov_b32 exec_lo, 0x300003
    s_mov_b32 exec_hi, 0x30000300
    v_mov_b32 v104, v16
    v_mov_b32 v110, v16
    s_mov_b32 exec_lo, 0xc0000c
    s_mov_b32 exec_hi, 0xc0000c00
    v_mov_b32 v105, v16
    v_mov_b32 v111, v16
    s_mov_b64 exec, -1
    s_add_u32 s38, s87, 44
    s_lshl_b32 s37, s33, 6
    s_add_u32 s37, s37, s38
    s_lshl_b32 s37, s37, 7
    v_lshl_add_u32 v8, v0, 9, s37
    v_cmp_le_u32 vcc, 5, v0
    s_nop 1
    v_cndmask_b32 v8, v8, 2.0, vcc
    s_lshl_b32 s38, s87, 2
    s_add_u32 s38, s38, s32
    s_lshl_b32 s38, s38, 1
    s_lshr_b32 s37, s51, 1
    s_add_u32 s38, s38, s37
    s_mul_i32 s53, s33, 2097152
    s_add_u32 s53, s53, 0x7f0000
    s_lshl_b32 s37, s38, 11
    s_add_u32 s53, s53, s37
    s_lshl_b32 s37, s39, 10
    s_add_u32 s53, s53, s37
    v_and_b32 v16, 15, v0
    v_and_b32 v17, 0x30, v0
    s_lshl_b32 s38, s38, 6
    s_mov_b32 s8, s78
    s_mov_b32 s9, s79
    s_mov_b32 s10, 0x800
    s_mov_b32 s11, 0x00020000
    buffer_load_dwordx4 v[24:27], v17, s[8:11], s38 offen
    v_lshl_add_u32 v9, v16, 11, v17
    v_add_u32 v9, s38, v9
    s_lshl_b32 s50, s33, 5
    s_add_u32 s50, s50, 31
    s_sub_u32 s50, s50, s39
    v_bfe_u32 v17, v0, 4, 1
    v_lshl_add_u32 v16, v16, 1, v17
    s_lshl_b32 s37, s32, 2
    s_add_u32 s37, s37, 65536
    v_lshl_add_u32 v10, v16, 4, s37
    v_and_b32 v16, 31, v0
    v_lshrrev_b32 v12, 5, v0
    v_lshlrev_b32 v12, 30, v12
    v_lshl_add_u32 v12, v16, 2, v12
    v_lshlrev_b32 v16, 4, v16
    v_add_u32 v11, 65536, v16
    s_lshl_b32 s37, s87, 1
    s_lshr_b32 s38, s51, 1
    s_add_u32 s37, s37, s38
    s_lshl_b32 s37, s37, 7
    s_add_u32 s55, s37, 0x543fc00
    s_cmp_eq_u32 s32, 2
    s_cselect_b32 s55, s55, 0x5f00000
    v_add_u32 v60, 0, v56
    v_add_u32 v61, 0, v57
    v_add_u32 v62, 0, v58
    v_add_u32 v63, 0, v59
    s_waitcnt vmcnt(25)
    s_barrier
    ds_read_b64_tr_b16 a[0:1], v60 offset:0
    ds_read_b64_tr_b16 a[2:3], v60 offset:512
    ds_read_b64_tr_b16 a[4:5], v61 offset:0
    ds_read_b64_tr_b16 a[6:7], v61 offset:512
    ds_read_b64_tr_b16 a[8:9], v62 offset:0
    ds_read_b64_tr_b16 a[10:11], v62 offset:512
    ds_read_b64_tr_b16 a[12:13], v63 offset:0
    ds_read_b64_tr_b16 a[14:15], v63 offset:512
    ds_read_b64_tr_b16 a[16:17], v60 offset:4096
    ds_read_b64_tr_b16 a[18:19], v60 offset:4608
    ds_read_b64_tr_b16 a[20:21], v61 offset:4096
    ds_read_b64_tr_b16 a[22:23], v61 offset:4608
    ds_read_b64_tr_b16 a[24:25], v62 offset:4096
    ds_read_b64_tr_b16 a[26:27], v62 offset:4608
    ds_read_b64_tr_b16 a[28:29], v63 offset:4096
    ds_read_b64_tr_b16 a[30:31], v63 offset:4608
    s_add_u32 m0, s42, 131072
    s_nop 0
    buffer_load_dwordx4 v48, s[12:15], s54 offen lds
    s_add_u32 m0, s42, 132096
    s_nop 0
    buffer_load_dwordx4 v49, s[12:15], s54 offen lds
    s_add_u32 m0, s42, 139264
    s_nop 0
    buffer_load_dwordx4 v50, s[12:15], s54 offen lds
    s_add_u32 m0, s42, 140288
    s_nop 0
    buffer_load_dwordx4 v51, s[12:15], s54 offen lds
    s_add_u32 m0, s42, 147456
    s_nop 0
    buffer_load_dwordx4 v52, s[12:15], s54 offen lds
    s_add_u32 m0, s42, 148480
    s_nop 0
    buffer_load_dwordx4 v53, s[12:15], s54 offen lds
    s_add_u32 m0, s42, 155648
    s_nop 0
    buffer_load_dwordx4 v54, s[12:15], s54 offen lds
    s_add_u32 m0, s42, 156672
    s_nop 0
    buffer_load_dwordx4 v55, s[12:15], s54 offen lds
    s_add_u32 s54, s54, 131072
    s_waitcnt lgkmcnt(0)
    v_add_u32 v60, 32768, v56
    v_add_u32 v61, 32768, v57
    v_add_u32 v62, 32768, v58
    v_add_u32 v63, 32768, v59
    s_waitcnt vmcnt(25)
    s_barrier
    ds_read_b64_tr_b16 a[32:33], v60 offset:0
    ds_read_b64_tr_b16 a[34:35], v60 offset:512
    ds_read_b64_tr_b16 a[36:37], v61 offset:0
    ds_read_b64_tr_b16 a[38:39], v61 offset:512
    ds_read_b64_tr_b16 a[40:41], v62 offset:0
    ds_read_b64_tr_b16 a[42:43], v62 offset:512
    ds_read_b64_tr_b16 a[44:45], v63 offset:0
    ds_read_b64_tr_b16 a[46:47], v63 offset:512
    ds_read_b64_tr_b16 a[48:49], v60 offset:4096
    ds_read_b64_tr_b16 a[50:51], v60 offset:4608
    ds_read_b64_tr_b16 a[52:53], v61 offset:4096
    ds_read_b64_tr_b16 a[54:55], v61 offset:4608
    ds_read_b64_tr_b16 a[56:57], v62 offset:4096
    ds_read_b64_tr_b16 a[58:59], v62 offset:4608
    ds_read_b64_tr_b16 a[60:61], v63 offset:4096
    ds_read_b64_tr_b16 a[62:63], v63 offset:4608
    s_add_u32 m0, s42, 0
    s_nop 0
    buffer_load_dwordx4 v48, s[12:15], s54 offen lds
    s_add_u32 m0, s42, 1024
    s_nop 0
    buffer_load_dwordx4 v49, s[12:15], s54 offen lds
    s_add_u32 m0, s42, 8192
    s_nop 0
    buffer_load_dwordx4 v50, s[12:15], s54 offen lds
    s_add_u32 m0, s42, 9216
    s_nop 0
    buffer_load_dwordx4 v51, s[12:15], s54 offen lds
    s_add_u32 m0, s42, 16384
    s_nop 0
    buffer_load_dwordx4 v52, s[12:15], s54 offen lds
    s_add_u32 m0, s42, 17408
    s_nop 0
    buffer_load_dwordx4 v53, s[12:15], s54 offen lds
    s_add_u32 m0, s42, 24576
    s_nop 0
    buffer_load_dwordx4 v54, s[12:15], s54 offen lds
    s_add_u32 m0, s42, 25600
    s_nop 0
    buffer_load_dwordx4 v55, s[12:15], s54 offen lds
    s_add_u32 s54, s54, 131072
    s_waitcnt lgkmcnt(0)
    v_add_u32 v60, 65536, v56
    v_add_u32 v61, 65536, v57
    v_add_u32 v62, 65536, v58
    v_add_u32 v63, 65536, v59
    s_waitcnt vmcnt(25)
    s_barrier
    ds_read_b64_tr_b16 a[64:65], v60 offset:0
    ds_read_b64_tr_b16 a[66:67], v60 offset:512
    ds_read_b64_tr_b16 a[68:69], v61 offset:0
    ds_read_b64_tr_b16 a[70:71], v61 offset:512
    ds_read_b64_tr_b16 a[72:73], v62 offset:0
    ds_read_b64_tr_b16 a[74:75], v62 offset:512
    ds_read_b64_tr_b16 a[76:77], v63 offset:0
    ds_read_b64_tr_b16 a[78:79], v63 offset:512
    ds_read_b64_tr_b16 a[80:81], v60 offset:4096
    ds_read_b64_tr_b16 a[82:83], v60 offset:4608
    ds_read_b64_tr_b16 a[84:85], v61 offset:4096
    ds_read_b64_tr_b16 a[86:87], v61 offset:4608
    ds_read_b64_tr_b16 a[88:89], v62 offset:4096
    ds_read_b64_tr_b16 a[90:91], v62 offset:4608
    ds_read_b64_tr_b16 a[92:93], v63 offset:4096
    ds_read_b64_tr_b16 a[94:95], v63 offset:4608
    s_add_u32 m0, s42, 32768
    s_nop 0
    buffer_load_dwordx4 v48, s[12:15], s54 offen lds
    s_add_u32 m0, s42, 33792
    s_nop 0
    buffer_load_dwordx4 v49, s[12:15], s54 offen lds
    s_add_u32 m0, s42, 40960
    s_nop 0
    buffer_load_dwordx4 v50, s[12:15], s54 offen lds
    s_add_u32 m0, s42, 41984
    s_nop 0
    buffer_load_dwordx4 v51, s[12:15], s54 offen lds
    s_add_u32 m0, s42, 49152
    s_nop 0
    buffer_load_dwordx4 v52, s[12:15], s54 offen lds
    s_add_u32 m0, s42, 50176
    s_nop 0
    buffer_load_dwordx4 v53, s[12:15], s54 offen lds
    s_add_u32 m0, s42, 57344
    s_nop 0
    buffer_load_dwordx4 v54, s[12:15], s54 offen lds
    s_add_u32 m0, s42, 58368
    s_nop 0
    buffer_load_dwordx4 v55, s[12:15], s54 offen lds
    s_add_u32 s54, s54, 131072
    s_waitcnt lgkmcnt(0)
    v_add_u32 v60, 98304, v56
    v_add_u32 v61, 98304, v57
    v_add_u32 v62, 98304, v58
    v_add_u32 v63, 98304, v59
    s_waitcnt vmcnt(25)
    s_barrier
    ds_read_b64_tr_b16 a[96:97], v60 offset:0
    ds_read_b64_tr_b16 a[98:99], v60 offset:512
    ds_read_b64_tr_b16 a[100:101], v61 offset:0
    ds_read_b64_tr_b16 a[102:103], v61 offset:512
    ds_read_b64_tr_b16 a[104:105], v62 offset:0
    ds_read_b64_tr_b16 a[106:107], v62 offset:512
    ds_read_b64_tr_b16 a[108:109], v63 offset:0
    ds_read_b64_tr_b16 a[110:111], v63 offset:512
    ds_read_b64_tr_b16 a[112:113], v60 offset:4096
    ds_read_b64_tr_b16 a[114:115], v60 offset:4608
    ds_read_b64_tr_b16 a[116:117], v61 offset:4096
    ds_read_b64_tr_b16 a[118:119], v61 offset:4608
    ds_read_b64_tr_b16 a[120:121], v62 offset:4096
    ds_read_b64_tr_b16 a[122:123], v62 offset:4608
    ds_read_b64_tr_b16 a[124:125], v63 offset:4096
    ds_read_b64_tr_b16 a[126:127], v63 offset:4608
    s_add_u32 m0, s42, 65536
    s_nop 0
    buffer_load_dwordx4 v48, s[12:15], s54 offen lds
    s_add_u32 m0, s42, 66560
    s_nop 0
    buffer_load_dwordx4 v49, s[12:15], s54 offen lds
    s_add_u32 m0, s42, 73728
    s_nop 0
    buffer_load_dwordx4 v50, s[12:15], s54 offen lds
    s_add_u32 m0, s42, 74752
    s_nop 0
    buffer_load_dwordx4 v51, s[12:15], s54 offen lds
    s_add_u32 m0, s42, 81920
    s_nop 0
    buffer_load_dwordx4 v52, s[12:15], s54 offen lds
    s_add_u32 m0, s42, 82944
    s_nop 0
    buffer_load_dwordx4 v53, s[12:15], s54 offen lds
    s_add_u32 m0, s42, 90112
    s_nop 0
    buffer_load_dwordx4 v54, s[12:15], s54 offen lds
    s_add_u32 m0, s42, 91136
    s_nop 0
    buffer_load_dwordx4 v55, s[12:15], s54 offen lds
    s_add_u32 s54, s54, 131072
    s_waitcnt lgkmcnt(0)
    v_add_u32 v60, 131072, v56
    v_add_u32 v61, 131072, v57
    v_add_u32 v62, 131072, v58
    v_add_u32 v63, 131072, v59
    s_waitcnt vmcnt(24)
    s_barrier
    ds_read_b64_tr_b16 a[128:129], v60 offset:0
    ds_read_b64_tr_b16 a[130:131], v60 offset:512
    ds_read_b64_tr_b16 a[132:133], v61 offset:0
    ds_read_b64_tr_b16 a[134:135], v61 offset:512
    ds_read_b64_tr_b16 a[136:137], v62 offset:0
    ds_read_b64_tr_b16 a[138:139], v62 offset:512
    ds_read_b64_tr_b16 a[140:141], v63 offset:0
    ds_read_b64_tr_b16 a[142:143], v63 offset:512
    ds_read_b64_tr_b16 a[144:145], v60 offset:4096
    ds_read_b64_tr_b16 a[146:147], v60 offset:4608
    ds_read_b64_tr_b16 a[148:149], v61 offset:4096
    ds_read_b64_tr_b16 a[150:151], v61 offset:4608
    ds_read_b64_tr_b16 a[152:153], v62 offset:4096
    ds_read_b64_tr_b16 a[154:155], v62 offset:4608
    ds_read_b64_tr_b16 a[156:157], v63 offset:4096
    ds_read_b64_tr_b16 a[158:159], v63 offset:4608
    s_add_u32 m0, s42, 98304
    s_nop 0
    buffer_load_dwordx4 v48, s[12:15], s54 offen lds
    s_add_u32 m0, s42, 99328
    s_nop 0
    buffer_load_dwordx4 v49, s[12:15], s54 offen lds
    s_add_u32 m0, s42, 106496
    s_nop 0
    buffer_load_dwordx4 v50, s[12:15], s54 offen lds
    s_add_u32 m0, s42, 107520
    s_nop 0
    buffer_load_dwordx4 v51, s[12:15], s54 offen lds
    s_add_u32 m0, s42, 114688
    s_nop 0
    buffer_load_dwordx4 v52, s[12:15], s54 offen lds
    s_add_u32 m0, s42, 115712
    s_nop 0
    buffer_load_dwordx4 v53, s[12:15], s54 offen lds
    s_add_u32 m0, s42, 122880
    s_nop 0
    buffer_load_dwordx4 v54, s[12:15], s54 offen lds
    s_add_u32 m0, s42, 123904
    s_nop 0
    buffer_load_dwordx4 v55, s[12:15], s54 offen lds
    s_add_u32 s54, s54, 131072
    s_waitcnt lgkmcnt(0)
    v_add_u32 v60, 0, v56
    v_add_u32 v61, 0, v57
    v_add_u32 v62, 0, v58
    v_add_u32 v63, 0, v59
    s_waitcnt vmcnt(24)
    s_barrier
    ds_read_b64_tr_b16 a[160:161], v60 offset:0
    ds_read_b64_tr_b16 a[162:163], v60 offset:512
    ds_read_b64_tr_b16 a[164:165], v61 offset:0
    ds_read_b64_tr_b16 a[166:167], v61 offset:512
    ds_read_b64_tr_b16 a[168:169], v62 offset:0
    ds_read_b64_tr_b16 a[170:171], v62 offset:512
    ds_read_b64_tr_b16 a[172:173], v63 offset:0
    ds_read_b64_tr_b16 a[174:175], v63 offset:512
    ds_read_b64_tr_b16 a[176:177], v60 offset:4096
    ds_read_b64_tr_b16 a[178:179], v60 offset:4608
    ds_read_b64_tr_b16 a[180:181], v61 offset:4096
    ds_read_b64_tr_b16 a[182:183], v61 offset:4608
    ds_read_b64_tr_b16 a[184:185], v62 offset:4096
    ds_read_b64_tr_b16 a[186:187], v62 offset:4608
    ds_read_b64_tr_b16 a[188:189], v63 offset:4096
    ds_read_b64_tr_b16 a[190:191], v63 offset:4608
    s_add_u32 m0, s42, 131072
    s_nop 0
    buffer_load_dwordx4 v48, s[12:15], s54 offen lds
    s_add_u32 m0, s42, 132096
    s_nop 0
    buffer_load_dwordx4 v49, s[12:15], s54 offen lds
    s_add_u32 m0, s42, 139264
    s_nop 0
    buffer_load_dwordx4 v50, s[12:15], s54 offen lds
    s_add_u32 m0, s42, 140288
    s_nop 0
    buffer_load_dwordx4 v51, s[12:15], s54 offen lds
    s_add_u32 m0, s42, 147456
    s_nop 0
    buffer_load_dwordx4 v52, s[12:15], s54 offen lds
    s_add_u32 m0, s42, 148480
    s_nop 0
    buffer_load_dwordx4 v53, s[12:15], s54 offen lds
    s_add_u32 m0, s42, 155648
    s_nop 0
    buffer_load_dwordx4 v54, s[12:15], s54 offen lds
    s_add_u32 m0, s42, 156672
    s_nop 0
    buffer_load_dwordx4 v55, s[12:15], s54 offen lds
    s_add_u32 s54, s54, 131072
    s_waitcnt lgkmcnt(0)
    v_add_u32 v60, 32768, v56
    v_add_u32 v61, 32768, v57
    v_add_u32 v62, 32768, v58
    v_add_u32 v63, 32768, v59
    s_waitcnt vmcnt(24)
    s_barrier
    ds_read_b64_tr_b16 a[192:193], v60 offset:0
    ds_read_b64_tr_b16 a[194:195], v60 offset:512
    ds_read_b64_tr_b16 a[196:197], v61 offset:0
    ds_read_b64_tr_b16 a[198:199], v61 offset:512
    ds_read_b64_tr_b16 a[200:201], v62 offset:0
    ds_read_b64_tr_b16 a[202:203], v62 offset:512
    ds_read_b64_tr_b16 a[204:205], v63 offset:0
    ds_read_b64_tr_b16 a[206:207], v63 offset:512
    ds_read_b64_tr_b16 a[208:209], v60 offset:4096
    ds_read_b64_tr_b16 a[210:211], v60 offset:4608
    ds_read_b64_tr_b16 a[212:213], v61 offset:4096
    ds_read_b64_tr_b16 a[214:215], v61 offset:4608
    ds_read_b64_tr_b16 a[216:217], v62 offset:4096
    ds_read_b64_tr_b16 a[218:219], v62 offset:4608
    ds_read_b64_tr_b16 a[220:221], v63 offset:4096
    ds_read_b64_tr_b16 a[222:223], v63 offset:4608
    s_add_u32 m0, s42, 0
    s_nop 0
    buffer_load_dwordx4 v48, s[12:15], s54 offen lds
    s_add_u32 m0, s42, 1024
    s_nop 0
    buffer_load_dwordx4 v49, s[12:15], s54 offen lds
    s_add_u32 m0, s42, 8192
    s_nop 0
    buffer_load_dwordx4 v50, s[12:15], s54 offen lds
    s_add_u32 m0, s42, 9216
    s_nop 0
    buffer_load_dwordx4 v51, s[12:15], s54 offen lds
    s_add_u32 m0, s42, 16384
    s_nop 0
    buffer_load_dwordx4 v52, s[12:15], s54 offen lds
    s_add_u32 m0, s42, 17408
    s_nop 0
    buffer_load_dwordx4 v53, s[12:15], s54 offen lds
    s_add_u32 m0, s42, 24576
    s_nop 0
    buffer_load_dwordx4 v54, s[12:15], s54 offen lds
    s_add_u32 m0, s42, 25600
    s_nop 0
    buffer_load_dwordx4 v55, s[12:15], s54 offen lds
    s_add_u32 s54, s54, 131072
    s_waitcnt lgkmcnt(0)
    v_add_u32 v60, 65536, v56
    v_add_u32 v61, 65536, v57
    v_add_u32 v62, 65536, v58
    v_add_u32 v63, 65536, v59
    s_waitcnt vmcnt(24)
    s_barrier
    ds_read_b64_tr_b16 a[224:225], v60 offset:0
    ds_read_b64_tr_b16 a[226:227], v60 offset:512
    ds_read_b64_tr_b16 a[228:229], v61 offset:0
    ds_read_b64_tr_b16 a[230:231], v61 offset:512
    ds_read_b64_tr_b16 a[232:233], v62 offset:0
    ds_read_b64_tr_b16 a[234:235], v62 offset:512
    ds_read_b64_tr_b16 a[236:237], v63 offset:0
    ds_read_b64_tr_b16 a[238:239], v63 offset:512
    ds_read_b64_tr_b16 a[240:241], v60 offset:4096
    ds_read_b64_tr_b16 a[242:243], v60 offset:4608
    ds_read_b64_tr_b16 a[244:245], v61 offset:4096
    ds_read_b64_tr_b16 a[246:247], v61 offset:4608
    ds_read_b64_tr_b16 a[248:249], v62 offset:4096
    ds_read_b64_tr_b16 a[250:251], v62 offset:4608
    ds_read_b64_tr_b16 a[252:253], v63 offset:4096
    ds_read_b64_tr_b16 a[254:255], v63 offset:4608
    s_waitcnt lgkmcnt(0)
    v_add_u32 v60, 98304, v56
    v_add_u32 v61, 98304, v57
    v_add_u32 v62, 98304, v58
    v_add_u32 v63, 98304, v59
    s_waitcnt vmcnt(16)
    s_barrier
    ds_read_b64_tr_b16 v[160:161], v60 offset:0
    ds_read_b64_tr_b16 v[162:163], v60 offset:512
    ds_read_b64_tr_b16 v[164:165], v61 offset:0
    ds_read_b64_tr_b16 v[166:167], v61 offset:512
    ds_read_b64_tr_b16 v[168:169], v62 offset:0
    ds_read_b64_tr_b16 v[170:171], v62 offset:512
    ds_read_b64_tr_b16 v[172:173], v63 offset:0
    ds_read_b64_tr_b16 v[174:175], v63 offset:512
    ds_read_b64_tr_b16 v[176:177], v60 offset:4096
    ds_read_b64_tr_b16 v[178:179], v60 offset:4608
    ds_read_b64_tr_b16 v[180:181], v61 offset:4096
    ds_read_b64_tr_b16 v[182:183], v61 offset:4608
    ds_read_b64_tr_b16 v[184:185], v62 offset:4096
    ds_read_b64_tr_b16 v[186:187], v62 offset:4608
    ds_read_b64_tr_b16 v[188:189], v63 offset:4096
    ds_read_b64_tr_b16 v[190:191], v63 offset:4608
    s_waitcnt lgkmcnt(0)
    v_add_u32 v60, 131072, v56
    v_add_u32 v61, 131072, v57
    v_add_u32 v62, 131072, v58
    v_add_u32 v63, 131072, v59
    s_waitcnt vmcnt(8)
    s_barrier
    ds_read_b64_tr_b16 v[192:193], v60 offset:0
    ds_read_b64_tr_b16 v[194:195], v60 offset:512
    ds_read_b64_tr_b16 v[196:197], v61 offset:0
    ds_read_b64_tr_b16 v[198:199], v61 offset:512
    ds_read_b64_tr_b16 v[200:201], v62 offset:0
    ds_read_b64_tr_b16 v[202:203], v62 offset:512
    ds_read_b64_tr_b16 v[204:205], v63 offset:0
    ds_read_b64_tr_b16 v[206:207], v63 offset:512
    ds_read_b64_tr_b16 v[208:209], v60 offset:4096
    ds_read_b64_tr_b16 v[210:211], v60 offset:4608
    ds_read_b64_tr_b16 v[212:213], v61 offset:4096
    ds_read_b64_tr_b16 v[214:215], v61 offset:4608
    ds_read_b64_tr_b16 v[216:217], v62 offset:4096
    ds_read_b64_tr_b16 v[218:219], v62 offset:4608
    ds_read_b64_tr_b16 v[220:221], v63 offset:4096
    ds_read_b64_tr_b16 v[222:223], v63 offset:4608
    s_waitcnt lgkmcnt(0)
    v_add_u32 v60, 0, v56
    v_add_u32 v61, 0, v57
    v_add_u32 v62, 0, v58
    v_add_u32 v63, 0, v59
    s_waitcnt vmcnt(0)
    s_barrier
    ds_read_b64_tr_b16 v[224:225], v60 offset:0
    ds_read_b64_tr_b16 v[226:227], v60 offset:512
    ds_read_b64_tr_b16 v[228:229], v61 offset:0
    ds_read_b64_tr_b16 v[230:231], v61 offset:512
    ds_read_b64_tr_b16 v[232:233], v62 offset:0
    ds_read_b64_tr_b16 v[234:235], v62 offset:512
    ds_read_b64_tr_b16 v[236:237], v63 offset:0
    ds_read_b64_tr_b16 v[238:239], v63 offset:512
    ds_read_b64_tr_b16 v[240:241], v60 offset:4096
    ds_read_b64_tr_b16 v[242:243], v60 offset:4608
    ds_read_b64_tr_b16 v[244:245], v61 offset:4096
    ds_read_b64_tr_b16 v[246:247], v61 offset:4608
    ds_read_b64_tr_b16 v[248:249], v62 offset:4096
    ds_read_b64_tr_b16 v[250:251], v62 offset:4608
    ds_read_b64_tr_b16 v[252:253], v63 offset:4096
    ds_read_b64_tr_b16 v[254:255], v63 offset:4608
    s_waitcnt lgkmcnt(0)
    s_barrier
    s_mov_b32 s37, 0xffff0000
    v_lshlrev_b32 v112, 16, v24
    v_and_b32 v113, s37, v24
    v_lshlrev_b32 v114, 16, v25
    v_and_b32 v115, s37, v25
    v_lshlrev_b32 v116, 16, v26
    v_and_b32 v117, s37, v26
    v_lshlrev_b32 v118, 16, v27
    v_and_b32 v119, s37, v27
    s_add_u32 s37, s90, 8388608
    v_mov_b32 v16, -1
    v_mov_b32 v17, -1
    v_mov_b32 v18, -1
    v_mov_b32 v19, -1
    buffer_store_dwordx4 v[16:19], v1, s[16:19], s37 offen offset:0 sc1
    buffer_store_dwordx4 v[16:19], v1, s[16:19], s37 offen offset:1024 sc1
    buffer_store_dwordx4 v[16:19], v1, s[16:19], s37 offen offset:2048 sc1
    buffer_store_dwordx4 v[16:19], v1, s[16:19], s37 offen offset:3072 sc1
    s_cmp_lg_u32 s32, 0
    s_cbranch_scc1 L_arv50
    s_add_u32 s20, s82, 0x80
    s_addc_u32 s21, s83, 0
    s_mov_b32 s22, 0x4
    s_mov_b32 s23, 0x00020000
    buffer_load_dword v80, v124, s[20:23], 0 offen sc1
    s_waitcnt vmcnt(0)
    v_cmp_eq_u32 vcc, v124, v80
    s_cbranch_vccnz L_spin51
L_back52:
L_arv50:
    s_add_u32 s96, s41, 8126464
    s_mov_b32 s98, s41
    s_mov_b32 s45, 0x5530000
    buffer_load_dword v96, v6, s[16:19], s45 offen sc1
    s_waitcnt vmcnt(0)
    v_cmp_ne_u32 vcc, 0, v96
    s_cbranch_vccnz L_spin53
L_back54:
    s_barrier
    s_add_u32 m0, s43, 0
    s_add_u32 s42, s41, 0
    buffer_load_dwordx4 v1, s[16:19], s42 offen offset:0 sc1 lds
    buffer_load_dwordx4 v1, s[16:19], s42 offen offset:1024 sc1 lds
    buffer_load_dwordx4 v1, s[16:19], s42 offen offset:2048 sc1 lds
    buffer_load_dwordx4 v1, s[16:19], s42 offen offset:3072 sc1 lds
    s_add_u32 m0, s88, 16384
    s_add_u32 s42, s41, 16384
    s_add_u32 s42, s42, s89
    buffer_load_dwordx4 v1, s[16:19], s42 offen offset:0 sc1 lds
    buffer_load_dwordx4 v1, s[16:19], s42 offen offset:1024 sc1 lds
    buffer_load_dwordx4 v1, s[16:19], s42 offen offset:2048 sc1 lds
    s_add_u32 m0, s43, 28672
    s_add_u32 s42, s41, 28672
    buffer_load_dwordx4 v1, s[16:19], s42 offen offset:0 sc1 lds
    buffer_load_dwordx4 v1, s[16:19], s42 offen offset:1024 sc1 lds
    buffer_load_dwordx4 v1, s[16:19], s42 offen offset:2048 sc1 lds
    buffer_load_dwordx4 v1, s[16:19], s42 offen offset:3072 sc1 lds
    s_add_u32 s45, s45, 65536
    s_waitcnt vmcnt(0) lgkmcnt(0)
    s_barrier
    s_mov_b32 s52, 0x5e00000
    s_mov_b32 s46, 0x5e00000
    s_add_u32 s20, s84, 0x5e00000
    s_addc_u32 s21, s85, 0
    s_mov_b32 s22, 0x400000
    s_mov_b32 s23, 0x00020000
    ds_read_b128 v[80:83], v2 offset:0
    ds_read_b128 v[84:87], v3 offset:0
    s_mov_b32 s36, 0
    s_waitcnt lgkmcnt(0)
    s_nop 7
L_bf_b0:
    v_mfma_f32_16x16x32_bf16 v[16:19], a[0:3], v[80:83], v[112:115]
    s_sub_u32 s47, s45, 196608
    ds_read_b128 v[88:91], v2 offset:2048
    s_max_u32 s47, s47, 0x5500000
    v_mfma_f32_16x16x32_bf16 v[24:27], a[0:3], v[84:87], 0
    buffer_load_dword v13, v8, s[16:19], s47 offen sc1
    v_mfma_f32_16x16x32_bf16 v[28:31], a[4:7], v[84:87], 0
    s_and_b32 s38, s53, 0xffffffff
    ds_read_b128 v[92:95], v3 offset:2048
    s_cmp_lt_i32 s36, 1
    v_mfma_f32_16x16x32_bf16 v[20:23], a[4:7], v[80:83], v[116:119]
    s_cselect_b32 s38, 0x5e00000, s38
    v_mfma_f32_16x16x32_bf16 v[32:35], a[8:11], v[80:83], 0
    buffer_load_dwordx4 v[136:139], v1, s[16:19], s38 offen sc1
    v_mfma_f32_16x16x32_bf16 v[40:43], a[8:11], v[84:87], 0
    s_add_u32 s53, s53, 65536
    ds_read_b128 v[144:147], v11 offset:0
    s_and_b32 s44, s90, 0xffffffff
    v_mfma_f32_16x16x32_bf16 v[44:47], a[12:15], v[84:87], 0
    s_cmp_lt_i32 s36, 1
    s_cselect_b32 s44, 0x5e00000, s44
    s_xor_b32 s49, s44, 16384
    v_mfma_f32_16x16x32_bf16 v[36:39], a[12:15], v[80:83], 0
    s_waitcnt lgkmcnt(1)
    v_cvt_pk_bf16_f32 v56, v56, v57
    v_cvt_pk_bf16_f32 v57, v58, v59
    v_mfma_f32_16x16x32_bf16 v[16:19], a[16:19], v[88:91], v[16:19]
    ds_read_b128 v[80:83], v2 offset:4096
    v_cvt_pk_bf16_f32 v58, v60, v61
    v_mfma_f32_16x16x32_bf16 v[24:27], a[16:19], v[92:95], v[24:27]
    v_cvt_pk_bf16_f32 v59, v62, v63
    v_mfma_f32_16x16x32_bf16 v[28:31], a[20:23], v[92:95], v[28:31]
    s_waitcnt lgkmcnt(1)
    ds_read_b128 v[84:87], v3 offset:4096
    v_add_f32 v144, v144, v145
    v_mfma_f32_16x16x32_bf16 v[20:23], a[20:23], v[88:91], v[20:23]
    buffer_store_dwordx4 v[56:59], v1, s[16:19], s49 offen offset:0 sc1
    v_mfma_f32_16x16x32_bf16 v[32:35], a[24:27], v[88:91], v[32:35]
    s_xor_b32 s49, s44, 32768
    v_cvt_pk_bf16_f32 v64, v64, v65
    v_cvt_pk_bf16_f32 v65, v66, v67
    v_mfma_f32_16x16x32_bf16 v[40:43], a[24:27], v[92:95], v[40:43]
    v_cvt_pk_bf16_f32 v66, v68, v69
    v_cvt_pk_bf16_f32 v67, v70, v71
    v_mfma_f32_16x16x32_bf16 v[44:47], a[28:31], v[92:95], v[44:47]
    buffer_store_dwordx4 v[64:67], v1, s[16:19], s49 offen offset:1024 sc1
    v_mfma_f32_16x16x32_bf16 v[36:39], a[28:31], v[88:91], v[36:39]
    s_waitcnt lgkmcnt(0)
    v_add_f32 v146, v146, v147
    v_add_f32 v144, v144, v146
    v_mfma_f32_16x16x32_bf16 v[16:19], a[32:35], v[80:83], v[16:19]
    s_xor_b32 s49, s44, 49152
    ds_read_b128 v[88:91], v2 offset:6144
    v_cvt_pk_bf16_f32 v72, v72, v73
    v_mfma_f32_16x16x32_bf16 v[24:27], a[32:35], v[84:87], v[24:27]
    v_cvt_pk_bf16_f32 v73, v74, v75
    v_cvt_pk_bf16_f32 v74, v76, v77
    v_mfma_f32_16x16x32_bf16 v[28:31], a[36:39], v[84:87], v[28:31]
    ds_read_b128 v[92:95], v3 offset:6144
    v_cvt_pk_bf16_f32 v75, v78, v79
    v_mfma_f32_16x16x32_bf16 v[20:23], a[36:39], v[80:83], v[20:23]
    buffer_store_dwordx4 v[72:75], v1, s[16:19], s49 offen offset:2048 sc1
    v_mfma_f32_16x16x32_bf16 v[32:35], a[40:43], v[80:83], v[32:35]
    s_add_u32 s90, s90, 262144
    v_mfma_f32_16x16x32_bf16 v[40:43], a[40:43], v[84:87], v[40:43]
    v_mfma_f32_16x16x32_bf16 v[44:47], a[44:47], v[84:87], v[44:47]
    buffer_store_dword v144, v12, s[16:19], s46 offen sc1
    v_mfma_f32_16x16x32_bf16 v[36:39], a[44:47], v[80:83], v[36:39]
    s_waitcnt lgkmcnt(0)
    v_mfma_f32_16x16x32_bf16 v[16:19], a[48:51], v[88:91], v[16:19]
    s_add_u32 s98, s98, 262144
    ds_read_b128 v[80:83], v2 offset:8192
    s_min_i32 s98, s98, s96
    v_mfma_f32_16x16x32_bf16 v[24:27], a[48:51], v[92:95], v[24:27]
    s_and_b32 s41, s98, 0xffffffff
    s_add_u32 m0, s43, 98304
    s_add_u32 s42, s41, 0
    v_mfma_f32_16x16x32_bf16 v[28:31], a[52:55], v[92:95], v[28:31]
    ds_read_b128 v[84:87], v3 offset:8192
    v_mfma_f32_16x16x32_bf16 v[20:23], a[52:55], v[88:91], v[20:23]
    v_mfma_f32_16x16x32_bf16 v[32:35], a[56:59], v[88:91], v[32:35]
    v_mfma_f32_16x16x32_bf16 v[40:43], a[56:59], v[92:95], v[40:43]
    v_mfma_f32_16x16x32_bf16 v[44:47], a[60:63], v[92:95], v[44:47]
    v_mfma_f32_16x16x32_bf16 v[36:39], a[60:63], v[88:91], v[36:39]
    s_waitcnt lgkmcnt(0)
    v_mfma_f32_16x16x32_bf16 v[16:19], a[64:67], v[80:83], v[16:19]
    ds_read_b128 v[88:91], v2 offset:10240
    v_mfma_f32_16x16x32_bf16 v[24:27], a[64:67], v[84:87], v[24:27]
    v_mfma_f32_16x16x32_bf16 v[28:31], a[68:71], v[84:87], v[28:31]
    ds_read_b128 v[92:95], v3 offset:10240
    v_mfma_f32_16x16x32_bf16 v[20:23], a[68:71], v[80:83], v[20:23]
    v_mfma_f32_16x16x32_bf16 v[32:35], a[72:75], v[80:83], v[32:35]
    v_mfma_f32_16x16x32_bf16 v[40:43], a[72:75], v[84:87], v[40:43]
    v_mfma_f32_16x16x32_bf16 v[44:47], a[76:79], v[84:87], v[44:47]
    v_mfma_f32_16x16x32_bf16 v[36:39], a[76:79], v[80:83], v[36:39]
    s_waitcnt lgkmcnt(0)
    v_mfma_f32_16x16x32_bf16 v[16:19], a[80:83], v[88:91], v[16:19]
    ds_read_b128 v[80:83], v2 offset:12288
    v_mfma_f32_16x16x32_bf16 v[24:27], a[80:83], v[92:95], v[24:27]
    v_mfma_f32_16x16x32_bf16 v[28:31], a[84:87], v[92:95], v[28:31]
    ds_read_b128 v[84:87], v3 offset:12288
    v_mfma_f32_16x16x32_bf16 v[20:23], a[84:87], v[88:91], v[20:23]
    v_mfma_f32_16x16x32_bf16 v[32:35], a[88:91], v[88:91], v[32:35]
    s_waitcnt vmcnt(5)
    v_cmp_ne_u32 vcc, 0, v13
    v_mfma_f32_16x16x32_bf16 v[40:43], a[88:91], v[92:95], v[40:43]
    v_mfma_f32_16x16x32_bf16 v[44:47], a[92:95], v[92:95], v[44:47]
    s_cbranch_vccnz L_spin55
L_back56:
    s_sub_u32 s48, s90, 524288
    s_and_b32 s48, s48, 0xffffffff
    v_mfma_f32_16x16x32_bf16 v[36:39], a[92:95], v[88:91], v[36:39]
    s_waitcnt lgkmcnt(0)
    s_cmp_lt_i32 s36, 2
    s_cselect_b32 s48, s52, s48
    v_mfma_f32_16x16x32_bf16 v[16:19], a[96:99], v[80:83], v[16:19]
    ds_read_b128 v[88:91], v2 offset:14336
    v_mfma_f32_16x16x32_bf16 v[24:27], a[96:99], v[84:87], v[24:27]
    buffer_load_dwordx4 v[140:143], v1, s[16:19], s48 offen offset:0 sc1
    v_mfma_f32_16x16x32_bf16 v[28:31], a[100:103], v[84:87], v[28:31]
    ds_read_b128 v[92:95], v3 offset:14336
    v_mfma_f32_16x16x32_bf16 v[20:23], a[100:103], v[80:83], v[20:23]
    v_mfma_f32_16x16x32_bf16 v[32:35], a[104:107], v[80:83], v[32:35]
    buffer_load_dword v96, v6, s[16:19], s45 offen sc1
    v_mfma_f32_16x16x32_bf16 v[40:43], a[104:107], v[84:87], v[40:43]
    v_mfma_f32_16x16x32_bf16 v[44:47], a[108:111], v[84:87], v[44:47]
    v_mfma_f32_16x16x32_bf16 v[36:39], a[108:111], v[80:83], v[36:39]
    s_waitcnt lgkmcnt(0)
    v_mfma_f32_16x16x32_bf16 v[16:19], a[112:115], v[88:91], v[16:19]
    ds_read_b128 v[80:83], v2 offset:16384
    v_mfma_f32_16x16x32_bf16 v[24:27], a[112:115], v[92:95], v[24:27]
    buffer_load_dwordx4 v[144:147], v1, s[16:19], s48 offen offset:1024 sc1
    v_mfma_f32_16x16x32_bf16 v[28:31], a[116:119], v[92:95], v[28:31]
    ds_read_b128 v[84:87], v3 offset:16384
    v_mfma_f32_16x16x32_bf16 v[20:23], a[116:119], v[88:91], v[20:23]
    v_mfma_f32_16x16x32_bf16 v[32:35], a[120:123], v[88:91], v[32:35]
    buffer_load_dwordx4 v[148:151], v1, s[16:19], s48 offen offset:2048 sc1
    v_mfma_f32_16x16x32_bf16 v[40:43], a[120:123], v[92:95], v[40:43]
    v_mfma_f32_16x16x32_bf16 v[44:47], a[124:127], v[92:95], v[44:47]
    v_mfma_f32_16x16x32_bf16 v[36:39], a[124:127], v[88:91], v[36:39]
    s_waitcnt lgkmcnt(0)
    v_mfma_f32_16x16x32_bf16 v[16:19], a[128:131], v[80:83], v[16:19]
    ds_read_b128 v[88:91], v2 offset:18432
    v_mfma_f32_16x16x32_bf16 v[24:27], a[128:131], v[84:87], v[24:27]
    buffer_load_dwordx4 v[152:155], v1, s[16:19], s48 offen offset:3072 sc1
    v_mfma_f32_16x16x32_bf16 v[28:31], a[132:135], v[84:87], v[28:31]
    s_sub_u32 s47, s36, 2
    ds_read_b128 v[92:95], v3 offset:18432
    s_cmp_lt_u32 s47, 16
    v_mfma_f32_16x16x32_bf16 v[20:23], a[132:135], v[80:83], v[20:23]
    s_cselect_b32 s48, 0x5000000, s52
    s_add_u32 s20, s84, s48
    s_addc_u32 s21, s85, 0
    v_mfma_f32_16x16x32_bf16 v[32:35], a[136:139], v[80:83], v[32:35]
    s_cmp_ge_i32 s47, 16
    s_cselect_b32 s20, s80, s20
    s_cselect_b32 s21, s81, s21
    v_mfma_f32_16x16x32_bf16 v[40:43], a[136:139], v[84:87], v[40:43]
    s_and_b32 s48, s47, 15
    s_lshl_b32 s48, s48, 1
    s_sub_u32 s48, s50, s48
    v_mfma_f32_16x16x32_bf16 v[44:47], a[140:143], v[84:87], v[44:47]
    s_lshl_b32 s46, s48, 10
    s_sub_u32 s46, s55, s46
    s_cmp_lt_u32 s47, 16
    v_mfma_f32_16x16x32_bf16 v[36:39], a[140:143], v[80:83], v[36:39]
    s_waitcnt lgkmcnt(0)
    s_cselect_b32 s46, s46, s52
    s_lshl_b32 s48, s48, 15
    v_mfma_f32_16x16x32_bf16 v[16:19], a[144:147], v[88:91], v[16:19]
    ds_read_b128 v[80:83], v2 offset:20480
    v_mfma_f32_16x16x32_bf16 v[24:27], a[144:147], v[92:95], v[24:27]
    v_mfma_f32_16x16x32_bf16 v[28:31], a[148:151], v[92:95], v[28:31]
    ds_read_b128 v[84:87], v3 offset:20480
    v_mfma_f32_16x16x32_bf16 v[20:23], a[148:151], v[88:91], v[20:23]
    v_mfma_f32_16x16x32_bf16 v[32:35], a[152:155], v[88:91], v[32:35]
    v_mfma_f32_16x16x32_bf16 v[40:43], a[152:155], v[92:95], v[40:43]
    v_mfma_f32_16x16x32_bf16 v[44:47], a[156:159], v[92:95], v[44:47]
    v_mfma_f32_16x16x32_bf16 v[36:39], a[156:159], v[88:91], v[36:39]
    s_waitcnt lgkmcnt(0)
    v_mfma_f32_16x16x32_bf16 v[16:19], a[160:163], v[80:83], v[16:19]
    ds_read_b128 v[88:91], v2 offset:22528
    v_mfma_f32_16x16x32_bf16 v[24:27], a[160:163], v[84:87], v[24:27]
    v_mfma_f32_16x16x32_bf16 v[28:31], a[164:167], v[84:87], v[28:31]
    ds_read_b128 v[92:95], v3 offset:22528
    v_mfma_f32_16x16x32_bf16 v[20:23], a[164:167], v[80:83], v[20:23]
    v_mfma_f32_16x16x32_bf16 v[32:35], a[168:171], v[80:83], v[32:35]
    v_mfma_f32_16x16x32_bf16 v[40:43], a[168:171], v[84:87], v[40:43]
    v_mfma_f32_16x16x32_bf16 v[44:47], a[172:175], v[84:87], v[44:47]
    v_mfma_f32_16x16x32_bf16 v[36:39], a[172:175], v[80:83], v[36:39]
    s_waitcnt lgkmcnt(0)
    v_mfma_f32_16x16x32_bf16 v[16:19], a[176:179], v[88:91], v[16:19]
    ds_read_b128 v[80:83], v2 offset:24576
    v_mfma_f32_16x16x32_bf16 v[24:27], a[176:179], v[92:95], v[24:27]
    v_mfma_f32_16x16x32_bf16 v[28:31], a[180:183], v[92:95], v[28:31]
    ds_read_b128 v[84:87], v3 offset:24576
    v_mfma_f32_16x16x32_bf16 v[20:23], a[180:183], v[88:91], v[20:23]
    v_mfma_f32_16x16x32_bf16 v[32:35], a[184:187], v[88:91], v[32:35]
    v_mfma_f32_16x16x32_bf16 v[40:43], a[184:187], v[92:95], v[40:43]
    v_mfma_f32_16x16x32_bf16 v[44:47], a[188:191], v[92:95], v[44:47]
    s_waitcnt vmcnt(3)
    v_cmp_ne_u32 vcc, 0, v96
    v_mfma_f32_16x16x32_bf16 v[36:39], a[188:191], v[88:91], v[36:39]
    s_waitcnt lgkmcnt(0)
    v_mfma_f32_16x16x32_bf16 v[16:19], a[192:195], v[80:83], v[16:19]
    s_cbranch_vccnz L_spin57
L_back58:
    ds_read_b128 v[88:91], v2 offset:26624
    s_barrier
    v_mfma_f32_16x16x32_bf16 v[24:27], a[192:195], v[84:87], v[24:27]
    buffer_load_dwordx4 v1, s[16:19], s42 offen offset:0 sc1 lds
    v_mfma_f32_16x16x32_bf16 v[28:31], a[196:199], v[84:87], v[28:31]
    ds_read_b128 v[92:95], v3 offset:26624
    v_mfma_f32_16x16x32_bf16 v[20:23], a[196:199], v[80:83], v[20:23]
    v_mfma_f32_16x16x32_bf16 v[32:35], a[200:203], v[80:83], v[32:35]
    v_mfma_f32_16x16x32_bf16 v[40:43], a[200:203], v[84:87], v[40:43]
    buffer_load_dwordx4 v1, s[16:19], s42 offen offset:1024 sc1 lds
    v_mfma_f32_16x16x32_bf16 v[44:47], a[204:207], v[84:87], v[44:47]
    v_mfma_f32_16x16x32_bf16 v[36:39], a[204:207], v[80:83], v[36:39]
    s_waitcnt lgkmcnt(0)
    v_mfma_f32_16x16x32_bf16 v[16:19], a[208:211], v[88:91], v[16:19]
    ds_read_b128 v[80:83], v2 offset:28672
    v_mfma_f32_16x16x32_bf16 v[24:27], a[208:211], v[92:95], v[24:27]
    buffer_load_dwordx4 v1, s[16:19], s42 offen offset:2048 sc1 lds
    v_mfma_f32_16x16x32_bf16 v[28:31], a[212:215], v[92:95], v[28:31]
    ds_read_b128 v[84:87], v3 offset:28672
    v_mfma_f32_16x16x32_bf16 v[20:23], a[212:215], v[88:91], v[20:23]
    v_mfma_f32_16x16x32_bf16 v[32:35], a[216:219], v[88:91], v[32:35]
    v_mfma_f32_16x16x32_bf16 v[40:43], a[216:219], v[92:95], v[40:43]
    buffer_load_dwordx4 v1, s[16:19], s42 offen offset:3072 sc1 lds
    v_mfma_f32_16x16x32_bf16 v[44:47], a[220:223], v[92:95], v[44:47]
    s_add_u32 m0, s88, 114688
    s_add_u32 s42, s41, 16384
    s_add_u32 s42, s42, s89
    v_mfma_f32_16x16x32_bf16 v[36:39], a[220:223], v[88:91], v[36:39]
    s_waitcnt lgkmcnt(0)
    v_mfma_f32_16x16x32_bf16 v[16:19], a[224:227], v[80:83], v[16:19]
    ds_read_b128 v[88:91], v2 offset:30720
    v_mfma_f32_16x16x32_bf16 v[24:27], a[224:227], v[84:87], v[24:27]
    buffer_load_dwordx4 v1, s[16:19], s42 offen offset:0 sc1 lds
    v_mfma_f32_16x16x32_bf16 v[28:31], a[228:231], v[84:87], v[28:31]
    ds_read_b128 v[92:95], v3 offset:30720
    v_mfma_f32_16x16x32_bf16 v[20:23], a[228:231], v[80:83], v[20:23]
    v_mfma_f32_16x16x32_bf16 v[32:35], a[232:235], v[80:83], v[32:35]
    s_waitcnt vmcnt(5)
    v_mfma_f32_16x16x32_bf16 v[128:131], v[104:107], v[140:143], v[128:131]
    v_mfma_f32_16x16x32_bf16 v[132:135], v[108:111], v[140:143], v[132:135]
    v_mfma_f32_16x16x32_bf16 v[128:131], v[104:107], v[144:147], v[128:131]
    v_mfma_f32_16x16x32_bf16 v[132:135], v[108:111], v[144:147], v[132:135]
    v_mfma_f32_16x16x32_bf16 v[128:131], v[104:107], v[148:151], v[128:131]
    v_mfma_f32_16x16x32_bf16 v[132:135], v[108:111], v[148:151], v[132:135]
    v_mfma_f32_16x16x32_bf16 v[128:131], v[104:107], v[152:155], v[128:131]
    v_mfma_f32_16x16x32_bf16 v[132:135], v[108:111], v[152:155], v[132:135]
    v_mfma_f32_16x16x32_bf16 v[40:43], a[232:235], v[84:87], v[40:43]
    buffer_load_dwordx4 v1, s[16:19], s42 offen offset:1024 sc1 lds
    v_mfma_f32_16x16x32_bf16 v[44:47], a[236:239], v[84:87], v[44:47]
    s_nop 0
    v_cvt_pk_bf16_f32 v140, v128, v129
    v_cvt_pk_bf16_f32 v141, v130, v131
    v_mfma_f32_16x16x32_bf16 v[36:39], a[236:239], v[80:83], v[36:39]
    s_waitcnt lgkmcnt(0)
    v_cvt_pk_bf16_f32 v142, v132, v133
    v_cvt_pk_bf16_f32 v143, v134, v135
    v_mfma_f32_16x16x32_bf16 v[16:19], a[240:243], v[88:91], v[16:19]
    ds_read_b128 v[80:83], v2 offset:32768
    v_mfma_f32_16x16x32_bf16 v[24:27], a[240:243], v[92:95], v[24:27]
    buffer_load_dwordx4 v1, s[16:19], s42 offen offset:2048 sc1 lds
    v_mfma_f32_16x16x32_bf16 v[28:31], a[244:247], v[92:95], v[28:31]
    ds_read_b128 v[84:87], v3 offset:32768
    v_mfma_f32_16x16x32_bf16 v[20:23], a[244:247], v[88:91], v[20:23]
    v_mfma_f32_16x16x32_bf16 v[32:35], a[248:251], v[88:91], v[32:35]
    buffer_store_dword v124, v124, s[16:19], s91 offen sc1
    v_mfma_f32_16x16x32_bf16 v[40:43], a[248:251], v[92:95], v[40:43]
    s_add_u32 s91, s91, 65536
    s_add_u32 s39, s91, -163840
    v_mfma_f32_16x16x32_bf16 v[44:47], a[252:255], v[92:95], v[44:47]
    v_mfma_f32_16x16x32_bf16 v[36:39], a[252:255], v[88:91], v[36:39]
    s_waitcnt lgkmcnt(0)
    v_mfma_f32_16x16x32_bf16 v[16:19], v[160:163], v[80:83], v[16:19]
    ds_read_b128 v[88:91], v2 offset:34816
    v_mfma_f32_16x16x32_bf16 v[24:27], v[160:163], v[84:87], v[24:27]
    buffer_store_dword v124, v124, s[16:19], s39 offen sc1
    v_mfma_f32_16x16x32_bf16 v[28:31], v[164:167], v[84:87], v[28:31]
    ds_read_b128 v[92:95], v3 offset:34816
    v_mfma_f32_16x16x32_bf16 v[20:23], v[164:167], v[80:83], v[20:23]
    v_mfma_f32_16x16x32_bf16 v[32:35], v[168:171], v[80:83], v[32:35]
    buffer_store_dwordx4 v[140:143], v9, s[20:23], s48 offen sc1
    v_mfma_f32_16x16x32_bf16 v[40:43], v[168:171], v[84:87], v[40:43]
    v_add_f32 v100, v128, v129
    v_mul_f32 v101, v128, v128
    v_mfma_f32_16x16x32_bf16 v[44:47], v[172:175], v[84:87], v[44:47]
    v_fmac_f32 v101, v129, v129
    v_add_f32 v100, v100, v130
    v_mfma_f32_16x16x32_bf16 v[36:39], v[172:175], v[80:83], v[36:39]
    s_waitcnt lgkmcnt(0)
    v_fmac_f32 v101, v130, v130
    v_add_f32 v100, v100, v131
    v_mfma_f32_16x16x32_bf16 v[16:19], v[176:179], v[88:91], v[16:19]
    ds_read_b128 v[80:83], v2 offset:36864
    v_fmac_f32 v101, v131, v131
    v_mfma_f32_16x16x32_bf16 v[24:27], v[176:179], v[92:95], v[24:27]
    v_add_f32 v100, v100, v132
    v_fmac_f32 v101, v132, v132
    v_mfma_f32_16x16x32_bf16 v[28:31], v[180:183], v[92:95], v[28:31]
    ds_read_b128 v[84:87], v3 offset:36864
    v_add_f32 v100, v100, v133
    v_mfma_f32_16x16x32_bf16 v[20:23], v[180:183], v[88:91], v[20:23]
    v_fmac_f32 v101, v133, v133
    v_add_f32 v100, v100, v134
    v_mfma_f32_16x16x32_bf16 v[32:35], v[184:187], v[88:91], v[32:35]
    v_fmac_f32 v101, v134, v134
    v_add_f32 v100, v100, v135
    v_mfma_f32_16x16x32_bf16 v[40:43], v[184:187], v[92:95], v[40:43]
    v_fmac_f32 v101, v135, v135
    v_mfma_f32_16x16x32_bf16 v[44:47], v[188:191], v[92:95], v[44:47]
    v_permlane16_swap_b32 v100, v101
    v_mfma_f32_16x16x32_bf16 v[36:39], v[188:191], v[88:91], v[36:39]
    s_waitcnt lgkmcnt(0)
    v_add_f32 v100, v100, v101
    v_mov_b32 v102, v100
    v_mfma_f32_16x16x32_bf16 v[16:19], v[192:195], v[80:83], v[16:19]
    ds_read_b128 v[88:91], v2 offset:38912
    v_mfma_f32_16x16x32_bf16 v[24:27], v[192:195], v[84:87], v[24:27]
    v_permlane32_swap_b32 v100, v102
    v_mfma_f32_16x16x32_bf16 v[28:31], v[196:199], v[84:87], v[28:31]
    ds_read_b128 v[92:95], v3 offset:38912
    v_add_f32 v100, v100, v102
    v_mfma_f32_16x16x32_bf16 v[20:23], v[196:199], v[80:83], v[20:23]
    ds_write_b32 v10, v100 offset:512
    v_mfma_f32_16x16x32_bf16 v[32:35], v[200:203], v[80:83], v[32:35]
    s_waitcnt vmcnt(19)
    v_mfma_f32_16x16x32_bf16 v[128:131], v[104:107], v[136:139], v[48:51]
    v_mfma_f32_16x16x32_bf16 v[132:135], v[108:111], v[136:139], v[52:55]
    v_mfma_f32_16x16x32_bf16 v[40:43], v[200:203], v[84:87], v[40:43]
    v_mfma_f32_16x16x32_bf16 v[44:47], v[204:207], v[84:87], v[44:47]
    s_add_u32 m0, s43, 126976
    s_add_u32 s42, s41, 28672
    v_mfma_f32_16x16x32_bf16 v[36:39], v[204:207], v[80:83], v[36:39]
    s_waitcnt lgkmcnt(1)
    v_mfma_f32_16x16x32_bf16 v[16:19], v[208:211], v[88:91], v[16:19]
    ds_read_b128 v[80:83], v2 offset:40960
    v_mfma_f32_16x16x32_bf16 v[24:27], v[208:211], v[92:95], v[24:27]
    buffer_load_dwordx4 v1, s[16:19], s42 offen offset:0 sc1 lds
    v_mfma_f32_16x16x32_bf16 v[28:31], v[212:215], v[92:95], v[28:31]
    ds_read_b128 v[84:87], v3 offset:40960
    v_mfma_f32_16x16x32_bf16 v[20:23], v[212:215], v[88:91], v[20:23]
    v_mfma_f32_16x16x32_bf16 v[32:35], v[216:219], v[88:91], v[32:35]
    v_mfma_f32_16x16x32_bf16 v[40:43], v[216:219], v[92:95], v[40:43]
    v_mfma_f32_16x16x32_bf16 v[44:47], v[220:223], v[92:95], v[44:47]
    buffer_load_dwordx4 v1, s[16:19], s42 offen offset:1024 sc1 lds
    v_mfma_f32_16x16x32_bf16 v[36:39], v[220:223], v[88:91], v[36:39]
    s_waitcnt lgkmcnt(0)
    v_mfma_f32_16x16x32_bf16 v[16:19], v[224:227], v[80:83], v[16:19]
    ds_read_b128 v[88:91], v2 offset:43008
    v_mfma_f32_16x16x32_bf16 v[24:27], v[224:227], v[84:87], v[24:27]
    v_mfma_f32_16x16x32_bf16 v[28:31], v[228:231], v[84:87], v[28:31]
    ds_read_b128 v[92:95], v3 offset:43008
    v_mfma_f32_16x16x32_bf16 v[20:23], v[228:231], v[80:83], v[20:23]
    buffer_load_dwordx4 v1, s[16:19], s42 offen offset:2048 sc1 lds
    v_mfma_f32_16x16x32_bf16 v[32:35], v[232:235], v[80:83], v[32:35]
    v_mfma_f32_16x16x32_bf16 v[40:43], v[232:235], v[84:87], v[40:43]
    v_mfma_f32_16x16x32_bf16 v[44:47], v[236:239], v[84:87], v[44:47]
    v_mfma_f32_16x16x32_bf16 v[36:39], v[236:239], v[80:83], v[36:39]
    s_waitcnt vmcnt(6) lgkmcnt(0)
    s_barrier
    v_mfma_f32_16x16x32_bf16 v[16:19], v[240:243], v[88:91], v[16:19]
    ds_read_b128 v[80:83], v4 offset:0
    v_mfma_f32_16x16x32_bf16 v[24:27], v[240:243], v[92:95], v[24:27]
    buffer_load_dwordx4 v1, s[16:19], s42 offen offset:3072 sc1 lds
    v_mfma_f32_16x16x32_bf16 v[28:31], v[244:247], v[92:95], v[28:31]
    s_add_u32 s45, s45, 65536
    ds_read_b128 v[84:87], v5 offset:0
    v_mfma_f32_16x16x32_bf16 v[20:23], v[244:247], v[88:91], v[20:23]
    v_mfma_f32_16x16x32_bf16 v[32:35], v[248:251], v[88:91], v[32:35]
    v_mfma_f32_16x16x32_bf16 v[40:43], v[248:251], v[92:95], v[40:43]
    v_mfma_f32_16x16x32_bf16 v[44:47], v[252:255], v[92:95], v[44:47]
    s_add_u32 s36, s36, 1
    v_mfma_f32_16x16x32_bf16 v[36:39], v[252:255], v[88:91], v[36:39]
    s_waitcnt lgkmcnt(0)
L_bf_b1:
    v_mfma_f32_16x16x32_bf16 v[48:51], a[0:3], v[80:83], v[112:115]
    s_sub_u32 s47, s45, 196608
    ds_read_b128 v[88:91], v4 offset:2048
    s_max_u32 s47, s47, 0x5500000
    v_mfma_f32_16x16x32_bf16 v[56:59], a[0:3], v[84:87], 0
    buffer_load_dword v13, v8, s[16:19], s47 offen sc1
    v_mfma_f32_16x16x32_bf16 v[60:63], a[4:7], v[84:87], 0
    s_and_b32 s38, s53, 0xffffffff
    ds_read_b128 v[92:95], v5 offset:2048
    s_cmp_lt_i32 s36, 1
    v_mfma_f32_16x16x32_bf16 v[52:55], a[4:7], v[80:83], v[116:119]
    s_cselect_b32 s38, 0x5e00000, s38
    v_mfma_f32_16x16x32_bf16 v[64:67], a[8:11], v[80:83], 0
    buffer_load_dwordx4 v[136:139], v1, s[16:19], s38 offen sc1
    v_mfma_f32_16x16x32_bf16 v[72:75], a[8:11], v[84:87], 0
    s_add_u32 s53, s53, 65536
    ds_read_b128 v[144:147], v11 offset:512
    s_and_b32 s44, s90, 0xffffffff
    v_mfma_f32_16x16x32_bf16 v[76:79], a[12:15], v[84:87], 0
    s_cmp_lt_i32 s36, 1
    s_cselect_b32 s44, 0x5e00000, s44
    s_xor_b32 s49, s44, 16384
    v_mfma_f32_16x16x32_bf16 v[68:71], a[12:15], v[80:83], 0
    s_waitcnt lgkmcnt(1)
    v_cvt_pk_bf16_f32 v24, v24, v25
    v_cvt_pk_bf16_f32 v25, v26, v27
    v_mfma_f32_16x16x32_bf16 v[48:51], a[16:19], v[88:91], v[48:51]
    ds_read_b128 v[80:83], v4 offset:4096
    v_cvt_pk_bf16_f32 v26, v28, v29
    v_mfma_f32_16x16x32_bf16 v[56:59], a[16:19], v[92:95], v[56:59]
    v_cvt_pk_bf16_f32 v27, v30, v31
    v_mfma_f32_16x16x32_bf16 v[60:63], a[20:23], v[92:95], v[60:63]
    s_waitcnt lgkmcnt(1)
    ds_read_b128 v[84:87], v5 offset:4096
    v_add_f32 v144, v144, v145
    v_mfma_f32_16x16x32_bf16 v[52:55], a[20:23], v[88:91], v[52:55]
    buffer_store_dwordx4 v[24:27], v1, s[16:19], s49 offen offset:0 sc1
    v_mfma_f32_16x16x32_bf16 v[64:67], a[24:27], v[88:91], v[64:67]
    s_xor_b32 s49, s44, 32768
    v_cvt_pk_bf16_f32 v32, v32, v33
    v_cvt_pk_bf16_f32 v33, v34, v35
    v_mfma_f32_16x16x32_bf16 v[72:75], a[24:27], v[92:95], v[72:75]
    v_cvt_pk_bf16_f32 v34, v36, v37
    v_cvt_pk_bf16_f32 v35, v38, v39
    v_mfma_f32_16x16x32_bf16 v[76:79], a[28:31], v[92:95], v[76:79]
    buffer_store_dwordx4 v[32:35], v1, s[16:19], s49 offen offset:1024 sc1
    v_mfma_f32_16x16x32_bf16 v[68:71], a[28:31], v[88:91], v[68:71]
    s_waitcnt lgkmcnt(0)
    v_add_f32 v146, v146, v147
    v_add_f32 v144, v144, v146
    v_mfma_f32_16x16x32_bf16 v[48:51], a[32:35], v[80:83], v[48:51]
    s_xor_b32 s49, s44, 49152
    ds_read_b128 v[88:91], v4 offset:6144
    v_cvt_pk_bf16_f32 v40, v40, v41
    v_mfma_f32_16x16x32_bf16 v[56:59], a[32:35], v[84:87], v[56:59]
    v_cvt_pk_bf16_f32 v41, v42, v43
    v_cvt_pk_bf16_f32 v42, v44, v45
    v_mfma_f32_16x16x32_bf16 v[60:63], a[36:39], v[84:87], v[60:63]
    ds_read_b128 v[92:95], v5 offset:6144
    v_cvt_pk_bf16_f32 v43, v46, v47
    v_mfma_f32_16x16x32_bf16 v[52:55], a[36:39], v[80:83], v[52:55]
    buffer_store_dwordx4 v[40:43], v1, s[16:19], s49 offen offset:2048 sc1
    v_mfma_f32_16x16x32_bf16 v[64:67], a[40:43], v[80:83], v[64:67]
    s_add_u32 s90, s90, 262144
    v_mfma_f32_16x16x32_bf16 v[72:75], a[40:43], v[84:87], v[72:75]
    v_mfma_f32_16x16x32_bf16 v[76:79], a[44:47], v[84:87], v[76:79]
    buffer_store_dword v144, v12, s[16:19], s46 offen sc1
    v_mfma_f32_16x16x32_bf16 v[68:71], a[44:47], v[80:83], v[68:71]
    s_waitcnt lgkmcnt(0)
    v_mfma_f32_16x16x32_bf16 v[48:51], a[48:51], v[88:91], v[48:51]
    s_add_u32 s98, s98, 262144
    ds_read_b128 v[80:83], v4 offset:8192
    s_min_i32 s98, s98, s96
    v_mfma_f32_16x16x32_bf16 v[56:59], a[48:51], v[92:95], v[56:59]
    s_and_b32 s41, s98, 0xffffffff
    s_add_u32 m0, s43, 0
    s_add_u32 s42, s41, 0
    v_mfma_f32_16x16x32_bf16 v[60:63], a[52:55], v[92:95], v[60:63]
    ds_read_b128 v[84:87], v5 offset:8192
    v_mfma_f32_16x16x32_bf16 v[52:55], a[52:55], v[88:91], v[52:55]
    v_mfma_f32_16x16x32_bf16 v[64:67], a[56:59], v[88:91], v[64:67]
    v_mfma_f32_16x16x32_bf16 v[72:75], a[56:59], v[92:95], v[72:75]
    v_mfma_f32_16x16x32_bf16 v[76:79], a[60:63], v[92:95], v[76:79]
    v_mfma_f32_16x16x32_bf16 v[68:71], a[60:63], v[88:91], v[68:71]
    s_waitcnt lgkmcnt(0)
    v_mfma_f32_16x16x32_bf16 v[48:51], a[64:67], v[80:83], v[48:51]
    ds_read_b128 v[88:91], v4 offset:10240
    v_mfma_f32_16x16x32_bf16 v[56:59], a[64:67], v[84:87], v[56:59]
    v_mfma_f32_16x16x32_bf16 v[60:63], a[68:71], v[84:87], v[60:63]
    ds_read_b128 v[92:95], v5 offset:10240
    v_mfma_f32_16x16x32_bf16 v[52:55], a[68:71], v[80:83], v[52:55]
    v_mfma_f32_16x16x32_bf16 v[64:67], a[72:75], v[80:83], v[64:67]
    v_mfma_f32_16x16x32_bf16 v[72:75], a[72:75], v[84:87], v[72:75]
    v_mfma_f32_16x16x32_bf16 v[76:79], a[76:79], v[84:87], v[76:79]
    v_mfma_f32_16x16x32_bf16 v[68:71], a[76:79], v[80:83], v[68:71]
    s_waitcnt lgkmcnt(0)
    v_mfma_f32_16x16x32_bf16 v[48:51], a[80:83], v[88:91], v[48:51]
    ds_read_b128 v[80:83], v4 offset:12288
    v_mfma_f32_16x16x32_bf16 v[56:59], a[80:83], v[92:95], v[56:59]
    v_mfma_f32_16x16x32_bf16 v[60:63], a[84:87], v[92:95], v[60:63]
    ds_read_b128 v[84:87], v5 offset:12288
    v_mfma_f32_16x16x32_bf16 v[52:55], a[84:87], v[88:91], v[52:55]
    v_mfma_f32_16x16x32_bf16 v[64:67], a[88:91], v[88:91], v[64:67]
    s_waitcnt vmcnt(5)
    v_cmp_ne_u32 vcc, 0, v13
    v_mfma_f32_16x16x32_bf16 v[72:75], a[88:91], v[92:95], v[72:75]
    v_mfma_f32_16x16x32_bf16 v[76:79], a[92:95], v[92:95], v[76:79]
    s_cbranch_vccnz L_spin59
L_back60:
    s_sub_u32 s48, s90, 524288
    s_and_b32 s48, s48, 0xffffffff
    v_mfma_f32_16x16x32_bf16 v[68:71], a[92:95], v[88:91], v[68:71]
    s_waitcnt lgkmcnt(0)
    s_cmp_lt_i32 s36, 2
    s_cselect_b32 s48, s52, s48
    v_mfma_f32_16x16x32_bf16 v[48:51], a[96:99], v[80:83], v[48:51]
    ds_read_b128 v[88:91], v4 offset:14336
    v_mfma_f32_16x16x32_bf16 v[56:59], a[96:99], v[84:87], v[56:59]
    buffer_load_dwordx4 v[140:143], v1, s[16:19], s48 offen offset:0 sc1
    v_mfma_f32_16x16x32_bf16 v[60:63], a[100:103], v[84:87], v[60:63]
    ds_read_b128 v[92:95], v5 offset:14336
    v_mfma_f32_16x16x32_bf16 v[52:55], a[100:103], v[80:83], v[52:55]
    v_mfma_f32_16x16x32_bf16 v[64:67], a[104:107], v[80:83], v[64:67]
    buffer_load_dword v96, v6, s[16:19], s45 offen sc1
    v_mfma_f32_16x16x32_bf16 v[72:75], a[104:107], v[84:87], v[72:75]
    v_mfma_f32_16x16x32_bf16 v[76:79], a[108:111], v[84:87], v[76:79]
    v_mfma_f32_16x16x32_bf16 v[68:71], a[108:111], v[80:83], v[68:71]
    s_waitcnt lgkmcnt(0)
    v_mfma_f32_16x16x32_bf16 v[48:51], a[112:115], v[88:91], v[48:51]
    ds_read_b128 v[80:83], v4 offset:16384
    v_mfma_f32_16x16x32_bf16 v[56:59], a[112:115], v[92:95], v[56:59]
    buffer_load_dwordx4 v[144:147], v1, s[16:19], s48 offen offset:1024 sc1
    v_mfma_f32_16x16x32_bf16 v[60:63], a[116:119], v[92:95], v[60:63]
    ds_read_b128 v[84:87], v5 offset:16384
    v_mfma_f32_16x16x32_bf16 v[52:55], a[116:119], v[88:91], v[52:55]
    v_mfma_f32_16x16x32_bf16 v[64:67], a[120:123], v[88:91], v[64:67]
    buffer_load_dwordx4 v[148:151], v1, s[16:19], s48 offen offset:2048 sc1
    v_mfma_f32_16x16x32_bf16 v[72:75], a[120:123], v[92:95], v[72:75]
    v_mfma_f32_16x16x32_bf16 v[76:79], a[124:127], v[92:95], v[76:79]
    v_mfma_f32_16x16x32_bf16 v[68:71], a[124:127], v[88:91], v[68:71]
    s_waitcnt lgkmcnt(0)
    v_mfma_f32_16x16x32_bf16 v[48:51], a[128:131], v[80:83], v[48:51]
    ds_read_b128 v[88:91], v4 offset:18432
    v_mfma_f32_16x16x32_bf16 v[56:59], a[128:131], v[84:87], v[56:59]
    buffer_load_dwordx4 v[152:155], v1, s[16:19], s48 offen offset:3072 sc1
    v_mfma_f32_16x16x32_bf16 v[60:63], a[132:135], v[84:87], v[60:63]
    s_sub_u32 s47, s36, 2
    ds_read_b128 v[92:95], v5 offset:18432
    s_cmp_lt_u32 s47, 16
    v_mfma_f32_16x16x32_bf16 v[52:55], a[132:135], v[80:83], v[52:55]
    s_cselect_b32 s48, 0x5000000, s52
    s_add_u32 s20, s84, s48
    s_addc_u32 s21, s85, 0
    v_mfma_f32_16x16x32_bf16 v[64:67], a[136:139], v[80:83], v[64:67]
    s_cmp_ge_i32 s47, 16
    s_cselect_b32 s20, s80, s20
    s_cselect_b32 s21, s81, s21
    v_mfma_f32_16x16x32_bf16 v[72:75], a[136:139], v[84:87], v[72:75]
    s_and_b32 s48, s47, 15
    s_lshl_b32 s48, s48, 1
    s_sub_u32 s48, s50, s48
    v_mfma_f32_16x16x32_bf16 v[76:79], a[140:143], v[84:87], v[76:79]
    s_lshl_b32 s46, s48, 10
    s_sub_u32 s46, s55, s46
    s_cmp_lt_u32 s47, 16
    v_mfma_f32_16x16x32_bf16 v[68:71], a[140:143], v[80:83], v[68:71]
    s_waitcnt lgkmcnt(0)
    s_cselect_b32 s46, s46, s52
    s_lshl_b32 s48, s48, 15
    v_mfma_f32_16x16x32_bf16 v[48:51], a[144:147], v[88:91], v[48:51]
    ds_read_b128 v[80:83], v4 offset:20480
    v_mfma_f32_16x16x32_bf16 v[56:59], a[144:147], v[92:95], v[56:59]
    v_mfma_f32_16x16x32_bf16 v[60:63], a[148:151], v[92:95], v[60:63]
    ds_read_b128 v[84:87], v5 offset:20480
    v_mfma_f32_16x16x32_bf16 v[52:55], a[148:151], v[88:91], v[52:55]
    v_mfma_f32_16x16x32_bf16 v[64:67], a[152:155], v[88:91], v[64:67]
    v_mfma_f32_16x16x32_bf16 v[72:75], a[152:155], v[92:95], v[72:75]
    v_mfma_f32_16x16x32_bf16 v[76:79], a[156:159], v[92:95], v[76:79]
    v_mfma_f32_16x16x32_bf16 v[68:71], a[156:159], v[88:91], v[68:71]
    s_waitcnt lgkmcnt(0)
    v_mfma_f32_16x16x32_bf16 v[48:51], a[160:163], v[80:83], v[48:51]
    ds_read_b128 v[88:91], v4 offset:22528
    v_mfma_f32_16x16x32_bf16 v[56:59], a[160:163], v[84:87], v[56:59]
    v_mfma_f32_16x16x32_bf16 v[60:63], a[164:167], v[84:87], v[60:63]
    ds_read_b128 v[92:95], v5 offset:22528
    v_mfma_f32_16x16x32_bf16 v[52:55], a[164:167], v[80:83], v[52:55]
    v_mfma_f32_16x16x32_bf16 v[64:67], a[168:171], v[80:83], v[64:67]
    v_mfma_f32_16x16x32_bf16 v[72:75], a[168:171], v[84:87], v[72:75]
    v_mfma_f32_16x16x32_bf16 v[76:79], a[172:175], v[84:87], v[76:79]
    v_mfma_f32_16x16x32_bf16 v[68:71], a[172:175], v[80:83], v[68:71]
    s_waitcnt lgkmcnt(0)
    v_mfma_f32_16x16x32_bf16 v[48:51], a[176:179], v[88:91], v[48:51]
    ds_read_b128 v[80:83], v4 offset:24576
    v_mfma_f32_16x16x32_bf16 v[56:59], a[176:179], v[92:95], v[56:59]
    v_mfma_f32_16x16x32_bf16 v[60:63], a[180:183], v[92:95], v[60:63]
    ds_read_b128 v[84:87], v5 offset:24576
    v_mfma_f32_16x16x32_bf16 v[52:55], a[180:183], v[88:91], v[52:55]
    v_mfma_f32_16x16x32_bf16 v[64:67], a[184:187], v[88:91], v[64:67]
    v_mfma_f32_16x16x32_bf16 v[72:75], a[184:187], v[92:95], v[72:75]
    v_mfma_f32_16x16x32_bf16 v[76:79], a[188:191], v[92:95], v[76:79]
    s_waitcnt vmcnt(3)
    v_cmp_ne_u32 vcc, 0, v96
    v_mfma_f32_16x16x32_bf16 v[68:71], a[188:191], v[88:91], v[68:71]
    s_waitcnt lgkmcnt(0)
    v_mfma_f32_16x16x32_bf16 v[48:51], a[192:195], v[80:83], v[48:51]
    s_cbranch_vccnz L_spin61
L_back62:
    ds_read_b128 v[88:91], v4 offset:26624
    s_barrier
    v_mfma_f32_16x16x32_bf16 v[56:59], a[192:195], v[84:87], v[56:59]
    buffer_load_dwordx4 v1, s[16:19], s42 offen offset:0 sc1 lds
    v_mfma_f32_16x16x32_bf16 v[60:63], a[196:199], v[84:87], v[60:63]
    ds_read_b128 v[92:95], v5 offset:26624
    v_mfma_f32_16x16x32_bf16 v[52:55], a[196:199], v[80:83], v[52:55]
    v_mfma_f32_16x16x32_bf16 v[64:67], a[200:203], v[80:83], v[64:67]
    v_mfma_f32_16x16x32_bf16 v[72:75], a[200:203], v[84:87], v[72:75]
    buffer_load_dwordx4 v1, s[16:19], s42 offen offset:1024 sc1 lds
    v_mfma_f32_16x16x32_bf16 v[76:79], a[204:207], v[84:87], v[76:79]
    v_mfma_f32_16x16x32_bf16 v[68:71], a[204:207], v[80:83], v[68:71]
    s_waitcnt lgkmcnt(0)
    v_mfma_f32_16x16x32_bf16 v[48:51], a[208:211], v[88:91], v[48:51]
    ds_read_b128 v[80:83], v4 offset:28672
    v_mfma_f32_16x16x32_bf16 v[56:59], a[208:211], v[92:95], v[56:59]
    buffer_load_dwordx4 v1, s[16:19], s42 offen offset:2048 sc1 lds
    v_mfma_f32_16x16x32_bf16 v[60:63], a[212:215], v[92:95], v[60:63]
    ds_read_b128 v[84:87], v5 offset:28672
    v_mfma_f32_16x16x32_bf16 v[52:55], a[212:215], v[88:91], v[52:55]
    v_mfma_f32_16x16x32_bf16 v[64:67], a[216:219], v[88:91], v[64:67]
    v_mfma_f32_16x16x32_bf16 v[72:75], a[216:219], v[92:95], v[72:75]
    buffer_load_dwordx4 v1, s[16:19], s42 offen offset:3072 sc1 lds
    v_mfma_f32_16x16x32_bf16 v[76:79], a[220:223], v[92:95], v[76:79]
    s_add_u32 m0, s88, 16384
    s_add_u32 s42, s41, 16384
    s_add_u32 s42, s42, s89
    v_mfma_f32_16x16x32_bf16 v[68:71], a[220:223], v[88:91], v[68:71]
    s_waitcnt lgkmcnt(0)
    v_mfma_f32_16x16x32_bf16 v[48:51], a[224:227], v[80:83], v[48:51]
    ds_read_b128 v[88:91], v4 offset:30720
    v_mfma_f32_16x16x32_bf16 v[56:59], a[224:227], v[84:87], v[56:59]
    buffer_load_dwordx4 v1, s[16:19], s42 offen offset:0 sc1 lds
    v_mfma_f32_16x16x32_bf16 v[60:63], a[228:231], v[84:87], v[60:63]
    ds_read_b128 v[92:95], v5 offset:30720
    v_mfma_f32_16x16x32_bf16 v[52:55], a[228:231], v[80:83], v[52:55]
    v_mfma_f32_16x16x32_bf16 v[64:67], a[232:235], v[80:83], v[64:67]
    s_waitcnt vmcnt(5)
    v_mfma_f32_16x16x32_bf16 v[128:131], v[104:107], v[140:143], v[128:131]
    v_mfma_f32_16x16x32_bf16 v[132:135], v[108:111], v[140:143], v[132:135]
    v_mfma_f32_16x16x32_bf16 v[128:131], v[104:107], v[144:147], v[128:131]
    v_mfma_f32_16x16x32_bf16 v[132:135], v[108:111], v[144:147], v[132:135]
    v_mfma_f32_16x16x32_bf16 v[128:131], v[104:107], v[148:151], v[128:131]
    v_mfma_f32_16x16x32_bf16 v[132:135], v[108:111], v[148:151], v[132:135]
    v_mfma_f32_16x16x32_bf16 v[128:131], v[104:107], v[152:155], v[128:131]
    v_mfma_f32_16x16x32_bf16 v[132:135], v[108:111], v[152:155], v[132:135]
    v_mfma_f32_16x16x32_bf16 v[72:75], a[232:235], v[84:87], v[72:75]
    buffer_load_dwordx4 v1, s[16:19], s42 offen offset:1024 sc1 lds
    v_mfma_f32_16x16x32_bf16 v[76:79], a[236:239], v[84:87], v[76:79]
    s_nop 0
    v_cvt_pk_bf16_f32 v140, v128, v129
    v_cvt_pk_bf16_f32 v141, v130, v131
    v_mfma_f32_16x16x32_bf16 v[68:71], a[236:239], v[80:83], v[68:71]
    s_waitcnt lgkmcnt(0)
    v_cvt_pk_bf16_f32 v142, v132, v133
    v_cvt_pk_bf16_f32 v143, v134, v135
    v_mfma_f32_16x16x32_bf16 v[48:51], a[240:243], v[88:91], v[48:51]
    ds_read_b128 v[80:83], v4 offset:32768
    v_mfma_f32_16x16x32_bf16 v[56:59], a[240:243], v[92:95], v[56:59]
    buffer_load_dwordx4 v1, s[16:19], s42 offen offset:2048 sc1 lds
    v_mfma_f32_16x16x32_bf16 v[60:63], a[244:247], v[92:95], v[60:63]
    ds_read_b128 v[84:87], v5 offset:32768
    v_mfma_f32_16x16x32_bf16 v[52:55], a[244:247], v[88:91], v[52:55]
    v_mfma_f32_16x16x32_bf16 v[64:67], a[248:251], v[88:91], v[64:67]
    buffer_store_dword v124, v124, s[16:19], s91 offen sc1
    v_mfma_f32_16x16x32_bf16 v[72:75], a[248:251], v[92:95], v[72:75]
    s_add_u32 s91, s91, 65536
    s_add_u32 s39, s91, -163840
    v_mfma_f32_16x16x32_bf16 v[76:79], a[252:255], v[92:95], v[76:79]
    v_mfma_f32_16x16x32_bf16 v[68:71], a[252:255], v[88:91], v[68:71]
    s_waitcnt lgkmcnt(0)
    v_mfma_f32_16x16x32_bf16 v[48:51], v[160:163], v[80:83], v[48:51]
    ds_read_b128 v[88:91], v4 offset:34816
    v_mfma_f32_16x16x32_bf16 v[56:59], v[160:163], v[84:87], v[56:59]
    buffer_store_dword v124, v124, s[16:19], s39 offen sc1
    v_mfma_f32_16x16x32_bf16 v[60:63], v[164:167], v[84:87], v[60:63]
    ds_read_b128 v[92:95], v5 offset:34816
    v_mfma_f32_16x16x32_bf16 v[52:55], v[164:167], v[80:83], v[52:55]
    v_mfma_f32_16x16x32_bf16 v[64:67], v[168:171], v[80:83], v[64:67]
    buffer_store_dwordx4 v[140:143], v9, s[20:23], s48 offen sc1
    v_mfma_f32_16x16x32_bf16 v[72:75], v[168:171], v[84:87], v[72:75]
    v_add_f32 v100, v128, v129
    v_mul_f32 v101, v128, v128
    v_mfma_f32_16x16x32_bf16 v[76:79], v[172:175], v[84:87], v[76:79]
    v_fmac_f32 v101, v129, v129
    v_add_f32 v100, v100, v130
    v_mfma_f32_16x16x32_bf16 v[68:71], v[172:175], v[80:83], v[68:71]
    s_waitcnt lgkmcnt(0)
    v_fmac_f32 v101, v130, v130
    v_add_f32 v100, v100, v131
    v_mfma_f32_16x16x32_bf16 v[48:51], v[176:179], v[88:91], v[48:51]
    ds_read_b128 v[80:83], v4 offset:36864
    v_fmac_f32 v101, v131, v131
    v_mfma_f32_16x16x32_bf16 v[56:59], v[176:179], v[92:95], v[56:59]
    v_add_f32 v100, v100, v132
    v_fmac_f32 v101, v132, v132
    v_mfma_f32_16x16x32_bf16 v[60:63], v[180:183], v[92:95], v[60:63]
    ds_read_b128 v[84:87], v5 offset:36864
    v_add_f32 v100, v100, v133
    v_mfma_f32_16x16x32_bf16 v[52:55], v[180:183], v[88:91], v[52:55]
    v_fmac_f32 v101, v133, v133
    v_add_f32 v100, v100, v134
    v_mfma_f32_16x16x32_bf16 v[64:67], v[184:187], v[88:91], v[64:67]
    v_fmac_f32 v101, v134, v134
    v_add_f32 v100, v100, v135
    v_mfma_f32_16x16x32_bf16 v[72:75], v[184:187], v[92:95], v[72:75]
    v_fmac_f32 v101, v135, v135
    v_mfma_f32_16x16x32_bf16 v[76:79], v[188:191], v[92:95], v[76:79]
    v_permlane16_swap_b32 v100, v101
    v_mfma_f32_16x16x32_bf16 v[68:71], v[188:191], v[88:91], v[68:71]
    s_waitcnt lgkmcnt(0)
    v_add_f32 v100, v100, v101
    v_mov_b32 v102, v100
    v_mfma_f32_16x16x32_bf16 v[48:51], v[192:195], v[80:83], v[48:51]
    ds_read_b128 v[88:91], v4 offset:38912
    v_mfma_f32_16x16x32_bf16 v[56:59], v[192:195], v[84:87], v[56:59]
    v_permlane32_swap_b32 v100, v102
    v_mfma_f32_16x16x32_bf16 v[60:63], v[196:199], v[84:87], v[60:63]
    ds_read_b128 v[92:95], v5 offset:38912
    v_add_f32 v100, v100, v102
    v_mfma_f32_16x16x32_bf16 v[52:55], v[196:199], v[80:83], v[52:55]
    ds_write_b32 v10, v100 offset:0
    v_mfma_f32_16x16x32_bf16 v[64:67], v[200:203], v[80:83], v[64:67]
    s_waitcnt vmcnt(19)
    v_mfma_f32_16x16x32_bf16 v[128:131], v[104:107], v[136:139], v[16:19]
    v_mfma_f32_16x16x32_bf16 v[132:135], v[108:111], v[136:139], v[20:23]
    v_mfma_f32_16x16x32_bf16 v[72:75], v[200:203], v[84:87], v[72:75]
    v_mfma_f32_16x16x32_bf16 v[76:79], v[204:207], v[84:87], v[76:79]
    s_add_u32 m0, s43, 28672
    s_add_u32 s42, s41, 28672
    v_mfma_f32_16x16x32_bf16 v[68:71], v[204:207], v[80:83], v[68:71]
    s_waitcnt lgkmcnt(1)
    v_mfma_f32_16x16x32_bf16 v[48:51], v[208:211], v[88:91], v[48:51]
    ds_read_b128 v[80:83], v4 offset:40960
    v_mfma_f32_16x16x32_bf16 v[56:59], v[208:211], v[92:95], v[56:59]
    buffer_load_dwordx4 v1, s[16:19], s42 offen offset:0 sc1 lds
    v_mfma_f32_16x16x32_bf16 v[60:63], v[212:215], v[92:95], v[60:63]
    ds_read_b128 v[84:87], v5 offset:40960
    v_mfma_f32_16x16x32_bf16 v[52:55], v[212:215], v[88:91], v[52:55]
    v_mfma_f32_16x16x32_bf16 v[64:67], v[216:219], v[88:91], v[64:67]
    v_mfma_f32_16x16x32_bf16 v[72:75], v[216:219], v[92:95], v[72:75]
    v_mfma_f32_16x16x32_bf16 v[76:79], v[220:223], v[92:95], v[76:79]
    buffer_load_dwordx4 v1, s[16:19], s42 offen offset:1024 sc1 lds
    v_mfma_f32_16x16x32_bf16 v[68:71], v[220:223], v[88:91], v[68:71]
    s_waitcnt lgkmcnt(0)
    v_mfma_f32_16x16x32_bf16 v[48:51], v[224:227], v[80:83], v[48:51]
    ds_read_b128 v[88:91], v4 offset:43008
    v_mfma_f32_16x16x32_bf16 v[56:59], v[224:227], v[84:87], v[56:59]
    v_mfma_f32_16x16x32_bf16 v[60:63], v[228:231], v[84:87], v[60:63]
    ds_read_b128 v[92:95], v5 offset:43008
    v_mfma_f32_16x16x32_bf16 v[52:55], v[228:231], v[80:83], v[52:55]
    buffer_load_dwordx4 v1, s[16:19], s42 offen offset:2048 sc1 lds
    v_mfma_f32_16x16x32_bf16 v[64:67], v[232:235], v[80:83], v[64:67]
    v_mfma_f32_16x16x32_bf16 v[72:75], v[232:235], v[84:87], v[72:75]
    v_mfma_f32_16x16x32_bf16 v[76:79], v[236:239], v[84:87], v[76:79]
    v_mfma_f32_16x16x32_bf16 v[68:71], v[236:239], v[80:83], v[68:71]
    s_waitcnt vmcnt(6) lgkmcnt(0)
    s_barrier
    v_mfma_f32_16x16x32_bf16 v[48:51], v[240:243], v[88:91], v[48:51]
    ds_read_b128 v[80:83], v2 offset:0
    v_mfma_f32_16x16x32_bf16 v[56:59], v[240:243], v[92:95], v[56:59]
    buffer_load_dwordx4 v1, s[16:19], s42 offen offset:3072 sc1 lds
    v_mfma_f32_16x16x32_bf16 v[60:63], v[244:247], v[92:95], v[60:63]
    s_add_u32 s45, s45, 65536
    ds_read_b128 v[84:87], v3 offset:0
    v_mfma_f32_16x16x32_bf16 v[52:55], v[244:247], v[88:91], v[52:55]
    v_mfma_f32_16x16x32_bf16 v[64:67], v[248:251], v[88:91], v[64:67]
    v_mfma_f32_16x16x32_bf16 v[72:75], v[248:251], v[92:95], v[72:75]
    v_mfma_f32_16x16x32_bf16 v[76:79], v[252:255], v[92:95], v[76:79]
    s_add_u32 s36, s36, 1
    v_mfma_f32_16x16x32_bf16 v[68:71], v[252:255], v[88:91], v[68:71]
    s_waitcnt lgkmcnt(0)
    s_cmp_lt_u32 s36, 32
    s_cbranch_scc1 L_bf_b0
    s_nop 7
    s_sub_u32 s47, s45, 196608
    s_max_u32 s47, s47, 0x5500000
    buffer_load_dword v13, v8, s[16:19], s47 offen sc1
    s_and_b32 s38, s53, 0xffffffff
    s_cmp_lt_i32 s36, 1
    s_cselect_b32 s38, 0x5e00000, s38
    buffer_load_dwordx4 v[136:139], v1, s[16:19], s38 offen sc1
    s_add_u32 s53, s53, 65536
    s_and_b32 s44, s90, 0xffffffff
    s_cmp_lt_i32 s36, 1
    s_cselect_b32 s44, 0x5e00000, s44
    s_xor_b32 s49, s44, 16384
    v_cvt_pk_bf16_f32 v56, v56, v57
    v_cvt_pk_bf16_f32 v57, v58, v59
    v_cvt_pk_bf16_f32 v58, v60, v61
    v_cvt_pk_bf16_f32 v59, v62, v63
    v_min_u32 v56, -2, v56
    v_min_u32 v57, -2, v57
    v_min_u32 v58, -2, v58
    v_min_u32 v59, -2, v59
    buffer_store_dwordx4 v[56:59], v1, s[16:19], s49 offen offset:0 sc1
    s_xor_b32 s49, s44, 32768
    v_cvt_pk_bf16_f32 v64, v64, v65
    v_cvt_pk_bf16_f32 v65, v66, v67
    v_cvt_pk_bf16_f32 v66, v68, v69
    v_cvt_pk_bf16_f32 v67, v70, v71
    v_min_u32 v64, -2, v64
    v_min_u32 v65, -2, v65
    v_min_u32 v66, -2, v66
    v_min_u32 v67, -2, v67
    buffer_store_dwordx4 v[64:67], v1, s[16:19], s49 offen offset:1024 sc1
    s_xor_b32 s49, s44, 49152
    v_cvt_pk_bf16_f32 v72, v72, v73
    v_cvt_pk_bf16_f32 v73, v74, v75
    v_cvt_pk_bf16_f32 v74, v76, v77
    v_cvt_pk_bf16_f32 v75, v78, v79
    v_min_u32 v72, -2, v72
    v_min_u32 v73, -2, v73
    v_min_u32 v74, -2, v74
    v_min_u32 v75, -2, v75
    buffer_store_dwordx4 v[72:75], v1, s[16:19], s49 offen offset:2048 sc1
    s_add_u32 s90, s90, 262144
    s_waitcnt vmcnt(4)
    v_cmp_ne_u32 vcc, 0, v13
    s_cbranch_vccnz L_spin63
L_back64:
    s_barrier
    s_sub_u32 s48, s90, 524288
    s_and_b32 s48, s48, 0xffffffff
    s_cmp_lt_i32 s36, 2
    s_cselect_b32 s48, s52, s48
    buffer_load_dwordx4 v[140:143], v1, s[16:19], s48 offen offset:0 sc1
    buffer_load_dwordx4 v[144:147], v1, s[16:19], s48 offen offset:1024 sc1
    buffer_load_dwordx4 v[148:151], v1, s[16:19], s48 offen offset:2048 sc1
    buffer_load_dwordx4 v[152:155], v1, s[16:19], s48 offen offset:3072 sc1
    s_sub_u32 s47, s36, 2
    s_cmp_lt_u32 s47, 16
    s_cselect_b32 s48, 0x5000000, s52
    s_add_u32 s20, s84, s48
    s_addc_u32 s21, s85, 0
    s_cmp_ge_i32 s47, 16
    s_cselect_b32 s20, s80, s20
    s_cselect_b32 s21, s81, s21
    s_and_b32 s48, s47, 15
    s_lshl_b32 s48, s48, 1
    s_sub_u32 s48, s50, s48
    s_lshl_b32 s46, s48, 10
    s_sub_u32 s46, s55, s46
    s_cmp_lt_u32 s47, 16
    s_cselect_b32 s46, s46, s52
    s_lshl_b32 s48, s48, 15
    s_waitcnt vmcnt(7)
    v_mfma_f32_16x16x32_bf16 v[48:51], v[104:107], v[136:139], v[48:51]
    v_mfma_f32_16x16x32_bf16 v[52:55], v[108:111], v[136:139], v[52:55]
    s_waitcnt vmcnt(4)
    buffer_load_dwordx4 v[160:163], v1, s[16:19], s44 offen offset:0 sc1
    buffer_load_dwordx4 v[164:167], v1, s[16:19], s44 offen offset:1024 sc1
    buffer_load_dwordx4 v[168:171], v1, s[16:19], s44 offen offset:2048 sc1
    buffer_load_dwordx4 v[172:175], v1, s[16:19], s44 offen offset:3072 sc1
    s_waitcnt vmcnt(4)
    v_mfma_f32_16x16x32_bf16 v[128:131], v[104:107], v[140:143], v[128:131]
    v_mfma_f32_16x16x32_bf16 v[132:135], v[108:111], v[140:143], v[132:135]
    v_mfma_f32_16x16x32_bf16 v[128:131], v[104:107], v[144:147], v[128:131]
    v_mfma_f32_16x16x32_bf16 v[132:135], v[108:111], v[144:147], v[132:135]
    v_mfma_f32_16x16x32_bf16 v[128:131], v[104:107], v[148:151], v[128:131]
    v_mfma_f32_16x16x32_bf16 v[132:135], v[108:111], v[148:151], v[132:135]
    v_mfma_f32_16x16x32_bf16 v[128:131], v[104:107], v[152:155], v[128:131]
    v_mfma_f32_16x16x32_bf16 v[132:135], v[108:111], v[152:155], v[132:135]
    s_nop 5
    v_cvt_pk_bf16_f32 v140, v128, v129
    v_cvt_pk_bf16_f32 v141, v130, v131
    v_cvt_pk_bf16_f32 v142, v132, v133
    v_cvt_pk_bf16_f32 v143, v134, v135
    s_waitcnt vmcnt(0)
    v_max3_u32 v176, v160, v161, v162
    v_max3_u32 v177, v163, v164, v165
    v_max3_u32 v178, v166, v167, v168
    v_max3_u32 v179, v169, v170, v171
    v_max3_u32 v180, v172, v173, v174
    v_max3_u32 v176, v176, v177, v178
    v_max3_u32 v179, v179, v180, v175
    v_max_u32 v176, v176, v179
    v_cmp_eq_u32 vcc, -1, v176
    s_cbranch_vccnz L_gspin65
L_gback66:
    buffer_store_dwordx4 v[140:143], v9, s[20:23], s48 offen sc1
    v_mfma_f32_16x16x32_bf16 v[48:51], v[104:107], v[160:163], v[48:51]
    v_mfma_f32_16x16x32_bf16 v[52:55], v[108:111], v[160:163], v[52:55]
    v_mfma_f32_16x16x32_bf16 v[48:51], v[104:107], v[164:167], v[48:51]
    v_mfma_f32_16x16x32_bf16 v[52:55], v[108:111], v[164:167], v[52:55]
    v_mfma_f32_16x16x32_bf16 v[48:51], v[104:107], v[168:171], v[48:51]
    v_mfma_f32_16x16x32_bf16 v[52:55], v[108:111], v[168:171], v[52:55]
    v_mfma_f32_16x16x32_bf16 v[48:51], v[104:107], v[172:175], v[48:51]
    v_mfma_f32_16x16x32_bf16 v[52:55], v[108:111], v[172:175], v[52:55]
    s_sub_u32 s48, s48, 65536
    s_nop 4
    v_cvt_pk_bf16_f32 v160, v48, v49
    v_cvt_pk_bf16_f32 v161, v50, v51
    v_cvt_pk_bf16_f32 v162, v52, v53
    v_cvt_pk_bf16_f32 v163, v54, v55
    buffer_store_dwordx4 v[160:163], v9, s[20:23], s48 offen sc1
    s_waitcnt vmcnt(0)
    s_endpgm
L_spin48:
    s_mov_b32 s40, 0x20000
L_spin48_l:
    buffer_load_dword v8, v124, s[20:23], 0 offen sc1
    s_sub_u32 s40, s40, 1
    s_waitcnt vmcnt(0)
    v_cmp_eq_u32 vcc, v124, v8
    s_cbranch_scc1 L_back49
    s_cbranch_vccz L_back49
    s_sleep 8
    s_branch L_spin48_l
L_spin51:
    s_mov_b32 s40, 0x20000
L_spin51_l:
    buffer_load_dword v80, v124, s[20:23], 0 offen sc1
    s_sub_u32 s40, s40, 1
    s_waitcnt vmcnt(0)
    v_cmp_eq_u32 vcc, v124, v80
    s_cbranch_scc1 L_back52
    s_cbranch_vccz L_back52
    s_sleep 8
    s_branch L_spin51_l
L_spin53:
    s_mov_b32 s40, 0x20000
L_spin53_l:
    buffer_load_dword v96, v6, s[16:19], s45 offen sc1
    s_sub_u32 s40, s40, 1
    s_waitcnt vmcnt(0)
    v_cmp_ne_u32 vcc, 0, v96
    s_cbranch_scc1 L_back54
    s_cbranch_vccz L_back54
    s_sleep 2
    s_branch L_spin53_l
L_spin55:
    s_mov_b32 s40, 0x20000
L_spin55_l:
    buffer_load_dword v13, v8, s[16:19], s47 offen sc1
    s_sub_u32 s40, s40, 1
    s_waitcnt vmcnt(0)
    v_cmp_ne_u32 vcc, 0, v13
    s_cbranch_scc1 L_back56
    s_cbranch_vccz L_back56
    s_sleep 2
    s_branch L_spin55_l
L_spin57:
    s_mov_b32 s40, 0x20000
L_spin57_l:
    buffer_load_dword v96, v6, s[16:19], s45 offen sc1
    s_sub_u32 s40, s40, 1
    s_waitcnt vmcnt(0)
    v_cmp_ne_u32 vcc, 0, v96
    s_cbranch_scc1 L_back58
    s_cbranch_vccz L_back58
    s_sleep 2
    s_branch L_spin57_l
L_spin59:
    s_mov_b32 s40, 0x20000
L_spin59_l:
    buffer_load_dword v13, v8, s[16:19], s47 offen sc1
    s_sub_u32 s40, s40, 1
    s_waitcnt vmcnt(0)
    v_cmp_ne_u32 vcc, 0, v13
    s_cbranch_scc1 L_back60
    s_cbranch_vccz L_back60
    s_sleep 2
    s_branch L_spin59_l
L_spin61:
    s_mov_b32 s40, 0x20000
L_spin61_l:
    buffer_load_dword v96, v6, s[16:19], s45 offen sc1
    s_sub_u32 s40, s40, 1
    s_waitcnt vmcnt(0)
    v_cmp_ne_u32 vcc, 0, v96
    s_cbranch_scc1 L_back62
    s_cbranch_vccz L_back62
    s_sleep 2
    s_branch L_spin61_l
L_spin63:
    s_mov_b32 s40, 0x20000
L_spin63_l:
    buffer_load_dword v13, v8, s[16:19], s47 offen sc1
    s_sub_u32 s40, s40, 1
    s_waitcnt vmcnt(0)
    v_cmp_ne_u32 vcc, 0, v13
    s_cbranch_scc1 L_back64
    s_cbranch_vccz L_back64
    s_sleep 2
    s_branch L_spin63_l
L_gspin65:
    s_mov_b32 s40, 0x20000
L_gspin65_l:
    buffer_load_dwordx4 v[160:163], v1, s[16:19], s44 offen offset:0 sc1
    buffer_load_dwordx4 v[164:167], v1, s[16:19], s44 offen offset:1024 sc1
    buffer_load_dwordx4 v[168:171], v1, s[16:19], s44 offen offset:2048 sc1
    buffer_load_dwordx4 v[172:175], v1, s[16:19], s44 offen offset:3072 sc1
    s_sub_u32 s40, s40, 1
    s_waitcnt vmcnt(0)
    v_max3_u32 v176, v160, v161, v162
    v_max3_u32 v177, v163, v164, v165
    v_max3_u32 v178, v166, v167, v168
    v_max3_u32 v179, v169, v170, v171
    v_max3_u32 v180, v172, v173, v174
    v_max3_u32 v176, v176, v177, v178
    v_max3_u32 v179, v179, v180, v175
    v_max_u32 v176, v176, v179
    v_cmp_eq_u32 vcc, -1, v176
    s_cbranch_scc1 L_gback66
    s_cbranch_vccz L_gback66
    s_sleep 2
    s_branch L_gspin65_l
L_role_60:
    s_sub_u32 s35, s34, 44
    s_barrier
    s_add_u32 s12, s72, 0x400000
    s_addc_u32 s13, s73, 0
    s_mov_b32 s14, 0x300000
    s_mov_b32 s15, 0x00020000
    s_sub_u32 s37, s35, 12
    s_lshl2_add_u32 s37, s37, s33
    s_lshl2_add_u32 s37, s37, s32
    s_lshl_b32 s37, s37, 13
    v_lshlrev_b32 v6, 7, v0
    buffer_load_dword v240, v6, s[12:15], s37 offen
    s_add_u32 s37, s37, 1048576
    buffer_load_dword v241, v6, s[12:15], s37 offen
    s_add_u32 s37, s37, 1048576
    buffer_load_dword v242, v6, s[12:15], s37 offen
    s_add_u32 s37, s37, 1048576
    s_lshr_b32 s51, s35, 2
    s_and_b32 s87, s35, 3
    s_mul_i32 s54, s51, 1441792
    s_lshl_b32 s37, s87, 9
    s_add_u32 s54, s54, s37
    s_mov_b32 s12, s76
    s_mov_b32 s13, s77
    s_mov_b32 s14, 0x700000
    s_mov_b32 s15, 0x00020000
    s_mov_b32 s39, 2048
    v_lshrrev_b32 v64, 3, v0
    v_lshlrev_b32 v65, 2, v0
    v_and_b32 v65, 64, v65
    v_and_b32 v66, 0x70, v1
    v_xor_b32 v65, v65, v66
    v_mad_u32_u24 v48, v64, s39, v65
    v_add_u32 v49, 16384, v48
    v_add_u32 v50, 128, v48
    v_add_u32 v51, 16512, v48
    v_add_u32 v52, 256, v48
    v_add_u32 v53, 16640, v48
    v_add_u32 v54, 384, v48
    v_add_u32 v55, 16768, v48
    s_mul_i32 s38, s32, 32768
    s_add_u32 s54, s54, s38
    s_lshl_b32 s42, s32, 11
    s_add_u32 m0, s42, 0
    s_nop 0
    buffer_load_dwordx4 v48, s[12:15], s54 offen lds
    s_add_u32 m0, s42, 1024
    s_nop 0
    buffer_load_dwordx4 v49, s[12:15], s54 offen lds
    s_add_u32 m0, s42, 8192
    s_nop 0
    buffer_load_dwordx4 v50, s[12:15], s54 offen lds
    s_add_u32 m0, s42, 9216
    s_nop 0
    buffer_load_dwordx4 v51, s[12:15], s54 offen lds
    s_add_u32 m0, s42, 16384
    s_nop 0
    buffer_load_dwordx4 v52, s[12:15], s54 offen lds
    s_add_u32 m0, s42, 17408
    s_nop 0
    buffer_load_dwordx4 v53, s[12:15], s54 offen lds
    s_add_u32 m0, s42, 24576
    s_nop 0
    buffer_load_dwordx4 v54, s[12:15], s54 offen lds
    s_add_u32 m0, s42, 25600
    s_nop 0
    buffer_load_dwordx4 v55, s[12:15], s54 offen lds
    s_add_u32 s54, s54, 131072
    s_add_u32 m0, s42, 32768
    s_nop 0
    buffer_load_dwordx4 v48, s[12:15], s54 offen lds
    s_add_u32 m0, s42, 33792
    s_nop 0
    buffer_load_dwordx4 v49, s[12:15], s54 offen lds
    s_add_u32 m0, s42, 40960
    s_nop 0
    buffer_load_dwordx4 v50, s[12:15], s54 offen lds
    s_add_u32 m0, s42, 41984
    s_nop 0
    buffer_load_dwordx4 v51, s[12:15], s54 offen lds
    s_add_u32 m0, s42, 49152
    s_nop 0
    buffer_load_dwordx4 v52, s[12:15], s54 offen lds
    s_add_u32 m0, s42, 50176
    s_nop 0
    buffer_load_dwordx4 v53, s[12:15], s54 offen lds
    s_add_u32 m0, s42, 57344
    s_nop 0
    buffer_load_dwordx4 v54, s[12:15], s54 offen lds
    s_add_u32 m0, s42, 58368
    s_nop 0
    buffer_load_dwordx4 v55, s[12:15], s54 offen lds
    s_add_u32 s54, s54, 131072
    s_add_u32 m0, s42, 65536
    s_nop 0
    buffer_load_dwordx4 v48, s[12:15], s54 offen lds
    s_add_u32 m0, s42, 66560
    s_nop 0
    buffer_load_dwordx4 v49, s[12:15], s54 offen lds
    s_add_u32 m0, s42, 73728
    s_nop 0
    buffer_load_dwordx4 v50, s[12:15], s54 offen lds
    s_add_u32 m0, s42, 74752
    s_nop 0
    buffer_load_dwordx4 v51, s[12:15], s54 offen lds
    s_add_u32 m0, s42, 81920
    s_nop 0
    buffer_load_dwordx4 v52, s[12:15], s54 offen lds
    s_add_u32 m0, s42, 82944
    s_nop 0
    buffer_load_dwordx4 v53, s[12:15], s54 offen lds
    s_add_u32 m0, s42, 90112
    s_nop 0
    buffer_load_dwordx4 v54, s[12:15], s54 offen lds
    s_add_u32 m0, s42, 91136
    s_nop 0
    buffer_load_dwordx4 v55, s[12:15], s54 offen lds
    s_add_u32 s54, s54, 131072
    s_add_u32 m0, s42, 98304
    s_nop 0
    buffer_load_dwordx4 v48, s[12:15], s54 offen lds
    s_add_u32 m0, s42, 99328
    s_nop 0
    buffer_load_dwordx4 v49, s[12:15], s54 offen lds
    s_add_u32 m0, s42, 106496
    s_nop 0
    buffer_load_dwordx4 v50, s[12:15], s54 offen lds
    s_add_u32 m0, s42, 107520
    s_nop 0
    buffer_load_dwordx4 v51, s[12:15], s54 offen lds
    s_add_u32 m0, s42, 114688
    s_nop 0
    buffer_load_dwordx4 v52, s[12:15], s54 offen lds
    s_add_u32 m0, s42, 115712
    s_nop 0
    buffer_load_dwordx4 v53, s[12:15], s54 offen lds
    s_add_u32 m0, s42, 122880
    s_nop 0
    buffer_load_dwordx4 v54, s[12:15], s54 offen lds
    s_add_u32 m0, s42, 123904
    s_nop 0
    buffer_load_dwordx4 v55, s[12:15], s54 offen lds
    s_add_u32 s54, s54, 131072
    v_lshrrev_b32 v64, 4, v0
    v_bfe_u32 v65, v0, 2, 2
    v_lshl_add_u32 v64, v64, 3, v65
    v_lshlrev_b32 v64, 7, v64
    v_lshrrev_b32 v65, 1, v65
    v_lshl_add_u32 v64, v65, 6, v64
    v_and_b32 v65, 3, v0
    v_lshl_add_u32 v64, v65, 4, v64
    s_lshl_b32 s37, s32, 13
    s_and_b32 s38, s51, 2
    s_lshl_b32 s38, s38, 5
    s_xor_b32 s38, s38, 0
    s_add_u32 s37, s37, s38
    v_xor_b32 v56, s37, v64
    s_lshl_b32 s37, s32, 13
    s_and_b32 s38, s51, 2
    s_lshl_b32 s38, s38, 5
    s_xor_b32 s38, s38, 8
    s_add_u32 s37, s37, s38
    v_xor_b32 v57, s37, v64
    s_lshl_b32 s37, s32, 13
    s_and_b32 s38, s51, 2
    s_lshl_b32 s38, s38, 5
    s_xor_b32 s38, s38, 64
    s_add_u32 s37, s37, s38
    v_xor_b32 v58, s37, v64
    s_lshl_b32 s37, s32, 13
    s_and_b32 s38, s51, 2
    s_lshl_b32 s38, s38, 5
    s_xor_b32 s38, s38, 72
    s_add_u32 s37, s37, s38
    v_xor_b32 v59, s37, v64
    s_and_b32 s39, s51, 1
    s_lshl_b32 s37, s39, 10
    v_add_u32 v2, s37, v1
    v_xor_b32 v3, 1024, v2
    v_add_u32 v4, 98304, v2
    v_add_u32 v5, 98304, v3
    s_mul_i32 s38, s51, 11*43
    s_lshr_b32 s38, s38, 7
    s_add_u32 s38, s38, 24
    s_lshl_b32 s37, s33, 6
    s_add_u32 s37, s37, s38
    s_lshl_b32 s37, s37, 7
    v_lshl_add_u32 v6, v0, 7, s37
    s_cmp_eq_u32 s32, 0
    s_cselect_b32 s37, 6, 0
    v_cmp_le_u32 vcc, s37, v0
    s_nop 1
    v_cndmask_b32 v6, v6, 2.0, vcc
    s_mul_i32 s43, s32, 4096
    s_mul_i32 s88, s32, 3072
    s_sub_u32 s89, s88, s43
    s_mul_i32 s41, s33, 8388608
    s_add_u32 s41, s41, 0x1000000
    s_mul_i32 s37, s51, 45056
    s_add_u32 s41, s41, s37
    s_add_u32 s41, s41, s43
    s_mul_i32 s90, s33, 8388608
    s_add_u32 s90, s90, 0x2fc0000
    s_lshl_b32 s37, s87, 16
    s_add_u32 s90, s90, s37
    s_lshl_b32 s37, s32, 12
    s_add_u32 s90, s90, s37
    s_and_b32 s37, s51, 3
    s_lshl_b32 s37, s37, 14
    s_add_u32 s90, s90, s37
    v_add_u32 v60, 0, v56
    v_add_u32 v61, 0, v57
    v_add_u32 v62, 0, v58
    v_add_u32 v63, 0, v59
    s_waitcnt vmcnt(24)
    s_barrier
    ds_read_b64_tr_b16 a[0:1], v60 offset:0
    ds_read_b64_tr_b16 a[2:3], v60 offset:512
    ds_read_b64_tr_b16 a[4:5], v61 offset:0
    ds_read_b64_tr_b16 a[6:7], v61 offset:512
    ds_read_b64_tr_b16 a[8:9], v62 offset:0
    ds_read_b64_tr_b16 a[10:11], v62 offset:512
    ds_read_b64_tr_b16 a[12:13], v63 offset:0
    ds_read_b64_tr_b16 a[14:15], v63 offset:512
    ds_read_b64_tr_b16 a[16:17], v60 offset:4096
    ds_read_b64_tr_b16 a[18:19], v60 offset:4608
    ds_read_b64_tr_b16 a[20:21], v61 offset:4096
    ds_read_b64_tr_b16 a[22:23], v61 offset:4608
    ds_read_b64_tr_b16 a[24:25], v62 offset:4096
    ds_read_b64_tr_b16 a[26:27], v62 offset:4608
    ds_read_b64_tr_b16 a[28:29], v63 offset:4096
    ds_read_b64_tr_b16 a[30:31], v63 offset:4608
    s_add_u32 m0, s42, 131072
    s_nop 0
    buffer_load_dwordx4 v48, s[12:15], s54 offen lds
    s_add_u32 m0, s42, 132096
    s_nop 0
    buffer_load_dwordx4 v49, s[12:15], s54 offen lds
    s_add_u32 m0, s42, 139264
    s_nop 0
    buffer_load_dwordx4 v50, s[12:15], s54 offen lds
    s_add_u32 m0, s42, 140288
    s_nop 0
    buffer_load_dwordx4 v51, s[12:15], s54 offen lds
    s_add_u32 m0, s42, 147456
    s_nop 0
    buffer_load_dwordx4 v52, s[12:15], s54 offen lds
    s_add_u32 m0, s42, 148480
    s_nop 0
    buffer_load_dwordx4 v53, s[12:15], s54 offen lds
    s_add_u32 m0, s42, 155648
    s_nop 0
    buffer_load_dwordx4 v54, s[12:15], s54 offen lds
    s_add_u32 m0, s42, 156672
    s_nop 0
    buffer_load_dwordx4 v55, s[12:15], s54 offen lds
    s_add_u32 s54, s54, 131072
    s_waitcnt lgkmcnt(0)
    v_add_u32 v60, 32768, v56
    v_add_u32 v61, 32768, v57
    v_add_u32 v62, 32768, v58
    v_add_u32 v63, 32768, v59
    s_waitcnt vmcnt(24)
    s_barrier
    ds_read_b64_tr_b16 a[32:33], v60 offset:0
    ds_read_b64_tr_b16 a[34:35], v60 offset:512
    ds_read_b64_tr_b16 a[36:37], v61 offset:0
    ds_read_b64_tr_b16 a[38:39], v61 offset:512
    ds_read_b64_tr_b16 a[40:41], v62 offset:0
    ds_read_b64_tr_b16 a[42:43], v62 offset:512
    ds_read_b64_tr_b16 a[44:45], v63 offset:0
    ds_read_b64_tr_b16 a[46:47], v63 offset:512
    ds_read_b64_tr_b16 a[48:49], v60 offset:4096
    ds_read_b64_tr_b16 a[50:51], v60 offset:4608
    ds_read_b64_tr_b16 a[52:53], v61 offset:4096
    ds_read_b64_tr_b16 a[54:55], v61 offset:4608
    ds_read_b64_tr_b16 a[56:57], v62 offset:4096
    ds_read_b64_tr_b16 a[58:59], v62 offset:4608
    ds_read_b64_tr_b16 a[60:61], v63 offset:4096
    ds_read_b64_tr_b16 a[62:63], v63 offset:4608
    s_add_u32 m0, s42, 0
    s_nop 0
    buffer_load_dwordx4 v48, s[12:15], s54 offen lds
    s_add_u32 m0, s42, 1024
    s_nop 0
    buffer_load_dwordx4 v49, s[12:15], s54 offen lds
    s_add_u32 m0, s42, 8192
    s_nop 0
    buffer_load_dwordx4 v50, s[12:15], s54 offen lds
    s_add_u32 m0, s42, 9216
    s_nop 0
    buffer_load_dwordx4 v51, s[12:15], s54 offen lds
    s_add_u32 m0, s42, 16384
    s_nop 0
    buffer_load_dwordx4 v52, s[12:15], s54 offen lds
    s_add_u32 m0, s42, 17408
    s_nop 0
    buffer_load_dwordx4 v53, s[12:15], s54 offen lds
    s_add_u32 m0, s42, 24576
    s_nop 0
    buffer_load_dwordx4 v54, s[12:15], s54 offen lds
    s_add_u32 m0, s42, 25600
    s_nop 0
    buffer_load_dwordx4 v55, s[12:15], s54 offen lds
    s_add_u32 s54, s54, 131072
    s_waitcnt lgkmcnt(0)
    v_add_u32 v60, 65536, v56
    v_add_u32 v61, 65536, v57
    v_add_u32 v62, 65536, v58
    v_add_u32 v63, 65536, v59
    s_waitcnt vmcnt(24)
    s_barrier
    ds_read_b64_tr_b16 a[64:65], v60 offset:0
    ds_read_b64_tr_b16 a[66:67], v60 offset:512
    ds_read_b64_tr_b16 a[68:69], v61 offset:0
    ds_read_b64_tr_b16 a[70:71], v61 offset:512
    ds_read_b64_tr_b16 a[72:73], v62 offset:0
    ds_read_b64_tr_b16 a[74:75], v62 offset:512
    ds_read_b64_tr_b16 a[76:77], v63 offset:0
    ds_read_b64_tr_b16 a[78:79], v63 offset:512
    ds_read_b64_tr_b16 a[80:81], v60 offset:4096
    ds_read_b64_tr_b16 a[82:83], v60 offset:4608
    ds_read_b64_tr_b16 a[84:85], v61 offset:4096
    ds_read_b64_tr_b16 a[86:87], v61 offset:4608
    ds_read_b64_tr_b16 a[88:89], v62 offset:4096
    ds_read_b64_tr_b16 a[90:91], v62 offset:4608
    ds_read_b64_tr_b16 a[92:93], v63 offset:4096
    ds_read_b64_tr_b16 a[94:95], v63 offset:4608
    s_add_u32 m0, s42, 32768
    s_nop 0
    buffer_load_dwordx4 v48, s[12:15], s54 offen lds
    s_add_u32 m0, s42, 33792
    s_nop 0
    buffer_load_dwordx4 v49, s[12:15], s54 offen lds
    s_add_u32 m0, s42, 40960
    s_nop 0
    buffer_load_dwordx4 v50, s[12:15], s54 offen lds
    s_add_u32 m0, s42, 41984
    s_nop 0
    buffer_load_dwordx4 v51, s[12:15], s54 offen lds
    s_add_u32 m0, s42, 49152
    s_nop 0
    buffer_load_dwordx4 v52, s[12:15], s54 offen lds
    s_add_u32 m0, s42, 50176
    s_nop 0
    buffer_load_dwordx4 v53, s[12:15], s54 offen lds
    s_add_u32 m0, s42, 57344
    s_nop 0
    buffer_load_dwordx4 v54, s[12:15], s54 offen lds
    s_add_u32 m0, s42, 58368
    s_nop 0
    buffer_load_dwordx4 v55, s[12:15], s54 offen lds
    s_add_u32 s54, s54, 131072
    s_waitcnt lgkmcnt(0)
    v_add_u32 v60, 98304, v56
    v_add_u32 v61, 98304, v57
    v_add_u32 v62, 98304, v58
    v_add_u32 v63, 98304, v59
    s_waitcnt vmcnt(24)
    s_barrier
    ds_read_b64_tr_b16 a[96:97], v60 offset:0
    ds_read_b64_tr_b16 a[98:99], v60 offset:512
    ds_read_b64_tr_b16 a[100:101], v61 offset:0
    ds_read_b64_tr_b16 a[102:103], v61 offset:512
    ds_read_b64_tr_b16 a[104:105], v62 offset:0
    ds_read_b64_tr_b16 a[106:107], v62 offset:512
    ds_read_b64_tr_b16 a[108:109], v63 offset:0
    ds_read_b64_tr_b16 a[110:111], v63 offset:512
    ds_read_b64_tr_b16 a[112:113], v60 offset:4096
    ds_read_b64_tr_b16 a[114:115], v60 offset:4608
    ds_read_b64_tr_b16 a[116:117], v61 offset:4096
    ds_read_b64_tr_b16 a[118:119], v61 offset:4608
    ds_read_b64_tr_b16 a[120:121], v62 offset:4096
    ds_read_b64_tr_b16 a[122:123], v62 offset:4608
    ds_read_b64_tr_b16 a[124:125], v63 offset:4096
    ds_read_b64_tr_b16 a[126:127], v63 offset:4608
    s_add_u32 m0, s42, 65536
    s_nop 0
    buffer_load_dwordx4 v48, s[12:15], s54 offen lds
    s_add_u32 m0, s42, 66560
    s_nop 0
    buffer_load_dwordx4 v49, s[12:15], s54 offen lds
    s_add_u32 m0, s42, 73728
    s_nop 0
    buffer_load_dwordx4 v50, s[12:15], s54 offen lds
    s_add_u32 m0, s42, 74752
    s_nop 0
    buffer_load_dwordx4 v51, s[12:15], s54 offen lds
    s_add_u32 m0, s42, 81920
    s_nop 0
    buffer_load_dwordx4 v52, s[12:15], s54 offen lds
    s_add_u32 m0, s42, 82944
    s_nop 0
    buffer_load_dwordx4 v53, s[12:15], s54 offen lds
    s_add_u32 m0, s42, 90112
    s_nop 0
    buffer_load_dwordx4 v54, s[12:15], s54 offen lds
    s_add_u32 m0, s42, 91136
    s_nop 0
    buffer_load_dwordx4 v55, s[12:15], s54 offen lds
    s_add_u32 s54, s54, 131072
    s_waitcnt lgkmcnt(0)
    v_add_u32 v60, 131072, v56
    v_add_u32 v61, 131072, v57
    v_add_u32 v62, 131072, v58
    v_add_u32 v63, 131072, v59
    s_waitcnt vmcnt(24)
    s_barrier
    ds_read_b64_tr_b16 a[128:129], v60 offset:0
    ds_read_b64_tr_b16 a[130:131], v60 offset:512
    ds_read_b64_tr_b16 a[132:133], v61 offset:0
    ds_read_b64_tr_b16 a[134:135], v61 offset:512
    ds_read_b64_tr_b16 a[136:137], v62 offset:0
    ds_read_b64_tr_b16 a[138:139], v62 offset:512
    ds_read_b64_tr_b16 a[140:141], v63 offset:0
    ds_read_b64_tr_b16 a[142:143], v63 offset:512
    ds_read_b64_tr_b16 a[144:145], v60 offset:4096
    ds_read_b64_tr_b16 a[146:147], v60 offset:4608
    ds_read_b64_tr_b16 a[148:149], v61 offset:4096
    ds_read_b64_tr_b16 a[150:151], v61 offset:4608
    ds_read_b64_tr_b16 a[152:153], v62 offset:4096
    ds_read_b64_tr_b16 a[154:155], v62 offset:4608
    ds_read_b64_tr_b16 a[156:157], v63 offset:4096
    ds_read_b64_tr_b16 a[158:159], v63 offset:4608
    s_add_u32 m0, s42, 98304
    s_nop 0
    buffer_load_dwordx4 v48, s[12:15], s54 offen lds
    s_add_u32 m0, s42, 99328
    s_nop 0
    buffer_load_dwordx4 v49, s[12:15], s54 offen lds
    s_add_u32 m0, s42, 106496
    s_nop 0
    buffer_load_dwordx4 v50, s[12:15], s54 offen lds
    s_add_u32 m0, s42, 107520
    s_nop 0
    buffer_load_dwordx4 v51, s[12:15], s54 offen lds
    s_add_u32 m0, s42, 114688
    s_nop 0
    buffer_load_dwordx4 v52, s[12:15], s54 offen lds
    s_add_u32 m0, s42, 115712
    s_nop 0
    buffer_load_dwordx4 v53, s[12:15], s54 offen lds
    s_add_u32 m0, s42, 122880
    s_nop 0
    buffer_load_dwordx4 v54, s[12:15], s54 offen lds
    s_add_u32 m0, s42, 123904
    s_nop 0
    buffer_load_dwordx4 v55, s[12:15], s54 offen lds
    s_add_u32 s54, s54, 131072
    s_waitcnt lgkmcnt(0)
    v_add_u32 v60, 0, v56
    v_add_u32 v61, 0, v57
    v_add_u32 v62, 0, v58
    v_add_u32 v63, 0, v59
    s_waitcnt vmcnt(24)
    s_barrier
    ds_read_b64_tr_b16 a[160:161], v60 offset:0
    ds_read_b64_tr_b16 a[162:163], v60 offset:512
    ds_read_b64_tr_b16 a[164:165], v61 offset:0
    ds_read_b64_tr_b16 a[166:167], v61 offset:512
    ds_read_b64_tr_b16 a[168:169], v62 offset:0
    ds_read_b64_tr_b16 a[170:171], v62 offset:512
    ds_read_b64_tr_b16 a[172:173], v63 offset:0
    ds_read_b64_tr_b16 a[174:175], v63 offset:512
    ds_read_b64_tr_b16 a[176:177], v60 offset:4096
    ds_read_b64_tr_b16 a[178:179], v60 offset:4608
    ds_read_b64_tr_b16 a[180:181], v61 offset:4096
    ds_read_b64_tr_b16 a[182:183], v61 offset:4608
    ds_read_b64_tr_b16 a[184:185], v62 offset:4096
    ds_read_b64_tr_b16 a[186:187], v62 offset:4608
    ds_read_b64_tr_b16 a[188:189], v63 offset:4096
    ds_read_b64_tr_b16 a[190:191], v63 offset:4608
    s_add_u32 m0, s42, 131072
    s_nop 0
    buffer_load_dwordx4 v48, s[12:15], s54 offen lds
    s_add_u32 m0, s42, 132096
    s_nop 0
    buffer_load_dwordx4 v49, s[12:15], s54 offen lds
    s_add_u32 m0, s42, 139264
    s_nop 0
    buffer_load_dwordx4 v50, s[12:15], s54 offen lds
    s_add_u32 m0, s42, 140288
    s_nop 0
    buffer_load_dwordx4 v51, s[12:15], s54 offen lds
    s_add_u32 m0, s42, 147456
    s_nop 0
    buffer_load_dwordx4 v52, s[12:15], s54 offen lds
    s_add_u32 m0, s42, 148480
    s_nop 0
    buffer_load_dwordx4 v53, s[12:15], s54 offen lds
    s_add_u32 m0, s42, 155648
    s_nop 0
    buffer_load_dwordx4 v54, s[12:15], s54 offen lds
    s_add_u32 m0, s42, 156672
    s_nop 0
    buffer_load_dwordx4 v55, s[12:15], s54 offen lds
    s_add_u32 s54, s54, 131072
    s_waitcnt lgkmcnt(0)
    v_add_u32 v60, 32768, v56
    v_add_u32 v61, 32768, v57
    v_add_u32 v62, 32768, v58
    v_add_u32 v63, 32768, v59
    s_waitcnt vmcnt(24)
    s_barrier
    ds_read_b64_tr_b16 a[192:193], v60 offset:0
    ds_read_b64_tr_b16 a[194:195], v60 offset:512
    ds_read_b64_tr_b16 a[196:197], v61 offset:0
    ds_read_b64_tr_b16 a[198:199], v61 offset:512
    ds_read_b64_tr_b16 a[200:201], v62 offset:0
    ds_read_b64_tr_b16 a[202:203], v62 offset:512
    ds_read_b64_tr_b16 a[204:205], v63 offset:0
    ds_read_b64_tr_b16 a[206:207], v63 offset:512
    ds_read_b64_tr_b16 a[208:209], v60 offset:4096
    ds_read_b64_tr_b16 a[210:211], v60 offset:4608
    ds_read_b64_tr_b16 a[212:213], v61 offset:4096
    ds_read_b64_tr_b16 a[214:215], v61 offset:4608
    ds_read_b64_tr_b16 a[216:217], v62 offset:4096
    ds_read_b64_tr_b16 a[218:219], v62 offset:4608
    ds_read_b64_tr_b16 a[220:221], v63 offset:4096
    ds_read_b64_tr_b16 a[222:223], v63 offset:4608
    s_add_u32 m0, s42, 0
    s_nop 0
    buffer_load_dwordx4 v48, s[12:15], s54 offen lds
    s_add_u32 m0, s42, 1024
    s_nop 0
    buffer_load_dwordx4 v49, s[12:15], s54 offen lds
    s_add_u32 m0, s42, 8192
    s_nop 0
    buffer_load_dwordx4 v50, s[12:15], s54 offen lds
    s_add_u32 m0, s42, 9216
    s_nop 0
    buffer_load_dwordx4 v51, s[12:15], s54 offen lds
    s_add_u32 m0, s42, 16384
    s_nop 0
    buffer_load_dwordx4 v52, s[12:15], s54 offen lds
    s_add_u32 m0, s42, 17408
    s_nop 0
    buffer_load_dwordx4 v53, s[12:15], s54 offen lds
    s_add_u32 m0, s42, 24576
    s_nop 0
    buffer_load_dwordx4 v54, s[12:15], s54 offen lds
    s_add_u32 m0, s42, 25600
    s_nop 0
    buffer_load_dwordx4 v55, s[12:15], s54 offen lds
    s_add_u32 s54, s54, 131072
    s_waitcnt lgkmcnt(0)
    v_add_u32 v60, 65536, v56
    v_add_u32 v61, 65536, v57
    v_add_u32 v62, 65536, v58
    v_add_u32 v63, 65536, v59
    s_waitcnt vmcnt(24)
    s_barrier
    ds_read_b64_tr_b16 a[224:225], v60 offset:0
    ds_read_b64_tr_b16 a[226:227], v60 offset:512
    ds_read_b64_tr_b16 a[228:229], v61 offset:0
    ds_read_b64_tr_b16 a[230:231], v61 offset:512
    ds_read_b64_tr_b16 a[232:233], v62 offset:0
    ds_read_b64_tr_b16 a[234:235], v62 offset:512
    ds_read_b64_tr_b16 a[236:237], v63 offset:0
    ds_read_b64_tr_b16 a[238:239], v63 offset:512
    ds_read_b64_tr_b16 a[240:241], v60 offset:4096
    ds_read_b64_tr_b16 a[242:243], v60 offset:4608
    ds_read_b64_tr_b16 a[244:245], v61 offset:4096
    ds_read_b64_tr_b16 a[246:247], v61 offset:4608
    ds_read_b64_tr_b16 a[248:249], v62 offset:4096
    ds_read_b64_tr_b16 a[250:251], v62 offset:4608
    ds_read_b64_tr_b16 a[252:253], v63 offset:4096
    ds_read_b64_tr_b16 a[254:255], v63 offset:4608
    s_add_u32 m0, s42, 32768
    s_nop 0
    buffer_load_dwordx4 v48, s[12:15], s54 offen lds
    s_add_u32 m0, s42, 33792
    s_nop 0
    buffer_load_dwordx4 v49, s[12:15], s54 offen lds
    s_add_u32 m0, s42, 40960
    s_nop 0
    buffer_load_dwordx4 v50, s[12:15], s54 offen lds
    s_add_u32 m0, s42, 41984
    s_nop 0
    buffer_load_dwordx4 v51, s[12:15], s54 offen lds
    s_add_u32 m0, s42, 49152
    s_nop 0
    buffer_load_dwordx4 v52, s[12:15], s54 offen lds
    s_add_u32 m0, s42, 50176
    s_nop 0
    buffer_load_dwordx4 v53, s[12:15], s54 offen lds
    s_add_u32 m0, s42, 57344
    s_nop 0
    buffer_load_dwordx4 v54, s[12:15], s54 offen lds
    s_add_u32 m0, s42, 58368
    s_nop 0
    buffer_load_dwordx4 v55, s[12:15], s54 offen lds
    s_add_u32 s54, s54, 131072
    s_waitcnt lgkmcnt(0)
    v_add_u32 v60, 98304, v56
    v_add_u32 v61, 98304, v57
    v_add_u32 v62, 98304, v58
    v_add_u32 v63, 98304, v59
    s_waitcnt vmcnt(24)
    s_barrier
    ds_read_b64_tr_b16 v[128:129], v60 offset:0
    ds_read_b64_tr_b16 v[130:131], v60 offset:512
    ds_read_b64_tr_b16 v[132:133], v61 offset:0
    ds_read_b64_tr_b16 v[134:135], v61 offset:512
    ds_read_b64_tr_b16 v[136:137], v62 offset:0
    ds_read_b64_tr_b16 v[138:139], v62 offset:512
    ds_read_b64_tr_b16 v[140:141], v63 offset:0
    ds_read_b64_tr_b16 v[142:143], v63 offset:512
    ds_read_b64_tr_b16 v[144:145], v60 offset:4096
    ds_read_b64_tr_b16 v[146:147], v60 offset:4608
    ds_read_b64_tr_b16 v[148:149], v61 offset:4096
    ds_read_b64_tr_b16 v[150:151], v61 offset:4608
    ds_read_b64_tr_b16 v[152:153], v62 offset:4096
    ds_read_b64_tr_b16 v[154:155], v62 offset:4608
    ds_read_b64_tr_b16 v[156:157], v63 offset:4096
    ds_read_b64_tr_b16 v[158:159], v63 offset:4608
    s_waitcnt lgkmcnt(0)
    v_add_u32 v60, 131072, v56
    v_add_u32 v61, 131072, v57
    v_add_u32 v62, 131072, v58
    v_add_u32 v63, 131072, v59
    s_waitcnt vmcnt(16)
    s_barrier
    ds_read_b64_tr_b16 v[160:161], v60 offset:0
    ds_read_b64_tr_b16 v[162:163], v60 offset:512
    ds_read_b64_tr_b16 v[164:165], v61 offset:0
    ds_read_b64_tr_b16 v[166:167], v61 offset:512
    ds_read_b64_tr_b16 v[168:169], v62 offset:0
    ds_read_b64_tr_b16 v[170:171], v62 offset:512
    ds_read_b64_tr_b16 v[172:173], v63 offset:0
    ds_read_b64_tr_b16 v[174:175], v63 offset:512
    ds_read_b64_tr_b16 v[176:177], v60 offset:4096
    ds_read_b64_tr_b16 v[178:179], v60 offset:4608
    ds_read_b64_tr_b16 v[180:181], v61 offset:4096
    ds_read_b64_tr_b16 v[182:183], v61 offset:4608
    ds_read_b64_tr_b16 v[184:185], v62 offset:4096
    ds_read_b64_tr_b16 v[186:187], v62 offset:4608
    ds_read_b64_tr_b16 v[188:189], v63 offset:4096
    ds_read_b64_tr_b16 v[190:191], v63 offset:4608
    s_waitcnt lgkmcnt(0)
    v_add_u32 v60, 0, v56
    v_add_u32 v61, 0, v57
    v_add_u32 v62, 0, v58
    v_add_u32 v63, 0, v59
    s_waitcnt vmcnt(8)
    s_barrier
    ds_read_b64_tr_b16 v[192:193], v60 offset:0
    ds_read_b64_tr_b16 v[194:195], v60 offset:512
    ds_read_b64_tr_b16 v[196:197], v61 offset:0
    ds_read_b64_tr_b16 v[198:199], v61 offset:512
    ds_read_b64_tr_b16 v[200:201], v62 offset:0
    ds_read_b64_tr_b16 v[202:203], v62 offset:512
    ds_read_b64_tr_b16 v[204:205], v63 offset:0
    ds_read_b64_tr_b16 v[206:207], v63 offset:512
    ds_read_b64_tr_b16 v[208:209], v60 offset:4096
    ds_read_b64_tr_b16 v[210:211], v60 offset:4608
    ds_read_b64_tr_b16 v[212:213], v61 offset:4096
    ds_read_b64_tr_b16 v[214:215], v61 offset:4608
    ds_read_b64_tr_b16 v[216:217], v62 offset:4096
    ds_read_b64_tr_b16 v[218:219], v62 offset:4608
    ds_read_b64_tr_b16 v[220:221], v63 offset:4096
    ds_read_b64_tr_b16 v[222:223], v63 offset:4608
    s_waitcnt lgkmcnt(0)
    v_add_u32 v60, 32768, v56
    v_add_u32 v61, 32768, v57
    v_add_u32 v62, 32768, v58
    v_add_u32 v63, 32768, v59
    s_waitcnt vmcnt(0)
    s_barrier
    ds_read_b64_tr_b16 v[224:225], v60 offset:0
    ds_read_b64_tr_b16 v[226:227], v60 offset:512
    ds_read_b64_tr_b16 v[228:229], v61 offset:0
    ds_read_b64_tr_b16 v[230:231], v61 offset:512
    ds_read_b64_tr_b16 v[232:233], v62 offset:0
    ds_read_b64_tr_b16 v[234:235], v62 offset:512
    ds_read_b64_tr_b16 v[236:237], v63 offset:0
    ds_read_b64_tr_b16 v[238:239], v63 offset:512
    ds_read_b64_tr_b16 v[240:241], v60 offset:4096
    ds_read_b64_tr_b16 v[242:243], v60 offset:4608
    ds_read_b64_tr_b16 v[244:245], v61 offset:4096
    ds_read_b64_tr_b16 v[246:247], v61 offset:4608
    ds_read_b64_tr_b16 v[248:249], v62 offset:4096
    ds_read_b64_tr_b16 v[250:251], v62 offset:4608
    ds_read_b64_tr_b16 v[252:253], v63 offset:4096
    ds_read_b64_tr_b16 v[254:255], v63 offset:4608
    s_waitcnt lgkmcnt(0)
    s_barrier
    s_cmp_lg_u32 s32, 0
    s_cbranch_scc1 L_arv67
    s_add_u32 s20, s82, 0x80
    s_addc_u32 s21, s83, 0
    s_mov_b32 s22, 0x4
    s_mov_b32 s23, 0x00020000
    buffer_load_dword v80, v124, s[20:23], 0 offen sc1
    s_waitcnt vmcnt(0)
    v_cmp_eq_u32 vcc, v124, v80
    s_cbranch_vccnz L_spin68
L_back69:
L_arv67:
    s_add_u32 s96, s41, 8126464
    s_mov_b32 s98, s41
    s_mov_b32 s45, 0x5530000
    buffer_load_dword v96, v6, s[16:19], s45 offen sc1
    s_waitcnt vmcnt(0)
    v_cmp_ne_u32 vcc, 0, v96
    s_cbranch_vccnz L_spin70
L_back71:
    s_barrier
    s_add_u32 m0, s43, 0
    s_add_u32 s42, s41, 0
    buffer_load_dwordx4 v1, s[16:19], s42 offen offset:0 sc1 lds
    buffer_load_dwordx4 v1, s[16:19], s42 offen offset:1024 sc1 lds
    buffer_load_dwordx4 v1, s[16:19], s42 offen offset:2048 sc1 lds
    buffer_load_dwordx4 v1, s[16:19], s42 offen offset:3072 sc1 lds
    s_add_u32 m0, s43, 16384
    s_add_u32 s42, s41, 16384
    buffer_load_dwordx4 v1, s[16:19], s42 offen offset:0 sc1 lds
    buffer_load_dwordx4 v1, s[16:19], s42 offen offset:1024 sc1 lds
    buffer_load_dwordx4 v1, s[16:19], s42 offen offset:2048 sc1 lds
    buffer_load_dwordx4 v1, s[16:19], s42 offen offset:3072 sc1 lds
    s_add_u32 m0, s43, 32768
    s_add_u32 s42, s41, 32768
    buffer_load_dwordx4 v1, s[16:19], s42 offen offset:0 sc1 lds
    buffer_load_dwordx4 v1, s[16:19], s42 offen offset:1024 sc1 lds
    buffer_load_dwordx4 v1, s[16:19], s42 offen offset:2048 sc1 lds
    buffer_load_dwordx4 v1, s[16:19], s42 offen offset:3072 sc1 lds
    s_add_u32 s45, s45, 65536
    s_waitcnt vmcnt(0) lgkmcnt(0)
    s_barrier
    s_mov_b32 s52, 0x5e00000
    s_mov_b32 s46, 0x5e00000
    s_add_u32 s20, s84, 0x5e00000
    s_addc_u32 s21, s85, 0
    s_mov_b32 s22, 0x400000
    s_mov_b32 s23, 0x00020000
    ds_read_b128 v[80:83], v2 offset:0
    ds_read_b128 v[84:87], v3 offset:0
    s_mov_b32 s36, 0
    s_waitcnt lgkmcnt(0)
    s_nop 7
L_bs_b0:
    v_mfma_f32_16x16x32_bf16 v[16:19], a[0:3], v[80:83], 0
    s_and_b32 s44, s90, 0xffffffff
    ds_read_b128 v[88:91], v2 offset:2048
    s_cmp_lt_i32 s36, 1
    v_mfma_f32_16x16x32_bf16 v[24:27], a[0:3], v[84:87], 0
    s_cselect_b32 s44, 0x5e00000, s44
    s_xor_b32 s49, s44, 0
    v_cvt_pk_bf16_f32 v48, v48, v49
    v_mfma_f32_16x16x32_bf16 v[28:31], a[4:7], v[84:87], 0
    ds_read_b128 v[92:95], v3 offset:2048
    v_cvt_pk_bf16_f32 v49, v50, v51
    v_mfma_f32_16x16x32_bf16 v[20:23], a[4:7], v[80:83], 0
    v_cvt_pk_bf16_f32 v50, v52, v53
    v_cvt_pk_bf16_f32 v51, v54, v55
    v_mfma_f32_16x16x32_bf16 v[32:35], a[8:11], v[80:83], 0
    buffer_store_dwordx4 v[48:51], v1, s[16:19], s49 offen offset:3072 sc1
    v_mfma_f32_16x16x32_bf16 v[40:43], a[8:11], v[84:87], 0
    s_xor_b32 s49, s44, 16384
    v_cvt_pk_bf16_f32 v56, v56, v57
    v_cvt_pk_bf16_f32 v57, v58, v59
    v_mfma_f32_16x16x32_bf16 v[44:47], a[12:15], v[84:87], 0
    v_cvt_pk_bf16_f32 v58, v60, v61
    v_cvt_pk_bf16_f32 v59, v62, v63
    v_mfma_f32_16x16x32_bf16 v[36:39], a[12:15], v[80:83], 0
    s_waitcnt lgkmcnt(0)
    v_mfma_f32_16x16x32_bf16 v[16:19], a[16:19], v[88:91], v[16:19]
    ds_read_b128 v[80:83], v2 offset:4096
    v_mfma_f32_16x16x32_bf16 v[24:27], a[16:19], v[92:95], v[24:27]
    buffer_store_dwordx4 v[56:59], v1, s[16:19], s49 offen offset:3072 sc1
    v_mfma_f32_16x16x32_bf16 v[28:31], a[20:23], v[92:95], v[28:31]
    s_xor_b32 s49, s44, 32768
    ds_read_b128 v[84:87], v3 offset:4096
    v_cvt_pk_bf16_f32 v64, v64, v65
    v_mfma_f32_16x16x32_bf16 v[20:23], a[20:23], v[88:91], v[20:23]
    v_cvt_pk_bf16_f32 v65, v66, v67
    v_cvt_pk_bf16_f32 v66, v68, v69
    v_mfma_f32_16x16x32_bf16 v[32:35], a[24:27], v[88:91], v[32:35]
    v_cvt_pk_bf16_f32 v67, v70, v71
    v_mfma_f32_16x16x32_bf16 v[40:43], a[24:27], v[92:95], v[40:43]
    buffer_store_dwordx4 v[64:67], v1, s[16:19], s49 offen offset:3072 sc1
    v_mfma_f32_16x16x32_bf16 v[44:47], a[28:31], v[92:95], v[44:47]
    s_xor_b32 s49, s44, 49152
    v_cvt_pk_bf16_f32 v72, v72, v73
    v_cvt_pk_bf16_f32 v73, v74, v75
    v_mfma_f32_16x16x32_bf16 v[36:39], a[28:31], v[88:91], v[36:39]
    s_waitcnt lgkmcnt(0)
    v_cvt_pk_bf16_f32 v74, v76, v77
    v_cvt_pk_bf16_f32 v75, v78, v79
    v_mfma_f32_16x16x32_bf16 v[16:19], a[32:35], v[80:83], v[16:19]
    ds_read_b128 v[88:91], v2 offset:6144
    v_mfma_f32_16x16x32_bf16 v[24:27], a[32:35], v[84:87], v[24:27]
    buffer_store_dwordx4 v[72:75], v1, s[16:19], s49 offen offset:3072 sc1
    v_mfma_f32_16x16x32_bf16 v[28:31], a[36:39], v[84:87], v[28:31]
    s_add_u32 s90, s90, 262144
    ds_read_b128 v[92:95], v3 offset:6144
    v_mfma_f32_16x16x32_bf16 v[20:23], a[36:39], v[80:83], v[20:23]
    v_mfma_f32_16x16x32_bf16 v[32:35], a[40:43], v[80:83], v[32:35]
    v_mfma_f32_16x16x32_bf16 v[40:43], a[40:43], v[84:87], v[40:43]
    v_mfma_f32_16x16x32_bf16 v[44:47], a[44:47], v[84:87], v[44:47]
    v_mfma_f32_16x16x32_bf16 v[36:39], a[44:47], v[80:83], v[36:39]
    s_waitcnt lgkmcnt(0)
    v_mfma_f32_16x16x32_bf16 v[16:19], a[48:51], v[88:91], v[16:19]
    s_add_u32 s98, s98, 262144
    ds_read_b128 v[80:83], v2 offset:8192
    s_min_i32 s98, s98, s96
    v_mfma_f32_16x16x32_bf16 v[24:27], a[48:51], v[92:95], v[24:27]
    s_and_b32 s41, s98, 0xffffffff
    s_add_u32 m0, s43, 98304
    s_add_u32 s42, s41, 0
    v_mfma_f32_16x16x32_bf16 v[28:31], a[52:55], v[92:95], v[28:31]
    ds_read_b128 v[84:87], v3 offset:8192
    v_mfma_f32_16x16x32_bf16 v[20:23], a[52:55], v[88:91], v[20:23]
    v_mfma_f32_16x16x32_bf16 v[32:35], a[56:59], v[88:91], v[32:35]
    v_mfma_f32_16x16x32_bf16 v[40:43], a[56:59], v[92:95], v[40:43]
    v_mfma_f32_16x16x32_bf16 v[44:47], a[60:63], v[92:95], v[44:47]
    v_mfma_f32_16x16x32_bf16 v[36:39], a[60:63], v[88:91], v[36:39]
    s_waitcnt lgkmcnt(0)
    v_mfma_f32_16x16x32_bf16 v[16:19], a[64:67], v[80:83], v[16:19]
    ds_read_b128 v[88:91], v2 offset:10240
    v_mfma_f32_16x16x32_bf16 v[24:27], a[64:67], v[84:87], v[24:27]
    v_mfma_f32_16x16x32_bf16 v[28:31], a[68:71], v[84:87], v[28:31]
    ds_read_b128 v[92:95], v3 offset:10240
    v_mfma_f32_16x16x32_bf16 v[20:23], a[68:71], v[80:83], v[20:23]
    v_mfma_f32_16x16x32_bf16 v[32:35], a[72:75], v[80:83], v[32:35]
    v_mfma_f32_16x16x32_bf16 v[40:43], a[72:75], v[84:87], v[40:43]
    v_mfma_f32_16x16x32_bf16 v[44:47], a[76:79], v[84:87], v[44:47]
    v_mfma_f32_16x16x32_bf16 v[36:39], a[76:79], v[80:83], v[36:39]
    s_waitcnt lgkmcnt(0)
    v_mfma_f32_16x16x32_bf16 v[16:19], a[80:83], v[88:91], v[16:19]
    ds_read_b128 v[80:83], v2 offset:12288
    v_mfma_f32_16x16x32_bf16 v[24:27], a[80:83], v[92:95], v[24:27]
    v_mfma_f32_16x16x32_bf16 v[28:31], a[84:87], v[92:95], v[28:31]
    ds_read_b128 v[84:87], v3 offset:12288
    v_mfma_f32_16x16x32_bf16 v[20:23], a[84:87], v[88:91], v[20:23]
    v_mfma_f32_16x16x32_bf16 v[32:35], a[88:91], v[88:91], v[32:35]
    v_mfma_f32_16x16x32_bf16 v[40:43], a[88:91], v[92:95], v[40:43]
    v_mfma_f32_16x16x32_bf16 v[44:47], a[92:95], v[92:95], v[44:47]
    v_mfma_f32_16x16x32_bf16 v[36:39], a[92:95], v[88:91], v[36:39]
    s_waitcnt lgkmcnt(0)
    v_mfma_f32_16x16x32_bf16 v[16:19], a[96:99], v[80:83], v[16:19]
    ds_read_b128 v[88:91], v2 offset:14336
    v_mfma_f32_16x16x32_bf16 v[24:27], a[96:99], v[84:87], v[24:27]
    v_mfma_f32_16x16x32_bf16 v[28:31], a[100:103], v[84:87], v[28:31]
    ds_read_b128 v[92:95], v3 offset:14336
    v_mfma_f32_16x16x32_bf16 v[20:23], a[100:103], v[80:83], v[20:23]
    v_mfma_f32_16x16x32_bf16 v[32:35], a[104:107], v[80:83], v[32:35]
    v_mfma_f32_16x16x32_bf16 v[40:43], a[104:107], v[84:87], v[40:43]
    v_mfma_f32_16x16x32_bf16 v[44:47], a[108:111], v[84:87], v[44:47]
    v_mfma_f32_16x16x32_bf16 v[36:39], a[108:111], v[80:83], v[36:39]
    s_waitcnt lgkmcnt(0)
    v_mfma_f32_16x16x32_bf16 v[16:19], a[112:115], v[88:91], v[16:19]
    ds_read_b128 v[80:83], v2 offset:16384
    v_mfma_f32_16x16x32_bf16 v[24:27], a[112:115], v[92:95], v[24:27]
    v_mfma_f32_16x16x32_bf16 v[28:31], a[116:119], v[92:95], v[28:31]
    ds_read_b128 v[84:87], v3 offset:16384
    v_mfma_f32_16x16x32_bf16 v[20:23], a[116:119], v[88:91], v[20:23]
    v_mfma_f32_16x16x32_bf16 v[32:35], a[120:123], v[88:91], v[32:35]
    v_mfma_f32_16x16x32_bf16 v[40:43], a[120:123], v[92:95], v[40:43]
    v_mfma_f32_16x16x32_bf16 v[44:47], a[124:127], v[92:95], v[44:47]
    buffer_load_dword v96, v6, s[16:19], s45 offen sc1
    v_mfma_f32_16x16x32_bf16 v[36:39], a[124:127], v[88:91], v[36:39]
    s_waitcnt lgkmcnt(0)
    v_mfma_f32_16x16x32_bf16 v[16:19], a[128:131], v[80:83], v[16:19]
    ds_read_b128 v[88:91], v2 offset:18432
    v_mfma_f32_16x16x32_bf16 v[24:27], a[128:131], v[84:87], v[24:27]
    v_mfma_f32_16x16x32_bf16 v[28:31], a[132:135], v[84:87], v[28:31]
    ds_read_b128 v[92:95], v3 offset:18432
    v_mfma_f32_16x16x32_bf16 v[20:23], a[132:135], v[80:83], v[20:23]
    v_mfma_f32_16x16x32_bf16 v[32:35], a[136:139], v[80:83], v[32:35]
    v_mfma_f32_16x16x32_bf16 v[40:43], a[136:139], v[84:87], v[40:43]
    v_mfma_f32_16x16x32_bf16 v[44:47], a[140:143], v[84:87], v[44:47]
    v_mfma_f32_16x16x32_bf16 v[36:39], a[140:143], v[80:83], v[36:39]
    s_waitcnt lgkmcnt(0)
    v_mfma_f32_16x16x32_bf16 v[16:19], a[144:147], v[88:91], v[16:19]
    ds_read_b128 v[80:83], v2 offset:20480
    v_mfma_f32_16x16x32_bf16 v[24:27], a[144:147], v[92:95], v[24:27]
    v_mfma_f32_16x16x32_bf16 v[28:31], a[148:151], v[92:95], v[28:31]
    ds_read_b128 v[84:87], v3 offset:20480
    v_mfma_f32_16x16x32_bf16 v[20:23], a[148:151], v[88:91], v[20:23]
    v_mfma_f32_16x16x32_bf16 v[32:35], a[152:155], v[88:91], v[32:35]
    v_mfma_f32_16x16x32_bf16 v[40:43], a[152:155], v[92:95], v[40:43]
    v_mfma_f32_16x16x32_bf16 v[44:47], a[156:159], v[92:95], v[44:47]
    v_mfma_f32_16x16x32_bf16 v[36:39], a[156:159], v[88:91], v[36:39]
    s_waitcnt lgkmcnt(0)
    v_mfma_f32_16x16x32_bf16 v[16:19], a[160:163], v[80:83], v[16:19]
    ds_read_b128 v[88:91], v2 offset:22528
    v_mfma_f32_16x16x32_bf16 v[24:27], a[160:163], v[84:87], v[24:27]
    v_mfma_f32_16x16x32_bf16 v[28:31], a[164:167], v[84:87], v[28:31]
    ds_read_b128 v[92:95], v3 offset:22528
    v_mfma_f32_16x16x32_bf16 v[20:23], a[164:167], v[80:83], v[20:23]
    v_mfma_f32_16x16x32_bf16 v[32:35], a[168:171], v[80:83], v[32:35]
    v_mfma_f32_16x16x32_bf16 v[40:43], a[168:171], v[84:87], v[40:43]
    v_mfma_f32_16x16x32_bf16 v[44:47], a[172:175], v[84:87], v[44:47]
    v_mfma_f32_16x16x32_bf16 v[36:39], a[172:175], v[80:83], v[36:39]
    s_waitcnt lgkmcnt(0)
    v_mfma_f32_16x16x32_bf16 v[16:19], a[176:179], v[88:91], v[16:19]
    ds_read_b128 v[80:83], v2 offset:24576
    v_mfma_f32_16x16x32_bf16 v[24:27], a[176:179], v[92:95], v[24:27]
    v_mfma_f32_16x16x32_bf16 v[28:31], a[180:183], v[92:95], v[28:31]
    ds_read_b128 v[84:87], v3 offset:24576
    v_mfma_f32_16x16x32_bf16 v[20:23], a[180:183], v[88:91], v[20:23]
    v_mfma_f32_16x16x32_bf16 v[32:35], a[184:187], v[88:91], v[32:35]
    v_mfma_f32_16x16x32_bf16 v[40:43], a[184:187], v[92:95], v[40:43]
    v_mfma_f32_16x16x32_bf16 v[44:47], a[188:191], v[92:95], v[44:47]
    v_mfma_f32_16x16x32_bf16 v[36:39], a[188:191], v[88:91], v[36:39]
    s_waitcnt lgkmcnt(0)
    v_mfma_f32_16x16x32_bf16 v[16:19], a[192:195], v[80:83], v[16:19]
    ds_read_b128 v[88:91], v2 offset:26624
    v_mfma_f32_16x16x32_bf16 v[24:27], a[192:195], v[84:87], v[24:27]
    v_mfma_f32_16x16x32_bf16 v[28:31], a[196:199], v[84:87], v[28:31]
    ds_read_b128 v[92:95], v3 offset:26624
    v_mfma_f32_16x16x32_bf16 v[20:23], a[196:199], v[80:83], v[20:23]
    v_mfma_f32_16x16x32_bf16 v[32:35], a[200:203], v[80:83], v[32:35]
    v_mfma_f32_16x16x32_bf16 v[40:43], a[200:203], v[84:87], v[40:43]
    v_mfma_f32_16x16x32_bf16 v[44:47], a[204:207], v[84:87], v[44:47]
    v_mfma_f32_16x16x32_bf16 v[36:39], a[204:207], v[80:83], v[36:39]
    s_waitcnt lgkmcnt(0)
    v_mfma_f32_16x16x32_bf16 v[16:19], a[208:211], v[88:91], v[16:19]
    ds_read_b128 v[80:83], v2 offset:28672
    v_mfma_f32_16x16x32_bf16 v[24:27], a[208:211], v[92:95], v[24:27]
    v_mfma_f32_16x16x32_bf16 v[28:31], a[212:215], v[92:95], v[28:31]
    s_waitcnt vmcnt(0)
    ds_read_b128 v[84:87], v3 offset:28672
    v_cmp_ne_u32 vcc, 0, v96
    v_mfma_f32_16x16x32_bf16 v[20:23], a[212:215], v[88:91], v[20:23]
    v_mfma_f32_16x16x32_bf16 v[32:35], a[216:219], v[88:91], v[32:35]
    s_cbranch_vccnz L_spin72
L_back73:
    s_barrier
    v_mfma_f32_16x16x32_bf16 v[40:43], a[216:219], v[92:95], v[40:43]
    buffer_load_dwordx4 v1, s[16:19], s42 offen offset:0 sc1 lds
    v_mfma_f32_16x16x32_bf16 v[44:47], a[220:223], v[92:95], v[44:47]
    v_mfma_f32_16x16x32_bf16 v[36:39], a[220:223], v[88:91], v[36:39]
    s_waitcnt lgkmcnt(0)
    v_mfma_f32_16x16x32_bf16 v[16:19], a[224:227], v[80:83], v[16:19]
    ds_read_b128 v[88:91], v2 offset:30720
    v_mfma_f32_16x16x32_bf16 v[24:27], a[224:227], v[84:87], v[24:27]
    buffer_load_dwordx4 v1, s[16:19], s42 offen offset:1024 sc1 lds
    v_mfma_f32_16x16x32_bf16 v[28:31], a[228:231], v[84:87], v[28:31]
    ds_read_b128 v[92:95], v3 offset:30720
    v_mfma_f32_16x16x32_bf16 v[20:23], a[228:231], v[80:83], v[20:23]
    v_mfma_f32_16x16x32_bf16 v[32:35], a[232:235], v[80:83], v[32:35]
    v_mfma_f32_16x16x32_bf16 v[40:43], a[232:235], v[84:87], v[40:43]
    buffer_load_dwordx4 v1, s[16:19], s42 offen offset:2048 sc1 lds
    v_mfma_f32_16x16x32_bf16 v[44:47], a[236:239], v[84:87], v[44:47]
    v_mfma_f32_16x16x32_bf16 v[36:39], a[236:239], v[80:83], v[36:39]
    s_waitcnt lgkmcnt(0)
    v_mfma_f32_16x16x32_bf16 v[16:19], a[240:243], v[88:91], v[16:19]
    ds_read_b128 v[80:83], v2 offset:32768
    v_mfma_f32_16x16x32_bf16 v[24:27], a[240:243], v[92:95], v[24:27]
    buffer_load_dwordx4 v1, s[16:19], s42 offen offset:3072 sc1 lds
    v_mfma_f32_16x16x32_bf16 v[28:31], a[244:247], v[92:95], v[28:31]
    s_add_u32 m0, s43, 114688
    ds_read_b128 v[84:87], v3 offset:32768
    s_add_u32 s42, s41, 16384
    v_mfma_f32_16x16x32_bf16 v[20:23], a[244:247], v[88:91], v[20:23]
    v_mfma_f32_16x16x32_bf16 v[32:35], a[248:251], v[88:91], v[32:35]
    v_mfma_f32_16x16x32_bf16 v[40:43], a[248:251], v[92:95], v[40:43]
    buffer_load_dwordx4 v1, s[16:19], s42 offen offset:0 sc1 lds
    v_mfma_f32_16x16x32_bf16 v[44:47], a[252:255], v[92:95], v[44:47]
    v_mfma_f32_16x16x32_bf16 v[36:39], a[252:255], v[88:91], v[36:39]
    s_waitcnt lgkmcnt(0)
    v_mfma_f32_16x16x32_bf16 v[16:19], v[128:131], v[80:83], v[16:19]
    ds_read_b128 v[88:91], v2 offset:34816
    v_mfma_f32_16x16x32_bf16 v[24:27], v[128:131], v[84:87], v[24:27]
    buffer_load_dwordx4 v1, s[16:19], s42 offen offset:1024 sc1 lds
    v_mfma_f32_16x16x32_bf16 v[28:31], v[132:135], v[84:87], v[28:31]
    ds_read_b128 v[92:95], v3 offset:34816
    v_mfma_f32_16x16x32_bf16 v[20:23], v[132:135], v[80:83], v[20:23]
    v_mfma_f32_16x16x32_bf16 v[32:35], v[136:139], v[80:83], v[32:35]
    v_mfma_f32_16x16x32_bf16 v[40:43], v[136:139], v[84:87], v[40:43]
    buffer_load_dwordx4 v1, s[16:19], s42 offen offset:2048 sc1 lds
    v_mfma_f32_16x16x32_bf16 v[44:47], v[140:143], v[84:87], v[44:47]
    v_mfma_f32_16x16x32_bf16 v[36:39], v[140:143], v[80:83], v[36:39]
    s_waitcnt lgkmcnt(0)
    v_mfma_f32_16x16x32_bf16 v[16:19], v[144:147], v[88:91], v[16:19]
    ds_read_b128 v[80:83], v2 offset:36864
    v_mfma_f32_16x16x32_bf16 v[24:27], v[144:147], v[92:95], v[24:27]
    buffer_load_dwordx4 v1, s[16:19], s42 offen offset:3072 sc1 lds
    v_mfma_f32_16x16x32_bf16 v[28:31], v[148:151], v[92:95], v[28:31]
    ds_read_b128 v[84:87], v3 offset:36864
    v_mfma_f32_16x16x32_bf16 v[20:23], v[148:151], v[88:91], v[20:23]
    v_mfma_f32_16x16x32_bf16 v[32:35], v[152:155], v[88:91], v[32:35]
    buffer_store_dword v124, v124, s[16:19], s91 offen sc1
    v_mfma_f32_16x16x32_bf16 v[40:43], v[152:155], v[92:95], v[40:43]
    s_add_u32 s91, s91, 65536
    v_mfma_f32_16x16x32_bf16 v[44:47], v[156:159], v[92:95], v[44:47]
    v_mfma_f32_16x16x32_bf16 v[36:39], v[156:159], v[88:91], v[36:39]
    s_waitcnt lgkmcnt(0)
    v_mfma_f32_16x16x32_bf16 v[16:19], v[160:163], v[80:83], v[16:19]
    ds_read_b128 v[88:91], v2 offset:38912
    v_mfma_f32_16x16x32_bf16 v[24:27], v[160:163], v[84:87], v[24:27]
    v_mfma_f32_16x16x32_bf16 v[28:31], v[164:167], v[84:87], v[28:31]
    ds_read_b128 v[92:95], v3 offset:38912
    v_mfma_f32_16x16x32_bf16 v[20:23], v[164:167], v[80:83], v[20:23]
    v_mfma_f32_16x16x32_bf16 v[32:35], v[168:171], v[80:83], v[32:35]
    v_mfma_f32_16x16x32_bf16 v[40:43], v[168:171], v[84:87], v[40:43]
    v_mfma_f32_16x16x32_bf16 v[44:47], v[172:175], v[84:87], v[44:47]
    v_mfma_f32_16x16x32_bf16 v[36:39], v[172:175], v[80:83], v[36:39]
    s_waitcnt lgkmcnt(0)
    v_mfma_f32_16x16x32_bf16 v[16:19], v[176:179], v[88:91], v[16:19]
    ds_read_b128 v[80:83], v2 offset:40960
    v_mfma_f32_16x16x32_bf16 v[24:27], v[176:179], v[92:95], v[24:27]
    v_mfma_f32_16x16x32_bf16 v[28:31], v[180:183], v[92:95], v[28:31]
    ds_read_b128 v[84:87], v3 offset:40960
    v_mfma_f32_16x16x32_bf16 v[20:23], v[180:183], v[88:91], v[20:23]
    v_mfma_f32_16x16x32_bf16 v[32:35], v[184:187], v[88:91], v[32:35]
    v_mfma_f32_16x16x32_bf16 v[40:43], v[184:187], v[92:95], v[40:43]
    v_mfma_f32_16x16x32_bf16 v[44:47], v[188:191], v[92:95], v[44:47]
    v_mfma_f32_16x16x32_bf16 v[36:39], v[188:191], v[88:91], v[36:39]
    s_waitcnt lgkmcnt(0)
    v_mfma_f32_16x16x32_bf16 v[16:19], v[192:195], v[80:83], v[16:19]
    ds_read_b128 v[88:91], v2 offset:43008
    v_mfma_f32_16x16x32_bf16 v[24:27], v[192:195], v[84:87], v[24:27]
    v_mfma_f32_16x16x32_bf16 v[28:31], v[196:199], v[84:87], v[28:31]
    s_add_u32 m0, s43, 131072
    ds_read_b128 v[92:95], v3 offset:43008
    s_add_u32 s42, s41, 32768
    v_mfma_f32_16x16x32_bf16 v[20:23], v[196:199], v[80:83], v[20:23]
    buffer_load_dwordx4 v1, s[16:19], s42 offen offset:0 sc1 lds
    v_mfma_f32_16x16x32_bf16 v[32:35], v[200:203], v[80:83], v[32:35]
    v_mfma_f32_16x16x32_bf16 v[40:43], v[200:203], v[84:87], v[40:43]
    v_mfma_f32_16x16x32_bf16 v[44:47], v[204:207], v[84:87], v[44:47]
    v_mfma_f32_16x16x32_bf16 v[36:39], v[204:207], v[80:83], v[36:39]
    s_waitcnt lgkmcnt(0)
    v_mfma_f32_16x16x32_bf16 v[16:19], v[208:211], v[88:91], v[16:19]
    ds_read_b128 v[80:83], v2 offset:45056
    v_mfma_f32_16x16x32_bf16 v[24:27], v[208:211], v[92:95], v[24:27]
    buffer_load_dwordx4 v1, s[16:19], s42 offen offset:1024 sc1 lds
    v_mfma_f32_16x16x32_bf16 v[28:31], v[212:215], v[92:95], v[28:31]
    ds_read_b128 v[84:87], v3 offset:45056
    v_mfma_f32_16x16x32_bf16 v[20:23], v[212:215], v[88:91], v[20:23]
    v_mfma_f32_16x16x32_bf16 v[32:35], v[216:219], v[88:91], v[32:35]
    v_mfma_f32_16x16x32_bf16 v[40:43], v[216:219], v[92:95], v[40:43]
    v_mfma_f32_16x16x32_bf16 v[44:47], v[220:223], v[92:95], v[44:47]
    buffer_load_dwordx4 v1, s[16:19], s42 offen offset:2048 sc1 lds
    v_mfma_f32_16x16x32_bf16 v[36:39], v[220:223], v[88:91], v[36:39]
    s_waitcnt lgkmcnt(0)
    v_mfma_f32_16x16x32_bf16 v[16:19], v[224:227], v[80:83], v[16:19]
    ds_read_b128 v[88:91], v2 offset:47104
    v_mfma_f32_16x16x32_bf16 v[24:27], v[224:227], v[84:87], v[24:27]
    v_mfma_f32_16x16x32_bf16 v[28:31], v[228:231], v[84:87], v[28:31]
    ds_read_b128 v[92:95], v3 offset:47104
    v_mfma_f32_16x16x32_bf16 v[20:23], v[228:231], v[80:83], v[20:23]
    buffer_load_dwordx4 v1, s[16:19], s42 offen offset:3072 sc1 lds
    v_mfma_f32_16x16x32_bf16 v[32:35], v[232:235], v[80:83], v[32:35]
    s_add_u32 s45, s45, 65536
    v_mfma_f32_16x16x32_bf16 v[40:43], v[232:235], v[84:87], v[40:43]
    v_mfma_f32_16x16x32_bf16 v[44:47], v[236:239], v[84:87], v[44:47]
    v_mfma_f32_16x16x32_bf16 v[36:39], v[236:239], v[80:83], v[36:39]
    s_waitcnt vmcnt(5) lgkmcnt(0)
    s_barrier
    v_mfma_f32_16x16x32_bf16 v[16:19], v[240:243], v[88:91], v[16:19]
    ds_read_b128 v[80:83], v4 offset:0
    v_mfma_f32_16x16x32_bf16 v[24:27], v[240:243], v[92:95], v[24:27]
    v_mfma_f32_16x16x32_bf16 v[28:31], v[244:247], v[92:95], v[28:31]
    ds_read_b128 v[84:87], v5 offset:0
    v_mfma_f32_16x16x32_bf16 v[20:23], v[244:247], v[88:91], v[20:23]
    v_mfma_f32_16x16x32_bf16 v[32:35], v[248:251], v[88:91], v[32:35]
    v_mfma_f32_16x16x32_bf16 v[40:43], v[248:251], v[92:95], v[40:43]
    v_mfma_f32_16x16x32_bf16 v[44:47], v[252:255], v[92:95], v[44:47]
    s_add_u32 s36, s36, 1
    v_mfma_f32_16x16x32_bf16 v[36:39], v[252:255], v[88:91], v[36:39]
    s_waitcnt lgkmcnt(0)
L_bs_b1:
    v_mfma_f32_16x16x32_bf16 v[48:51], a[0:3], v[80:83], 0
    s_and_b32 s44, s90, 0xffffffff
    ds_read_b128 v[88:91], v4 offset:2048
    s_cmp_lt_i32 s36, 1
    v_mfma_f32_16x16x32_bf16 v[56:59], a[0:3], v[84:87], 0
    s_cselect_b32 s44, 0x5e00000, s44
    s_xor_b32 s49, s44, 0
    v_cvt_pk_bf16_f32 v16, v16, v17
    v_mfma_f32_16x16x32_bf16 v[60:63], a[4:7], v[84:87], 0
    ds_read_b128 v[92:95], v5 offset:2048
    v_cvt_pk_bf16_f32 v17, v18, v19
    v_mfma_f32_16x16x32_bf16 v[52:55], a[4:7], v[80:83], 0
    v_cvt_pk_bf16_f32 v18, v20, v21
    v_cvt_pk_bf16_f32 v19, v22, v23
    v_mfma_f32_16x16x32_bf16 v[64:67], a[8:11], v[80:83], 0
    buffer_store_dwordx4 v[16:19], v1, s[16:19], s49 offen offset:3072 sc1
    v_mfma_f32_16x16x32_bf16 v[72:75], a[8:11], v[84:87], 0
    s_xor_b32 s49, s44, 16384
    v_cvt_pk_bf16_f32 v24, v24, v25
    v_cvt_pk_bf16_f32 v25, v26, v27
    v_mfma_f32_16x16x32_bf16 v[76:79], a[12:15], v[84:87], 0
    v_cvt_pk_bf16_f32 v26, v28, v29
    v_cvt_pk_bf16_f32 v27, v30, v31
    v_mfma_f32_16x16x32_bf16 v[68:71], a[12:15], v[80:83], 0
    s_waitcnt lgkmcnt(0)
    v_mfma_f32_16x16x32_bf16 v[48:51], a[16:19], v[88:91], v[48:51]
    ds_read_b128 v[80:83], v4 offset:4096
    v_mfma_f32_16x16x32_bf16 v[56:59], a[16:19], v[92:95], v[56:59]
    buffer_store_dwordx4 v[24:27], v1, s[16:19], s49 offen offset:3072 sc1
    v_mfma_f32_16x16x32_bf16 v[60:63], a[20:23], v[92:95], v[60:63]
    s_xor_b32 s49, s44, 32768
    ds_read_b128 v[84:87], v5 offset:4096
    v_cvt_pk_bf16_f32 v32, v32, v33
    v_mfma_f32_16x16x32_bf16 v[52:55], a[20:23], v[88:91], v[52:55]
    v_cvt_pk_bf16_f32 v33, v34, v35
    v_cvt_pk_bf16_f32 v34, v36, v37
    v_mfma_f32_16x16x32_bf16 v[64:67], a[24:27], v[88:91], v[64:67]
    v_cvt_pk_bf16_f32 v35, v38, v39
    v_mfma_f32_16x16x32_bf16 v[72:75], a[24:27], v[92:95], v[72:75]
    buffer_store_dwordx4 v[32:35], v1, s[16:19], s49 offen offset:3072 sc1
    v_mfma_f32_16x16x32_bf16 v[76:79], a[28:31], v[92:95], v[76:79]
    s_xor_b32 s49, s44, 49152
    v_cvt_pk_bf16_f32 v40, v40, v41
    v_cvt_pk_bf16_f32 v41, v42, v43
    v_mfma_f32_16x16x32_bf16 v[68:71], a[28:31], v[88:91], v[68:71]
    s_waitcnt lgkmcnt(0)
    v_cvt_pk_bf16_f32 v42, v44, v45
    v_cvt_pk_bf16_f32 v43, v46, v47
    v_mfma_f32_16x16x32_bf16 v[48:51], a[32:35], v[80:83], v[48:51]
    ds_read_b128 v[88:91], v4 offset:6144
    v_mfma_f32_16x16x32_bf16 v[56:59], a[32:35], v[84:87], v[56:59]
    buffer_store_dwordx4 v[40:43], v1, s[16:19], s49 offen offset:3072 sc1
    v_mfma_f32_16x16x32_bf16 v[60:63], a[36:39], v[84:87], v[60:63]
    s_add_u32 s90, s90, 262144
    ds_read_b128 v[92:95], v5 offset:6144
    v_mfma_f32_16x16x32_bf16 v[52:55], a[36:39], v[80:83], v[52:55]
    v_mfma_f32_16x16x32_bf16 v[64:67], a[40:43], v[80:83], v[64:67]
    v_mfma_f32_16x16x32_bf16 v[72:75], a[40:43], v[84:87], v[72:75]
    v_mfma_f32_16x16x32_bf16 v[76:79], a[44:47], v[84:87], v[76:79]
    v_mfma_f32_16x16x32_bf16 v[68:71], a[44:47], v[80:83], v[68:71]
    s_waitcnt lgkmcnt(0)
    v_mfma_f32_16x16x32_bf16 v[48:51], a[48:51], v[88:91], v[48:51]
    s_add_u32 s98, s98, 262144
    ds_read_b128 v[80:83], v4 offset:8192
    s_min_i32 s98, s98, s96
    v_mfma_f32_16x16x32_bf16 v[56:59], a[48:51], v[92:95], v[56:59]
    s_and_b32 s41, s98, 0xffffffff
    s_add_u32 m0, s43, 0
    s_add_u32 s42, s41, 0
    v_mfma_f32_16x16x32_bf16 v[60:63], a[52:55], v[92:95], v[60:63]
    ds_read_b128 v[84:87], v5 offset:8192
    v_mfma_f32_16x16x32_bf16 v[52:55], a[52:55], v[88:91], v[52:55]
    v_mfma_f32_16x16x32_bf16 v[64:67], a[56:59], v[88:91], v[64:67]
    v_mfma_f32_16x16x32_bf16 v[72:75], a[56:59], v[92:95], v[72:75]
    v_mfma_f32_16x16x32_bf16 v[76:79], a[60:63], v[92:95], v[76:79]
    v_mfma_f32_16x16x32_bf16 v[68:71], a[60:63], v[88:91], v[68:71]
    s_waitcnt lgkmcnt(0)
    v_mfma_f32_16x16x32_bf16 v[48:51], a[64:67], v[80:83], v[48:51]
    ds_read_b128 v[88:91], v4 offset:10240
    v_mfma_f32_16x16x32_bf16 v[56:59], a[64:67], v[84:87], v[56:59]
    v_mfma_f32_16x16x32_bf16 v[60:63], a[68:71], v[84:87], v[60:63]
    ds_read_b128 v[92:95], v5 offset:10240
    v_mfma_f32_16x16x32_bf16 v[52:55], a[68:71], v[80:83], v[52:55]
    v_mfma_f32_16x16x32_bf16 v[64:67], a[72:75], v[80:83], v[64:67]
    v_mfma_f32_16x16x32_bf16 v[72:75], a[72:75], v[84:87], v[72:75]
    v_mfma_f32_16x16x32_bf16 v[76:79], a[76:79], v[84:87], v[76:79]
    v_mfma_f32_16x16x32_bf16 v[68:71], a[76:79], v[80:83], v[68:71]
    s_waitcnt lgkmcnt(0)
    v_mfma_f32_16x16x32_bf16 v[48:51], a[80:83], v[88:91], v[48:51]
    ds_read_b128 v[80:83], v4 offset:12288
    v_mfma_f32_16x16x32_bf16 v[56:59], a[80:83], v[92:95], v[56:59]
    v_mfma_f32_16x16x32_bf16 v[60:63], a[84:87], v[92:95], v[60:63]
    ds_read_b128 v[84:87], v5 offset:12288
    v_mfma_f32_16x16x32_bf16 v[52:55], a[84:87], v[88:91], v[52:55]
    v_mfma_f32_16x16x32_bf16 v[64:67], a[88:91], v[88:91], v[64:67]
    v_mfma_f32_16x16x32_bf16 v[72:75], a[88:91], v[92:95], v[72:75]
    v_mfma_f32_16x16x32_bf16 v[76:79], a[92:95], v[92:95], v[76:79]
    v_mfma_f32_16x16x32_bf16 v[68:71], a[92:95], v[88:91], v[68:71]
    s_waitcnt lgkmcnt(0)
    v_mfma_f32_16x16x32_bf16 v[48:51], a[96:99], v[80:83], v[48:51]
    ds_read_b128 v[88:91], v4 offset:14336
    v_mfma_f32_16x16x32_bf16 v[56:59], a[96:99], v[84:87], v[56:59]
    v_mfma_f32_16x16x32_bf16 v[60:63], a[100:103], v[84:87], v[60:63]
    ds_read_b128 v[92:95], v5 offset:14336
    v_mfma_f32_16x16x32_bf16 v[52:55], a[100:103], v[80:83], v[52:55]
    v_mfma_f32_16x16x32_bf16 v[64:67], a[104:107], v[80:83], v[64:67]
    v_mfma_f32_16x16x32_bf16 v[72:75], a[104:107], v[84:87], v[72:75]
    v_mfma_f32_16x16x32_bf16 v[76:79], a[108:111], v[84:87], v[76:79]
    v_mfma_f32_16x16x32_bf16 v[68:71], a[108:111], v[80:83], v[68:71]
    s_waitcnt lgkmcnt(0)
    v_mfma_f32_16x16x32_bf16 v[48:51], a[112:115], v[88:91], v[48:51]
    ds_read_b128 v[80:83], v4 offset:16384
    v_mfma_f32_16x16x32_bf16 v[56:59], a[112:115], v[92:95], v[56:59]
    v_mfma_f32_16x16x32_bf16 v[60:63], a[116:119], v[92:95], v[60:63]
    ds_read_b128 v[84:87], v5 offset:16384
    v_mfma_f32_16x16x32_bf16 v[52:55], a[116:119], v[88:91], v[52:55]
    v_mfma_f32_16x16x32_bf16 v[64:67], a[120:123], v[88:91], v[64:67]
    v_mfma_f32_16x16x32_bf16 v[72:75], a[120:123], v[92:95], v[72:75]
    v_mfma_f32_16x16x32_bf16 v[76:79], a[124:127], v[92:95], v[76:79]
    buffer_load_dword v96, v6, s[16:19], s45 offen sc1
    v_mfma_f32_16x16x32_bf16 v[68:71], a[124:127], v[88:91], v[68:71]
    s_waitcnt lgkmcnt(0)
    v_mfma_f32_16x16x32_bf16 v[48:51], a[128:131], v[80:83], v[48:51]
    ds_read_b128 v[88:91], v4 offset:18432
    v_mfma_f32_16x16x32_bf16 v[56:59], a[128:131], v[84:87], v[56:59]
    v_mfma_f32_16x16x32_bf16 v[60:63], a[132:135], v[84:87], v[60:63]
    ds_read_b128 v[92:95], v5 offset:18432
    v_mfma_f32_16x16x32_bf16 v[52:55], a[132:135], v[80:83], v[52:55]
    v_mfma_f32_16x16x32_bf16 v[64:67], a[136:139], v[80:83], v[64:67]
    v_mfma_f32_16x16x32_bf16 v[72:75], a[136:139], v[84:87], v[72:75]
    v_mfma_f32_16x16x32_bf16 v[76:79], a[140:143], v[84:87], v[76:79]
    v_mfma_f32_16x16x32_bf16 v[68:71], a[140:143], v[80:83], v[68:71]
    s_waitcnt lgkmcnt(0)
    v_mfma_f32_16x16x32_bf16 v[48:51], a[144:147], v[88:91], v[48:51]
    ds_read_b128 v[80:83], v4 offset:20480
    v_mfma_f32_16x16x32_bf16 v[56:59], a[144:147], v[92:95], v[56:59]
    v_mfma_f32_16x16x32_bf16 v[60:63], a[148:151], v[92:95], v[60:63]
    ds_read_b128 v[84:87], v5 offset:20480
    v_mfma_f32_16x16x32_bf16 v[52:55], a[148:151], v[88:91], v[52:55]
    v_mfma_f32_16x16x32_bf16 v[64:67], a[152:155], v[88:91], v[64:67]
    v_mfma_f32_16x16x32_bf16 v[72:75], a[152:155], v[92:95], v[72:75]
    v_mfma_f32_16x16x32_bf16 v[76:79], a[156:159], v[92:95], v[76:79]
    v_mfma_f32_16x16x32_bf16 v[68:71], a[156:159], v[88:91], v[68:71]
    s_waitcnt lgkmcnt(0)
    v_mfma_f32_16x16x32_bf16 v[48:51], a[160:163], v[80:83], v[48:51]
    ds_read_b128 v[88:91], v4 offset:22528
    v_mfma_f32_16x16x32_bf16 v[56:59], a[160:163], v[84:87], v[56:59]
    v_mfma_f32_16x16x32_bf16 v[60:63], a[164:167], v[84:87], v[60:63]
    ds_read_b128 v[92:95], v5 offset:22528
    v_mfma_f32_16x16x32_bf16 v[52:55], a[164:167], v[80:83], v[52:55]
    v_mfma_f32_16x16x32_bf16 v[64:67], a[168:171], v[80:83], v[64:67]
    v_mfma_f32_16x16x32_bf16 v[72:75], a[168:171], v[84:87], v[72:75]
    v_mfma_f32_16x16x32_bf16 v[76:79], a[172:175], v[84:87], v[76:79]
    v_mfma_f32_16x16x32_bf16 v[68:71], a[172:175], v[80:83], v[68:71]
    s_waitcnt lgkmcnt(0)
    v_mfma_f32_16x16x32_bf16 v[48:51], a[176:179], v[88:91], v[48:51]
    ds_read_b128 v[80:83], v4 offset:24576
    v_mfma_f32_16x16x32_bf16 v[56:59], a[176:179], v[92:95], v[56:59]
    v_mfma_f32_16x16x32_bf16 v[60:63], a[180:183], v[92:95], v[60:63]
    ds_read_b128 v[84:87], v5 offset:24576
    v_mfma_f32_16x16x32_bf16 v[52:55], a[180:183], v[88:91], v[52:55]
    v_mfma_f32_16x16x32_bf16 v[64:67], a[184:187], v[88:91], v[64:67]
    v_mfma_f32_16x16x32_bf16 v[72:75], a[184:187], v[92:95], v[72:75]
    v_mfma_f32_16x16x32_bf16 v[76:79], a[188:191], v[92:95], v[76:79]
    v_mfma_f32_16x16x32_bf16 v[68:71], a[188:191], v[88:91], v[68:71]
    s_waitcnt lgkmcnt(0)
    v_mfma_f32_16x16x32_bf16 v[48:51], a[192:195], v[80:83], v[48:51]
    ds_read_b128 v[88:91], v4 offset:26624
    v_mfma_f32_16x16x32_bf16 v[56:59], a[192:195], v[84:87], v[56:59]
    v_mfma_f32_16x16x32_bf16 v[60:63], a[196:199], v[84:87], v[60:63]
    ds_read_b128 v[92:95], v5 offset:26624
    v_mfma_f32_16x16x32_bf16 v[52:55], a[196:199], v[80:83], v[52:55]
    v_mfma_f32_16x16x32_bf16 v[64:67], a[200:203], v[80:83], v[64:67]
    v_mfma_f32_16x16x32_bf16 v[72:75], a[200:203], v[84:87], v[72:75]
    v_mfma_f32_16x16x32_bf16 v[76:79], a[204:207], v[84:87], v[76:79]
    v_mfma_f32_16x16x32_bf16 v[68:71], a[204:207], v[80:83], v[68:71]
    s_waitcnt lgkmcnt(0)
    v_mfma_f32_16x16x32_bf16 v[48:51], a[208:211], v[88:91], v[48:51]
    ds_read_b128 v[80:83], v4 offset:28672
    v_mfma_f32_16x16x32_bf16 v[56:59], a[208:211], v[92:95], v[56:59]
    v_mfma_f32_16x16x32_bf16 v[60:63], a[212:215], v[92:95], v[60:63]
    s_waitcnt vmcnt(0)
    ds_read_b128 v[84:87], v5 offset:28672
    v_cmp_ne_u32 vcc, 0, v96
    v_mfma_f32_16x16x32_bf16 v[52:55], a[212:215], v[88:91], v[52:55]
    v_mfma_f32_16x16x32_bf16 v[64:67], a[216:219], v[88:91], v[64:67]
    s_cbranch_vccnz L_spin74
L_back75:
    s_barrier
    v_mfma_f32_16x16x32_bf16 v[72:75], a[216:219], v[92:95], v[72:75]
    buffer_load_dwordx4 v1, s[16:19], s42 offen offset:0 sc1 lds
    v_mfma_f32_16x16x32_bf16 v[76:79], a[220:223], v[92:95], v[76:79]
    v_mfma_f32_16x16x32_bf16 v[68:71], a[220:223], v[88:91], v[68:71]
    s_waitcnt lgkmcnt(0)
    v_mfma_f32_16x16x32_bf16 v[48:51], a[224:227], v[80:83], v[48:51]
    ds_read_b128 v[88:91], v4 offset:30720
    v_mfma_f32_16x16x32_bf16 v[56:59], a[224:227], v[84:87], v[56:59]
    buffer_load_dwordx4 v1, s[16:19], s42 offen offset:1024 sc1 lds
    v_mfma_f32_16x16x32_bf16 v[60:63], a[228:231], v[84:87], v[60:63]
    ds_read_b128 v[92:95], v5 offset:30720
    v_mfma_f32_16x16x32_bf16 v[52:55], a[228:231], v[80:83], v[52:55]
    v_mfma_f32_16x16x32_bf16 v[64:67], a[232:235], v[80:83], v[64:67]
    v_mfma_f32_16x16x32_bf16 v[72:75], a[232:235], v[84:87], v[72:75]
    buffer_load_dwordx4 v1, s[16:19], s42 offen offset:2048 sc1 lds
    v_mfma_f32_16x16x32_bf16 v[76:79], a[236:239], v[84:87], v[76:79]
    v_mfma_f32_16x16x32_bf16 v[68:71], a[236:239], v[80:83], v[68:71]
    s_waitcnt lgkmcnt(0)
    v_mfma_f32_16x16x32_bf16 v[48:51], a[240:243], v[88:91], v[48:51]
    ds_read_b128 v[80:83], v4 offset:32768
    v_mfma_f32_16x16x32_bf16 v[56:59], a[240:243], v[92:95], v[56:59]
    buffer_load_dwordx4 v1, s[16:19], s42 offen offset:3072 sc1 lds
    v_mfma_f32_16x16x32_bf16 v[60:63], a[244:247], v[92:95], v[60:63]
    s_add_u32 m0, s43, 16384
    ds_read_b128 v[84:87], v5 offset:32768
    s_add_u32 s42, s41, 16384
    v_mfma_f32_16x16x32_bf16 v[52:55], a[244:247], v[88:91], v[52:55]
    v_mfma_f32_16x16x32_bf16 v[64:67], a[248:251], v[88:91], v[64:67]
    v_mfma_f32_16x16x32_bf16 v[72:75], a[248:251], v[92:95], v[72:75]
    buffer_load_dwordx4 v1, s[16:19], s42 offen offset:0 sc1 lds
    v_mfma_f32_16x16x32_bf16 v[76:79], a[252:255], v[92:95], v[76:79]
    v_mfma_f32_16x16x32_bf16 v[68:71], a[252:255], v[88:91], v[68:71]
    s_waitcnt lgkmcnt(0)
    v_mfma_f32_16x16x32_bf16 v[48:51], v[128:131], v[80:83], v[48:51]
    ds_read_b128 v[88:91], v4 offset:34816
    v_mfma_f32_16x16x32_bf16 v[56:59], v[128:131], v[84:87], v[56:59]
    buffer_load_dwordx4 v1, s[16:19], s42 offen offset:1024 sc1 lds
    v_mfma_f32_16x16x32_bf16 v[60:63], v[132:135], v[84:87], v[60:63]
    ds_read_b128 v[92:95], v5 offset:34816
    v_mfma_f32_16x16x32_bf16 v[52:55], v[132:135], v[80:83], v[52:55]
    v_mfma_f32_16x16x32_bf16 v[64:67], v[136:139], v[80:83], v[64:67]
    v_mfma_f32_16x16x32_bf16 v[72:75], v[136:139], v[84:87], v[72:75]
    buffer_load_dwordx4 v1, s[16:19], s42 offen offset:2048 sc1 lds
    v_mfma_f32_16x16x32_bf16 v[76:79], v[140:143], v[84:87], v[76:79]
    v_mfma_f32_16x16x32_bf16 v[68:71], v[140:143], v[80:83], v[68:71]
    s_waitcnt lgkmcnt(0)
    v_mfma_f32_16x16x32_bf16 v[48:51], v[144:147], v[88:91], v[48:51]
    ds_read_b128 v[80:83], v4 offset:36864
    v_mfma_f32_16x16x32_bf16 v[56:59], v[144:147], v[92:95], v[56:59]
    buffer_load_dwordx4 v1, s[16:19], s42 offen offset:3072 sc1 lds
    v_mfma_f32_16x16x32_bf16 v[60:63], v[148:151], v[92:95], v[60:63]
    ds_read_b128 v[84:87], v5 offset:36864
    v_mfma_f32_16x16x32_bf16 v[52:55], v[148:151], v[88:91], v[52:55]
    v_mfma_f32_16x16x32_bf16 v[64:67], v[152:155], v[88:91], v[64:67]
    buffer_store_dword v124, v124, s[16:19], s91 offen sc1
    v_mfma_f32_16x16x32_bf16 v[72:75], v[152:155], v[92:95], v[72:75]
    s_add_u32 s91, s91, 65536
    v_mfma_f32_16x16x32_bf16 v[76:79], v[156:159], v[92:95], v[76:79]
    v_mfma_f32_16x16x32_bf16 v[68:71], v[156:159], v[88:91], v[68:71]
    s_waitcnt lgkmcnt(0)
    v_mfma_f32_16x16x32_bf16 v[48:51], v[160:163], v[80:83], v[48:51]
    ds_read_b128 v[88:91], v4 offset:38912
    v_mfma_f32_16x16x32_bf16 v[56:59], v[160:163], v[84:87], v[56:59]
    v_mfma_f32_16x16x32_bf16 v[60:63], v[164:167], v[84:87], v[60:63]
    ds_read_b128 v[92:95], v5 offset:38912
    v_mfma_f32_16x16x32_bf16 v[52:55], v[164:167], v[80:83], v[52:55]
    v_mfma_f32_16x16x32_bf16 v[64:67], v[168:171], v[80:83], v[64:67]
    v_mfma_f32_16x16x32_bf16 v[72:75], v[168:171], v[84:87], v[72:75]
    v_mfma_f32_16x16x32_bf16 v[76:79], v[172:175], v[84:87], v[76:79]
    v_mfma_f32_16x16x32_bf16 v[68:71], v[172:175], v[80:83], v[68:71]
    s_waitcnt lgkmcnt(0)
    v_mfma_f32_16x16x32_bf16 v[48:51], v[176:179], v[88:91], v[48:51]
    ds_read_b128 v[80:83], v4 offset:40960
    v_mfma_f32_16x16x32_bf16 v[56:59], v[176:179], v[92:95], v[56:59]
    v_mfma_f32_16x16x32_bf16 v[60:63], v[180:183], v[92:95], v[60:63]
    ds_read_b128 v[84:87], v5 offset:40960
    v_mfma_f32_16x16x32_bf16 v[52:55], v[180:183], v[88:91], v[52:55]
    v_mfma_f32_16x16x32_bf16 v[64:67], v[184:187], v[88:91], v[64:67]
    v_mfma_f32_16x16x32_bf16 v[72:75], v[184:187], v[92:95], v[72:75]
    v_mfma_f32_16x16x32_bf16 v[76:79], v[188:191], v[92:95], v[76:79]
    v_mfma_f32_16x16x32_bf16 v[68:71], v[188:191], v[88:91], v[68:71]
    s_waitcnt lgkmcnt(0)
    v_mfma_f32_16x16x32_bf16 v[48:51], v[192:195], v[80:83], v[48:51]
    ds_read_b128 v[88:91], v4 offset:43008
    v_mfma_f32_16x16x32_bf16 v[56:59], v[192:195], v[84:87], v[56:59]
    v_mfma_f32_16x16x32_bf16 v[60:63], v[196:199], v[84:87], v[60:63]
    s_add_u32 m0, s43, 32768
    ds_read_b128 v[92:95], v5 offset:43008
    s_add_u32 s42, s41, 32768
    v_mfma_f32_16x16x32_bf16 v[52:55], v[196:199], v[80:83], v[52:55]
    buffer_load_dwordx4 v1, s[16:19], s42 offen offset:0 sc1 lds
    v_mfma_f32_16x16x32_bf16 v[64:67], v[200:203], v[80:83], v[64:67]
    v_mfma_f32_16x16x32_bf16 v[72:75], v[200:203], v[84:87], v[72:75]
    v_mfma_f32_16x16x32_bf16 v[76:79], v[204:207], v[84:87], v[76:79]
    v_mfma_f32_16x16x32_bf16 v[68:71], v[204:207], v[80:83], v[68:71]
    s_waitcnt lgkmcnt(0)
    v_mfma_f32_16x16x32_bf16 v[48:51], v[208:211], v[88:91], v[48:51]
    ds_read_b128 v[80:83], v4 offset:45056
    v_mfma_f32_16x16x32_bf16 v[56:59], v[208:211], v[92:95], v[56:59]
    buffer_load_dwordx4 v1, s[16:19], s42 offen offset:1024 sc1 lds
    v_mfma_f32_16x16x32_bf16 v[60:63], v[212:215], v[92:95], v[60:63]
    ds_read_b128 v[84:87], v5 offset:45056
    v_mfma_f32_16x16x32_bf16 v[52:55], v[212:215], v[88:91], v[52:55]
    v_mfma_f32_16x16x32_bf16 v[64:67], v[216:219], v[88:91], v[64:67]
    v_mfma_f32_16x16x32_bf16 v[72:75], v[216:219], v[92:95], v[72:75]
    v_mfma_f32_16x16x32_bf16 v[76:79], v[220:223], v[92:95], v[76:79]
    buffer_load_dwordx4 v1, s[16:19], s42 offen offset:2048 sc1 lds
    v_mfma_f32_16x16x32_bf16 v[68:71], v[220:223], v[88:91], v[68:71]
    s_waitcnt lgkmcnt(0)
    v_mfma_f32_16x16x32_bf16 v[48:51], v[224:227], v[80:83], v[48:51]
    ds_read_b128 v[88:91], v4 offset:47104
    v_mfma_f32_16x16x32_bf16 v[56:59], v[224:227], v[84:87], v[56:59]
    v_mfma_f32_16x16x32_bf16 v[60:63], v[228:231], v[84:87], v[60:63]
    ds_read_b128 v[92:95], v5 offset:47104
    v_mfma_f32_16x16x32_bf16 v[52:55], v[228:231], v[80:83], v[52:55]
    buffer_load_dwordx4 v1, s[16:19], s42 offen offset:3072 sc1 lds
    v_mfma_f32_16x16x32_bf16 v[64:67], v[232:235], v[80:83], v[64:67]
    s_add_u32 s45, s45, 65536
    v_mfma_f32_16x16x32_bf16 v[72:75], v[232:235], v[84:87], v[72:75]
    v_mfma_f32_16x16x32_bf16 v[76:79], v[236:239], v[84:87], v[76:79]
    v_mfma_f32_16x16x32_bf16 v[68:71], v[236:239], v[80:83], v[68:71]
    s_waitcnt vmcnt(5) lgkmcnt(0)
    s_barrier
    v_mfma_f32_16x16x32_bf16 v[48:51], v[240:243], v[88:91], v[48:51]
    ds_read_b128 v[80:83], v2 offset:0
    v_mfma_f32_16x16x32_bf16 v[56:59], v[240:243], v[92:95], v[56:59]
    v_mfma_f32_16x16x32_bf16 v[60:63], v[244:247], v[92:95], v[60:63]
    ds_read_b128 v[84:87], v3 offset:0
    v_mfma_f32_16x16x32_bf16 v[52:55], v[244:247], v[88:91], v[52:55]
    v_mfma_f32_16x16x32_bf16 v[64:67], v[248:251], v[88:91], v[64:67]
    v_mfma_f32_16x16x32_bf16 v[72:75], v[248:251], v[92:95], v[72:75]
    v_mfma_f32_16x16x32_bf16 v[76:79], v[252:255], v[92:95], v[76:79]
    s_add_u32 s36, s36, 1
    v_mfma_f32_16x16x32_bf16 v[68:71], v[252:255], v[88:91], v[68:71]
    s_waitcnt lgkmcnt(0)
    s_cmp_lt_u32 s36, 32
    s_cbranch_scc1 L_bs_b0
    s_nop 7
    s_and_b32 s44, s90, 0xffffffff
    s_cmp_lt_i32 s36, 1
    s_cselect_b32 s44, 0x5e00000, s44
    s_xor_b32 s49, s44, 0
    v_cvt_pk_bf16_f32 v48, v48, v49
    v_cvt_pk_bf16_f32 v49, v50, v51
    v_cvt_pk_bf16_f32 v50, v52, v53
    v_cvt_pk_bf16_f32 v51, v54, v55
    v_min_u32 v48, -2, v48
    v_min_u32 v49, -2, v49
    v_min_u32 v50, -2, v50
    v_min_u32 v51, -2, v51
    buffer_store_dwordx4 v[48:51], v1, s[16:19], s49 offen offset:3072 sc1
    s_xor_b32 s49, s44, 16384
    v_cvt_pk_bf16_f32 v56, v56, v57
    v_cvt_pk_bf16_f32 v57, v58, v59
    v_cvt_pk_bf16_f32 v58, v60, v61
    v_cvt_pk_bf16_f32 v59, v62, v63
    v_min_u32 v56, -2, v56
    v_min_u32 v57, -2, v57
    v_min_u32 v58, -2, v58
    v_min_u32 v59, -2, v59
    buffer_store_dwordx4 v[56:59], v1, s[16:19], s49 offen offset:3072 sc1
    s_xor_b32 s49, s44, 32768
    v_cvt_pk_bf16_f32 v64, v64, v65
    v_cvt_pk_bf16_f32 v65, v66, v67
    v_cvt_pk_bf16_f32 v66, v68, v69
    v_cvt_pk_bf16_f32 v67, v70, v71
    v_min_u32 v64, -2, v64
    v_min_u32 v65, -2, v65
    v_min_u32 v66, -2, v66
    v_min_u32 v67, -2, v67
    buffer_store_dwordx4 v[64:67], v1, s[16:19], s49 offen offset:3072 sc1
    s_xor_b32 s49, s44, 49152
    v_cvt_pk_bf16_f32 v72, v72, v73
    v_cvt_pk_bf16_f32 v73, v74, v75
    v_cvt_pk_bf16_f32 v74, v76, v77
    v_cvt_pk_bf16_f32 v75, v78, v79
    v_min_u32 v72, -2, v72
    v_min_u32 v73, -2, v73
    v_min_u32 v74, -2, v74
    v_min_u32 v75, -2, v75
    buffer_store_dwordx4 v[72:75], v1, s[16:19], s49 offen offset:3072 sc1
    s_add_u32 s90, s90, 262144
    s_waitcnt vmcnt(0)
    s_endpgm
L_spin68:
    s_mov_b32 s40, 0x20000
L_spin68_l:
    buffer_load_dword v80, v124, s[20:23], 0 offen sc1
    s_sub_u32 s40, s40, 1
    s_waitcnt vmcnt(0)
    v_cmp_eq_u32 vcc, v124, v80
    s_cbranch_scc1 L_back69
    s_cbranch_vccz L_back69
    s_sleep 8
    s_branch L_spin68_l
L_spin70:
    s_mov_b32 s40, 0x20000
L_spin70_l:
    buffer_load_dword v96, v6, s[16:19], s45 offen sc1
    s_sub_u32 s40, s40, 1
    s_waitcnt vmcnt(0)
    v_cmp_ne_u32 vcc, 0, v96
    s_cbranch_scc1 L_back71
    s_cbranch_vccz L_back71
    s_sleep 2
    s_branch L_spin70_l
L_spin72:
    s_mov_b32 s40, 0x20000
L_spin72_l:
    buffer_load_dword v96, v6, s[16:19], s45 offen sc1
    s_sub_u32 s40, s40, 1
    s_waitcnt vmcnt(0)
    v_cmp_ne_u32 vcc, 0, v96
    s_cbranch_scc1 L_back73
    s_cbranch_vccz L_back73
    s_sleep 2
    s_branch L_spin72_l
L_spin74:
    s_mov_b32 s40, 0x20000
L_spin74_l:
    buffer_load_dword v96, v6, s[16:19], s45 offen sc1
    s_sub_u32 s40, s40, 1
    s_waitcnt vmcnt(0)
    v_cmp_ne_u32 vcc, 0, v96
    s_cbranch_scc1 L_back75
    s_cbranch_vccz L_back75
    s_sleep 2
    s_branch L_spin74_l
L_code_end:
    s_endpgm
.section .rodata,"a"
.p2align 6
.amdhsa_kernel interleave_layers__sliding_local_dilated__dense_activation_squared_relu__prompt_kernel
  .amdhsa_next_free_vgpr 512
  .amdhsa_next_free_sgpr 102
  .amdhsa_accum_offset 256
  .amdhsa_group_segment_fixed_size 0
  .amdhsa_kernarg_size 88
  .amdhsa_user_sgpr_count 2
  .amdhsa_user_sgpr_kernarg_segment_ptr 1
  .amdhsa_system_sgpr_workgroup_id_x 1
.end_amdhsa_kernel
```

```asm
; @launch grid=(256,1,1) block=(256,1,1) lds=163840
.amdgcn_target "amdgcn-amd-amdhsa--gfx950"
.text
.globl interleave_layers__sliding_local_dilated__dense_activation_squared_relu__prompt_kernel
.p2align 8
.type interleave_layers__sliding_local_dilated__dense_activation_squared_relu__prompt_kernel,@function
interleave_layers__sliding_local_dilated__dense_activation_squared_relu__prompt_kernel:
    s_load_dwordx16 s[64:79], s[0:1], 0x0
    s_load_dwordx4 s[80:83], s[0:1], 0x40
    s_load_dwordx2 s[84:85], s[0:1], 0x50
    v_lshrrev_b32 v1, 6, v0
    s_cmp_ge_u32 s2, 256
    s_cbranch_scc1 L_code_end
    s_getpc_b64 s[20:21]
L_pc:
    s_mov_b32 s22, L_code_end-L_pc
    s_mov_b32 s23, 0x00020000
    v_lshlrev_b32 v7, 12, v0
    s_lshl_b32 s37, s2, 4
    buffer_load_dword v252, v7, s[20:23], s37 offen
    v_readfirstlane_b32 s32, v1
    v_and_b32 v0, 63, v0
    v_lshlrev_b32 v1, 4, v0
    s_getreg_b32 s3, hwreg(HW_REG_XCC_ID)
    s_xor_b32 s3, s3, s2
    s_and_b32 s3, s3, 1
    s_lshl2_add_u32 s37, s2, s32
    s_xor_b32 s2, s2, s3
    s_add_u32 s3, s3, 1
    s_cmp_eq_u32 s37, 514
    s_cbranch_scc0 L_dispatch
    s_waitcnt lgkmcnt(0)
    s_add_u32 s20, s82, 0xa0
    s_addc_u32 s21, s83, 0
    s_mov_b32 s22, 0x4
    s_mov_b32 s23, 0x00020000
    v_mov_b32 v2, s3
    buffer_store_dword v2, v1, s[20:23], 0 offen sc1
L_dispatch:
    s_bfe_u32 s47, s2, 0x20001
    s_and_b32 s37, s2, 0x81
    s_cmp_lg_u32 s37, 0
    s_cbranch_scc1 L_other
    s_bfe_u32 s33, s2, 0x20003
    s_lshr_b32 s34, s2, 5
    s_lshl2_add_u32 s34, s47, s34
    s_mov_b32 s35, s34
    s_movk_i32 s39, 6144
    s_lshl_b32 s54, s35, 7
    v_lshrrev_b32 v32, 3, v0
    v_lshlrev_b32 v33, 2, v0
    v_and_b32 v33, 64, v33
    v_and_b32 v34, 0x70, v1
    v_xor_b32 v33, v33, v34
    v_mad_u32_u24 v20, v32, s39, v33
    v_add_u32 v21, 49152, v20
    v_add_u32 v22, 2048, v20
    v_add_u32 v23, 51200, v20
    v_add_u32 v24, 4096, v20
    v_add_u32 v25, 53248, v20
    s_mul_i32 s38, s32, 98304
    s_add_u32 s54, s54, s38
    s_lshl_b32 s42, s32, 11
    s_lshr_b32 s51, s32, 1
    s_lshl_b32 s50, s33, 5
    s_add_u32 s53, s50, 31
    s_lshl_b32 s53, s53, 8
    s_add_u32 s53, s53, s51
    s_lshl_b32 s53, s53, 7
    s_add_u32 s50, s50, 30
    s_sub_u32 s50, s50, s51
    s_lshl_b32 s41, s50, 15
    s_lshl_b32 s43, s32, 10
    v_lshlrev_b32 v37, 1, v0
    v_and_b32 v37, 0x60, v37
    v_xor_b32 v37, v37, v34
    s_and_b32 s37, s32, 1
    s_lshl_b32 s37, s37, 14
    v_lshl_add_u32 v6, v32, 11, v37
    v_add_u32 v6, s37, v6
    s_waitcnt lgkmcnt(0)
    s_mov_b32 s12, s66
    s_mov_b32 s13, s67
    s_mov_b32 s14, 0x600000
    s_mov_b32 s15, 0x00020000
    s_mov_b32 s8, s64
    s_mov_b32 s9, s65
    s_mov_b32 s10, 0x400000
    s_mov_b32 s11, 0x00020000
    s_add_u32 m0, s43, 131072
    s_nop 0
    buffer_load_dwordx4 v6, s[8:11], s53 offen offset:0 sc1 lds
    s_add_u32 m0, s43, 98304
    s_nop 0
    buffer_load_dwordx4 v6, s[8:11], s41 offen offset:0 sc1 lds
    s_add_u32 m0, s42, 73728
    s_nop 0
    buffer_load_dwordx4 v20, s[12:15], s54 offen lds
    s_add_u32 m0, s42, 74752
    s_nop 0
    buffer_load_dwordx4 v21, s[12:15], s54 offen lds
    s_add_u32 m0, s42, 81920
    s_nop 0
    buffer_load_dwordx4 v22, s[12:15], s54 offen lds
    s_add_u32 m0, s42, 82944
    s_nop 0
    buffer_load_dwordx4 v23, s[12:15], s54 offen lds
    s_add_u32 m0, s42, 90112
    s_nop 0
    buffer_load_dwordx4 v24, s[12:15], s54 offen lds
    s_add_u32 m0, s42, 91136
    s_nop 0
    buffer_load_dwordx4 v25, s[12:15], s54 offen lds
    s_add_u32 s54, s54, 393216
    v_lshrrev_b32 v32, 4, v0
    v_bfe_u32 v33, v0, 2, 2
    v_lshl_add_u32 v32, v32, 3, v33
    v_lshlrev_b32 v32, 7, v32
    v_lshrrev_b32 v33, 1, v33
    v_lshl_add_u32 v32, v33, 6, v32
    v_and_b32 v33, 3, v0
    v_lshl_add_u32 v32, v33, 4, v32
    s_lshl_b32 s37, s51, 6
    s_and_b32 s38, s32, 1
    s_lshl_b32 s38, s38, 3
    s_add_u32 s37, s37, s38
    s_add_u32 s37, s37, 0
    v_xor_b32 v26, s37, v32
    s_lshl_b32 s37, s51, 6
    s_and_b32 s38, s32, 1
    s_lshl_b32 s38, s38, 3
    s_add_u32 s37, s37, s38
    s_add_u32 s37, s37, 8192
    v_xor_b32 v27, s37, v32
    s_lshl_b32 s37, s51, 6
    s_and_b32 s38, s32, 1
    s_lshl_b32 s38, s38, 3
    s_add_u32 s37, s37, s38
    s_add_u32 s37, s37, 16384
    v_xor_b32 v28, s37, v32
    v_mov_b32 v32, 0x3f803f80
    v_mov_b32 v33, 0x3f803f80
    v_mov_b32 v34, 0x3f803f80
    v_mov_b32 v35, 0x3f803f80
    v_and_b32 v36, 15, v0
    v_lshrrev_b32 v37, 4, v0
    v_and_b32 v38, 6, v36
    v_xor_b32 v38, v37, v38
    v_lshlrev_b32 v38, 4, v38
    v_lshl_add_u32 v2, v36, 7, v38
    v_xor_b32 v3, 64, v2
    v_add_u32 v4, 98304, v2
    v_add_u32 v5, 98304, v3
    s_add_u32 m0, s43, 102272
    s_nop 0
    buffer_load_dwordx4 v6, s[8:11], s41 offen offset:128 sc1 lds
    s_add_u32 m0, s42, 0
    s_nop 0
    buffer_load_dwordx4 v20, s[12:15], s54 offen lds
    s_add_u32 m0, s42, 1024
    s_nop 0
    buffer_load_dwordx4 v21, s[12:15], s54 offen lds
    s_add_u32 m0, s42, 8192
    s_nop 0
    buffer_load_dwordx4 v22, s[12:15], s54 offen lds
    s_add_u32 m0, s42, 9216
    s_nop 0
    buffer_load_dwordx4 v23, s[12:15], s54 offen lds
    s_add_u32 m0, s42, 16384
    s_nop 0
    buffer_load_dwordx4 v24, s[12:15], s54 offen lds
    s_add_u32 m0, s42, 17408
    s_nop 0
    buffer_load_dwordx4 v25, s[12:15], s54 offen lds
    s_add_u32 s54, s54, 393216
    s_add_u32 m0, s43, 134912
    s_nop 0
    buffer_load_dwordx4 v6, s[8:11], s53 offen offset:256 sc1 lds
    s_add_u32 m0, s43, 106240
    s_nop 0
    buffer_load_dwordx4 v6, s[8:11], s41 offen offset:256 sc1 lds
    s_add_u32 m0, s42, 24576
    s_nop 0
    buffer_load_dwordx4 v20, s[12:15], s54 offen lds
    s_add_u32 m0, s42, 25600
    s_nop 0
    buffer_load_dwordx4 v21, s[12:15], s54 offen lds
    s_add_u32 m0, s42, 32768
    s_nop 0
    buffer_load_dwordx4 v22, s[12:15], s54 offen lds
    s_add_u32 m0, s42, 33792
    s_nop 0
    buffer_load_dwordx4 v23, s[12:15], s54 offen lds
    s_add_u32 m0, s42, 40960
    s_nop 0
    buffer_load_dwordx4 v24, s[12:15], s54 offen lds
    s_add_u32 m0, s42, 41984
    s_nop 0
    buffer_load_dwordx4 v25, s[12:15], s54 offen lds
    s_add_u32 s54, s54, 393216
    s_mov_b32 s36, -1
    v_add_u32 v29, 73728, v26
    v_add_u32 v30, 73728, v27
    v_add_u32 v31, 73728, v28
    s_waitcnt vmcnt(15) lgkmcnt(0)
    s_barrier
    ds_read_b128 v[68:71], v4 offset:0
    s_add_u32 m0, s43, 110208
    ds_read_b128 v[72:75], v4 offset:2048
    buffer_load_dwordx4 v6, s[8:11], s41 offen offset:384 sc1 lds
    ds_read_b128 v[76:79], v4 offset:32768
    s_add_u32 m0, s42, 49152
    ds_read_b64_tr_b16 a[0:1], v29 offset:0
    buffer_load_dwordx4 v20, s[12:15], s54 offen lds
    ds_read_b64_tr_b16 a[2:3], v29 offset:512
    s_add_u32 m0, s42, 50176
    ds_read_b64_tr_b16 a[4:5], v30 offset:0
    buffer_load_dwordx4 v21, s[12:15], s54 offen lds
    ds_read_b64_tr_b16 a[6:7], v30 offset:512
    s_add_u32 m0, s42, 57344
    ds_read_b64_tr_b16 a[8:9], v31 offset:0
    buffer_load_dwordx4 v22, s[12:15], s54 offen lds
    ds_read_b64_tr_b16 a[10:11], v31 offset:512
    s_waitcnt lgkmcnt(4)
    v_mfma_f32_16x16x32_bf16 v[44:47], a[0:3], v[68:71], 0
    s_add_u32 m0, s42, 58368
    ds_read_b128 v[80:83], v5 offset:0
    v_mfma_f32_16x16x32_bf16 v[48:51], a[0:3], v[72:75], 0
    ds_read_b128 v[84:87], v5 offset:2048
    v_mfma_f32_16x16x32_bf16 v[92:95], a[0:3], v[76:79], 0
    ds_read_b128 v[88:91], v5 offset:32768
    s_waitcnt lgkmcnt(5)
    v_mfma_f32_16x16x32_bf16 v[52:55], a[4:7], v[68:71], 0
    ds_read_b64_tr_b16 a[12:13], v29 offset:4096
    v_mfma_f32_16x16x32_bf16 v[56:59], a[4:7], v[72:75], 0
    ds_read_b64_tr_b16 a[14:15], v29 offset:4608
    v_mfma_f32_16x16x32_bf16 v[96:99], a[4:7], v[76:79], 0
    ds_read_b64_tr_b16 a[16:17], v30 offset:4096
    s_waitcnt lgkmcnt(6)
    v_mfma_f32_16x16x32_bf16 v[60:63], a[8:11], v[68:71], 0
    ds_read_b64_tr_b16 a[18:19], v30 offset:4608
    v_mfma_f32_16x16x32_bf16 v[64:67], a[8:11], v[72:75], 0
    ds_read_b64_tr_b16 a[20:21], v31 offset:4096
    v_mfma_f32_16x16x32_bf16 v[118:121], a[8:11], v[76:79], 0
    ds_read_b64_tr_b16 a[22:23], v31 offset:4608
    v_mfma_f32_16x16x32_bf16 v[100:103], a[0:3], v[32:35], 0
    buffer_load_dwordx4 v23, s[12:15], s54 offen lds
    v_mfma_f32_16x16x32_bf16 v[104:107], a[4:7], v[32:35], 0
    s_add_u32 m0, s42, 65536
    s_nop 0
    buffer_load_dwordx4 v24, s[12:15], s54 offen lds
    v_mfma_f32_16x16x32_bf16 v[108:111], a[8:11], v[32:35], 0
    s_add_u32 m0, s42, 66560
    s_nop 0
    buffer_load_dwordx4 v25, s[12:15], s54 offen lds
    s_add_u32 s54, s54, 393216
    s_mov_b32 s16, s84
    s_mov_b32 s17, s85
    s_mov_b32 s18, 0x5e00000
    s_mov_b32 s19, 0x00020000
    v_min_u32 v124, 1, v0
    v_lshlrev_b32 v124, 30, v124
    s_lshl_b32 s91, s33, 6
    s_add_u32 s91, s91, s34
    s_lshl_b32 s91, s91, 7
    s_add_u32 s91, s91, 0x5520000
    s_cmp_eq_u32 s32, 1
    s_cselect_b32 s91, s91, 0x5f00000
    s_add_u32 s88, s84, 0x5000000
    s_addc_u32 s89, s85, 0
    s_mov_b32 s97, 14
    s_and_b32 s38, s32, 1
    v_lshlrev_b32 v40, 1, v0
    v_and_b32 v40, 0x30, v40
    v_xor_b32 v40, v40, v1
    s_mul_i32 s37, s51, 3072
    s_add_u32 s37, s37, 65536
    s_lshl_b32 s39, s38, 3
    s_add_u32 s39, s39, s37
    v_add_u32 v7, s39, v40
    v_bfe_u32 v38, v0, 1, 2
    v_xor_b32 v38, v38, v37
    s_waitcnt vmcnt(15) lgkmcnt(0)
    s_barrier
    v_mfma_f32_16x16x32_bf16 v[44:47], a[12:15], v[80:83], v[44:47]
    s_add_u32 m0, s43, 138752
    ds_read_b128 v[68:71], v4 offset:4096
    ds_read_b128 v[72:75], v4 offset:6144
    v_mfma_f32_16x16x32_bf16 v[48:51], a[12:15], v[84:87], v[48:51]
    ds_read_b128 v[76:79], v4 offset:34816
    ds_read_b64_tr_b16 a[24:25], v26 offset:0
    v_mfma_f32_16x16x32_bf16 v[92:95], a[12:15], v[88:91], v[92:95]
    buffer_load_dwordx4 v6, s[8:11], s53 offen offset:512 sc1 lds
    v_mfma_f32_16x16x32_bf16 v[52:55], a[16:19], v[80:83], v[52:55]
    s_add_u32 m0, s43, 114176
    ds_read_b64_tr_b16 a[26:27], v26 offset:512
    v_mfma_f32_16x16x32_bf16 v[56:59], a[16:19], v[84:87], v[56:59]
    buffer_load_dwordx4 v6, s[8:11], s41 offen offset:512 sc1 lds
    v_mfma_f32_16x16x32_bf16 v[96:99], a[16:19], v[88:91], v[96:99]
    s_add_u32 m0, s42, 73728
    ds_read_b64_tr_b16 a[28:29], v27 offset:0
    v_mfma_f32_16x16x32_bf16 v[60:63], a[20:23], v[80:83], v[60:63]
    ds_read_b64_tr_b16 a[30:31], v27 offset:512
    v_mfma_f32_16x16x32_bf16 v[64:67], a[20:23], v[84:87], v[64:67]
    buffer_load_dwordx4 v20, s[12:15], s54 offen lds
    v_mfma_f32_16x16x32_bf16 v[118:121], a[20:23], v[88:91], v[118:121]
    s_add_u32 m0, s42, 74752
    ds_read_b64_tr_b16 a[32:33], v28 offset:0
    v_mfma_f32_16x16x32_bf16 v[100:103], a[12:15], v[32:35], v[100:103]
    buffer_load_dwordx4 v21, s[12:15], s54 offen lds
    v_mfma_f32_16x16x32_bf16 v[104:107], a[16:19], v[32:35], v[104:107]
    s_add_u32 m0, s42, 81920
    ds_read_b64_tr_b16 a[34:35], v28 offset:512
    v_mfma_f32_16x16x32_bf16 v[108:111], a[20:23], v[32:35], v[108:111]
    buffer_load_dwordx4 v22, s[12:15], s54 offen lds
    s_waitcnt lgkmcnt(4)
    v_mfma_f32_16x16x32_bf16 v[44:47], a[24:27], v[68:71], v[44:47]
    s_add_u32 m0, s42, 82944
    ds_read_b128 v[80:83], v5 offset:4096
    v_mfma_f32_16x16x32_bf16 v[48:51], a[24:27], v[72:75], v[48:51]
    ds_read_b128 v[84:87], v5 offset:6144
    v_mfma_f32_16x16x32_bf16 v[92:95], a[24:27], v[76:79], v[92:95]
    ds_read_b128 v[88:91], v5 offset:34816
    s_waitcnt lgkmcnt(5)
    v_mfma_f32_16x16x32_bf16 v[52:55], a[28:31], v[68:71], v[52:55]
    ds_read_b64_tr_b16 a[36:37], v26 offset:4096
    v_mfma_f32_16x16x32_bf16 v[56:59], a[28:31], v[72:75], v[56:59]
    ds_read_b64_tr_b16 a[38:39], v26 offset:4608
    v_mfma_f32_16x16x32_bf16 v[96:99], a[28:31], v[76:79], v[96:99]
    ds_read_b64_tr_b16 a[40:41], v27 offset:4096
    s_waitcnt lgkmcnt(6)
    v_mfma_f32_16x16x32_bf16 v[60:63], a[32:35], v[68:71], v[60:63]
    ds_read_b64_tr_b16 a[42:43], v27 offset:4608
    v_mfma_f32_16x16x32_bf16 v[64:67], a[32:35], v[72:75], v[64:67]
    ds_read_b64_tr_b16 a[44:45], v28 offset:4096
    v_mfma_f32_16x16x32_bf16 v[118:121], a[32:35], v[76:79], v[118:121]
    ds_read_b64_tr_b16 a[46:47], v28 offset:4608
    v_mfma_f32_16x16x32_bf16 v[100:103], a[24:27], v[32:35], v[100:103]
    buffer_load_dwordx4 v23, s[12:15], s54 offen lds
    v_mfma_f32_16x16x32_bf16 v[104:107], a[28:31], v[32:35], v[104:107]
    s_add_u32 m0, s42, 90112
    s_nop 0
    buffer_load_dwordx4 v24, s[12:15], s54 offen lds
    v_mfma_f32_16x16x32_bf16 v[108:111], a[32:35], v[32:35], v[108:111]
    s_add_u32 m0, s42, 91136
    s_nop 0
    buffer_load_dwordx4 v25, s[12:15], s54 offen lds
    s_add_u32 s54, s54, 393216
    v_lshlrev_b32 v38, 4, v38
    v_lshl_add_u32 v38, v36, 6, v38
    v_add_u32 v8, s39, v38
    s_mul_i32 s39, s38, 6144
    s_add_u32 s39, s39, s37
    v_add_u32 v9, s39, v40
    s_cmp_eq_u32 s38, 0
    s_cselect_b32 s39, 18432, 0
    s_add_u32 s39, s39, s37
    v_add_u32 v10, s39, v40
    s_sub_u32 s39, s33, 1
    s_max_i32 s39, s39, 0
    v_mov_b32 v38, s33
    v_mov_b32 v39, s39
    v_mov_b32 v12, 1048576
    v_mov_b32 v41, 131072
    v_cmp_lt_u32 vcc, 15, v0
    s_nop 1
    v_cndmask_b32 v38, v38, v39, vcc
    v_cndmask_b32 v12, v12, v41, vcc
    v_lshl_add_u32 v38, v38, 6, v36
    v_add_u32 v38, 697644, v38
    v_lshlrev_b32 v11, 7, v38
    s_cmp_eq_u32 s32, 0
    s_cselect_b32 s37, 32, 0
    v_cmp_le_u32 vcc, s37, v0
    s_nop 1
    v_cndmask_b32 v11, v11, 2.0, vcc
    s_waitcnt vmcnt(15) lgkmcnt(0)
    s_barrier
    v_mfma_f32_16x16x32_bf16 v[44:47], a[36:39], v[80:83], v[44:47]
    s_add_u32 m0, s43, 118144
    ds_read_b128 v[68:71], v4 offset:8192
    ds_read_b128 v[72:75], v4 offset:10240
    v_mfma_f32_16x16x32_bf16 v[48:51], a[36:39], v[84:87], v[48:51]
    ds_read_b128 v[76:79], v4 offset:36864
    v_mfma_f32_16x16x32_bf16 v[92:95], a[36:39], v[88:91], v[92:95]
    buffer_load_dwordx4 v6, s[8:11], s41 offen offset:640 sc1 lds
    v_mfma_f32_16x16x32_bf16 v[52:55], a[40:43], v[80:83], v[52:55]
    s_add_u32 m0, s42, 0
    ds_read_b64_tr_b16 a[48:49], v26 offset:24576
    v_mfma_f32_16x16x32_bf16 v[56:59], a[40:43], v[84:87], v[56:59]
    buffer_load_dwordx4 v20, s[12:15], s54 offen lds
    v_mfma_f32_16x16x32_bf16 v[96:99], a[40:43], v[88:91], v[96:99]
    s_add_u32 m0, s42, 1024
    ds_read_b64_tr_b16 a[50:51], v26 offset:25088
    v_mfma_f32_16x16x32_bf16 v[60:63], a[44:47], v[80:83], v[60:63]
    ds_read_b64_tr_b16 a[52:53], v27 offset:24576
    v_mfma_f32_16x16x32_bf16 v[64:67], a[44:47], v[84:87], v[64:67]
    buffer_load_dwordx4 v21, s[12:15], s54 offen lds
    v_mfma_f32_16x16x32_bf16 v[118:121], a[44:47], v[88:91], v[118:121]
    s_add_u32 m0, s42, 8192
    ds_read_b64_tr_b16 a[54:55], v27 offset:25088
    v_mfma_f32_16x16x32_bf16 v[100:103], a[36:39], v[32:35], v[100:103]
    buffer_load_dwordx4 v22, s[12:15], s54 offen lds
    v_mfma_f32_16x16x32_bf16 v[104:107], a[40:43], v[32:35], v[104:107]
    ds_read_b64_tr_b16 a[56:57], v28 offset:24576
    v_mfma_f32_16x16x32_bf16 v[108:111], a[44:47], v[32:35], v[108:111]
    ds_read_b64_tr_b16 a[58:59], v28 offset:25088
    s_waitcnt lgkmcnt(4)
    v_mfma_f32_16x16x32_bf16 v[44:47], a[48:51], v[68:71], v[44:47]
    s_add_u32 m0, s42, 9216
    ds_read_b128 v[80:83], v5 offset:8192
    v_mfma_f32_16x16x32_bf16 v[48:51], a[48:51], v[72:75], v[48:51]
    ds_read_b128 v[84:87], v5 offset:10240
    v_mfma_f32_16x16x32_bf16 v[92:95], a[48:51], v[76:79], v[92:95]
    ds_read_b128 v[88:91], v5 offset:36864
    s_waitcnt lgkmcnt(5)
    v_mfma_f32_16x16x32_bf16 v[52:55], a[52:55], v[68:71], v[52:55]
    ds_read_b64_tr_b16 a[60:61], v26 offset:28672
    v_mfma_f32_16x16x32_bf16 v[56:59], a[52:55], v[72:75], v[56:59]
    ds_read_b64_tr_b16 a[62:63], v26 offset:29184
    v_mfma_f32_16x16x32_bf16 v[96:99], a[52:55], v[76:79], v[96:99]
    ds_read_b64_tr_b16 a[64:65], v27 offset:28672
    s_waitcnt lgkmcnt(6)
    v_mfma_f32_16x16x32_bf16 v[60:63], a[56:59], v[68:71], v[60:63]
    ds_read_b64_tr_b16 a[66:67], v27 offset:29184
    v_mfma_f32_16x16x32_bf16 v[64:67], a[56:59], v[72:75], v[64:67]
    ds_read_b64_tr_b16 a[68:69], v28 offset:28672
    v_mfma_f32_16x16x32_bf16 v[118:121], a[56:59], v[76:79], v[118:121]
    ds_read_b64_tr_b16 a[70:71], v28 offset:29184
    v_mfma_f32_16x16x32_bf16 v[100:103], a[48:51], v[32:35], v[100:103]
    buffer_load_dwordx4 v23, s[12:15], s54 offen lds
    v_mfma_f32_16x16x32_bf16 v[104:107], a[52:55], v[32:35], v[104:107]
    s_add_u32 m0, s42, 16384
    s_nop 0
    buffer_load_dwordx4 v24, s[12:15], s54 offen lds
    v_mfma_f32_16x16x32_bf16 v[108:111], a[56:59], v[32:35], v[108:111]
    s_add_u32 m0, s42, 17408
    s_nop 0
    buffer_load_dwordx4 v25, s[12:15], s54 offen lds
    s_add_u32 s54, s54, 393216
    s_mov_b32 s45, -786432
    v_and_b32 v13, 15, v0
    v_lshlrev_b32 v13, 3, v13
    v_lshrrev_b32 v38, 5, v0
    v_lshl_add_u32 v13, v38, 9, v13
    v_and_b32 v38, 16, v0
    v_lshl_add_u32 v13, v38, 6, v13
    v_add_u32 v13, 90112, v13
    s_lshl_b32 s52, s51, 10
    s_or_b32 s96, s50, 31
    s_mov_b32 s55, 0x541fc00
    s_lshl_b32 s46, s50, 10
    s_sub_u32 s46, s55, s46
    s_mov_b32 s56, 0xaaaaaaaa
    s_mov_b32 s57, 0xaaaaaaaa
    s_mov_b32 s58, 0xfff0ffff
    s_mov_b32 s59, 0xf000ff00
    s_mov_b32 s60, 0xffc0fffc
    s_mov_b32 s61, 0xc000fc00
    s_mov_b32 s86, 0x3e8293ee
    v_mov_b32 v38, 0x0c0c0c0c
    v_mov_b32 v36, 0xc0c0100
    v_mov_b32 v37, 0x1000c0c
    v_cndmask_b32 v36, v36, v37, s[56:57]
    v_cndmask_b32 v14, v36, v38, s[58:59]
    v_cndmask_b32 v16, v38, v36, s[58:59]
    s_waitcnt vmcnt(15) lgkmcnt(0)
    s_barrier
    v_mfma_f32_16x16x32_bf16 v[44:47], a[60:63], v[80:83], v[44:47]
    s_add_u32 m0, s43, 142592
    ds_read_b128 v[68:71], v4 offset:12288
    ds_read_b128 v[72:75], v4 offset:14336
    v_mfma_f32_16x16x32_bf16 v[48:51], a[60:63], v[84:87], v[48:51]
    ds_read_b128 v[76:79], v4 offset:38912
    ds_read_b64_tr_b16 a[72:73], v26 offset:49152
    v_mfma_f32_16x16x32_bf16 v[92:95], a[60:63], v[88:91], v[92:95]
    buffer_load_dwordx4 v6, s[8:11], s53 offen offset:768 sc1 lds
    v_mfma_f32_16x16x32_bf16 v[52:55], a[64:67], v[80:83], v[52:55]
    s_add_u32 m0, s43, 122112
    ds_read_b64_tr_b16 a[74:75], v26 offset:49664
    v_mfma_f32_16x16x32_bf16 v[56:59], a[64:67], v[84:87], v[56:59]
    buffer_load_dwordx4 v6, s[8:11], s41 offen offset:768 sc1 lds
    v_mfma_f32_16x16x32_bf16 v[96:99], a[64:67], v[88:91], v[96:99]
    s_add_u32 m0, s42, 24576
    ds_read_b64_tr_b16 a[76:77], v27 offset:49152
    v_mfma_f32_16x16x32_bf16 v[60:63], a[68:71], v[80:83], v[60:63]
    ds_read_b64_tr_b16 a[78:79], v27 offset:49664
    v_mfma_f32_16x16x32_bf16 v[64:67], a[68:71], v[84:87], v[64:67]
    buffer_load_dwordx4 v20, s[12:15], s54 offen lds
    v_mfma_f32_16x16x32_bf16 v[118:121], a[68:71], v[88:91], v[118:121]
    s_add_u32 m0, s42, 25600
    ds_read_b64_tr_b16 a[80:81], v28 offset:49152
    v_mfma_f32_16x16x32_bf16 v[100:103], a[60:63], v[32:35], v[100:103]
    buffer_load_dwordx4 v21, s[12:15], s54 offen lds
    v_mfma_f32_16x16x32_bf16 v[104:107], a[64:67], v[32:35], v[104:107]
    s_add_u32 m0, s42, 32768
    ds_read_b64_tr_b16 a[82:83], v28 offset:49664
    v_mfma_f32_16x16x32_bf16 v[108:111], a[68:71], v[32:35], v[108:111]
    buffer_load_dwordx4 v22, s[12:15], s54 offen lds
    s_waitcnt lgkmcnt(4)
    v_mfma_f32_16x16x32_bf16 v[44:47], a[72:75], v[68:71], v[44:47]
    s_add_u32 m0, s42, 33792
    ds_read_b128 v[80:83], v5 offset:12288
    v_mfma_f32_16x16x32_bf16 v[48:51], a[72:75], v[72:75], v[48:51]
    ds_read_b128 v[84:87], v5 offset:14336
    v_mfma_f32_16x16x32_bf16 v[92:95], a[72:75], v[76:79], v[92:95]
    ds_read_b128 v[88:91], v5 offset:38912
    s_waitcnt lgkmcnt(5)
    v_mfma_f32_16x16x32_bf16 v[52:55], a[76:79], v[68:71], v[52:55]
    ds_read_b64_tr_b16 a[84:85], v26 offset:53248
    v_mfma_f32_16x16x32_bf16 v[56:59], a[76:79], v[72:75], v[56:59]
    ds_read_b64_tr_b16 a[86:87], v26 offset:53760
    v_mfma_f32_16x16x32_bf16 v[96:99], a[76:79], v[76:79], v[96:99]
    ds_read_b64_tr_b16 a[88:89], v27 offset:53248
    s_waitcnt lgkmcnt(6)
    v_mfma_f32_16x16x32_bf16 v[60:63], a[80:83], v[68:71], v[60:63]
    ds_read_b64_tr_b16 a[90:91], v27 offset:53760
    v_mfma_f32_16x16x32_bf16 v[64:67], a[80:83], v[72:75], v[64:67]
    ds_read_b64_tr_b16 a[92:93], v28 offset:53248
    v_mfma_f32_16x16x32_bf16 v[118:121], a[80:83], v[76:79], v[118:121]
    ds_read_b64_tr_b16 a[94:95], v28 offset:53760
    v_mfma_f32_16x16x32_bf16 v[100:103], a[72:75], v[32:35], v[100:103]
    buffer_load_dwordx4 v23, s[12:15], s54 offen lds
    v_mfma_f32_16x16x32_bf16 v[104:107], a[76:79], v[32:35], v[104:107]
    s_add_u32 m0, s42, 40960
    s_nop 0
    buffer_load_dwordx4 v24, s[12:15], s54 offen lds
    v_mfma_f32_16x16x32_bf16 v[108:111], a[80:83], v[32:35], v[108:111]
    s_add_u32 m0, s42, 41984
    s_nop 0
    buffer_load_dwordx4 v25, s[12:15], s54 offen lds
    s_add_u32 s54, s54, 393216
    v_mov_b32 v36, 0xc0c0302
    v_mov_b32 v37, 0x3020c0c
    v_cndmask_b32 v36, v36, v37, s[56:57]
    v_cndmask_b32 v15, v36, v38, s[60:61]
    v_cndmask_b32 v17, v38, v36, s[60:61]
    v_mov_b32 v18, 0xff800000
    s_mul_i32 s90, s33, 2097152
    s_add_u32 s90, s90, 0xffff0000
    s_lshl_b32 s37, s35, 1
    s_add_u32 s37, s37, s51
    s_lshl_b32 s37, s37, 11
    s_add_u32 s90, s90, s37
    s_mul_i32 s37, s38, 1024
    s_add_u32 s90, s90, s37
    s_mov_b32 s87, -1024
    s_mov_b32 s24, 0xfffeffff
    s_mov_b32 s25, -1
    s_lshl_b32 s26, s38, 15
    s_mov_b32 s27, s38
    s_add_u32 s87, s87, 1024
    s_cmp_eq_u32 s33, 0
    s_cselect_b64 s[26:27], s[26:27], 0
    s_add_u32 s20, s82, 0x80
    s_addc_u32 s21, s83, 0
    s_mov_b32 s22, 0x80
    s_mov_b32 s23, 0x00020000
    v_lshl_add_u32 v36, s32, 7, v124
    v_mov_b32 v116, v36
    s_waitcnt vmcnt(15) lgkmcnt(0)
    s_barrier
    v_mfma_f32_16x16x32_bf16 v[44:47], a[84:87], v[80:83], v[44:47]
    s_add_u32 m0, s43, 126080
    ds_read_b128 v[68:71], v4 offset:16384
    ds_read_b128 v[72:75], v4 offset:18432
    v_mfma_f32_16x16x32_bf16 v[48:51], a[84:87], v[84:87], v[48:51]
    ds_read_b128 v[76:79], v4 offset:40960
    v_mfma_f32_16x16x32_bf16 v[92:95], a[84:87], v[88:91], v[92:95]
    buffer_load_dwordx4 v6, s[8:11], s41 offen offset:896 sc1 lds
    v_mfma_f32_16x16x32_bf16 v[52:55], a[88:91], v[80:83], v[52:55]
    s_add_u32 m0, s42, 49152
    ds_read_b64_tr_b16 a[96:97], v29 offset:0
    v_mfma_f32_16x16x32_bf16 v[56:59], a[88:91], v[84:87], v[56:59]
    buffer_load_dwordx4 v20, s[12:15], s54 offen lds
    v_mfma_f32_16x16x32_bf16 v[96:99], a[88:91], v[88:91], v[96:99]
    s_add_u32 m0, s42, 50176
    ds_read_b64_tr_b16 a[98:99], v29 offset:512
    v_mfma_f32_16x16x32_bf16 v[60:63], a[92:95], v[80:83], v[60:63]
    ds_read_b64_tr_b16 a[100:101], v30 offset:0
    v_mfma_f32_16x16x32_bf16 v[64:67], a[92:95], v[84:87], v[64:67]
    buffer_load_dwordx4 v21, s[12:15], s54 offen lds
    v_mfma_f32_16x16x32_bf16 v[118:121], a[92:95], v[88:91], v[118:121]
    s_add_u32 m0, s42, 57344
    ds_read_b64_tr_b16 a[102:103], v30 offset:512
    v_mfma_f32_16x16x32_bf16 v[100:103], a[84:87], v[32:35], v[100:103]
    buffer_load_dwordx4 v22, s[12:15], s54 offen lds
    v_mfma_f32_16x16x32_bf16 v[104:107], a[88:91], v[32:35], v[104:107]
    ds_read_b64_tr_b16 a[104:105], v31 offset:0
    v_mfma_f32_16x16x32_bf16 v[108:111], a[92:95], v[32:35], v[108:111]
    ds_read_b64_tr_b16 a[106:107], v31 offset:512
    s_waitcnt lgkmcnt(4)
    v_mfma_f32_16x16x32_bf16 v[44:47], a[96:99], v[68:71], v[44:47]
    s_add_u32 m0, s42, 58368
    ds_read_b128 v[80:83], v5 offset:16384
    v_mfma_f32_16x16x32_bf16 v[48:51], a[96:99], v[72:75], v[48:51]
    ds_read_b128 v[84:87], v5 offset:18432
    v_mfma_f32_16x16x32_bf16 v[92:95], a[96:99], v[76:79], v[92:95]
    ds_read_b128 v[88:91], v5 offset:40960
    s_waitcnt lgkmcnt(5)
    v_mfma_f32_16x16x32_bf16 v[52:55], a[100:103], v[68:71], v[52:55]
    ds_read_b64_tr_b16 a[108:109], v29 offset:4096
    v_mfma_f32_16x16x32_bf16 v[56:59], a[100:103], v[72:75], v[56:59]
    ds_read_b64_tr_b16 a[110:111], v29 offset:4608
    v_mfma_f32_16x16x32_bf16 v[96:99], a[100:103], v[76:79], v[96:99]
    ds_read_b64_tr_b16 a[112:113], v30 offset:4096
    s_waitcnt lgkmcnt(6)
    v_mfma_f32_16x16x32_bf16 v[60:63], a[104:107], v[68:71], v[60:63]
    ds_read_b64_tr_b16 a[114:115], v30 offset:4608
    v_mfma_f32_16x16x32_bf16 v[64:67], a[104:107], v[72:75], v[64:67]
    ds_read_b64_tr_b16 a[116:117], v31 offset:4096
    v_mfma_f32_16x16x32_bf16 v[118:121], a[104:107], v[76:79], v[118:121]
    ds_read_b64_tr_b16 a[118:119], v31 offset:4608
    v_mfma_f32_16x16x32_bf16 v[100:103], a[96:99], v[32:35], v[100:103]
    buffer_load_dwordx4 v23, s[12:15], s54 offen lds
    v_mfma_f32_16x16x32_bf16 v[104:107], a[100:103], v[32:35], v[104:107]
    s_add_u32 m0, s42, 65536
    s_nop 0
    buffer_load_dwordx4 v24, s[12:15], s54 offen lds
    v_mfma_f32_16x16x32_bf16 v[108:111], a[104:107], v[32:35], v[108:111]
    s_add_u32 m0, s42, 66560
    s_nop 0
    buffer_load_dwordx4 v25, s[12:15], s54 offen lds
    s_add_u32 s54, s54, 393216
    s_waitcnt vmcnt(15) lgkmcnt(0)
    s_barrier
    v_mfma_f32_16x16x32_bf16 v[44:47], a[108:111], v[80:83], v[44:47]
    s_add_u32 m0, s43, 146432
    ds_read_b128 v[68:71], v4 offset:20480
    ds_read_b128 v[72:75], v4 offset:22528
    v_mfma_f32_16x16x32_bf16 v[48:51], a[108:111], v[84:87], v[48:51]
    ds_read_b128 v[76:79], v4 offset:43008
    ds_read_b64_tr_b16 a[120:121], v26 offset:0
    v_mfma_f32_16x16x32_bf16 v[92:95], a[108:111], v[88:91], v[92:95]
    buffer_load_dwordx4 v6, s[8:11], s53 offen offset:1024 sc1 lds
    v_mfma_f32_16x16x32_bf16 v[52:55], a[112:115], v[80:83], v[52:55]
    s_add_u32 m0, s43, 97280
    ds_read_b64_tr_b16 a[122:123], v26 offset:512
    v_mfma_f32_16x16x32_bf16 v[56:59], a[112:115], v[84:87], v[56:59]
    buffer_load_dwordx4 v6, s[8:11], s41 offen offset:1024 sc1 lds
    v_mfma_f32_16x16x32_bf16 v[96:99], a[112:115], v[88:91], v[96:99]
    s_add_u32 m0, s42, 73728
    ds_read_b64_tr_b16 a[124:125], v27 offset:0
    v_mfma_f32_16x16x32_bf16 v[60:63], a[116:119], v[80:83], v[60:63]
    ds_read_b64_tr_b16 a[126:127], v27 offset:512
    v_mfma_f32_16x16x32_bf16 v[64:67], a[116:119], v[84:87], v[64:67]
    buffer_load_dwordx4 v20, s[12:15], s54 offen lds
    v_mfma_f32_16x16x32_bf16 v[118:121], a[116:119], v[88:91], v[118:121]
    s_add_u32 m0, s42, 74752
    ds_read_b64_tr_b16 a[128:129], v28 offset:0
    v_mfma_f32_16x16x32_bf16 v[100:103], a[108:111], v[32:35], v[100:103]
    buffer_load_dwordx4 v21, s[12:15], s54 offen lds
    v_mfma_f32_16x16x32_bf16 v[104:107], a[112:115], v[32:35], v[104:107]
    s_add_u32 m0, s42, 81920
    ds_read_b64_tr_b16 a[130:131], v28 offset:512
    v_mfma_f32_16x16x32_bf16 v[108:111], a[116:119], v[32:35], v[108:111]
    buffer_load_dwordx4 v22, s[12:15], s54 offen lds
    s_waitcnt lgkmcnt(4)
    v_mfma_f32_16x16x32_bf16 v[44:47], a[120:123], v[68:71], v[44:47]
    s_add_u32 m0, s42, 82944
    ds_read_b128 v[80:83], v5 offset:20480
    v_mfma_f32_16x16x32_bf16 v[48:51], a[120:123], v[72:75], v[48:51]
    ds_read_b128 v[84:87], v5 offset:22528
    v_mfma_f32_16x16x32_bf16 v[92:95], a[120:123], v[76:79], v[92:95]
    ds_read_b128 v[88:91], v5 offset:43008
    s_waitcnt lgkmcnt(5)
    v_mfma_f32_16x16x32_bf16 v[52:55], a[124:127], v[68:71], v[52:55]
    ds_read_b64_tr_b16 a[132:133], v26 offset:4096
    v_mfma_f32_16x16x32_bf16 v[56:59], a[124:127], v[72:75], v[56:59]
    ds_read_b64_tr_b16 a[134:135], v26 offset:4608
    v_mfma_f32_16x16x32_bf16 v[96:99], a[124:127], v[76:79], v[96:99]
    ds_read_b64_tr_b16 a[136:137], v27 offset:4096
    s_waitcnt lgkmcnt(6)
    v_mfma_f32_16x16x32_bf16 v[60:63], a[128:131], v[68:71], v[60:63]
    ds_read_b64_tr_b16 a[138:139], v27 offset:4608
    v_mfma_f32_16x16x32_bf16 v[64:67], a[128:131], v[72:75], v[64:67]
    ds_read_b64_tr_b16 a[140:141], v28 offset:4096
    v_mfma_f32_16x16x32_bf16 v[118:121], a[128:131], v[76:79], v[118:121]
    ds_read_b64_tr_b16 a[142:143], v28 offset:4608
    v_mfma_f32_16x16x32_bf16 v[100:103], a[120:123], v[32:35], v[100:103]
    buffer_load_dwordx4 v23, s[12:15], s54 offen lds
    v_mfma_f32_16x16x32_bf16 v[104:107], a[124:127], v[32:35], v[104:107]
    s_add_u32 m0, s42, 90112
    s_nop 0
    buffer_load_dwordx4 v24, s[12:15], s54 offen lds
    v_mfma_f32_16x16x32_bf16 v[108:111], a[128:131], v[32:35], v[108:111]
    s_add_u32 m0, s42, 91136
    s_nop 0
    buffer_load_dwordx4 v25, s[12:15], s54 offen lds
    s_add_u32 s54, s54, 393216
    s_waitcnt vmcnt(15) lgkmcnt(0)
    s_barrier
    v_mfma_f32_16x16x32_bf16 v[44:47], a[132:135], v[80:83], v[44:47]
    s_add_u32 m0, s43, 101248
    ds_read_b128 v[68:71], v4 offset:24576
    ds_read_b128 v[72:75], v4 offset:26624
    v_mfma_f32_16x16x32_bf16 v[48:51], a[132:135], v[84:87], v[48:51]
    ds_read_b128 v[76:79], v4 offset:45056
    v_mfma_f32_16x16x32_bf16 v[92:95], a[132:135], v[88:91], v[92:95]
    buffer_load_dwordx4 v6, s[8:11], s41 offen offset:1152 sc1 lds
    v_mfma_f32_16x16x32_bf16 v[52:55], a[136:139], v[80:83], v[52:55]
    s_add_u32 m0, s42, 0
    ds_read_b64_tr_b16 a[144:145], v26 offset:24576
    v_mfma_f32_16x16x32_bf16 v[56:59], a[136:139], v[84:87], v[56:59]
    buffer_load_dwordx4 v20, s[12:15], s54 offen lds
    v_mfma_f32_16x16x32_bf16 v[96:99], a[136:139], v[88:91], v[96:99]
    s_add_u32 m0, s42, 1024
    ds_read_b64_tr_b16 a[146:147], v26 offset:25088
    v_mfma_f32_16x16x32_bf16 v[60:63], a[140:143], v[80:83], v[60:63]
    ds_read_b64_tr_b16 a[148:149], v27 offset:24576
    v_mfma_f32_16x16x32_bf16 v[64:67], a[140:143], v[84:87], v[64:67]
    buffer_load_dwordx4 v21, s[12:15], s54 offen lds
    v_mfma_f32_16x16x32_bf16 v[118:121], a[140:143], v[88:91], v[118:121]
    s_add_u32 m0, s42, 8192
    ds_read_b64_tr_b16 a[150:151], v27 offset:25088
    v_mfma_f32_16x16x32_bf16 v[100:103], a[132:135], v[32:35], v[100:103]
    buffer_load_dwordx4 v22, s[12:15], s54 offen lds
    v_mfma_f32_16x16x32_bf16 v[104:107], a[136:139], v[32:35], v[104:107]
    ds_read_b64_tr_b16 a[152:153], v28 offset:24576
    v_mfma_f32_16x16x32_bf16 v[108:111], a[140:143], v[32:35], v[108:111]
    ds_read_b64_tr_b16 a[154:155], v28 offset:25088
    s_waitcnt lgkmcnt(4)
    v_mfma_f32_16x16x32_bf16 v[44:47], a[144:147], v[68:71], v[44:47]
    s_add_u32 m0, s42, 9216
    ds_read_b128 v[80:83], v5 offset:24576
    v_mfma_f32_16x16x32_bf16 v[48:51], a[144:147], v[72:75], v[48:51]
    ds_read_b128 v[84:87], v5 offset:26624
    v_mfma_f32_16x16x32_bf16 v[92:95], a[144:147], v[76:79], v[92:95]
    ds_read_b128 v[88:91], v5 offset:45056
    s_waitcnt lgkmcnt(5)
    v_mfma_f32_16x16x32_bf16 v[52:55], a[148:151], v[68:71], v[52:55]
    ds_read_b64_tr_b16 a[156:157], v26 offset:28672
    v_mfma_f32_16x16x32_bf16 v[56:59], a[148:151], v[72:75], v[56:59]
    ds_read_b64_tr_b16 a[158:159], v26 offset:29184
    v_mfma_f32_16x16x32_bf16 v[96:99], a[148:151], v[76:79], v[96:99]
    ds_read_b64_tr_b16 a[160:161], v27 offset:28672
    s_waitcnt lgkmcnt(6)
    v_mfma_f32_16x16x32_bf16 v[60:63], a[152:155], v[68:71], v[60:63]
    ds_read_b64_tr_b16 a[162:163], v27 offset:29184
    v_mfma_f32_16x16x32_bf16 v[64:67], a[152:155], v[72:75], v[64:67]
    ds_read_b64_tr_b16 a[164:165], v28 offset:28672
    v_mfma_f32_16x16x32_bf16 v[118:121], a[152:155], v[76:79], v[118:121]
    ds_read_b64_tr_b16 a[166:167], v28 offset:29184
    v_mfma_f32_16x16x32_bf16 v[100:103], a[144:147], v[32:35], v[100:103]
    buffer_load_dwordx4 v23, s[12:15], s54 offen lds
    v_mfma_f32_16x16x32_bf16 v[104:107], a[148:151], v[32:35], v[104:107]
    s_add_u32 m0, s42, 16384
    s_nop 0
    buffer_load_dwordx4 v24, s[12:15], s54 offen lds
    v_mfma_f32_16x16x32_bf16 v[108:111], a[152:155], v[32:35], v[108:111]
    s_add_u32 m0, s42, 17408
    s_nop 0
    buffer_load_dwordx4 v25, s[12:15], s54 offen lds
    s_add_u32 s54, s54, 393216
    s_waitcnt vmcnt(15) lgkmcnt(0)
    s_barrier
    v_mfma_f32_16x16x32_bf16 v[44:47], a[156:159], v[80:83], v[44:47]
    s_add_u32 m0, s43, 150272
    ds_read_b128 v[68:71], v4 offset:28672
    ds_read_b128 v[72:75], v4 offset:30720
    v_mfma_f32_16x16x32_bf16 v[48:51], a[156:159], v[84:87], v[48:51]
    ds_read_b128 v[76:79], v4 offset:47104
    ds_read_b64_tr_b16 a[168:169], v26 offset:49152
    v_mfma_f32_16x16x32_bf16 v[92:95], a[156:159], v[88:91], v[92:95]
    buffer_load_dwordx4 v6, s[8:11], s53 offen offset:1280 sc1 lds
    v_mfma_f32_16x16x32_bf16 v[52:55], a[160:163], v[80:83], v[52:55]
    s_add_u32 m0, s43, 105216
    ds_read_b64_tr_b16 a[170:171], v26 offset:49664
    v_mfma_f32_16x16x32_bf16 v[56:59], a[160:163], v[84:87], v[56:59]
    buffer_load_dwordx4 v6, s[8:11], s41 offen offset:1280 sc1 lds
    v_mfma_f32_16x16x32_bf16 v[96:99], a[160:163], v[88:91], v[96:99]
    s_add_u32 m0, s42, 24576
    ds_read_b64_tr_b16 a[172:173], v27 offset:49152
    v_mfma_f32_16x16x32_bf16 v[60:63], a[164:167], v[80:83], v[60:63]
    ds_read_b64_tr_b16 a[174:175], v27 offset:49664
    v_mfma_f32_16x16x32_bf16 v[64:67], a[164:167], v[84:87], v[64:67]
    buffer_load_dwordx4 v20, s[12:15], s54 offen lds
    v_mfma_f32_16x16x32_bf16 v[118:121], a[164:167], v[88:91], v[118:121]
    s_add_u32 m0, s42, 25600
    ds_read_b64_tr_b16 a[176:177], v28 offset:49152
    v_mfma_f32_16x16x32_bf16 v[100:103], a[156:159], v[32:35], v[100:103]
    buffer_load_dwordx4 v21, s[12:15], s54 offen lds
    v_mfma_f32_16x16x32_bf16 v[104:107], a[160:163], v[32:35], v[104:107]
    s_add_u32 m0, s42, 32768
    ds_read_b64_tr_b16 a[178:179], v28 offset:49664
    v_mfma_f32_16x16x32_bf16 v[108:111], a[164:167], v[32:35], v[108:111]
    buffer_load_dwordx4 v22, s[12:15], s54 offen lds
    s_waitcnt lgkmcnt(4)
    v_mfma_f32_16x16x32_bf16 v[44:47], a[168:171], v[68:71], v[44:47]
    s_add_u32 m0, s42, 33792
    ds_read_b128 v[80:83], v5 offset:28672
    v_mfma_f32_16x16x32_bf16 v[48:51], a[168:171], v[72:75], v[48:51]
    ds_read_b128 v[84:87], v5 offset:30720
    v_mfma_f32_16x16x32_bf16 v[92:95], a[168:171], v[76:79], v[92:95]
    ds_read_b128 v[88:91], v5 offset:47104
    s_waitcnt lgkmcnt(5)
    v_mfma_f32_16x16x32_bf16 v[52:55], a[172:175], v[68:71], v[52:55]
    ds_read_b64_tr_b16 a[180:181], v26 offset:53248
    v_mfma_f32_16x16x32_bf16 v[56:59], a[172:175], v[72:75], v[56:59]
    ds_read_b64_tr_b16 a[182:183], v26 offset:53760
    v_mfma_f32_16x16x32_bf16 v[96:99], a[172:175], v[76:79], v[96:99]
    ds_read_b64_tr_b16 a[184:185], v27 offset:53248
    s_waitcnt lgkmcnt(6)
    v_mfma_f32_16x16x32_bf16 v[60:63], a[176:179], v[68:71], v[60:63]
    ds_read_b64_tr_b16 a[186:187], v27 offset:53760
    v_mfma_f32_16x16x32_bf16 v[64:67], a[176:179], v[72:75], v[64:67]
    ds_read_b64_tr_b16 a[188:189], v28 offset:53248
    v_mfma_f32_16x16x32_bf16 v[118:121], a[176:179], v[76:79], v[118:121]
    ds_read_b64_tr_b16 a[190:191], v28 offset:53760
    v_mfma_f32_16x16x32_bf16 v[100:103], a[168:171], v[32:35], v[100:103]
    buffer_load_dwordx4 v23, s[12:15], s54 offen lds
    v_mfma_f32_16x16x32_bf16 v[104:107], a[172:175], v[32:35], v[104:107]
    s_add_u32 m0, s42, 40960
    s_nop 0
    buffer_load_dwordx4 v24, s[12:15], s54 offen lds
    v_mfma_f32_16x16x32_bf16 v[108:111], a[176:179], v[32:35], v[108:111]
    s_add_u32 m0, s42, 41984
    s_nop 0
    buffer_load_dwordx4 v25, s[12:15], s54 offen lds
    s_add_u32 s54, s54, 393216
    s_waitcnt vmcnt(15) lgkmcnt(0)
    s_barrier
    v_mfma_f32_16x16x32_bf16 v[44:47], a[180:183], v[80:83], v[44:47]
    ds_read_b128 v[68:71], v4 offset:0
    ds_read_b128 v[72:75], v4 offset:2048
    v_mfma_f32_16x16x32_bf16 v[48:51], a[180:183], v[84:87], v[48:51]
    ds_read_b128 v[76:79], v4 offset:49152
    ds_read_b64_tr_b16 a[192:193], v29 offset:0
    v_mfma_f32_16x16x32_bf16 v[92:95], a[180:183], v[88:91], v[92:95]
    buffer_load_dword v38, v124, s[20:23], 0 offen offset:32 sc1
    v_mfma_f32_16x16x32_bf16 v[52:55], a[184:187], v[80:83], v[52:55]
    s_add_u32 m0, s43, 109184
    ds_read_b64_tr_b16 a[194:195], v29 offset:512
    v_mfma_f32_16x16x32_bf16 v[56:59], a[184:187], v[84:87], v[56:59]
    buffer_load_dwordx4 v6, s[8:11], s41 offen offset:1408 sc1 lds
    v_mfma_f32_16x16x32_bf16 v[96:99], a[184:187], v[88:91], v[96:99]
    s_add_u32 m0, s42, 49152
    ds_read_b64_tr_b16 a[196:197], v30 offset:0
    v_mfma_f32_16x16x32_bf16 v[60:63], a[188:191], v[80:83], v[60:63]
    ds_read_b64_tr_b16 a[198:199], v30 offset:512
    v_mfma_f32_16x16x32_bf16 v[64:67], a[188:191], v[84:87], v[64:67]
    buffer_load_dwordx4 v20, s[12:15], s54 offen lds
    v_mfma_f32_16x16x32_bf16 v[118:121], a[188:191], v[88:91], v[118:121]
    s_add_u32 m0, s42, 50176
    ds_read_b64_tr_b16 a[200:201], v31 offset:0
    v_mfma_f32_16x16x32_bf16 v[100:103], a[180:183], v[32:35], v[100:103]
    buffer_load_dwordx4 v21, s[12:15], s54 offen lds
    v_mfma_f32_16x16x32_bf16 v[104:107], a[184:187], v[32:35], v[104:107]
    s_add_u32 m0, s42, 57344
    ds_read_b64_tr_b16 a[202:203], v31 offset:512
    v_mfma_f32_16x16x32_bf16 v[108:111], a[188:191], v[32:35], v[108:111]
    buffer_load_dwordx4 v22, s[12:15], s54 offen lds
    s_waitcnt lgkmcnt(4)
    v_mfma_f32_16x16x32_bf16 v[44:47], a[192:195], v[68:71], v[44:47]
    s_add_u32 m0, s42, 58368
    ds_read_b128 v[80:83], v5 offset:0
    v_mfma_f32_16x16x32_bf16 v[48:51], a[192:195], v[72:75], v[48:51]
    ds_read_b128 v[84:87], v5 offset:2048
    v_mfma_f32_16x16x32_bf16 v[92:95], a[192:195], v[76:79], v[92:95]
    ds_read_b128 v[88:91], v5 offset:49152
    s_waitcnt lgkmcnt(5)
    v_mfma_f32_16x16x32_bf16 v[52:55], a[196:199], v[68:71], v[52:55]
    ds_read_b64_tr_b16 a[204:205], v29 offset:4096
    v_mfma_f32_16x16x32_bf16 v[56:59], a[196:199], v[72:75], v[56:59]
    ds_read_b64_tr_b16 a[206:207], v29 offset:4608
    v_mfma_f32_16x16x32_bf16 v[96:99], a[196:199], v[76:79], v[96:99]
    ds_read_b64_tr_b16 a[208:209], v30 offset:4096
    s_waitcnt lgkmcnt(6)
    v_mfma_f32_16x16x32_bf16 v[60:63], a[200:203], v[68:71], v[60:63]
    ds_read_b64_tr_b16 a[210:211], v30 offset:4608
    v_mfma_f32_16x16x32_bf16 v[64:67], a[200:203], v[72:75], v[64:67]
    ds_read_b64_tr_b16 a[212:213], v31 offset:4096
    v_mfma_f32_16x16x32_bf16 v[118:121], a[200:203], v[76:79], v[118:121]
    ds_read_b64_tr_b16 a[214:215], v31 offset:4608
    v_mfma_f32_16x16x32_bf16 v[100:103], a[192:195], v[32:35], v[100:103]
    buffer_load_dwordx4 v23, s[12:15], s54 offen lds
    v_mfma_f32_16x16x32_bf16 v[104:107], a[196:199], v[32:35], v[104:107]
    s_add_u32 m0, s42, 65536
    s_nop 0
    buffer_load_dwordx4 v24, s[12:15], s54 offen lds
    v_mfma_f32_16x16x32_bf16 v[108:111], a[200:203], v[32:35], v[108:111]
    s_add_u32 m0, s42, 66560
    s_nop 0
    buffer_load_dwordx4 v25, s[12:15], s54 offen lds
    s_add_u32 s54, s54, 393216
    s_waitcnt vmcnt(16) lgkmcnt(0)
    s_barrier
    v_mfma_f32_16x16x32_bf16 v[44:47], a[204:207], v[80:83], v[44:47]
    s_add_u32 m0, s43, 154112
    ds_read_b128 v[68:71], v4 offset:4096
    ds_read_b128 v[72:75], v4 offset:6144
    v_mfma_f32_16x16x32_bf16 v[48:51], a[204:207], v[84:87], v[48:51]
    ds_read_b128 v[76:79], v4 offset:51200
    ds_read_b64_tr_b16 a[216:217], v26 offset:0
    v_mfma_f32_16x16x32_bf16 v[92:95], a[204:207], v[88:91], v[92:95]
    buffer_load_dwordx4 v6, s[8:11], s53 offen offset:1536 sc1 lds
    v_mfma_f32_16x16x32_bf16 v[52:55], a[208:211], v[80:83], v[52:55]
    s_add_u32 m0, s43, 113152
    ds_read_b64_tr_b16 a[218:219], v26 offset:512
    v_mfma_f32_16x16x32_bf16 v[56:59], a[208:211], v[84:87], v[56:59]
    buffer_load_dwordx4 v6, s[8:11], s41 offen offset:1536 sc1 lds
    v_mfma_f32_16x16x32_bf16 v[96:99], a[208:211], v[88:91], v[96:99]
    s_add_u32 m0, s42, 73728
    ds_read_b64_tr_b16 a[220:221], v27 offset:0
    v_mfma_f32_16x16x32_bf16 v[60:63], a[212:215], v[80:83], v[60:63]
    ds_read_b64_tr_b16 a[222:223], v27 offset:512
    v_mfma_f32_16x16x32_bf16 v[64:67], a[212:215], v[84:87], v[64:67]
    buffer_load_dwordx4 v20, s[12:15], s54 offen lds
    v_mfma_f32_16x16x32_bf16 v[118:121], a[212:215], v[88:91], v[118:121]
    s_add_u32 m0, s42, 74752
    ds_read_b64_tr_b16 a[224:225], v28 offset:0
    v_mfma_f32_16x16x32_bf16 v[100:103], a[204:207], v[32:35], v[100:103]
    buffer_load_dwordx4 v21, s[12:15], s54 offen lds
    v_mfma_f32_16x16x32_bf16 v[104:107], a[208:211], v[32:35], v[104:107]
    s_add_u32 m0, s42, 81920
    ds_read_b64_tr_b16 a[226:227], v28 offset:512
    v_mfma_f32_16x16x32_bf16 v[108:111], a[212:215], v[32:35], v[108:111]
    buffer_load_dwordx4 v22, s[12:15], s54 offen lds
    s_waitcnt lgkmcnt(4)
    v_mfma_f32_16x16x32_bf16 v[44:47], a[216:219], v[68:71], v[44:47]
    s_add_u32 m0, s42, 82944
    ds_read_b128 v[80:83], v5 offset:4096
    v_mfma_f32_16x16x32_bf16 v[48:51], a[216:219], v[72:75], v[48:51]
    ds_read_b128 v[84:87], v5 offset:6144
    v_mfma_f32_16x16x32_bf16 v[92:95], a[216:219], v[76:79], v[92:95]
    ds_read_b128 v[88:91], v5 offset:51200
    s_waitcnt lgkmcnt(5)
    v_mfma_f32_16x16x32_bf16 v[52:55], a[220:223], v[68:71], v[52:55]
    ds_read_b64_tr_b16 a[228:229], v26 offset:4096
    v_mfma_f32_16x16x32_bf16 v[56:59], a[220:223], v[72:75], v[56:59]
    ds_read_b64_tr_b16 a[230:231], v26 offset:4608
    v_mfma_f32_16x16x32_bf16 v[96:99], a[220:223], v[76:79], v[96:99]
    ds_read_b64_tr_b16 a[232:233], v27 offset:4096
    s_waitcnt lgkmcnt(6)
    v_mfma_f32_16x16x32_bf16 v[60:63], a[224:227], v[68:71], v[60:63]
    ds_read_b64_tr_b16 a[234:235], v27 offset:4608
    v_mfma_f32_16x16x32_bf16 v[64:67], a[224:227], v[72:75], v[64:67]
    ds_read_b64_tr_b16 a[236:237], v28 offset:4096
    v_mfma_f32_16x16x32_bf16 v[118:121], a[224:227], v[76:79], v[118:121]
    ds_read_b64_tr_b16 a[238:239], v28 offset:4608
    v_mfma_f32_16x16x32_bf16 v[100:103], a[216:219], v[32:35], v[100:103]
    buffer_load_dwordx4 v23, s[12:15], s54 offen lds
    v_mfma_f32_16x16x32_bf16 v[104:107], a[220:223], v[32:35], v[104:107]
    s_add_u32 m0, s42, 90112
    s_nop 0
    buffer_load_dwordx4 v24, s[12:15], s54 offen lds
    v_mfma_f32_16x16x32_bf16 v[108:111], a[224:227], v[32:35], v[108:111]
    s_add_u32 m0, s42, 91136
    s_nop 0
    buffer_load_dwordx4 v25, s[12:15], s54 offen lds
    s_add_u32 s54, s54, 393216
    s_waitcnt vmcnt(16) lgkmcnt(0)
    s_barrier
    v_mfma_f32_16x16x32_bf16 v[44:47], a[228:231], v[80:83], v[44:47]
    s_add_u32 m0, s43, 117120
    ds_read_b128 v[68:71], v4 offset:8192
    ds_read_b128 v[72:75], v4 offset:10240
    v_mfma_f32_16x16x32_bf16 v[48:51], a[228:231], v[84:87], v[48:51]
    ds_read_b128 v[76:79], v4 offset:53248
    v_mfma_f32_16x16x32_bf16 v[92:95], a[228:231], v[88:91], v[92:95]
    buffer_load_dwordx4 v6, s[8:11], s41 offen offset:1664 sc1 lds
    v_mfma_f32_16x16x32_bf16 v[52:55], a[232:235], v[80:83], v[52:55]
    s_add_u32 m0, s42, 0
    ds_read_b64_tr_b16 a[240:241], v26 offset:24576
    v_mfma_f32_16x16x32_bf16 v[56:59], a[232:235], v[84:87], v[56:59]
    buffer_load_dwordx4 v20, s[12:15], s54 offen lds
    v_mfma_f32_16x16x32_bf16 v[96:99], a[232:235], v[88:91], v[96:99]
    s_add_u32 m0, s42, 1024
    ds_read_b64_tr_b16 a[242:243], v26 offset:25088
    v_mfma_f32_16x16x32_bf16 v[60:63], a[236:239], v[80:83], v[60:63]
    ds_read_b64_tr_b16 a[244:245], v27 offset:24576
    v_mfma_f32_16x16x32_bf16 v[64:67], a[236:239], v[84:87], v[64:67]
    buffer_load_dwordx4 v21, s[12:15], s54 offen lds
    v_mfma_f32_16x16x32_bf16 v[118:121], a[236:239], v[88:91], v[118:121]
    s_add_u32 m0, s42, 8192
    ds_read_b64_tr_b16 a[246:247], v27 offset:25088
    v_mfma_f32_16x16x32_bf16 v[100:103], a[228:231], v[32:35], v[100:103]
    buffer_load_dwordx4 v22, s[12:15], s54 offen lds
    v_mfma_f32_16x16x32_bf16 v[104:107], a[232:235], v[32:35], v[104:107]
    ds_read_b64_tr_b16 a[248:249], v28 offset:24576
    v_mfma_f32_16x16x32_bf16 v[108:111], a[236:239], v[32:35], v[108:111]
    ds_read_b64_tr_b16 a[250:251], v28 offset:25088
    s_waitcnt lgkmcnt(4)
    v_mfma_f32_16x16x32_bf16 v[44:47], a[240:243], v[68:71], v[44:47]
    s_add_u32 m0, s42, 9216
    ds_read_b128 v[80:83], v5 offset:8192
    v_mfma_f32_16x16x32_bf16 v[48:51], a[240:243], v[72:75], v[48:51]
    ds_read_b128 v[84:87], v5 offset:10240
    v_mfma_f32_16x16x32_bf16 v[92:95], a[240:243], v[76:79], v[92:95]
    ds_read_b128 v[88:91], v5 offset:53248
    s_waitcnt lgkmcnt(5)
    v_mfma_f32_16x16x32_bf16 v[52:55], a[244:247], v[68:71], v[52:55]
    ds_read_b64_tr_b16 a[252:253], v26 offset:28672
    v_mfma_f32_16x16x32_bf16 v[56:59], a[244:247], v[72:75], v[56:59]
    ds_read_b64_tr_b16 a[254:255], v26 offset:29184
    v_mfma_f32_16x16x32_bf16 v[96:99], a[244:247], v[76:79], v[96:99]
    ds_read_b64_tr_b16 v[128:129], v27 offset:28672
    s_waitcnt lgkmcnt(6)
    v_mfma_f32_16x16x32_bf16 v[60:63], a[248:251], v[68:71], v[60:63]
    ds_read_b64_tr_b16 v[130:131], v27 offset:29184
    v_mfma_f32_16x16x32_bf16 v[64:67], a[248:251], v[72:75], v[64:67]
    ds_read_b64_tr_b16 v[132:133], v28 offset:28672
    v_mfma_f32_16x16x32_bf16 v[118:121], a[248:251], v[76:79], v[118:121]
    ds_read_b64_tr_b16 v[134:135], v28 offset:29184
    v_mfma_f32_16x16x32_bf16 v[100:103], a[240:243], v[32:35], v[100:103]
    buffer_load_dwordx4 v23, s[12:15], s54 offen lds
    v_mfma_f32_16x16x32_bf16 v[104:107], a[244:247], v[32:35], v[104:107]
    s_add_u32 m0, s42, 16384
    s_nop 0
    buffer_load_dwordx4 v24, s[12:15], s54 offen lds
    v_mfma_f32_16x16x32_bf16 v[108:111], a[248:251], v[32:35], v[108:111]
    s_add_u32 m0, s42, 17408
    s_nop 0
    buffer_load_dwordx4 v25, s[12:15], s54 offen lds
    s_add_u32 s54, s54, 393216
    s_waitcnt vmcnt(15) lgkmcnt(0)
    s_barrier
    v_mfma_f32_16x16x32_bf16 v[44:47], a[252:255], v[80:83], v[44:47]
    buffer_load_dword v37, v36, s[20:23], 64 offen sc1
    v_mfma_f32_16x16x32_bf16 v[48:51], a[252:255], v[84:87], v[48:51]
    s_add_u32 m0, s43, 157952
    ds_read_b128 v[68:71], v4 offset:12288
    ds_read_b128 v[72:75], v4 offset:14336
    v_mfma_f32_16x16x32_bf16 v[92:95], a[252:255], v[88:91], v[92:95]
    buffer_load_dwordx4 v6, s[8:11], s53 offen offset:1792 sc1 lds
    v_mfma_f32_16x16x32_bf16 v[52:55], v[128:131], v[80:83], v[52:55]
    s_add_u32 m0, s43, 121088
    ds_read_b128 v[76:79], v4 offset:55296
    ds_read_b64_tr_b16 v[136:137], v26 offset:49152
    v_mfma_f32_16x16x32_bf16 v[56:59], v[128:131], v[84:87], v[56:59]
    buffer_load_dwordx4 v6, s[8:11], s41 offen offset:1792 sc1 lds
    v_mfma_f32_16x16x32_bf16 v[96:99], v[128:131], v[88:91], v[96:99]
    s_add_u32 m0, s42, 24576
    ds_read_b64_tr_b16 v[138:139], v26 offset:49664
    ds_read_b64_tr_b16 v[140:141], v27 offset:49152
    v_mfma_f32_16x16x32_bf16 v[60:63], v[132:135], v[80:83], v[60:63]
    ds_read_b64_tr_b16 v[142:143], v27 offset:49664
    v_mfma_f32_16x16x32_bf16 v[64:67], v[132:135], v[84:87], v[64:67]
    buffer_load_dwordx4 v20, s[12:15], s54 offen lds
    v_mfma_f32_16x16x32_bf16 v[118:121], v[132:135], v[88:91], v[118:121]
    s_add_u32 m0, s42, 25600
    ds_read_b64_tr_b16 v[144:145], v28 offset:49152
    v_mfma_f32_16x16x32_bf16 v[100:103], a[252:255], v[32:35], v[100:103]
    buffer_load_dwordx4 v21, s[12:15], s54 offen lds
    v_mfma_f32_16x16x32_bf16 v[104:107], v[128:131], v[32:35], v[104:107]
    s_add_u32 m0, s42, 32768
    ds_read_b64_tr_b16 v[146:147], v28 offset:49664
    v_mfma_f32_16x16x32_bf16 v[108:111], v[132:135], v[32:35], v[108:111]
    buffer_load_dwordx4 v22, s[12:15], s54 offen lds
    s_waitcnt lgkmcnt(4)
    v_mfma_f32_16x16x32_bf16 v[44:47], v[136:139], v[68:71], v[44:47]
    s_add_u32 m0, s42, 33792
    ds_read_b128 v[80:83], v5 offset:12288
    v_mfma_f32_16x16x32_bf16 v[48:51], v[136:139], v[72:75], v[48:51]
    ds_read_b128 v[84:87], v5 offset:14336
    v_mfma_f32_16x16x32_bf16 v[92:95], v[136:139], v[76:79], v[92:95]
    ds_read_b128 v[88:91], v5 offset:55296
    s_waitcnt lgkmcnt(5)
    v_mfma_f32_16x16x32_bf16 v[52:55], v[140:143], v[68:71], v[52:55]
    ds_read_b64_tr_b16 v[148:149], v26 offset:53248
    v_mfma_f32_16x16x32_bf16 v[56:59], v[140:143], v[72:75], v[56:59]
    ds_read_b64_tr_b16 v[150:151], v26 offset:53760
    v_mfma_f32_16x16x32_bf16 v[96:99], v[140:143], v[76:79], v[96:99]
    ds_read_b64_tr_b16 v[152:153], v27 offset:53248
    s_waitcnt lgkmcnt(6)
    v_mfma_f32_16x16x32_bf16 v[60:63], v[144:147], v[68:71], v[60:63]
    ds_read_b64_tr_b16 v[154:155], v27 offset:53760
    v_mfma_f32_16x16x32_bf16 v[64:67], v[144:147], v[72:75], v[64:67]
    ds_read_b64_tr_b16 v[156:157], v28 offset:53248
    v_mfma_f32_16x16x32_bf16 v[118:121], v[144:147], v[76:79], v[118:121]
    ds_read_b64_tr_b16 v[158:159], v28 offset:53760
    v_mfma_f32_16x16x32_bf16 v[100:103], v[136:139], v[32:35], v[100:103]
    buffer_load_dwordx4 v23, s[12:15], s54 offen lds
    v_mfma_f32_16x16x32_bf16 v[104:107], v[140:143], v[32:35], v[104:107]
    s_add_u32 m0, s42, 40960
    s_nop 0
    buffer_load_dwordx4 v24, s[12:15], s54 offen lds
    v_mfma_f32_16x16x32_bf16 v[108:111], v[144:147], v[32:35], v[108:111]
    s_add_u32 m0, s42, 41984
    s_nop 0
    buffer_load_dwordx4 v25, s[12:15], s54 offen lds
    s_add_u32 s54, s54, 393216
    s_waitcnt vmcnt(16) lgkmcnt(0)
    s_barrier
    v_mfma_f32_16x16x32_bf16 v[44:47], v[148:151], v[80:83], v[44:47]
    s_add_u32 m0, s43, 125056
    ds_read_b128 v[68:71], v4 offset:16384
    ds_read_b128 v[72:75], v4 offset:18432
    v_mfma_f32_16x16x32_bf16 v[48:51], v[148:151], v[84:87], v[48:51]
    ds_read_b128 v[76:79], v4 offset:57344
    v_mfma_f32_16x16x32_bf16 v[92:95], v[148:151], v[88:91], v[92:95]
    buffer_load_dwordx4 v6, s[8:11], s41 offen offset:1920 sc1 lds
    v_mfma_f32_16x16x32_bf16 v[52:55], v[152:155], v[80:83], v[52:55]
    s_add_u32 m0, s42, 49152
    ds_read_b64_tr_b16 v[160:161], v29 offset:0
    v_mfma_f32_16x16x32_bf16 v[56:59], v[152:155], v[84:87], v[56:59]
    buffer_load_dwordx4 v20, s[12:15], s54 offen lds
    v_mfma_f32_16x16x32_bf16 v[96:99], v[152:155], v[88:91], v[96:99]
    s_add_u32 m0, s42, 50176
    ds_read_b64_tr_b16 v[162:163], v29 offset:512
    v_mfma_f32_16x16x32_bf16 v[60:63], v[156:159], v[80:83], v[60:63]
    ds_read_b64_tr_b16 v[164:165], v30 offset:0
    v_mfma_f32_16x16x32_bf16 v[64:67], v[156:159], v[84:87], v[64:67]
    buffer_load_dwordx4 v21, s[12:15], s54 offen lds
    v_mfma_f32_16x16x32_bf16 v[118:121], v[156:159], v[88:91], v[118:121]
    s_add_u32 m0, s42, 57344
    ds_read_b64_tr_b16 v[166:167], v30 offset:512
    v_mfma_f32_16x16x32_bf16 v[100:103], v[148:151], v[32:35], v[100:103]
    buffer_load_dwordx4 v22, s[12:15], s54 offen lds
    v_mfma_f32_16x16x32_bf16 v[104:107], v[152:155], v[32:35], v[104:107]
    ds_read_b64_tr_b16 v[168:169], v31 offset:0
    v_mfma_f32_16x16x32_bf16 v[108:111], v[156:159], v[32:35], v[108:111]
    ds_read_b64_tr_b16 v[170:171], v31 offset:512
    s_waitcnt lgkmcnt(4)
    v_mfma_f32_16x16x32_bf16 v[44:47], v[160:163], v[68:71], v[44:47]
    s_add_u32 m0, s42, 58368
    ds_read_b128 v[80:83], v5 offset:16384
    v_mfma_f32_16x16x32_bf16 v[48:51], v[160:163], v[72:75], v[48:51]
    ds_read_b128 v[84:87], v5 offset:18432
    v_mfma_f32_16x16x32_bf16 v[92:95], v[160:163], v[76:79], v[92:95]
    ds_read_b128 v[88:91], v5 offset:57344
    s_waitcnt lgkmcnt(5)
    v_mfma_f32_16x16x32_bf16 v[52:55], v[164:167], v[68:71], v[52:55]
    ds_read_b64_tr_b16 v[172:173], v29 offset:4096
    v_mfma_f32_16x16x32_bf16 v[56:59], v[164:167], v[72:75], v[56:59]
    ds_read_b64_tr_b16 v[174:175], v29 offset:4608
    v_mfma_f32_16x16x32_bf16 v[96:99], v[164:167], v[76:79], v[96:99]
    ds_read_b64_tr_b16 v[176:177], v30 offset:4096
    s_waitcnt lgkmcnt(6)
    v_mfma_f32_16x16x32_bf16 v[60:63], v[168:171], v[68:71], v[60:63]
    ds_read_b64_tr_b16 v[178:179], v30 offset:4608
    v_mfma_f32_16x16x32_bf16 v[64:67], v[168:171], v[72:75], v[64:67]
    ds_read_b64_tr_b16 v[180:181], v31 offset:4096
    v_mfma_f32_16x16x32_bf16 v[118:121], v[168:171], v[76:79], v[118:121]
    ds_read_b64_tr_b16 v[182:183], v31 offset:4608
    v_mfma_f32_16x16x32_bf16 v[100:103], v[160:163], v[32:35], v[100:103]
    buffer_load_dwordx4 v23, s[12:15], s54 offen lds
    v_mfma_f32_16x16x32_bf16 v[104:107], v[164:167], v[32:35], v[104:107]
    s_add_u32 m0, s42, 65536
    s_nop 0
    buffer_load_dwordx4 v24, s[12:15], s54 offen lds
    v_mfma_f32_16x16x32_bf16 v[108:111], v[168:171], v[32:35], v[108:111]
    s_add_u32 m0, s42, 66560
    s_nop 0
    buffer_load_dwordx4 v25, s[12:15], s54 offen lds
    s_add_u32 s54, s54, 393216
    s_waitcnt vmcnt(15) lgkmcnt(0)
    v_readfirstlane_b32 s37, v38
    s_nop 0
    s_cmp_lg_u32 s37, s3
    s_cbranch_scc1 L_vspin5
L_vback6:
    v_cmp_eq_u32 vcc, v36, v37
    s_cbranch_vccnz L_spin1
L_back2:
    s_barrier
    v_mfma_f32_16x16x32_bf16 v[44:47], v[172:175], v[80:83], v[44:47]
    s_lshl_b32 s53, s33, 15
    s_sub_u32 s53, 0x5418000, s53
    s_add_u32 m0, s52, 94208
    ds_read_b128 v[68:71], v4 offset:20480
    v_mfma_f32_16x16x32_bf16 v[48:51], v[172:175], v[84:87], v[48:51]
    ds_read_b128 v[72:75], v4 offset:22528
    v_mfma_f32_16x16x32_bf16 v[92:95], v[172:175], v[88:91], v[92:95]
    buffer_load_dwordx4 v1, s[16:19], s53 offen sc1 lds
    v_mfma_f32_16x16x32_bf16 v[52:55], v[176:179], v[80:83], v[52:55]
    ds_read_b128 v[76:79], v4 offset:59392
    v_mfma_f32_16x16x32_bf16 v[56:59], v[176:179], v[84:87], v[56:59]
    ds_read_b64_tr_b16 v[184:185], v26 offset:0
    v_mfma_f32_16x16x32_bf16 v[96:99], v[176:179], v[88:91], v[96:99]
    ds_read_b64_tr_b16 v[186:187], v26 offset:512
    v_mfma_f32_16x16x32_bf16 v[60:63], v[180:183], v[80:83], v[60:63]
    ds_read_b64_tr_b16 v[188:189], v27 offset:0
    v_mfma_f32_16x16x32_bf16 v[64:67], v[180:183], v[84:87], v[64:67]
    ds_read_b64_tr_b16 v[190:191], v27 offset:512
    v_mfma_f32_16x16x32_bf16 v[118:121], v[180:183], v[88:91], v[118:121]
    ds_read_b64_tr_b16 v[192:193], v28 offset:0
    v_mfma_f32_16x16x32_bf16 v[100:103], v[172:175], v[32:35], v[100:103]
    ds_read_b64_tr_b16 v[194:195], v28 offset:512
    v_mfma_f32_16x16x32_bf16 v[104:107], v[176:179], v[32:35], v[104:107]
    v_mfma_f32_16x16x32_bf16 v[108:111], v[180:183], v[32:35], v[108:111]
    s_waitcnt lgkmcnt(4)
    v_mfma_f32_16x16x32_bf16 v[44:47], v[184:187], v[68:71], v[44:47]
    s_add_u32 m0, s52, 92160
    ds_read_b128 v[80:83], v5 offset:20480
    v_mfma_f32_16x16x32_bf16 v[48:51], v[184:187], v[72:75], v[48:51]
    ds_read_b128 v[84:87], v5 offset:22528
    v_mfma_f32_16x16x32_bf16 v[92:95], v[184:187], v[76:79], v[92:95]
    ds_read_b128 v[88:91], v5 offset:59392
    s_waitcnt lgkmcnt(5)
    v_mfma_f32_16x16x32_bf16 v[52:55], v[188:191], v[68:71], v[52:55]
    ds_read_b64_tr_b16 v[196:197], v26 offset:4096
    v_mfma_f32_16x16x32_bf16 v[56:59], v[188:191], v[72:75], v[56:59]
    ds_read_b64_tr_b16 v[198:199], v26 offset:4608
    v_mfma_f32_16x16x32_bf16 v[96:99], v[188:191], v[76:79], v[96:99]
    ds_read_b64_tr_b16 v[200:201], v27 offset:4096
    s_waitcnt lgkmcnt(6)
    v_mfma_f32_16x16x32_bf16 v[60:63], v[192:195], v[68:71], v[60:63]
    ds_read_b64_tr_b16 v[202:203], v27 offset:4608
    v_mfma_f32_16x16x32_bf16 v[64:67], v[192:195], v[72:75], v[64:67]
    ds_read_b64_tr_b16 v[204:205], v28 offset:4096
    v_mfma_f32_16x16x32_bf16 v[118:121], v[192:195], v[76:79], v[118:121]
    ds_read_b64_tr_b16 v[206:207], v28 offset:4608
    v_mfma_f32_16x16x32_bf16 v[100:103], v[184:187], v[32:35], v[100:103]
    v_mfma_f32_16x16x32_bf16 v[104:107], v[188:191], v[32:35], v[104:107]
    buffer_load_dwordx4 v1, s[16:19], s46 offen sc1 lds
    v_mfma_f32_16x16x32_bf16 v[108:111], v[192:195], v[32:35], v[108:111]
    s_cmp_eq_u32 s36, s97
    s_cselect_b32 s47, 32, -2
    s_cselect_b64 s[8:9], s[88:89], s[8:9]
    s_cselect_b32 s55, 0x543fc00, s55
    s_add_u32 s50, s50, s47
    s_max_i32 s47, s50, 0
    s_min_i32 s47, s47, s96
    s_lshl_b32 s41, s47, 15
    s_lshl_b32 s46, s47, 10
    s_sub_u32 s46, s55, s46
    s_add_u32 m0, s52, 90112
    s_nop 0
    buffer_load_dwordx4 v1, s[16:19], s46 offen sc1 lds
    s_add_u32 s91, s91, 65536
    s_waitcnt vmcnt(10) lgkmcnt(0)
    s_barrier
    v_mfma_f32_16x16x32_bf16 v[44:47], v[196:199], v[80:83], v[44:47]
    ds_read_b128 v[68:71], v4 offset:24576
    ds_read_b128 v[72:75], v4 offset:26624
    v_mfma_f32_16x16x32_bf16 v[48:51], v[196:199], v[84:87], v[48:51]
    ds_read_b128 v[76:79], v4 offset:61440
    v_mfma_f32_16x16x32_bf16 v[92:95], v[196:199], v[88:91], v[92:95]
    buffer_load_dword v117, v116, s[20:23], 0 offen sc1
    v_mfma_f32_16x16x32_bf16 v[52:55], v[200:203], v[80:83], v[52:55]
    s_add_u32 m0, s43, 0
    ds_read_b64_tr_b16 v[208:209], v26 offset:24576
    v_mfma_f32_16x16x32_bf16 v[56:59], v[200:203], v[84:87], v[56:59]
    buffer_load_dwordx4 v6, s[8:11], s41 offen offset:0 sc1 lds
    v_mfma_f32_16x16x32_bf16 v[96:99], v[200:203], v[88:91], v[96:99]
    s_add_u32 m0, s43, 3968
    ds_read_b64_tr_b16 v[210:211], v26 offset:25088
    v_mfma_f32_16x16x32_bf16 v[60:63], v[204:207], v[80:83], v[60:63]
    ds_read_b64_tr_b16 v[212:213], v27 offset:24576
    v_mfma_f32_16x16x32_bf16 v[64:67], v[204:207], v[84:87], v[64:67]
    buffer_load_dwordx4 v6, s[8:11], s41 offen offset:128 sc1 lds
    v_mfma_f32_16x16x32_bf16 v[118:121], v[204:207], v[88:91], v[118:121]
    s_add_u32 m0, s43, 7936
    ds_read_b64_tr_b16 v[214:215], v27 offset:25088
    v_mfma_f32_16x16x32_bf16 v[100:103], v[196:199], v[32:35], v[100:103]
    buffer_load_dwordx4 v6, s[8:11], s41 offen offset:256 sc1 lds
    v_mfma_f32_16x16x32_bf16 v[104:107], v[200:203], v[32:35], v[104:107]
    ds_read_b64_tr_b16 v[216:217], v28 offset:24576
    v_mfma_f32_16x16x32_bf16 v[108:111], v[204:207], v[32:35], v[108:111]
    ds_read_b64_tr_b16 v[218:219], v28 offset:25088
    s_waitcnt lgkmcnt(4)
    v_mfma_f32_16x16x32_bf16 v[44:47], v[208:211], v[68:71], v[44:47]
    s_add_u32 m0, s43, 11904
    ds_read_b128 v[80:83], v5 offset:24576
    v_mfma_f32_16x16x32_bf16 v[48:51], v[208:211], v[72:75], v[48:51]
    ds_read_b128 v[84:87], v5 offset:26624
    v_mfma_f32_16x16x32_bf16 v[92:95], v[208:211], v[76:79], v[92:95]
    ds_read_b128 v[88:91], v5 offset:61440
    s_waitcnt lgkmcnt(5)
    v_mfma_f32_16x16x32_bf16 v[52:55], v[212:215], v[68:71], v[52:55]
    ds_read_b64_tr_b16 v[220:221], v26 offset:28672
    v_mfma_f32_16x16x32_bf16 v[56:59], v[212:215], v[72:75], v[56:59]
    ds_read_b64_tr_b16 v[222:223], v26 offset:29184
    v_mfma_f32_16x16x32_bf16 v[96:99], v[212:215], v[76:79], v[96:99]
    ds_read_b64_tr_b16 v[224:225], v27 offset:28672
    s_waitcnt lgkmcnt(6)
    v_mfma_f32_16x16x32_bf16 v[60:63], v[216:219], v[68:71], v[60:63]
    ds_read_b64_tr_b16 v[226:227], v27 offset:29184
    v_mfma_f32_16x16x32_bf16 v[64:67], v[216:219], v[72:75], v[64:67]
    ds_read_b64_tr_b16 v[228:229], v28 offset:28672
    v_mfma_f32_16x16x32_bf16 v[118:121], v[216:219], v[76:79], v[118:121]
    ds_read_b64_tr_b16 v[230:231], v28 offset:29184
    v_mfma_f32_16x16x32_bf16 v[100:103], v[208:211], v[32:35], v[100:103]
    buffer_load_dwordx4 v6, s[8:11], s41 offen offset:384 sc1 lds
    v_mfma_f32_16x16x32_bf16 v[104:107], v[212:215], v[32:35], v[104:107]
    s_add_u32 m0, s43, 15872
    s_nop 0
    buffer_load_dwordx4 v6, s[8:11], s41 offen offset:512 sc1 lds
    v_mfma_f32_16x16x32_bf16 v[108:111], v[216:219], v[32:35], v[108:111]
    s_add_u32 m0, s43, 19840
    s_nop 0
    buffer_load_dwordx4 v6, s[8:11], s41 offen offset:640 sc1 lds
    s_waitcnt vmcnt(8) lgkmcnt(0)
    s_barrier
    v_mfma_f32_16x16x32_bf16 v[44:47], v[220:223], v[80:83], v[44:47]
    ds_read_b64 v[20:21], v13 offset:4096
    s_add_u32 m0, s43, 23808
    v_mfma_f32_16x16x32_bf16 v[48:51], v[220:223], v[84:87], v[48:51]
    ds_read_b64 v[22:23], v13 offset:4224
    buffer_load_dwordx4 v6, s[8:11], s41 offen offset:768 sc1 lds
    v_mfma_f32_16x16x32_bf16 v[92:95], v[220:223], v[88:91], v[92:95]
    ds_read_b64 v[24:25], v13 offset:4352
    s_add_u32 m0, s43, 27776
    v_mfma_f32_16x16x32_bf16 v[52:55], v[224:227], v[80:83], v[52:55]
    ds_read_b64 v[36:37], v13 offset:4480
    buffer_load_dwordx4 v6, s[8:11], s41 offen offset:896 sc1 lds
    v_mfma_f32_16x16x32_bf16 v[56:59], v[224:227], v[84:87], v[56:59]
    ds_read_b128 v[68:71], v4 offset:28672
    s_add_u32 m0, s43, 31744
    v_mfma_f32_16x16x32_bf16 v[96:99], v[224:227], v[88:91], v[96:99]
    ds_read_b128 v[72:75], v4 offset:30720
    buffer_load_dwordx4 v6, s[8:11], s41 offen offset:1024 sc1 lds
    v_mfma_f32_16x16x32_bf16 v[60:63], v[228:231], v[80:83], v[60:63]
    ds_read_b128 v[76:79], v4 offset:63488
    v_mfma_f32_16x16x32_bf16 v[64:67], v[228:231], v[84:87], v[64:67]
    ds_read_b64_tr_b16 v[232:233], v26 offset:49152
    v_mfma_f32_16x16x32_bf16 v[118:121], v[228:231], v[88:91], v[118:121]
    ds_read_b64_tr_b16 v[234:235], v26 offset:49664
    v_mfma_f32_16x16x32_bf16 v[100:103], v[220:223], v[32:35], v[100:103]
    ds_read_b64_tr_b16 v[236:237], v27 offset:49152
    v_mfma_f32_16x16x32_bf16 v[104:107], v[224:227], v[32:35], v[104:107]
    ds_read_b64_tr_b16 v[238:239], v27 offset:49664
    v_mfma_f32_16x16x32_bf16 v[108:111], v[228:231], v[32:35], v[108:111]
    ds_read_b64_tr_b16 v[240:241], v28 offset:49152
    ds_read_b64_tr_b16 v[242:243], v28 offset:49664
    s_waitcnt lgkmcnt(0)
    v_mfma_f32_16x16x32_bf16 v[44:47], v[232:235], v[68:71], v[44:47]
    ds_read_b64 v[30:31], v13 offset:2048
    s_add_u32 m0, s43, 35712
    v_add_f32 v42, v24, v36
    v_add_f32 v43, v25, v37
    v_mfma_f32_16x16x32_bf16 v[48:51], v[232:235], v[72:75], v[48:51]
    ds_read_b64 v[112:113], v13 offset:2176
    buffer_load_dwordx4 v6, s[8:11], s41 offen offset:1152 sc1 lds
    v_add_f32 v20, v20, v22
    v_add_f32 v21, v21, v23
    v_mfma_f32_16x16x32_bf16 v[92:95], v[232:235], v[76:79], v[92:95]
    ds_read_b64 v[114:115], v13 offset:2304
    s_add_u32 m0, s43, 39680
    v_add_f32 v20, v20, v42
    v_add_f32 v21, v21, v43
    v_mfma_f32_16x16x32_bf16 v[52:55], v[236:239], v[68:71], v[52:55]
    ds_read_b64 v[122:123], v13 offset:2432
    buffer_load_dwordx4 v6, s[8:11], s41 offen offset:1280 sc1 lds
    v_mov_b32 v42, v20
    v_mov_b32 v43, v21
    v_mfma_f32_16x16x32_bf16 v[56:59], v[236:239], v[72:75], v[56:59]
    ds_read_b128 v[80:83], v5 offset:28672
    s_add_u32 m0, s43, 43648
    v_permlane32_swap_b32 v20, v42
    v_permlane32_swap_b32 v21, v43
    v_mfma_f32_16x16x32_bf16 v[96:99], v[236:239], v[76:79], v[96:99]
    ds_read_b128 v[84:87], v5 offset:30720
    buffer_load_dwordx4 v6, s[8:11], s41 offen offset:1408 sc1 lds
    v_add_f32 v20, v20, v42
    v_add_f32 v21, v21, v43
    v_mfma_f32_16x16x32_bf16 v[60:63], v[240:243], v[68:71], v[60:63]
    ds_read_b128 v[88:91], v5 offset:63488
    v_mul_f32 v38, 0xba800000, v20
    v_mul_f32 v21, 0x3a800000, v21
    v_mfma_f32_16x16x32_bf16 v[64:67], v[240:243], v[72:75], v[64:67]
    ds_read_b64_tr_b16 v[244:245], v26 offset:53248
    v_fma_f32 v21, -v38, v38, v21
    v_mov_b32 v39, v38
    v_mfma_f32_16x16x32_bf16 v[118:121], v[240:243], v[76:79], v[118:121]
    ds_read_b64_tr_b16 v[246:247], v26 offset:53760
    v_max_f32 v21, 0, v21
    v_add_f32 v21, 0x3727c5ac, v21
    v_mfma_f32_16x16x32_bf16 v[100:103], v[232:235], v[32:35], v[100:103]
    ds_read_b64_tr_b16 v[248:249], v27 offset:53248
    v_rsq_f32 v40, v21
    v_permlane16_swap_b32 v38, v39
    v_mfma_f32_16x16x32_bf16 v[104:107], v[236:239], v[32:35], v[104:107]
    ds_read_b64_tr_b16 v[250:251], v27 offset:53760
    v_mov_b32 v41, v40
    s_nop 1
    v_permlane16_swap_b32 v40, v41
    v_mfma_f32_16x16x32_bf16 v[108:111], v[240:243], v[32:35], v[108:111]
    ds_read_b64_tr_b16 v[252:253], v28 offset:53248
    ds_read_b64_tr_b16 v[254:255], v28 offset:53760
    s_waitcnt vmcnt(12) lgkmcnt(0)
    v_cmp_eq_u32 vcc, v116, v117
    s_cbranch_vccnz L_spin3
L_back4:
    s_barrier
    v_mfma_f32_16x16x32_bf16 v[44:47], v[244:247], v[80:83], v[44:47]
    s_add_u32 m0, s43, 47616
    v_add_f32 v29, v114, v122
    v_add_f32 v19, v115, v123
    v_mfma_f32_16x16x32_bf16 v[48:51], v[244:247], v[84:87], v[48:51]
    buffer_load_dwordx4 v6, s[8:11], s41 offen offset:1536 sc1 lds
    v_add_f32 v30, v30, v112
    v_add_f32 v31, v31, v113
    v_mfma_f32_16x16x32_bf16 v[92:95], v[244:247], v[88:91], v[92:95]
    s_add_u32 m0, s43, 51584
    v_add_f32 v30, v30, v29
    v_add_f32 v31, v31, v19
    v_mfma_f32_16x16x32_bf16 v[52:55], v[248:251], v[80:83], v[52:55]
    buffer_load_dwordx4 v6, s[8:11], s41 offen offset:1664 sc1 lds
    v_mov_b32 v29, v30
    v_mov_b32 v19, v31
    v_mfma_f32_16x16x32_bf16 v[56:59], v[248:251], v[84:87], v[56:59]
    s_add_u32 m0, s43, 55552
    v_permlane32_swap_b32 v30, v29
    v_permlane32_swap_b32 v31, v19
    v_mfma_f32_16x16x32_bf16 v[96:99], v[248:251], v[88:91], v[96:99]
    buffer_load_dwordx4 v6, s[8:11], s41 offen offset:1792 sc1 lds
    v_add_f32 v30, v30, v29
    v_add_f32 v31, v31, v19
    v_mfma_f32_16x16x32_bf16 v[60:63], v[252:255], v[80:83], v[60:63]
    s_add_u32 m0, s43, 59520
    v_mul_f32 v112, 0xba800000, v30
    v_mul_f32 v31, 0x3a800000, v31
    v_mfma_f32_16x16x32_bf16 v[64:67], v[252:255], v[84:87], v[64:67]
    buffer_load_dwordx4 v6, s[8:11], s41 offen offset:1920 sc1 lds
    v_fma_f32 v31, -v112, v112, v31
    v_mov_b32 v113, v112
    v_mfma_f32_16x16x32_bf16 v[118:121], v[252:255], v[88:91], v[118:121]
    s_sub_u32 s53, s91, 65536
    v_max_f32 v31, 0, v31
    v_add_f32 v31, 0x3727c5ac, v31
    v_mfma_f32_16x16x32_bf16 v[100:103], v[244:247], v[32:35], v[100:103]
    buffer_store_dword v124, v124, s[16:19], s53 offen sc1
    v_rsq_f32 v114, v31
    v_permlane16_swap_b32 v112, v113
    v_mfma_f32_16x16x32_bf16 v[104:107], v[248:251], v[32:35], v[104:107]
    s_add_u32 s91, s91, 65536
    v_mov_b32 v115, v114
    s_nop 1
    v_permlane16_swap_b32 v114, v115
    v_mfma_f32_16x16x32_bf16 v[108:111], v[252:255], v[32:35], v[108:111]
    s_mov_b32 s36, 0
    v_mov_b32 v116, 0
    v_mov_b32 v117, v11
    s_cmp_eq_u32 s36, s97
    s_cselect_b32 s47, 32, -2
    s_cselect_b64 s[8:9], s[88:89], s[8:9]
    s_cselect_b32 s55, 0x543fc00, s55
    s_add_u32 s50, s50, s47
    s_max_i32 s47, s50, 0
    s_min_i32 s47, s47, s96
    s_lshl_b32 s41, s47, 15
    s_lshl_b32 s46, s47, 10
    s_sub_u32 s46, s55, s46
    s_cmp_eq_u32 s36, 17
    s_cselect_b32 s49, s87, 0x10000
    s_add_u32 s90, s90, s49
    s_and_b32 s49, s90, 0xffffffff
    s_bitcmp1_b64 s[24:25], s36
    s_cselect_b32 s44, s49, 0x5e00000
    s_bitcmp1_b64 s[26:27], s36
    s_cselect_b64 s[62:63], 0, -1
    v_fmac_f32 v92, v38, v100
    v_fmac_f32 v93, v38, v101
    v_fmac_f32 v94, v38, v102
    v_fmac_f32 v95, v38, v103
    v_mul_f32 v92, v92, v40
    v_mul_f32 v93, v93, v40
    v_mul_f32 v94, v94, v40
    v_mul_f32 v95, v95, v40
    v_cvt_pk_bf16_f32 v92, v92, v93
    v_cvt_pk_bf16_f32 v93, v94, v95
    ds_write_b64 v7, v[92:93] offset:6144
    v_fmac_f32 v96, v38, v104
    v_fmac_f32 v97, v38, v105
    v_fmac_f32 v98, v38, v106
    v_fmac_f32 v99, v38, v107
    v_mul_f32 v96, v96, v40
    v_mul_f32 v97, v97, v40
    v_mul_f32 v98, v98, v40
    v_mul_f32 v99, v99, v40
    v_cvt_pk_bf16_f32 v96, v96, v97
    v_cvt_pk_bf16_f32 v97, v98, v99
    ds_write_b64 v7, v[96:97] offset:7168
    v_fmac_f32 v118, v38, v108
    v_fmac_f32 v119, v38, v109
    v_fmac_f32 v120, v38, v110
    v_fmac_f32 v121, v38, v111
    v_mul_f32 v118, v118, v40
    v_mul_f32 v119, v119, v40
    v_mul_f32 v120, v120, v40
    v_mul_f32 v121, v121, v40
    v_cvt_pk_bf16_f32 v118, v118, v119
    v_cvt_pk_bf16_f32 v119, v120, v121
    ds_write_b64 v8, v[118:119] offset:8192
    v_fmac_f32 v44, v112, v100
    v_fmac_f32 v45, v112, v101
    v_fmac_f32 v46, v112, v102
    v_fmac_f32 v47, v112, v103
    v_fmac_f32 v48, v113, v100
    v_fmac_f32 v49, v113, v101
    v_fmac_f32 v50, v113, v102
    v_fmac_f32 v51, v113, v103
    v_fmac_f32 v52, v112, v104
    v_fmac_f32 v53, v112, v105
    v_fmac_f32 v54, v112, v106
    v_fmac_f32 v55, v112, v107
    v_fmac_f32 v56, v113, v104
    v_fmac_f32 v57, v113, v105
    v_fmac_f32 v58, v113, v106
    v_fmac_f32 v59, v113, v107
    v_fmac_f32 v60, v112, v108
    v_fmac_f32 v61, v112, v109
    v_fmac_f32 v62, v112, v110
    v_fmac_f32 v63, v112, v111
    v_fmac_f32 v64, v113, v108
    v_fmac_f32 v65, v113, v109
    v_fmac_f32 v66, v113, v110
    v_fmac_f32 v67, v113, v111
    s_waitcnt vmcnt(5) lgkmcnt(0)
    s_barrier
    ds_read_b128 v[68:71], v2 offset:0
    ds_read_b128 v[72:75], v2 offset:2048
    ds_read_b128 v[76:79], v3 offset:0
    ds_read_b128 v[80:83], v3 offset:2048
    s_mov_b32 s36, 1
    s_waitcnt lgkmcnt(0)
    s_nop 7
L_q_b0:
    v_mfma_f32_16x16x32_bf16 v[20:23], a[0:3], v[68:71], 0
    ds_read_b128 v[84:87], v2 offset:4096
    v_mul_f32 v44, v44, v114
    v_mfma_f32_16x16x32_bf16 v[24:27], a[0:3], v[72:75], 0
    v_mul_f32 v45, v45, v114
    v_mul_f32 v46, v46, v114
    v_mfma_f32_16x16x32_bf16 v[32:35], a[4:7], v[72:75], 0
    v_mul_f32 v47, v47, v114
    v_cvt_pk_bf16_f32 v44, v44, v45
    v_mfma_f32_16x16x32_bf16 v[28:31], a[4:7], v[68:71], 0
    ds_read_b128 v[88:91], v2 offset:6144
    v_cvt_pk_bf16_f32 v45, v46, v47
    v_mfma_f32_16x16x32_bf16 v[36:39], a[8:11], v[68:71], 0
    ds_write_b64 v7, v[44:45] offset:12288
    v_mfma_f32_16x16x32_bf16 v[40:43], a[8:11], v[72:75], 0
    s_waitcnt lgkmcnt(3)
    v_mul_f32 v48, v48, v115
    v_mul_f32 v49, v49, v115
    v_mfma_f32_16x16x32_bf16 v[20:23], a[12:15], v[76:79], v[20:23]
    ds_read_b128 v[92:95], v3 offset:4096
    v_mul_f32 v50, v50, v115
    v_mfma_f32_16x16x32_bf16 v[24:27], a[12:15], v[80:83], v[24:27]
    v_mul_f32 v51, v51, v115
    v_cvt_pk_bf16_f32 v48, v48, v49
    v_mfma_f32_16x16x32_bf16 v[32:35], a[16:19], v[80:83], v[32:35]
    v_cvt_pk_bf16_f32 v49, v50, v51
    v_mfma_f32_16x16x32_bf16 v[28:31], a[16:19], v[76:79], v[28:31]
    ds_read_b128 v[96:99], v3 offset:6144
    v_mfma_f32_16x16x32_bf16 v[36:39], a[20:23], v[76:79], v[36:39]
    ds_write_b64 v7, v[48:49] offset:18432
    v_mfma_f32_16x16x32_bf16 v[40:43], a[20:23], v[80:83], v[40:43]
    s_waitcnt lgkmcnt(4)
    v_mul_f32 v52, v52, v114
    v_mul_f32 v53, v53, v114
    v_mfma_f32_16x16x32_bf16 v[20:23], a[24:27], v[84:87], v[20:23]
    ds_read_b128 v[68:71], v2 offset:8192
    v_mul_f32 v54, v54, v114
    v_mfma_f32_16x16x32_bf16 v[24:27], a[24:27], v[88:91], v[24:27]
    v_mul_f32 v55, v55, v114
    v_cvt_pk_bf16_f32 v52, v52, v53
    v_mfma_f32_16x16x32_bf16 v[32:35], a[28:31], v[88:91], v[32:35]
    v_cvt_pk_bf16_f32 v53, v54, v55
    v_mfma_f32_16x16x32_bf16 v[28:31], a[28:31], v[84:87], v[28:31]
    ds_read_b128 v[72:75], v2 offset:10240
    v_mfma_f32_16x16x32_bf16 v[36:39], a[32:35], v[84:87], v[36:39]
    ds_write_b64 v7, v[52:53] offset:13312
    v_mfma_f32_16x16x32_bf16 v[40:43], a[32:35], v[88:91], v[40:43]
    s_waitcnt lgkmcnt(4)
    v_mul_f32 v56, v56, v115
    v_mul_f32 v57, v57, v115
    v_mfma_f32_16x16x32_bf16 v[20:23], a[36:39], v[92:95], v[20:23]
    ds_read_b128 v[76:79], v3 offset:8192
    v_mul_f32 v58, v58, v115
    v_mfma_f32_16x16x32_bf16 v[24:27], a[36:39], v[96:99], v[24:27]
    v_mul_f32 v59, v59, v115
    v_cvt_pk_bf16_f32 v56, v56, v57
    v_mfma_f32_16x16x32_bf16 v[32:35], a[40:43], v[96:99], v[32:35]
    v_cvt_pk_bf16_f32 v57, v58, v59
    v_mfma_f32_16x16x32_bf16 v[28:31], a[40:43], v[92:95], v[28:31]
    ds_read_b128 v[80:83], v3 offset:10240
    v_mfma_f32_16x16x32_bf16 v[36:39], a[44:47], v[92:95], v[36:39]
    ds_write_b64 v7, v[56:57] offset:19456
    v_mfma_f32_16x16x32_bf16 v[40:43], a[44:47], v[96:99], v[40:43]
    s_waitcnt lgkmcnt(4)
    v_mul_f32 v60, v60, v114
    v_mul_f32 v61, v61, v114
    v_mfma_f32_16x16x32_bf16 v[20:23], a[48:51], v[68:71], v[20:23]
    s_waitcnt vmcnt(1)
    ds_read_b128 v[84:87], v2 offset:12288
    v_cmp_ne_u32 vcc, 0, v116
    v_mfma_f32_16x16x32_bf16 v[24:27], a[48:51], v[72:75], v[24:27]
    v_mul_f32 v62, v62, v114
    v_mul_f32 v63, v63, v114
    v_mfma_f32_16x16x32_bf16 v[32:35], a[52:55], v[72:75], v[32:35]
    s_cbranch_vccnz L_spin7
L_back8:
    v_cvt_pk_bf16_f32 v60, v60, v61
    v_cvt_pk_bf16_f32 v61, v62, v63
    v_mfma_f32_16x16x32_bf16 v[28:31], a[52:55], v[68:71], v[28:31]
    ds_read_b128 v[88:91], v2 offset:14336
    v_mfma_f32_16x16x32_bf16 v[36:39], a[56:59], v[68:71], v[36:39]
    ds_write_b64 v8, v[60:61] offset:14336
    v_mfma_f32_16x16x32_bf16 v[40:43], a[56:59], v[72:75], v[40:43]
    s_waitcnt lgkmcnt(4)
    v_mul_f32 v64, v64, v115
    v_mul_f32 v65, v65, v115
    v_mfma_f32_16x16x32_bf16 v[20:23], a[60:63], v[76:79], v[20:23]
    ds_read_b128 v[92:95], v3 offset:12288
    v_mul_f32 v66, v66, v115
    v_mfma_f32_16x16x32_bf16 v[24:27], a[60:63], v[80:83], v[24:27]
    v_mul_f32 v67, v67, v115
    v_cvt_pk_bf16_f32 v64, v64, v65
    v_mfma_f32_16x16x32_bf16 v[32:35], a[64:67], v[80:83], v[32:35]
    v_cvt_pk_bf16_f32 v65, v66, v67
    v_mfma_f32_16x16x32_bf16 v[28:31], a[64:67], v[76:79], v[28:31]
    ds_read_b128 v[96:99], v3 offset:14336
    v_mfma_f32_16x16x32_bf16 v[36:39], a[68:71], v[76:79], v[36:39]
    ds_write_b64 v8, v[64:65] offset:20480
    v_mfma_f32_16x16x32_bf16 v[40:43], a[68:71], v[80:83], v[40:43]
    s_waitcnt lgkmcnt(4)
    v_mfma_f32_16x16x32_bf16 v[20:23], a[72:75], v[84:87], v[20:23]
    ds_read_b128 v[68:71], v2 offset:16384
    v_mfma_f32_16x16x32_bf16 v[24:27], a[72:75], v[88:91], v[24:27]
    v_mfma_f32_16x16x32_bf16 v[32:35], a[76:79], v[88:91], v[32:35]
    s_waitcnt lgkmcnt(1)
    s_barrier
    v_mfma_f32_16x16x32_bf16 v[28:31], a[76:79], v[84:87], v[28:31]
    ds_read_b128 v[72:75], v2 offset:18432
    v_mfma_f32_16x16x32_bf16 v[36:39], a[80:83], v[84:87], v[36:39]
    ds_read_b128 v[44:47], v9 offset:6144
    v_mfma_f32_16x16x32_bf16 v[40:43], a[80:83], v[88:91], v[40:43]
    s_waitcnt lgkmcnt(4)
    ds_read_b128 v[48:51], v9 offset:13312
    v_mfma_f32_16x16x32_bf16 v[20:23], a[84:87], v[92:95], v[20:23]
    ds_read_b128 v[76:79], v3 offset:16384
    v_mfma_f32_16x16x32_bf16 v[24:27], a[84:87], v[96:99], v[24:27]
    ds_read_b128 v[52:55], v9 offset:7168
    s_add_u32 m0, s43, 98304
    v_mfma_f32_16x16x32_bf16 v[32:35], a[88:91], v[96:99], v[32:35]
    buffer_load_dwordx4 v6, s[8:11], s41 offen offset:0 sc1 lds
    v_mfma_f32_16x16x32_bf16 v[28:31], a[88:91], v[92:95], v[28:31]
    s_add_u32 m0, s43, 102272
    ds_read_b128 v[80:83], v3 offset:18432
    v_mfma_f32_16x16x32_bf16 v[36:39], a[92:95], v[92:95], v[36:39]
    ds_read_b64_tr_b16 v[56:57], v9 offset:14336
    v_mfma_f32_16x16x32_bf16 v[40:43], a[92:95], v[96:99], v[40:43]
    s_waitcnt lgkmcnt(6)
    ds_read_b64_tr_b16 v[58:59], v9 offset:8192
    s_waitcnt lgkmcnt(3)
    v_mfma_f32_16x16x32_bf16 v[20:23], a[96:99], v[68:71], v[20:23]
    ds_read_b128 v[84:87], v2 offset:20480
    v_mfma_f32_16x16x32_bf16 v[64:67], v[48:51], v[44:47], 0
    ds_read_b64_tr_b16 v[60:61], v9 offset:14344
    v_mfma_f32_16x16x32_bf16 v[118:121], v[52:55], v[44:47], 0
    ds_read_b64_tr_b16 v[62:63], v9 offset:8200
    v_mfma_f32_16x16x32_bf16 v[24:27], a[96:99], v[72:75], v[24:27]
    v_mfma_f32_16x16x32_bf16 v[32:35], a[100:103], v[72:75], v[32:35]
    buffer_load_dwordx4 v6, s[8:11], s41 offen offset:128 sc1 lds
    v_mfma_f32_16x16x32_bf16 v[28:31], a[100:103], v[68:71], v[28:31]
    s_add_u32 m0, s43, 106240
    ds_read_b128 v[88:91], v2 offset:22528
    v_cndmask_b32 v64, v64, v65, s[56:57]
    v_mfma_f32_16x16x32_bf16 v[36:39], a[104:107], v[68:71], v[36:39]
    v_cndmask_b32 v66, v66, v67, s[56:57]
    v_cndmask_b32 v118, v118, v119, s[56:57]
    v_mfma_f32_16x16x32_bf16 v[40:43], a[104:107], v[72:75], v[40:43]
    s_waitcnt lgkmcnt(6)
    v_cndmask_b32 v120, v120, v121, s[56:57]
    v_cndmask_b32 v64, v18, v64, s[62:63]
    v_mfma_f32_16x16x32_bf16 v[20:23], a[108:111], v[76:79], v[20:23]
    ds_read_b128 v[92:95], v3 offset:20480
    v_cndmask_b32 v66, v18, v66, s[62:63]
    v_mfma_f32_16x16x32_bf16 v[24:27], a[108:111], v[80:83], v[24:27]
    v_cndmask_b32 v46, v64, v118, s[58:59]
    v_cndmask_b32 v47, v66, v120, s[60:61]
    v_mfma_f32_16x16x32_bf16 v[32:35], a[112:115], v[80:83], v[32:35]
    buffer_load_dwordx4 v6, s[8:11], s41 offen offset:256 sc1 lds
    v_mfma_f32_16x16x32_bf16 v[28:31], a[112:115], v[76:79], v[28:31]
    s_add_u32 m0, s43, 110208
    ds_read_b128 v[96:99], v3 offset:22528
    v_max_f32 v44, v46, v47
    v_mfma_f32_16x16x32_bf16 v[36:39], a[116:119], v[76:79], v[36:39]
    v_mov_b32 v45, v44
    v_mfma_f32_16x16x32_bf16 v[40:43], a[116:119], v[80:83], v[40:43]
    s_waitcnt lgkmcnt(2)
    v_permlane16_swap_b32 v44, v45
    v_mfma_f32_16x16x32_bf16 v[20:23], a[120:123], v[84:87], v[20:23]
    ds_read_b128 v[68:71], v2 offset:24576
    v_max_f32 v44, v44, v45
    v_mfma_f32_16x16x32_bf16 v[24:27], a[120:123], v[88:91], v[24:27]
    v_mov_b32 v45, v44
    v_mfma_f32_16x16x32_bf16 v[32:35], a[124:127], v[88:91], v[32:35]
    buffer_load_dwordx4 v6, s[8:11], s41 offen offset:384 sc1 lds
    v_mfma_f32_16x16x32_bf16 v[28:31], a[124:127], v[84:87], v[28:31]
    s_add_u32 m0, s43, 114176
    ds_read_b128 v[72:75], v2 offset:26624
    v_mfma_f32_16x16x32_bf16 v[36:39], a[128:131], v[84:87], v[36:39]
    v_permlane32_swap_b32 v44, v45
    v_mfma_f32_16x16x32_bf16 v[40:43], a[128:131], v[88:91], v[40:43]
    s_waitcnt lgkmcnt(2)
    v_max_f32 v44, v44, v45
    v_mul_f32 v44, s86, v44
    v_mfma_f32_16x16x32_bf16 v[20:23], a[132:135], v[92:95], v[20:23]
    ds_read_b128 v[76:79], v3 offset:24576
    v_fma_f32 v46, v46, s86, -v44
    v_mfma_f32_16x16x32_bf16 v[24:27], a[132:135], v[96:99], v[24:27]
    v_fma_f32 v47, v47, s86, -v44
    v_mfma_f32_16x16x32_bf16 v[32:35], a[136:139], v[96:99], v[32:35]
    buffer_load_dwordx4 v6, s[8:11], s41 offen offset:512 sc1 lds
    v_mfma_f32_16x16x32_bf16 v[28:31], a[136:139], v[92:95], v[28:31]
    s_add_u32 m0, s43, 118144
    ds_read_b128 v[80:83], v3 offset:26624
    v_mfma_f32_16x16x32_bf16 v[36:39], a[140:143], v[92:95], v[36:39]
    v_exp_f32 v46, v46
    v_mfma_f32_16x16x32_bf16 v[40:43], a[140:143], v[96:99], v[40:43]
    s_waitcnt lgkmcnt(2)
    v_exp_f32 v47, v47
    v_mfma_f32_16x16x32_bf16 v[20:23], a[144:147], v[68:71], v[20:23]
    ds_read_b128 v[84:87], v2 offset:28672
    v_cvt_pk_bf16_f32 v52, v46, v47
    v_mfma_f32_16x16x32_bf16 v[24:27], a[144:147], v[72:75], v[24:27]
    v_perm_b32 v48, v52, v52, v14
    v_perm_b32 v49, v52, v52, v15
    v_mfma_f32_16x16x32_bf16 v[32:35], a[148:151], v[72:75], v[32:35]
    buffer_load_dwordx4 v6, s[8:11], s41 offen offset:640 sc1 lds
    v_mfma_f32_16x16x32_bf16 v[28:31], a[148:151], v[68:71], v[28:31]
    s_add_u32 m0, s43, 122112
    ds_read_b128 v[88:91], v2 offset:30720
    v_perm_b32 v50, v52, v52, v16
    v_mfma_f32_16x16x32_bf16 v[36:39], a[152:155], v[68:71], v[36:39]
    v_perm_b32 v51, v52, v52, v17
    v_add_f32 v44, v46, v47
    v_mfma_f32_16x16x32_bf16 v[40:43], a[152:155], v[72:75], v[40:43]
    s_waitcnt lgkmcnt(2)
    v_mov_b32 v45, v44
    s_waitcnt lgkmcnt(9)
    v_mfma_f32_16x16x32_bf16 v[20:23], a[156:159], v[76:79], v[20:23]
    ds_read_b128 v[92:95], v3 offset:28672
    v_mfma_f32_16x16x32_bf16 v[64:67], v[56:59], v[48:51], 0
    v_mfma_f32_16x16x32_bf16 v[118:121], v[60:63], v[48:51], 0
    v_permlane16_swap_b32 v44, v45
    v_mfma_f32_16x16x32_bf16 v[24:27], a[156:159], v[80:83], v[24:27]
    v_add_f32 v44, v44, v45
    v_mov_b32 v45, v44
    v_mfma_f32_16x16x32_bf16 v[32:35], a[160:163], v[80:83], v[32:35]
    buffer_load_dwordx4 v6, s[8:11], s41 offen offset:768 sc1 lds
    v_mfma_f32_16x16x32_bf16 v[28:31], a[160:163], v[76:79], v[28:31]
    s_add_u32 m0, s43, 126080
    ds_read_b128 v[96:99], v3 offset:30720
    v_mfma_f32_16x16x32_bf16 v[36:39], a[164:167], v[76:79], v[36:39]
    v_permlane32_swap_b32 v44, v45
    v_mfma_f32_16x16x32_bf16 v[40:43], a[164:167], v[80:83], v[40:43]
    s_waitcnt lgkmcnt(2)
    v_add_f32 v44, v44, v45
    v_mfma_f32_16x16x32_bf16 v[20:23], a[168:171], v[84:87], v[20:23]
    ds_read_b128 v[68:71], v2 offset:32768
    v_mfma_f32_16x16x32_bf16 v[24:27], a[168:171], v[88:91], v[24:27]
    v_rcp_f32 v44, v44
    v_mfma_f32_16x16x32_bf16 v[32:35], a[172:175], v[88:91], v[32:35]
    buffer_load_dwordx4 v6, s[8:11], s41 offen offset:896 sc1 lds
    v_mfma_f32_16x16x32_bf16 v[28:31], a[172:175], v[84:87], v[28:31]
    s_add_u32 m0, s43, 130048
    ds_read_b128 v[72:75], v2 offset:34816
    v_mul_f32 v64, v64, v44
    v_mfma_f32_16x16x32_bf16 v[36:39], a[176:179], v[84:87], v[36:39]
    v_mul_f32 v65, v65, v44
    v_mul_f32 v66, v66, v44
    v_mfma_f32_16x16x32_bf16 v[40:43], a[176:179], v[88:91], v[40:43]
    s_waitcnt lgkmcnt(2)
    v_mul_f32 v67, v67, v44
    v_cvt_pk_bf16_f32 v52, v64, v65
    v_mfma_f32_16x16x32_bf16 v[20:23], a[180:183], v[92:95], v[20:23]
    ds_read_b128 v[76:79], v3 offset:32768
    v_cvt_pk_bf16_f32 v53, v66, v67
    v_mfma_f32_16x16x32_bf16 v[24:27], a[180:183], v[96:99], v[24:27]
    v_mul_f32 v118, v118, v44
    v_mul_f32 v119, v119, v44
    v_mfma_f32_16x16x32_bf16 v[32:35], a[184:187], v[96:99], v[32:35]
    buffer_load_dwordx4 v6, s[8:11], s41 offen offset:1024 sc1 lds
    v_mfma_f32_16x16x32_bf16 v[28:31], a[184:187], v[92:95], v[28:31]
    s_add_u32 m0, s43, 134016
    ds_read_b128 v[80:83], v3 offset:34816
    v_mul_f32 v120, v120, v44
    v_mfma_f32_16x16x32_bf16 v[36:39], a[188:191], v[92:95], v[36:39]
    v_mul_f32 v121, v121, v44
    v_cvt_pk_bf16_f32 v54, v118, v119
    v_mfma_f32_16x16x32_bf16 v[40:43], a[188:191], v[96:99], v[40:43]
    s_waitcnt lgkmcnt(2)
    v_cvt_pk_bf16_f32 v55, v120, v121
    v_mfma_f32_16x16x32_bf16 v[20:23], a[192:195], v[68:71], v[20:23]
    ds_read_b128 v[84:87], v2 offset:36864
    v_mfma_f32_16x16x32_bf16 v[24:27], a[192:195], v[72:75], v[24:27]
    buffer_store_dwordx4 v[52:55], v1, s[16:19], s44 offen sc1
    v_mfma_f32_16x16x32_bf16 v[32:35], a[196:199], v[72:75], v[32:35]
    buffer_load_dwordx4 v6, s[8:11], s41 offen offset:1152 sc1 lds
    v_mfma_f32_16x16x32_bf16 v[28:31], a[196:199], v[68:71], v[28:31]
    s_add_u32 m0, s43, 137984
    ds_read_b128 v[88:91], v2 offset:38912
    s_cmp_eq_u32 s36, 17
    v_mfma_f32_16x16x32_bf16 v[36:39], a[200:203], v[68:71], v[36:39]
    s_cselect_b32 s49, s87, 0x10000
    ds_read_b64 v[56:57], v13 offset:0
    s_add_u32 s90, s90, s49
    v_mfma_f32_16x16x32_bf16 v[40:43], a[200:203], v[72:75], v[40:43]
    s_waitcnt lgkmcnt(3)
    ds_read_b64 v[58:59], v13 offset:128
    s_and_b32 s49, s90, 0xffffffff
    v_mfma_f32_16x16x32_bf16 v[20:23], a[204:207], v[76:79], v[20:23]
    s_bitcmp1_b64 s[24:25], s36
    ds_read_b128 v[92:95], v3 offset:36864
    s_cselect_b32 s44, s49, 0x5e00000
    v_mfma_f32_16x16x32_bf16 v[24:27], a[204:207], v[80:83], v[24:27]
    s_bitcmp1_b64 s[26:27], s36
    ds_read_b64 v[60:61], v13 offset:256
    s_cselect_b64 s[62:63], 0, -1
    v_mfma_f32_16x16x32_bf16 v[32:35], a[208:211], v[80:83], v[32:35]
    buffer_load_dwordx4 v6, s[8:11], s41 offen offset:1280 sc1 lds
    v_mfma_f32_16x16x32_bf16 v[28:31], a[208:211], v[76:79], v[28:31]
    s_add_u32 m0, s43, 141952
    ds_read_b128 v[96:99], v3 offset:38912
    v_mfma_f32_16x16x32_bf16 v[36:39], a[212:215], v[76:79], v[36:39]
    ds_read_b64 v[62:63], v13 offset:384
    v_mfma_f32_16x16x32_bf16 v[40:43], a[212:215], v[80:83], v[40:43]
    s_waitcnt lgkmcnt(6)
    v_mfma_f32_16x16x32_bf16 v[20:23], a[216:219], v[84:87], v[20:23]
    ds_read_b128 v[68:71], v2 offset:40960
    v_mfma_f32_16x16x32_bf16 v[24:27], a[216:219], v[88:91], v[24:27]
    v_mfma_f32_16x16x32_bf16 v[32:35], a[220:223], v[88:91], v[32:35]
    buffer_load_dwordx4 v6, s[8:11], s41 offen offset:1408 sc1 lds
    v_mfma_f32_16x16x32_bf16 v[28:31], a[220:223], v[84:87], v[28:31]
    s_add_u32 m0, s43, 145920
    ds_read_b128 v[72:75], v2 offset:43008
    s_waitcnt lgkmcnt(2)
    v_mfma_f32_16x16x32_bf16 v[36:39], a[224:227], v[84:87], v[36:39]
    v_add_f32 v64, v60, v62
    v_add_f32 v65, v61, v63
    v_mfma_f32_16x16x32_bf16 v[40:43], a[224:227], v[88:91], v[40:43]
    s_waitcnt lgkmcnt(3)
    v_add_f32 v56, v56, v58
    v_add_f32 v57, v57, v59
    v_mfma_f32_16x16x32_bf16 v[20:23], a[228:231], v[92:95], v[20:23]
    ds_read_b128 v[76:79], v3 offset:40960
    v_add_f32 v56, v56, v64
    v_mfma_f32_16x16x32_bf16 v[24:27], a[228:231], v[96:99], v[24:27]
    v_add_f32 v57, v57, v65
    v_mov_b32 v64, v56
    v_mfma_f32_16x16x32_bf16 v[32:35], a[232:235], v[96:99], v[32:35]
    buffer_load_dwordx4 v6, s[8:11], s41 offen offset:1536 sc1 lds
    v_mfma_f32_16x16x32_bf16 v[28:31], a[232:235], v[92:95], v[28:31]
    s_add_u32 m0, s43, 149888
    ds_read_b128 v[80:83], v3 offset:43008
    v_mov_b32 v65, v57
    v_mfma_f32_16x16x32_bf16 v[36:39], a[236:239], v[92:95], v[36:39]
    v_permlane32_swap_b32 v56, v64
    v_mfma_f32_16x16x32_bf16 v[40:43], a[236:239], v[96:99], v[40:43]
    s_waitcnt lgkmcnt(2)
    v_permlane32_swap_b32 v57, v65
    v_mfma_f32_16x16x32_bf16 v[20:23], a[240:243], v[68:71], v[20:23]
    ds_read_b128 v[84:87], v2 offset:45056
    v_add_f32 v56, v56, v64
    v_mfma_f32_16x16x32_bf16 v[24:27], a[240:243], v[72:75], v[24:27]
    v_add_f32 v57, v57, v65
    v_mul_f32 v112, 0xba800000, v56
    v_mfma_f32_16x16x32_bf16 v[32:35], a[244:247], v[72:75], v[32:35]
    buffer_load_dwordx4 v6, s[8:11], s41 offen offset:1664 sc1 lds
    v_mfma_f32_16x16x32_bf16 v[28:31], a[244:247], v[68:71], v[28:31]
    s_add_u32 m0, s43, 153856
    ds_read_b128 v[88:91], v2 offset:47104
    v_mul_f32 v57, 0x3a800000, v57
    v_mfma_f32_16x16x32_bf16 v[36:39], a[248:251], v[68:71], v[36:39]
    v_fma_f32 v57, -v112, v112, v57
    v_mov_b32 v113, v112
    v_mfma_f32_16x16x32_bf16 v[40:43], a[248:251], v[72:75], v[40:43]
    s_waitcnt lgkmcnt(2)
    v_max_f32 v57, 0, v57
    v_add_f32 v57, 0x3727c5ac, v57
    v_mfma_f32_16x16x32_bf16 v[20:23], a[252:255], v[76:79], v[20:23]
    ds_read_b128 v[92:95], v3 offset:45056
    v_mfma_f32_16x16x32_bf16 v[24:27], a[252:255], v[80:83], v[24:27]
    v_rsq_f32 v114, v57
    v_mfma_f32_16x16x32_bf16 v[32:35], v[128:131], v[80:83], v[32:35]
    buffer_load_dwordx4 v6, s[8:11], s41 offen offset:1792 sc1 lds
    v_mfma_f32_16x16x32_bf16 v[28:31], v[128:131], v[76:79], v[28:31]
    s_add_u32 m0, s43, 157824
    ds_read_b128 v[96:99], v3 offset:47104
    v_mfma_f32_16x16x32_bf16 v[36:39], v[132:135], v[76:79], v[36:39]
    v_permlane16_swap_b32 v112, v113
    v_mfma_f32_16x16x32_bf16 v[40:43], v[132:135], v[80:83], v[40:43]
    s_waitcnt lgkmcnt(2)
    v_mov_b32 v115, v114
    v_fmac_f32 v24, v113, v100
    v_mfma_f32_16x16x32_bf16 v[20:23], v[136:139], v[84:87], v[20:23]
    ds_read_b128 v[68:71], v2 offset:49152
    v_fmac_f32 v28, v112, v104
    v_mfma_f32_16x16x32_bf16 v[24:27], v[136:139], v[88:91], v[24:27]
    v_permlane16_swap_b32 v114, v115
    v_mfma_f32_16x16x32_bf16 v[32:35], v[140:143], v[88:91], v[32:35]
    buffer_load_dwordx4 v6, s[8:11], s41 offen offset:1920 sc1 lds
    v_mfma_f32_16x16x32_bf16 v[28:31], v[140:143], v[84:87], v[28:31]
    s_add_u32 m0, s52, 92160
    ds_read_b128 v[72:75], v2 offset:51200
    v_fmac_f32 v20, v112, v100
    v_mfma_f32_16x16x32_bf16 v[36:39], v[144:147], v[84:87], v[36:39]
    v_fmac_f32 v21, v112, v101
    v_fmac_f32 v22, v112, v102
    v_mfma_f32_16x16x32_bf16 v[40:43], v[144:147], v[88:91], v[40:43]
    s_waitcnt lgkmcnt(2)
    v_fmac_f32 v25, v113, v101
    v_fmac_f32 v26, v113, v102
    v_mfma_f32_16x16x32_bf16 v[20:23], v[148:151], v[92:95], v[20:23]
    ds_read_b128 v[76:79], v3 offset:49152
    v_fmac_f32 v29, v112, v105
    v_mfma_f32_16x16x32_bf16 v[24:27], v[148:151], v[96:99], v[24:27]
    v_fmac_f32 v30, v112, v106
    v_fmac_f32 v31, v112, v107
    v_mfma_f32_16x16x32_bf16 v[32:35], v[152:155], v[96:99], v[32:35]
    buffer_load_dwordx4 v1, s[16:19], s46 offen sc1 lds
    v_mfma_f32_16x16x32_bf16 v[28:31], v[152:155], v[92:95], v[28:31]
    s_cmp_eq_u32 s36, s97
    ds_read_b128 v[80:83], v3 offset:51200
    v_med3_i32 v117, s45, 0, v12
    v_mfma_f32_16x16x32_bf16 v[36:39], v[156:159], v[92:95], v[36:39]
    s_cselect_b32 s47, 32, -2
    v_add_u32 v117, v117, v11
    v_fmac_f32 v23, v112, v103
    v_mfma_f32_16x16x32_bf16 v[40:43], v[156:159], v[96:99], v[40:43]
    s_waitcnt lgkmcnt(2)
    v_fmac_f32 v27, v113, v103
    v_fmac_f32 v32, v113, v104
    v_mfma_f32_16x16x32_bf16 v[20:23], v[160:163], v[68:71], v[20:23]
    s_cselect_b64 s[8:9], s[88:89], s[8:9]
    ds_read_b128 v[84:87], v2 offset:53248
    v_fmac_f32 v33, v113, v105
    v_mfma_f32_16x16x32_bf16 v[24:27], v[160:163], v[72:75], v[24:27]
    s_cselect_b32 s55, 0x543fc00, s55
    v_fmac_f32 v36, v112, v108
    v_fmac_f32 v37, v112, v109
    v_mfma_f32_16x16x32_bf16 v[32:35], v[164:167], v[72:75], v[32:35]
    s_add_u32 s45, s45, 65536
    v_fmac_f32 v38, v112, v110
    v_fmac_f32 v39, v112, v111
    v_mfma_f32_16x16x32_bf16 v[28:31], v[164:167], v[68:71], v[28:31]
    s_add_u32 s50, s50, s47
    ds_read_b128 v[88:91], v2 offset:55296
    v_fmac_f32 v40, v113, v108
    v_mfma_f32_16x16x32_bf16 v[36:39], v[168:171], v[68:71], v[36:39]
    buffer_load_dword v116, v117, s[16:19], 0 offen sc1
    v_mfma_f32_16x16x32_bf16 v[40:43], v[168:171], v[72:75], v[40:43]
    s_waitcnt lgkmcnt(2)
    v_fmac_f32 v34, v113, v106
    v_fmac_f32 v35, v113, v107
    v_mfma_f32_16x16x32_bf16 v[20:23], v[172:175], v[76:79], v[20:23]
    s_max_i32 s47, s50, 0
    ds_read_b128 v[92:95], v3 offset:53248
    s_min_i32 s47, s47, s96
    v_mfma_f32_16x16x32_bf16 v[24:27], v[172:175], v[80:83], v[24:27]
    s_lshl_b32 s41, s47, 15
    v_fmac_f32 v41, v113, v109
    v_fmac_f32 v42, v113, v110
    v_mfma_f32_16x16x32_bf16 v[32:35], v[176:179], v[80:83], v[32:35]
    s_lshl_b32 s46, s47, 10
    v_fmac_f32 v43, v113, v111
    s_sub_u32 s46, s55, s46
    v_mfma_f32_16x16x32_bf16 v[28:31], v[176:179], v[76:79], v[28:31]
    ds_read_b128 v[96:99], v3 offset:55296
    v_mfma_f32_16x16x32_bf16 v[36:39], v[180:183], v[76:79], v[36:39]
    v_mfma_f32_16x16x32_bf16 v[40:43], v[180:183], v[80:83], v[40:43]
    s_waitcnt lgkmcnt(2)
    v_mfma_f32_16x16x32_bf16 v[20:23], v[184:187], v[84:87], v[20:23]
    ds_read_b128 v[68:71], v2 offset:57344
    v_mfma_f32_16x16x32_bf16 v[24:27], v[184:187], v[88:91], v[24:27]
    v_mfma_f32_16x16x32_bf16 v[32:35], v[188:191], v[88:91], v[32:35]
    v_mfma_f32_16x16x32_bf16 v[28:31], v[188:191], v[84:87], v[28:31]
    ds_read_b128 v[72:75], v2 offset:59392
    v_mfma_f32_16x16x32_bf16 v[36:39], v[192:195], v[84:87], v[36:39]
    s_waitcnt vmcnt(9)
    s_barrier
    v_mfma_f32_16x16x32_bf16 v[40:43], v[192:195], v[88:91], v[40:43]
    s_waitcnt lgkmcnt(2)
    v_mfma_f32_16x16x32_bf16 v[20:23], v[196:199], v[92:95], v[20:23]
    ds_read_b128 v[76:79], v3 offset:57344
    v_mfma_f32_16x16x32_bf16 v[24:27], v[196:199], v[96:99], v[24:27]
    buffer_store_dword v124, v124, s[16:19], s91 offen sc1
    v_mfma_f32_16x16x32_bf16 v[32:35], v[200:203], v[96:99], v[32:35]
    s_add_u32 s91, s91, 65536
    v_mfma_f32_16x16x32_bf16 v[28:31], v[200:203], v[92:95], v[28:31]
    ds_read_b128 v[80:83], v3 offset:59392
    v_mfma_f32_16x16x32_bf16 v[36:39], v[204:207], v[92:95], v[36:39]
    v_mfma_f32_16x16x32_bf16 v[40:43], v[204:207], v[96:99], v[40:43]
    s_waitcnt lgkmcnt(2)
    v_mfma_f32_16x16x32_bf16 v[20:23], v[208:211], v[68:71], v[20:23]
    ds_read_b128 v[84:87], v2 offset:61440
    v_mfma_f32_16x16x32_bf16 v[24:27], v[208:211], v[72:75], v[24:27]
    v_mfma_f32_16x16x32_bf16 v[32:35], v[212:215], v[72:75], v[32:35]
    v_mfma_f32_16x16x32_bf16 v[28:31], v[212:215], v[68:71], v[28:31]
    ds_read_b128 v[88:91], v2 offset:63488
    v_mfma_f32_16x16x32_bf16 v[36:39], v[216:219], v[68:71], v[36:39]
    v_mfma_f32_16x16x32_bf16 v[40:43], v[216:219], v[72:75], v[40:43]
    s_waitcnt lgkmcnt(2)
    v_mfma_f32_16x16x32_bf16 v[20:23], v[220:223], v[76:79], v[20:23]
    ds_read_b128 v[92:95], v3 offset:61440
    v_mfma_f32_16x16x32_bf16 v[24:27], v[220:223], v[80:83], v[24:27]
    v_mfma_f32_16x16x32_bf16 v[32:35], v[224:227], v[80:83], v[32:35]
    v_mfma_f32_16x16x32_bf16 v[28:31], v[224:227], v[76:79], v[28:31]
    ds_read_b128 v[96:99], v3 offset:63488
    v_mfma_f32_16x16x32_bf16 v[36:39], v[228:231], v[76:79], v[36:39]
    v_mfma_f32_16x16x32_bf16 v[40:43], v[228:231], v[80:83], v[40:43]
    s_waitcnt lgkmcnt(2)
    v_mfma_f32_16x16x32_bf16 v[20:23], v[232:235], v[84:87], v[20:23]
    ds_read_b128 v[68:71], v4 offset:0
    v_mfma_f32_16x16x32_bf16 v[24:27], v[232:235], v[88:91], v[24:27]
    v_mfma_f32_16x16x32_bf16 v[32:35], v[236:239], v[88:91], v[32:35]
    v_mfma_f32_16x16x32_bf16 v[28:31], v[236:239], v[84:87], v[28:31]
    ds_read_b128 v[72:75], v4 offset:2048
    v_mfma_f32_16x16x32_bf16 v[36:39], v[240:243], v[84:87], v[36:39]
    v_mfma_f32_16x16x32_bf16 v[40:43], v[240:243], v[88:91], v[40:43]
    s_waitcnt lgkmcnt(2)
    v_mfma_f32_16x16x32_bf16 v[20:23], v[244:247], v[92:95], v[20:23]
    ds_read_b128 v[76:79], v5 offset:0
    v_mfma_f32_16x16x32_bf16 v[24:27], v[244:247], v[96:99], v[24:27]
    v_mfma_f32_16x16x32_bf16 v[32:35], v[248:251], v[96:99], v[32:35]
    v_mfma_f32_16x16x32_bf16 v[28:31], v[248:251], v[92:95], v[28:31]
    ds_read_b128 v[80:83], v5 offset:2048
    v_mfma_f32_16x16x32_bf16 v[36:39], v[252:255], v[92:95], v[36:39]
    s_add_u32 s36, s36, 1
    v_mfma_f32_16x16x32_bf16 v[40:43], v[252:255], v[96:99], v[40:43]
    s_waitcnt lgkmcnt(2)
    s_cmp_eq_u32 s36, 16
    s_cbranch_scc1 L_q_short
L_q_b1:
    v_mfma_f32_16x16x32_bf16 v[44:47], a[0:3], v[68:71], 0
    ds_read_b128 v[84:87], v4 offset:4096
    v_mul_f32 v20, v20, v114
    v_mfma_f32_16x16x32_bf16 v[48:51], a[0:3], v[72:75], 0
    v_mul_f32 v21, v21, v114
    v_mul_f32 v22, v22, v114
    v_mfma_f32_16x16x32_bf16 v[56:59], a[4:7], v[72:75], 0
    v_mul_f32 v23, v23, v114
    v_cvt_pk_bf16_f32 v20, v20, v21
    v_mfma_f32_16x16x32_bf16 v[52:55], a[4:7], v[68:71], 0
    ds_read_b128 v[88:91], v4 offset:6144
    v_cvt_pk_bf16_f32 v21, v22, v23
    v_mfma_f32_16x16x32_bf16 v[60:63], a[8:11], v[68:71], 0
    ds_write_b64 v7, v[20:21] offset:0
    v_mfma_f32_16x16x32_bf16 v[64:67], a[8:11], v[72:75], 0
    s_waitcnt lgkmcnt(3)
    v_mul_f32 v24, v24, v115
    v_mul_f32 v25, v25, v115
    v_mfma_f32_16x16x32_bf16 v[44:47], a[12:15], v[76:79], v[44:47]
    ds_read_b128 v[92:95], v5 offset:4096
    v_mul_f32 v26, v26, v115
    v_mfma_f32_16x16x32_bf16 v[48:51], a[12:15], v[80:83], v[48:51]
    v_mul_f32 v27, v27, v115
    v_cvt_pk_bf16_f32 v24, v24, v25
    v_mfma_f32_16x16x32_bf16 v[56:59], a[16:19], v[80:83], v[56:59]
    v_cvt_pk_bf16_f32 v25, v26, v27
    v_mfma_f32_16x16x32_bf16 v[52:55], a[16:19], v[76:79], v[52:55]
    ds_read_b128 v[96:99], v5 offset:6144
    v_mfma_f32_16x16x32_bf16 v[60:63], a[20:23], v[76:79], v[60:63]
    ds_write_b64 v7, v[24:25] offset:6144
    v_mfma_f32_16x16x32_bf16 v[64:67], a[20:23], v[80:83], v[64:67]
    s_waitcnt lgkmcnt(4)
    v_mul_f32 v28, v28, v114
    v_mul_f32 v29, v29, v114
    v_mfma_f32_16x16x32_bf16 v[44:47], a[24:27], v[84:87], v[44:47]
    ds_read_b128 v[68:71], v4 offset:8192
    v_mul_f32 v30, v30, v114
    v_mfma_f32_16x16x32_bf16 v[48:51], a[24:27], v[88:91], v[48:51]
    v_mul_f32 v31, v31, v114
    v_cvt_pk_bf16_f32 v28, v28, v29
    v_mfma_f32_16x16x32_bf16 v[56:59], a[28:31], v[88:91], v[56:59]
    v_cvt_pk_bf16_f32 v29, v30, v31
    v_mfma_f32_16x16x32_bf16 v[52:55], a[28:31], v[84:87], v[52:55]
    ds_read_b128 v[72:75], v4 offset:10240
    v_mfma_f32_16x16x32_bf16 v[60:63], a[32:35], v[84:87], v[60:63]
    ds_write_b64 v7, v[28:29] offset:1024
    v_mfma_f32_16x16x32_bf16 v[64:67], a[32:35], v[88:91], v[64:67]
    s_waitcnt lgkmcnt(4)
    v_mul_f32 v32, v32, v115
    v_mul_f32 v33, v33, v115
    v_mfma_f32_16x16x32_bf16 v[44:47], a[36:39], v[92:95], v[44:47]
    ds_read_b128 v[76:79], v5 offset:8192
    v_mul_f32 v34, v34, v115
    v_mfma_f32_16x16x32_bf16 v[48:51], a[36:39], v[96:99], v[48:51]
    v_mul_f32 v35, v35, v115
    v_cvt_pk_bf16_f32 v32, v32, v33
    v_mfma_f32_16x16x32_bf16 v[56:59], a[40:43], v[96:99], v[56:59]
    v_cvt_pk_bf16_f32 v33, v34, v35
    v_mfma_f32_16x16x32_bf16 v[52:55], a[40:43], v[92:95], v[52:55]
    ds_read_b128 v[80:83], v5 offset:10240
    v_mfma_f32_16x16x32_bf16 v[60:63], a[44:47], v[92:95], v[60:63]
    ds_write_b64 v7, v[32:33] offset:7168
    v_mfma_f32_16x16x32_bf16 v[64:67], a[44:47], v[96:99], v[64:67]
    s_waitcnt lgkmcnt(4)
    v_mul_f32 v36, v36, v114
    v_mul_f32 v37, v37, v114
    v_mfma_f32_16x16x32_bf16 v[44:47], a[48:51], v[68:71], v[44:47]
    s_waitcnt vmcnt(1)
    ds_read_b128 v[84:87], v4 offset:12288
    v_cmp_ne_u32 vcc, 0, v116
    v_mfma_f32_16x16x32_bf16 v[48:51], a[48:51], v[72:75], v[48:51]
    v_mul_f32 v38, v38, v114
    v_mul_f32 v39, v39, v114
    v_mfma_f32_16x16x32_bf16 v[56:59], a[52:55], v[72:75], v[56:59]
    s_cbranch_vccnz L_spin9
L_back10:
    v_cvt_pk_bf16_f32 v36, v36, v37
    v_cvt_pk_bf16_f32 v37, v38, v39
    v_mfma_f32_16x16x32_bf16 v[52:55], a[52:55], v[68:71], v[52:55]
    ds_read_b128 v[88:91], v4 offset:14336
    v_mfma_f32_16x16x32_bf16 v[60:63], a[56:59], v[68:71], v[60:63]
    ds_write_b64 v8, v[36:37] offset:2048
    v_mfma_f32_16x16x32_bf16 v[64:67], a[56:59], v[72:75], v[64:67]
    s_waitcnt lgkmcnt(4)
    v_mul_f32 v40, v40, v115
    v_mul_f32 v41, v41, v115
    v_mfma_f32_16x16x32_bf16 v[44:47], a[60:63], v[76:79], v[44:47]
    ds_read_b128 v[92:95], v5 offset:12288
    v_mul_f32 v42, v42, v115
    v_mfma_f32_16x16x32_bf16 v[48:51], a[60:63], v[80:83], v[48:51]
    v_mul_f32 v43, v43, v115
    v_cvt_pk_bf16_f32 v40, v40, v41
    v_mfma_f32_16x16x32_bf16 v[56:59], a[64:67], v[80:83], v[56:59]
    v_cvt_pk_bf16_f32 v41, v42, v43
    v_mfma_f32_16x16x32_bf16 v[52:55], a[64:67], v[76:79], v[52:55]
    ds_read_b128 v[96:99], v5 offset:14336
    v_mfma_f32_16x16x32_bf16 v[60:63], a[68:71], v[76:79], v[60:63]
    ds_write_b64 v8, v[40:41] offset:8192
    v_mfma_f32_16x16x32_bf16 v[64:67], a[68:71], v[80:83], v[64:67]
    s_waitcnt lgkmcnt(4)
    v_mfma_f32_16x16x32_bf16 v[44:47], a[72:75], v[84:87], v[44:47]
    ds_read_b128 v[68:71], v4 offset:16384
    v_mfma_f32_16x16x32_bf16 v[48:51], a[72:75], v[88:91], v[48:51]
    v_mfma_f32_16x16x32_bf16 v[56:59], a[76:79], v[88:91], v[56:59]
    s_waitcnt lgkmcnt(1)
    s_barrier
    v_mfma_f32_16x16x32_bf16 v[52:55], a[76:79], v[84:87], v[52:55]
    ds_read_b128 v[72:75], v4 offset:18432
    v_mfma_f32_16x16x32_bf16 v[60:63], a[80:83], v[84:87], v[60:63]
    ds_read_b128 v[20:23], v10 offset:0
    v_mfma_f32_16x16x32_bf16 v[64:67], a[80:83], v[88:91], v[64:67]
    s_waitcnt lgkmcnt(4)
    ds_read_b128 v[24:27], v9 offset:1024
    v_mfma_f32_16x16x32_bf16 v[44:47], a[84:87], v[92:95], v[44:47]
    ds_read_b128 v[76:79], v5 offset:16384
    v_mfma_f32_16x16x32_bf16 v[48:51], a[84:87], v[96:99], v[48:51]
    ds_read_b128 v[28:31], v10 offset:1024
    s_add_u32 m0, s43, 0
    v_mfma_f32_16x16x32_bf16 v[56:59], a[88:91], v[96:99], v[56:59]
    buffer_load_dwordx4 v6, s[8:11], s41 offen offset:0 sc1 lds
    v_mfma_f32_16x16x32_bf16 v[52:55], a[88:91], v[92:95], v[52:55]
    s_add_u32 m0, s43, 3968
    ds_read_b128 v[80:83], v5 offset:18432
    v_mfma_f32_16x16x32_bf16 v[60:63], a[92:95], v[92:95], v[60:63]
    ds_read_b64_tr_b16 v[32:33], v9 offset:2048
    v_mfma_f32_16x16x32_bf16 v[64:67], a[92:95], v[96:99], v[64:67]
    s_waitcnt lgkmcnt(6)
    ds_read_b64_tr_b16 v[34:35], v10 offset:2048
    s_waitcnt lgkmcnt(3)
    v_mfma_f32_16x16x32_bf16 v[44:47], a[96:99], v[68:71], v[44:47]
    ds_read_b128 v[84:87], v4 offset:20480
    v_mfma_f32_16x16x32_bf16 v[40:43], v[24:27], v[20:23], 0
    ds_read_b64_tr_b16 v[36:37], v9 offset:2056
    v_mfma_f32_16x16x32_bf16 v[118:121], v[28:31], v[20:23], 0
    ds_read_b64_tr_b16 v[38:39], v10 offset:2056
    v_mfma_f32_16x16x32_bf16 v[48:51], a[96:99], v[72:75], v[48:51]
    v_mfma_f32_16x16x32_bf16 v[56:59], a[100:103], v[72:75], v[56:59]
    buffer_load_dwordx4 v6, s[8:11], s41 offen offset:128 sc1 lds
    v_mfma_f32_16x16x32_bf16 v[52:55], a[100:103], v[68:71], v[52:55]
    s_add_u32 m0, s43, 7936
    ds_read_b128 v[88:91], v4 offset:22528
    v_cndmask_b32 v40, v40, v41, s[56:57]
    v_mfma_f32_16x16x32_bf16 v[60:63], a[104:107], v[68:71], v[60:63]
    v_cndmask_b32 v42, v42, v43, s[56:57]
    v_cndmask_b32 v118, v118, v119, s[56:57]
    v_mfma_f32_16x16x32_bf16 v[64:67], a[104:107], v[72:75], v[64:67]
    s_waitcnt lgkmcnt(6)
    v_cndmask_b32 v120, v120, v121, s[56:57]
    v_cndmask_b32 v40, v18, v40, s[62:63]
    v_mfma_f32_16x16x32_bf16 v[44:47], a[108:111], v[76:79], v[44:47]
    ds_read_b128 v[92:95], v5 offset:20480
    v_cndmask_b32 v42, v18, v42, s[62:63]
    v_mfma_f32_16x16x32_bf16 v[48:51], a[108:111], v[80:83], v[48:51]
    v_cndmask_b32 v22, v40, v118, s[58:59]
    v_cndmask_b32 v23, v42, v120, s[60:61]
    v_mfma_f32_16x16x32_bf16 v[56:59], a[112:115], v[80:83], v[56:59]
    buffer_load_dwordx4 v6, s[8:11], s41 offen offset:256 sc1 lds
    v_mfma_f32_16x16x32_bf16 v[52:55], a[112:115], v[76:79], v[52:55]
    s_add_u32 m0, s43, 11904
    ds_read_b128 v[96:99], v5 offset:22528
    v_max_f32 v20, v22, v23
    v_mfma_f32_16x16x32_bf16 v[60:63], a[116:119], v[76:79], v[60:63]
    v_mov_b32 v21, v20
    v_mfma_f32_16x16x32_bf16 v[64:67], a[116:119], v[80:83], v[64:67]
    s_waitcnt lgkmcnt(2)
    v_permlane16_swap_b32 v20, v21
    v_mfma_f32_16x16x32_bf16 v[44:47], a[120:123], v[84:87], v[44:47]
    ds_read_b128 v[68:71], v4 offset:24576
    v_max_f32 v20, v20, v21
    v_mfma_f32_16x16x32_bf16 v[48:51], a[120:123], v[88:91], v[48:51]
    v_mov_b32 v21, v20
    v_mfma_f32_16x16x32_bf16 v[56:59], a[124:127], v[88:91], v[56:59]
    buffer_load_dwordx4 v6, s[8:11], s41 offen offset:384 sc1 lds
    v_mfma_f32_16x16x32_bf16 v[52:55], a[124:127], v[84:87], v[52:55]
    s_add_u32 m0, s43, 15872
    ds_read_b128 v[72:75], v4 offset:26624
    v_mfma_f32_16x16x32_bf16 v[60:63], a[128:131], v[84:87], v[60:63]
    v_permlane32_swap_b32 v20, v21
    v_mfma_f32_16x16x32_bf16 v[64:67], a[128:131], v[88:91], v[64:67]
    s_waitcnt lgkmcnt(2)
    v_max_f32 v20, v20, v21
    v_mul_f32 v20, s86, v20
    v_mfma_f32_16x16x32_bf16 v[44:47], a[132:135], v[92:95], v[44:47]
    ds_read_b128 v[76:79], v5 offset:24576
    v_fma_f32 v22, v22, s86, -v20
    v_mfma_f32_16x16x32_bf16 v[48:51], a[132:135], v[96:99], v[48:51]
    v_fma_f32 v23, v23, s86, -v20
    v_mfma_f32_16x16x32_bf16 v[56:59], a[136:139], v[96:99], v[56:59]
    buffer_load_dwordx4 v6, s[8:11], s41 offen offset:512 sc1 lds
    v_mfma_f32_16x16x32_bf16 v[52:55], a[136:139], v[92:95], v[52:55]
    s_add_u32 m0, s43, 19840
    ds_read_b128 v[80:83], v5 offset:26624
    v_mfma_f32_16x16x32_bf16 v[60:63], a[140:143], v[92:95], v[60:63]
    v_exp_f32 v22, v22
    v_mfma_f32_16x16x32_bf16 v[64:67], a[140:143], v[96:99], v[64:67]
    s_waitcnt lgkmcnt(2)
    v_exp_f32 v23, v23
    v_mfma_f32_16x16x32_bf16 v[44:47], a[144:147], v[68:71], v[44:47]
    ds_read_b128 v[84:87], v4 offset:28672
    v_cvt_pk_bf16_f32 v28, v22, v23
    v_mfma_f32_16x16x32_bf16 v[48:51], a[144:147], v[72:75], v[48:51]
    v_perm_b32 v24, v28, v28, v14
    v_perm_b32 v25, v28, v28, v15
    v_mfma_f32_16x16x32_bf16 v[56:59], a[148:151], v[72:75], v[56:59]
    buffer_load_dwordx4 v6, s[8:11], s41 offen offset:640 sc1 lds
    v_mfma_f32_16x16x32_bf16 v[52:55], a[148:151], v[68:71], v[52:55]
    s_add_u32 m0, s43, 23808
    ds_read_b128 v[88:91], v4 offset:30720
    v_perm_b32 v26, v28, v28, v16
    v_mfma_f32_16x16x32_bf16 v[60:63], a[152:155], v[68:71], v[60:63]
    v_perm_b32 v27, v28, v28, v17
    v_add_f32 v20, v22, v23
    v_mfma_f32_16x16x32_bf16 v[64:67], a[152:155], v[72:75], v[64:67]
    s_waitcnt lgkmcnt(2)
    v_mov_b32 v21, v20
    s_waitcnt lgkmcnt(9)
    v_mfma_f32_16x16x32_bf16 v[44:47], a[156:159], v[76:79], v[44:47]
    ds_read_b128 v[92:95], v5 offset:28672
    v_mfma_f32_16x16x32_bf16 v[40:43], v[32:35], v[24:27], 0
    v_mfma_f32_16x16x32_bf16 v[118:121], v[36:39], v[24:27], 0
    v_permlane16_swap_b32 v20, v21
    v_mfma_f32_16x16x32_bf16 v[48:51], a[156:159], v[80:83], v[48:51]
    v_add_f32 v20, v20, v21
    v_mov_b32 v21, v20
    v_mfma_f32_16x16x32_bf16 v[56:59], a[160:163], v[80:83], v[56:59]
    buffer_load_dwordx4 v6, s[8:11], s41 offen offset:768 sc1 lds
    v_mfma_f32_16x16x32_bf16 v[52:55], a[160:163], v[76:79], v[52:55]
    s_add_u32 m0, s43, 27776
    ds_read_b128 v[96:99], v5 offset:30720
    v_mfma_f32_16x16x32_bf16 v[60:63], a[164:167], v[76:79], v[60:63]
    v_permlane32_swap_b32 v20, v21
    v_mfma_f32_16x16x32_bf16 v[64:67], a[164:167], v[80:83], v[64:67]
    s_waitcnt lgkmcnt(2)
    v_add_f32 v20, v20, v21
    v_mfma_f32_16x16x32_bf16 v[44:47], a[168:171], v[84:87], v[44:47]
    ds_read_b128 v[68:71], v4 offset:32768
    v_mfma_f32_16x16x32_bf16 v[48:51], a[168:171], v[88:91], v[48:51]
    v_rcp_f32 v20, v20
    v_mfma_f32_16x16x32_bf16 v[56:59], a[172:175], v[88:91], v[56:59]
    buffer_load_dwordx4 v6, s[8:11], s41 offen offset:896 sc1 lds
    v_mfma_f32_16x16x32_bf16 v[52:55], a[172:175], v[84:87], v[52:55]
    s_add_u32 m0, s43, 31744
    ds_read_b128 v[72:75], v4 offset:34816
    v_mul_f32 v40, v40, v20
    v_mfma_f32_16x16x32_bf16 v[60:63], a[176:179], v[84:87], v[60:63]
    v_mul_f32 v41, v41, v20
    v_mul_f32 v42, v42, v20
    v_mfma_f32_16x16x32_bf16 v[64:67], a[176:179], v[88:91], v[64:67]
    s_waitcnt lgkmcnt(2)
    v_mul_f32 v43, v43, v20
    v_cvt_pk_bf16_f32 v28, v40, v41
    v_mfma_f32_16x16x32_bf16 v[44:47], a[180:183], v[92:95], v[44:47]
    ds_read_b128 v[76:79], v5 offset:32768
    v_cvt_pk_bf16_f32 v29, v42, v43
    v_mfma_f32_16x16x32_bf16 v[48:51], a[180:183], v[96:99], v[48:51]
    v_mul_f32 v118, v118, v20
    v_mul_f32 v119, v119, v20
    v_mfma_f32_16x16x32_bf16 v[56:59], a[184:187], v[96:99], v[56:59]
    buffer_load_dwordx4 v6, s[8:11], s41 offen offset:1024 sc1 lds
    v_mfma_f32_16x16x32_bf16 v[52:55], a[184:187], v[92:95], v[52:55]
    s_add_u32 m0, s43, 35712
    ds_read_b128 v[80:83], v5 offset:34816
    v_mul_f32 v120, v120, v20
    v_mfma_f32_16x16x32_bf16 v[60:63], a[188:191], v[92:95], v[60:63]
    v_mul_f32 v121, v121, v20
    v_cvt_pk_bf16_f32 v30, v118, v119
    v_mfma_f32_16x16x32_bf16 v[64:67], a[188:191], v[96:99], v[64:67]
    s_waitcnt lgkmcnt(2)
    v_cvt_pk_bf16_f32 v31, v120, v121
    v_mfma_f32_16x16x32_bf16 v[44:47], a[192:195], v[68:71], v[44:47]
    ds_read_b128 v[84:87], v4 offset:36864
    v_mfma_f32_16x16x32_bf16 v[48:51], a[192:195], v[72:75], v[48:51]
    buffer_store_dwordx4 v[28:31], v1, s[16:19], s44 offen sc1
    v_mfma_f32_16x16x32_bf16 v[56:59], a[196:199], v[72:75], v[56:59]
    buffer_load_dwordx4 v6, s[8:11], s41 offen offset:1152 sc1 lds
    v_mfma_f32_16x16x32_bf16 v[52:55], a[196:199], v[68:71], v[52:55]
    s_add_u32 m0, s43, 39680
    ds_read_b128 v[88:91], v4 offset:38912
    s_cmp_eq_u32 s36, 17
    v_mfma_f32_16x16x32_bf16 v[60:63], a[200:203], v[68:71], v[60:63]
    s_cselect_b32 s49, s87, 0x10000
    ds_read_b64 v[32:33], v13 offset:2048
    s_add_u32 s90, s90, s49
    v_mfma_f32_16x16x32_bf16 v[64:67], a[200:203], v[72:75], v[64:67]
    s_waitcnt lgkmcnt(3)
    ds_read_b64 v[34:35], v13 offset:2176
    s_and_b32 s49, s90, 0xffffffff
    v_mfma_f32_16x16x32_bf16 v[44:47], a[204:207], v[76:79], v[44:47]
    s_bitcmp1_b64 s[24:25], s36
    ds_read_b128 v[92:95], v5 offset:36864
    s_cselect_b32 s44, s49, 0x5e00000
    v_mfma_f32_16x16x32_bf16 v[48:51], a[204:207], v[80:83], v[48:51]
    s_bitcmp1_b64 s[26:27], s36
    ds_read_b64 v[36:37], v13 offset:2304
    s_cselect_b64 s[62:63], 0, -1
    v_mfma_f32_16x16x32_bf16 v[56:59], a[208:211], v[80:83], v[56:59]
    buffer_load_dwordx4 v6, s[8:11], s41 offen offset:1280 sc1 lds
    v_mfma_f32_16x16x32_bf16 v[52:55], a[208:211], v[76:79], v[52:55]
    s_add_u32 m0, s43, 43648
    ds_read_b128 v[96:99], v5 offset:38912
    v_mfma_f32_16x16x32_bf16 v[60:63], a[212:215], v[76:79], v[60:63]
    ds_read_b64 v[38:39], v13 offset:2432
    v_mfma_f32_16x16x32_bf16 v[64:67], a[212:215], v[80:83], v[64:67]
    s_waitcnt lgkmcnt(6)
    v_mfma_f32_16x16x32_bf16 v[44:47], a[216:219], v[84:87], v[44:47]
    ds_read_b128 v[68:71], v4 offset:40960
    v_mfma_f32_16x16x32_bf16 v[48:51], a[216:219], v[88:91], v[48:51]
    v_mfma_f32_16x16x32_bf16 v[56:59], a[220:223], v[88:91], v[56:59]
    buffer_load_dwordx4 v6, s[8:11], s41 offen offset:1408 sc1 lds
    v_mfma_f32_16x16x32_bf16 v[52:55], a[220:223], v[84:87], v[52:55]
    s_add_u32 m0, s43, 47616
    ds_read_b128 v[72:75], v4 offset:43008
    s_waitcnt lgkmcnt(2)
    v_mfma_f32_16x16x32_bf16 v[60:63], a[224:227], v[84:87], v[60:63]
    v_add_f32 v40, v36, v38
    v_add_f32 v41, v37, v39
    v_mfma_f32_16x16x32_bf16 v[64:67], a[224:227], v[88:91], v[64:67]
    s_waitcnt lgkmcnt(3)
    v_add_f32 v32, v32, v34
    v_add_f32 v33, v33, v35
    v_mfma_f32_16x16x32_bf16 v[44:47], a[228:231], v[92:95], v[44:47]
    ds_read_b128 v[76:79], v5 offset:40960
    v_add_f32 v32, v32, v40
    v_mfma_f32_16x16x32_bf16 v[48:51], a[228:231], v[96:99], v[48:51]
    v_add_f32 v33, v33, v41
    v_mov_b32 v40, v32
    v_mfma_f32_16x16x32_bf16 v[56:59], a[232:235], v[96:99], v[56:59]
    buffer_load_dwordx4 v6, s[8:11], s41 offen offset:1536 sc1 lds
    v_mfma_f32_16x16x32_bf16 v[52:55], a[232:235], v[92:95], v[52:55]
    s_add_u32 m0, s43, 51584
    ds_read_b128 v[80:83], v5 offset:43008
    v_mov_b32 v41, v33
    v_mfma_f32_16x16x32_bf16 v[60:63], a[236:239], v[92:95], v[60:63]
    v_permlane32_swap_b32 v32, v40
    v_mfma_f32_16x16x32_bf16 v[64:67], a[236:239], v[96:99], v[64:67]
    s_waitcnt lgkmcnt(2)
    v_permlane32_swap_b32 v33, v41
    v_mfma_f32_16x16x32_bf16 v[44:47], a[240:243], v[68:71], v[44:47]
    ds_read_b128 v[84:87], v4 offset:45056
    v_add_f32 v32, v32, v40
    v_mfma_f32_16x16x32_bf16 v[48:51], a[240:243], v[72:75], v[48:51]
    v_add_f32 v33, v33, v41
    v_mul_f32 v112, 0xba800000, v32
    v_mfma_f32_16x16x32_bf16 v[56:59], a[244:247], v[72:75], v[56:59]
    buffer_load_dwordx4 v6, s[8:11], s41 offen offset:1664 sc1 lds
    v_mfma_f32_16x16x32_bf16 v[52:55], a[244:247], v[68:71], v[52:55]
    s_add_u32 m0, s43, 55552
    ds_read_b128 v[88:91], v4 offset:47104
    v_mul_f32 v33, 0x3a800000, v33
    v_mfma_f32_16x16x32_bf16 v[60:63], a[248:251], v[68:71], v[60:63]
    v_fma_f32 v33, -v112, v112, v33
    v_mov_b32 v113, v112
    v_mfma_f32_16x16x32_bf16 v[64:67], a[248:251], v[72:75], v[64:67]
    s_waitcnt lgkmcnt(2)
    v_max_f32 v33, 0, v33
    v_add_f32 v33, 0x3727c5ac, v33
    v_mfma_f32_16x16x32_bf16 v[44:47], a[252:255], v[76:79], v[44:47]
    ds_read_b128 v[92:95], v5 offset:45056
    v_mfma_f32_16x16x32_bf16 v[48:51], a[252:255], v[80:83], v[48:51]
    v_rsq_f32 v114, v33
    v_mfma_f32_16x16x32_bf16 v[56:59], v[128:131], v[80:83], v[56:59]
    buffer_load_dwordx4 v6, s[8:11], s41 offen offset:1792 sc1 lds
    v_mfma_f32_16x16x32_bf16 v[52:55], v[128:131], v[76:79], v[52:55]
    s_add_u32 m0, s43, 59520
    ds_read_b128 v[96:99], v5 offset:47104
    v_mfma_f32_16x16x32_bf16 v[60:63], v[132:135], v[76:79], v[60:63]
    v_permlane16_swap_b32 v112, v113
    v_mfma_f32_16x16x32_bf16 v[64:67], v[132:135], v[80:83], v[64:67]
    s_waitcnt lgkmcnt(2)
    v_mov_b32 v115, v114
    v_fmac_f32 v48, v113, v100
    v_mfma_f32_16x16x32_bf16 v[44:47], v[136:139], v[84:87], v[44:47]
    ds_read_b128 v[68:71], v4 offset:49152
    v_fmac_f32 v52, v112, v104
    v_mfma_f32_16x16x32_bf16 v[48:51], v[136:139], v[88:91], v[48:51]
    v_permlane16_swap_b32 v114, v115
    v_mfma_f32_16x16x32_bf16 v[56:59], v[140:143], v[88:91], v[56:59]
    buffer_load_dwordx4 v6, s[8:11], s41 offen offset:1920 sc1 lds
    v_mfma_f32_16x16x32_bf16 v[52:55], v[140:143], v[84:87], v[52:55]
    s_add_u32 m0, s52, 90112
    ds_read_b128 v[72:75], v4 offset:51200
    v_fmac_f32 v44, v112, v100
    v_mfma_f32_16x16x32_bf16 v[60:63], v[144:147], v[84:87], v[60:63]
    v_fmac_f32 v45, v112, v101
    v_fmac_f32 v46, v112, v102
    v_mfma_f32_16x16x32_bf16 v[64:67], v[144:147], v[88:91], v[64:67]
    s_waitcnt lgkmcnt(2)
    v_fmac_f32 v49, v113, v101
    v_fmac_f32 v50, v113, v102
    v_mfma_f32_16x16x32_bf16 v[44:47], v[148:151], v[92:95], v[44:47]
    ds_read_b128 v[76:79], v5 offset:49152
    v_fmac_f32 v53, v112, v105
    v_mfma_f32_16x16x32_bf16 v[48:51], v[148:151], v[96:99], v[48:51]
    v_fmac_f32 v54, v112, v106
    v_fmac_f32 v55, v112, v107
    v_mfma_f32_16x16x32_bf16 v[56:59], v[152:155], v[96:99], v[56:59]
    buffer_load_dwordx4 v1, s[16:19], s46 offen sc1 lds
    v_mfma_f32_16x16x32_bf16 v[52:55], v[152:155], v[92:95], v[52:55]
    s_cmp_eq_u32 s36, s97
    ds_read_b128 v[80:83], v5 offset:51200
    v_med3_i32 v117, s45, 0, v12
    v_mfma_f32_16x16x32_bf16 v[60:63], v[156:159], v[92:95], v[60:63]
    s_cselect_b32 s47, 32, -2
    v_add_u32 v117, v117, v11
    v_fmac_f32 v47, v112, v103
    v_mfma_f32_16x16x32_bf16 v[64:67], v[156:159], v[96:99], v[64:67]
    s_waitcnt lgkmcnt(2)
    v_fmac_f32 v51, v113, v103
    v_fmac_f32 v56, v113, v104
    v_mfma_f32_16x16x32_bf16 v[44:47], v[160:163], v[68:71], v[44:47]
    s_cselect_b64 s[8:9], s[88:89], s[8:9]
    ds_read_b128 v[84:87], v4 offset:53248
    v_fmac_f32 v57, v113, v105
    v_mfma_f32_16x16x32_bf16 v[48:51], v[160:163], v[72:75], v[48:51]
    s_cselect_b32 s55, 0x543fc00, s55
    v_fmac_f32 v60, v112, v108
    v_fmac_f32 v61, v112, v109
    v_mfma_f32_16x16x32_bf16 v[56:59], v[164:167], v[72:75], v[56:59]
    s_add_u32 s45, s45, 65536
    v_fmac_f32 v62, v112, v110
    v_fmac_f32 v63, v112, v111
    v_mfma_f32_16x16x32_bf16 v[52:55], v[164:167], v[68:71], v[52:55]
    s_add_u32 s50, s50, s47
    ds_read_b128 v[88:91], v4 offset:55296
    v_fmac_f32 v64, v113, v108
    v_mfma_f32_16x16x32_bf16 v[60:63], v[168:171], v[68:71], v[60:63]
    buffer_load_dword v116, v117, s[16:19], 0 offen sc1
    v_mfma_f32_16x16x32_bf16 v[64:67], v[168:171], v[72:75], v[64:67]
    s_waitcnt lgkmcnt(2)
    v_fmac_f32 v58, v113, v106
    v_fmac_f32 v59, v113, v107
    v_mfma_f32_16x16x32_bf16 v[44:47], v[172:175], v[76:79], v[44:47]
    s_max_i32 s47, s50, 0
    ds_read_b128 v[92:95], v5 offset:53248
    s_min_i32 s47, s47, s96
    v_mfma_f32_16x16x32_bf16 v[48:51], v[172:175], v[80:83], v[48:51]
    s_lshl_b32 s41, s47, 15
    v_fmac_f32 v65, v113, v109
    v_fmac_f32 v66, v113, v110
    v_mfma_f32_16x16x32_bf16 v[56:59], v[176:179], v[80:83], v[56:59]
    s_lshl_b32 s46, s47, 10
    v_fmac_f32 v67, v113, v111
    s_sub_u32 s46, s55, s46
    v_mfma_f32_16x16x32_bf16 v[52:55], v[176:179], v[76:79], v[52:55]
    ds_read_b128 v[96:99], v5 offset:55296
    v_mfma_f32_16x16x32_bf16 v[60:63], v[180:183], v[76:79], v[60:63]
    v_mfma_f32_16x16x32_bf16 v[64:67], v[180:183], v[80:83], v[64:67]
    s_waitcnt lgkmcnt(2)
    v_mfma_f32_16x16x32_bf16 v[44:47], v[184:187], v[84:87], v[44:47]
    ds_read_b128 v[68:71], v4 offset:57344
    v_mfma_f32_16x16x32_bf16 v[48:51], v[184:187], v[88:91], v[48:51]
    v_mfma_f32_16x16x32_bf16 v[56:59], v[188:191], v[88:91], v[56:59]
    v_mfma_f32_16x16x32_bf16 v[52:55], v[188:191], v[84:87], v[52:55]
    ds_read_b128 v[72:75], v4 offset:59392
    v_mfma_f32_16x16x32_bf16 v[60:63], v[192:195], v[84:87], v[60:63]
    s_waitcnt vmcnt(9)
    s_barrier
    v_mfma_f32_16x16x32_bf16 v[64:67], v[192:195], v[88:91], v[64:67]
    s_waitcnt lgkmcnt(2)
    v_mfma_f32_16x16x32_bf16 v[44:47], v[196:199], v[92:95], v[44:47]
    ds_read_b128 v[76:79], v5 offset:57344
    v_mfma_f32_16x16x32_bf16 v[48:51], v[196:199], v[96:99], v[48:51]
    buffer_store_dword v124, v124, s[16:19], s91 offen sc1
    v_mfma_f32_16x16x32_bf16 v[56:59], v[200:203], v[96:99], v[56:59]
    s_add_u32 s91, s91, 65536
    v_mfma_f32_16x16x32_bf16 v[52:55], v[200:203], v[92:95], v[52:55]
    ds_read_b128 v[80:83], v5 offset:59392
    v_mfma_f32_16x16x32_bf16 v[60:63], v[204:207], v[92:95], v[60:63]
    v_mfma_f32_16x16x32_bf16 v[64:67], v[204:207], v[96:99], v[64:67]
    s_waitcnt lgkmcnt(2)
    v_mfma_f32_16x16x32_bf16 v[44:47], v[208:211], v[68:71], v[44:47]
    ds_read_b128 v[84:87], v4 offset:61440
    v_mfma_f32_16x16x32_bf16 v[48:51], v[208:211], v[72:75], v[48:51]
    v_mfma_f32_16x16x32_bf16 v[56:59], v[212:215], v[72:75], v[56:59]
    v_mfma_f32_16x16x32_bf16 v[52:55], v[212:215], v[68:71], v[52:55]
    ds_read_b128 v[88:91], v4 offset:63488
    v_mfma_f32_16x16x32_bf16 v[60:63], v[216:219], v[68:71], v[60:63]
    v_mfma_f32_16x16x32_bf16 v[64:67], v[216:219], v[72:75], v[64:67]
    s_waitcnt lgkmcnt(2)
    v_mfma_f32_16x16x32_bf16 v[44:47], v[220:223], v[76:79], v[44:47]
    ds_read_b128 v[92:95], v5 offset:61440
    v_mfma_f32_16x16x32_bf16 v[48:51], v[220:223], v[80:83], v[48:51]
    v_mfma_f32_16x16x32_bf16 v[56:59], v[224:227], v[80:83], v[56:59]
    v_mfma_f32_16x16x32_bf16 v[52:55], v[224:227], v[76:79], v[52:55]
    ds_read_b128 v[96:99], v5 offset:63488
    v_mfma_f32_16x16x32_bf16 v[60:63], v[228:231], v[76:79], v[60:63]
    v_mfma_f32_16x16x32_bf16 v[64:67], v[228:231], v[80:83], v[64:67]
    s_waitcnt lgkmcnt(2)
    v_mfma_f32_16x16x32_bf16 v[44:47], v[232:235], v[84:87], v[44:47]
    ds_read_b128 v[68:71], v2 offset:0
    v_mfma_f32_16x16x32_bf16 v[48:51], v[232:235], v[88:91], v[48:51]
    v_mfma_f32_16x16x32_bf16 v[56:59], v[236:239], v[88:91], v[56:59]
    v_mfma_f32_16x16x32_bf16 v[52:55], v[236:239], v[84:87], v[52:55]
    ds_read_b128 v[72:75], v2 offset:2048
    v_mfma_f32_16x16x32_bf16 v[60:63], v[240:243], v[84:87], v[60:63]
    v_mfma_f32_16x16x32_bf16 v[64:67], v[240:243], v[88:91], v[64:67]
    s_waitcnt lgkmcnt(2)
    v_mfma_f32_16x16x32_bf16 v[44:47], v[244:247], v[92:95], v[44:47]
    ds_read_b128 v[76:79], v3 offset:0
    v_mfma_f32_16x16x32_bf16 v[48:51], v[244:247], v[96:99], v[48:51]
    v_mfma_f32_16x16x32_bf16 v[56:59], v[248:251], v[96:99], v[56:59]
    v_mfma_f32_16x16x32_bf16 v[52:55], v[248:251], v[92:95], v[52:55]
    ds_read_b128 v[80:83], v3 offset:2048
    v_mfma_f32_16x16x32_bf16 v[60:63], v[252:255], v[92:95], v[60:63]
    s_add_u32 s36, s36, 1
    v_mfma_f32_16x16x32_bf16 v[64:67], v[252:255], v[96:99], v[64:67]
    s_waitcnt lgkmcnt(2)
    s_cmp_lt_u32 s36, 33
    s_cbranch_scc1 L_q_b0
    s_nop 7
    v_mul_f32 v44, v44, v114
    v_mul_f32 v45, v45, v114
    v_mul_f32 v46, v46, v114
    v_mul_f32 v47, v47, v114
    v_cvt_pk_bf16_f32 v44, v44, v45
    v_cvt_pk_bf16_f32 v45, v46, v47
    ds_write_b64 v7, v[44:45] offset:12288
    v_mul_f32 v48, v48, v115
    v_mul_f32 v49, v49, v115
    v_mul_f32 v50, v50, v115
    v_mul_f32 v51, v51, v115
    v_cvt_pk_bf16_f32 v48, v48, v49
    v_cvt_pk_bf16_f32 v49, v50, v51
    ds_write_b64 v7, v[48:49] offset:18432
    v_mul_f32 v52, v52, v114
    v_mul_f32 v53, v53, v114
    v_mul_f32 v54, v54, v114
    v_mul_f32 v55, v55, v114
    v_cvt_pk_bf16_f32 v52, v52, v53
    v_cvt_pk_bf16_f32 v53, v54, v55
    ds_write_b64 v7, v[52:53] offset:13312
    v_mul_f32 v56, v56, v115
    v_mul_f32 v57, v57, v115
    v_mul_f32 v58, v58, v115
    v_mul_f32 v59, v59, v115
    v_cvt_pk_bf16_f32 v56, v56, v57
    v_cvt_pk_bf16_f32 v57, v58, v59
    ds_write_b64 v7, v[56:57] offset:19456
    v_mul_f32 v60, v60, v114
    v_mul_f32 v61, v61, v114
    v_mul_f32 v62, v62, v114
    v_mul_f32 v63, v63, v114
    v_cvt_pk_bf16_f32 v60, v60, v61
    v_cvt_pk_bf16_f32 v61, v62, v63
    ds_write_b64 v8, v[60:61] offset:14336
    v_mul_f32 v64, v64, v115
    v_mul_f32 v65, v65, v115
    v_mul_f32 v66, v66, v115
    v_mul_f32 v67, v67, v115
    v_cvt_pk_bf16_f32 v64, v64, v65
    v_cvt_pk_bf16_f32 v65, v66, v67
    ds_write_b64 v8, v[64:65] offset:20480
    s_waitcnt lgkmcnt(0)
    s_barrier
    ds_read_b128 v[44:47], v9 offset:6144
    ds_read_b128 v[48:51], v9 offset:13312
    ds_read_b128 v[52:55], v9 offset:7168
    ds_read_b64_tr_b16 v[56:57], v9 offset:14336
    ds_read_b64_tr_b16 v[58:59], v9 offset:8192
    ds_read_b64_tr_b16 v[60:61], v9 offset:14344
    ds_read_b64_tr_b16 v[62:63], v9 offset:8200
    s_waitcnt lgkmcnt(4)
    v_mfma_f32_16x16x32_bf16 v[64:67], v[48:51], v[44:47], 0
    v_mfma_f32_16x16x32_bf16 v[118:121], v[52:55], v[44:47], 0
    s_nop 5
    v_cndmask_b32 v64, v64, v65, s[56:57]
    v_cndmask_b32 v66, v66, v67, s[56:57]
    v_cndmask_b32 v118, v118, v119, s[56:57]
    v_cndmask_b32 v120, v120, v121, s[56:57]
    v_cndmask_b32 v64, v18, v64, s[62:63]
    v_cndmask_b32 v66, v18, v66, s[62:63]
    v_cndmask_b32 v46, v64, v118, s[58:59]
    v_cndmask_b32 v47, v66, v120, s[60:61]
    v_max_f32 v44, v46, v47
    v_mov_b32 v45, v44
    s_nop 1
    v_permlane16_swap_b32 v44, v45
    v_max_f32 v44, v44, v45
    v_mov_b32 v45, v44
    s_nop 1
    v_permlane32_swap_b32 v44, v45
    v_max_f32 v44, v44, v45
    v_mul_f32 v44, s86, v44
    v_fma_f32 v46, v46, s86, -v44
    v_fma_f32 v47, v47, s86, -v44
    v_exp_f32 v46, v46
    v_exp_f32 v47, v47
    s_nop 0
    v_cvt_pk_bf16_f32 v52, v46, v47
    v_perm_b32 v48, v52, v52, v14
    v_perm_b32 v49, v52, v52, v15
    v_perm_b32 v50, v52, v52, v16
    v_perm_b32 v51, v52, v52, v17
    s_waitcnt lgkmcnt(0)
    v_add_f32 v44, v46, v47
    v_mfma_f32_16x16x32_bf16 v[64:67], v[56:59], v[48:51], 0
    v_mfma_f32_16x16x32_bf16 v[118:121], v[60:63], v[48:51], 0
    v_mov_b32 v45, v44
    s_nop 1
    v_permlane16_swap_b32 v44, v45
    v_add_f32 v44, v44, v45
    v_mov_b32 v45, v44
    s_nop 1
    v_permlane32_swap_b32 v44, v45
    v_add_f32 v44, v44, v45
    v_rcp_f32 v44, v44
    s_nop 0
    v_mul_f32 v64, v64, v44
    v_mul_f32 v65, v65, v44
    v_mul_f32 v66, v66, v44
    v_mul_f32 v67, v67, v44
    v_cvt_pk_bf16_f32 v52, v64, v65
    v_cvt_pk_bf16_f32 v53, v66, v67
    v_mul_f32 v118, v118, v44
    v_mul_f32 v119, v119, v44
    v_mul_f32 v120, v120, v44
    v_mul_f32 v121, v121, v44
    v_cvt_pk_bf16_f32 v54, v118, v119
    v_cvt_pk_bf16_f32 v55, v120, v121
    buffer_store_dwordx4 v[52:55], v1, s[16:19], s44 offen sc1
    s_waitcnt vmcnt(0)
    s_barrier
    buffer_store_dword v124, v124, s[16:19], s91 offen sc1
    s_add_u32 s91, s91, 65536
    s_waitcnt vmcnt(0)
    s_endpgm
L_q_short:
    s_nop 5
    s_waitcnt lgkmcnt(2)
    v_mfma_f32_16x16x32_bf16 v[48:51], a[0:3], v[72:75], 0
    s_mov_b32 s39, 0x5e00000
    ds_read_b128 v[96:99], v5 offset:6144
    v_mul_f32 v20, v20, v114
    v_mfma_f32_16x16x32_bf16 v[56:59], a[4:7], v[72:75], 0
    ds_read_b128 v[88:91], v4 offset:6144
    v_mul_f32 v21, v21, v114
    v_mfma_f32_16x16x32_bf16 v[64:67], a[8:11], v[72:75], 0
    s_waitcnt lgkmcnt(2)
    v_mul_f32 v22, v22, v114
    v_mul_f32 v23, v23, v114
    v_mfma_f32_16x16x32_bf16 v[48:51], a[12:15], v[80:83], v[48:51]
    ds_read_b128 v[72:75], v4 offset:10240
    v_cvt_pk_bf16_f32 v20, v20, v21
    v_mfma_f32_16x16x32_bf16 v[56:59], a[16:19], v[80:83], v[56:59]
    v_cvt_pk_bf16_f32 v21, v22, v23
    ds_write_b64 v7, v[20:21] offset:0
    v_mfma_f32_16x16x32_bf16 v[64:67], a[20:23], v[80:83], v[64:67]
    s_waitcnt lgkmcnt(2)
    v_mul_f32 v24, v24, v115
    v_mul_f32 v25, v25, v115
    v_mfma_f32_16x16x32_bf16 v[48:51], a[24:27], v[88:91], v[48:51]
    ds_read_b128 v[80:83], v5 offset:10240
    v_mul_f32 v26, v26, v115
    v_mfma_f32_16x16x32_bf16 v[56:59], a[28:31], v[88:91], v[56:59]
    v_mul_f32 v27, v27, v115
    v_cvt_pk_bf16_f32 v24, v24, v25
    v_mfma_f32_16x16x32_bf16 v[64:67], a[32:35], v[88:91], v[64:67]
    s_waitcnt lgkmcnt(4)
    v_cvt_pk_bf16_f32 v25, v26, v27
    ds_write_b64 v7, v[24:25] offset:6144
    v_mfma_f32_16x16x32_bf16 v[48:51], a[36:39], v[96:99], v[48:51]
    ds_read_b128 v[88:91], v4 offset:14336
    v_mul_f32 v28, v28, v114
    v_mfma_f32_16x16x32_bf16 v[56:59], a[40:43], v[96:99], v[56:59]
    v_mul_f32 v29, v29, v114
    v_mul_f32 v30, v30, v114
    v_mfma_f32_16x16x32_bf16 v[64:67], a[44:47], v[96:99], v[64:67]
    s_waitcnt lgkmcnt(4)
    v_mul_f32 v31, v31, v114
    v_cvt_pk_bf16_f32 v28, v28, v29
    v_mfma_f32_16x16x32_bf16 v[48:51], a[48:51], v[72:75], v[48:51]
    ds_read_b128 v[96:99], v5 offset:14336
    v_cvt_pk_bf16_f32 v29, v30, v31
    v_mfma_f32_16x16x32_bf16 v[56:59], a[52:55], v[72:75], v[56:59]
    ds_write_b64 v7, v[28:29] offset:1024
    v_mfma_f32_16x16x32_bf16 v[64:67], a[56:59], v[72:75], v[64:67]
    s_waitcnt lgkmcnt(4)
    v_mul_f32 v32, v32, v115
    v_mul_f32 v33, v33, v115
    v_mfma_f32_16x16x32_bf16 v[48:51], a[60:63], v[80:83], v[48:51]
    ds_read_b128 v[72:75], v4 offset:18432
    v_mul_f32 v34, v34, v115
    v_mfma_f32_16x16x32_bf16 v[56:59], a[64:67], v[80:83], v[56:59]
    v_mul_f32 v35, v35, v115
    v_cvt_pk_bf16_f32 v32, v32, v33
    v_mfma_f32_16x16x32_bf16 v[64:67], a[68:71], v[80:83], v[64:67]
    s_waitcnt lgkmcnt(3)
    v_cvt_pk_bf16_f32 v33, v34, v35
    ds_write_b64 v7, v[32:33] offset:7168
    v_mfma_f32_16x16x32_bf16 v[48:51], a[72:75], v[88:91], v[48:51]
    ds_read_b128 v[80:83], v5 offset:18432
    v_mul_f32 v36, v36, v114
    v_mfma_f32_16x16x32_bf16 v[56:59], a[76:79], v[88:91], v[56:59]
    v_mul_f32 v37, v37, v114
    v_mul_f32 v38, v38, v114
    v_mfma_f32_16x16x32_bf16 v[64:67], a[80:83], v[88:91], v[64:67]
    s_waitcnt lgkmcnt(4)
    v_mul_f32 v39, v39, v114
    v_cvt_pk_bf16_f32 v36, v36, v37
    v_mfma_f32_16x16x32_bf16 v[48:51], a[84:87], v[96:99], v[48:51]
    s_waitcnt vmcnt(1)
    ds_read_b128 v[88:91], v4 offset:22528
    v_cmp_ne_u32 vcc, 0, v116
    v_mfma_f32_16x16x32_bf16 v[56:59], a[88:91], v[96:99], v[56:59]
    v_cvt_pk_bf16_f32 v37, v38, v39
    ds_write_b64 v8, v[36:37] offset:2048
    v_mfma_f32_16x16x32_bf16 v[64:67], a[92:95], v[96:99], v[64:67]
    s_waitcnt lgkmcnt(4)
    v_mul_f32 v40, v40, v115
    v_mul_f32 v41, v41, v115
    v_mfma_f32_16x16x32_bf16 v[48:51], a[96:99], v[72:75], v[48:51]
    s_cbranch_vccnz L_spin11
L_back12:
    ds_read_b128 v[96:99], v5 offset:22528
    v_mul_f32 v42, v42, v115
    v_mfma_f32_16x16x32_bf16 v[56:59], a[100:103], v[72:75], v[56:59]
    v_mul_f32 v43, v43, v115
    v_cvt_pk_bf16_f32 v40, v40, v41
    v_mfma_f32_16x16x32_bf16 v[64:67], a[104:107], v[72:75], v[64:67]
    s_waitcnt lgkmcnt(3)
    v_cvt_pk_bf16_f32 v41, v42, v43
    ds_write_b64 v8, v[40:41] offset:8192
    v_mfma_f32_16x16x32_bf16 v[48:51], a[108:111], v[80:83], v[48:51]
    ds_read_b128 v[72:75], v4 offset:26624
    v_mfma_f32_16x16x32_bf16 v[56:59], a[112:115], v[80:83], v[56:59]
    v_mfma_f32_16x16x32_bf16 v[64:67], a[116:119], v[80:83], v[64:67]
    s_waitcnt lgkmcnt(4)
    s_waitcnt lgkmcnt(1)
    s_barrier
    v_mfma_f32_16x16x32_bf16 v[48:51], a[120:123], v[88:91], v[48:51]
    s_add_u32 m0, s43, 0
    ds_read_b128 v[80:83], v5 offset:26624
    buffer_load_dwordx4 v6, s[8:11], s41 offen offset:0 sc1 lds
    v_mfma_f32_16x16x32_bf16 v[56:59], a[124:127], v[88:91], v[56:59]
    s_add_u32 m0, s43, 3968
    ds_read_b128 v[20:23], v10 offset:0
    ds_read_b128 v[24:27], v9 offset:1024
    v_mfma_f32_16x16x32_bf16 v[64:67], a[128:131], v[88:91], v[64:67]
    s_waitcnt lgkmcnt(5)
    ds_read_b128 v[28:31], v10 offset:1024
    ds_read_b64_tr_b16 v[32:33], v9 offset:2048
    v_mfma_f32_16x16x32_bf16 v[48:51], a[132:135], v[96:99], v[48:51]
    ds_read_b128 v[88:91], v4 offset:30720
    buffer_load_dwordx4 v6, s[8:11], s41 offen offset:128 sc1 lds
    v_mfma_f32_16x16x32_bf16 v[56:59], a[136:139], v[96:99], v[56:59]
    s_add_u32 m0, s43, 7936
    ds_read_b64_tr_b16 v[34:35], v10 offset:2048
    ds_read_b64_tr_b16 v[36:37], v9 offset:2056
    v_mfma_f32_16x16x32_bf16 v[64:67], a[140:143], v[96:99], v[64:67]
    s_waitcnt lgkmcnt(8)
    ds_read_b64_tr_b16 v[38:39], v10 offset:2056
    ds_read_b64 v[44:45], v13 offset:2048
    v_mfma_f32_16x16x32_bf16 v[48:51], a[144:147], v[72:75], v[48:51]
    s_waitcnt lgkmcnt(6)
    ds_read_b128 v[96:99], v5 offset:30720
    buffer_load_dwordx4 v6, s[8:11], s41 offen offset:256 sc1 lds
    v_mfma_f32_16x16x32_bf16 v[56:59], a[148:151], v[72:75], v[56:59]
    v_mfma_f32_16x16x32_bf16 v[40:43], v[24:27], v[20:23], 0
    v_mfma_f32_16x16x32_bf16 v[118:121], v[28:31], v[20:23], 0
    s_add_u32 m0, s43, 11904
    ds_read_b64 v[46:47], v13 offset:2176
    ds_read_b64 v[52:53], v13 offset:2304
    v_mfma_f32_16x16x32_bf16 v[64:67], a[152:155], v[72:75], v[64:67]
    s_waitcnt lgkmcnt(12)
    v_cndmask_b32 v40, v40, v41, s[56:57]
    v_cndmask_b32 v42, v42, v43, s[56:57]
    v_mfma_f32_16x16x32_bf16 v[48:51], a[156:159], v[80:83], v[48:51]
    ds_read_b128 v[72:75], v4 offset:34816
    buffer_load_dwordx4 v6, s[8:11], s41 offen offset:384 sc1 lds
    v_mfma_f32_16x16x32_bf16 v[56:59], a[160:163], v[80:83], v[56:59]
    s_add_u32 m0, s43, 15872
    v_cndmask_b32 v118, v118, v119, s[56:57]
    v_cndmask_b32 v120, v120, v121, s[56:57]
    v_mfma_f32_16x16x32_bf16 v[64:67], a[164:167], v[80:83], v[64:67]
    s_waitcnt lgkmcnt(8)
    v_cndmask_b32 v40, v18, v40, s[62:63]
    v_cndmask_b32 v42, v18, v42, s[62:63]
    v_mfma_f32_16x16x32_bf16 v[48:51], a[168:171], v[88:91], v[48:51]
    ds_read_b128 v[80:83], v5 offset:34816
    buffer_load_dwordx4 v6, s[8:11], s41 offen offset:512 sc1 lds
    v_mfma_f32_16x16x32_bf16 v[56:59], a[172:175], v[88:91], v[56:59]
    s_add_u32 m0, s43, 19840
    v_cndmask_b32 v22, v40, v118, s[58:59]
    v_cndmask_b32 v23, v42, v120, s[60:61]
    v_mfma_f32_16x16x32_bf16 v[64:67], a[176:179], v[88:91], v[64:67]
    s_waitcnt lgkmcnt(4)
    v_max_f32 v20, v22, v23
    v_mov_b32 v21, v20
    v_mfma_f32_16x16x32_bf16 v[48:51], a[180:183], v[96:99], v[48:51]
    ds_read_b128 v[88:91], v4 offset:38912
    buffer_load_dwordx4 v6, s[8:11], s41 offen offset:640 sc1 lds
    v_mfma_f32_16x16x32_bf16 v[56:59], a[184:187], v[96:99], v[56:59]
    s_add_u32 m0, s43, 23808
    v_permlane16_swap_b32 v20, v21
    v_mfma_f32_16x16x32_bf16 v[64:67], a[188:191], v[96:99], v[64:67]
    s_waitcnt lgkmcnt(2)
    v_max_f32 v20, v20, v21
    v_mov_b32 v21, v20
    v_mfma_f32_16x16x32_bf16 v[48:51], a[192:195], v[72:75], v[48:51]
    ds_read_b128 v[96:99], v5 offset:38912
    buffer_load_dwordx4 v6, s[8:11], s41 offen offset:768 sc1 lds
    v_mfma_f32_16x16x32_bf16 v[56:59], a[196:199], v[72:75], v[56:59]
    s_add_u32 m0, s43, 27776
    v_permlane32_swap_b32 v20, v21
    v_mfma_f32_16x16x32_bf16 v[64:67], a[200:203], v[72:75], v[64:67]
    s_waitcnt lgkmcnt(2)
    v_max_f32 v20, v20, v21
    v_mul_f32 v20, s86, v20
    v_mfma_f32_16x16x32_bf16 v[48:51], a[204:207], v[80:83], v[48:51]
    ds_read_b128 v[72:75], v4 offset:43008
    buffer_load_dwordx4 v6, s[8:11], s41 offen offset:896 sc1 lds
    v_mfma_f32_16x16x32_bf16 v[56:59], a[208:211], v[80:83], v[56:59]
    s_add_u32 m0, s43, 31744
    v_fma_f32 v22, v22, s86, -v20
    v_fma_f32 v23, v23, s86, -v20
    v_mfma_f32_16x16x32_bf16 v[64:67], a[212:215], v[80:83], v[64:67]
    s_waitcnt lgkmcnt(2)
    v_exp_f32 v22, v22
    v_mfma_f32_16x16x32_bf16 v[48:51], a[216:219], v[88:91], v[48:51]
    ds_read_b128 v[80:83], v5 offset:43008
    buffer_load_dwordx4 v6, s[8:11], s41 offen offset:1024 sc1 lds
    v_mfma_f32_16x16x32_bf16 v[56:59], a[220:223], v[88:91], v[56:59]
    s_add_u32 m0, s43, 35712
    v_exp_f32 v23, v23
    v_mfma_f32_16x16x32_bf16 v[64:67], a[224:227], v[88:91], v[64:67]
    s_waitcnt lgkmcnt(2)
    v_cvt_pk_bf16_f32 v28, v22, v23
    v_perm_b32 v24, v28, v28, v14
    v_mfma_f32_16x16x32_bf16 v[48:51], a[228:231], v[96:99], v[48:51]
    ds_read_b128 v[88:91], v4 offset:47104
    buffer_load_dwordx4 v6, s[8:11], s41 offen offset:1152 sc1 lds
    v_mfma_f32_16x16x32_bf16 v[56:59], a[232:235], v[96:99], v[56:59]
    s_add_u32 m0, s43, 39680
    v_perm_b32 v25, v28, v28, v15
    v_perm_b32 v26, v28, v28, v16
    v_mfma_f32_16x16x32_bf16 v[64:67], a[236:239], v[96:99], v[64:67]
    s_waitcnt lgkmcnt(2)
    v_perm_b32 v27, v28, v28, v17
    v_add_f32 v20, v22, v23
    v_mfma_f32_16x16x32_bf16 v[48:51], a[240:243], v[72:75], v[48:51]
    s_waitcnt lgkmcnt(11)
    ds_read_b128 v[96:99], v5 offset:47104
    buffer_load_dwordx4 v6, s[8:11], s41 offen offset:1280 sc1 lds
    v_mfma_f32_16x16x32_bf16 v[56:59], a[244:247], v[72:75], v[56:59]
    v_mfma_f32_16x16x32_bf16 v[40:43], v[32:35], v[24:27], 0
    v_mfma_f32_16x16x32_bf16 v[118:121], v[36:39], v[24:27], 0
    s_add_u32 m0, s43, 43648
    v_mov_b32 v21, v20
    ds_read_b64 v[54:55], v13 offset:2432
    v_mfma_f32_16x16x32_bf16 v[64:67], a[248:251], v[72:75], v[64:67]
    s_waitcnt lgkmcnt(3)
    v_permlane16_swap_b32 v20, v21
    v_mfma_f32_16x16x32_bf16 v[48:51], a[252:255], v[80:83], v[48:51]
    ds_read_b128 v[72:75], v4 offset:51200
    buffer_load_dwordx4 v6, s[8:11], s41 offen offset:1408 sc1 lds
    v_mfma_f32_16x16x32_bf16 v[56:59], v[128:131], v[80:83], v[56:59]
    s_add_u32 m0, s43, 47616
    v_add_f32 v20, v20, v21
    v_mov_b32 v21, v20
    v_mfma_f32_16x16x32_bf16 v[64:67], v[132:135], v[80:83], v[64:67]
    s_waitcnt lgkmcnt(3)
    v_permlane32_swap_b32 v20, v21
    v_mfma_f32_16x16x32_bf16 v[48:51], v[136:139], v[88:91], v[48:51]
    s_waitcnt lgkmcnt(1)
    ds_read_b128 v[80:83], v5 offset:51200
    buffer_load_dwordx4 v6, s[8:11], s41 offen offset:1536 sc1 lds
    v_mfma_f32_16x16x32_bf16 v[56:59], v[140:143], v[88:91], v[56:59]
    s_add_u32 m0, s43, 51584
    v_add_f32 v20, v20, v21
    v_rcp_f32 v20, v20
    v_mfma_f32_16x16x32_bf16 v[64:67], v[144:147], v[88:91], v[64:67]
    s_waitcnt lgkmcnt(3)
    v_mul_f32 v40, v40, v20
    v_mul_f32 v41, v41, v20
    v_mfma_f32_16x16x32_bf16 v[48:51], v[148:151], v[96:99], v[48:51]
    ds_read_b128 v[88:91], v4 offset:55296
    buffer_load_dwordx4 v6, s[8:11], s41 offen offset:1664 sc1 lds
    v_mfma_f32_16x16x32_bf16 v[56:59], v[152:155], v[96:99], v[56:59]
    s_add_u32 m0, s43, 55552
    v_mul_f32 v42, v42, v20
    v_mul_f32 v43, v43, v20
    v_mfma_f32_16x16x32_bf16 v[64:67], v[156:159], v[96:99], v[64:67]
    s_waitcnt lgkmcnt(2)
    v_cvt_pk_bf16_f32 v28, v40, v41
    v_cvt_pk_bf16_f32 v29, v42, v43
    v_mfma_f32_16x16x32_bf16 v[48:51], v[160:163], v[72:75], v[48:51]
    ds_read_b128 v[96:99], v5 offset:55296
    buffer_load_dwordx4 v6, s[8:11], s41 offen offset:1792 sc1 lds
    v_mfma_f32_16x16x32_bf16 v[56:59], v[164:167], v[72:75], v[56:59]
    s_add_u32 m0, s43, 59520
    v_mul_f32 v118, v118, v20
    v_mul_f32 v119, v119, v20
    v_mfma_f32_16x16x32_bf16 v[64:67], v[168:171], v[72:75], v[64:67]
    s_waitcnt lgkmcnt(2)
    v_mul_f32 v120, v120, v20
    v_mul_f32 v121, v121, v20
    v_mfma_f32_16x16x32_bf16 v[48:51], v[172:175], v[80:83], v[48:51]
    ds_read_b128 v[72:75], v4 offset:59392
    buffer_load_dwordx4 v6, s[8:11], s41 offen offset:1920 sc1 lds
    v_mfma_f32_16x16x32_bf16 v[56:59], v[176:179], v[80:83], v[56:59]
    s_add_u32 m0, s52, 90112
    v_cvt_pk_bf16_f32 v30, v118, v119
    v_cvt_pk_bf16_f32 v31, v120, v121
    v_mfma_f32_16x16x32_bf16 v[64:67], v[180:183], v[80:83], v[64:67]
    s_waitcnt lgkmcnt(2)
    buffer_store_dwordx4 v[28:31], v1, s[16:19], s44 offen sc1
    v_mfma_f32_16x16x32_bf16 v[48:51], v[184:187], v[88:91], v[48:51]
    s_cmp_eq_u32 s36, 17
    ds_read_b128 v[80:83], v5 offset:59392
    buffer_load_dwordx4 v1, s[16:19], s46 offen sc1 lds
    v_mfma_f32_16x16x32_bf16 v[56:59], v[188:191], v[88:91], v[56:59]
    s_cselect_b32 s49, s87, 0x10000
    v_med3_i32 v117, s45, 0, v12
    v_add_u32 v117, v117, v11
    v_mfma_f32_16x16x32_bf16 v[64:67], v[192:195], v[88:91], v[64:67]
    s_waitcnt lgkmcnt(2)
    v_add_f32 v60, v52, v54
    v_add_f32 v61, v53, v55
    v_mfma_f32_16x16x32_bf16 v[48:51], v[196:199], v[96:99], v[48:51]
    s_add_u32 s45, s45, 65536
    ds_read_b128 v[88:91], v4 offset:63488
    buffer_load_dword v116, v117, s[16:19], 0 offen sc1
    v_mfma_f32_16x16x32_bf16 v[56:59], v[200:203], v[96:99], v[56:59]
    buffer_store_dword v124, v124, s[16:19], s39 offen sc1
    v_mfma_f32_16x16x32_bf16 v[64:67], v[204:207], v[96:99], v[64:67]
    s_waitcnt lgkmcnt(2)
    v_add_f32 v44, v44, v46
    v_add_f32 v45, v45, v47
    v_mfma_f32_16x16x32_bf16 v[48:51], v[208:211], v[72:75], v[48:51]
    s_add_u32 s90, s90, s49
    ds_read_b128 v[96:99], v5 offset:63488
    v_add_f32 v44, v44, v60
    v_mfma_f32_16x16x32_bf16 v[56:59], v[212:215], v[72:75], v[56:59]
    s_and_b32 s49, s90, 0xffffffff
    v_add_f32 v45, v45, v61
    v_mov_b32 v60, v44
    v_mfma_f32_16x16x32_bf16 v[64:67], v[216:219], v[72:75], v[64:67]
    s_waitcnt lgkmcnt(2)
    v_mov_b32 v61, v45
    v_permlane32_swap_b32 v44, v60
    v_mfma_f32_16x16x32_bf16 v[48:51], v[220:223], v[80:83], v[48:51]
    s_bitcmp1_b64 s[24:25], s36
    v_permlane32_swap_b32 v45, v61
    v_mfma_f32_16x16x32_bf16 v[56:59], v[224:227], v[80:83], v[56:59]
    s_cselect_b32 s44, s49, 0x5e00000
    v_add_f32 v44, v44, v60
    v_add_f32 v45, v45, v61
    v_mfma_f32_16x16x32_bf16 v[64:67], v[228:231], v[80:83], v[64:67]
    s_waitcnt lgkmcnt(1)
    v_mul_f32 v112, 0xba800000, v44
    v_mul_f32 v45, 0x3a800000, v45
    v_mfma_f32_16x16x32_bf16 v[48:51], v[232:235], v[88:91], v[48:51]
    s_bitcmp1_b64 s[26:27], s36
    v_fma_f32 v45, -v112, v112, v45
    v_mov_b32 v113, v112
    v_mfma_f32_16x16x32_bf16 v[56:59], v[236:239], v[88:91], v[56:59]
    s_cselect_b64 s[62:63], 0, -1
    v_max_f32 v45, 0, v45
    v_add_f32 v45, 0x3727c5ac, v45
    v_mfma_f32_16x16x32_bf16 v[64:67], v[240:243], v[88:91], v[64:67]
    s_waitcnt lgkmcnt(0)
    v_rsq_f32 v114, v45
    v_mfma_f32_16x16x32_bf16 v[48:51], v[244:247], v[96:99], v[48:51]
    s_cmp_eq_u32 s36, s97
    v_permlane16_swap_b32 v112, v113
    v_mfma_f32_16x16x32_bf16 v[56:59], v[248:251], v[96:99], v[56:59]
    s_cselect_b32 s47, 32, -2
    v_mov_b32 v115, v114
    s_cselect_b64 s[8:9], s[88:89], s[8:9]
    v_mfma_f32_16x16x32_bf16 v[64:67], v[252:255], v[96:99], v[64:67]
    s_cselect_b32 s55, 0x543fc00, s55
    v_permlane16_swap_b32 v114, v115
    s_add_u32 s50, s50, s47
    s_max_i32 s47, s50, 0
    s_min_i32 s47, s47, s96
    s_lshl_b32 s41, s47, 15
    s_lshl_b32 s46, s47, 10
    s_sub_u32 s46, s55, s46
    v_fmac_f32 v48, v113, v100
    v_fmac_f32 v49, v113, v101
    v_fmac_f32 v50, v113, v102
    v_fmac_f32 v51, v113, v103
    v_fmac_f32 v56, v113, v104
    v_fmac_f32 v57, v113, v105
    v_fmac_f32 v58, v113, v106
    v_fmac_f32 v59, v113, v107
    v_fmac_f32 v64, v113, v108
    v_fmac_f32 v65, v113, v109
    v_fmac_f32 v66, v113, v110
    v_fmac_f32 v67, v113, v111
    s_waitcnt vmcnt(12)
    s_barrier
    ds_read_b128 v[68:71], v2 offset:0
    ds_read_b128 v[72:75], v2 offset:2048
    ds_read_b128 v[76:79], v3 offset:0
    ds_read_b128 v[80:83], v3 offset:2048
    s_waitcnt lgkmcnt(0)
    s_add_u32 s36, s36, 1
    s_branch L_q_b0
L_spin1:
    s_mov_b32 s40, 0x20000
L_spin1_l:
    buffer_load_dword v37, v36, s[20:23], 64 offen sc1
    s_sub_u32 s40, s40, 1
    s_waitcnt vmcnt(0)
    v_cmp_eq_u32 vcc, v36, v37
    s_cbranch_scc1 L_back2
    s_cbranch_vccz L_back2
    s_sleep 8
    s_branch L_spin1_l
L_spin3:
    s_mov_b32 s40, 0x20000
L_spin3_l:
    buffer_load_dword v117, v116, s[20:23], 0 offen sc1
    s_sub_u32 s40, s40, 1
    s_waitcnt vmcnt(0)
    v_cmp_eq_u32 vcc, v116, v117
    s_cbranch_scc1 L_back4
    s_cbranch_vccz L_back4
    s_sleep 8
    s_branch L_spin3_l
L_vspin5:
    s_mov_b32 s40, 0x20000
L_vspin5_l:
    s_cmp_lg_u32 s37, 0
    s_cbranch_scc1 L_restart
    s_sleep 4
    buffer_load_dword v38, v124, s[20:23], 0 offen offset:32 sc1
    s_waitcnt vmcnt(0)
    v_readfirstlane_b32 s37, v38
    s_sub_u32 s40, s40, 1
    s_cbranch_scc1 L_vback6
    s_cmp_lg_u32 s37, s3
    s_cbranch_scc1 L_vspin5_l
    s_branch L_vback6
L_spin7:
    s_mov_b32 s40, 0x20000
L_spin7_l:
    buffer_load_dword v116, v117, s[16:19], 0 offen sc1
    s_sub_u32 s40, s40, 1
    s_waitcnt vmcnt(0)
    v_cmp_ne_u32 vcc, 0, v116
    s_cbranch_scc1 L_back8
    s_cbranch_vccz L_back8
    s_sleep 2
    s_branch L_spin7_l
L_spin9:
    s_mov_b32 s40, 0x20000
L_spin9_l:
    buffer_load_dword v116, v117, s[16:19], 0 offen sc1
    s_sub_u32 s40, s40, 1
    s_waitcnt vmcnt(0)
    v_cmp_ne_u32 vcc, 0, v116
    s_cbranch_scc1 L_back10
    s_cbranch_vccz L_back10
    s_sleep 2
    s_branch L_spin9_l
L_spin11:
    s_mov_b32 s40, 0x20000
L_spin11_l:
    buffer_load_dword v116, v117, s[16:19], 0 offen sc1
    s_sub_u32 s40, s40, 1
    s_waitcnt vmcnt(0)
    v_cmp_ne_u32 vcc, 0, v116
    s_cbranch_scc1 L_back12
    s_cbranch_vccz L_back12
    s_sleep 2
    s_branch L_spin11_l
L_other:
    s_lshr_b32 s48, s2, 3
    s_bitcmp1_b32 s2, 0
    s_cbranch_scc1 L_odd
    v_lshrrev_b32 v6, 2, v0
    v_and_b32 v7, 3, v0
    v_lshlrev_b32 v7, 7, v7
    v_lshl_add_u32 v6, v6, 11, v7
    s_and_b32 s48, s48, 15
    s_lshl2_add_u32 s39, s48, s32
    s_lshl_b32 s39, s39, 15
    s_lshl_b32 s37, s47, 9
    s_add_u32 s39, s39, s37
    s_lshr_b32 s37, s48, 2
    s_lshl_b32 s37, s37, 20
    s_and_b32 s38, s48, 3
    s_lshl2_add_u32 s38, s38, s32
    s_lshl_b32 s38, s38, 13
    s_add_u32 s37, s37, s38
    v_lshlrev_b32 v5, 7, v0
    s_waitcnt lgkmcnt(0)
    s_add_u32 s8, s64, 0xe0000
    s_addc_u32 s9, s65, 0
    s_mov_b32 s10, 0x320000
    s_mov_b32 s11, 0x00020000
    buffer_load_dword v251, v5, s[8:11], s37 offen
    s_mov_b32 s12, s66
    s_mov_b32 s13, s67
    s_mov_b32 s14, 0x600000
    s_mov_b32 s15, 0x00020000
    buffer_load_dword v248, v6, s[12:15], s39 offen
    s_add_u32 s39, s39, 2097152
    buffer_load_dword v249, v6, s[12:15], s39 offen
    s_add_u32 s39, s39, 2097152
    buffer_load_dword v250, v6, s[12:15], s39 offen
    s_add_u32 s39, s39, 2097152
    s_mov_b32 s16, s84
    s_mov_b32 s17, s85
    s_mov_b32 s18, 0x5e00000
    s_mov_b32 s19, 0x00020000
    v_min_u32 v124, 1, v0
    v_lshlrev_b32 v124, 30, v124
    s_lshr_b32 s33, s47, 1
    s_lshl_b32 s33, s33, 1
    s_and_b32 s37, s48, 1
    s_add_u32 s33, s33, s37
    s_and_b32 s35, s47, 1
    s_lshl_b32 s35, s35, 3
    s_lshr_b32 s37, s48, 1
    s_add_u32 s35, s35, s37
    s_add_u32 s34, s35, 24
    s_lshl_b32 s91, s33, 6
    s_add_u32 s91, s91, s34
    s_lshl_b32 s91, s91, 7
    s_add_u32 s91, s91, 0x5520000
    s_cmp_eq_u32 s32, 1
    s_cselect_b32 s91, s91, 0x5f00000
    s_mul_i32 s51, s35, 6
    s_min_u32 s51, s51, 106
    s_lshl_b32 s54, s51, 6
    s_mov_b32 s12, s72
    s_mov_b32 s13, s73
    s_mov_b32 s14, 0x700000
    s_mov_b32 s15, 0x00020000
    s_mov_b32 s39, 7168
    v_lshrrev_b32 v68, 3, v0
    v_lshlrev_b32 v69, 2, v0
    v_and_b32 v69, 64, v69
    v_and_b32 v70, 0x70, v1
    v_xor_b32 v69, v69, v70
    v_mad_u32_u24 v56, v68, s39, v69
    v_add_u32 v57, 57344, v56
    v_add_u32 v58, 128, v56
    v_add_u32 v59, 57472, v56
    v_add_u32 v60, 256, v56
    v_add_u32 v61, 57600, v56
    s_mul_i32 s38, s32, 114688
    s_add_u32 s54, s54, s38
    s_lshl_b32 s42, s32, 11
    s_add_u32 m0, s42, 0
    s_nop 0
    buffer_load_dwordx4 v56, s[12:15], s54 offen lds
    s_add_u32 m0, s42, 1024
    s_nop 0
    buffer_load_dwordx4 v57, s[12:15], s54 offen lds
    s_add_u32 m0, s42, 8192
    s_nop 0
    buffer_load_dwordx4 v58, s[12:15], s54 offen lds
    s_add_u32 m0, s42, 9216
    s_nop 0
    buffer_load_dwordx4 v59, s[12:15], s54 offen lds
    s_add_u32 m0, s42, 16384
    s_nop 0
    buffer_load_dwordx4 v60, s[12:15], s54 offen lds
    s_add_u32 m0, s42, 17408
    s_nop 0
    buffer_load_dwordx4 v61, s[12:15], s54 offen lds
    s_add_u32 s54, s54, 458752
    s_add_u32 m0, s42, 24576
    s_nop 0
    buffer_load_dwordx4 v56, s[12:15], s54 offen lds
    s_add_u32 m0, s42, 25600
    s_nop 0
    buffer_load_dwordx4 v57, s[12:15], s54 offen lds
    s_add_u32 m0, s42, 32768
    s_nop 0
    buffer_load_dwordx4 v58, s[12:15], s54 offen lds
    s_add_u32 m0, s42, 33792
    s_nop 0
    buffer_load_dwordx4 v59, s[12:15], s54 offen lds
    s_add_u32 m0, s42, 40960
    s_nop 0
    buffer_load_dwordx4 v60, s[12:15], s54 offen lds
    s_add_u32 m0, s42, 41984
    s_nop 0
    buffer_load_dwordx4 v61, s[12:15], s54 offen lds
    s_add_u32 s54, s54, 458752
    s_add_u32 m0, s42, 49152
    s_nop 0
    buffer_load_dwordx4 v56, s[12:15], s54 offen lds
    s_add_u32 m0, s42, 50176
    s_nop 0
    buffer_load_dwordx4 v57, s[12:15], s54 offen lds
    s_add_u32 m0, s42, 57344
    s_nop 0
    buffer_load_dwordx4 v58, s[12:15], s54 offen lds
    s_add_u32 m0, s42, 58368
    s_nop 0
    buffer_load_dwordx4 v59, s[12:15], s54 offen lds
    s_add_u32 m0, s42, 65536
    s_nop 0
    buffer_load_dwordx4 v60, s[12:15], s54 offen lds
    s_add_u32 m0, s42, 66560
    s_nop 0
    buffer_load_dwordx4 v61, s[12:15], s54 offen lds
    s_add_u32 s54, s54, 458752
    s_add_u32 m0, s42, 73728
    s_nop 0
    buffer_load_dwordx4 v56, s[12:15], s54 offen lds
    s_add_u32 m0, s42, 74752
    s_nop 0
    buffer_load_dwordx4 v57, s[12:15], s54 offen lds
    s_add_u32 m0, s42, 81920
    s_nop 0
    buffer_load_dwordx4 v58, s[12:15], s54 offen lds
    s_add_u32 m0, s42, 82944
    s_nop 0
    buffer_load_dwordx4 v59, s[12:15], s54 offen lds
    s_add_u32 m0, s42, 90112
    s_nop 0
    buffer_load_dwordx4 v60, s[12:15], s54 offen lds
    s_add_u32 m0, s42, 91136
    s_nop 0
    buffer_load_dwordx4 v61, s[12:15], s54 offen lds
    s_add_u32 s54, s54, 458752
    s_add_u32 m0, s42, 98304
    s_nop 0
    buffer_load_dwordx4 v56, s[12:15], s54 offen lds
    s_add_u32 m0, s42, 99328
    s_nop 0
    buffer_load_dwordx4 v57, s[12:15], s54 offen lds
    s_add_u32 m0, s42, 106496
    s_nop 0
    buffer_load_dwordx4 v58, s[12:15], s54 offen lds
    s_add_u32 m0, s42, 107520
    s_nop 0
    buffer_load_dwordx4 v59, s[12:15], s54 offen lds
    s_add_u32 m0, s42, 114688
    s_nop 0
    buffer_load_dwordx4 v60, s[12:15], s54 offen lds
    s_add_u32 m0, s42, 115712
    s_nop 0
    buffer_load_dwordx4 v61, s[12:15], s54 offen lds
    s_add_u32 s54, s54, 458752
    v_lshrrev_b32 v68, 4, v0
    v_bfe_u32 v69, v0, 2, 2
    v_lshl_add_u32 v68, v68, 3, v69
    v_lshlrev_b32 v68, 7, v68
    v_lshrrev_b32 v69, 1, v69
    v_lshl_add_u32 v68, v69, 6, v68
    v_and_b32 v69, 3, v0
    v_lshl_add_u32 v68, v69, 4, v68
    s_lshr_b32 s37, s32, 1
    s_lshl_b32 s37, s37, 13
    s_and_b32 s38, s32, 1
    s_lshl_b32 s38, s38, 6
    s_add_u32 s37, s37, s38
    s_add_u32 s37, s37, 0
    v_xor_b32 v62, s37, v68
    s_lshr_b32 s37, s32, 1
    s_lshl_b32 s37, s37, 13
    s_and_b32 s38, s32, 1
    s_lshl_b32 s38, s38, 6
    s_add_u32 s37, s37, s38
    s_add_u32 s37, s37, 8
    v_xor_b32 v63, s37, v68
    s_lshr_b32 s37, s32, 1
    s_lshl_b32 s37, s37, 6
    s_and_b32 s38, s32, 1
    s_lshl_b32 s38, s38, 3
    s_add_u32 s37, s37, s38
    s_add_u32 s37, s37, 16384
    v_xor_b32 v64, s37, v68
    v_mov_b32 v68, 0x3f803f80
    v_mov_b32 v69, 0x3f803f80
    v_mov_b32 v70, 0x3f803f80
    v_mov_b32 v71, 0x3f803f80
    v_add_u32 v2, 98304, v1
    s_lshl_b32 s37, s33, 6
    s_add_u32 s37, s37, 16
    s_lshl_b32 s37, s37, 7
    v_lshl_add_u32 v5, v0, 7, s37
    s_cmp_eq_u32 s32, 0
    s_cselect_b32 s37, 8, 0
    v_cmp_le_u32 vcc, s37, v0
    s_nop 1
    v_cndmask_b32 v5, v5, 2.0, vcc
    s_lshl_b32 s43, s32, 12
    s_mul_i32 s41, s33, 2097152
    s_add_u32 s41, s41, 0x800000
    s_add_u32 s41, s41, s43
    s_mul_i32 s90, s33, 8388608
    s_add_u32 s90, s90, 0xfc0000
    s_add_u32 s37, s51, s32
    s_lshl_b32 s37, s37, 11
    s_add_u32 s90, s90, s37
    s_lshl_b32 s37, s32, 10
    s_sub_u32 s87, 8192, s37
    s_lshl_b32 s38, s35, 1
    s_lshr_b32 s39, s32, 1
    s_add_u32 s38, s38, s39
    s_cmp_eq_u32 s38, 36
    s_cselect_b32 s88, 0x5e00000, 0
    s_and_b32 s38, s32, 1
    s_lshl_b32 s38, s38, 3
    s_and_b32 s39, s32, 2
    s_lshl_b32 s39, s39, 10
    s_add_u32 s38, s38, s39
    s_add_u32 s38, s38, 65536
    v_add_u32 v3, s38, v1
    s_add_u32 s37, s37, 65536
    v_add_u32 v4, s37, v1
    v_and_b32 v6, 15, v0
    v_lshlrev_b32 v6, 3, v6
    v_lshrrev_b32 v8, 5, v0
    v_lshl_add_u32 v6, v8, 9, v6
    v_and_b32 v8, 16, v0
    v_lshl_add_u32 v6, v8, 6, v6
    v_add_u32 v118, 73728, v6
    s_mul_i32 s46, s33, 65536
    s_add_u32 s46, s46, 0x5440000
    s_add_u32 s55, s46, 63488
    s_and_b32 s52, s32, 1
    s_lshl_b32 s52, s52, 10
    s_mov_b32 s8, s74
    s_mov_b32 s9, s75
    s_mov_b32 s10, 0x1c00
    s_mov_b32 s11, 0x00020000
    v_and_b32 v8, 0x30, v0
    s_add_u32 s37, s51, s32
    s_lshl_b32 s37, s37, 6
    buffer_load_dwordx4 v[16:19], v8, s[8:11], s37 offen
    s_lshr_b32 s37, s32, 1
    s_add_u32 s37, s37, s51
    s_lshl_b32 s37, s37, 6
    s_and_b32 s38, s32, 1
    s_lshl_b32 s38, s38, 3
    s_add_u32 s37, s37, s38
    buffer_load_dwordx2 v[20:21], v8, s[8:11], s37 offen offset:256
    v_add_u32 v65, 0, v62
    v_add_u32 v66, 0, v63
    v_add_u32 v67, 0, v64
    s_waitcnt vmcnt(26)
    s_barrier
    ds_read_b64_tr_b16 a[0:1], v65 offset:0
    ds_read_b64_tr_b16 a[2:3], v65 offset:512
    ds_read_b64_tr_b16 a[4:5], v66 offset:0
    ds_read_b64_tr_b16 a[6:7], v66 offset:512
    ds_read_b64_tr_b16 a[8:9], v67 offset:0
    ds_read_b64_tr_b16 a[10:11], v67 offset:512
    ds_read_b64_tr_b16 a[12:13], v65 offset:4096
    ds_read_b64_tr_b16 a[14:15], v65 offset:4608
    ds_read_b64_tr_b16 a[16:17], v66 offset:4096
    ds_read_b64_tr_b16 a[18:19], v66 offset:4608
    ds_read_b64_tr_b16 a[20:21], v67 offset:4096
    ds_read_b64_tr_b16 a[22:23], v67 offset:4608
    s_add_u32 m0, s42, 122880
    s_nop 0
    buffer_load_dwordx4 v56, s[12:15], s54 offen lds
    s_add_u32 m0, s42, 123904
    s_nop 0
    buffer_load_dwordx4 v57, s[12:15], s54 offen lds
    s_add_u32 m0, s42, 131072
    s_nop 0
    buffer_load_dwordx4 v58, s[12:15], s54 offen lds
    s_add_u32 m0, s42, 132096
    s_nop 0
    buffer_load_dwordx4 v59, s[12:15], s54 offen lds
    s_add_u32 m0, s42, 139264
    s_nop 0
    buffer_load_dwordx4 v60, s[12:15], s54 offen lds
    s_add_u32 m0, s42, 140288
    s_nop 0
    buffer_load_dwordx4 v61, s[12:15], s54 offen lds
    s_add_u32 s54, s54, 458752
    s_waitcnt lgkmcnt(0)
    v_mfma_f32_16x16x32_bf16 v[88:91], a[0:3], v[68:71], 0
    v_mfma_f32_16x16x32_bf16 v[92:95], a[4:7], v[68:71], 0
    v_mfma_f32_16x16x32_bf16 v[96:99], a[8:11], v[68:71], 0
    v_mfma_f32_16x16x32_bf16 v[88:91], a[12:15], v[68:71], v[88:91]
    v_mfma_f32_16x16x32_bf16 v[92:95], a[16:19], v[68:71], v[92:95]
    v_mfma_f32_16x16x32_bf16 v[96:99], a[20:23], v[68:71], v[96:99]
    v_add_u32 v65, 24576, v62
    v_add_u32 v66, 24576, v63
    v_add_u32 v67, 24576, v64
    s_waitcnt vmcnt(26)
    s_barrier
    ds_read_b64_tr_b16 a[24:25], v65 offset:0
    ds_read_b64_tr_b16 a[26:27], v65 offset:512
    ds_read_b64_tr_b16 a[28:29], v66 offset:0
    ds_read_b64_tr_b16 a[30:31], v66 offset:512
    ds_read_b64_tr_b16 a[32:33], v67 offset:0
    ds_read_b64_tr_b16 a[34:35], v67 offset:512
    ds_read_b64_tr_b16 a[36:37], v65 offset:4096
    ds_read_b64_tr_b16 a[38:39], v65 offset:4608
    ds_read_b64_tr_b16 a[40:41], v66 offset:4096
    ds_read_b64_tr_b16 a[42:43], v66 offset:4608
    ds_read_b64_tr_b16 a[44:45], v67 offset:4096
    ds_read_b64_tr_b16 a[46:47], v67 offset:4608
    s_add_u32 m0, s42, 0
    s_nop 0
    buffer_load_dwordx4 v56, s[12:15], s54 offen lds
    s_add_u32 m0, s42, 1024
    s_nop 0
    buffer_load_dwordx4 v57, s[12:15], s54 offen lds
    s_add_u32 m0, s42, 8192
    s_nop 0
    buffer_load_dwordx4 v58, s[12:15], s54 offen lds
    s_add_u32 m0, s42, 9216
    s_nop 0
    buffer_load_dwordx4 v59, s[12:15], s54 offen lds
    s_add_u32 m0, s42, 16384
    s_nop 0
    buffer_load_dwordx4 v60, s[12:15], s54 offen lds
    s_add_u32 m0, s42, 17408
    s_nop 0
    buffer_load_dwordx4 v61, s[12:15], s54 offen lds
    s_add_u32 s54, s54, 458752
    s_waitcnt lgkmcnt(0)
    v_mfma_f32_16x16x32_bf16 v[88:91], a[24:27], v[68:71], v[88:91]
    v_mfma_f32_16x16x32_bf16 v[92:95], a[28:31], v[68:71], v[92:95]
    v_mfma_f32_16x16x32_bf16 v[96:99], a[32:35], v[68:71], v[96:99]
    v_mfma_f32_16x16x32_bf16 v[88:91], a[36:39], v[68:71], v[88:91]
    v_mfma_f32_16x16x32_bf16 v[92:95], a[40:43], v[68:71], v[92:95]
    v_mfma_f32_16x16x32_bf16 v[96:99], a[44:47], v[68:71], v[96:99]
    v_add_u32 v65, 49152, v62
    v_add_u32 v66, 49152, v63
    v_add_u32 v67, 49152, v64
    s_waitcnt vmcnt(26)
    s_barrier
    ds_read_b64_tr_b16 a[48:49], v65 offset:0
    ds_read_b64_tr_b16 a[50:51], v65 offset:512
    ds_read_b64_tr_b16 a[52:53], v66 offset:0
    ds_read_b64_tr_b16 a[54:55], v66 offset:512
    ds_read_b64_tr_b16 a[56:57], v67 offset:0
    ds_read_b64_tr_b16 a[58:59], v67 offset:512
    ds_read_b64_tr_b16 a[60:61], v65 offset:4096
    ds_read_b64_tr_b16 a[62:63], v65 offset:4608
    ds_read_b64_tr_b16 a[64:65], v66 offset:4096
    ds_read_b64_tr_b16 a[66:67], v66 offset:4608
    ds_read_b64_tr_b16 a[68:69], v67 offset:4096
    ds_read_b64_tr_b16 a[70:71], v67 offset:4608
    s_add_u32 m0, s42, 24576
    s_nop 0
    buffer_load_dwordx4 v56, s[12:15], s54 offen lds
    s_add_u32 m0, s42, 25600
    s_nop 0
    buffer_load_dwordx4 v57, s[12:15], s54 offen lds
    s_add_u32 m0, s42, 32768
    s_nop 0
    buffer_load_dwordx4 v58, s[12:15], s54 offen lds
    s_add_u32 m0, s42, 33792
    s_nop 0
    buffer_load_dwordx4 v59, s[12:15], s54 offen lds
    s_add_u32 m0, s42, 40960
    s_nop 0
    buffer_load_dwordx4 v60, s[12:15], s54 offen lds
    s_add_u32 m0, s42, 41984
    s_nop 0
    buffer_load_dwordx4 v61, s[12:15], s54 offen lds
    s_add_u32 s54, s54, 458752
    s_waitcnt lgkmcnt(0)
    v_mfma_f32_16x16x32_bf16 v[88:91], a[48:51], v[68:71], v[88:91]
    v_mfma_f32_16x16x32_bf16 v[92:95], a[52:55], v[68:71], v[92:95]
    v_mfma_f32_16x16x32_bf16 v[96:99], a[56:59], v[68:71], v[96:99]
    v_mfma_f32_16x16x32_bf16 v[88:91], a[60:63], v[68:71], v[88:91]
    v_mfma_f32_16x16x32_bf16 v[92:95], a[64:67], v[68:71], v[92:95]
    v_mfma_f32_16x16x32_bf16 v[96:99], a[68:71], v[68:71], v[96:99]
    v_add_u32 v65, 73728, v62
    v_add_u32 v66, 73728, v63
    v_add_u32 v67, 73728, v64
    s_waitcnt vmcnt(26)
    s_barrier
    ds_read_b64_tr_b16 a[72:73], v65 offset:0
    ds_read_b64_tr_b16 a[74:75], v65 offset:512
    ds_read_b64_tr_b16 a[76:77], v66 offset:0
    ds_read_b64_tr_b16 a[78:79], v66 offset:512
    ds_read_b64_tr_b16 a[80:81], v67 offset:0
    ds_read_b64_tr_b16 a[82:83], v67 offset:512
    ds_read_b64_tr_b16 a[84:85], v65 offset:4096
    ds_read_b64_tr_b16 a[86:87], v65 offset:4608
    ds_read_b64_tr_b16 a[88:89], v66 offset:4096
    ds_read_b64_tr_b16 a[90:91], v66 offset:4608
    ds_read_b64_tr_b16 a[92:93], v67 offset:4096
    ds_read_b64_tr_b16 a[94:95], v67 offset:4608
    s_add_u32 m0, s42, 49152
    s_nop 0
    buffer_load_dwordx4 v56, s[12:15], s54 offen lds
    s_add_u32 m0, s42, 50176
    s_nop 0
    buffer_load_dwordx4 v57, s[12:15], s54 offen lds
    s_add_u32 m0, s42, 57344
    s_nop 0
    buffer_load_dwordx4 v58, s[12:15], s54 offen lds
    s_add_u32 m0, s42, 58368
    s_nop 0
    buffer_load_dwordx4 v59, s[12:15], s54 offen lds
    s_add_u32 m0, s42, 65536
    s_nop 0
    buffer_load_dwordx4 v60, s[12:15], s54 offen lds
    s_add_u32 m0, s42, 66560
    s_nop 0
    buffer_load_dwordx4 v61, s[12:15], s54 offen lds
    s_add_u32 s54, s54, 458752
    s_waitcnt lgkmcnt(0)
    v_mfma_f32_16x16x32_bf16 v[88:91], a[72:75], v[68:71], v[88:91]
    v_mfma_f32_16x16x32_bf16 v[92:95], a[76:79], v[68:71], v[92:95]
    v_mfma_f32_16x16x32_bf16 v[96:99], a[80:83], v[68:71], v[96:99]
    v_mfma_f32_16x16x32_bf16 v[88:91], a[84:87], v[68:71], v[88:91]
    v_mfma_f32_16x16x32_bf16 v[92:95], a[88:91], v[68:71], v[92:95]
    v_mfma_f32_16x16x32_bf16 v[96:99], a[92:95], v[68:71], v[96:99]
    v_add_u32 v65, 98304, v62
    v_add_u32 v66, 98304, v63
    v_add_u32 v67, 98304, v64
    s_waitcnt vmcnt(26)
    s_barrier
    ds_read_b64_tr_b16 a[96:97], v65 offset:0
    ds_read_b64_tr_b16 a[98:99], v65 offset:512
    ds_read_b64_tr_b16 a[100:101], v66 offset:0
    ds_read_b64_tr_b16 a[102:103], v66 offset:512
    ds_read_b64_tr_b16 a[104:105], v67 offset:0
    ds_read_b64_tr_b16 a[106:107], v67 offset:512
    ds_read_b64_tr_b16 a[108:109], v65 offset:4096
    ds_read_b64_tr_b16 a[110:111], v65 offset:4608
    ds_read_b64_tr_b16 a[112:113], v66 offset:4096
    ds_read_b64_tr_b16 a[114:115], v66 offset:4608
    ds_read_b64_tr_b16 a[116:117], v67 offset:4096
    ds_read_b64_tr_b16 a[118:119], v67 offset:4608
    s_add_u32 m0, s42, 73728
    s_nop 0
    buffer_load_dwordx4 v56, s[12:15], s54 offen lds
    s_add_u32 m0, s42, 74752
    s_nop 0
    buffer_load_dwordx4 v57, s[12:15], s54 offen lds
    s_add_u32 m0, s42, 81920
    s_nop 0
    buffer_load_dwordx4 v58, s[12:15], s54 offen lds
    s_add_u32 m0, s42, 82944
    s_nop 0
    buffer_load_dwordx4 v59, s[12:15], s54 offen lds
    s_add_u32 m0, s42, 90112
    s_nop 0
    buffer_load_dwordx4 v60, s[12:15], s54 offen lds
    s_add_u32 m0, s42, 91136
    s_nop 0
    buffer_load_dwordx4 v61, s[12:15], s54 offen lds
    s_add_u32 s54, s54, 458752
    s_waitcnt lgkmcnt(0)
    v_mfma_f32_16x16x32_bf16 v[88:91], a[96:99], v[68:71], v[88:91]
    v_mfma_f32_16x16x32_bf16 v[92:95], a[100:103], v[68:71], v[92:95]
    v_mfma_f32_16x16x32_bf16 v[96:99], a[104:107], v[68:71], v[96:99]
    v_mfma_f32_16x16x32_bf16 v[88:91], a[108:111], v[68:71], v[88:91]
    v_mfma_f32_16x16x32_bf16 v[92:95], a[112:115], v[68:71], v[92:95]
    v_mfma_f32_16x16x32_bf16 v[96:99], a[116:119], v[68:71], v[96:99]
    v_add_u32 v65, 122880, v62
    v_add_u32 v66, 122880, v63
    v_add_u32 v67, 122880, v64
    s_waitcnt vmcnt(24)
    s_barrier
    ds_read_b64_tr_b16 a[120:121], v65 offset:0
    ds_read_b64_tr_b16 a[122:123], v65 offset:512
    ds_read_b64_tr_b16 a[124:125], v66 offset:0
    ds_read_b64_tr_b16 a[126:127], v66 offset:512
    ds_read_b64_tr_b16 a[128:129], v67 offset:0
    ds_read_b64_tr_b16 a[130:131], v67 offset:512
    ds_read_b64_tr_b16 a[132:133], v65 offset:4096
    ds_read_b64_tr_b16 a[134:135], v65 offset:4608
    ds_read_b64_tr_b16 a[136:137], v66 offset:4096
    ds_read_b64_tr_b16 a[138:139], v66 offset:4608
    ds_read_b64_tr_b16 a[140:141], v67 offset:4096
    ds_read_b64_tr_b16 a[142:143], v67 offset:4608
    s_add_u32 m0, s42, 98304
    s_nop 0
    buffer_load_dwordx4 v56, s[12:15], s54 offen lds
    s_add_u32 m0, s42, 99328
    s_nop 0
    buffer_load_dwordx4 v57, s[12:15], s54 offen lds
    s_add_u32 m0, s42, 106496
    s_nop 0
    buffer_load_dwordx4 v58, s[12:15], s54 offen lds
    s_add_u32 m0, s42, 107520
    s_nop 0
    buffer_load_dwordx4 v59, s[12:15], s54 offen lds
    s_add_u32 m0, s42, 114688
    s_nop 0
    buffer_load_dwordx4 v60, s[12:15], s54 offen lds
    s_add_u32 m0, s42, 115712
    s_nop 0
    buffer_load_dwordx4 v61, s[12:15], s54 offen lds
    s_add_u32 s54, s54, 458752
    s_waitcnt lgkmcnt(0)
    v_mfma_f32_16x16x32_bf16 v[88:91], a[120:123], v[68:71], v[88:91]
    v_mfma_f32_16x16x32_bf16 v[92:95], a[124:127], v[68:71], v[92:95]
    v_mfma_f32_16x16x32_bf16 v[96:99], a[128:131], v[68:71], v[96:99]
    v_mfma_f32_16x16x32_bf16 v[88:91], a[132:135], v[68:71], v[88:91]
    v_mfma_f32_16x16x32_bf16 v[92:95], a[136:139], v[68:71], v[92:95]
    v_mfma_f32_16x16x32_bf16 v[96:99], a[140:143], v[68:71], v[96:99]
    v_add_u32 v65, 0, v62
    v_add_u32 v66, 0, v63
    v_add_u32 v67, 0, v64
    s_waitcnt vmcnt(24)
    s_barrier
    ds_read_b64_tr_b16 a[144:145], v65 offset:0
    ds_read_b64_tr_b16 a[146:147], v65 offset:512
    ds_read_b64_tr_b16 a[148:149], v66 offset:0
    ds_read_b64_tr_b16 a[150:151], v66 offset:512
    ds_read_b64_tr_b16 a[152:153], v67 offset:0
    ds_read_b64_tr_b16 a[154:155], v67 offset:512
    ds_read_b64_tr_b16 a[156:157], v65 offset:4096
    ds_read_b64_tr_b16 a[158:159], v65 offset:4608
    ds_read_b64_tr_b16 a[160:161], v66 offset:4096
    ds_read_b64_tr_b16 a[162:163], v66 offset:4608
    ds_read_b64_tr_b16 a[164:165], v67 offset:4096
    ds_read_b64_tr_b16 a[166:167], v67 offset:4608
    s_add_u32 m0, s42, 122880
    s_nop 0
    buffer_load_dwordx4 v56, s[12:15], s54 offen lds
    s_add_u32 m0, s42, 123904
    s_nop 0
    buffer_load_dwordx4 v57, s[12:15], s54 offen lds
    s_add_u32 m0, s42, 131072
    s_nop 0
    buffer_load_dwordx4 v58, s[12:15], s54 offen lds
    s_add_u32 m0, s42, 132096
    s_nop 0
    buffer_load_dwordx4 v59, s[12:15], s54 offen lds
    s_add_u32 m0, s42, 139264
    s_nop 0
    buffer_load_dwordx4 v60, s[12:15], s54 offen lds
    s_add_u32 m0, s42, 140288
    s_nop 0
    buffer_load_dwordx4 v61, s[12:15], s54 offen lds
    s_add_u32 s54, s54, 458752
    s_waitcnt lgkmcnt(0)
    v_mfma_f32_16x16x32_bf16 v[88:91], a[144:147], v[68:71], v[88:91]
    v_mfma_f32_16x16x32_bf16 v[92:95], a[148:151], v[68:71], v[92:95]
    v_mfma_f32_16x16x32_bf16 v[96:99], a[152:155], v[68:71], v[96:99]
    v_mfma_f32_16x16x32_bf16 v[88:91], a[156:159], v[68:71], v[88:91]
    v_mfma_f32_16x16x32_bf16 v[92:95], a[160:163], v[68:71], v[92:95]
    v_mfma_f32_16x16x32_bf16 v[96:99], a[164:167], v[68:71], v[96:99]
    v_add_u32 v65, 24576, v62
    v_add_u32 v66, 24576, v63
    v_add_u32 v67, 24576, v64
    s_waitcnt vmcnt(24)
    s_barrier
    ds_read_b64_tr_b16 a[168:169], v65 offset:0
    ds_read_b64_tr_b16 a[170:171], v65 offset:512
    ds_read_b64_tr_b16 a[172:173], v66 offset:0
    ds_read_b64_tr_b16 a[174:175], v66 offset:512
    ds_read_b64_tr_b16 a[176:177], v67 offset:0
    ds_read_b64_tr_b16 a[178:179], v67 offset:512
    ds_read_b64_tr_b16 a[180:181], v65 offset:4096
    ds_read_b64_tr_b16 a[182:183], v65 offset:4608
    ds_read_b64_tr_b16 a[184:185], v66 offset:4096
    ds_read_b64_tr_b16 a[186:187], v66 offset:4608
    ds_read_b64_tr_b16 a[188:189], v67 offset:4096
    ds_read_b64_tr_b16 a[190:191], v67 offset:4608
    s_add_u32 m0, s42, 0
    s_nop 0
    buffer_load_dwordx4 v56, s[12:15], s54 offen lds
    s_add_u32 m0, s42, 1024
    s_nop 0
    buffer_load_dwordx4 v57, s[12:15], s54 offen lds
    s_add_u32 m0, s42, 8192
    s_nop 0
    buffer_load_dwordx4 v58, s[12:15], s54 offen lds
    s_add_u32 m0, s42, 9216
    s_nop 0
    buffer_load_dwordx4 v59, s[12:15], s54 offen lds
    s_add_u32 m0, s42, 16384
    s_nop 0
    buffer_load_dwordx4 v60, s[12:15], s54 offen lds
    s_add_u32 m0, s42, 17408
    s_nop 0
    buffer_load_dwordx4 v61, s[12:15], s54 offen lds
    s_add_u32 s54, s54, 458752
    s_waitcnt lgkmcnt(0)
    v_mfma_f32_16x16x32_bf16 v[88:91], a[168:171], v[68:71], v[88:91]
    v_mfma_f32_16x16x32_bf16 v[92:95], a[172:175], v[68:71], v[92:95]
    v_mfma_f32_16x16x32_bf16 v[96:99], a[176:179], v[68:71], v[96:99]
    v_mfma_f32_16x16x32_bf16 v[88:91], a[180:183], v[68:71], v[88:91]
    v_mfma_f32_16x16x32_bf16 v[92:95], a[184:187], v[68:71], v[92:95]
    v_mfma_f32_16x16x32_bf16 v[96:99], a[188:191], v[68:71], v[96:99]
    v_add_u32 v65, 49152, v62
    v_add_u32 v66, 49152, v63
    v_add_u32 v67, 49152, v64
    s_waitcnt vmcnt(24)
    s_barrier
    ds_read_b64_tr_b16 a[192:193], v65 offset:0
    ds_read_b64_tr_b16 a[194:195], v65 offset:512
    ds_read_b64_tr_b16 a[196:197], v66 offset:0
    ds_read_b64_tr_b16 a[198:199], v66 offset:512
    ds_read_b64_tr_b16 a[200:201], v67 offset:0
    ds_read_b64_tr_b16 a[202:203], v67 offset:512
    ds_read_b64_tr_b16 a[204:205], v65 offset:4096
    ds_read_b64_tr_b16 a[206:207], v65 offset:4608
    ds_read_b64_tr_b16 a[208:209], v66 offset:4096
    ds_read_b64_tr_b16 a[210:211], v66 offset:4608
    ds_read_b64_tr_b16 a[212:213], v67 offset:4096
    ds_read_b64_tr_b16 a[214:215], v67 offset:4608
    s_add_u32 m0, s42, 24576
    s_nop 0
    buffer_load_dwordx4 v56, s[12:15], s54 offen lds
    s_add_u32 m0, s42, 25600
    s_nop 0
    buffer_load_dwordx4 v57, s[12:15], s54 offen lds
    s_add_u32 m0, s42, 32768
    s_nop 0
    buffer_load_dwordx4 v58, s[12:15], s54 offen lds
    s_add_u32 m0, s42, 33792
    s_nop 0
    buffer_load_dwordx4 v59, s[12:15], s54 offen lds
    s_add_u32 m0, s42, 40960
    s_nop 0
    buffer_load_dwordx4 v60, s[12:15], s54 offen lds
    s_add_u32 m0, s42, 41984
    s_nop 0
    buffer_load_dwordx4 v61, s[12:15], s54 offen lds
    s_add_u32 s54, s54, 458752
    s_waitcnt lgkmcnt(0)
    v_mfma_f32_16x16x32_bf16 v[88:91], a[192:195], v[68:71], v[88:91]
    v_mfma_f32_16x16x32_bf16 v[92:95], a[196:199], v[68:71], v[92:95]
    v_mfma_f32_16x16x32_bf16 v[96:99], a[200:203], v[68:71], v[96:99]
    v_mfma_f32_16x16x32_bf16 v[88:91], a[204:207], v[68:71], v[88:91]
    v_mfma_f32_16x16x32_bf16 v[92:95], a[208:211], v[68:71], v[92:95]
    v_mfma_f32_16x16x32_bf16 v[96:99], a[212:215], v[68:71], v[96:99]
    v_add_u32 v65, 73728, v62
    v_add_u32 v66, 73728, v63
    v_add_u32 v67, 73728, v64
    s_waitcnt vmcnt(24)
    s_barrier
    ds_read_b64_tr_b16 a[216:217], v65 offset:0
    ds_read_b64_tr_b16 a[218:219], v65 offset:512
    ds_read_b64_tr_b16 a[220:221], v66 offset:0
    ds_read_b64_tr_b16 a[222:223], v66 offset:512
    ds_read_b64_tr_b16 a[224:225], v67 offset:0
    ds_read_b64_tr_b16 a[226:227], v67 offset:512
    ds_read_b64_tr_b16 a[228:229], v65 offset:4096
    ds_read_b64_tr_b16 a[230:231], v65 offset:4608
    ds_read_b64_tr_b16 a[232:233], v66 offset:4096
    ds_read_b64_tr_b16 a[234:235], v66 offset:4608
    ds_read_b64_tr_b16 a[236:237], v67 offset:4096
    ds_read_b64_tr_b16 a[238:239], v67 offset:4608
    s_add_u32 m0, s42, 49152
    s_nop 0
    buffer_load_dwordx4 v56, s[12:15], s54 offen lds
    s_add_u32 m0, s42, 50176
    s_nop 0
    buffer_load_dwordx4 v57, s[12:15], s54 offen lds
    s_add_u32 m0, s42, 57344
    s_nop 0
    buffer_load_dwordx4 v58, s[12:15], s54 offen lds
    s_add_u32 m0, s42, 58368
    s_nop 0
    buffer_load_dwordx4 v59, s[12:15], s54 offen lds
    s_add_u32 m0, s42, 65536
    s_nop 0
    buffer_load_dwordx4 v60, s[12:15], s54 offen lds
    s_add_u32 m0, s42, 66560
    s_nop 0
    buffer_load_dwordx4 v61, s[12:15], s54 offen lds
    s_add_u32 s54, s54, 458752
    s_waitcnt lgkmcnt(0)
    v_mfma_f32_16x16x32_bf16 v[88:91], a[216:219], v[68:71], v[88:91]
    v_mfma_f32_16x16x32_bf16 v[92:95], a[220:223], v[68:71], v[92:95]
    v_mfma_f32_16x16x32_bf16 v[96:99], a[224:227], v[68:71], v[96:99]
    v_mfma_f32_16x16x32_bf16 v[88:91], a[228:231], v[68:71], v[88:91]
    v_mfma_f32_16x16x32_bf16 v[92:95], a[232:235], v[68:71], v[92:95]
    v_mfma_f32_16x16x32_bf16 v[96:99], a[236:239], v[68:71], v[96:99]
    v_add_u32 v65, 98304, v62
    v_add_u32 v66, 98304, v63
    v_add_u32 v67, 98304, v64
    s_waitcnt vmcnt(24)
    s_barrier
    ds_read_b64_tr_b16 a[240:241], v65 offset:0
    ds_read_b64_tr_b16 a[242:243], v65 offset:512
    ds_read_b64_tr_b16 a[244:245], v66 offset:0
    ds_read_b64_tr_b16 a[246:247], v66 offset:512
    ds_read_b64_tr_b16 a[248:249], v67 offset:0
    ds_read_b64_tr_b16 a[250:251], v67 offset:512
    ds_read_b64_tr_b16 a[252:253], v65 offset:4096
    ds_read_b64_tr_b16 a[254:255], v65 offset:4608
    ds_read_b64_tr_b16 v[128:129], v66 offset:4096
    ds_read_b64_tr_b16 v[130:131], v66 offset:4608
    ds_read_b64_tr_b16 v[132:133], v67 offset:4096
    ds_read_b64_tr_b16 v[134:135], v67 offset:4608
    s_add_u32 m0, s42, 73728
    s_nop 0
    buffer_load_dwordx4 v56, s[12:15], s54 offen lds
    s_add_u32 m0, s42, 74752
    s_nop 0
    buffer_load_dwordx4 v57, s[12:15], s54 offen lds
    s_add_u32 m0, s42, 81920
    s_nop 0
    buffer_load_dwordx4 v58, s[12:15], s54 offen lds
    s_add_u32 m0, s42, 82944
    s_nop 0
    buffer_load_dwordx4 v59, s[12:15], s54 offen lds
    s_add_u32 m0, s42, 90112
    s_nop 0
    buffer_load_dwordx4 v60, s[12:15], s54 offen lds
    s_add_u32 m0, s42, 91136
    s_nop 0
    buffer_load_dwordx4 v61, s[12:15], s54 offen lds
    s_add_u32 s54, s54, 458752
    s_waitcnt lgkmcnt(0)
    v_mfma_f32_16x16x32_bf16 v[88:91], a[240:243], v[68:71], v[88:91]
    v_mfma_f32_16x16x32_bf16 v[92:95], a[244:247], v[68:71], v[92:95]
    v_mfma_f32_16x16x32_bf16 v[96:99], a[248:251], v[68:71], v[96:99]
    v_mfma_f32_16x16x32_bf16 v[88:91], a[252:255], v[68:71], v[88:91]
    v_mfma_f32_16x16x32_bf16 v[92:95], v[128:131], v[68:71], v[92:95]
    v_mfma_f32_16x16x32_bf16 v[96:99], v[132:135], v[68:71], v[96:99]
    v_add_u32 v65, 122880, v62
    v_add_u32 v66, 122880, v63
    v_add_u32 v67, 122880, v64
    s_waitcnt vmcnt(24)
    s_barrier
    ds_read_b64_tr_b16 v[136:137], v65 offset:0
    ds_read_b64_tr_b16 v[138:139], v65 offset:512
    ds_read_b64_tr_b16 v[140:141], v66 offset:0
    ds_read_b64_tr_b16 v[142:143], v66 offset:512
    ds_read_b64_tr_b16 v[144:145], v67 offset:0
    ds_read_b64_tr_b16 v[146:147], v67 offset:512
    ds_read_b64_tr_b16 v[148:149], v65 offset:4096
    ds_read_b64_tr_b16 v[150:151], v65 offset:4608
    ds_read_b64_tr_b16 v[152:153], v66 offset:4096
    ds_read_b64_tr_b16 v[154:155], v66 offset:4608
    ds_read_b64_tr_b16 v[156:157], v67 offset:4096
    ds_read_b64_tr_b16 v[158:159], v67 offset:4608
    s_waitcnt lgkmcnt(0)
    v_mfma_f32_16x16x32_bf16 v[88:91], v[136:139], v[68:71], v[88:91]
    v_mfma_f32_16x16x32_bf16 v[92:95], v[140:143], v[68:71], v[92:95]
    v_mfma_f32_16x16x32_bf16 v[96:99], v[144:147], v[68:71], v[96:99]
    v_mfma_f32_16x16x32_bf16 v[88:91], v[148:151], v[68:71], v[88:91]
    v_mfma_f32_16x16x32_bf16 v[92:95], v[152:155], v[68:71], v[92:95]
    v_mfma_f32_16x16x32_bf16 v[96:99], v[156:159], v[68:71], v[96:99]
    v_add_u32 v65, 0, v62
    v_add_u32 v66, 0, v63
    v_add_u32 v67, 0, v64
    s_waitcnt vmcnt(18)
    s_barrier
    ds_read_b64_tr_b16 v[160:161], v65 offset:0
    ds_read_b64_tr_b16 v[162:163], v65 offset:512
    ds_read_b64_tr_b16 v[164:165], v66 offset:0
    ds_read_b64_tr_b16 v[166:167], v66 offset:512
    ds_read_b64_tr_b16 v[168:169], v67 offset:0
    ds_read_b64_tr_b16 v[170:171], v67 offset:512
    ds_read_b64_tr_b16 v[172:173], v65 offset:4096
    ds_read_b64_tr_b16 v[174:175], v65 offset:4608
    ds_read_b64_tr_b16 v[176:177], v66 offset:4096
    ds_read_b64_tr_b16 v[178:179], v66 offset:4608
    ds_read_b64_tr_b16 v[180:181], v67 offset:4096
    ds_read_b64_tr_b16 v[182:183], v67 offset:4608
    s_waitcnt lgkmcnt(0)
    v_mfma_f32_16x16x32_bf16 v[88:91], v[160:163], v[68:71], v[88:91]
    v_mfma_f32_16x16x32_bf16 v[92:95], v[164:167], v[68:71], v[92:95]
    v_mfma_f32_16x16x32_bf16 v[96:99], v[168:171], v[68:71], v[96:99]
    v_mfma_f32_16x16x32_bf16 v[88:91], v[172:175], v[68:71], v[88:91]
    v_mfma_f32_16x16x32_bf16 v[92:95], v[176:179], v[68:71], v[92:95]
    v_mfma_f32_16x16x32_bf16 v[96:99], v[180:183], v[68:71], v[96:99]
    v_add_u32 v65, 24576, v62
    v_add_u32 v66, 24576, v63
    v_add_u32 v67, 24576, v64
    s_waitcnt vmcnt(12)
    s_barrier
    ds_read_b64_tr_b16 v[184:185], v65 offset:0
    ds_read_b64_tr_b16 v[186:187], v65 offset:512
    ds_read_b64_tr_b16 v[188:189], v66 offset:0
    ds_read_b64_tr_b16 v[190:191], v66 offset:512
    ds_read_b64_tr_b16 v[192:193], v67 offset:0
    ds_read_b64_tr_b16 v[194:195], v67 offset:512
    ds_read_b64_tr_b16 v[196:197], v65 offset:4096
    ds_read_b64_tr_b16 v[198:199], v65 offset:4608
    ds_read_b64_tr_b16 v[200:201], v66 offset:4096
    ds_read_b64_tr_b16 v[202:203], v66 offset:4608
    ds_read_b64_tr_b16 v[204:205], v67 offset:4096
    ds_read_b64_tr_b16 v[206:207], v67 offset:4608
    s_waitcnt lgkmcnt(0)
    v_mfma_f32_16x16x32_bf16 v[88:91], v[184:187], v[68:71], v[88:91]
    v_mfma_f32_16x16x32_bf16 v[92:95], v[188:191], v[68:71], v[92:95]
    v_mfma_f32_16x16x32_bf16 v[96:99], v[192:195], v[68:71], v[96:99]
    v_mfma_f32_16x16x32_bf16 v[88:91], v[196:199], v[68:71], v[88:91]
    v_mfma_f32_16x16x32_bf16 v[92:95], v[200:203], v[68:71], v[92:95]
    v_mfma_f32_16x16x32_bf16 v[96:99], v[204:207], v[68:71], v[96:99]
    v_add_u32 v65, 49152, v62
    v_add_u32 v66, 49152, v63
    v_add_u32 v67, 49152, v64
    s_waitcnt vmcnt(6)
    s_barrier
    ds_read_b64_tr_b16 v[208:209], v65 offset:0
    ds_read_b64_tr_b16 v[210:211], v65 offset:512
    ds_read_b64_tr_b16 v[212:213], v66 offset:0
    ds_read_b64_tr_b16 v[214:215], v66 offset:512
    ds_read_b64_tr_b16 v[216:217], v67 offset:0
    ds_read_b64_tr_b16 v[218:219], v67 offset:512
    ds_read_b64_tr_b16 v[220:221], v65 offset:4096
    ds_read_b64_tr_b16 v[222:223], v65 offset:4608
    ds_read_b64_tr_b16 v[224:225], v66 offset:4096
    ds_read_b64_tr_b16 v[226:227], v66 offset:4608
    ds_read_b64_tr_b16 v[228:229], v67 offset:4096
    ds_read_b64_tr_b16 v[230:231], v67 offset:4608
    s_waitcnt lgkmcnt(0)
    v_mfma_f32_16x16x32_bf16 v[88:91], v[208:211], v[68:71], v[88:91]
    v_mfma_f32_16x16x32_bf16 v[92:95], v[212:215], v[68:71], v[92:95]
    v_mfma_f32_16x16x32_bf16 v[96:99], v[216:219], v[68:71], v[96:99]
    v_mfma_f32_16x16x32_bf16 v[88:91], v[220:223], v[68:71], v[88:91]
    v_mfma_f32_16x16x32_bf16 v[92:95], v[224:227], v[68:71], v[92:95]
    v_mfma_f32_16x16x32_bf16 v[96:99], v[228:231], v[68:71], v[96:99]
    v_add_u32 v65, 73728, v62
    v_add_u32 v66, 73728, v63
    v_add_u32 v67, 73728, v64
    s_waitcnt vmcnt(0)
    s_barrier
    ds_read_b64_tr_b16 v[232:233], v65 offset:0
    ds_read_b64_tr_b16 v[234:235], v65 offset:512
    ds_read_b64_tr_b16 v[236:237], v66 offset:0
    ds_read_b64_tr_b16 v[238:239], v66 offset:512
    ds_read_b64_tr_b16 v[240:241], v67 offset:0
    ds_read_b64_tr_b16 v[242:243], v67 offset:512
    ds_read_b64_tr_b16 v[244:245], v65 offset:4096
    ds_read_b64_tr_b16 v[246:247], v65 offset:4608
    ds_read_b64_tr_b16 v[248:249], v66 offset:4096
    ds_read_b64_tr_b16 v[250:251], v66 offset:4608
    ds_read_b64_tr_b16 v[252:253], v67 offset:4096
    ds_read_b64_tr_b16 v[254:255], v67 offset:4608
    s_waitcnt lgkmcnt(0)
    v_mfma_f32_16x16x32_bf16 v[88:91], v[232:235], v[68:71], v[88:91]
    v_mfma_f32_16x16x32_bf16 v[92:95], v[236:239], v[68:71], v[92:95]
    v_mfma_f32_16x16x32_bf16 v[96:99], v[240:243], v[68:71], v[96:99]
    v_mfma_f32_16x16x32_bf16 v[88:91], v[244:247], v[68:71], v[88:91]
    v_mfma_f32_16x16x32_bf16 v[92:95], v[248:251], v[68:71], v[92:95]
    v_mfma_f32_16x16x32_bf16 v[96:99], v[252:255], v[68:71], v[96:99]
    s_barrier
    s_mov_b32 s37, 0xffff0000
    v_lshlrev_b32 v100, 16, v16
    v_and_b32 v101, s37, v16
    v_lshlrev_b32 v102, 16, v17
    v_and_b32 v103, s37, v17
    v_lshlrev_b32 v104, 16, v18
    v_and_b32 v105, s37, v18
    v_lshlrev_b32 v106, 16, v19
    v_and_b32 v107, s37, v19
    v_lshlrev_b32 v108, 16, v20
    v_and_b32 v109, s37, v20
    v_lshlrev_b32 v110, 16, v21
    v_and_b32 v111, s37, v21
    s_add_u32 s20, s82, 128
    s_addc_u32 s21, s83, 0
    s_mov_b32 s22, 128
    s_mov_b32 s23, 0x00020000
    buffer_load_dword v56, v124, s[20:23], 0 offen offset:32 sc1
    s_waitcnt vmcnt(0)
    v_readfirstlane_b32 s37, v56
    s_nop 0
    s_cmp_lg_u32 s37, s3
    s_cbranch_scc1 L_vspin13
L_vback14:
    s_cmp_lg_u32 s32, 0
    s_cbranch_scc1 L_arv15
    s_add_u32 s20, s82, 0x80
    s_addc_u32 s21, s83, 0
    s_mov_b32 s22, 0x4
    s_mov_b32 s23, 0x00020000
    buffer_load_dword v56, v124, s[20:23], 0 offen sc1
    s_waitcnt vmcnt(0)
    v_cmp_eq_u32 vcc, v124, v56
    s_cbranch_vccnz L_spin16
L_back17:
L_arv15:
    s_add_u32 s96, s41, 2031616
    s_mov_b32 s98, s41
    s_mov_b32 s45, 0x5530000
    buffer_load_dword v7, v5, s[16:19], s45 offen sc1
    s_waitcnt vmcnt(0)
    v_cmp_ne_u32 vcc, 0, v7
    s_cbranch_vccnz L_spin18
L_back19:
    s_barrier
    s_add_u32 m0, s43, 0
    s_add_u32 s42, s41, 0
    buffer_load_dwordx4 v1, s[16:19], s42 offen offset:0 sc1 lds
    buffer_load_dwordx4 v1, s[16:19], s42 offen offset:1024 sc1 lds
    buffer_load_dwordx4 v1, s[16:19], s42 offen offset:2048 sc1 lds
    buffer_load_dwordx4 v1, s[16:19], s42 offen offset:3072 sc1 lds
    s_add_u32 m0, s43, 16384
    s_add_u32 s42, s41, 16384
    buffer_load_dwordx4 v1, s[16:19], s42 offen offset:0 sc1 lds
    buffer_load_dwordx4 v1, s[16:19], s42 offen offset:1024 sc1 lds
    buffer_load_dwordx4 v1, s[16:19], s42 offen offset:2048 sc1 lds
    buffer_load_dwordx4 v1, s[16:19], s42 offen offset:3072 sc1 lds
    s_add_u32 m0, s43, 32768
    s_add_u32 s42, s41, 32768
    buffer_load_dwordx4 v1, s[16:19], s42 offen offset:0 sc1 lds
    buffer_load_dwordx4 v1, s[16:19], s42 offen offset:1024 sc1 lds
    buffer_load_dwordx4 v1, s[16:19], s42 offen offset:2048 sc1 lds
    buffer_load_dwordx4 v1, s[16:19], s42 offen offset:3072 sc1 lds
    s_add_u32 m0, s43, 49152
    s_add_u32 s42, s41, 49152
    buffer_load_dwordx4 v1, s[16:19], s42 offen offset:0 sc1 lds
    buffer_load_dwordx4 v1, s[16:19], s42 offen offset:1024 sc1 lds
    buffer_load_dwordx4 v1, s[16:19], s42 offen offset:2048 sc1 lds
    buffer_load_dwordx4 v1, s[16:19], s42 offen offset:3072 sc1 lds
    s_add_u32 s45, s45, 65536
    s_waitcnt vmcnt(0) lgkmcnt(0)
    s_barrier
    ds_read_b128 v[56:59], v1 offset:0
    ds_read_b128 v[60:63], v1 offset:1024
    ds_read_b128 v[64:67], v1 offset:2048
    ds_read_b128 v[68:71], v1 offset:3072
    s_mov_b32 s36, 0
    s_waitcnt lgkmcnt(0)
    s_nop 7
L_a_b0:
    v_mfma_f32_16x16x32_bf16 v[8:11], a[0:3], v[56:59], 0
    s_and_b32 s44, s90, 0xffffffff
    ds_read_b128 v[72:75], v1 offset:4096
    v_mul_f32 v120, v48, v116
    v_mfma_f32_16x16x32_bf16 v[16:19], a[0:3], v[60:63], 0
    s_cmp_lt_i32 s36, 1
    v_mul_f32 v121, v49, v116
    v_mul_f32 v120, v120, abs(v48)
    v_mfma_f32_16x16x32_bf16 v[20:23], a[4:7], v[60:63], 0
    s_cselect_b32 s44, 0x5e00000, s44
    v_mul_f32 v121, v121, abs(v49)
    v_cvt_pk_bf16_f32 v48, v120, v121
    v_mfma_f32_16x16x32_bf16 v[12:15], a[4:7], v[56:59], 0
    s_add_u32 s49, s44, s87
    ds_read_b128 v[76:79], v1 offset:5120
    v_pk_max_i16 v48, v48, 0
    v_mfma_f32_16x16x32_bf16 v[24:27], a[8:11], v[56:59], 0
    s_max_u32 s44, s44, s88
    v_mul_f32 v120, v50, v116
    v_mul_f32 v121, v51, v116
    v_mfma_f32_16x16x32_bf16 v[28:31], a[8:11], v[60:63], 0
    s_waitcnt lgkmcnt(2)
    v_mul_f32 v120, v120, abs(v50)
    v_mul_f32 v121, v121, abs(v51)
    v_mfma_f32_16x16x32_bf16 v[8:11], a[12:15], v[64:67], v[8:11]
    s_add_u32 s90, s90, 262144
    ds_read_b128 v[80:83], v1 offset:6144
    v_cvt_pk_bf16_f32 v49, v120, v121
    v_mfma_f32_16x16x32_bf16 v[16:19], a[12:15], v[68:71], v[16:19]
    s_add_u32 m0, s52, 73728
    v_pk_max_i16 v49, v49, 0
    s_add_u32 s42, s46, s52
    v_mfma_f32_16x16x32_bf16 v[20:23], a[16:19], v[68:71], v[20:23]
    buffer_load_dwordx4 v1, s[16:19], s42 offen sc1 lds
    v_mfma_f32_16x16x32_bf16 v[12:15], a[16:19], v[64:67], v[12:15]
    s_add_u32 s98, s98, 65536
    ds_read_b128 v[84:87], v1 offset:7168
    s_min_i32 s98, s98, s96
    v_mfma_f32_16x16x32_bf16 v[24:27], a[20:23], v[64:67], v[24:27]
    s_and_b32 s41, s98, 0xffffffff
    ds_write_b64 v3, v[48:49] offset:4096
    v_mfma_f32_16x16x32_bf16 v[28:31], a[20:23], v[68:71], v[28:31]
    s_waitcnt lgkmcnt(3)
    v_mul_f32 v120, v52, v117
    v_mul_f32 v121, v53, v117
    v_mfma_f32_16x16x32_bf16 v[8:11], a[24:27], v[72:75], v[8:11]
    ds_read_b128 v[56:59], v1 offset:8192
    v_mul_f32 v120, v120, abs(v52)
    v_mfma_f32_16x16x32_bf16 v[16:19], a[24:27], v[76:79], v[16:19]
    v_mul_f32 v121, v121, abs(v53)
    v_cvt_pk_bf16_f32 v52, v120, v121
    v_mfma_f32_16x16x32_bf16 v[20:23], a[28:31], v[76:79], v[20:23]
    v_pk_max_i16 v52, v52, 0
    v_mul_f32 v120, v54, v117
    v_mfma_f32_16x16x32_bf16 v[12:15], a[28:31], v[72:75], v[12:15]
    ds_read_b128 v[60:63], v1 offset:9216
    v_mul_f32 v121, v55, v117
    v_mfma_f32_16x16x32_bf16 v[24:27], a[32:35], v[72:75], v[24:27]
    v_mul_f32 v120, v120, abs(v54)
    v_mul_f32 v121, v121, abs(v55)
    v_mfma_f32_16x16x32_bf16 v[28:31], a[32:35], v[76:79], v[28:31]
    s_waitcnt lgkmcnt(3)
    v_cvt_pk_bf16_f32 v53, v120, v121
    v_pk_max_i16 v53, v53, 0
    v_mfma_f32_16x16x32_bf16 v[8:11], a[36:39], v[80:83], v[8:11]
    ds_read_b128 v[64:67], v1 offset:10240
    v_mfma_f32_16x16x32_bf16 v[16:19], a[36:39], v[84:87], v[16:19]
    ds_write_b64 v3, v[52:53] offset:5120
    v_mfma_f32_16x16x32_bf16 v[20:23], a[40:43], v[84:87], v[20:23]
    v_mul_f32 v120, v32, v116
    v_mul_f32 v121, v33, v116
    v_mfma_f32_16x16x32_bf16 v[12:15], a[40:43], v[80:83], v[12:15]
    ds_read_b128 v[68:71], v1 offset:11264
    v_mul_f32 v120, v120, abs(v32)
    v_mfma_f32_16x16x32_bf16 v[24:27], a[44:47], v[80:83], v[24:27]
    v_mul_f32 v121, v121, abs(v33)
    v_cvt_pk_bf16_f32 v32, v120, v121
    v_mfma_f32_16x16x32_bf16 v[28:31], a[44:47], v[84:87], v[28:31]
    s_waitcnt lgkmcnt(3)
    v_pk_max_i16 v32, v32, 0
    v_mul_f32 v120, v34, v116
    v_mfma_f32_16x16x32_bf16 v[8:11], a[48:51], v[56:59], v[8:11]
    ds_read_b128 v[72:75], v1 offset:12288
    v_mul_f32 v121, v35, v116
    v_mfma_f32_16x16x32_bf16 v[16:19], a[48:51], v[60:63], v[16:19]
    v_mul_f32 v120, v120, abs(v34)
    v_mul_f32 v121, v121, abs(v35)
    v_mfma_f32_16x16x32_bf16 v[20:23], a[52:55], v[60:63], v[20:23]
    v_cvt_pk_bf16_f32 v33, v120, v121
    v_pk_max_i16 v33, v33, 0
    v_mfma_f32_16x16x32_bf16 v[12:15], a[52:55], v[56:59], v[12:15]
    ds_read_b128 v[76:79], v1 offset:13312
    v_mul_f32 v120, v36, v116
    v_mfma_f32_16x16x32_bf16 v[24:27], a[56:59], v[56:59], v[24:27]
    v_mul_f32 v121, v37, v116
    v_mul_f32 v120, v120, abs(v36)
    v_mfma_f32_16x16x32_bf16 v[28:31], a[56:59], v[60:63], v[28:31]
    s_waitcnt vmcnt(9) lgkmcnt(2)
    s_barrier
    v_mul_f32 v121, v121, abs(v37)
    v_mfma_f32_16x16x32_bf16 v[8:11], a[60:63], v[64:67], v[8:11]
    ds_read_b128 v[80:83], v1 offset:14336
    v_cvt_pk_bf16_f32 v34, v120, v121
    v_mfma_f32_16x16x32_bf16 v[16:19], a[60:63], v[68:71], v[16:19]
    ds_read_b128 v[48:51], v4 offset:4096
    v_pk_max_i16 v34, v34, 0
    v_mfma_f32_16x16x32_bf16 v[20:23], a[64:67], v[68:71], v[20:23]
    buffer_load_dword v7, v5, s[16:19], s45 offen sc1
    v_mfma_f32_16x16x32_bf16 v[12:15], a[64:67], v[64:67], v[12:15]
    ds_read_b128 v[84:87], v1 offset:15360
    v_mul_f32 v120, v38, v116
    v_mfma_f32_16x16x32_bf16 v[24:27], a[68:71], v[64:67], v[24:27]
    v_mul_f32 v121, v39, v116
    v_mul_f32 v120, v120, abs(v38)
    v_mfma_f32_16x16x32_bf16 v[28:31], a[68:71], v[68:71], v[28:31]
    s_waitcnt lgkmcnt(3)
    v_mul_f32 v121, v121, abs(v39)
    v_cvt_pk_bf16_f32 v35, v120, v121
    v_mfma_f32_16x16x32_bf16 v[8:11], a[72:75], v[72:75], v[8:11]
    s_waitcnt lgkmcnt(1)
    ds_read_b128 v[56:59], v1 offset:16384
    v_pk_max_i16 v35, v35, 0
    v_mfma_f32_16x16x32_bf16 v[16:19], a[72:75], v[76:79], v[16:19]
    buffer_store_dwordx4 v[48:51], v1, s[16:19], s49 offen sc1
    v_mfma_f32_16x16x32_bf16 v[20:23], a[76:79], v[76:79], v[20:23]
    buffer_store_dwordx4 v[32:35], v1, s[16:19], s44 offen offset:0 sc1
    v_mfma_f32_16x16x32_bf16 v[12:15], a[76:79], v[72:75], v[12:15]
    ds_read_b128 v[60:63], v1 offset:17408
    v_mul_f32 v120, v40, v117
    v_mfma_f32_16x16x32_bf16 v[24:27], a[80:83], v[72:75], v[24:27]
    v_mul_f32 v121, v41, v117
    v_mul_f32 v120, v120, abs(v40)
    v_mfma_f32_16x16x32_bf16 v[28:31], a[80:83], v[76:79], v[28:31]
    s_waitcnt lgkmcnt(2)
    v_mul_f32 v121, v121, abs(v41)
    v_cvt_pk_bf16_f32 v40, v120, v121
    v_mfma_f32_16x16x32_bf16 v[8:11], a[84:87], v[80:83], v[8:11]
    ds_read_b128 v[64:67], v1 offset:18432
    v_pk_max_i16 v40, v40, 0
    v_mfma_f32_16x16x32_bf16 v[16:19], a[84:87], v[84:87], v[16:19]
    v_mul_f32 v120, v42, v117
    v_mul_f32 v121, v43, v117
    v_mfma_f32_16x16x32_bf16 v[20:23], a[88:91], v[84:87], v[20:23]
    v_mul_f32 v120, v120, abs(v42)
    v_mul_f32 v121, v121, abs(v43)
    v_mfma_f32_16x16x32_bf16 v[12:15], a[88:91], v[80:83], v[12:15]
    ds_read_b128 v[68:71], v1 offset:19456
    v_cvt_pk_bf16_f32 v41, v120, v121
    v_mfma_f32_16x16x32_bf16 v[24:27], a[92:95], v[80:83], v[24:27]
    v_pk_max_i16 v41, v41, 0
    v_mul_f32 v120, v44, v117
    v_mfma_f32_16x16x32_bf16 v[28:31], a[92:95], v[84:87], v[28:31]
    s_waitcnt lgkmcnt(2)
    v_mul_f32 v121, v45, v117
    v_mul_f32 v120, v120, abs(v44)
    v_mfma_f32_16x16x32_bf16 v[8:11], a[96:99], v[56:59], v[8:11]
    ds_read_b128 v[72:75], v1 offset:20480
    v_mul_f32 v121, v121, abs(v45)
    v_mfma_f32_16x16x32_bf16 v[16:19], a[96:99], v[60:63], v[16:19]
    v_cvt_pk_bf16_f32 v42, v120, v121
    v_pk_max_i16 v42, v42, 0
    v_mfma_f32_16x16x32_bf16 v[20:23], a[100:103], v[60:63], v[20:23]
    v_mul_f32 v120, v46, v117
    v_mul_f32 v121, v47, v117
    v_mfma_f32_16x16x32_bf16 v[12:15], a[100:103], v[56:59], v[12:15]
    ds_read_b128 v[76:79], v1 offset:21504
    v_mul_f32 v120, v120, abs(v46)
    v_mfma_f32_16x16x32_bf16 v[24:27], a[104:107], v[56:59], v[24:27]
    v_mul_f32 v121, v121, abs(v47)
    v_cvt_pk_bf16_f32 v43, v120, v121
    v_mfma_f32_16x16x32_bf16 v[28:31], a[104:107], v[60:63], v[28:31]
    s_waitcnt lgkmcnt(2)
    v_pk_max_i16 v43, v43, 0
    v_mfma_f32_16x16x32_bf16 v[8:11], a[108:111], v[64:67], v[8:11]
    ds_read_b128 v[80:83], v1 offset:22528
    v_mfma_f32_16x16x32_bf16 v[16:19], a[108:111], v[68:71], v[16:19]
    buffer_store_dwordx4 v[40:43], v1, s[16:19], s44 offen offset:1024 sc1
    v_mfma_f32_16x16x32_bf16 v[20:23], a[112:115], v[68:71], v[20:23]
    v_mfma_f32_16x16x32_bf16 v[12:15], a[112:115], v[64:67], v[12:15]
    ds_read_b128 v[84:87], v1 offset:23552
    v_mfma_f32_16x16x32_bf16 v[24:27], a[116:119], v[64:67], v[24:27]
    v_mfma_f32_16x16x32_bf16 v[28:31], a[116:119], v[68:71], v[28:31]
    s_waitcnt lgkmcnt(2)
    v_mfma_f32_16x16x32_bf16 v[8:11], a[120:123], v[72:75], v[8:11]
    ds_read_b128 v[56:59], v1 offset:24576
    v_mfma_f32_16x16x32_bf16 v[16:19], a[120:123], v[76:79], v[16:19]
    v_mfma_f32_16x16x32_bf16 v[20:23], a[124:127], v[76:79], v[20:23]
    v_mfma_f32_16x16x32_bf16 v[12:15], a[124:127], v[72:75], v[12:15]
    ds_read_b128 v[60:63], v1 offset:25600
    v_mfma_f32_16x16x32_bf16 v[24:27], a[128:131], v[72:75], v[24:27]
    v_mfma_f32_16x16x32_bf16 v[28:31], a[128:131], v[76:79], v[28:31]
    s_waitcnt lgkmcnt(2)
    v_mfma_f32_16x16x32_bf16 v[8:11], a[132:135], v[80:83], v[8:11]
    ds_read_b128 v[64:67], v1 offset:26624
    v_mfma_f32_16x16x32_bf16 v[16:19], a[132:135], v[84:87], v[16:19]
    v_mfma_f32_16x16x32_bf16 v[20:23], a[136:139], v[84:87], v[20:23]
    v_mfma_f32_16x16x32_bf16 v[12:15], a[136:139], v[80:83], v[12:15]
    ds_read_b128 v[68:71], v1 offset:27648
    v_mfma_f32_16x16x32_bf16 v[24:27], a[140:143], v[80:83], v[24:27]
    v_mfma_f32_16x16x32_bf16 v[28:31], a[140:143], v[84:87], v[28:31]
    s_waitcnt lgkmcnt(2)
    v_mfma_f32_16x16x32_bf16 v[8:11], a[144:147], v[56:59], v[8:11]
    ds_read_b128 v[72:75], v1 offset:28672
    v_mfma_f32_16x16x32_bf16 v[16:19], a[144:147], v[60:63], v[16:19]
    v_mfma_f32_16x16x32_bf16 v[20:23], a[148:151], v[60:63], v[20:23]
    v_mfma_f32_16x16x32_bf16 v[12:15], a[148:151], v[56:59], v[12:15]
    ds_read_b128 v[76:79], v1 offset:29696
    v_mfma_f32_16x16x32_bf16 v[24:27], a[152:155], v[56:59], v[24:27]
    v_mfma_f32_16x16x32_bf16 v[28:31], a[152:155], v[60:63], v[28:31]
    s_waitcnt lgkmcnt(2)
    v_mfma_f32_16x16x32_bf16 v[8:11], a[156:159], v[64:67], v[8:11]
    ds_read_b128 v[80:83], v1 offset:30720
    v_mfma_f32_16x16x32_bf16 v[16:19], a[156:159], v[68:71], v[16:19]
    s_waitcnt vmcnt(3)
    v_cmp_ne_u32 vcc, 0, v7
    v_mfma_f32_16x16x32_bf16 v[20:23], a[160:163], v[68:71], v[20:23]
    v_mfma_f32_16x16x32_bf16 v[12:15], a[160:163], v[64:67], v[12:15]
    s_cbranch_vccnz L_spin20
L_back21:
    ds_read_b128 v[84:87], v1 offset:31744
    v_mfma_f32_16x16x32_bf16 v[24:27], a[164:167], v[64:67], v[24:27]
    v_mfma_f32_16x16x32_bf16 v[28:31], a[164:167], v[68:71], v[28:31]
    s_waitcnt vmcnt(4) lgkmcnt(2)
    s_barrier
    v_mfma_f32_16x16x32_bf16 v[8:11], a[168:171], v[72:75], v[8:11]
    s_add_u32 m0, s43, 98304
    ds_read_b128 v[56:59], v1 offset:32768
    s_add_u32 s42, s41, 0
    v_mfma_f32_16x16x32_bf16 v[16:19], a[168:171], v[76:79], v[16:19]
    buffer_load_dwordx4 v1, s[16:19], s42 offen offset:0 sc1 lds
    v_mfma_f32_16x16x32_bf16 v[20:23], a[172:175], v[76:79], v[20:23]
    ds_read_b64 v[36:37], v118 offset:0
    v_mfma_f32_16x16x32_bf16 v[12:15], a[172:175], v[72:75], v[12:15]
    ds_read_b128 v[60:63], v1 offset:33792
    v_mfma_f32_16x16x32_bf16 v[24:27], a[176:179], v[72:75], v[24:27]
    ds_read_b64 v[38:39], v118 offset:128
    v_mfma_f32_16x16x32_bf16 v[28:31], a[176:179], v[76:79], v[28:31]
    s_waitcnt lgkmcnt(4)
    ds_read_b64 v[40:41], v118 offset:256
    v_mfma_f32_16x16x32_bf16 v[8:11], a[180:183], v[80:83], v[8:11]
    ds_read_b128 v[64:67], v1 offset:34816
    v_mfma_f32_16x16x32_bf16 v[16:19], a[180:183], v[84:87], v[16:19]
    buffer_load_dwordx4 v1, s[16:19], s42 offen offset:1024 sc1 lds
    v_mfma_f32_16x16x32_bf16 v[20:23], a[184:187], v[84:87], v[20:23]
    ds_read_b64 v[42:43], v118 offset:384
    v_mfma_f32_16x16x32_bf16 v[12:15], a[184:187], v[80:83], v[12:15]
    ds_read_b128 v[68:71], v1 offset:35840
    v_mfma_f32_16x16x32_bf16 v[24:27], a[188:191], v[80:83], v[24:27]
    v_mfma_f32_16x16x32_bf16 v[28:31], a[188:191], v[84:87], v[28:31]
    s_waitcnt lgkmcnt(5)
    v_mfma_f32_16x16x32_bf16 v[8:11], a[192:195], v[56:59], v[8:11]
    ds_read_b128 v[72:75], v1 offset:36864
    v_mfma_f32_16x16x32_bf16 v[16:19], a[192:195], v[60:63], v[16:19]
    buffer_load_dwordx4 v1, s[16:19], s42 offen offset:2048 sc1 lds
    v_mfma_f32_16x16x32_bf16 v[20:23], a[196:199], v[60:63], v[20:23]
    s_waitcnt lgkmcnt(2)
    v_max3_u32 v44, v36, v37, v38
    v_max3_u32 v45, v39, v40, v41
    v_mfma_f32_16x16x32_bf16 v[12:15], a[196:199], v[56:59], v[12:15]
    ds_read_b128 v[76:79], v1 offset:37888
    v_max3_u32 v44, v44, v42, v43
    v_mfma_f32_16x16x32_bf16 v[24:27], a[200:203], v[56:59], v[24:27]
    v_max_u32 v44, v44, v45
    v_cmp_eq_u32 vcc, -1, v44
    v_mfma_f32_16x16x32_bf16 v[28:31], a[200:203], v[60:63], v[28:31]
    s_waitcnt lgkmcnt(2)
    v_mfma_f32_16x16x32_bf16 v[8:11], a[204:207], v[64:67], v[8:11]
    s_cbranch_vccnz L_sspin22
L_sback23:
    ds_read_b128 v[80:83], v1 offset:38912
    v_add_f32 v44, v40, v42
    v_mfma_f32_16x16x32_bf16 v[16:19], a[204:207], v[68:71], v[16:19]
    buffer_load_dwordx4 v1, s[16:19], s42 offen offset:3072 sc1 lds
    v_mfma_f32_16x16x32_bf16 v[20:23], a[208:211], v[68:71], v[20:23]
    s_add_u32 m0, s43, 114688
    v_add_f32 v45, v41, v43
    v_add_f32 v36, v36, v38
    v_mfma_f32_16x16x32_bf16 v[12:15], a[208:211], v[64:67], v[12:15]
    s_add_u32 s42, s41, 16384
    ds_read_b128 v[84:87], v1 offset:39936
    v_add_f32 v37, v37, v39
    v_mfma_f32_16x16x32_bf16 v[24:27], a[212:215], v[64:67], v[24:27]
    v_add_f32 v36, v36, v44
    v_add_f32 v37, v37, v45
    v_mfma_f32_16x16x32_bf16 v[28:31], a[212:215], v[68:71], v[28:31]
    s_waitcnt lgkmcnt(2)
    v_mov_b32 v44, v36
    v_mov_b32 v45, v37
    v_mfma_f32_16x16x32_bf16 v[8:11], a[216:219], v[72:75], v[8:11]
    ds_read_b128 v[56:59], v1 offset:40960
    v_mfma_f32_16x16x32_bf16 v[16:19], a[216:219], v[76:79], v[16:19]
    buffer_load_dwordx4 v1, s[16:19], s42 offen offset:0 sc1 lds
    v_mfma_f32_16x16x32_bf16 v[20:23], a[220:223], v[76:79], v[20:23]
    v_permlane32_swap_b32 v36, v44
    v_mfma_f32_16x16x32_bf16 v[12:15], a[220:223], v[72:75], v[12:15]
    ds_read_b128 v[60:63], v1 offset:41984
    v_mfma_f32_16x16x32_bf16 v[24:27], a[224:227], v[72:75], v[24:27]
    v_permlane32_swap_b32 v37, v45
    v_mfma_f32_16x16x32_bf16 v[28:31], a[224:227], v[76:79], v[28:31]
    s_waitcnt lgkmcnt(2)
    v_add_f32 v36, v36, v44
    v_add_f32 v37, v37, v45
    v_mfma_f32_16x16x32_bf16 v[8:11], a[228:231], v[80:83], v[8:11]
    ds_read_b128 v[64:67], v1 offset:43008
    v_mul_f32 v112, 0xba800000, v36
    v_mfma_f32_16x16x32_bf16 v[16:19], a[228:231], v[84:87], v[16:19]
    buffer_load_dwordx4 v1, s[16:19], s42 offen offset:1024 sc1 lds
    v_mfma_f32_16x16x32_bf16 v[20:23], a[232:235], v[84:87], v[20:23]
    v_mul_f32 v37, 0x3a800000, v37
    v_fma_f32 v37, -v112, v112, v37
    v_mfma_f32_16x16x32_bf16 v[12:15], a[232:235], v[80:83], v[12:15]
    ds_read_b128 v[68:71], v1 offset:44032
    v_mov_b32 v113, v112
    v_mfma_f32_16x16x32_bf16 v[24:27], a[236:239], v[80:83], v[24:27]
    s_waitcnt vmcnt(6)
    v_max_f32 v37, 0, v37
    v_add_f32 v37, 0x3727c5ac, v37
    v_mfma_f32_16x16x32_bf16 v[28:31], a[236:239], v[84:87], v[28:31]
    s_waitcnt lgkmcnt(2)
    v_rsq_f32 v116, v37
    v_mfma_f32_16x16x32_bf16 v[8:11], a[240:243], v[56:59], v[8:11]
    s_barrier
    ds_read_b128 v[72:75], v1 offset:45056
    v_mfma_f32_16x16x32_bf16 v[16:19], a[240:243], v[60:63], v[16:19]
    buffer_store_dword v124, v124, s[16:19], s91 offen sc1
    v_mfma_f32_16x16x32_bf16 v[20:23], a[244:247], v[60:63], v[20:23]
    buffer_load_dwordx4 v1, s[16:19], s42 offen offset:2048 sc1 lds
    v_mfma_f32_16x16x32_bf16 v[12:15], a[244:247], v[56:59], v[12:15]
    s_add_u32 s91, s91, 65536
    ds_read_b128 v[76:79], v1 offset:46080
    v_mfma_f32_16x16x32_bf16 v[24:27], a[248:251], v[56:59], v[24:27]
    v_permlane16_swap_b32 v112, v113
    v_mfma_f32_16x16x32_bf16 v[28:31], a[248:251], v[60:63], v[28:31]
    s_waitcnt lgkmcnt(2)
    v_mul_f32 v114, v37, v116
    v_mul_f32 v116, v116, v116
    v_mfma_f32_16x16x32_bf16 v[8:11], a[252:255], v[64:67], v[8:11]
    ds_read_b128 v[80:83], v1 offset:47104
    v_mov_b32 v115, v114
    v_mfma_f32_16x16x32_bf16 v[16:19], a[252:255], v[68:71], v[16:19]
    v_mov_b32 v117, v116
    v_fmac_f32 v12, v112, v92
    v_mfma_f32_16x16x32_bf16 v[20:23], v[128:131], v[68:71], v[20:23]
    buffer_load_dwordx4 v1, s[16:19], s42 offen offset:3072 sc1 lds
    v_mfma_f32_16x16x32_bf16 v[12:15], v[128:131], v[64:67], v[12:15]
    s_add_u32 m0, s43, 131072
    ds_read_b128 v[84:87], v1 offset:48128
    v_fmac_f32 v8, v112, v88
    v_mfma_f32_16x16x32_bf16 v[24:27], v[132:135], v[64:67], v[24:27]
    s_add_u32 s42, s41, 32768
    v_permlane16_swap_b32 v114, v115
    v_mfma_f32_16x16x32_bf16 v[28:31], v[132:135], v[68:71], v[28:31]
    s_waitcnt lgkmcnt(2)
    v_permlane16_swap_b32 v116, v117
    v_mfma_f32_16x16x32_bf16 v[8:11], v[136:139], v[72:75], v[8:11]
    s_add_u32 s46, s46, 2048
    ds_read_b128 v[56:59], v1 offset:49152
    v_fmac_f32 v13, v112, v93
    v_mfma_f32_16x16x32_bf16 v[16:19], v[136:139], v[76:79], v[16:19]
    s_min_u32 s46, s46, s55
    v_fmac_f32 v14, v112, v94
    v_fmac_f32 v15, v112, v95
    v_mfma_f32_16x16x32_bf16 v[20:23], v[140:143], v[76:79], v[20:23]
    buffer_load_dwordx4 v1, s[16:19], s42 offen offset:0 sc1 lds
    v_mfma_f32_16x16x32_bf16 v[12:15], v[140:143], v[72:75], v[12:15]
    ds_read_b128 v[60:63], v1 offset:50176
    v_fmac_f32 v9, v112, v89
    v_mfma_f32_16x16x32_bf16 v[24:27], v[144:147], v[72:75], v[24:27]
    v_fmac_f32 v10, v112, v90
    v_fmac_f32 v11, v112, v91
    v_mfma_f32_16x16x32_bf16 v[28:31], v[144:147], v[76:79], v[28:31]
    s_waitcnt lgkmcnt(2)
    v_fmac_f32 v16, v113, v88
    v_fmac_f32 v17, v113, v89
    v_mfma_f32_16x16x32_bf16 v[8:11], v[148:151], v[80:83], v[8:11]
    ds_read_b128 v[64:67], v1 offset:51200
    v_fmac_f32 v12, v114, v104
    v_mfma_f32_16x16x32_bf16 v[16:19], v[148:151], v[84:87], v[16:19]
    v_fmac_f32 v13, v114, v105
    v_fmac_f32 v14, v114, v106
    v_mfma_f32_16x16x32_bf16 v[20:23], v[152:155], v[84:87], v[20:23]
    buffer_load_dwordx4 v1, s[16:19], s42 offen offset:1024 sc1 lds
    v_mfma_f32_16x16x32_bf16 v[12:15], v[152:155], v[80:83], v[12:15]
    ds_read_b128 v[68:71], v1 offset:52224
    v_fmac_f32 v8, v114, v100
    v_mfma_f32_16x16x32_bf16 v[24:27], v[156:159], v[80:83], v[24:27]
    v_fmac_f32 v9, v114, v101
    v_fmac_f32 v10, v114, v102
    v_mfma_f32_16x16x32_bf16 v[28:31], v[156:159], v[84:87], v[28:31]
    s_waitcnt lgkmcnt(2)
    v_fmac_f32 v18, v113, v90
    v_fmac_f32 v19, v113, v91
    v_mfma_f32_16x16x32_bf16 v[8:11], v[160:163], v[56:59], v[8:11]
    ds_read_b128 v[72:75], v1 offset:53248
    v_fmac_f32 v15, v114, v107
    v_mfma_f32_16x16x32_bf16 v[16:19], v[160:163], v[60:63], v[16:19]
    v_fmac_f32 v24, v112, v96
    v_fmac_f32 v25, v112, v97
    v_mfma_f32_16x16x32_bf16 v[20:23], v[164:167], v[60:63], v[20:23]
    buffer_load_dwordx4 v1, s[16:19], s42 offen offset:2048 sc1 lds
    v_mfma_f32_16x16x32_bf16 v[12:15], v[164:167], v[56:59], v[12:15]
    ds_read_b128 v[76:79], v1 offset:54272
    v_fmac_f32 v11, v114, v103
    v_mfma_f32_16x16x32_bf16 v[24:27], v[168:171], v[56:59], v[24:27]
    v_fmac_f32 v16, v115, v100
    v_fmac_f32 v17, v115, v101
    v_mfma_f32_16x16x32_bf16 v[28:31], v[168:171], v[60:63], v[28:31]
    s_waitcnt lgkmcnt(2)
    v_fmac_f32 v18, v115, v102
    v_fmac_f32 v19, v115, v103
    v_mfma_f32_16x16x32_bf16 v[8:11], v[172:175], v[64:67], v[8:11]
    ds_read_b128 v[80:83], v1 offset:55296
    v_fmac_f32 v20, v113, v92
    v_mfma_f32_16x16x32_bf16 v[16:19], v[172:175], v[68:71], v[16:19]
    v_fmac_f32 v26, v112, v98
    v_fmac_f32 v27, v112, v99
    v_mfma_f32_16x16x32_bf16 v[20:23], v[176:179], v[68:71], v[20:23]
    buffer_load_dwordx4 v1, s[16:19], s42 offen offset:3072 sc1 lds
    v_mfma_f32_16x16x32_bf16 v[12:15], v[176:179], v[64:67], v[12:15]
    s_add_u32 m0, s43, 147456
    ds_read_b128 v[84:87], v1 offset:56320
    v_fmac_f32 v28, v113, v96
    v_mfma_f32_16x16x32_bf16 v[24:27], v[180:183], v[64:67], v[24:27]
    s_add_u32 s42, s41, 49152
    v_fmac_f32 v21, v113, v93
    v_fmac_f32 v22, v113, v94
    v_mfma_f32_16x16x32_bf16 v[28:31], v[180:183], v[68:71], v[28:31]
    s_waitcnt lgkmcnt(2)
    v_fmac_f32 v23, v113, v95
    v_fmac_f32 v20, v115, v104
    v_mfma_f32_16x16x32_bf16 v[8:11], v[184:187], v[72:75], v[8:11]
    ds_read_b128 v[56:59], v1 offset:57344
    v_fmac_f32 v21, v115, v105
    v_mfma_f32_16x16x32_bf16 v[16:19], v[184:187], v[76:79], v[16:19]
    v_fmac_f32 v24, v114, v108
    v_fmac_f32 v25, v114, v109
    v_mfma_f32_16x16x32_bf16 v[20:23], v[188:191], v[76:79], v[20:23]
    buffer_load_dwordx4 v1, s[16:19], s42 offen offset:0 sc1 lds
    v_mfma_f32_16x16x32_bf16 v[12:15], v[188:191], v[72:75], v[12:15]
    ds_read_b128 v[60:63], v1 offset:58368
    v_fmac_f32 v29, v113, v97
    v_mfma_f32_16x16x32_bf16 v[24:27], v[192:195], v[72:75], v[24:27]
    s_nop 0
    v_fmac_f32 v22, v115, v106
    v_fmac_f32 v23, v115, v107
    v_mfma_f32_16x16x32_bf16 v[28:31], v[192:195], v[76:79], v[28:31]
    s_waitcnt lgkmcnt(2)
    v_mfma_f32_16x16x32_bf16 v[8:11], v[196:199], v[80:83], v[8:11]
    ds_read_b128 v[64:67], v1 offset:59392
    v_fmac_f32 v26, v114, v110
    v_mfma_f32_16x16x32_bf16 v[16:19], v[196:199], v[84:87], v[16:19]
    v_fmac_f32 v27, v114, v111
    v_fmac_f32 v30, v113, v98
    v_mfma_f32_16x16x32_bf16 v[20:23], v[200:203], v[84:87], v[20:23]
    buffer_load_dwordx4 v1, s[16:19], s42 offen offset:1024 sc1 lds
    v_mfma_f32_16x16x32_bf16 v[12:15], v[200:203], v[80:83], v[12:15]
    ds_read_b128 v[68:71], v1 offset:60416
    v_fmac_f32 v31, v113, v99
    v_mfma_f32_16x16x32_bf16 v[24:27], v[204:207], v[80:83], v[24:27]
    v_mfma_f32_16x16x32_bf16 v[28:31], v[204:207], v[84:87], v[28:31]
    s_waitcnt lgkmcnt(2)
    v_mfma_f32_16x16x32_bf16 v[8:11], v[208:211], v[56:59], v[8:11]
    ds_read_b128 v[72:75], v1 offset:61440
    v_mfma_f32_16x16x32_bf16 v[16:19], v[208:211], v[60:63], v[16:19]
    v_mfma_f32_16x16x32_bf16 v[20:23], v[212:215], v[60:63], v[20:23]
    buffer_load_dwordx4 v1, s[16:19], s42 offen offset:2048 sc1 lds
    v_mfma_f32_16x16x32_bf16 v[12:15], v[212:215], v[56:59], v[12:15]
    ds_read_b128 v[76:79], v1 offset:62464
    v_fmac_f32 v28, v115, v108
    v_mfma_f32_16x16x32_bf16 v[24:27], v[216:219], v[56:59], v[24:27]
    v_mfma_f32_16x16x32_bf16 v[28:31], v[216:219], v[60:63], v[28:31]
    s_waitcnt lgkmcnt(2)
    v_mfma_f32_16x16x32_bf16 v[8:11], v[220:223], v[64:67], v[8:11]
    ds_read_b128 v[80:83], v1 offset:63488
    v_mfma_f32_16x16x32_bf16 v[16:19], v[220:223], v[68:71], v[16:19]
    v_mfma_f32_16x16x32_bf16 v[20:23], v[224:227], v[68:71], v[20:23]
    buffer_load_dwordx4 v1, s[16:19], s42 offen offset:3072 sc1 lds
    v_mfma_f32_16x16x32_bf16 v[12:15], v[224:227], v[64:67], v[12:15]
    s_add_u32 s45, s45, 65536
    ds_read_b128 v[84:87], v1 offset:64512
    v_fmac_f32 v29, v115, v109
    v_mfma_f32_16x16x32_bf16 v[24:27], v[228:231], v[64:67], v[24:27]
    v_mfma_f32_16x16x32_bf16 v[28:31], v[228:231], v[68:71], v[28:31]
    s_waitcnt vmcnt(13) lgkmcnt(2)
    s_barrier
    v_mfma_f32_16x16x32_bf16 v[8:11], v[232:235], v[72:75], v[8:11]
    ds_read_b128 v[56:59], v2 offset:0
    v_mfma_f32_16x16x32_bf16 v[16:19], v[232:235], v[76:79], v[16:19]
    s_nop 0
    v_fmac_f32 v30, v115, v110
    v_fmac_f32 v31, v115, v111
    v_mfma_f32_16x16x32_bf16 v[20:23], v[236:239], v[76:79], v[20:23]
    v_mfma_f32_16x16x32_bf16 v[12:15], v[236:239], v[72:75], v[12:15]
    ds_read_b128 v[60:63], v2 offset:1024
    v_mfma_f32_16x16x32_bf16 v[24:27], v[240:243], v[72:75], v[24:27]
    v_mfma_f32_16x16x32_bf16 v[28:31], v[240:243], v[76:79], v[28:31]
    s_waitcnt lgkmcnt(2)
    v_mfma_f32_16x16x32_bf16 v[8:11], v[244:247], v[80:83], v[8:11]
    ds_read_b128 v[64:67], v2 offset:2048
    v_mfma_f32_16x16x32_bf16 v[16:19], v[244:247], v[84:87], v[16:19]
    v_mfma_f32_16x16x32_bf16 v[20:23], v[248:251], v[84:87], v[20:23]
    v_mfma_f32_16x16x32_bf16 v[12:15], v[248:251], v[80:83], v[12:15]
    ds_read_b128 v[68:71], v2 offset:3072
    v_mfma_f32_16x16x32_bf16 v[24:27], v[252:255], v[80:83], v[24:27]
    s_add_u32 s36, s36, 1
    v_mfma_f32_16x16x32_bf16 v[28:31], v[252:255], v[84:87], v[28:31]
    s_waitcnt lgkmcnt(2)
L_a_b1:
    v_mfma_f32_16x16x32_bf16 v[32:35], a[0:3], v[56:59], 0
    s_and_b32 s44, s90, 0xffffffff
    ds_read_b128 v[72:75], v2 offset:4096
    v_mul_f32 v120, v24, v116
    v_mfma_f32_16x16x32_bf16 v[40:43], a[0:3], v[60:63], 0
    s_cmp_lt_i32 s36, 1
    v_mul_f32 v121, v25, v116
    v_mul_f32 v120, v120, abs(v24)
    v_mfma_f32_16x16x32_bf16 v[44:47], a[4:7], v[60:63], 0
    s_cselect_b32 s44, 0x5e00000, s44
    v_mul_f32 v121, v121, abs(v25)
    v_cvt_pk_bf16_f32 v24, v120, v121
    v_mfma_f32_16x16x32_bf16 v[36:39], a[4:7], v[56:59], 0
    s_add_u32 s49, s44, s87
    ds_read_b128 v[76:79], v2 offset:5120
    v_pk_max_i16 v24, v24, 0
    v_mfma_f32_16x16x32_bf16 v[48:51], a[8:11], v[56:59], 0
    s_max_u32 s44, s44, s88
    v_mul_f32 v120, v26, v116
    v_mul_f32 v121, v27, v116
    v_mfma_f32_16x16x32_bf16 v[52:55], a[8:11], v[60:63], 0
    s_waitcnt lgkmcnt(2)
    v_mul_f32 v120, v120, abs(v26)
    v_mul_f32 v121, v121, abs(v27)
    v_mfma_f32_16x16x32_bf16 v[32:35], a[12:15], v[64:67], v[32:35]
    s_add_u32 s90, s90, 262144
    ds_read_b128 v[80:83], v2 offset:6144
    v_cvt_pk_bf16_f32 v25, v120, v121
    v_mfma_f32_16x16x32_bf16 v[40:43], a[12:15], v[68:71], v[40:43]
    s_add_u32 m0, s52, 73728
    v_pk_max_i16 v25, v25, 0
    s_add_u32 s42, s46, s52
    v_mfma_f32_16x16x32_bf16 v[44:47], a[16:19], v[68:71], v[44:47]
    buffer_load_dwordx4 v1, s[16:19], s42 offen sc1 lds
    v_mfma_f32_16x16x32_bf16 v[36:39], a[16:19], v[64:67], v[36:39]
    s_add_u32 s98, s98, 65536
    ds_read_b128 v[84:87], v2 offset:7168
    s_min_i32 s98, s98, s96
    v_mfma_f32_16x16x32_bf16 v[48:51], a[20:23], v[64:67], v[48:51]
    s_and_b32 s41, s98, 0xffffffff
    ds_write_b64 v3, v[24:25] offset:0
    v_mfma_f32_16x16x32_bf16 v[52:55], a[20:23], v[68:71], v[52:55]
    s_waitcnt lgkmcnt(3)
    v_mul_f32 v120, v28, v117
    v_mul_f32 v121, v29, v117
    v_mfma_f32_16x16x32_bf16 v[32:35], a[24:27], v[72:75], v[32:35]
    ds_read_b128 v[56:59], v2 offset:8192
    v_mul_f32 v120, v120, abs(v28)
    v_mfma_f32_16x16x32_bf16 v[40:43], a[24:27], v[76:79], v[40:43]
    v_mul_f32 v121, v121, abs(v29)
    v_cvt_pk_bf16_f32 v28, v120, v121
    v_mfma_f32_16x16x32_bf16 v[44:47], a[28:31], v[76:79], v[44:47]
    v_pk_max_i16 v28, v28, 0
    v_mul_f32 v120, v30, v117
    v_mfma_f32_16x16x32_bf16 v[36:39], a[28:31], v[72:75], v[36:39]
    ds_read_b128 v[60:63], v2 offset:9216
    v_mul_f32 v121, v31, v117
    v_mfma_f32_16x16x32_bf16 v[48:51], a[32:35], v[72:75], v[48:51]
    v_mul_f32 v120, v120, abs(v30)
    v_mul_f32 v121, v121, abs(v31)
    v_mfma_f32_16x16x32_bf16 v[52:55], a[32:35], v[76:79], v[52:55]
    s_waitcnt lgkmcnt(3)
    v_cvt_pk_bf16_f32 v29, v120, v121
    v_pk_max_i16 v29, v29, 0
    v_mfma_f32_16x16x32_bf16 v[32:35], a[36:39], v[80:83], v[32:35]
    ds_read_b128 v[64:67], v2 offset:10240
    v_mfma_f32_16x16x32_bf16 v[40:43], a[36:39], v[84:87], v[40:43]
    ds_write_b64 v3, v[28:29] offset:1024
    v_mfma_f32_16x16x32_bf16 v[44:47], a[40:43], v[84:87], v[44:47]
    v_mul_f32 v120, v8, v116
    v_mul_f32 v121, v9, v116
    v_mfma_f32_16x16x32_bf16 v[36:39], a[40:43], v[80:83], v[36:39]
    ds_read_b128 v[68:71], v2 offset:11264
    v_mul_f32 v120, v120, abs(v8)
    v_mfma_f32_16x16x32_bf16 v[48:51], a[44:47], v[80:83], v[48:51]
    v_mul_f32 v121, v121, abs(v9)
    v_cvt_pk_bf16_f32 v8, v120, v121
    v_mfma_f32_16x16x32_bf16 v[52:55], a[44:47], v[84:87], v[52:55]
    s_waitcnt lgkmcnt(3)
    v_pk_max_i16 v8, v8, 0
    v_mul_f32 v120, v10, v116
    v_mfma_f32_16x16x32_bf16 v[32:35], a[48:51], v[56:59], v[32:35]
    ds_read_b128 v[72:75], v2 offset:12288
    v_mul_f32 v121, v11, v116
    v_mfma_f32_16x16x32_bf16 v[40:43], a[48:51], v[60:63], v[40:43]
    v_mul_f32 v120, v120, abs(v10)
    v_mul_f32 v121, v121, abs(v11)
    v_mfma_f32_16x16x32_bf16 v[44:47], a[52:55], v[60:63], v[44:47]
    v_cvt_pk_bf16_f32 v9, v120, v121
    v_pk_max_i16 v9, v9, 0
    v_mfma_f32_16x16x32_bf16 v[36:39], a[52:55], v[56:59], v[36:39]
    ds_read_b128 v[76:79], v2 offset:13312
    v_mul_f32 v120, v12, v116
    v_mfma_f32_16x16x32_bf16 v[48:51], a[56:59], v[56:59], v[48:51]
    v_mul_f32 v121, v13, v116
    v_mul_f32 v120, v120, abs(v12)
    v_mfma_f32_16x16x32_bf16 v[52:55], a[56:59], v[60:63], v[52:55]
    s_waitcnt vmcnt(9) lgkmcnt(2)
    s_barrier
    v_mul_f32 v121, v121, abs(v13)
    v_mfma_f32_16x16x32_bf16 v[32:35], a[60:63], v[64:67], v[32:35]
    ds_read_b128 v[80:83], v2 offset:14336
    v_cvt_pk_bf16_f32 v10, v120, v121
    v_mfma_f32_16x16x32_bf16 v[40:43], a[60:63], v[68:71], v[40:43]
    ds_read_b128 v[24:27], v4 offset:0
    v_pk_max_i16 v10, v10, 0
    v_mfma_f32_16x16x32_bf16 v[44:47], a[64:67], v[68:71], v[44:47]
    buffer_load_dword v7, v5, s[16:19], s45 offen sc1
    v_mfma_f32_16x16x32_bf16 v[36:39], a[64:67], v[64:67], v[36:39]
    ds_read_b128 v[84:87], v2 offset:15360
    v_mul_f32 v120, v14, v116
    v_mfma_f32_16x16x32_bf16 v[48:51], a[68:71], v[64:67], v[48:51]
    v_mul_f32 v121, v15, v116
    v_mul_f32 v120, v120, abs(v14)
    v_mfma_f32_16x16x32_bf16 v[52:55], a[68:71], v[68:71], v[52:55]
    s_waitcnt lgkmcnt(3)
    v_mul_f32 v121, v121, abs(v15)
    v_cvt_pk_bf16_f32 v11, v120, v121
    v_mfma_f32_16x16x32_bf16 v[32:35], a[72:75], v[72:75], v[32:35]
    s_waitcnt lgkmcnt(1)
    ds_read_b128 v[56:59], v2 offset:16384
    v_pk_max_i16 v11, v11, 0
    v_mfma_f32_16x16x32_bf16 v[40:43], a[72:75], v[76:79], v[40:43]
    buffer_store_dwordx4 v[24:27], v1, s[16:19], s49 offen sc1
    v_mfma_f32_16x16x32_bf16 v[44:47], a[76:79], v[76:79], v[44:47]
    buffer_store_dwordx4 v[8:11], v1, s[16:19], s44 offen offset:0 sc1
    v_mfma_f32_16x16x32_bf16 v[36:39], a[76:79], v[72:75], v[36:39]
    ds_read_b128 v[60:63], v2 offset:17408
    v_mul_f32 v120, v16, v117
    v_mfma_f32_16x16x32_bf16 v[48:51], a[80:83], v[72:75], v[48:51]
    v_mul_f32 v121, v17, v117
    v_mul_f32 v120, v120, abs(v16)
    v_mfma_f32_16x16x32_bf16 v[52:55], a[80:83], v[76:79], v[52:55]
    s_waitcnt lgkmcnt(2)
    v_mul_f32 v121, v121, abs(v17)
    v_cvt_pk_bf16_f32 v16, v120, v121
    v_mfma_f32_16x16x32_bf16 v[32:35], a[84:87], v[80:83], v[32:35]
    ds_read_b128 v[64:67], v2 offset:18432
    v_pk_max_i16 v16, v16, 0
    v_mfma_f32_16x16x32_bf16 v[40:43], a[84:87], v[84:87], v[40:43]
    v_mul_f32 v120, v18, v117
    v_mul_f32 v121, v19, v117
    v_mfma_f32_16x16x32_bf16 v[44:47], a[88:91], v[84:87], v[44:47]
    v_mul_f32 v120, v120, abs(v18)
    v_mul_f32 v121, v121, abs(v19)
    v_mfma_f32_16x16x32_bf16 v[36:39], a[88:91], v[80:83], v[36:39]
    ds_read_b128 v[68:71], v2 offset:19456
    v_cvt_pk_bf16_f32 v17, v120, v121
    v_mfma_f32_16x16x32_bf16 v[48:51], a[92:95], v[80:83], v[48:51]
    v_pk_max_i16 v17, v17, 0
    v_mul_f32 v120, v20, v117
    v_mfma_f32_16x16x32_bf16 v[52:55], a[92:95], v[84:87], v[52:55]
    s_waitcnt lgkmcnt(2)
    v_mul_f32 v121, v21, v117
    v_mul_f32 v120, v120, abs(v20)
    v_mfma_f32_16x16x32_bf16 v[32:35], a[96:99], v[56:59], v[32:35]
    ds_read_b128 v[72:75], v2 offset:20480
    v_mul_f32 v121, v121, abs(v21)
    v_mfma_f32_16x16x32_bf16 v[40:43], a[96:99], v[60:63], v[40:43]
    v_cvt_pk_bf16_f32 v18, v120, v121
    v_pk_max_i16 v18, v18, 0
    v_mfma_f32_16x16x32_bf16 v[44:47], a[100:103], v[60:63], v[44:47]
    v_mul_f32 v120, v22, v117
    v_mul_f32 v121, v23, v117
    v_mfma_f32_16x16x32_bf16 v[36:39], a[100:103], v[56:59], v[36:39]
    ds_read_b128 v[76:79], v2 offset:21504
    v_mul_f32 v120, v120, abs(v22)
    v_mfma_f32_16x16x32_bf16 v[48:51], a[104:107], v[56:59], v[48:51]
    v_mul_f32 v121, v121, abs(v23)
    v_cvt_pk_bf16_f32 v19, v120, v121
    v_mfma_f32_16x16x32_bf16 v[52:55], a[104:107], v[60:63], v[52:55]
    s_waitcnt lgkmcnt(2)
    v_pk_max_i16 v19, v19, 0
    v_mfma_f32_16x16x32_bf16 v[32:35], a[108:111], v[64:67], v[32:35]
    ds_read_b128 v[80:83], v2 offset:22528
    v_mfma_f32_16x16x32_bf16 v[40:43], a[108:111], v[68:71], v[40:43]
    buffer_store_dwordx4 v[16:19], v1, s[16:19], s44 offen offset:1024 sc1
    v_mfma_f32_16x16x32_bf16 v[44:47], a[112:115], v[68:71], v[44:47]
    v_mfma_f32_16x16x32_bf16 v[36:39], a[112:115], v[64:67], v[36:39]
    ds_read_b128 v[84:87], v2 offset:23552
    v_mfma_f32_16x16x32_bf16 v[48:51], a[116:119], v[64:67], v[48:51]
    v_mfma_f32_16x16x32_bf16 v[52:55], a[116:119], v[68:71], v[52:55]
    s_waitcnt lgkmcnt(2)
    v_mfma_f32_16x16x32_bf16 v[32:35], a[120:123], v[72:75], v[32:35]
    ds_read_b128 v[56:59], v2 offset:24576
    v_mfma_f32_16x16x32_bf16 v[40:43], a[120:123], v[76:79], v[40:43]
    v_mfma_f32_16x16x32_bf16 v[44:47], a[124:127], v[76:79], v[44:47]
    v_mfma_f32_16x16x32_bf16 v[36:39], a[124:127], v[72:75], v[36:39]
    ds_read_b128 v[60:63], v2 offset:25600
    v_mfma_f32_16x16x32_bf16 v[48:51], a[128:131], v[72:75], v[48:51]
    v_mfma_f32_16x16x32_bf16 v[52:55], a[128:131], v[76:79], v[52:55]
    s_waitcnt lgkmcnt(2)
    v_mfma_f32_16x16x32_bf16 v[32:35], a[132:135], v[80:83], v[32:35]
    ds_read_b128 v[64:67], v2 offset:26624
    v_mfma_f32_16x16x32_bf16 v[40:43], a[132:135], v[84:87], v[40:43]
    v_mfma_f32_16x16x32_bf16 v[44:47], a[136:139], v[84:87], v[44:47]
    v_mfma_f32_16x16x32_bf16 v[36:39], a[136:139], v[80:83], v[36:39]
    ds_read_b128 v[68:71], v2 offset:27648
    v_mfma_f32_16x16x32_bf16 v[48:51], a[140:143], v[80:83], v[48:51]
    v_mfma_f32_16x16x32_bf16 v[52:55], a[140:143], v[84:87], v[52:55]
    s_waitcnt lgkmcnt(2)
    v_mfma_f32_16x16x32_bf16 v[32:35], a[144:147], v[56:59], v[32:35]
    ds_read_b128 v[72:75], v2 offset:28672
    v_mfma_f32_16x16x32_bf16 v[40:43], a[144:147], v[60:63], v[40:43]
    v_mfma_f32_16x16x32_bf16 v[44:47], a[148:151], v[60:63], v[44:47]
    v_mfma_f32_16x16x32_bf16 v[36:39], a[148:151], v[56:59], v[36:39]
    ds_read_b128 v[76:79], v2 offset:29696
    v_mfma_f32_16x16x32_bf16 v[48:51], a[152:155], v[56:59], v[48:51]
    v_mfma_f32_16x16x32_bf16 v[52:55], a[152:155], v[60:63], v[52:55]
    s_waitcnt lgkmcnt(2)
    v_mfma_f32_16x16x32_bf16 v[32:35], a[156:159], v[64:67], v[32:35]
    ds_read_b128 v[80:83], v2 offset:30720
    v_mfma_f32_16x16x32_bf16 v[40:43], a[156:159], v[68:71], v[40:43]
    s_waitcnt vmcnt(3)
    v_cmp_ne_u32 vcc, 0, v7
    v_mfma_f32_16x16x32_bf16 v[44:47], a[160:163], v[68:71], v[44:47]
    v_mfma_f32_16x16x32_bf16 v[36:39], a[160:163], v[64:67], v[36:39]
    s_cbranch_vccnz L_spin24
L_back25:
    ds_read_b128 v[84:87], v2 offset:31744
    v_mfma_f32_16x16x32_bf16 v[48:51], a[164:167], v[64:67], v[48:51]
    v_mfma_f32_16x16x32_bf16 v[52:55], a[164:167], v[68:71], v[52:55]
    s_waitcnt vmcnt(4) lgkmcnt(2)
    s_barrier
    v_mfma_f32_16x16x32_bf16 v[32:35], a[168:171], v[72:75], v[32:35]
    s_add_u32 m0, s43, 0
    ds_read_b128 v[56:59], v2 offset:32768
    s_add_u32 s42, s41, 0
    v_mfma_f32_16x16x32_bf16 v[40:43], a[168:171], v[76:79], v[40:43]
    buffer_load_dwordx4 v1, s[16:19], s42 offen offset:0 sc1 lds
    v_mfma_f32_16x16x32_bf16 v[44:47], a[172:175], v[76:79], v[44:47]
    ds_read_b64 v[12:13], v118 offset:0
    v_mfma_f32_16x16x32_bf16 v[36:39], a[172:175], v[72:75], v[36:39]
    ds_read_b128 v[60:63], v2 offset:33792
    v_mfma_f32_16x16x32_bf16 v[48:51], a[176:179], v[72:75], v[48:51]
    ds_read_b64 v[14:15], v118 offset:128
    v_mfma_f32_16x16x32_bf16 v[52:55], a[176:179], v[76:79], v[52:55]
    s_waitcnt lgkmcnt(4)
    ds_read_b64 v[16:17], v118 offset:256
    v_mfma_f32_16x16x32_bf16 v[32:35], a[180:183], v[80:83], v[32:35]
    ds_read_b128 v[64:67], v2 offset:34816
    v_mfma_f32_16x16x32_bf16 v[40:43], a[180:183], v[84:87], v[40:43]
    buffer_load_dwordx4 v1, s[16:19], s42 offen offset:1024 sc1 lds
    v_mfma_f32_16x16x32_bf16 v[44:47], a[184:187], v[84:87], v[44:47]
    ds_read_b64 v[18:19], v118 offset:384
    v_mfma_f32_16x16x32_bf16 v[36:39], a[184:187], v[80:83], v[36:39]
    ds_read_b128 v[68:71], v2 offset:35840
    v_mfma_f32_16x16x32_bf16 v[48:51], a[188:191], v[80:83], v[48:51]
    v_mfma_f32_16x16x32_bf16 v[52:55], a[188:191], v[84:87], v[52:55]
    s_waitcnt lgkmcnt(5)
    v_mfma_f32_16x16x32_bf16 v[32:35], a[192:195], v[56:59], v[32:35]
    ds_read_b128 v[72:75], v2 offset:36864
    v_mfma_f32_16x16x32_bf16 v[40:43], a[192:195], v[60:63], v[40:43]
    buffer_load_dwordx4 v1, s[16:19], s42 offen offset:2048 sc1 lds
    v_mfma_f32_16x16x32_bf16 v[44:47], a[196:199], v[60:63], v[44:47]
    s_waitcnt lgkmcnt(2)
    v_max3_u32 v20, v12, v13, v14
    v_max3_u32 v21, v15, v16, v17
    v_mfma_f32_16x16x32_bf16 v[36:39], a[196:199], v[56:59], v[36:39]
    ds_read_b128 v[76:79], v2 offset:37888
    v_max3_u32 v20, v20, v18, v19
    v_mfma_f32_16x16x32_bf16 v[48:51], a[200:203], v[56:59], v[48:51]
    v_max_u32 v20, v20, v21
    v_cmp_eq_u32 vcc, -1, v20
    v_mfma_f32_16x16x32_bf16 v[52:55], a[200:203], v[60:63], v[52:55]
    s_waitcnt lgkmcnt(2)
    v_mfma_f32_16x16x32_bf16 v[32:35], a[204:207], v[64:67], v[32:35]
    s_cbranch_vccnz L_sspin26
L_sback27:
    ds_read_b128 v[80:83], v2 offset:38912
    v_add_f32 v20, v16, v18
    v_mfma_f32_16x16x32_bf16 v[40:43], a[204:207], v[68:71], v[40:43]
    buffer_load_dwordx4 v1, s[16:19], s42 offen offset:3072 sc1 lds
    v_mfma_f32_16x16x32_bf16 v[44:47], a[208:211], v[68:71], v[44:47]
    s_add_u32 m0, s43, 16384
    v_add_f32 v21, v17, v19
    v_add_f32 v12, v12, v14
    v_mfma_f32_16x16x32_bf16 v[36:39], a[208:211], v[64:67], v[36:39]
    s_add_u32 s42, s41, 16384
    ds_read_b128 v[84:87], v2 offset:39936
    v_add_f32 v13, v13, v15
    v_mfma_f32_16x16x32_bf16 v[48:51], a[212:215], v[64:67], v[48:51]
    v_add_f32 v12, v12, v20
    v_add_f32 v13, v13, v21
    v_mfma_f32_16x16x32_bf16 v[52:55], a[212:215], v[68:71], v[52:55]
    s_waitcnt lgkmcnt(2)
    v_mov_b32 v20, v12
    v_mov_b32 v21, v13
    v_mfma_f32_16x16x32_bf16 v[32:35], a[216:219], v[72:75], v[32:35]
    ds_read_b128 v[56:59], v2 offset:40960
    v_mfma_f32_16x16x32_bf16 v[40:43], a[216:219], v[76:79], v[40:43]
    buffer_load_dwordx4 v1, s[16:19], s42 offen offset:0 sc1 lds
    v_mfma_f32_16x16x32_bf16 v[44:47], a[220:223], v[76:79], v[44:47]
    v_permlane32_swap_b32 v12, v20
    v_mfma_f32_16x16x32_bf16 v[36:39], a[220:223], v[72:75], v[36:39]
    ds_read_b128 v[60:63], v2 offset:41984
    v_mfma_f32_16x16x32_bf16 v[48:51], a[224:227], v[72:75], v[48:51]
    v_permlane32_swap_b32 v13, v21
    v_mfma_f32_16x16x32_bf16 v[52:55], a[224:227], v[76:79], v[52:55]
    s_waitcnt lgkmcnt(2)
    v_add_f32 v12, v12, v20
    v_add_f32 v13, v13, v21
    v_mfma_f32_16x16x32_bf16 v[32:35], a[228:231], v[80:83], v[32:35]
    ds_read_b128 v[64:67], v2 offset:43008
    v_mul_f32 v112, 0xba800000, v12
    v_mfma_f32_16x16x32_bf16 v[40:43], a[228:231], v[84:87], v[40:43]
    buffer_load_dwordx4 v1, s[16:19], s42 offen offset:1024 sc1 lds
    v_mfma_f32_16x16x32_bf16 v[44:47], a[232:235], v[84:87], v[44:47]
    v_mul_f32 v13, 0x3a800000, v13
    v_fma_f32 v13, -v112, v112, v13
    v_mfma_f32_16x16x32_bf16 v[36:39], a[232:235], v[80:83], v[36:39]
    ds_read_b128 v[68:71], v2 offset:44032
    v_mov_b32 v113, v112
    v_mfma_f32_16x16x32_bf16 v[48:51], a[236:239], v[80:83], v[48:51]
    s_waitcnt vmcnt(6)
    v_max_f32 v13, 0, v13
    v_add_f32 v13, 0x3727c5ac, v13
    v_mfma_f32_16x16x32_bf16 v[52:55], a[236:239], v[84:87], v[52:55]
    s_waitcnt lgkmcnt(2)
    v_rsq_f32 v116, v13
    v_mfma_f32_16x16x32_bf16 v[32:35], a[240:243], v[56:59], v[32:35]
    s_barrier
    ds_read_b128 v[72:75], v2 offset:45056
    v_mfma_f32_16x16x32_bf16 v[40:43], a[240:243], v[60:63], v[40:43]
    buffer_store_dword v124, v124, s[16:19], s91 offen sc1
    v_mfma_f32_16x16x32_bf16 v[44:47], a[244:247], v[60:63], v[44:47]
    buffer_load_dwordx4 v1, s[16:19], s42 offen offset:2048 sc1 lds
    v_mfma_f32_16x16x32_bf16 v[36:39], a[244:247], v[56:59], v[36:39]
    s_add_u32 s91, s91, 65536
    ds_read_b128 v[76:79], v2 offset:46080
    v_mfma_f32_16x16x32_bf16 v[48:51], a[248:251], v[56:59], v[48:51]
    v_permlane16_swap_b32 v112, v113
    v_mfma_f32_16x16x32_bf16 v[52:55], a[248:251], v[60:63], v[52:55]
    s_waitcnt lgkmcnt(2)
    v_mul_f32 v114, v13, v116
    v_mul_f32 v116, v116, v116
    v_mfma_f32_16x16x32_bf16 v[32:35], a[252:255], v[64:67], v[32:35]
    ds_read_b128 v[80:83], v2 offset:47104
    v_mov_b32 v115, v114
    v_mfma_f32_16x16x32_bf16 v[40:43], a[252:255], v[68:71], v[40:43]
    v_mov_b32 v117, v116
    v_fmac_f32 v36, v112, v92
    v_mfma_f32_16x16x32_bf16 v[44:47], v[128:131], v[68:71], v[44:47]
    buffer_load_dwordx4 v1, s[16:19], s42 offen offset:3072 sc1 lds
    v_mfma_f32_16x16x32_bf16 v[36:39], v[128:131], v[64:67], v[36:39]
    s_add_u32 m0, s43, 32768
    ds_read_b128 v[84:87], v2 offset:48128
    v_fmac_f32 v32, v112, v88
    v_mfma_f32_16x16x32_bf16 v[48:51], v[132:135], v[64:67], v[48:51]
    s_add_u32 s42, s41, 32768
    v_permlane16_swap_b32 v114, v115
    v_mfma_f32_16x16x32_bf16 v[52:55], v[132:135], v[68:71], v[52:55]
    s_waitcnt lgkmcnt(2)
    v_permlane16_swap_b32 v116, v117
    v_mfma_f32_16x16x32_bf16 v[32:35], v[136:139], v[72:75], v[32:35]
    s_add_u32 s46, s46, 2048
    ds_read_b128 v[56:59], v2 offset:49152
    v_fmac_f32 v37, v112, v93
    v_mfma_f32_16x16x32_bf16 v[40:43], v[136:139], v[76:79], v[40:43]
    s_min_u32 s46, s46, s55
    v_fmac_f32 v38, v112, v94
    v_fmac_f32 v39, v112, v95
    v_mfma_f32_16x16x32_bf16 v[44:47], v[140:143], v[76:79], v[44:47]
    buffer_load_dwordx4 v1, s[16:19], s42 offen offset:0 sc1 lds
    v_mfma_f32_16x16x32_bf16 v[36:39], v[140:143], v[72:75], v[36:39]
    ds_read_b128 v[60:63], v2 offset:50176
    v_fmac_f32 v33, v112, v89
    v_mfma_f32_16x16x32_bf16 v[48:51], v[144:147], v[72:75], v[48:51]
    v_fmac_f32 v34, v112, v90
    v_fmac_f32 v35, v112, v91
    v_mfma_f32_16x16x32_bf16 v[52:55], v[144:147], v[76:79], v[52:55]
    s_waitcnt lgkmcnt(2)
    v_fmac_f32 v40, v113, v88
    v_fmac_f32 v41, v113, v89
    v_mfma_f32_16x16x32_bf16 v[32:35], v[148:151], v[80:83], v[32:35]
    ds_read_b128 v[64:67], v2 offset:51200
    v_fmac_f32 v36, v114, v104
    v_mfma_f32_16x16x32_bf16 v[40:43], v[148:151], v[84:87], v[40:43]
    v_fmac_f32 v37, v114, v105
    v_fmac_f32 v38, v114, v106
    v_mfma_f32_16x16x32_bf16 v[44:47], v[152:155], v[84:87], v[44:47]
    buffer_load_dwordx4 v1, s[16:19], s42 offen offset:1024 sc1 lds
    v_mfma_f32_16x16x32_bf16 v[36:39], v[152:155], v[80:83], v[36:39]
    ds_read_b128 v[68:71], v2 offset:52224
    v_fmac_f32 v32, v114, v100
    v_mfma_f32_16x16x32_bf16 v[48:51], v[156:159], v[80:83], v[48:51]
    v_fmac_f32 v33, v114, v101
    v_fmac_f32 v34, v114, v102
    v_mfma_f32_16x16x32_bf16 v[52:55], v[156:159], v[84:87], v[52:55]
    s_waitcnt lgkmcnt(2)
    v_fmac_f32 v42, v113, v90
    v_fmac_f32 v43, v113, v91
    v_mfma_f32_16x16x32_bf16 v[32:35], v[160:163], v[56:59], v[32:35]
    ds_read_b128 v[72:75], v2 offset:53248
    v_fmac_f32 v39, v114, v107
    v_mfma_f32_16x16x32_bf16 v[40:43], v[160:163], v[60:63], v[40:43]
    v_fmac_f32 v48, v112, v96
    v_fmac_f32 v49, v112, v97
    v_mfma_f32_16x16x32_bf16 v[44:47], v[164:167], v[60:63], v[44:47]
    buffer_load_dwordx4 v1, s[16:19], s42 offen offset:2048 sc1 lds
    v_mfma_f32_16x16x32_bf16 v[36:39], v[164:167], v[56:59], v[36:39]
    ds_read_b128 v[76:79], v2 offset:54272
    v_fmac_f32 v35, v114, v103
    v_mfma_f32_16x16x32_bf16 v[48:51], v[168:171], v[56:59], v[48:51]
    v_fmac_f32 v40, v115, v100
    v_fmac_f32 v41, v115, v101
    v_mfma_f32_16x16x32_bf16 v[52:55], v[168:171], v[60:63], v[52:55]
    s_waitcnt lgkmcnt(2)
    v_fmac_f32 v42, v115, v102
    v_fmac_f32 v43, v115, v103
    v_mfma_f32_16x16x32_bf16 v[32:35], v[172:175], v[64:67], v[32:35]
    ds_read_b128 v[80:83], v2 offset:55296
    v_fmac_f32 v44, v113, v92
    v_mfma_f32_16x16x32_bf16 v[40:43], v[172:175], v[68:71], v[40:43]
    v_fmac_f32 v50, v112, v98
    v_fmac_f32 v51, v112, v99
    v_mfma_f32_16x16x32_bf16 v[44:47], v[176:179], v[68:71], v[44:47]
    buffer_load_dwordx4 v1, s[16:19], s42 offen offset:3072 sc1 lds
    v_mfma_f32_16x16x32_bf16 v[36:39], v[176:179], v[64:67], v[36:39]
    s_add_u32 m0, s43, 49152
    ds_read_b128 v[84:87], v2 offset:56320
    v_fmac_f32 v52, v113, v96
    v_mfma_f32_16x16x32_bf16 v[48:51], v[180:183], v[64:67], v[48:51]
    s_add_u32 s42, s41, 49152
    v_fmac_f32 v45, v113, v93
    v_fmac_f32 v46, v113, v94
    v_mfma_f32_16x16x32_bf16 v[52:55], v[180:183], v[68:71], v[52:55]
    s_waitcnt lgkmcnt(2)
    v_fmac_f32 v47, v113, v95
    v_fmac_f32 v44, v115, v104
    v_mfma_f32_16x16x32_bf16 v[32:35], v[184:187], v[72:75], v[32:35]
    ds_read_b128 v[56:59], v2 offset:57344
    v_fmac_f32 v45, v115, v105
    v_mfma_f32_16x16x32_bf16 v[40:43], v[184:187], v[76:79], v[40:43]
    v_fmac_f32 v48, v114, v108
    v_fmac_f32 v49, v114, v109
    v_mfma_f32_16x16x32_bf16 v[44:47], v[188:191], v[76:79], v[44:47]
    buffer_load_dwordx4 v1, s[16:19], s42 offen offset:0 sc1 lds
    v_mfma_f32_16x16x32_bf16 v[36:39], v[188:191], v[72:75], v[36:39]
    ds_read_b128 v[60:63], v2 offset:58368
    v_fmac_f32 v53, v113, v97
    v_mfma_f32_16x16x32_bf16 v[48:51], v[192:195], v[72:75], v[48:51]
    s_nop 0
    v_fmac_f32 v46, v115, v106
    v_fmac_f32 v47, v115, v107
    v_mfma_f32_16x16x32_bf16 v[52:55], v[192:195], v[76:79], v[52:55]
    s_waitcnt lgkmcnt(2)
    v_mfma_f32_16x16x32_bf16 v[32:35], v[196:199], v[80:83], v[32:35]
    ds_read_b128 v[64:67], v2 offset:59392
    v_fmac_f32 v50, v114, v110
    v_mfma_f32_16x16x32_bf16 v[40:43], v[196:199], v[84:87], v[40:43]
    v_fmac_f32 v51, v114, v111
    v_fmac_f32 v54, v113, v98
    v_mfma_f32_16x16x32_bf16 v[44:47], v[200:203], v[84:87], v[44:47]
    buffer_load_dwordx4 v1, s[16:19], s42 offen offset:1024 sc1 lds
    v_mfma_f32_16x16x32_bf16 v[36:39], v[200:203], v[80:83], v[36:39]
    ds_read_b128 v[68:71], v2 offset:60416
    v_fmac_f32 v55, v113, v99
    v_mfma_f32_16x16x32_bf16 v[48:51], v[204:207], v[80:83], v[48:51]
    v_mfma_f32_16x16x32_bf16 v[52:55], v[204:207], v[84:87], v[52:55]
    s_waitcnt lgkmcnt(2)
    v_mfma_f32_16x16x32_bf16 v[32:35], v[208:211], v[56:59], v[32:35]
    ds_read_b128 v[72:75], v2 offset:61440
    v_mfma_f32_16x16x32_bf16 v[40:43], v[208:211], v[60:63], v[40:43]
    v_mfma_f32_16x16x32_bf16 v[44:47], v[212:215], v[60:63], v[44:47]
    buffer_load_dwordx4 v1, s[16:19], s42 offen offset:2048 sc1 lds
    v_mfma_f32_16x16x32_bf16 v[36:39], v[212:215], v[56:59], v[36:39]
    ds_read_b128 v[76:79], v2 offset:62464
    v_fmac_f32 v52, v115, v108
    v_mfma_f32_16x16x32_bf16 v[48:51], v[216:219], v[56:59], v[48:51]
    v_mfma_f32_16x16x32_bf16 v[52:55], v[216:219], v[60:63], v[52:55]
    s_waitcnt lgkmcnt(2)
    v_mfma_f32_16x16x32_bf16 v[32:35], v[220:223], v[64:67], v[32:35]
    ds_read_b128 v[80:83], v2 offset:63488
    v_mfma_f32_16x16x32_bf16 v[40:43], v[220:223], v[68:71], v[40:43]
    v_mfma_f32_16x16x32_bf16 v[44:47], v[224:227], v[68:71], v[44:47]
    buffer_load_dwordx4 v1, s[16:19], s42 offen offset:3072 sc1 lds
    v_mfma_f32_16x16x32_bf16 v[36:39], v[224:227], v[64:67], v[36:39]
    s_add_u32 s45, s45, 65536
    ds_read_b128 v[84:87], v2 offset:64512
    v_fmac_f32 v53, v115, v109
    v_mfma_f32_16x16x32_bf16 v[48:51], v[228:231], v[64:67], v[48:51]
    v_mfma_f32_16x16x32_bf16 v[52:55], v[228:231], v[68:71], v[52:55]
    s_waitcnt vmcnt(13) lgkmcnt(2)
    s_barrier
    v_mfma_f32_16x16x32_bf16 v[32:35], v[232:235], v[72:75], v[32:35]
    ds_read_b128 v[56:59], v1 offset:0
    v_mfma_f32_16x16x32_bf16 v[40:43], v[232:235], v[76:79], v[40:43]
    s_nop 0
    v_fmac_f32 v54, v115, v110
    v_fmac_f32 v55, v115, v111
    v_mfma_f32_16x16x32_bf16 v[44:47], v[236:239], v[76:79], v[44:47]
    v_mfma_f32_16x16x32_bf16 v[36:39], v[236:239], v[72:75], v[36:39]
    ds_read_b128 v[60:63], v1 offset:1024
    v_mfma_f32_16x16x32_bf16 v[48:51], v[240:243], v[72:75], v[48:51]
    v_mfma_f32_16x16x32_bf16 v[52:55], v[240:243], v[76:79], v[52:55]
    s_waitcnt lgkmcnt(2)
    v_mfma_f32_16x16x32_bf16 v[32:35], v[244:247], v[80:83], v[32:35]
    ds_read_b128 v[64:67], v1 offset:2048
    v_mfma_f32_16x16x32_bf16 v[40:43], v[244:247], v[84:87], v[40:43]
    v_mfma_f32_16x16x32_bf16 v[44:47], v[248:251], v[84:87], v[44:47]
    v_mfma_f32_16x16x32_bf16 v[36:39], v[248:251], v[80:83], v[36:39]
    ds_read_b128 v[68:71], v1 offset:3072
    v_mfma_f32_16x16x32_bf16 v[48:51], v[252:255], v[80:83], v[48:51]
    s_add_u32 s36, s36, 1
    v_mfma_f32_16x16x32_bf16 v[52:55], v[252:255], v[84:87], v[52:55]
    s_waitcnt lgkmcnt(2)
    s_cmp_lt_u32 s36, 32
    s_cbranch_scc1 L_a_b0
    s_nop 7
    s_and_b32 s44, s90, 0xffffffff
    s_cmp_lt_i32 s36, 1
    s_cselect_b32 s44, 0x5e00000, s44
    s_add_u32 s49, s44, s87
    s_max_u32 s44, s44, s88
    s_add_u32 s90, s90, 262144
    v_mul_f32 v120, v48, v116
    v_mul_f32 v121, v49, v116
    v_mul_f32 v120, v120, abs(v48)
    v_mul_f32 v121, v121, abs(v49)
    v_cvt_pk_bf16_f32 v48, v120, v121
    v_pk_max_i16 v48, v48, 0
    v_mul_f32 v120, v50, v116
    v_mul_f32 v121, v51, v116
    v_mul_f32 v120, v120, abs(v50)
    v_mul_f32 v121, v121, abs(v51)
    v_cvt_pk_bf16_f32 v49, v120, v121
    v_pk_max_i16 v49, v49, 0
    ds_write_b64 v3, v[48:49] offset:4096
    v_mul_f32 v120, v52, v117
    v_mul_f32 v121, v53, v117
    v_mul_f32 v120, v120, abs(v52)
    v_mul_f32 v121, v121, abs(v53)
    v_cvt_pk_bf16_f32 v52, v120, v121
    v_pk_max_i16 v52, v52, 0
    v_mul_f32 v120, v54, v117
    v_mul_f32 v121, v55, v117
    v_mul_f32 v120, v120, abs(v54)
    v_mul_f32 v121, v121, abs(v55)
    v_cvt_pk_bf16_f32 v53, v120, v121
    v_pk_max_i16 v53, v53, 0
    ds_write_b64 v3, v[52:53] offset:5120
    v_mul_f32 v120, v32, v116
    v_mul_f32 v121, v33, v116
    v_mul_f32 v120, v120, abs(v32)
    v_mul_f32 v121, v121, abs(v33)
    v_cvt_pk_bf16_f32 v32, v120, v121
    v_pk_max_i16 v32, v32, 0
    v_mul_f32 v120, v34, v116
    v_mul_f32 v121, v35, v116
    v_mul_f32 v120, v120, abs(v34)
    v_mul_f32 v121, v121, abs(v35)
    v_cvt_pk_bf16_f32 v33, v120, v121
    v_pk_max_i16 v33, v33, 0
    v_mul_f32 v120, v36, v116
    v_mul_f32 v121, v37, v116
    v_mul_f32 v120, v120, abs(v36)
    v_mul_f32 v121, v121, abs(v37)
    v_cvt_pk_bf16_f32 v34, v120, v121
    v_pk_max_i16 v34, v34, 0
    v_mul_f32 v120, v38, v116
    v_mul_f32 v121, v39, v116
    v_mul_f32 v120, v120, abs(v38)
    v_mul_f32 v121, v121, abs(v39)
    v_cvt_pk_bf16_f32 v35, v120, v121
    v_pk_max_i16 v35, v35, 0
    buffer_store_dwordx4 v[32:35], v1, s[16:19], s44 offen offset:0 sc1
    v_mul_f32 v120, v40, v117
    v_mul_f32 v121, v41, v117
    v_mul_f32 v120, v120, abs(v40)
    s_waitcnt lgkmcnt(0)
    s_barrier
    ds_read_b128 v[48:51], v4 offset:4096
    v_mul_f32 v121, v121, abs(v41)
    v_cvt_pk_bf16_f32 v40, v120, v121
    v_pk_max_i16 v40, v40, 0
    v_mul_f32 v120, v42, v117
    v_mul_f32 v121, v43, v117
    v_mul_f32 v120, v120, abs(v42)
    v_mul_f32 v121, v121, abs(v43)
    v_cvt_pk_bf16_f32 v41, v120, v121
    v_pk_max_i16 v41, v41, 0
    s_waitcnt lgkmcnt(0)
    buffer_store_dwordx4 v[48:51], v1, s[16:19], s49 offen sc1
    v_mul_f32 v120, v44, v117
    v_mul_f32 v121, v45, v117
    v_mul_f32 v120, v120, abs(v44)
    v_mul_f32 v121, v121, abs(v45)
    v_cvt_pk_bf16_f32 v42, v120, v121
    v_pk_max_i16 v42, v42, 0
    v_mul_f32 v120, v46, v117
    v_mul_f32 v121, v47, v117
    v_mul_f32 v120, v120, abs(v46)
    v_mul_f32 v121, v121, abs(v47)
    v_cvt_pk_bf16_f32 v43, v120, v121
    v_pk_max_i16 v43, v43, 0
    buffer_store_dwordx4 v[40:43], v1, s[16:19], s44 offen offset:1024 sc1
    s_waitcnt vmcnt(0)
    s_barrier
    buffer_store_dword v124, v124, s[16:19], s91 offen sc1
    s_add_u32 s91, s91, 65536
    s_waitcnt vmcnt(0)
    s_endpgm
L_vspin13:
    s_mov_b32 s40, 0x20000
L_vspin13_l:
    s_cmp_lg_u32 s37, 0
    s_cbranch_scc1 L_restart
    s_sleep 4
    buffer_load_dword v56, v124, s[20:23], 0 offen offset:32 sc1
    s_waitcnt vmcnt(0)
    v_readfirstlane_b32 s37, v56
    s_sub_u32 s40, s40, 1
    s_cbranch_scc1 L_vback14
    s_cmp_lg_u32 s37, s3
    s_cbranch_scc1 L_vspin13_l
    s_branch L_vback14
L_spin16:
    s_mov_b32 s40, 0x20000
L_spin16_l:
    buffer_load_dword v56, v124, s[20:23], 0 offen sc1
    s_sub_u32 s40, s40, 1
    s_waitcnt vmcnt(0)
    v_cmp_eq_u32 vcc, v124, v56
    s_cbranch_scc1 L_back17
    s_cbranch_vccz L_back17
    s_sleep 8
    s_branch L_spin16_l
L_spin18:
    s_mov_b32 s40, 0x20000
L_spin18_l:
    buffer_load_dword v7, v5, s[16:19], s45 offen sc1
    s_sub_u32 s40, s40, 1
    s_waitcnt vmcnt(0)
    v_cmp_ne_u32 vcc, 0, v7
    s_cbranch_scc1 L_back19
    s_cbranch_vccz L_back19
    s_sleep 2
    s_branch L_spin18_l
L_spin20:
    s_mov_b32 s40, 0x20000
L_spin20_l:
    buffer_load_dword v7, v5, s[16:19], s45 offen sc1
    s_sub_u32 s40, s40, 1
    s_waitcnt vmcnt(0)
    v_cmp_ne_u32 vcc, 0, v7
    s_cbranch_scc1 L_back21
    s_cbranch_vccz L_back21
    s_sleep 2
    s_branch L_spin20_l
L_sspin22:
    s_mov_b32 s40, 0x20000
L_sspin22_l:
    buffer_load_dwordx2 v[36:37], v6, s[16:19], s46 offen offset:0 sc1
    buffer_load_dwordx2 v[38:39], v6, s[16:19], s46 offen offset:128 sc1
    buffer_load_dwordx2 v[40:41], v6, s[16:19], s46 offen offset:256 sc1
    buffer_load_dwordx2 v[42:43], v6, s[16:19], s46 offen offset:384 sc1
    s_sub_u32 s40, s40, 1
    s_waitcnt vmcnt(0)
    v_max3_u32 v44, v36, v37, v38
    v_max3_u32 v45, v39, v40, v41
    v_max3_u32 v44, v44, v42, v43
    v_max_u32 v44, v44, v45
    v_cmp_eq_u32 vcc, -1, v44
    s_cbranch_scc1 L_sback23
    s_cbranch_vccz L_sback23
    s_sleep 4
    s_branch L_sspin22_l
L_spin24:
    s_mov_b32 s40, 0x20000
L_spin24_l:
    buffer_load_dword v7, v5, s[16:19], s45 offen sc1
    s_sub_u32 s40, s40, 1
    s_waitcnt vmcnt(0)
    v_cmp_ne_u32 vcc, 0, v7
    s_cbranch_scc1 L_back25
    s_cbranch_vccz L_back25
    s_sleep 2
    s_branch L_spin24_l
L_sspin26:
    s_mov_b32 s40, 0x20000
L_sspin26_l:
    buffer_load_dwordx2 v[12:13], v6, s[16:19], s46 offen offset:0 sc1
    buffer_load_dwordx2 v[14:15], v6, s[16:19], s46 offen offset:128 sc1
    buffer_load_dwordx2 v[16:17], v6, s[16:19], s46 offen offset:256 sc1
    buffer_load_dwordx2 v[18:19], v6, s[16:19], s46 offen offset:384 sc1
    s_sub_u32 s40, s40, 1
    s_waitcnt vmcnt(0)
    v_max3_u32 v20, v12, v13, v14
    v_max3_u32 v21, v15, v16, v17
    v_max3_u32 v20, v20, v18, v19
    v_max_u32 v20, v20, v21
    v_cmp_eq_u32 vcc, -1, v20
    s_cbranch_scc1 L_sback27
    s_cbranch_vccz L_sback27
    s_sleep 4
    s_branch L_sspin26_l
L_odd:
    s_mov_b32 s33, s47
    s_lshl2_add_u32 s53, s48, s47
    s_cmp_lt_u32 s48, 8
    s_cselect_b32 s34, 16, 32
    s_add_u32 s34, s34, s48
    s_sub_u32 s37, s48, 8
    s_cmp_lt_u32 s37, 20
    s_cselect_b32 s44, -16, 0
    s_cmp_lt_u32 s37, 4
    s_cselect_b32 s44, 64, s44
    s_add_u32 s44, s44, s53
    s_lshl2_add_u32 s44, s44, s32
    s_lshl_b32 s44, s44, 13
    v_lshlrev_b32 v6, 7, v0
    s_waitcnt lgkmcnt(0)
    s_mov_b32 s12, s66
    s_mov_b32 s13, s67
    s_mov_b32 s14, 0x400000
    s_mov_b32 s15, 0x00020000
    s_mov_b32 s16, s84
    s_mov_b32 s17, s85
    s_mov_b32 s18, 0x5e00000
    s_mov_b32 s19, 0x00020000
    v_min_u32 v124, 1, v0
    v_lshlrev_b32 v124, 30, v124
    s_cmp_lt_u32 s48, 8
    s_cbranch_scc1 L_touch
    s_sub_u32 s37, s48, 12
    s_cmp_lt_u32 s37, 16
    s_cbranch_scc1 L_lines
    s_lshl_b32 s50, s33, 5
    s_or_b32 s37, s48, 16
    s_add_u32 s50, s50, s37
    s_lshl_b32 s46, s50, 15
    s_lshl_b32 s37, s32, 9
    s_add_u32 s46, s46, s37
    v_lshrrev_b32 v48, 3, v0
    v_and_b32 v49, 0x70, v1
    v_lshl_add_u32 v48, v48, 11, v49
    v_add_u32 v49, 16384, v48
    s_mov_b32 s8, s64
    s_mov_b32 s9, s65
    s_mov_b32 s10, 0x400000
    s_mov_b32 s11, 0x00020000
    buffer_load_dwordx4 v[16:19], v48, s[8:11], s46 offen offset:0
    buffer_load_dwordx4 v[20:23], v48, s[8:11], s46 offen offset:128
    buffer_load_dwordx4 v[24:27], v48, s[8:11], s46 offen offset:256
    buffer_load_dwordx4 v[28:31], v48, s[8:11], s46 offen offset:384
    buffer_load_dwordx4 v[32:35], v49, s[8:11], s46 offen offset:0
    buffer_load_dwordx4 v[36:39], v49, s[8:11], s46 offen offset:128
    buffer_load_dwordx4 v[40:43], v49, s[8:11], s46 offen offset:256
    buffer_load_dwordx4 v[44:47], v49, s[8:11], s46 offen offset:384
    s_mov_b32 s86, 0x3f803f80
    v_and_b32 v56, 1, v0
    v_lshlrev_b32 v56, 7, v56
    v_bfe_u32 v57, v0, 1, 1
    v_lshl_add_u32 v56, v57, 6, v56
    v_and_b32 v57, 0x38, v0
    v_add_u32 v56, v57, v56
    s_sub_u32 s46, 127, s50
    s_lshl_b32 s46, s46, 10
    s_lshl_b32 s37, s32, 8
    s_add_u32 s46, s46, s37
    s_add_u32 s46, s46, 0x5400000
    s_waitcnt vmcnt(0)
    v_dot2_f32_bf16 v48, v16, s86, 0
    v_dot2_f32_bf16 v49, v16, v16, 0
    v_dot2_f32_bf16 v50, v24, s86, 0
    v_dot2_f32_bf16 v51, v24, v24, 0
    v_dot2_f32_bf16 v52, v32, s86, 0
    v_dot2_f32_bf16 v53, v32, v32, 0
    v_dot2_f32_bf16 v54, v40, s86, 0
    v_dot2_f32_bf16 v55, v40, v40, 0
    v_dot2_f32_bf16 v48, v17, s86, v48
    v_dot2_f32_bf16 v49, v17, v17, v49
    v_dot2_f32_bf16 v50, v25, s86, v50
    v_dot2_f32_bf16 v51, v25, v25, v51
    v_dot2_f32_bf16 v52, v33, s86, v52
    v_dot2_f32_bf16 v53, v33, v33, v53
    v_dot2_f32_bf16 v54, v41, s86, v54
    v_dot2_f32_bf16 v55, v41, v41, v55
    v_dot2_f32_bf16 v48, v18, s86, v48
    v_dot2_f32_bf16 v49, v18, v18, v49
    v_dot2_f32_bf16 v50, v26, s86, v50
    v_dot2_f32_bf16 v51, v26, v26, v51
    v_dot2_f32_bf16 v52, v34, s86, v52
    v_dot2_f32_bf16 v53, v34, v34, v53
    v_dot2_f32_bf16 v54, v42, s86, v54
    v_dot2_f32_bf16 v55, v42, v42, v55
    v_dot2_f32_bf16 v48, v19, s86, v48
    v_dot2_f32_bf16 v49, v19, v19, v49
    v_dot2_f32_bf16 v50, v27, s86, v50
    v_dot2_f32_bf16 v51, v27, v27, v51
    v_dot2_f32_bf16 v52, v35, s86, v52
    v_dot2_f32_bf16 v53, v35, v35, v53
    v_dot2_f32_bf16 v54, v43, s86, v54
    v_dot2_f32_bf16 v55, v43, v43, v55
    v_dot2_f32_bf16 v48, v20, s86, v48
    v_dot2_f32_bf16 v49, v20, v20, v49
    v_dot2_f32_bf16 v50, v28, s86, v50
    v_dot2_f32_bf16 v51, v28, v28, v51
    v_dot2_f32_bf16 v52, v36, s86, v52
    v_dot2_f32_bf16 v53, v36, v36, v53
    v_dot2_f32_bf16 v54, v44, s86, v54
    v_dot2_f32_bf16 v55, v44, v44, v55
    v_dot2_f32_bf16 v48, v21, s86, v48
    v_dot2_f32_bf16 v49, v21, v21, v49
    v_dot2_f32_bf16 v50, v29, s86, v50
    v_dot2_f32_bf16 v51, v29, v29, v51
    v_dot2_f32_bf16 v52, v37, s86, v52
    v_dot2_f32_bf16 v53, v37, v37, v53
    v_dot2_f32_bf16 v54, v45, s86, v54
    v_dot2_f32_bf16 v55, v45, v45, v55
    v_dot2_f32_bf16 v48, v22, s86, v48
    v_dot2_f32_bf16 v49, v22, v22, v49
    v_dot2_f32_bf16 v50, v30, s86, v50
    v_dot2_f32_bf16 v51, v30, v30, v51
    v_dot2_f32_bf16 v52, v38, s86, v52
    v_dot2_f32_bf16 v53, v38, v38, v53
    v_dot2_f32_bf16 v54, v46, s86, v54
    v_dot2_f32_bf16 v55, v46, v46, v55
    v_dot2_f32_bf16 v48, v23, s86, v48
    v_dot2_f32_bf16 v49, v23, v23, v49
    v_dot2_f32_bf16 v50, v31, s86, v50
    v_dot2_f32_bf16 v51, v31, v31, v51
    v_dot2_f32_bf16 v52, v39, s86, v52
    v_dot2_f32_bf16 v53, v39, v39, v53
    v_dot2_f32_bf16 v54, v47, s86, v54
    v_dot2_f32_bf16 v55, v47, v47, v55
    v_add_f32_dpp v48, v48, v48 quad_perm:[1,0,3,2] row_mask:0xf bank_mask:0xf
    v_add_f32_dpp v49, v49, v49 quad_perm:[1,0,3,2] row_mask:0xf bank_mask:0xf
    v_add_f32_dpp v50, v50, v50 quad_perm:[1,0,3,2] row_mask:0xf bank_mask:0xf
    v_add_f32_dpp v51, v51, v51 quad_perm:[1,0,3,2] row_mask:0xf bank_mask:0xf
    v_add_f32_dpp v52, v52, v52 quad_perm:[1,0,3,2] row_mask:0xf bank_mask:0xf
    v_add_f32_dpp v53, v53, v53 quad_perm:[1,0,3,2] row_mask:0xf bank_mask:0xf
    v_add_f32_dpp v54, v54, v54 quad_perm:[1,0,3,2] row_mask:0xf bank_mask:0xf
    v_add_f32_dpp v55, v55, v55 quad_perm:[1,0,3,2] row_mask:0xf bank_mask:0xf
    v_add_f32_dpp v48, v48, v48 quad_perm:[2,3,0,1] row_mask:0xf bank_mask:0xf
    v_add_f32_dpp v49, v49, v49 quad_perm:[2,3,0,1] row_mask:0xf bank_mask:0xf
    v_add_f32_dpp v50, v50, v50 quad_perm:[2,3,0,1] row_mask:0xf bank_mask:0xf
    v_add_f32_dpp v51, v51, v51 quad_perm:[2,3,0,1] row_mask:0xf bank_mask:0xf
    v_add_f32_dpp v52, v52, v52 quad_perm:[2,3,0,1] row_mask:0xf bank_mask:0xf
    v_add_f32_dpp v53, v53, v53 quad_perm:[2,3,0,1] row_mask:0xf bank_mask:0xf
    v_add_f32_dpp v54, v54, v54 quad_perm:[2,3,0,1] row_mask:0xf bank_mask:0xf
    v_add_f32_dpp v55, v55, v55 quad_perm:[2,3,0,1] row_mask:0xf bank_mask:0xf
    v_add_f32_dpp v48, v48, v48 row_half_mirror row_mask:0xf bank_mask:0xf
    v_add_f32_dpp v49, v49, v49 row_half_mirror row_mask:0xf bank_mask:0xf
    v_add_f32_dpp v50, v50, v50 row_half_mirror row_mask:0xf bank_mask:0xf
    v_add_f32_dpp v51, v51, v51 row_half_mirror row_mask:0xf bank_mask:0xf
    v_add_f32_dpp v52, v52, v52 row_half_mirror row_mask:0xf bank_mask:0xf
    v_add_f32_dpp v53, v53, v53 row_half_mirror row_mask:0xf bank_mask:0xf
    v_add_f32_dpp v54, v54, v54 row_half_mirror row_mask:0xf bank_mask:0xf
    v_add_f32_dpp v55, v55, v55 row_half_mirror row_mask:0xf bank_mask:0xf
    s_mov_b32 exec_lo, 0x2020202
    s_mov_b32 exec_hi, 0x2020202
    v_mov_b32 v48, v50
    v_mov_b32 v49, v51
    s_mov_b32 exec_lo, 0x4040404
    s_mov_b32 exec_hi, 0x4040404
    v_mov_b32 v48, v52
    v_mov_b32 v49, v53
    s_mov_b32 exec_lo, 0x8080808
    s_mov_b32 exec_hi, 0x8080808
    v_mov_b32 v48, v54
    v_mov_b32 v49, v55
    s_mov_b32 exec_lo, 0x0f0f0f0f
    s_mov_b32 exec_hi, 0x0f0f0f0f
    buffer_store_dwordx2 v[48:49], v56, s[16:19], s46 offen sc1
    s_mov_b64 exec, -1
    s_add_u32 s20, s82, 128
    s_addc_u32 s21, s83, 0
    s_mov_b32 s22, 128
    s_mov_b32 s23, 0x00020000
    buffer_load_dword v8, v124, s[20:23], 0 offen offset:32 sc1
    s_waitcnt vmcnt(0)
    v_readfirstlane_b32 s37, v8
    s_nop 0
    s_cmp_lg_u32 s37, s3
    s_cbranch_scc1 L_vspin28
L_vback29:
    s_mov_b32 s38, 64
    s_mov_b32 s39, 31
    s_waitcnt vmcnt(0)
    s_branch L_job_end
L_lines:
    s_add_u32 s20, s82, 128
    s_addc_u32 s21, s83, 0
    s_mov_b32 s22, 128
    s_mov_b32 s23, 0x00020000
    buffer_load_dword v8, v124, s[20:23], 0 offen offset:32 sc1
    s_waitcnt vmcnt(0)
    v_readfirstlane_b32 s37, v8
    s_nop 0
    s_cmp_lg_u32 s37, s3
    s_cbranch_scc1 L_vspin30
L_vback31:
    buffer_load_dword v248, v6, s[12:15], s44 offen
    s_mov_b32 s12, s68
    s_mov_b32 s13, s69
    s_mov_b32 s14, 0x200000
    s_mov_b32 s15, 0x00020000
    s_sub_u32 s39, 0x180, s12
    s_and_b32 s39, s39, 0x380
    s_sub_u32 s37, s48, 12
    s_lshl2_add_u32 s37, s37, s32
    s_lshl_b32 s37, s37, 15
    s_add_u32 s39, s39, s37
    v_and_b32 v7, 31, v0
    v_lshlrev_b32 v7, 10, v7
    buffer_load_dword v247, v7, s[12:15], s39 offen
    s_mov_b32 s14, 0
    s_sub_u32 s53, s53, 48
    s_and_b32 s37, s53, 7
    s_cmp_lt_u32 s37, 2
    s_cselect_b32 s87, 2, 3
    s_cselect_b32 s36, 34, 32
    s_cmp_ge_u32 s53, 32
    s_cselect_b32 s87, 2, s87
    s_cselect_b32 s36, 35, s36
    s_cselect_b32 s38, 5, 0
    s_cmp_lt_u32 s37, s38
    s_cselect_b32 s37, 0x5e00000, 0
    s_lshl_b32 s38, s53, 10
    s_add_u32 s37, s37, s38
    s_lshl_b32 s38, s32, 16
    s_add_u32 s37, s37, s38
    s_add_u32 s37, s37, 0x5500000
    s_sub_u32 s87, s32, s87
    s_cmp_lt_u32 s87, s36
    s_cselect_b32 s38, -1, 0
    v_mov_b32 v16, s38
    s_add_u32 s87, s87, 4
    buffer_store_dwordx4 v[16:19], v1, s[16:19], s37 offen sc1
    s_add_u32 s37, s37, 262144
    s_cmp_lt_u32 s87, s36
    s_cselect_b32 s38, -1, 0
    v_mov_b32 v20, s38
    s_add_u32 s87, s87, 4
    buffer_store_dwordx4 v[20:23], v1, s[16:19], s37 offen sc1
    s_add_u32 s37, s37, 262144
    s_cmp_lt_u32 s87, s36
    s_cselect_b32 s38, -1, 0
    v_mov_b32 v24, s38
    s_add_u32 s87, s87, 4
    buffer_store_dwordx4 v[24:27], v1, s[16:19], s37 offen sc1
    s_add_u32 s37, s37, 262144
    s_cmp_lt_u32 s87, s36
    s_cselect_b32 s38, -1, 0
    v_mov_b32 v28, s38
    s_add_u32 s87, s87, 4
    buffer_store_dwordx4 v[28:31], v1, s[16:19], s37 offen sc1
    s_add_u32 s37, s37, 262144
    s_cmp_lt_u32 s87, s36
    s_cselect_b32 s38, -1, 0
    v_mov_b32 v32, s38
    s_add_u32 s87, s87, 4
    buffer_store_dwordx4 v[32:35], v1, s[16:19], s37 offen sc1
    s_add_u32 s37, s37, 262144
    s_cmp_lt_u32 s87, s36
    s_cselect_b32 s38, -1, 0
    v_mov_b32 v36, s38
    s_add_u32 s87, s87, 4
    buffer_store_dwordx4 v[36:39], v1, s[16:19], s37 offen sc1
    s_add_u32 s37, s37, 262144
    s_cmp_lt_u32 s87, s36
    s_cselect_b32 s38, -1, 0
    v_mov_b32 v40, s38
    s_add_u32 s87, s87, 4
    buffer_store_dwordx4 v[40:43], v1, s[16:19], s37 offen sc1
    s_add_u32 s37, s37, 262144
    s_cmp_lt_u32 s87, s36
    s_cselect_b32 s38, -1, 0
    v_mov_b32 v44, s38
    s_add_u32 s87, s87, 4
    buffer_store_dwordx4 v[44:47], v1, s[16:19], s37 offen sc1
    s_add_u32 s37, s37, 262144
    s_cmp_lt_u32 s87, s36
    s_cselect_b32 s38, -1, 0
    v_mov_b32 v48, s38
    s_add_u32 s87, s87, 4
    buffer_store_dwordx4 v[48:51], v1, s[16:19], s37 offen sc1
    s_add_u32 s37, s37, 262144
    s_cmp_lt_u32 s87, s36
    s_cselect_b32 s38, -1, 0
    v_mov_b32 v52, s38
    s_add_u32 s87, s87, 4
    buffer_store_dwordx4 v[52:55], v1, s[16:19], s37 offen sc1
    s_add_u32 s37, s37, 262144
    v_mov_b32 v8, -1
    v_mov_b32 v9, -1
    v_mov_b32 v10, -1
    v_mov_b32 v11, -1
    s_lshl2_add_u32 s38, s53, s32
    s_lshl_b32 s38, s38, 10
    s_add_u32 s38, s38, 0x5440000
    buffer_store_dwordx4 v[8:11], v1, s[16:19], s38 offen sc1
    s_mov_b32 s38, 0
    s_mov_b32 s39, 63
    s_waitcnt vmcnt(0)
L_job_end:
    s_mov_b32 s8, s82
    s_mov_b32 s9, s83
    s_mov_b32 s10, 0x100
    s_mov_b32 s11, 0x00020000
    v_mov_b32 v123, 1
    s_barrier
    s_cmp_lg_u32 s32, 3
    s_cbranch_scc1 L_arr32
    buffer_atomic_add v123, v124, s[8:11], s38 offen sc0
    s_waitcnt vmcnt(0)
    v_readfirstlane_b32 s37, v123
    s_nop 0
    s_cmp_lg_u32 s37, s39
    s_cbranch_scc1 L_arr32
    buffer_store_dword v123, v124, s[8:11], s38 offen offset:128 sc1
L_arr32:
L_touch:
    buffer_load_dword v248, v6, s[12:15], s44 offen
    s_lshl_b32 s91, s33, 6
    s_add_u32 s91, s91, s34
    s_lshl_b32 s91, s91, 7
    s_add_u32 s91, s91, 0x5520000
    s_cmp_eq_u32 s32, 1
    s_cselect_b32 s91, s91, 0x5f00000
    s_cmp_ge_u32 s34, 60
    s_cbranch_scc1 L_role_60
    s_cmp_ge_u32 s34, 44
    s_cbranch_scc1 L_role_44
    s_cmp_ge_u32 s34, 40
    s_cbranch_scc1 L_role_40
L_role_16:
    s_sub_u32 s35, s34, 16
    s_lshl_b32 s54, s35, 8
    s_mov_b32 s12, s68
    s_mov_b32 s13, s69
    s_mov_b32 s14, 0x200000
    s_mov_b32 s15, 0x00020000
    s_mov_b32 s39, 2048
    v_lshrrev_b32 v52, 3, v0
    v_lshlrev_b32 v53, 2, v0
    v_and_b32 v53, 64, v53
    v_and_b32 v54, 0x70, v1
    v_xor_b32 v53, v53, v54
    v_mad_u32_u24 v44, v52, s39, v53
    v_add_u32 v45, 16384, v44
    v_add_u32 v46, 128, v44
    v_add_u32 v47, 16512, v44
    s_mul_i32 s38, s32, 32768
    s_add_u32 s54, s54, s38
    s_lshl_b32 s42, s32, 11
    s_add_u32 m0, s42, 0
    s_nop 0
    buffer_load_dwordx4 v44, s[12:15], s54 offen lds
    s_add_u32 m0, s42, 1024
    s_nop 0
    buffer_load_dwordx4 v45, s[12:15], s54 offen lds
    s_add_u32 m0, s42, 8192
    s_nop 0
    buffer_load_dwordx4 v46, s[12:15], s54 offen lds
    s_add_u32 m0, s42, 9216
    s_nop 0
    buffer_load_dwordx4 v47, s[12:15], s54 offen lds
    s_add_u32 s54, s54, 131072
    s_add_u32 m0, s42, 16384
    s_nop 0
    buffer_load_dwordx4 v44, s[12:15], s54 offen lds
    s_add_u32 m0, s42, 17408
    s_nop 0
    buffer_load_dwordx4 v45, s[12:15], s54 offen lds
    s_add_u32 m0, s42, 24576
    s_nop 0
    buffer_load_dwordx4 v46, s[12:15], s54 offen lds
    s_add_u32 m0, s42, 25600
    s_nop 0
    buffer_load_dwordx4 v47, s[12:15], s54 offen lds
    s_add_u32 s54, s54, 131072
    s_add_u32 m0, s42, 32768
    s_nop 0
    buffer_load_dwordx4 v44, s[12:15], s54 offen lds
    s_add_u32 m0, s42, 33792
    s_nop 0
    buffer_load_dwordx4 v45, s[12:15], s54 offen lds
    s_add_u32 m0, s42, 40960
    s_nop 0
    buffer_load_dwordx4 v46, s[12:15], s54 offen lds
    s_add_u32 m0, s42, 41984
    s_nop 0
    buffer_load_dwordx4 v47, s[12:15], s54 offen lds
    s_add_u32 s54, s54, 131072
    s_add_u32 m0, s42, 49152
    s_nop 0
    buffer_load_dwordx4 v44, s[12:15], s54 offen lds
    s_add_u32 m0, s42, 50176
    s_nop 0
    buffer_load_dwordx4 v45, s[12:15], s54 offen lds
    s_add_u32 m0, s42, 57344
    s_nop 0
    buffer_load_dwordx4 v46, s[12:15], s54 offen lds
    s_add_u32 m0, s42, 58368
    s_nop 0
    buffer_load_dwordx4 v47, s[12:15], s54 offen lds
    s_add_u32 s54, s54, 131072
    s_add_u32 m0, s42, 65536
    s_nop 0
    buffer_load_dwordx4 v44, s[12:15], s54 offen lds
    s_add_u32 m0, s42, 66560
    s_nop 0
    buffer_load_dwordx4 v45, s[12:15], s54 offen lds
    s_add_u32 m0, s42, 73728
    s_nop 0
    buffer_load_dwordx4 v46, s[12:15], s54 offen lds
    s_add_u32 m0, s42, 74752
    s_nop 0
    buffer_load_dwordx4 v47, s[12:15], s54 offen lds
    s_add_u32 s54, s54, 131072
    v_lshrrev_b32 v52, 4, v0
    v_bfe_u32 v53, v0, 2, 2
    v_lshl_add_u32 v52, v52, 3, v53
    v_lshlrev_b32 v52, 7, v52
    v_lshrrev_b32 v53, 1, v53
    v_lshl_add_u32 v52, v53, 6, v52
    v_and_b32 v53, 3, v0
    v_lshl_add_u32 v52, v53, 4, v52
    s_lshr_b32 s37, s32, 1
    s_lshl_b32 s37, s37, 13
    s_and_b32 s38, s32, 1
    s_lshl_b32 s38, s38, 6
    s_add_u32 s37, s37, s38
    s_add_u32 s37, s37, 0
    v_xor_b32 v48, s37, v52
    s_lshr_b32 s37, s32, 1
    s_lshl_b32 s37, s37, 13
    s_and_b32 s38, s32, 1
    s_lshl_b32 s38, s38, 6
    s_add_u32 s37, s37, s38
    s_add_u32 s37, s37, 8
    v_xor_b32 v49, s37, v52
    v_add_u32 v2, 98304, v1
    v_mov_b32 v108, 0
    v_mov_b32 v109, 0
    v_mov_b32 v110, 0
    v_mov_b32 v111, 0
    v_mov_b32 v112, 0
    v_mov_b32 v113, 0
    v_mov_b32 v114, 0
    v_mov_b32 v115, 0
    v_mov_b32 v13, 0x3f80
    v_and_b32 v12, 1, v0
    v_lshlrev_b32 v12, 4, v12
    v_lshlrev_b32 v12, v12, v13
    s_mov_b32 exec_lo, 0x300003
    s_mov_b32 exec_hi, 0x30000300
    v_mov_b32 v108, v12
    v_mov_b32 v114, v12
    s_mov_b32 exec_lo, 0xc0000c
    s_mov_b32 exec_hi, 0xc0000c00
    v_mov_b32 v109, v12
    v_mov_b32 v115, v12
    s_mov_b64 exec, -1
    s_lshl_b32 s37, s33, 6
    s_add_u32 s37, s37, 0
    s_lshl_b32 s37, s37, 7
    v_lshl_add_u32 v4, v0, 7, s37
    s_cmp_eq_u32 s32, 0
    s_cselect_b32 s37, 16, 0
    v_cmp_le_u32 vcc, s37, v0
    s_nop 1
    v_cndmask_b32 v4, v4, 2.0, vcc
    s_mov_b32 s86, 0x3f803f80
    s_lshl_b32 s43, s32, 12
    s_mul_i32 s41, s33, 2097152
    s_add_u32 s41, s41, 0x0
    s_add_u32 s41, s41, s43
    s_lshl_b32 s38, s35, 2
    s_add_u32 s38, s38, s32
    s_mul_i32 s90, s33, 2097152
    s_add_u32 s90, s90, 0x7f0000
    s_lshl_b32 s37, s38, 11
    s_add_u32 s90, s90, s37
    v_and_b32 v12, 15, v0
    v_and_b32 v13, 0x30, v0
    v_lshl_add_u32 v3, v12, 11, v13
    s_lshl_b32 s37, s38, 6
    v_add_u32 v3, s37, v3
    s_lshl_b32 s50, s33, 20
    s_add_u32 s50, s50, 983040
    s_add_u32 s88, s84, 0x5000000
    s_addc_u32 s89, s85, 0
    s_mov_b32 s8, s64
    s_mov_b32 s9, s65
    s_mov_b32 s10, 0x400000
    s_mov_b32 s11, 0x00020000
    v_bfe_u32 v13, v0, 4, 1
    v_lshl_add_u32 v12, v12, 1, v13
    s_lshl_b32 s37, s32, 2
    s_add_u32 s37, s37, 65536
    v_lshl_add_u32 v6, v12, 4, s37
    v_add_u32 v7, 65536, v1
    v_and_b32 v12, 31, v0
    v_lshrrev_b32 v13, 5, v0
    v_lshlrev_b32 v12, 2, v12
    v_lshl_add_u32 v8, v13, 10, v12
    s_mul_i32 s46, s33, 65536
    s_add_u32 s46, s46, 0x543f800
    s_lshl_b32 s37, s35, 7
    s_add_u32 s46, s46, s37
    s_cmp_eq_u32 s32, 2
    s_cselect_b32 s46, s46, 0x5f00000
    s_mov_b32 s36, -1
    v_add_u32 v50, 0, v48
    v_add_u32 v51, 0, v49
    s_waitcnt vmcnt(16)
    s_barrier
    ds_read_b64_tr_b16 a[0:1], v50 offset:0
    ds_read_b64_tr_b16 a[2:3], v50 offset:512
    ds_read_b64_tr_b16 a[4:5], v51 offset:0
    ds_read_b64_tr_b16 a[6:7], v51 offset:512
    ds_read_b64_tr_b16 a[8:9], v50 offset:4096
    ds_read_b64_tr_b16 a[10:11], v50 offset:4608
    ds_read_b64_tr_b16 a[12:13], v51 offset:4096
    ds_read_b64_tr_b16 a[14:15], v51 offset:4608
    s_add_u32 m0, s42, 81920
    s_nop 0
    buffer_load_dwordx4 v44, s[12:15], s54 offen lds
    s_add_u32 m0, s42, 82944
    s_nop 0
    buffer_load_dwordx4 v45, s[12:15], s54 offen lds
    s_add_u32 m0, s42, 90112
    s_nop 0
    buffer_load_dwordx4 v46, s[12:15], s54 offen lds
    s_add_u32 m0, s42, 91136
    s_nop 0
    buffer_load_dwordx4 v47, s[12:15], s54 offen lds
    s_add_u32 s54, s54, 131072
    s_waitcnt lgkmcnt(0)
    v_add_u32 v50, 16384, v48
    v_add_u32 v51, 16384, v49
    s_waitcnt vmcnt(16)
    s_barrier
    ds_read_b64_tr_b16 a[16:17], v50 offset:0
    ds_read_b64_tr_b16 a[18:19], v50 offset:512
    ds_read_b64_tr_b16 a[20:21], v51 offset:0
    ds_read_b64_tr_b16 a[22:23], v51 offset:512
    ds_read_b64_tr_b16 a[24:25], v50 offset:4096
    ds_read_b64_tr_b16 a[26:27], v50 offset:4608
    ds_read_b64_tr_b16 a[28:29], v51 offset:4096
    ds_read_b64_tr_b16 a[30:31], v51 offset:4608
    s_add_u32 m0, s42, 0
    s_nop 0
    buffer_load_dwordx4 v44, s[12:15], s54 offen lds
    s_add_u32 m0, s42, 1024
    s_nop 0
    buffer_load_dwordx4 v45, s[12:15], s54 offen lds
    s_add_u32 m0, s42, 8192
    s_nop 0
    buffer_load_dwordx4 v46, s[12:15], s54 offen lds
    s_add_u32 m0, s42, 9216
    s_nop 0
    buffer_load_dwordx4 v47, s[12:15], s54 offen lds
    s_add_u32 s54, s54, 131072
    s_waitcnt lgkmcnt(0)
    v_add_u32 v50, 32768, v48
    v_add_u32 v51, 32768, v49
    s_waitcnt vmcnt(16)
    s_barrier
    ds_read_b64_tr_b16 a[32:33], v50 offset:0
    ds_read_b64_tr_b16 a[34:35], v50 offset:512
    ds_read_b64_tr_b16 a[36:37], v51 offset:0
    ds_read_b64_tr_b16 a[38:39], v51 offset:512
    ds_read_b64_tr_b16 a[40:41], v50 offset:4096
    ds_read_b64_tr_b16 a[42:43], v50 offset:4608
    ds_read_b64_tr_b16 a[44:45], v51 offset:4096
    ds_read_b64_tr_b16 a[46:47], v51 offset:4608
    s_add_u32 m0, s42, 16384
    s_nop 0
    buffer_load_dwordx4 v44, s[12:15], s54 offen lds
    s_add_u32 m0, s42, 17408
    s_nop 0
    buffer_load_dwordx4 v45, s[12:15], s54 offen lds
    s_add_u32 m0, s42, 24576
    s_nop 0
    buffer_load_dwordx4 v46, s[12:15], s54 offen lds
    s_add_u32 m0, s42, 25600
    s_nop 0
    buffer_load_dwordx4 v47, s[12:15], s54 offen lds
    s_add_u32 s54, s54, 131072
    s_waitcnt lgkmcnt(0)
    v_add_u32 v50, 49152, v48
    v_add_u32 v51, 49152, v49
    s_waitcnt vmcnt(16)
    s_barrier
    ds_read_b64_tr_b16 a[48:49], v50 offset:0
    ds_read_b64_tr_b16 a[50:51], v50 offset:512
    ds_read_b64_tr_b16 a[52:53], v51 offset:0
    ds_read_b64_tr_b16 a[54:55], v51 offset:512
    ds_read_b64_tr_b16 a[56:57], v50 offset:4096
    ds_read_b64_tr_b16 a[58:59], v50 offset:4608
    ds_read_b64_tr_b16 a[60:61], v51 offset:4096
    ds_read_b64_tr_b16 a[62:63], v51 offset:4608
    s_add_u32 m0, s42, 32768
    s_nop 0
    buffer_load_dwordx4 v44, s[12:15], s54 offen lds
    s_add_u32 m0, s42, 33792
    s_nop 0
    buffer_load_dwordx4 v45, s[12:15], s54 offen lds
    s_add_u32 m0, s42, 40960
    s_nop 0
    buffer_load_dwordx4 v46, s[12:15], s54 offen lds
    s_add_u32 m0, s42, 41984
    s_nop 0
    buffer_load_dwordx4 v47, s[12:15], s54 offen lds
    s_add_u32 s54, s54, 131072
    s_waitcnt lgkmcnt(0)
    v_add_u32 v50, 65536, v48
    v_add_u32 v51, 65536, v49
    s_waitcnt vmcnt(16)
    s_barrier
    ds_read_b64_tr_b16 a[64:65], v50 offset:0
    ds_read_b64_tr_b16 a[66:67], v50 offset:512
    ds_read_b64_tr_b16 a[68:69], v51 offset:0
    ds_read_b64_tr_b16 a[70:71], v51 offset:512
    ds_read_b64_tr_b16 a[72:73], v50 offset:4096
    ds_read_b64_tr_b16 a[74:75], v50 offset:4608
    ds_read_b64_tr_b16 a[76:77], v51 offset:4096
    ds_read_b64_tr_b16 a[78:79], v51 offset:4608
    s_add_u32 m0, s42, 49152
    s_nop 0
    buffer_load_dwordx4 v44, s[12:15], s54 offen lds
    s_add_u32 m0, s42, 50176
    s_nop 0
    buffer_load_dwordx4 v45, s[12:15], s54 offen lds
    s_add_u32 m0, s42, 57344
    s_nop 0
    buffer_load_dwordx4 v46, s[12:15], s54 offen lds
    s_add_u32 m0, s42, 58368
    s_nop 0
    buffer_load_dwordx4 v47, s[12:15], s54 offen lds
    s_add_u32 s54, s54, 131072
    s_waitcnt lgkmcnt(0)
    v_add_u32 v50, 81920, v48
    v_add_u32 v51, 81920, v49
    s_waitcnt vmcnt(16)
    s_barrier
    ds_read_b64_tr_b16 a[80:81], v50 offset:0
    ds_read_b64_tr_b16 a[82:83], v50 offset:512
    ds_read_b64_tr_b16 a[84:85], v51 offset:0
    ds_read_b64_tr_b16 a[86:87], v51 offset:512
    ds_read_b64_tr_b16 a[88:89], v50 offset:4096
    ds_read_b64_tr_b16 a[90:91], v50 offset:4608
    ds_read_b64_tr_b16 a[92:93], v51 offset:4096
    ds_read_b64_tr_b16 a[94:95], v51 offset:4608
    s_add_u32 m0, s42, 65536
    s_nop 0
    buffer_load_dwordx4 v44, s[12:15], s54 offen lds
    s_add_u32 m0, s42, 66560
    s_nop 0
    buffer_load_dwordx4 v45, s[12:15], s54 offen lds
    s_add_u32 m0, s42, 73728
    s_nop 0
    buffer_load_dwordx4 v46, s[12:15], s54 offen lds
    s_add_u32 m0, s42, 74752
    s_nop 0
    buffer_load_dwordx4 v47, s[12:15], s54 offen lds
    s_add_u32 s54, s54, 131072
    s_waitcnt lgkmcnt(0)
    v_add_u32 v50, 0, v48
    v_add_u32 v51, 0, v49
    s_waitcnt vmcnt(16)
    s_barrier
    ds_read_b64_tr_b16 a[96:97], v50 offset:0
    ds_read_b64_tr_b16 a[98:99], v50 offset:512
    ds_read_b64_tr_b16 a[100:101], v51 offset:0
    ds_read_b64_tr_b16 a[102:103], v51 offset:512
    ds_read_b64_tr_b16 a[104:105], v50 offset:4096
    ds_read_b64_tr_b16 a[106:107], v50 offset:4608
    ds_read_b64_tr_b16 a[108:109], v51 offset:4096
    ds_read_b64_tr_b16 a[110:111], v51 offset:4608
    s_add_u32 m0, s42, 81920
    s_nop 0
    buffer_load_dwordx4 v44, s[12:15], s54 offen lds
    s_add_u32 m0, s42, 82944
    s_nop 0
    buffer_load_dwordx4 v45, s[12:15], s54 offen lds
    s_add_u32 m0, s42, 90112
    s_nop 0
    buffer_load_dwordx4 v46, s[12:15], s54 offen lds
    s_add_u32 m0, s42, 91136
    s_nop 0
    buffer_load_dwordx4 v47, s[12:15], s54 offen lds
    s_add_u32 s54, s54, 131072
    s_waitcnt lgkmcnt(0)
    v_add_u32 v50, 16384, v48
    v_add_u32 v51, 16384, v49
    s_waitcnt vmcnt(16)
    s_barrier
    ds_read_b64_tr_b16 a[112:113], v50 offset:0
    ds_read_b64_tr_b16 a[114:115], v50 offset:512
    ds_read_b64_tr_b16 a[116:117], v51 offset:0
    ds_read_b64_tr_b16 a[118:119], v51 offset:512
    ds_read_b64_tr_b16 a[120:121], v50 offset:4096
    ds_read_b64_tr_b16 a[122:123], v50 offset:4608
    ds_read_b64_tr_b16 a[124:125], v51 offset:4096
    ds_read_b64_tr_b16 a[126:127], v51 offset:4608
    s_add_u32 m0, s42, 0
    s_nop 0
    buffer_load_dwordx4 v44, s[12:15], s54 offen lds
    s_add_u32 m0, s42, 1024
    s_nop 0
    buffer_load_dwordx4 v45, s[12:15], s54 offen lds
    s_add_u32 m0, s42, 8192
    s_nop 0
    buffer_load_dwordx4 v46, s[12:15], s54 offen lds
    s_add_u32 m0, s42, 9216
    s_nop 0
    buffer_load_dwordx4 v47, s[12:15], s54 offen lds
    s_add_u32 s54, s54, 131072
    s_waitcnt lgkmcnt(0)
    v_add_u32 v50, 32768, v48
    v_add_u32 v51, 32768, v49
    s_waitcnt vmcnt(16)
    s_barrier
    ds_read_b64_tr_b16 a[128:129], v50 offset:0
    ds_read_b64_tr_b16 a[130:131], v50 offset:512
    ds_read_b64_tr_b16 a[132:133], v51 offset:0
    ds_read_b64_tr_b16 a[134:135], v51 offset:512
    ds_read_b64_tr_b16 a[136:137], v50 offset:4096
    ds_read_b64_tr_b16 a[138:139], v50 offset:4608
    ds_read_b64_tr_b16 a[140:141], v51 offset:4096
    ds_read_b64_tr_b16 a[142:143], v51 offset:4608
    s_add_u32 m0, s42, 16384
    s_nop 0
    buffer_load_dwordx4 v44, s[12:15], s54 offen lds
    s_add_u32 m0, s42, 17408
    s_nop 0
    buffer_load_dwordx4 v45, s[12:15], s54 offen lds
    s_add_u32 m0, s42, 24576
    s_nop 0
    buffer_load_dwordx4 v46, s[12:15], s54 offen lds
    s_add_u32 m0, s42, 25600
    s_nop 0
    buffer_load_dwordx4 v47, s[12:15], s54 offen lds
    s_add_u32 s54, s54, 131072
    s_waitcnt lgkmcnt(0)
    v_add_u32 v50, 49152, v48
    v_add_u32 v51, 49152, v49
    s_waitcnt vmcnt(16)
    s_barrier
    ds_read_b64_tr_b16 a[144:145], v50 offset:0
    ds_read_b64_tr_b16 a[146:147], v50 offset:512
    ds_read_b64_tr_b16 a[148:149], v51 offset:0
    ds_read_b64_tr_b16 a[150:151], v51 offset:512
    ds_read_b64_tr_b16 a[152:153], v50 offset:4096
    ds_read_b64_tr_b16 a[154:155], v50 offset:4608
    ds_read_b64_tr_b16 a[156:157], v51 offset:4096
    ds_read_b64_tr_b16 a[158:159], v51 offset:4608
    s_add_u32 m0, s42, 32768
    s_nop 0
    buffer_load_dwordx4 v44, s[12:15], s54 offen lds
    s_add_u32 m0, s42, 33792
    s_nop 0
    buffer_load_dwordx4 v45, s[12:15], s54 offen lds
    s_add_u32 m0, s42, 40960
    s_nop 0
    buffer_load_dwordx4 v46, s[12:15], s54 offen lds
    s_add_u32 m0, s42, 41984
    s_nop 0
    buffer_load_dwordx4 v47, s[12:15], s54 offen lds
    s_add_u32 s54, s54, 131072
    s_waitcnt lgkmcnt(0)
    v_add_u32 v50, 65536, v48
    v_add_u32 v51, 65536, v49
    s_waitcnt vmcnt(16)
    s_barrier
    ds_read_b64_tr_b16 a[160:161], v50 offset:0
    ds_read_b64_tr_b16 a[162:163], v50 offset:512
    ds_read_b64_tr_b16 a[164:165], v51 offset:0
    ds_read_b64_tr_b16 a[166:167], v51 offset:512
    ds_read_b64_tr_b16 a[168:169], v50 offset:4096
    ds_read_b64_tr_b16 a[170:171], v50 offset:4608
    ds_read_b64_tr_b16 a[172:173], v51 offset:4096
    ds_read_b64_tr_b16 a[174:175], v51 offset:4608
    s_add_u32 m0, s42, 49152
    s_nop 0
    buffer_load_dwordx4 v44, s[12:15], s54 offen lds
    s_add_u32 m0, s42, 50176
    s_nop 0
    buffer_load_dwordx4 v45, s[12:15], s54 offen lds
    s_add_u32 m0, s42, 57344
    s_nop 0
    buffer_load_dwordx4 v46, s[12:15], s54 offen lds
    s_add_u32 m0, s42, 58368
    s_nop 0
    buffer_load_dwordx4 v47, s[12:15], s54 offen lds
    s_add_u32 s54, s54, 131072
    s_waitcnt lgkmcnt(0)
    v_add_u32 v50, 81920, v48
    v_add_u32 v51, 81920, v49
    s_waitcnt vmcnt(16)
    s_barrier
    ds_read_b64_tr_b16 a[176:177], v50 offset:0
    ds_read_b64_tr_b16 a[178:179], v50 offset:512
    ds_read_b64_tr_b16 a[180:181], v51 offset:0
    ds_read_b64_tr_b16 a[182:183], v51 offset:512
    ds_read_b64_tr_b16 a[184:185], v50 offset:4096
    ds_read_b64_tr_b16 a[186:187], v50 offset:4608
    ds_read_b64_tr_b16 a[188:189], v51 offset:4096
    ds_read_b64_tr_b16 a[190:191], v51 offset:4608
    s_waitcnt lgkmcnt(0)
    v_add_u32 v50, 0, v48
    v_add_u32 v51, 0, v49
    s_waitcnt vmcnt(12)
    s_barrier
    ds_read_b64_tr_b16 a[192:193], v50 offset:0
    ds_read_b64_tr_b16 a[194:195], v50 offset:512
    ds_read_b64_tr_b16 a[196:197], v51 offset:0
    ds_read_b64_tr_b16 a[198:199], v51 offset:512
    ds_read_b64_tr_b16 a[200:201], v50 offset:4096
    ds_read_b64_tr_b16 a[202:203], v50 offset:4608
    ds_read_b64_tr_b16 a[204:205], v51 offset:4096
    ds_read_b64_tr_b16 a[206:207], v51 offset:4608
    s_waitcnt lgkmcnt(0)
    v_add_u32 v50, 16384, v48
    v_add_u32 v51, 16384, v49
    s_waitcnt vmcnt(8)
    s_barrier
    ds_read_b64_tr_b16 a[208:209], v50 offset:0
    ds_read_b64_tr_b16 a[210:211], v50 offset:512
    ds_read_b64_tr_b16 a[212:213], v51 offset:0
    ds_read_b64_tr_b16 a[214:215], v51 offset:512
    ds_read_b64_tr_b16 a[216:217], v50 offset:4096
    ds_read_b64_tr_b16 a[218:219], v50 offset:4608
    ds_read_b64_tr_b16 a[220:221], v51 offset:4096
    ds_read_b64_tr_b16 a[222:223], v51 offset:4608
    s_waitcnt lgkmcnt(0)
    v_add_u32 v50, 32768, v48
    v_add_u32 v51, 32768, v49
    s_waitcnt vmcnt(4)
    s_barrier
    ds_read_b64_tr_b16 a[224:225], v50 offset:0
    ds_read_b64_tr_b16 a[226:227], v50 offset:512
    ds_read_b64_tr_b16 a[228:229], v51 offset:0
    ds_read_b64_tr_b16 a[230:231], v51 offset:512
    ds_read_b64_tr_b16 a[232:233], v50 offset:4096
    ds_read_b64_tr_b16 a[234:235], v50 offset:4608
    ds_read_b64_tr_b16 a[236:237], v51 offset:4096
    ds_read_b64_tr_b16 a[238:239], v51 offset:4608
    s_waitcnt lgkmcnt(0)
    v_add_u32 v50, 49152, v48
    v_add_u32 v51, 49152, v49
    s_waitcnt vmcnt(0)
    s_barrier
    ds_read_b64_tr_b16 a[240:241], v50 offset:0
    ds_read_b64_tr_b16 a[242:243], v50 offset:512
    ds_read_b64_tr_b16 a[244:245], v51 offset:0
    ds_read_b64_tr_b16 a[246:247], v51 offset:512
    ds_read_b64_tr_b16 a[248:249], v50 offset:4096
    ds_read_b64_tr_b16 a[250:251], v50 offset:4608
    ds_read_b64_tr_b16 a[252:253], v51 offset:4096
    ds_read_b64_tr_b16 a[254:255], v51 offset:4608
    s_waitcnt lgkmcnt(0)
    s_barrier
    s_add_u32 s20, s82, 128
    s_addc_u32 s21, s83, 0
    s_mov_b32 s22, 128
    s_mov_b32 s23, 0x00020000
    buffer_load_dword v12, v124, s[20:23], 0 offen offset:32 sc1
    s_waitcnt vmcnt(0)
    v_readfirstlane_b32 s37, v12
    s_nop 0
    s_cmp_lg_u32 s37, s3
    s_cbranch_scc1 L_vspin33
L_vback34:
    s_cmp_lg_u32 s32, 0
    s_cbranch_scc1 L_arv35
    s_add_u32 s20, s82, 0x80
    s_addc_u32 s21, s83, 0
    s_mov_b32 s22, 0x4
    s_mov_b32 s23, 0x00020000
    buffer_load_dword v12, v124, s[20:23], 0 offen sc1
    s_waitcnt vmcnt(0)
    v_cmp_eq_u32 vcc, v124, v12
    s_cbranch_vccnz L_spin36
L_back37:
L_arv35:
    s_add_u32 s47, s36, 1
    s_min_i32 s47, s47, 31
    s_max_i32 s47, s47, 0
    s_cmp_ge_u32 s47, 16
    s_cselect_b32 s8, s88, s64
    s_cselect_b32 s9, s89, s65
    s_and_b32 s47, s47, 15
    s_lshl_b32 s47, s47, 16
    s_sub_u32 s47, s50, s47
    s_add_u32 s48, s47, 32768
    buffer_load_dwordx4 v[128:131], v3, s[8:11], s48 offen sc1
    buffer_load_dwordx4 v[132:135], v3, s[8:11], s47 offen sc1
    s_add_u32 s96, s41, 2031616
    s_mov_b32 s98, s41
    s_mov_b32 s45, 0x5540000
    buffer_load_dword v136, v4, s[16:19], s45 offen sc1
    s_waitcnt vmcnt(0)
    v_cmp_ne_u32 vcc, 0, v136
    s_cbranch_vccnz L_spin38
L_back39:
    s_barrier
    s_add_u32 m0, s43, 0
    s_add_u32 s42, s41, 0
    buffer_load_dwordx4 v1, s[16:19], s42 offen offset:0 sc1 lds
    buffer_load_dwordx4 v1, s[16:19], s42 offen offset:1024 sc1 lds
    buffer_load_dwordx4 v1, s[16:19], s42 offen offset:2048 sc1 lds
    buffer_load_dwordx4 v1, s[16:19], s42 offen offset:3072 sc1 lds
    s_add_u32 m0, s43, 16384
    s_add_u32 s42, s41, 16384
    buffer_load_dwordx4 v1, s[16:19], s42 offen offset:0 sc1 lds
    buffer_load_dwordx4 v1, s[16:19], s42 offen offset:1024 sc1 lds
    buffer_load_dwordx4 v1, s[16:19], s42 offen offset:2048 sc1 lds
    buffer_load_dwordx4 v1, s[16:19], s42 offen offset:3072 sc1 lds
    s_add_u32 m0, s43, 32768
    s_add_u32 s42, s41, 32768
    buffer_load_dwordx4 v1, s[16:19], s42 offen offset:0 sc1 lds
    buffer_load_dwordx4 v1, s[16:19], s42 offen offset:1024 sc1 lds
    buffer_load_dwordx4 v1, s[16:19], s42 offen offset:2048 sc1 lds
    buffer_load_dwordx4 v1, s[16:19], s42 offen offset:3072 sc1 lds
    s_add_u32 s45, s45, 65536
    s_waitcnt vmcnt(0) lgkmcnt(0)
    s_barrier
    v_mfma_f32_16x16x32_bf16 v[12:15], v[108:111], v[128:131], 0
    v_mfma_f32_16x16x32_bf16 v[16:19], v[112:115], v[128:131], 0
    v_mfma_f32_16x16x32_bf16 v[20:23], v[108:111], v[132:135], 0
    v_mfma_f32_16x16x32_bf16 v[24:27], v[112:115], v[132:135], 0
    ds_read_b128 v[44:47], v1 offset:0
    ds_read_b128 v[48:51], v1 offset:1024
    ds_read_b128 v[52:55], v1 offset:2048
    ds_read_b128 v[56:59], v1 offset:3072
    s_mov_b32 s36, 0
    s_waitcnt lgkmcnt(0)
    s_nop 7
L_o_b0:
    s_waitcnt lgkmcnt(2)
    v_mfma_f32_16x16x32_bf16 v[12:15], a[0:3], v[44:47], v[12:15]
    ds_read_b128 v[60:63], v1 offset:4096
    ds_read_b128 v[140:143], v7
    v_mfma_f32_16x16x32_bf16 v[20:23], a[0:3], v[48:51], v[20:23]
    s_cmp_eq_u32 s36, 0
    s_cselect_b32 s49, 0x5e00000, s46
    v_mfma_f32_16x16x32_bf16 v[24:27], a[4:7], v[48:51], v[24:27]
    ds_read_b128 v[64:67], v1 offset:5120
    v_mfma_f32_16x16x32_bf16 v[16:19], a[4:7], v[44:47], v[16:19]
    s_waitcnt lgkmcnt(3)
    v_mfma_f32_16x16x32_bf16 v[12:15], a[8:11], v[52:55], v[12:15]
    s_waitcnt lgkmcnt(1)
    ds_read_b128 v[68:71], v1 offset:6144
    v_add_f32 v140, v140, v141
    v_mfma_f32_16x16x32_bf16 v[20:23], a[8:11], v[56:59], v[20:23]
    v_add_f32 v142, v142, v143
    v_add_f32 v140, v140, v142
    v_mfma_f32_16x16x32_bf16 v[24:27], a[12:15], v[56:59], v[24:27]
    ds_read_b128 v[72:75], v1 offset:7168
    v_min_u32 v140, -2, v140
    v_mfma_f32_16x16x32_bf16 v[16:19], a[12:15], v[52:55], v[16:19]
    s_waitcnt lgkmcnt(2)
    buffer_store_dword v140, v8, s[16:19], s49 offen sc1
    v_mfma_f32_16x16x32_bf16 v[12:15], a[16:19], v[60:63], v[12:15]
    ds_read_b128 v[44:47], v1 offset:8192
    v_mfma_f32_16x16x32_bf16 v[20:23], a[16:19], v[64:67], v[20:23]
    v_mfma_f32_16x16x32_bf16 v[24:27], a[20:23], v[64:67], v[24:27]
    s_add_u32 m0, s43, 49152
    ds_read_b128 v[48:51], v1 offset:9216
    s_add_u32 s42, s41, 49152
    v_mfma_f32_16x16x32_bf16 v[16:19], a[20:23], v[60:63], v[16:19]
    s_waitcnt lgkmcnt(2)
    buffer_load_dwordx4 v1, s[16:19], s42 offen offset:0 sc1 lds
    v_mfma_f32_16x16x32_bf16 v[12:15], a[24:27], v[68:71], v[12:15]
    ds_read_b128 v[52:55], v1 offset:10240
    v_mfma_f32_16x16x32_bf16 v[20:23], a[24:27], v[72:75], v[20:23]
    v_mfma_f32_16x16x32_bf16 v[24:27], a[28:31], v[72:75], v[24:27]
    ds_read_b128 v[56:59], v1 offset:11264
    buffer_load_dwordx4 v1, s[16:19], s42 offen offset:1024 sc1 lds
    v_mfma_f32_16x16x32_bf16 v[16:19], a[28:31], v[68:71], v[16:19]
    s_waitcnt lgkmcnt(2)
    v_mfma_f32_16x16x32_bf16 v[12:15], a[32:35], v[44:47], v[12:15]
    ds_read_b128 v[60:63], v1 offset:12288
    v_mfma_f32_16x16x32_bf16 v[20:23], a[32:35], v[48:51], v[20:23]
    buffer_load_dwordx4 v1, s[16:19], s42 offen offset:2048 sc1 lds
    v_mfma_f32_16x16x32_bf16 v[24:27], a[36:39], v[48:51], v[24:27]
    ds_read_b128 v[64:67], v1 offset:13312
    v_mfma_f32_16x16x32_bf16 v[16:19], a[36:39], v[44:47], v[16:19]
    s_waitcnt lgkmcnt(2)
    v_mfma_f32_16x16x32_bf16 v[12:15], a[40:43], v[52:55], v[12:15]
    ds_read_b128 v[68:71], v1 offset:14336
    buffer_load_dwordx4 v1, s[16:19], s42 offen offset:3072 sc1 lds
    v_mfma_f32_16x16x32_bf16 v[20:23], a[40:43], v[56:59], v[20:23]
    s_add_u32 s98, s98, 65536
    s_min_i32 s98, s98, s96
    s_and_b32 s41, s98, 0xffffffff
    v_mfma_f32_16x16x32_bf16 v[24:27], a[44:47], v[56:59], v[24:27]
    s_add_u32 m0, s43, 98304
    ds_read_b128 v[72:75], v1 offset:15360
    s_add_u32 s42, s41, 0
    v_mfma_f32_16x16x32_bf16 v[16:19], a[44:47], v[52:55], v[16:19]
    s_waitcnt vmcnt(11) lgkmcnt(2)
    s_barrier
    v_mfma_f32_16x16x32_bf16 v[12:15], a[48:51], v[60:63], v[12:15]
    ds_read_b128 v[44:47], v1 offset:16384
    v_mfma_f32_16x16x32_bf16 v[20:23], a[48:51], v[64:67], v[20:23]
    v_mfma_f32_16x16x32_bf16 v[24:27], a[52:55], v[64:67], v[24:27]
    s_add_u32 s47, s36, 1
    ds_read_b128 v[48:51], v1 offset:17408
    s_min_i32 s47, s47, 31
    v_mfma_f32_16x16x32_bf16 v[16:19], a[52:55], v[60:63], v[16:19]
    s_waitcnt lgkmcnt(2)
    s_max_i32 s47, s47, 0
    s_cmp_ge_u32 s47, 16
    v_mfma_f32_16x16x32_bf16 v[12:15], a[56:59], v[68:71], v[12:15]
    s_cselect_b32 s8, s88, s64
    ds_read_b128 v[52:55], v1 offset:18432
    s_cselect_b32 s9, s89, s65
    v_mfma_f32_16x16x32_bf16 v[20:23], a[56:59], v[72:75], v[20:23]
    s_and_b32 s47, s47, 15
    s_lshl_b32 s47, s47, 16
    s_sub_u32 s47, s50, s47
    v_mfma_f32_16x16x32_bf16 v[24:27], a[60:63], v[72:75], v[24:27]
    s_add_u32 s48, s47, 32768
    ds_read_b128 v[56:59], v1 offset:19456
    buffer_load_dwordx4 v[128:131], v3, s[8:11], s48 offen sc1
    v_mfma_f32_16x16x32_bf16 v[16:19], a[60:63], v[68:71], v[16:19]
    s_waitcnt lgkmcnt(2)
    buffer_load_dwordx4 v[132:135], v3, s[8:11], s47 offen sc1
    v_mfma_f32_16x16x32_bf16 v[12:15], a[64:67], v[44:47], v[12:15]
    s_add_u32 s90, s90, 65536
    ds_read_b128 v[60:63], v1 offset:20480
    s_add_u32 s46, s46, 2048
    v_mfma_f32_16x16x32_bf16 v[20:23], a[64:67], v[48:51], v[20:23]
    s_and_b32 s44, s90, 0xffffffff
    v_mfma_f32_16x16x32_bf16 v[24:27], a[68:71], v[48:51], v[24:27]
    ds_read_b128 v[64:67], v1 offset:21504
    buffer_load_dword v136, v4, s[16:19], s45 offen sc1
    v_mfma_f32_16x16x32_bf16 v[16:19], a[68:71], v[44:47], v[16:19]
    s_waitcnt lgkmcnt(2)
    v_mfma_f32_16x16x32_bf16 v[12:15], a[72:75], v[52:55], v[12:15]
    ds_read_b128 v[68:71], v1 offset:22528
    v_mfma_f32_16x16x32_bf16 v[20:23], a[72:75], v[56:59], v[20:23]
    v_mfma_f32_16x16x32_bf16 v[24:27], a[76:79], v[56:59], v[24:27]
    ds_read_b128 v[72:75], v1 offset:23552
    v_mfma_f32_16x16x32_bf16 v[16:19], a[76:79], v[52:55], v[16:19]
    s_waitcnt lgkmcnt(2)
    v_mfma_f32_16x16x32_bf16 v[12:15], a[80:83], v[60:63], v[12:15]
    s_waitcnt vmcnt(12)
    ds_read_b128 v[44:47], v1 offset:24576
    s_barrier
    v_mfma_f32_16x16x32_bf16 v[20:23], a[80:83], v[64:67], v[20:23]
    buffer_store_dword v124, v124, s[16:19], s91 offen sc1
    v_mfma_f32_16x16x32_bf16 v[24:27], a[84:87], v[64:67], v[24:27]
    s_add_u32 s91, s91, 65536
    ds_read_b128 v[48:51], v1 offset:25600
    v_mfma_f32_16x16x32_bf16 v[16:19], a[84:87], v[60:63], v[16:19]
    s_waitcnt lgkmcnt(2)
    v_mfma_f32_16x16x32_bf16 v[12:15], a[88:91], v[68:71], v[12:15]
    ds_read_b128 v[52:55], v1 offset:26624
    v_mfma_f32_16x16x32_bf16 v[20:23], a[88:91], v[72:75], v[20:23]
    v_mfma_f32_16x16x32_bf16 v[24:27], a[92:95], v[72:75], v[24:27]
    ds_read_b128 v[56:59], v1 offset:27648
    v_mfma_f32_16x16x32_bf16 v[16:19], a[92:95], v[68:71], v[16:19]
    s_waitcnt lgkmcnt(2)
    v_mfma_f32_16x16x32_bf16 v[12:15], a[96:99], v[44:47], v[12:15]
    ds_read_b128 v[60:63], v1 offset:28672
    v_mfma_f32_16x16x32_bf16 v[20:23], a[96:99], v[48:51], v[20:23]
    v_mfma_f32_16x16x32_bf16 v[24:27], a[100:103], v[48:51], v[24:27]
    ds_read_b128 v[64:67], v1 offset:29696
    v_mfma_f32_16x16x32_bf16 v[16:19], a[100:103], v[44:47], v[16:19]
    s_waitcnt lgkmcnt(2)
    v_mfma_f32_16x16x32_bf16 v[12:15], a[104:107], v[52:55], v[12:15]
    ds_read_b128 v[68:71], v1 offset:30720
    v_mfma_f32_16x16x32_bf16 v[20:23], a[104:107], v[56:59], v[20:23]
    v_mfma_f32_16x16x32_bf16 v[24:27], a[108:111], v[56:59], v[24:27]
    ds_read_b128 v[72:75], v1 offset:31744
    v_mfma_f32_16x16x32_bf16 v[16:19], a[108:111], v[52:55], v[16:19]
    s_waitcnt vmcnt(9) lgkmcnt(2)
    s_barrier
    v_mfma_f32_16x16x32_bf16 v[12:15], a[112:115], v[60:63], v[12:15]
    ds_read_b128 v[44:47], v1 offset:32768
    v_mfma_f32_16x16x32_bf16 v[20:23], a[112:115], v[64:67], v[20:23]
    v_mfma_f32_16x16x32_bf16 v[24:27], a[116:119], v[64:67], v[24:27]
    ds_read_b128 v[48:51], v1 offset:33792
    v_mfma_f32_16x16x32_bf16 v[16:19], a[116:119], v[60:63], v[16:19]
    s_waitcnt lgkmcnt(2)
    v_mfma_f32_16x16x32_bf16 v[12:15], a[120:123], v[68:71], v[12:15]
    ds_read_b128 v[52:55], v1 offset:34816
    v_mfma_f32_16x16x32_bf16 v[20:23], a[120:123], v[72:75], v[20:23]
    v_mfma_f32_16x16x32_bf16 v[24:27], a[124:127], v[72:75], v[24:27]
    ds_read_b128 v[56:59], v1 offset:35840
    v_mfma_f32_16x16x32_bf16 v[16:19], a[124:127], v[68:71], v[16:19]
    s_waitcnt lgkmcnt(2)
    v_mfma_f32_16x16x32_bf16 v[12:15], a[128:131], v[44:47], v[12:15]
    ds_read_b128 v[60:63], v1 offset:36864
    v_mfma_f32_16x16x32_bf16 v[20:23], a[128:131], v[48:51], v[20:23]
    v_mfma_f32_16x16x32_bf16 v[24:27], a[132:135], v[48:51], v[24:27]
    ds_read_b128 v[64:67], v1 offset:37888
    v_mfma_f32_16x16x32_bf16 v[16:19], a[132:135], v[44:47], v[16:19]
    s_waitcnt lgkmcnt(2)
    v_mfma_f32_16x16x32_bf16 v[12:15], a[136:139], v[52:55], v[12:15]
    ds_read_b128 v[68:71], v1 offset:38912
    v_mfma_f32_16x16x32_bf16 v[20:23], a[136:139], v[56:59], v[20:23]
    v_mfma_f32_16x16x32_bf16 v[24:27], a[140:143], v[56:59], v[24:27]
    ds_read_b128 v[72:75], v1 offset:39936
    v_mfma_f32_16x16x32_bf16 v[16:19], a[140:143], v[52:55], v[16:19]
    s_waitcnt lgkmcnt(2)
    v_mfma_f32_16x16x32_bf16 v[12:15], a[144:147], v[60:63], v[12:15]
    ds_read_b128 v[44:47], v1 offset:40960
    v_mfma_f32_16x16x32_bf16 v[20:23], a[144:147], v[64:67], v[20:23]
    v_mfma_f32_16x16x32_bf16 v[24:27], a[148:151], v[64:67], v[24:27]
    ds_read_b128 v[48:51], v1 offset:41984
    v_mfma_f32_16x16x32_bf16 v[16:19], a[148:151], v[60:63], v[16:19]
    s_waitcnt lgkmcnt(2)
    v_mfma_f32_16x16x32_bf16 v[12:15], a[152:155], v[68:71], v[12:15]
    ds_read_b128 v[52:55], v1 offset:43008
    v_mfma_f32_16x16x32_bf16 v[20:23], a[152:155], v[72:75], v[20:23]
    v_mfma_f32_16x16x32_bf16 v[24:27], a[156:159], v[72:75], v[24:27]
    ds_read_b128 v[56:59], v1 offset:44032
    v_mfma_f32_16x16x32_bf16 v[16:19], a[156:159], v[68:71], v[16:19]
    s_waitcnt lgkmcnt(2)
    v_mfma_f32_16x16x32_bf16 v[12:15], a[160:163], v[44:47], v[12:15]
    ds_read_b128 v[60:63], v1 offset:45056
    v_mfma_f32_16x16x32_bf16 v[20:23], a[160:163], v[48:51], v[20:23]
    v_mfma_f32_16x16x32_bf16 v[24:27], a[164:167], v[48:51], v[24:27]
    ds_read_b128 v[64:67], v1 offset:46080
    v_mfma_f32_16x16x32_bf16 v[16:19], a[164:167], v[44:47], v[16:19]
    s_waitcnt lgkmcnt(2)
    v_mfma_f32_16x16x32_bf16 v[12:15], a[168:171], v[52:55], v[12:15]
    ds_read_b128 v[68:71], v1 offset:47104
    v_mfma_f32_16x16x32_bf16 v[20:23], a[168:171], v[56:59], v[20:23]
    v_mfma_f32_16x16x32_bf16 v[24:27], a[172:175], v[56:59], v[24:27]
    ds_read_b128 v[72:75], v1 offset:48128
    v_mfma_f32_16x16x32_bf16 v[16:19], a[172:175], v[52:55], v[16:19]
    s_waitcnt vmcnt(4) lgkmcnt(2)
    s_barrier
    v_mfma_f32_16x16x32_bf16 v[12:15], a[176:179], v[60:63], v[12:15]
    ds_read_b128 v[44:47], v1 offset:49152
    v_mfma_f32_16x16x32_bf16 v[20:23], a[176:179], v[64:67], v[20:23]
    v_mfma_f32_16x16x32_bf16 v[24:27], a[180:183], v[64:67], v[24:27]
    ds_read_b128 v[48:51], v1 offset:50176
    v_mfma_f32_16x16x32_bf16 v[16:19], a[180:183], v[60:63], v[16:19]
    s_waitcnt lgkmcnt(2)
    v_mfma_f32_16x16x32_bf16 v[12:15], a[184:187], v[68:71], v[12:15]
    s_waitcnt vmcnt(1)
    ds_read_b128 v[52:55], v1 offset:51200
    v_cmp_ne_u32 vcc, 0, v136
    v_mfma_f32_16x16x32_bf16 v[20:23], a[184:187], v[72:75], v[20:23]
    v_mfma_f32_16x16x32_bf16 v[24:27], a[188:191], v[72:75], v[24:27]
    s_cbranch_vccnz L_spin40
L_back41:
    ds_read_b128 v[56:59], v1 offset:52224
    s_barrier
    v_mfma_f32_16x16x32_bf16 v[16:19], a[188:191], v[68:71], v[16:19]
    s_waitcnt lgkmcnt(2)
    s_add_u32 s45, s45, 65536
    buffer_load_dwordx4 v1, s[16:19], s42 offen offset:0 sc1 lds
    v_mfma_f32_16x16x32_bf16 v[12:15], a[192:195], v[44:47], v[12:15]
    s_waitcnt vmcnt(3)
    ds_read_b128 v[60:63], v1 offset:53248
    v_mfma_f32_16x16x32_bf16 v[28:31], v[108:111], v[128:131], 0
    v_mfma_f32_16x16x32_bf16 v[32:35], v[112:115], v[128:131], 0
    v_mfma_f32_16x16x32_bf16 v[36:39], v[108:111], v[132:135], 0
    v_mfma_f32_16x16x32_bf16 v[40:43], v[112:115], v[132:135], 0
    v_mfma_f32_16x16x32_bf16 v[20:23], a[192:195], v[48:51], v[20:23]
    v_mfma_f32_16x16x32_bf16 v[24:27], a[196:199], v[48:51], v[24:27]
    ds_read_b128 v[64:67], v1 offset:54272
    v_mfma_f32_16x16x32_bf16 v[16:19], a[196:199], v[44:47], v[16:19]
    s_waitcnt lgkmcnt(2)
    buffer_load_dwordx4 v1, s[16:19], s42 offen offset:1024 sc1 lds
    v_mfma_f32_16x16x32_bf16 v[12:15], a[200:203], v[52:55], v[12:15]
    ds_read_b128 v[68:71], v1 offset:55296
    v_mfma_f32_16x16x32_bf16 v[20:23], a[200:203], v[56:59], v[20:23]
    v_mfma_f32_16x16x32_bf16 v[24:27], a[204:207], v[56:59], v[24:27]
    ds_read_b128 v[72:75], v1 offset:56320
    v_mfma_f32_16x16x32_bf16 v[16:19], a[204:207], v[52:55], v[16:19]
    s_waitcnt lgkmcnt(2)
    buffer_load_dwordx4 v1, s[16:19], s42 offen offset:2048 sc1 lds
    v_mfma_f32_16x16x32_bf16 v[12:15], a[208:211], v[60:63], v[12:15]
    ds_read_b128 v[44:47], v1 offset:57344
    v_mfma_f32_16x16x32_bf16 v[20:23], a[208:211], v[64:67], v[20:23]
    v_mfma_f32_16x16x32_bf16 v[24:27], a[212:215], v[64:67], v[24:27]
    ds_read_b128 v[48:51], v1 offset:58368
    v_mfma_f32_16x16x32_bf16 v[16:19], a[212:215], v[60:63], v[16:19]
    s_waitcnt lgkmcnt(2)
    buffer_load_dwordx4 v1, s[16:19], s42 offen offset:3072 sc1 lds
    v_mfma_f32_16x16x32_bf16 v[12:15], a[216:219], v[68:71], v[12:15]
    s_add_u32 m0, s43, 114688
    ds_read_b128 v[52:55], v1 offset:59392
    s_add_u32 s42, s41, 16384
    v_mfma_f32_16x16x32_bf16 v[20:23], a[216:219], v[72:75], v[20:23]
    v_mfma_f32_16x16x32_bf16 v[24:27], a[220:223], v[72:75], v[24:27]
    ds_read_b128 v[56:59], v1 offset:60416
    v_mfma_f32_16x16x32_bf16 v[16:19], a[220:223], v[68:71], v[16:19]
    s_waitcnt lgkmcnt(2)
    buffer_load_dwordx4 v1, s[16:19], s42 offen offset:0 sc1 lds
    v_mfma_f32_16x16x32_bf16 v[12:15], a[224:227], v[44:47], v[12:15]
    ds_read_b128 v[60:63], v1 offset:61440
    v_mfma_f32_16x16x32_bf16 v[20:23], a[224:227], v[48:51], v[20:23]
    v_mfma_f32_16x16x32_bf16 v[24:27], a[228:231], v[48:51], v[24:27]
    ds_read_b128 v[64:67], v1 offset:62464
    v_mfma_f32_16x16x32_bf16 v[16:19], a[228:231], v[44:47], v[16:19]
    s_waitcnt lgkmcnt(2)
    buffer_load_dwordx4 v1, s[16:19], s42 offen offset:1024 sc1 lds
    v_mfma_f32_16x16x32_bf16 v[12:15], a[232:235], v[52:55], v[12:15]
    ds_read_b128 v[68:71], v1 offset:63488
    v_mfma_f32_16x16x32_bf16 v[20:23], a[232:235], v[56:59], v[20:23]
    v_mfma_f32_16x16x32_bf16 v[24:27], a[236:239], v[56:59], v[24:27]
    ds_read_b128 v[72:75], v1 offset:64512
    v_mfma_f32_16x16x32_bf16 v[16:19], a[236:239], v[52:55], v[16:19]
    s_waitcnt lgkmcnt(2)
    buffer_load_dwordx4 v1, s[16:19], s42 offen offset:2048 sc1 lds
    v_mfma_f32_16x16x32_bf16 v[12:15], a[240:243], v[60:63], v[12:15]
    v_mfma_f32_16x16x32_bf16 v[20:23], a[240:243], v[64:67], v[20:23]
    v_mfma_f32_16x16x32_bf16 v[24:27], a[244:247], v[64:67], v[24:27]
    v_mfma_f32_16x16x32_bf16 v[16:19], a[244:247], v[60:63], v[16:19]
    s_waitcnt lgkmcnt(0)
    buffer_load_dwordx4 v1, s[16:19], s42 offen offset:3072 sc1 lds
    v_mfma_f32_16x16x32_bf16 v[12:15], a[248:251], v[68:71], v[12:15]
    v_mfma_f32_16x16x32_bf16 v[20:23], a[248:251], v[72:75], v[20:23]
    v_mfma_f32_16x16x32_bf16 v[24:27], a[252:255], v[72:75], v[24:27]
    v_mfma_f32_16x16x32_bf16 v[16:19], a[252:255], v[68:71], v[16:19]
    s_nop 1
    v_cvt_pk_bf16_f32 v148, v12, v13
    v_cvt_pk_bf16_f32 v149, v14, v15
    s_nop 3
    v_cvt_pk_bf16_f32 v150, v16, v17
    v_cvt_pk_bf16_f32 v151, v18, v19
    buffer_store_dwordx4 v[148:151], v1, s[16:19], s44 offen offset:0 sc1
    v_cvt_pk_bf16_f32 v152, v20, v21
    v_cvt_pk_bf16_f32 v153, v22, v23
    v_cvt_pk_bf16_f32 v154, v24, v25
    v_cvt_pk_bf16_f32 v155, v26, v27
    buffer_store_dwordx4 v[152:155], v1, s[16:19], s44 offen offset:1024 sc1
    s_add_u32 m0, s43, 131072
    s_add_u32 s42, s41, 32768
    v_add_f32 v140, v12, v13
    v_add_f32 v144, v20, v21
    v_mul_f32 v141, v12, v12
    v_mul_f32 v145, v20, v20
    buffer_load_dwordx4 v1, s[16:19], s42 offen offset:0 sc1 lds
    v_fmac_f32 v141, v13, v13
    v_fmac_f32 v145, v21, v21
    v_add_f32 v140, v140, v14
    v_add_f32 v144, v144, v22
    v_fmac_f32 v141, v14, v14
    v_fmac_f32 v145, v22, v22
    v_add_f32 v140, v140, v15
    v_add_f32 v144, v144, v23
    buffer_load_dwordx4 v1, s[16:19], s42 offen offset:1024 sc1 lds
    v_fmac_f32 v141, v15, v15
    v_fmac_f32 v145, v23, v23
    v_add_f32 v140, v140, v16
    v_add_f32 v144, v144, v24
    v_fmac_f32 v141, v16, v16
    v_fmac_f32 v145, v24, v24
    v_add_f32 v140, v140, v17
    v_add_f32 v144, v144, v25
    buffer_load_dwordx4 v1, s[16:19], s42 offen offset:2048 sc1 lds
    v_fmac_f32 v141, v17, v17
    v_fmac_f32 v145, v25, v25
    v_add_f32 v140, v140, v18
    v_add_f32 v144, v144, v26
    v_fmac_f32 v141, v18, v18
    v_fmac_f32 v145, v26, v26
    v_add_f32 v140, v140, v19
    v_add_f32 v144, v144, v27
    buffer_load_dwordx4 v1, s[16:19], s42 offen offset:3072 sc1 lds
    v_fmac_f32 v141, v19, v19
    v_fmac_f32 v145, v27, v27
    s_nop 0
    v_permlane16_swap_b32 v140, v141
    v_permlane16_swap_b32 v144, v145
    v_add_f32 v140, v140, v141
    v_add_f32 v144, v144, v145
    v_mov_b32 v142, v140
    v_mov_b32 v146, v144
    s_nop 0
    v_permlane32_swap_b32 v140, v142
    v_permlane32_swap_b32 v144, v146
    v_add_f32 v140, v140, v142
    v_add_f32 v144, v144, v146
    ds_write_b32 v6, v140 offset:0
    ds_write_b32 v6, v144 offset:512
    s_waitcnt vmcnt(10) lgkmcnt(0)
    s_barrier
    ds_read_b128 v[44:47], v2 offset:0
    ds_read_b128 v[48:51], v2 offset:1024
    ds_read_b128 v[52:55], v2 offset:2048
    ds_read_b128 v[56:59], v2 offset:3072
    s_add_u32 s36, s36, 1
L_o_b1:
    s_waitcnt lgkmcnt(2)
    v_mfma_f32_16x16x32_bf16 v[28:31], a[0:3], v[44:47], v[28:31]
    ds_read_b128 v[60:63], v2 offset:4096
    ds_read_b128 v[140:143], v7
    v_mfma_f32_16x16x32_bf16 v[36:39], a[0:3], v[48:51], v[36:39]
    s_cmp_eq_u32 s36, 0
    s_cselect_b32 s49, 0x5e00000, s46
    v_mfma_f32_16x16x32_bf16 v[40:43], a[4:7], v[48:51], v[40:43]
    ds_read_b128 v[64:67], v2 offset:5120
    v_mfma_f32_16x16x32_bf16 v[32:35], a[4:7], v[44:47], v[32:35]
    s_waitcnt lgkmcnt(3)
    v_mfma_f32_16x16x32_bf16 v[28:31], a[8:11], v[52:55], v[28:31]
    s_waitcnt lgkmcnt(1)
    ds_read_b128 v[68:71], v2 offset:6144
    v_add_f32 v140, v140, v141
    v_mfma_f32_16x16x32_bf16 v[36:39], a[8:11], v[56:59], v[36:39]
    v_add_f32 v142, v142, v143
    v_add_f32 v140, v140, v142
    v_mfma_f32_16x16x32_bf16 v[40:43], a[12:15], v[56:59], v[40:43]
    ds_read_b128 v[72:75], v2 offset:7168
    v_min_u32 v140, -2, v140
    v_mfma_f32_16x16x32_bf16 v[32:35], a[12:15], v[52:55], v[32:35]
    s_waitcnt lgkmcnt(2)
    buffer_store_dword v140, v8, s[16:19], s49 offen sc1
    v_mfma_f32_16x16x32_bf16 v[28:31], a[16:19], v[60:63], v[28:31]
    ds_read_b128 v[44:47], v2 offset:8192
    v_mfma_f32_16x16x32_bf16 v[36:39], a[16:19], v[64:67], v[36:39]
    v_mfma_f32_16x16x32_bf16 v[40:43], a[20:23], v[64:67], v[40:43]
    s_add_u32 m0, s43, 147456
    ds_read_b128 v[48:51], v2 offset:9216
    s_add_u32 s42, s41, 49152
    v_mfma_f32_16x16x32_bf16 v[32:35], a[20:23], v[60:63], v[32:35]
    s_waitcnt lgkmcnt(2)
    buffer_load_dwordx4 v1, s[16:19], s42 offen offset:0 sc1 lds
    v_mfma_f32_16x16x32_bf16 v[28:31], a[24:27], v[68:71], v[28:31]
    ds_read_b128 v[52:55], v2 offset:10240
    v_mfma_f32_16x16x32_bf16 v[36:39], a[24:27], v[72:75], v[36:39]
    v_mfma_f32_16x16x32_bf16 v[40:43], a[28:31], v[72:75], v[40:43]
    ds_read_b128 v[56:59], v2 offset:11264
    buffer_load_dwordx4 v1, s[16:19], s42 offen offset:1024 sc1 lds
    v_mfma_f32_16x16x32_bf16 v[32:35], a[28:31], v[68:71], v[32:35]
    s_waitcnt lgkmcnt(2)
    v_mfma_f32_16x16x32_bf16 v[28:31], a[32:35], v[44:47], v[28:31]
    ds_read_b128 v[60:63], v2 offset:12288
    v_mfma_f32_16x16x32_bf16 v[36:39], a[32:35], v[48:51], v[36:39]
    buffer_load_dwordx4 v1, s[16:19], s42 offen offset:2048 sc1 lds
    v_mfma_f32_16x16x32_bf16 v[40:43], a[36:39], v[48:51], v[40:43]
    ds_read_b128 v[64:67], v2 offset:13312
    v_mfma_f32_16x16x32_bf16 v[32:35], a[36:39], v[44:47], v[32:35]
    s_waitcnt lgkmcnt(2)
    v_mfma_f32_16x16x32_bf16 v[28:31], a[40:43], v[52:55], v[28:31]
    ds_read_b128 v[68:71], v2 offset:14336
    buffer_load_dwordx4 v1, s[16:19], s42 offen offset:3072 sc1 lds
    v_mfma_f32_16x16x32_bf16 v[36:39], a[40:43], v[56:59], v[36:39]
    s_add_u32 s98, s98, 65536
    s_min_i32 s98, s98, s96
    s_and_b32 s41, s98, 0xffffffff
    v_mfma_f32_16x16x32_bf16 v[40:43], a[44:47], v[56:59], v[40:43]
    s_add_u32 m0, s43, 0
    ds_read_b128 v[72:75], v2 offset:15360
    s_add_u32 s42, s41, 0
    v_mfma_f32_16x16x32_bf16 v[32:35], a[44:47], v[52:55], v[32:35]
    s_waitcnt vmcnt(11) lgkmcnt(2)
    s_barrier
    v_mfma_f32_16x16x32_bf16 v[28:31], a[48:51], v[60:63], v[28:31]
    ds_read_b128 v[44:47], v2 offset:16384
    v_mfma_f32_16x16x32_bf16 v[36:39], a[48:51], v[64:67], v[36:39]
    v_mfma_f32_16x16x32_bf16 v[40:43], a[52:55], v[64:67], v[40:43]
    s_add_u32 s47, s36, 1
    ds_read_b128 v[48:51], v2 offset:17408
    s_min_i32 s47, s47, 31
    v_mfma_f32_16x16x32_bf16 v[32:35], a[52:55], v[60:63], v[32:35]
    s_waitcnt lgkmcnt(2)
    s_max_i32 s47, s47, 0
    s_cmp_ge_u32 s47, 16
    v_mfma_f32_16x16x32_bf16 v[28:31], a[56:59], v[68:71], v[28:31]
    s_cselect_b32 s8, s88, s64
    ds_read_b128 v[52:55], v2 offset:18432
    s_cselect_b32 s9, s89, s65
    v_mfma_f32_16x16x32_bf16 v[36:39], a[56:59], v[72:75], v[36:39]
    s_and_b32 s47, s47, 15
    s_lshl_b32 s47, s47, 16
    s_sub_u32 s47, s50, s47
    v_mfma_f32_16x16x32_bf16 v[40:43], a[60:63], v[72:75], v[40:43]
    s_add_u32 s48, s47, 32768
    ds_read_b128 v[56:59], v2 offset:19456
    buffer_load_dwordx4 v[128:131], v3, s[8:11], s48 offen sc1
    v_mfma_f32_16x16x32_bf16 v[32:35], a[60:63], v[68:71], v[32:35]
    s_waitcnt lgkmcnt(2)
    buffer_load_dwordx4 v[132:135], v3, s[8:11], s47 offen sc1
    v_mfma_f32_16x16x32_bf16 v[28:31], a[64:67], v[44:47], v[28:31]
    s_add_u32 s90, s90, 65536
    ds_read_b128 v[60:63], v2 offset:20480
    s_add_u32 s46, s46, 2048
    v_mfma_f32_16x16x32_bf16 v[36:39], a[64:67], v[48:51], v[36:39]
    s_and_b32 s44, s90, 0xffffffff
    v_mfma_f32_16x16x32_bf16 v[40:43], a[68:71], v[48:51], v[40:43]
    ds_read_b128 v[64:67], v2 offset:21504
    buffer_load_dword v136, v4, s[16:19], s45 offen sc1
    v_mfma_f32_16x16x32_bf16 v[32:35], a[68:71], v[44:47], v[32:35]
    s_waitcnt lgkmcnt(2)
    v_mfma_f32_16x16x32_bf16 v[28:31], a[72:75], v[52:55], v[28:31]
    ds_read_b128 v[68:71], v2 offset:22528
    v_mfma_f32_16x16x32_bf16 v[36:39], a[72:75], v[56:59], v[36:39]
    v_mfma_f32_16x16x32_bf16 v[40:43], a[76:79], v[56:59], v[40:43]
    ds_read_b128 v[72:75], v2 offset:23552
    v_mfma_f32_16x16x32_bf16 v[32:35], a[76:79], v[52:55], v[32:35]
    s_waitcnt lgkmcnt(2)
    v_mfma_f32_16x16x32_bf16 v[28:31], a[80:83], v[60:63], v[28:31]
    s_waitcnt vmcnt(12)
    ds_read_b128 v[44:47], v2 offset:24576
    s_barrier
    v_mfma_f32_16x16x32_bf16 v[36:39], a[80:83], v[64:67], v[36:39]
    buffer_store_dword v124, v124, s[16:19], s91 offen sc1
    v_mfma_f32_16x16x32_bf16 v[40:43], a[84:87], v[64:67], v[40:43]
    s_add_u32 s91, s91, 65536
    ds_read_b128 v[48:51], v2 offset:25600
    v_mfma_f32_16x16x32_bf16 v[32:35], a[84:87], v[60:63], v[32:35]
    s_waitcnt lgkmcnt(2)
    v_mfma_f32_16x16x32_bf16 v[28:31], a[88:91], v[68:71], v[28:31]
    ds_read_b128 v[52:55], v2 offset:26624
    v_mfma_f32_16x16x32_bf16 v[36:39], a[88:91], v[72:75], v[36:39]
    v_mfma_f32_16x16x32_bf16 v[40:43], a[92:95], v[72:75], v[40:43]
    ds_read_b128 v[56:59], v2 offset:27648
    v_mfma_f32_16x16x32_bf16 v[32:35], a[92:95], v[68:71], v[32:35]
    s_waitcnt lgkmcnt(2)
    v_mfma_f32_16x16x32_bf16 v[28:31], a[96:99], v[44:47], v[28:31]
    ds_read_b128 v[60:63], v2 offset:28672
    v_mfma_f32_16x16x32_bf16 v[36:39], a[96:99], v[48:51], v[36:39]
    v_mfma_f32_16x16x32_bf16 v[40:43], a[100:103], v[48:51], v[40:43]
    ds_read_b128 v[64:67], v2 offset:29696
    v_mfma_f32_16x16x32_bf16 v[32:35], a[100:103], v[44:47], v[32:35]
    s_waitcnt lgkmcnt(2)
    v_mfma_f32_16x16x32_bf16 v[28:31], a[104:107], v[52:55], v[28:31]
    ds_read_b128 v[68:71], v2 offset:30720
    v_mfma_f32_16x16x32_bf16 v[36:39], a[104:107], v[56:59], v[36:39]
    v_mfma_f32_16x16x32_bf16 v[40:43], a[108:111], v[56:59], v[40:43]
    ds_read_b128 v[72:75], v2 offset:31744
    v_mfma_f32_16x16x32_bf16 v[32:35], a[108:111], v[52:55], v[32:35]
    s_waitcnt vmcnt(9) lgkmcnt(2)
    s_barrier
    v_mfma_f32_16x16x32_bf16 v[28:31], a[112:115], v[60:63], v[28:31]
    ds_read_b128 v[44:47], v2 offset:32768
    v_mfma_f32_16x16x32_bf16 v[36:39], a[112:115], v[64:67], v[36:39]
    v_mfma_f32_16x16x32_bf16 v[40:43], a[116:119], v[64:67], v[40:43]
    ds_read_b128 v[48:51], v2 offset:33792
    v_mfma_f32_16x16x32_bf16 v[32:35], a[116:119], v[60:63], v[32:35]
    s_waitcnt lgkmcnt(2)
    v_mfma_f32_16x16x32_bf16 v[28:31], a[120:123], v[68:71], v[28:31]
    ds_read_b128 v[52:55], v2 offset:34816
    v_mfma_f32_16x16x32_bf16 v[36:39], a[120:123], v[72:75], v[36:39]
    v_mfma_f32_16x16x32_bf16 v[40:43], a[124:127], v[72:75], v[40:43]
    ds_read_b128 v[56:59], v2 offset:35840
    v_mfma_f32_16x16x32_bf16 v[32:35], a[124:127], v[68:71], v[32:35]
    s_waitcnt lgkmcnt(2)
    v_mfma_f32_16x16x32_bf16 v[28:31], a[128:131], v[44:47], v[28:31]
    ds_read_b128 v[60:63], v2 offset:36864
    v_mfma_f32_16x16x32_bf16 v[36:39], a[128:131], v[48:51], v[36:39]
    v_mfma_f32_16x16x32_bf16 v[40:43], a[132:135], v[48:51], v[40:43]
    ds_read_b128 v[64:67], v2 offset:37888
    v_mfma_f32_16x16x32_bf16 v[32:35], a[132:135], v[44:47], v[32:35]
    s_waitcnt lgkmcnt(2)
    v_mfma_f32_16x16x32_bf16 v[28:31], a[136:139], v[52:55], v[28:31]
    ds_read_b128 v[68:71], v2 offset:38912
    v_mfma_f32_16x16x32_bf16 v[36:39], a[136:139], v[56:59], v[36:39]
    v_mfma_f32_16x16x32_bf16 v[40:43], a[140:143], v[56:59], v[40:43]
    ds_read_b128 v[72:75], v2 offset:39936
    v_mfma_f32_16x16x32_bf16 v[32:35], a[140:143], v[52:55], v[32:35]
    s_waitcnt lgkmcnt(2)
    v_mfma_f32_16x16x32_bf16 v[28:31], a[144:147], v[60:63], v[28:31]
    ds_read_b128 v[44:47], v2 offset:40960
    v_mfma_f32_16x16x32_bf16 v[36:39], a[144:147], v[64:67], v[36:39]
    v_mfma_f32_16x16x32_bf16 v[40:43], a[148:151], v[64:67], v[40:43]
    ds_read_b128 v[48:51], v2 offset:41984
    v_mfma_f32_16x16x32_bf16 v[32:35], a[148:151], v[60:63], v[32:35]
    s_waitcnt lgkmcnt(2)
    v_mfma_f32_16x16x32_bf16 v[28:31], a[152:155], v[68:71], v[28:31]
    ds_read_b128 v[52:55], v2 offset:43008
    v_mfma_f32_16x16x32_bf16 v[36:39], a[152:155], v[72:75], v[36:39]
    v_mfma_f32_16x16x32_bf16 v[40:43], a[156:159], v[72:75], v[40:43]
    ds_read_b128 v[56:59], v2 offset:44032
    v_mfma_f32_16x16x32_bf16 v[32:35], a[156:159], v[68:71], v[32:35]
    s_waitcnt lgkmcnt(2)
    v_mfma_f32_16x16x32_bf16 v[28:31], a[160:163], v[44:47], v[28:31]
    ds_read_b128 v[60:63], v2 offset:45056
    v_mfma_f32_16x16x32_bf16 v[36:39], a[160:163], v[48:51], v[36:39]
    v_mfma_f32_16x16x32_bf16 v[40:43], a[164:167], v[48:51], v[40:43]
    ds_read_b128 v[64:67], v2 offset:46080
    v_mfma_f32_16x16x32_bf16 v[32:35], a[164:167], v[44:47], v[32:35]
    s_waitcnt lgkmcnt(2)
    v_mfma_f32_16x16x32_bf16 v[28:31], a[168:171], v[52:55], v[28:31]
    ds_read_b128 v[68:71], v2 offset:47104
    v_mfma_f32_16x16x32_bf16 v[36:39], a[168:171], v[56:59], v[36:39]
    v_mfma_f32_16x16x32_bf16 v[40:43], a[172:175], v[56:59], v[40:43]
    ds_read_b128 v[72:75], v2 offset:48128
    v_mfma_f32_16x16x32_bf16 v[32:35], a[172:175], v[52:55], v[32:35]
    s_waitcnt vmcnt(4) lgkmcnt(2)
    s_barrier
    v_mfma_f32_16x16x32_bf16 v[28:31], a[176:179], v[60:63], v[28:31]
    ds_read_b128 v[44:47], v2 offset:49152
    v_mfma_f32_16x16x32_bf16 v[36:39], a[176:179], v[64:67], v[36:39]
    v_mfma_f32_16x16x32_bf16 v[40:43], a[180:183], v[64:67], v[40:43]
    ds_read_b128 v[48:51], v2 offset:50176
    v_mfma_f32_16x16x32_bf16 v[32:35], a[180:183], v[60:63], v[32:35]
    s_waitcnt lgkmcnt(2)
    v_mfma_f32_16x16x32_bf16 v[28:31], a[184:187], v[68:71], v[28:31]
    s_waitcnt vmcnt(1)
    ds_read_b128 v[52:55], v2 offset:51200
    v_cmp_ne_u32 vcc, 0, v136
    v_mfma_f32_16x16x32_bf16 v[36:39], a[184:187], v[72:75], v[36:39]
    v_mfma_f32_16x16x32_bf16 v[40:43], a[188:191], v[72:75], v[40:43]
    s_cbranch_vccnz L_spin42
L_back43:
    ds_read_b128 v[56:59], v2 offset:52224
    s_barrier
    v_mfma_f32_16x16x32_bf16 v[32:35], a[188:191], v[68:71], v[32:35]
    s_waitcnt lgkmcnt(2)
    s_add_u32 s45, s45, 65536
    buffer_load_dwordx4 v1, s[16:19], s42 offen offset:0 sc1 lds
    v_mfma_f32_16x16x32_bf16 v[28:31], a[192:195], v[44:47], v[28:31]
    s_waitcnt vmcnt(3)
    ds_read_b128 v[60:63], v2 offset:53248
    v_mfma_f32_16x16x32_bf16 v[12:15], v[108:111], v[128:131], 0
    v_mfma_f32_16x16x32_bf16 v[16:19], v[112:115], v[128:131], 0
    v_mfma_f32_16x16x32_bf16 v[20:23], v[108:111], v[132:135], 0
    v_mfma_f32_16x16x32_bf16 v[24:27], v[112:115], v[132:135], 0
    v_mfma_f32_16x16x32_bf16 v[36:39], a[192:195], v[48:51], v[36:39]
    v_mfma_f32_16x16x32_bf16 v[40:43], a[196:199], v[48:51], v[40:43]
    ds_read_b128 v[64:67], v2 offset:54272
    v_mfma_f32_16x16x32_bf16 v[32:35], a[196:199], v[44:47], v[32:35]
    s_waitcnt lgkmcnt(2)
    buffer_load_dwordx4 v1, s[16:19], s42 offen offset:1024 sc1 lds
    v_mfma_f32_16x16x32_bf16 v[28:31], a[200:203], v[52:55], v[28:31]
    ds_read_b128 v[68:71], v2 offset:55296
    v_mfma_f32_16x16x32_bf16 v[36:39], a[200:203], v[56:59], v[36:39]
    v_mfma_f32_16x16x32_bf16 v[40:43], a[204:207], v[56:59], v[40:43]
    ds_read_b128 v[72:75], v2 offset:56320
    v_mfma_f32_16x16x32_bf16 v[32:35], a[204:207], v[52:55], v[32:35]
    s_waitcnt lgkmcnt(2)
    buffer_load_dwordx4 v1, s[16:19], s42 offen offset:2048 sc1 lds
    v_mfma_f32_16x16x32_bf16 v[28:31], a[208:211], v[60:63], v[28:31]
    ds_read_b128 v[44:47], v2 offset:57344
    v_mfma_f32_16x16x32_bf16 v[36:39], a[208:211], v[64:67], v[36:39]
    v_mfma_f32_16x16x32_bf16 v[40:43], a[212:215], v[64:67], v[40:43]
    ds_read_b128 v[48:51], v2 offset:58368
    v_mfma_f32_16x16x32_bf16 v[32:35], a[212:215], v[60:63], v[32:35]
    s_waitcnt lgkmcnt(2)
    buffer_load_dwordx4 v1, s[16:19], s42 offen offset:3072 sc1 lds
    v_mfma_f32_16x16x32_bf16 v[28:31], a[216:219], v[68:71], v[28:31]
    s_add_u32 m0, s43, 16384
    ds_read_b128 v[52:55], v2 offset:59392
    s_add_u32 s42, s41, 16384
    v_mfma_f32_16x16x32_bf16 v[36:39], a[216:219], v[72:75], v[36:39]
    v_mfma_f32_16x16x32_bf16 v[40:43], a[220:223], v[72:75], v[40:43]
    ds_read_b128 v[56:59], v2 offset:60416
    v_mfma_f32_16x16x32_bf16 v[32:35], a[220:223], v[68:71], v[32:35]
    s_waitcnt lgkmcnt(2)
    buffer_load_dwordx4 v1, s[16:19], s42 offen offset:0 sc1 lds
    v_mfma_f32_16x16x32_bf16 v[28:31], a[224:227], v[44:47], v[28:31]
    ds_read_b128 v[60:63], v2 offset:61440
    v_mfma_f32_16x16x32_bf16 v[36:39], a[224:227], v[48:51], v[36:39]
    v_mfma_f32_16x16x32_bf16 v[40:43], a[228:231], v[48:51], v[40:43]
    ds_read_b128 v[64:67], v2 offset:62464
    v_mfma_f32_16x16x32_bf16 v[32:35], a[228:231], v[44:47], v[32:35]
    s_waitcnt lgkmcnt(2)
    buffer_load_dwordx4 v1, s[16:19], s42 offen offset:1024 sc1 lds
    v_mfma_f32_16x16x32_bf16 v[28:31], a[232:235], v[52:55], v[28:31]
    ds_read_b128 v[68:71], v2 offset:63488
    v_mfma_f32_16x16x32_bf16 v[36:39], a[232:235], v[56:59], v[36:39]
    v_mfma_f32_16x16x32_bf16 v[40:43], a[236:239], v[56:59], v[40:43]
    ds_read_b128 v[72:75], v2 offset:64512
    v_mfma_f32_16x16x32_bf16 v[32:35], a[236:239], v[52:55], v[32:35]
    s_waitcnt lgkmcnt(2)
    buffer_load_dwordx4 v1, s[16:19], s42 offen offset:2048 sc1 lds
    v_mfma_f32_16x16x32_bf16 v[28:31], a[240:243], v[60:63], v[28:31]
    v_mfma_f32_16x16x32_bf16 v[36:39], a[240:243], v[64:67], v[36:39]
    v_mfma_f32_16x16x32_bf16 v[40:43], a[244:247], v[64:67], v[40:43]
    v_mfma_f32_16x16x32_bf16 v[32:35], a[244:247], v[60:63], v[32:35]
    s_waitcnt lgkmcnt(0)
    buffer_load_dwordx4 v1, s[16:19], s42 offen offset:3072 sc1 lds
    v_mfma_f32_16x16x32_bf16 v[28:31], a[248:251], v[68:71], v[28:31]
    v_mfma_f32_16x16x32_bf16 v[36:39], a[248:251], v[72:75], v[36:39]
    v_mfma_f32_16x16x32_bf16 v[40:43], a[252:255], v[72:75], v[40:43]
    v_mfma_f32_16x16x32_bf16 v[32:35], a[252:255], v[68:71], v[32:35]
    s_nop 1
    v_cvt_pk_bf16_f32 v148, v28, v29
    v_cvt_pk_bf16_f32 v149, v30, v31
    s_nop 3
    v_cvt_pk_bf16_f32 v150, v32, v33
    v_cvt_pk_bf16_f32 v151, v34, v35
    buffer_store_dwordx4 v[148:151], v1, s[16:19], s44 offen offset:0 sc1
    v_cvt_pk_bf16_f32 v152, v36, v37
    v_cvt_pk_bf16_f32 v153, v38, v39
    v_cvt_pk_bf16_f32 v154, v40, v41
    v_cvt_pk_bf16_f32 v155, v42, v43
    buffer_store_dwordx4 v[152:155], v1, s[16:19], s44 offen offset:1024 sc1
    s_add_u32 m0, s43, 32768
    s_add_u32 s42, s41, 32768
    v_add_f32 v140, v28, v29
    v_add_f32 v144, v36, v37
    v_mul_f32 v141, v28, v28
    v_mul_f32 v145, v36, v36
    buffer_load_dwordx4 v1, s[16:19], s42 offen offset:0 sc1 lds
    v_fmac_f32 v141, v29, v29
    v_fmac_f32 v145, v37, v37
    v_add_f32 v140, v140, v30
    v_add_f32 v144, v144, v38
    v_fmac_f32 v141, v30, v30
    v_fmac_f32 v145, v38, v38
    v_add_f32 v140, v140, v31
    v_add_f32 v144, v144, v39
    buffer_load_dwordx4 v1, s[16:19], s42 offen offset:1024 sc1 lds
    v_fmac_f32 v141, v31, v31
    v_fmac_f32 v145, v39, v39
    v_add_f32 v140, v140, v32
    v_add_f32 v144, v144, v40
    v_fmac_f32 v141, v32, v32
    v_fmac_f32 v145, v40, v40
    v_add_f32 v140, v140, v33
    v_add_f32 v144, v144, v41
    buffer_load_dwordx4 v1, s[16:19], s42 offen offset:2048 sc1 lds
    v_fmac_f32 v141, v33, v33
    v_fmac_f32 v145, v41, v41
    v_add_f32 v140, v140, v34
    v_add_f32 v144, v144, v42
    v_fmac_f32 v141, v34, v34
    v_fmac_f32 v145, v42, v42
    v_add_f32 v140, v140, v35
    v_add_f32 v144, v144, v43
    buffer_load_dwordx4 v1, s[16:19], s42 offen offset:3072 sc1 lds
    v_fmac_f32 v141, v35, v35
    v_fmac_f32 v145, v43, v43
    s_nop 0
    v_permlane16_swap_b32 v140, v141
    v_permlane16_swap_b32 v144, v145
    v_add_f32 v140, v140, v141
    v_add_f32 v144, v144, v145
    v_mov_b32 v142, v140
    v_mov_b32 v146, v144
    s_nop 0
    v_permlane32_swap_b32 v140, v142
    v_permlane32_swap_b32 v144, v146
    v_add_f32 v140, v140, v142
    v_add_f32 v144, v144, v146
    ds_write_b32 v6, v140 offset:0
    ds_write_b32 v6, v144 offset:512
    s_waitcnt vmcnt(10) lgkmcnt(0)
    s_barrier
    ds_read_b128 v[44:47], v1 offset:0
    ds_read_b128 v[48:51], v1 offset:1024
    ds_read_b128 v[52:55], v1 offset:2048
    ds_read_b128 v[56:59], v1 offset:3072
    s_add_u32 s36, s36, 1
    s_cmp_lt_u32 s36, 32
    s_cbranch_scc1 L_o_b0
    s_nop 7
    ds_read_b128 v[140:143], v7
    s_cmp_eq_u32 s36, 0
    s_cselect_b32 s49, 0x5e00000, s46
    s_waitcnt lgkmcnt(0)
    v_add_f32 v140, v140, v141
    v_add_f32 v142, v142, v143
    v_add_f32 v140, v140, v142
    v_min_u32 v140, -2, v140
    buffer_store_dword v140, v8, s[16:19], s49 offen sc1
    s_waitcnt vmcnt(5)
    s_barrier
    buffer_store_dword v124, v124, s[16:19], s91 offen sc1
    s_add_u32 s91, s91, 65536
    s_waitcnt vmcnt(0)
    s_endpgm
L_vspin28:
    s_mov_b32 s40, 0x20000
L_vspin28_l:
    s_cmp_lg_u32 s37, 0
    s_cbranch_scc1 L_restart
    s_sleep 4
    buffer_load_dword v8, v124, s[20:23], 0 offen offset:32 sc1
    s_waitcnt vmcnt(0)
    v_readfirstlane_b32 s37, v8
    s_sub_u32 s40, s40, 1
    s_cbranch_scc1 L_vback29
    s_cmp_lg_u32 s37, s3
    s_cbranch_scc1 L_vspin28_l
    s_branch L_vback29
L_vspin30:
    s_mov_b32 s40, 0x20000
L_vspin30_l:
    s_cmp_lg_u32 s37, 0
    s_cbranch_scc1 L_restart
    s_sleep 4
    buffer_load_dword v8, v124, s[20:23], 0 offen offset:32 sc1
    s_waitcnt vmcnt(0)
    v_readfirstlane_b32 s37, v8
    s_sub_u32 s40, s40, 1
    s_cbranch_scc1 L_vback31
    s_cmp_lg_u32 s37, s3
    s_cbranch_scc1 L_vspin30_l
    s_branch L_vback31
L_vspin33:
    s_mov_b32 s40, 0x20000
L_vspin33_l:
    s_cmp_lg_u32 s37, 0
    s_cbranch_scc1 L_restart
    s_sleep 4
    buffer_load_dword v12, v124, s[20:23], 0 offen offset:32 sc1
    s_waitcnt vmcnt(0)
    v_readfirstlane_b32 s37, v12
    s_sub_u32 s40, s40, 1
    s_cbranch_scc1 L_vback34
    s_cmp_lg_u32 s37, s3
    s_cbranch_scc1 L_vspin33_l
    s_branch L_vback34
L_spin36:
    s_mov_b32 s40, 0x20000
L_spin36_l:
    buffer_load_dword v12, v124, s[20:23], 0 offen sc1
    s_sub_u32 s40, s40, 1
    s_waitcnt vmcnt(0)
    v_cmp_eq_u32 vcc, v124, v12
    s_cbranch_scc1 L_back37
    s_cbranch_vccz L_back37
    s_sleep 8
    s_branch L_spin36_l
L_spin38:
    s_mov_b32 s40, 0x20000
L_spin38_l:
    buffer_load_dword v136, v4, s[16:19], s45 offen sc1
    s_sub_u32 s40, s40, 1
    s_waitcnt vmcnt(0)
    v_cmp_ne_u32 vcc, 0, v136
    s_cbranch_scc1 L_back39
    s_cbranch_vccz L_back39
    s_sleep 2
    s_branch L_spin38_l
L_spin40:
    s_mov_b32 s40, 0x20000
L_spin40_l:
    buffer_load_dword v136, v4, s[16:19], s45 offen sc1
    s_sub_u32 s40, s40, 1
    s_waitcnt vmcnt(0)
    v_cmp_ne_u32 vcc, 0, v136
    s_cbranch_scc1 L_back41
    s_cbranch_vccz L_back41
    s_sleep 2
    s_branch L_spin40_l
L_spin42:
    s_mov_b32 s40, 0x20000
L_spin42_l:
    buffer_load_dword v136, v4, s[16:19], s45 offen sc1
    s_sub_u32 s40, s40, 1
    s_waitcnt vmcnt(0)
    v_cmp_ne_u32 vcc, 0, v136
    s_cbranch_scc1 L_back43
    s_cbranch_vccz L_back43
    s_sleep 2
    s_branch L_spin42_l
L_role_40:
    s_sub_u32 s35, s34, 40
    s_lshl_b32 s51, s35, 2
    s_add_u32 s51, s51, 96
    s_lshl_b32 s54, s51, 6
    s_mov_b32 s12, s72
    s_mov_b32 s13, s73
    s_mov_b32 s14, 0x700000
    s_mov_b32 s15, 0x00020000
    s_mov_b32 s39, 7168
    v_lshrrev_b32 v64, 3, v0
    v_lshlrev_b32 v65, 2, v0
    v_and_b32 v65, 64, v65
    v_and_b32 v66, 0x70, v1
    v_xor_b32 v65, v65, v66
    v_mad_u32_u24 v56, v64, s39, v65
    v_add_u32 v57, 57344, v56
    v_add_u32 v58, 128, v56
    v_add_u32 v59, 57472, v56
    s_mul_i32 s38, s32, 114688
    s_add_u32 s54, s54, s38
    s_lshl_b32 s42, s32, 11
    s_add_u32 m0, s42, 0
    s_nop 0
    buffer_load_dwordx4 v56, s[12:15], s54 offen lds
    s_add_u32 m0, s42, 1024
    s_nop 0
    buffer_load_dwordx4 v57, s[12:15], s54 offen lds
    s_add_u32 m0, s42, 8192
    s_nop 0
    buffer_load_dwordx4 v58, s[12:15], s54 offen lds
    s_add_u32 m0, s42, 9216
    s_nop 0
    buffer_load_dwordx4 v59, s[12:15], s54 offen lds
    s_add_u32 s54, s54, 458752
    s_add_u32 m0, s42, 16384
    s_nop 0
    buffer_load_dwordx4 v56, s[12:15], s54 offen lds
    s_add_u32 m0, s42, 17408
    s_nop 0
    buffer_load_dwordx4 v57, s[12:15], s54 offen lds
    s_add_u32 m0, s42, 24576
    s_nop 0
    buffer_load_dwordx4 v58, s[12:15], s54 offen lds
    s_add_u32 m0, s42, 25600
    s_nop 0
    buffer_load_dwordx4 v59, s[12:15], s54 offen lds
    s_add_u32 s54, s54, 458752
    s_add_u32 m0, s42, 32768
    s_nop 0
    buffer_load_dwordx4 v56, s[12:15], s54 offen lds
    s_add_u32 m0, s42, 33792
    s_nop 0
    buffer_load_dwordx4 v57, s[12:15], s54 offen lds
    s_add_u32 m0, s42, 40960
    s_nop 0
    buffer_load_dwordx4 v58, s[12:15], s54 offen lds
    s_add_u32 m0, s42, 41984
    s_nop 0
    buffer_load_dwordx4 v59, s[12:15], s54 offen lds
    s_add_u32 s54, s54, 458752
    s_add_u32 m0, s42, 49152
    s_nop 0
    buffer_load_dwordx4 v56, s[12:15], s54 offen lds
    s_add_u32 m0, s42, 50176
    s_nop 0
    buffer_load_dwordx4 v57, s[12:15], s54 offen lds
    s_add_u32 m0, s42, 57344
    s_nop 0
    buffer_load_dwordx4 v58, s[12:15], s54 offen lds
    s_add_u32 m0, s42, 58368
    s_nop 0
    buffer_load_dwordx4 v59, s[12:15], s54 offen lds
    s_add_u32 s54, s54, 458752
    s_add_u32 m0, s42, 65536
    s_nop 0
    buffer_load_dwordx4 v56, s[12:15], s54 offen lds
    s_add_u32 m0, s42, 66560
    s_nop 0
    buffer_load_dwordx4 v57, s[12:15], s54 offen lds
    s_add_u32 m0, s42, 73728
    s_nop 0
    buffer_load_dwordx4 v58, s[12:15], s54 offen lds
    s_add_u32 m0, s42, 74752
    s_nop 0
    buffer_load_dwordx4 v59, s[12:15], s54 offen lds
    s_add_u32 s54, s54, 458752
    v_lshrrev_b32 v64, 4, v0
    v_bfe_u32 v65, v0, 2, 2
    v_lshl_add_u32 v64, v64, 3, v65
    v_lshlrev_b32 v64, 7, v64
    v_lshrrev_b32 v65, 1, v65
    v_lshl_add_u32 v64, v65, 6, v64
    v_and_b32 v65, 3, v0
    v_lshl_add_u32 v64, v65, 4, v64
    s_lshr_b32 s37, s32, 1
    s_lshl_b32 s37, s37, 13
    s_and_b32 s38, s32, 1
    s_lshl_b32 s38, s38, 6
    s_add_u32 s37, s37, s38
    s_add_u32 s37, s37, 0
    v_xor_b32 v60, s37, v64
    s_lshr_b32 s37, s32, 1
    s_lshl_b32 s37, s37, 13
    s_and_b32 s38, s32, 1
    s_lshl_b32 s38, s38, 6
    s_add_u32 s37, s37, s38
    s_add_u32 s37, s37, 8
    v_xor_b32 v61, s37, v64
    v_mov_b32 v64, 0x3f803f80
    v_mov_b32 v65, 0x3f803f80
    v_mov_b32 v66, 0x3f803f80
    v_mov_b32 v67, 0x3f803f80
    v_add_u32 v2, 98304, v1
    s_lshl_b32 s37, s33, 6
    s_add_u32 s37, s37, 16
    s_lshl_b32 s37, s37, 7
    v_lshl_add_u32 v5, v0, 7, s37
    s_cmp_eq_u32 s32, 0
    s_cselect_b32 s37, 8, 0
    v_cmp_le_u32 vcc, s37, v0
    s_nop 1
    v_cndmask_b32 v5, v5, 2.0, vcc
    s_lshl_b32 s43, s32, 12
    s_mul_i32 s41, s33, 2097152
    s_add_u32 s41, s41, 0x800000
    s_add_u32 s41, s41, s43
    s_mul_i32 s90, s33, 8388608
    s_add_u32 s90, s90, 0xfc0000
    s_add_u32 s37, s51, s32
    s_lshl_b32 s37, s37, 11
    s_add_u32 s90, s90, s37
    s_lshl_b32 s37, s32, 10
    s_sub_u32 s87, 8192, s37
    s_lshl_b32 s38, s35, 1
    s_lshr_b32 s39, s32, 1
    s_add_u32 s38, s38, s39
    s_cmp_eq_u32 s38, 36
    s_cselect_b32 s88, 0x5e00000, 0
    s_and_b32 s38, s32, 1
    s_lshl_b32 s38, s38, 3
    s_and_b32 s39, s32, 2
    s_lshl_b32 s39, s39, 10
    s_add_u32 s38, s38, s39
    s_add_u32 s38, s38, 65536
    v_add_u32 v3, s38, v1
    s_add_u32 s37, s37, 65536
    v_add_u32 v4, s37, v1
    v_and_b32 v6, 15, v0
    v_lshlrev_b32 v6, 3, v6
    v_lshrrev_b32 v8, 5, v0
    v_lshl_add_u32 v6, v8, 9, v6
    v_and_b32 v8, 16, v0
    v_lshl_add_u32 v6, v8, 6, v6
    v_add_u32 v118, 73728, v6
    s_mul_i32 s46, s33, 65536
    s_add_u32 s46, s46, 0x5440000
    s_add_u32 s55, s46, 63488
    s_and_b32 s52, s32, 1
    s_lshl_b32 s52, s52, 10
    s_mov_b32 s8, s74
    s_mov_b32 s9, s75
    s_mov_b32 s10, 0x1c00
    s_mov_b32 s11, 0x00020000
    v_and_b32 v8, 0x30, v0
    s_add_u32 s37, s51, s32
    s_lshl_b32 s37, s37, 6
    buffer_load_dwordx4 v[16:19], v8, s[8:11], s37 offen
    s_lshr_b32 s37, s32, 1
    s_add_u32 s37, s37, s51
    s_lshl_b32 s37, s37, 6
    s_and_b32 s38, s32, 1
    s_lshl_b32 s38, s38, 3
    s_add_u32 s37, s37, s38
    buffer_load_dwordx2 v[20:21], v8, s[8:11], s37 offen offset:256
    v_add_u32 v62, 0, v60
    v_add_u32 v63, 0, v61
    s_waitcnt vmcnt(18)
    s_barrier
    ds_read_b64_tr_b16 a[0:1], v62 offset:0
    ds_read_b64_tr_b16 a[2:3], v62 offset:512
    ds_read_b64_tr_b16 a[4:5], v63 offset:0
    ds_read_b64_tr_b16 a[6:7], v63 offset:512
    ds_read_b64_tr_b16 a[8:9], v62 offset:4096
    ds_read_b64_tr_b16 a[10:11], v62 offset:4608
    ds_read_b64_tr_b16 a[12:13], v63 offset:4096
    ds_read_b64_tr_b16 a[14:15], v63 offset:4608
    s_add_u32 m0, s42, 81920
    s_nop 0
    buffer_load_dwordx4 v56, s[12:15], s54 offen lds
    s_add_u32 m0, s42, 82944
    s_nop 0
    buffer_load_dwordx4 v57, s[12:15], s54 offen lds
    s_add_u32 m0, s42, 90112
    s_nop 0
    buffer_load_dwordx4 v58, s[12:15], s54 offen lds
    s_add_u32 m0, s42, 91136
    s_nop 0
    buffer_load_dwordx4 v59, s[12:15], s54 offen lds
    s_add_u32 s54, s54, 458752
    s_waitcnt lgkmcnt(0)
    v_mfma_f32_16x16x32_bf16 v[88:91], a[0:3], v[64:67], 0
    v_mfma_f32_16x16x32_bf16 v[92:95], a[4:7], v[64:67], 0
    v_mfma_f32_16x16x32_bf16 v[88:91], a[8:11], v[64:67], v[88:91]
    v_mfma_f32_16x16x32_bf16 v[92:95], a[12:15], v[64:67], v[92:95]
    v_add_u32 v62, 16384, v60
    v_add_u32 v63, 16384, v61
    s_waitcnt vmcnt(18)
    s_barrier
    ds_read_b64_tr_b16 a[16:17], v62 offset:0
    ds_read_b64_tr_b16 a[18:19], v62 offset:512
    ds_read_b64_tr_b16 a[20:21], v63 offset:0
    ds_read_b64_tr_b16 a[22:23], v63 offset:512
    ds_read_b64_tr_b16 a[24:25], v62 offset:4096
    ds_read_b64_tr_b16 a[26:27], v62 offset:4608
    ds_read_b64_tr_b16 a[28:29], v63 offset:4096
    ds_read_b64_tr_b16 a[30:31], v63 offset:4608
    s_add_u32 m0, s42, 0
    s_nop 0
    buffer_load_dwordx4 v56, s[12:15], s54 offen lds
    s_add_u32 m0, s42, 1024
    s_nop 0
    buffer_load_dwordx4 v57, s[12:15], s54 offen lds
    s_add_u32 m0, s42, 8192
    s_nop 0
    buffer_load_dwordx4 v58, s[12:15], s54 offen lds
    s_add_u32 m0, s42, 9216
    s_nop 0
    buffer_load_dwordx4 v59, s[12:15], s54 offen lds
    s_add_u32 s54, s54, 458752
    s_waitcnt lgkmcnt(0)
    v_mfma_f32_16x16x32_bf16 v[88:91], a[16:19], v[64:67], v[88:91]
    v_mfma_f32_16x16x32_bf16 v[92:95], a[20:23], v[64:67], v[92:95]
    v_mfma_f32_16x16x32_bf16 v[88:91], a[24:27], v[64:67], v[88:91]
    v_mfma_f32_16x16x32_bf16 v[92:95], a[28:31], v[64:67], v[92:95]
    v_add_u32 v62, 32768, v60
    v_add_u32 v63, 32768, v61
    s_waitcnt vmcnt(18)
    s_barrier
    ds_read_b64_tr_b16 a[32:33], v62 offset:0
    ds_read_b64_tr_b16 a[34:35], v62 offset:512
    ds_read_b64_tr_b16 a[36:37], v63 offset:0
    ds_read_b64_tr_b16 a[38:39], v63 offset:512
    ds_read_b64_tr_b16 a[40:41], v62 offset:4096
    ds_read_b64_tr_b16 a[42:43], v62 offset:4608
    ds_read_b64_tr_b16 a[44:45], v63 offset:4096
    ds_read_b64_tr_b16 a[46:47], v63 offset:4608
    s_add_u32 m0, s42, 16384
    s_nop 0
    buffer_load_dwordx4 v56, s[12:15], s54 offen lds
    s_add_u32 m0, s42, 17408
    s_nop 0
    buffer_load_dwordx4 v57, s[12:15], s54 offen lds
    s_add_u32 m0, s42, 24576
    s_nop 0
    buffer_load_dwordx4 v58, s[12:15], s54 offen lds
    s_add_u32 m0, s42, 25600
    s_nop 0
    buffer_load_dwordx4 v59, s[12:15], s54 offen lds
    s_add_u32 s54, s54, 458752
    s_waitcnt lgkmcnt(0)
    v_mfma_f32_16x16x32_bf16 v[88:91], a[32:35], v[64:67], v[88:91]
    v_mfma_f32_16x16x32_bf16 v[92:95], a[36:39], v[64:67], v[92:95]
    v_mfma_f32_16x16x32_bf16 v[88:91], a[40:43], v[64:67], v[88:91]
    v_mfma_f32_16x16x32_bf16 v[92:95], a[44:47], v[64:67], v[92:95]
    v_add_u32 v62, 49152, v60
    v_add_u32 v63, 49152, v61
    s_waitcnt vmcnt(18)
    s_barrier
    ds_read_b64_tr_b16 a[48:49], v62 offset:0
    ds_read_b64_tr_b16 a[50:51], v62 offset:512
    ds_read_b64_tr_b16 a[52:53], v63 offset:0
    ds_read_b64_tr_b16 a[54:55], v63 offset:512
    ds_read_b64_tr_b16 a[56:57], v62 offset:4096
    ds_read_b64_tr_b16 a[58:59], v62 offset:4608
    ds_read_b64_tr_b16 a[60:61], v63 offset:4096
    ds_read_b64_tr_b16 a[62:63], v63 offset:4608
    s_add_u32 m0, s42, 32768
    s_nop 0
    buffer_load_dwordx4 v56, s[12:15], s54 offen lds
    s_add_u32 m0, s42, 33792
    s_nop 0
    buffer_load_dwordx4 v57, s[12:15], s54 offen lds
    s_add_u32 m0, s42, 40960
    s_nop 0
    buffer_load_dwordx4 v58, s[12:15], s54 offen lds
    s_add_u32 m0, s42, 41984
    s_nop 0
    buffer_load_dwordx4 v59, s[12:15], s54 offen lds
    s_add_u32 s54, s54, 458752
    s_waitcnt lgkmcnt(0)
    v_mfma_f32_16x16x32_bf16 v[88:91], a[48:51], v[64:67], v[88:91]
    v_mfma_f32_16x16x32_bf16 v[92:95], a[52:55], v[64:67], v[92:95]
    v_mfma_f32_16x16x32_bf16 v[88:91], a[56:59], v[64:67], v[88:91]
    v_mfma_f32_16x16x32_bf16 v[92:95], a[60:63], v[64:67], v[92:95]
    v_add_u32 v62, 65536, v60
    v_add_u32 v63, 65536, v61
    s_waitcnt vmcnt(18)
    s_barrier
    ds_read_b64_tr_b16 a[64:65], v62 offset:0
    ds_read_b64_tr_b16 a[66:67], v62 offset:512
    ds_read_b64_tr_b16 a[68:69], v63 offset:0
    ds_read_b64_tr_b16 a[70:71], v63 offset:512
    ds_read_b64_tr_b16 a[72:73], v62 offset:4096
    ds_read_b64_tr_b16 a[74:75], v62 offset:4608
    ds_read_b64_tr_b16 a[76:77], v63 offset:4096
    ds_read_b64_tr_b16 a[78:79], v63 offset:4608
    s_add_u32 m0, s42, 49152
    s_nop 0
    buffer_load_dwordx4 v56, s[12:15], s54 offen lds
    s_add_u32 m0, s42, 50176
    s_nop 0
    buffer_load_dwordx4 v57, s[12:15], s54 offen lds
    s_add_u32 m0, s42, 57344
    s_nop 0
    buffer_load_dwordx4 v58, s[12:15], s54 offen lds
    s_add_u32 m0, s42, 58368
    s_nop 0
    buffer_load_dwordx4 v59, s[12:15], s54 offen lds
    s_add_u32 s54, s54, 458752
    s_waitcnt lgkmcnt(0)
    v_mfma_f32_16x16x32_bf16 v[88:91], a[64:67], v[64:67], v[88:91]
    v_mfma_f32_16x16x32_bf16 v[92:95], a[68:71], v[64:67], v[92:95]
    v_mfma_f32_16x16x32_bf16 v[88:91], a[72:75], v[64:67], v[88:91]
    v_mfma_f32_16x16x32_bf16 v[92:95], a[76:79], v[64:67], v[92:95]
    v_add_u32 v62, 81920, v60
    v_add_u32 v63, 81920, v61
    s_waitcnt vmcnt(16)
    s_barrier
    ds_read_b64_tr_b16 a[80:81], v62 offset:0
    ds_read_b64_tr_b16 a[82:83], v62 offset:512
    ds_read_b64_tr_b16 a[84:85], v63 offset:0
    ds_read_b64_tr_b16 a[86:87], v63 offset:512
    ds_read_b64_tr_b16 a[88:89], v62 offset:4096
    ds_read_b64_tr_b16 a[90:91], v62 offset:4608
    ds_read_b64_tr_b16 a[92:93], v63 offset:4096
    ds_read_b64_tr_b16 a[94:95], v63 offset:4608
    s_add_u32 m0, s42, 65536
    s_nop 0
    buffer_load_dwordx4 v56, s[12:15], s54 offen lds
    s_add_u32 m0, s42, 66560
    s_nop 0
    buffer_load_dwordx4 v57, s[12:15], s54 offen lds
    s_add_u32 m0, s42, 73728
    s_nop 0
    buffer_load_dwordx4 v58, s[12:15], s54 offen lds
    s_add_u32 m0, s42, 74752
    s_nop 0
    buffer_load_dwordx4 v59, s[12:15], s54 offen lds
    s_add_u32 s54, s54, 458752
    s_waitcnt lgkmcnt(0)
    v_mfma_f32_16x16x32_bf16 v[88:91], a[80:83], v[64:67], v[88:91]
    v_mfma_f32_16x16x32_bf16 v[92:95], a[84:87], v[64:67], v[92:95]
    v_mfma_f32_16x16x32_bf16 v[88:91], a[88:91], v[64:67], v[88:91]
    v_mfma_f32_16x16x32_bf16 v[92:95], a[92:95], v[64:67], v[92:95]
    v_add_u32 v62, 0, v60
    v_add_u32 v63, 0, v61
    s_waitcnt vmcnt(16)
    s_barrier
    ds_read_b64_tr_b16 a[96:97], v62 offset:0
    ds_read_b64_tr_b16 a[98:99], v62 offset:512
    ds_read_b64_tr_b16 a[100:101], v63 offset:0
    ds_read_b64_tr_b16 a[102:103], v63 offset:512
    ds_read_b64_tr_b16 a[104:105], v62 offset:4096
    ds_read_b64_tr_b16 a[106:107], v62 offset:4608
    ds_read_b64_tr_b16 a[108:109], v63 offset:4096
    ds_read_b64_tr_b16 a[110:111], v63 offset:4608
    s_add_u32 m0, s42, 81920
    s_nop 0
    buffer_load_dwordx4 v56, s[12:15], s54 offen lds
    s_add_u32 m0, s42, 82944
    s_nop 0
    buffer_load_dwordx4 v57, s[12:15], s54 offen lds
    s_add_u32 m0, s42, 90112
    s_nop 0
    buffer_load_dwordx4 v58, s[12:15], s54 offen lds
    s_add_u32 m0, s42, 91136
    s_nop 0
    buffer_load_dwordx4 v59, s[12:15], s54 offen lds
    s_add_u32 s54, s54, 458752
    s_waitcnt lgkmcnt(0)
    v_mfma_f32_16x16x32_bf16 v[88:91], a[96:99], v[64:67], v[88:91]
    v_mfma_f32_16x16x32_bf16 v[92:95], a[100:103], v[64:67], v[92:95]
    v_mfma_f32_16x16x32_bf16 v[88:91], a[104:107], v[64:67], v[88:91]
    v_mfma_f32_16x16x32_bf16 v[92:95], a[108:111], v[64:67], v[92:95]
    v_add_u32 v62, 16384, v60
    v_add_u32 v63, 16384, v61
    s_waitcnt vmcnt(16)
    s_barrier
    ds_read_b64_tr_b16 a[112:113], v62 offset:0
    ds_read_b64_tr_b16 a[114:115], v62 offset:512
    ds_read_b64_tr_b16 a[116:117], v63 offset:0
    ds_read_b64_tr_b16 a[118:119], v63 offset:512
    ds_read_b64_tr_b16 a[120:121], v62 offset:4096
    ds_read_b64_tr_b16 a[122:123], v62 offset:4608
    ds_read_b64_tr_b16 a[124:125], v63 offset:4096
    ds_read_b64_tr_b16 a[126:127], v63 offset:4608
    s_add_u32 m0, s42, 0
    s_nop 0
    buffer_load_dwordx4 v56, s[12:15], s54 offen lds
    s_add_u32 m0, s42, 1024
    s_nop 0
    buffer_load_dwordx4 v57, s[12:15], s54 offen lds
    s_add_u32 m0, s42, 8192
    s_nop 0
    buffer_load_dwordx4 v58, s[12:15], s54 offen lds
    s_add_u32 m0, s42, 9216
    s_nop 0
    buffer_load_dwordx4 v59, s[12:15], s54 offen lds
    s_add_u32 s54, s54, 458752
    s_waitcnt lgkmcnt(0)
    v_mfma_f32_16x16x32_bf16 v[88:91], a[112:115], v[64:67], v[88:91]
    v_mfma_f32_16x16x32_bf16 v[92:95], a[116:119], v[64:67], v[92:95]
    v_mfma_f32_16x16x32_bf16 v[88:91], a[120:123], v[64:67], v[88:91]
    v_mfma_f32_16x16x32_bf16 v[92:95], a[124:127], v[64:67], v[92:95]
    v_add_u32 v62, 32768, v60
    v_add_u32 v63, 32768, v61
    s_waitcnt vmcnt(16)
    s_barrier
    ds_read_b64_tr_b16 a[128:129], v62 offset:0
    ds_read_b64_tr_b16 a[130:131], v62 offset:512
    ds_read_b64_tr_b16 a[132:133], v63 offset:0
    ds_read_b64_tr_b16 a[134:135], v63 offset:512
    ds_read_b64_tr_b16 a[136:137], v62 offset:4096
    ds_read_b64_tr_b16 a[138:139], v62 offset:4608
    ds_read_b64_tr_b16 a[140:141], v63 offset:4096
    ds_read_b64_tr_b16 a[142:143], v63 offset:4608
    s_add_u32 m0, s42, 16384
    s_nop 0
    buffer_load_dwordx4 v56, s[12:15], s54 offen lds
    s_add_u32 m0, s42, 17408
    s_nop 0
    buffer_load_dwordx4 v57, s[12:15], s54 offen lds
    s_add_u32 m0, s42, 24576
    s_nop 0
    buffer_load_dwordx4 v58, s[12:15], s54 offen lds
    s_add_u32 m0, s42, 25600
    s_nop 0
    buffer_load_dwordx4 v59, s[12:15], s54 offen lds
    s_add_u32 s54, s54, 458752
    s_waitcnt lgkmcnt(0)
    v_mfma_f32_16x16x32_bf16 v[88:91], a[128:131], v[64:67], v[88:91]
    v_mfma_f32_16x16x32_bf16 v[92:95], a[132:135], v[64:67], v[92:95]
    v_mfma_f32_16x16x32_bf16 v[88:91], a[136:139], v[64:67], v[88:91]
    v_mfma_f32_16x16x32_bf16 v[92:95], a[140:143], v[64:67], v[92:95]
    v_add_u32 v62, 49152, v60
    v_add_u32 v63, 49152, v61
    s_waitcnt vmcnt(16)
    s_barrier
    ds_read_b64_tr_b16 a[144:145], v62 offset:0
    ds_read_b64_tr_b16 a[146:147], v62 offset:512
    ds_read_b64_tr_b16 a[148:149], v63 offset:0
    ds_read_b64_tr_b16 a[150:151], v63 offset:512
    ds_read_b64_tr_b16 a[152:153], v62 offset:4096
    ds_read_b64_tr_b16 a[154:155], v62 offset:4608
    ds_read_b64_tr_b16 a[156:157], v63 offset:4096
    ds_read_b64_tr_b16 a[158:159], v63 offset:4608
    s_add_u32 m0, s42, 32768
    s_nop 0
    buffer_load_dwordx4 v56, s[12:15], s54 offen lds
    s_add_u32 m0, s42, 33792
    s_nop 0
    buffer_load_dwordx4 v57, s[12:15], s54 offen lds
    s_add_u32 m0, s42, 40960
    s_nop 0
    buffer_load_dwordx4 v58, s[12:15], s54 offen lds
    s_add_u32 m0, s42, 41984
    s_nop 0
    buffer_load_dwordx4 v59, s[12:15], s54 offen lds
    s_add_u32 s54, s54, 458752
    s_waitcnt lgkmcnt(0)
    v_mfma_f32_16x16x32_bf16 v[88:91], a[144:147], v[64:67], v[88:91]
    v_mfma_f32_16x16x32_bf16 v[92:95], a[148:151], v[64:67], v[92:95]
    v_mfma_f32_16x16x32_bf16 v[88:91], a[152:155], v[64:67], v[88:91]
    v_mfma_f32_16x16x32_bf16 v[92:95], a[156:159], v[64:67], v[92:95]
    v_add_u32 v62, 65536, v60
    v_add_u32 v63, 65536, v61
    s_waitcnt vmcnt(16)
    s_barrier
    ds_read_b64_tr_b16 a[160:161], v62 offset:0
    ds_read_b64_tr_b16 a[162:163], v62 offset:512
    ds_read_b64_tr_b16 a[164:165], v63 offset:0
    ds_read_b64_tr_b16 a[166:167], v63 offset:512
    ds_read_b64_tr_b16 a[168:169], v62 offset:4096
    ds_read_b64_tr_b16 a[170:171], v62 offset:4608
    ds_read_b64_tr_b16 a[172:173], v63 offset:4096
    ds_read_b64_tr_b16 a[174:175], v63 offset:4608
    s_add_u32 m0, s42, 49152
    s_nop 0
    buffer_load_dwordx4 v56, s[12:15], s54 offen lds
    s_add_u32 m0, s42, 50176
    s_nop 0
    buffer_load_dwordx4 v57, s[12:15], s54 offen lds
    s_add_u32 m0, s42, 57344
    s_nop 0
    buffer_load_dwordx4 v58, s[12:15], s54 offen lds
    s_add_u32 m0, s42, 58368
    s_nop 0
    buffer_load_dwordx4 v59, s[12:15], s54 offen lds
    s_add_u32 s54, s54, 458752
    s_waitcnt lgkmcnt(0)
    v_mfma_f32_16x16x32_bf16 v[88:91], a[160:163], v[64:67], v[88:91]
    v_mfma_f32_16x16x32_bf16 v[92:95], a[164:167], v[64:67], v[92:95]
    v_mfma_f32_16x16x32_bf16 v[88:91], a[168:171], v[64:67], v[88:91]
    v_mfma_f32_16x16x32_bf16 v[92:95], a[172:175], v[64:67], v[92:95]
    v_add_u32 v62, 81920, v60
    v_add_u32 v63, 81920, v61
    s_waitcnt vmcnt(16)
    s_barrier
    ds_read_b64_tr_b16 a[176:177], v62 offset:0
    ds_read_b64_tr_b16 a[178:179], v62 offset:512
    ds_read_b64_tr_b16 a[180:181], v63 offset:0
    ds_read_b64_tr_b16 a[182:183], v63 offset:512
    ds_read_b64_tr_b16 a[184:185], v62 offset:4096
    ds_read_b64_tr_b16 a[186:187], v62 offset:4608
    ds_read_b64_tr_b16 a[188:189], v63 offset:4096
    ds_read_b64_tr_b16 a[190:191], v63 offset:4608
    s_waitcnt lgkmcnt(0)
    v_mfma_f32_16x16x32_bf16 v[88:91], a[176:179], v[64:67], v[88:91]
    v_mfma_f32_16x16x32_bf16 v[92:95], a[180:183], v[64:67], v[92:95]
    v_mfma_f32_16x16x32_bf16 v[88:91], a[184:187], v[64:67], v[88:91]
    v_mfma_f32_16x16x32_bf16 v[92:95], a[188:191], v[64:67], v[92:95]
    v_add_u32 v62, 0, v60
    v_add_u32 v63, 0, v61
    s_waitcnt vmcnt(12)
    s_barrier
    ds_read_b64_tr_b16 a[192:193], v62 offset:0
    ds_read_b64_tr_b16 a[194:195], v62 offset:512
    ds_read_b64_tr_b16 a[196:197], v63 offset:0
    ds_read_b64_tr_b16 a[198:199], v63 offset:512
    ds_read_b64_tr_b16 a[200:201], v62 offset:4096
    ds_read_b64_tr_b16 a[202:203], v62 offset:4608
    ds_read_b64_tr_b16 a[204:205], v63 offset:4096
    ds_read_b64_tr_b16 a[206:207], v63 offset:4608
    s_waitcnt lgkmcnt(0)
    v_mfma_f32_16x16x32_bf16 v[88:91], a[192:195], v[64:67], v[88:91]
    v_mfma_f32_16x16x32_bf16 v[92:95], a[196:199], v[64:67], v[92:95]
    v_mfma_f32_16x16x32_bf16 v[88:91], a[200:203], v[64:67], v[88:91]
    v_mfma_f32_16x16x32_bf16 v[92:95], a[204:207], v[64:67], v[92:95]
    v_add_u32 v62, 16384, v60
    v_add_u32 v63, 16384, v61
    s_waitcnt vmcnt(8)
    s_barrier
    ds_read_b64_tr_b16 a[208:209], v62 offset:0
    ds_read_b64_tr_b16 a[210:211], v62 offset:512
    ds_read_b64_tr_b16 a[212:213], v63 offset:0
    ds_read_b64_tr_b16 a[214:215], v63 offset:512
    ds_read_b64_tr_b16 a[216:217], v62 offset:4096
    ds_read_b64_tr_b16 a[218:219], v62 offset:4608
    ds_read_b64_tr_b16 a[220:221], v63 offset:4096
    ds_read_b64_tr_b16 a[222:223], v63 offset:4608
    s_waitcnt lgkmcnt(0)
    v_mfma_f32_16x16x32_bf16 v[88:91], a[208:211], v[64:67], v[88:91]
    v_mfma_f32_16x16x32_bf16 v[92:95], a[212:215], v[64:67], v[92:95]
    v_mfma_f32_16x16x32_bf16 v[88:91], a[216:219], v[64:67], v[88:91]
    v_mfma_f32_16x16x32_bf16 v[92:95], a[220:223], v[64:67], v[92:95]
    v_add_u32 v62, 32768, v60
    v_add_u32 v63, 32768, v61
    s_waitcnt vmcnt(4)
    s_barrier
    ds_read_b64_tr_b16 a[224:225], v62 offset:0
    ds_read_b64_tr_b16 a[226:227], v62 offset:512
    ds_read_b64_tr_b16 a[228:229], v63 offset:0
    ds_read_b64_tr_b16 a[230:231], v63 offset:512
    ds_read_b64_tr_b16 a[232:233], v62 offset:4096
    ds_read_b64_tr_b16 a[234:235], v62 offset:4608
    ds_read_b64_tr_b16 a[236:237], v63 offset:4096
    ds_read_b64_tr_b16 a[238:239], v63 offset:4608
    s_waitcnt lgkmcnt(0)
    v_mfma_f32_16x16x32_bf16 v[88:91], a[224:227], v[64:67], v[88:91]
    v_mfma_f32_16x16x32_bf16 v[92:95], a[228:231], v[64:67], v[92:95]
    v_mfma_f32_16x16x32_bf16 v[88:91], a[232:235], v[64:67], v[88:91]
    v_mfma_f32_16x16x32_bf16 v[92:95], a[236:239], v[64:67], v[92:95]
    v_add_u32 v62, 49152, v60
    v_add_u32 v63, 49152, v61
    s_waitcnt vmcnt(0)
    s_barrier
    ds_read_b64_tr_b16 a[240:241], v62 offset:0
    ds_read_b64_tr_b16 a[242:243], v62 offset:512
    ds_read_b64_tr_b16 a[244:245], v63 offset:0
    ds_read_b64_tr_b16 a[246:247], v63 offset:512
    ds_read_b64_tr_b16 a[248:249], v62 offset:4096
    ds_read_b64_tr_b16 a[250:251], v62 offset:4608
    ds_read_b64_tr_b16 a[252:253], v63 offset:4096
    ds_read_b64_tr_b16 a[254:255], v63 offset:4608
    s_waitcnt lgkmcnt(0)
    v_mfma_f32_16x16x32_bf16 v[88:91], a[240:243], v[64:67], v[88:91]
    v_mfma_f32_16x16x32_bf16 v[92:95], a[244:247], v[64:67], v[92:95]
    v_mfma_f32_16x16x32_bf16 v[88:91], a[248:251], v[64:67], v[88:91]
    v_mfma_f32_16x16x32_bf16 v[92:95], a[252:255], v[64:67], v[92:95]
    s_barrier
    s_mov_b32 s37, 0xffff0000
    v_lshlrev_b32 v100, 16, v16
    v_and_b32 v101, s37, v16
    v_lshlrev_b32 v102, 16, v17
    v_and_b32 v103, s37, v17
    v_lshlrev_b32 v104, 16, v18
    v_and_b32 v105, s37, v18
    v_lshlrev_b32 v106, 16, v19
    v_and_b32 v107, s37, v19
    v_lshlrev_b32 v108, 16, v20
    v_and_b32 v109, s37, v20
    v_lshlrev_b32 v110, 16, v21
    v_and_b32 v111, s37, v21
    s_cmp_lg_u32 s32, 0
    s_cbranch_scc1 L_arv44
    s_add_u32 s20, s82, 0x80
    s_addc_u32 s21, s83, 0
    s_mov_b32 s22, 0x4
    s_mov_b32 s23, 0x00020000
    buffer_load_dword v56, v124, s[20:23], 0 offen sc1
    s_waitcnt vmcnt(0)
    v_cmp_eq_u32 vcc, v124, v56
    s_cbranch_vccnz L_spin45
L_back46:
L_arv44:
    s_add_u32 s96, s41, 2031616
    s_mov_b32 s98, s41
    s_mov_b32 s45, 0x5530000
    buffer_load_dword v7, v5, s[16:19], s45 offen sc1
    s_waitcnt vmcnt(0)
    v_cmp_ne_u32 vcc, 0, v7
    s_cbranch_vccnz L_spin47
L_back48:
    s_barrier
    s_add_u32 m0, s43, 0
    s_add_u32 s42, s41, 0
    buffer_load_dwordx4 v1, s[16:19], s42 offen offset:0 sc1 lds
    buffer_load_dwordx4 v1, s[16:19], s42 offen offset:1024 sc1 lds
    buffer_load_dwordx4 v1, s[16:19], s42 offen offset:2048 sc1 lds
    buffer_load_dwordx4 v1, s[16:19], s42 offen offset:3072 sc1 lds
    s_add_u32 m0, s43, 16384
    s_add_u32 s42, s41, 16384
    buffer_load_dwordx4 v1, s[16:19], s42 offen offset:0 sc1 lds
    buffer_load_dwordx4 v1, s[16:19], s42 offen offset:1024 sc1 lds
    buffer_load_dwordx4 v1, s[16:19], s42 offen offset:2048 sc1 lds
    buffer_load_dwordx4 v1, s[16:19], s42 offen offset:3072 sc1 lds
    s_add_u32 s45, s45, 65536
    s_waitcnt vmcnt(0) lgkmcnt(0)
    s_barrier
    ds_read_b128 v[56:59], v1 offset:0
    ds_read_b128 v[60:63], v1 offset:1024
    ds_read_b128 v[64:67], v1 offset:2048
    ds_read_b128 v[68:71], v1 offset:3072
    s_mov_b32 s36, 0
    s_waitcnt lgkmcnt(0)
    s_nop 7
L_l_b0:
    s_waitcnt lgkmcnt(2)
    v_mfma_f32_16x16x32_bf16 v[8:11], a[0:3], v[56:59], 0
    s_add_u32 m0, s52, 73728
    ds_read_b128 v[72:75], v1 offset:4096
    s_add_u32 s42, s46, s52
    v_mfma_f32_16x16x32_bf16 v[16:19], a[0:3], v[60:63], 0
    buffer_load_dwordx4 v1, s[16:19], s42 offen sc1 lds
    v_mfma_f32_16x16x32_bf16 v[20:23], a[4:7], v[60:63], 0
    s_add_u32 m0, s43, 32768
    ds_read_b128 v[76:79], v1 offset:5120
    s_add_u32 s42, s41, 32768
    v_mfma_f32_16x16x32_bf16 v[12:15], a[4:7], v[56:59], 0
    s_waitcnt lgkmcnt(2)
    buffer_load_dwordx4 v1, s[16:19], s42 offen offset:0 sc1 lds
    v_mfma_f32_16x16x32_bf16 v[8:11], a[8:11], v[64:67], v[8:11]
    s_and_b32 s44, s90, 0xffffffff
    ds_read_b128 v[80:83], v1 offset:6144
    s_cmp_lt_i32 s36, 1
    v_mfma_f32_16x16x32_bf16 v[16:19], a[8:11], v[68:71], v[16:19]
    buffer_load_dwordx4 v1, s[16:19], s42 offen offset:1024 sc1 lds
    v_mfma_f32_16x16x32_bf16 v[20:23], a[12:15], v[68:71], v[20:23]
    s_cselect_b32 s44, 0x5e00000, s44
    ds_read_b128 v[84:87], v1 offset:7168
    s_add_u32 s90, s90, 262144
    v_mfma_f32_16x16x32_bf16 v[12:15], a[12:15], v[64:67], v[12:15]
    s_waitcnt lgkmcnt(2)
    buffer_load_dwordx4 v1, s[16:19], s42 offen offset:2048 sc1 lds
    v_mfma_f32_16x16x32_bf16 v[8:11], a[16:19], v[72:75], v[8:11]
    ds_read_b128 v[56:59], v1 offset:8192
    v_add_f32 v32, v32, v128
    v_mfma_f32_16x16x32_bf16 v[16:19], a[16:19], v[76:79], v[16:19]
    buffer_load_dwordx4 v1, s[16:19], s42 offen offset:3072 sc1 lds
    v_mfma_f32_16x16x32_bf16 v[20:23], a[20:23], v[76:79], v[20:23]
    s_add_u32 m0, s43, 49152
    ds_read_b128 v[60:63], v1 offset:9216
    v_add_f32 v33, v33, v129
    v_mfma_f32_16x16x32_bf16 v[12:15], a[20:23], v[72:75], v[12:15]
    s_waitcnt lgkmcnt(2)
    v_mul_f32 v120, v32, v116
    v_mul_f32 v121, v33, v116
    v_mfma_f32_16x16x32_bf16 v[8:11], a[24:27], v[80:83], v[8:11]
    s_add_u32 s42, s41, 49152
    ds_read_b128 v[64:67], v1 offset:10240
    buffer_load_dwordx4 v1, s[16:19], s42 offen offset:0 sc1 lds
    v_mfma_f32_16x16x32_bf16 v[16:19], a[24:27], v[84:87], v[16:19]
    v_mul_f32 v120, v120, abs(v32)
    v_mul_f32 v121, v121, abs(v33)
    v_mfma_f32_16x16x32_bf16 v[20:23], a[28:31], v[84:87], v[20:23]
    ds_read_b128 v[68:71], v1 offset:11264
    buffer_load_dwordx4 v1, s[16:19], s42 offen offset:1024 sc1 lds
    v_mfma_f32_16x16x32_bf16 v[12:15], a[28:31], v[80:83], v[12:15]
    s_waitcnt lgkmcnt(2)
    v_cvt_pk_bf16_f32 v32, v120, v121
    v_pk_max_i16 v32, v32, 0
    v_mfma_f32_16x16x32_bf16 v[8:11], a[32:35], v[56:59], v[8:11]
    ds_read_b128 v[72:75], v1 offset:12288
    buffer_load_dwordx4 v1, s[16:19], s42 offen offset:2048 sc1 lds
    v_mfma_f32_16x16x32_bf16 v[16:19], a[32:35], v[60:63], v[16:19]
    v_add_f32 v34, v34, v130
    v_add_f32 v35, v35, v131
    v_mfma_f32_16x16x32_bf16 v[20:23], a[36:39], v[60:63], v[20:23]
    ds_read_b128 v[76:79], v1 offset:13312
    buffer_load_dwordx4 v1, s[16:19], s42 offen offset:3072 sc1 lds
    v_mfma_f32_16x16x32_bf16 v[12:15], a[36:39], v[56:59], v[12:15]
    s_waitcnt lgkmcnt(2)
    v_mul_f32 v120, v34, v116
    v_mul_f32 v121, v35, v116
    v_mfma_f32_16x16x32_bf16 v[8:11], a[40:43], v[64:67], v[8:11]
    s_add_u32 s98, s98, 65536
    ds_read_b128 v[80:83], v1 offset:14336
    v_mul_f32 v120, v120, abs(v34)
    v_mfma_f32_16x16x32_bf16 v[16:19], a[40:43], v[68:71], v[16:19]
    s_min_i32 s98, s98, s96
    v_mul_f32 v121, v121, abs(v35)
    v_cvt_pk_bf16_f32 v33, v120, v121
    v_mfma_f32_16x16x32_bf16 v[20:23], a[44:47], v[68:71], v[20:23]
    s_and_b32 s41, s98, 0xffffffff
    ds_read_b128 v[84:87], v1 offset:15360
    v_pk_max_i16 v33, v33, 0
    v_mfma_f32_16x16x32_bf16 v[12:15], a[44:47], v[64:67], v[12:15]
    s_waitcnt vmcnt(9) lgkmcnt(2)
    s_barrier
    v_add_f32 v36, v36, v132
    v_mfma_f32_16x16x32_bf16 v[8:11], a[48:51], v[72:75], v[8:11]
    ds_read_b128 v[56:59], v1 offset:16384
    v_add_f32 v37, v37, v133
    v_mfma_f32_16x16x32_bf16 v[16:19], a[48:51], v[76:79], v[16:19]
    v_mul_f32 v120, v36, v116
    v_mul_f32 v121, v37, v116
    v_mfma_f32_16x16x32_bf16 v[20:23], a[52:55], v[76:79], v[20:23]
    ds_read_b128 v[60:63], v1 offset:17408
    v_mul_f32 v120, v120, abs(v36)
    v_mfma_f32_16x16x32_bf16 v[12:15], a[52:55], v[72:75], v[12:15]
    s_waitcnt lgkmcnt(2)
    v_mul_f32 v121, v121, abs(v37)
    v_cvt_pk_bf16_f32 v34, v120, v121
    v_mfma_f32_16x16x32_bf16 v[8:11], a[56:59], v[80:83], v[8:11]
    ds_read_b128 v[64:67], v1 offset:18432
    v_pk_max_i16 v34, v34, 0
    v_mfma_f32_16x16x32_bf16 v[16:19], a[56:59], v[84:87], v[16:19]
    v_add_f32 v38, v38, v134
    v_add_f32 v39, v39, v135
    v_mfma_f32_16x16x32_bf16 v[20:23], a[60:63], v[84:87], v[20:23]
    ds_read_b128 v[68:71], v1 offset:19456
    v_mul_f32 v120, v38, v116
    v_mfma_f32_16x16x32_bf16 v[12:15], a[60:63], v[80:83], v[12:15]
    s_waitcnt lgkmcnt(2)
    v_mul_f32 v121, v39, v116
    v_mul_f32 v120, v120, abs(v38)
    v_mfma_f32_16x16x32_bf16 v[8:11], a[64:67], v[56:59], v[8:11]
    ds_read_b128 v[72:75], v1 offset:20480
    v_mul_f32 v121, v121, abs(v39)
    v_mfma_f32_16x16x32_bf16 v[16:19], a[64:67], v[60:63], v[16:19]
    v_cvt_pk_bf16_f32 v35, v120, v121
    v_pk_max_i16 v35, v35, 0
    v_mfma_f32_16x16x32_bf16 v[20:23], a[68:71], v[60:63], v[20:23]
    ds_read_b128 v[76:79], v1 offset:21504
    buffer_store_dwordx4 v[32:35], v1, s[16:19], s44 offen offset:0 sc1
    v_mfma_f32_16x16x32_bf16 v[12:15], a[68:71], v[56:59], v[12:15]
    s_waitcnt lgkmcnt(2)
    v_add_f32 v40, v40, v136
    v_add_f32 v41, v41, v137
    v_mfma_f32_16x16x32_bf16 v[8:11], a[72:75], v[64:67], v[8:11]
    ds_read_b128 v[80:83], v1 offset:22528
    v_mul_f32 v120, v40, v117
    v_mfma_f32_16x16x32_bf16 v[16:19], a[72:75], v[68:71], v[16:19]
    v_mul_f32 v121, v41, v117
    v_mul_f32 v120, v120, abs(v40)
    v_mfma_f32_16x16x32_bf16 v[20:23], a[76:79], v[68:71], v[20:23]
    ds_read_b128 v[84:87], v1 offset:23552
    v_mul_f32 v121, v121, abs(v41)
    v_mfma_f32_16x16x32_bf16 v[12:15], a[76:79], v[64:67], v[12:15]
    s_waitcnt lgkmcnt(2)
    v_cvt_pk_bf16_f32 v40, v120, v121
    v_pk_max_i16 v40, v40, 0
    v_mfma_f32_16x16x32_bf16 v[8:11], a[80:83], v[72:75], v[8:11]
    ds_read_b128 v[56:59], v1 offset:24576
    v_add_f32 v42, v42, v138
    v_mfma_f32_16x16x32_bf16 v[16:19], a[80:83], v[76:79], v[16:19]
    v_add_f32 v43, v43, v139
    v_mul_f32 v120, v42, v117
    v_mfma_f32_16x16x32_bf16 v[20:23], a[84:87], v[76:79], v[20:23]
    ds_read_b128 v[60:63], v1 offset:25600
    v_mul_f32 v121, v43, v117
    v_mfma_f32_16x16x32_bf16 v[12:15], a[84:87], v[72:75], v[12:15]
    s_waitcnt lgkmcnt(2)
    v_mul_f32 v120, v120, abs(v42)
    v_mul_f32 v121, v121, abs(v43)
    v_mfma_f32_16x16x32_bf16 v[8:11], a[88:91], v[80:83], v[8:11]
    ds_read_b128 v[64:67], v1 offset:26624
    v_cvt_pk_bf16_f32 v41, v120, v121
    v_mfma_f32_16x16x32_bf16 v[16:19], a[88:91], v[84:87], v[16:19]
    v_pk_max_i16 v41, v41, 0
    v_add_f32 v44, v44, v140
    v_mfma_f32_16x16x32_bf16 v[20:23], a[92:95], v[84:87], v[20:23]
    ds_read_b128 v[68:71], v1 offset:27648
    v_add_f32 v45, v45, v141
    v_mfma_f32_16x16x32_bf16 v[12:15], a[92:95], v[80:83], v[12:15]
    s_waitcnt lgkmcnt(2)
    v_mul_f32 v120, v44, v117
    v_mul_f32 v121, v45, v117
    v_mfma_f32_16x16x32_bf16 v[8:11], a[96:99], v[56:59], v[8:11]
    ds_read_b128 v[72:75], v1 offset:28672
    v_mul_f32 v120, v120, abs(v44)
    v_mfma_f32_16x16x32_bf16 v[16:19], a[96:99], v[60:63], v[16:19]
    v_mul_f32 v121, v121, abs(v45)
    v_cvt_pk_bf16_f32 v42, v120, v121
    v_mfma_f32_16x16x32_bf16 v[20:23], a[100:103], v[60:63], v[20:23]
    ds_read_b128 v[76:79], v1 offset:29696
    buffer_load_dword v7, v5, s[16:19], s45 offen sc1
    v_mfma_f32_16x16x32_bf16 v[12:15], a[100:103], v[56:59], v[12:15]
    s_waitcnt lgkmcnt(2)
    v_pk_max_i16 v42, v42, 0
    v_add_f32 v46, v46, v142
    v_mfma_f32_16x16x32_bf16 v[8:11], a[104:107], v[64:67], v[8:11]
    ds_read_b128 v[80:83], v1 offset:30720
    v_add_f32 v47, v47, v143
    v_mfma_f32_16x16x32_bf16 v[16:19], a[104:107], v[68:71], v[16:19]
    v_mul_f32 v120, v46, v117
    v_mul_f32 v121, v47, v117
    v_mfma_f32_16x16x32_bf16 v[20:23], a[108:111], v[68:71], v[20:23]
    ds_read_b128 v[84:87], v1 offset:31744
    v_mul_f32 v120, v120, abs(v46)
    v_mfma_f32_16x16x32_bf16 v[12:15], a[108:111], v[64:67], v[12:15]
    s_waitcnt vmcnt(6) lgkmcnt(2)
    s_barrier
    v_mul_f32 v121, v121, abs(v47)
    v_mfma_f32_16x16x32_bf16 v[8:11], a[112:115], v[72:75], v[8:11]
    ds_read_b128 v[56:59], v1 offset:32768
    v_cvt_pk_bf16_f32 v43, v120, v121
    v_mfma_f32_16x16x32_bf16 v[16:19], a[112:115], v[76:79], v[16:19]
    v_pk_max_i16 v43, v43, 0
    buffer_store_dwordx4 v[40:43], v1, s[16:19], s44 offen offset:1024 sc1
    v_mfma_f32_16x16x32_bf16 v[20:23], a[116:119], v[76:79], v[20:23]
    s_add_u32 m0, s43, 98304
    ds_read_b128 v[60:63], v1 offset:33792
    ds_read_b64 v[144:145], v118 offset:0
    v_mfma_f32_16x16x32_bf16 v[12:15], a[116:119], v[72:75], v[12:15]
    s_waitcnt lgkmcnt(3)
    ds_read_b64 v[146:147], v118 offset:128
    ds_read_b64 v[148:149], v118 offset:256
    v_mfma_f32_16x16x32_bf16 v[8:11], a[120:123], v[80:83], v[8:11]
    s_add_u32 s42, s41, 0
    ds_read_b128 v[64:67], v1 offset:34816
    ds_read_b64 v[150:151], v118 offset:384
    v_mfma_f32_16x16x32_bf16 v[16:19], a[120:123], v[84:87], v[16:19]
    v_mfma_f32_16x16x32_bf16 v[20:23], a[124:127], v[84:87], v[20:23]
    ds_read_b128 v[68:71], v1 offset:35840
    v_mfma_f32_16x16x32_bf16 v[12:15], a[124:127], v[80:83], v[12:15]
    s_waitcnt lgkmcnt(6)
    v_mfma_f32_16x16x32_bf16 v[8:11], a[128:131], v[56:59], v[8:11]
    ds_read_b128 v[72:75], v1 offset:36864
    v_mfma_f32_16x16x32_bf16 v[16:19], a[128:131], v[60:63], v[16:19]
    s_waitcnt lgkmcnt(2)
    v_max3_u32 v152, v144, v145, v146
    v_max3_u32 v153, v147, v148, v149
    v_mfma_f32_16x16x32_bf16 v[20:23], a[132:135], v[60:63], v[20:23]
    ds_read_b128 v[76:79], v1 offset:37888
    v_max3_u32 v152, v152, v150, v151
    v_mfma_f32_16x16x32_bf16 v[12:15], a[132:135], v[56:59], v[12:15]
    s_waitcnt lgkmcnt(2)
    v_max_u32 v152, v152, v153
    v_cmp_eq_u32 vcc, -1, v152
    v_mfma_f32_16x16x32_bf16 v[8:11], a[136:139], v[64:67], v[8:11]
    ds_read_b128 v[80:83], v1 offset:38912
    v_mfma_f32_16x16x32_bf16 v[16:19], a[136:139], v[68:71], v[16:19]
    s_cbranch_vccnz L_sspin51
L_sback52:
    v_add_f32 v152, v148, v150
    v_add_f32 v153, v149, v151
    v_mfma_f32_16x16x32_bf16 v[20:23], a[140:143], v[68:71], v[20:23]
    ds_read_b128 v[84:87], v1 offset:39936
    v_add_f32 v144, v144, v146
    v_mfma_f32_16x16x32_bf16 v[12:15], a[140:143], v[64:67], v[12:15]
    s_waitcnt lgkmcnt(2)
    v_add_f32 v145, v145, v147
    v_add_f32 v144, v144, v152
    v_mfma_f32_16x16x32_bf16 v[8:11], a[144:147], v[72:75], v[8:11]
    ds_read_b128 v[56:59], v1 offset:40960
    v_add_f32 v145, v145, v153
    v_mfma_f32_16x16x32_bf16 v[16:19], a[144:147], v[76:79], v[16:19]
    v_mov_b32 v152, v144
    v_mov_b32 v153, v145
    v_mfma_f32_16x16x32_bf16 v[20:23], a[148:151], v[76:79], v[20:23]
    ds_read_b128 v[60:63], v1 offset:41984
    v_permlane32_swap_b32 v144, v152
    v_mfma_f32_16x16x32_bf16 v[12:15], a[148:151], v[72:75], v[12:15]
    s_waitcnt lgkmcnt(2)
    v_permlane32_swap_b32 v145, v153
    v_mfma_f32_16x16x32_bf16 v[8:11], a[152:155], v[80:83], v[8:11]
    ds_read_b128 v[64:67], v1 offset:43008
    v_add_f32 v144, v144, v152
    v_mfma_f32_16x16x32_bf16 v[16:19], a[152:155], v[84:87], v[16:19]
    v_add_f32 v145, v145, v153
    v_mul_f32 v112, 0xba800000, v144
    v_mfma_f32_16x16x32_bf16 v[20:23], a[156:159], v[84:87], v[20:23]
    ds_read_b128 v[68:71], v1 offset:44032
    v_mul_f32 v145, 0x3a800000, v145
    v_mfma_f32_16x16x32_bf16 v[12:15], a[156:159], v[80:83], v[12:15]
    s_waitcnt lgkmcnt(2)
    v_fma_f32 v145, -v112, v112, v145
    v_mov_b32 v113, v112
    v_mfma_f32_16x16x32_bf16 v[8:11], a[160:163], v[56:59], v[8:11]
    ds_read_b128 v[72:75], v1 offset:45056
    v_max_f32 v145, 0, v145
    v_mfma_f32_16x16x32_bf16 v[16:19], a[160:163], v[60:63], v[16:19]
    v_add_f32 v145, 0x3727c5ac, v145
    v_rsq_f32 v116, v145
    v_mfma_f32_16x16x32_bf16 v[20:23], a[164:167], v[60:63], v[20:23]
    ds_read_b128 v[76:79], v1 offset:46080
    v_permlane16_swap_b32 v112, v113
    v_mfma_f32_16x16x32_bf16 v[12:15], a[164:167], v[56:59], v[12:15]
    s_waitcnt lgkmcnt(2)
    v_mul_f32 v114, v145, v116
    v_mul_f32 v116, v116, v116
    v_mfma_f32_16x16x32_bf16 v[8:11], a[168:171], v[64:67], v[8:11]
    s_waitcnt vmcnt(0)
    ds_read_b128 v[80:83], v1 offset:47104
    v_mov_b32 v115, v114
    v_mfma_f32_16x16x32_bf16 v[16:19], a[168:171], v[68:71], v[16:19]
    s_barrier
    buffer_store_dword v124, v124, s[16:19], s91 offen sc1
    v_mfma_f32_16x16x32_bf16 v[20:23], a[172:175], v[68:71], v[20:23]
    s_add_u32 s91, s91, 65536
    ds_read_b128 v[84:87], v1 offset:48128
    v_cmp_ne_u32 vcc, 0, v7
    v_mfma_f32_16x16x32_bf16 v[12:15], a[172:175], v[64:67], v[12:15]
    s_waitcnt lgkmcnt(2)
    v_mov_b32 v117, v116
    v_permlane16_swap_b32 v114, v115
    v_mfma_f32_16x16x32_bf16 v[8:11], a[176:179], v[72:75], v[8:11]
    s_cbranch_vccnz L_spin49
L_back50:
    ds_read_b128 v[56:59], v1 offset:49152
    v_permlane16_swap_b32 v116, v117
    v_mfma_f32_16x16x32_bf16 v[16:19], a[176:179], v[76:79], v[16:19]
    s_barrier
    buffer_load_dwordx4 v1, s[16:19], s42 offen offset:0 sc1 lds
    v_mfma_f32_16x16x32_bf16 v[20:23], a[180:183], v[76:79], v[20:23]
    s_add_u32 s46, s46, 2048
    ds_read_b128 v[60:63], v1 offset:50176
    buffer_load_dwordx4 v1, s[16:19], s42 offen offset:1024 sc1 lds
    v_mfma_f32_16x16x32_bf16 v[12:15], a[180:183], v[72:75], v[12:15]
    s_waitcnt lgkmcnt(2)
    buffer_load_dwordx4 v1, s[16:19], s42 offen offset:2048 sc1 lds
    v_mfma_f32_16x16x32_bf16 v[8:11], a[184:187], v[80:83], v[8:11]
    ds_read_b128 v[64:67], v1 offset:51200
    buffer_load_dwordx4 v1, s[16:19], s42 offen offset:3072 sc1 lds
    v_mfma_f32_16x16x32_bf16 v[16:19], a[184:187], v[84:87], v[16:19]
    s_add_u32 m0, s43, 114688
    v_mul_f32 v128, v112, v88
    v_fmac_f32 v128, v114, v100
    v_mfma_f32_16x16x32_bf16 v[20:23], a[188:191], v[84:87], v[20:23]
    s_add_u32 s42, s41, 16384
    ds_read_b128 v[68:71], v1 offset:52224
    v_mul_f32 v129, v112, v89
    v_mfma_f32_16x16x32_bf16 v[12:15], a[188:191], v[80:83], v[12:15]
    s_waitcnt lgkmcnt(2)
    v_fmac_f32 v129, v114, v101
    v_mul_f32 v130, v112, v90
    v_mfma_f32_16x16x32_bf16 v[8:11], a[192:195], v[56:59], v[8:11]
    ds_read_b128 v[72:75], v1 offset:53248
    buffer_load_dwordx4 v1, s[16:19], s42 offen offset:0 sc1 lds
    v_mfma_f32_16x16x32_bf16 v[16:19], a[192:195], v[60:63], v[16:19]
    v_fmac_f32 v130, v114, v102
    v_mul_f32 v131, v112, v91
    v_mfma_f32_16x16x32_bf16 v[20:23], a[196:199], v[60:63], v[20:23]
    ds_read_b128 v[76:79], v1 offset:54272
    v_fmac_f32 v131, v114, v103
    v_mfma_f32_16x16x32_bf16 v[12:15], a[196:199], v[56:59], v[12:15]
    s_waitcnt lgkmcnt(2)
    v_mul_f32 v132, v112, v92
    v_fmac_f32 v132, v114, v104
    v_mfma_f32_16x16x32_bf16 v[8:11], a[200:203], v[64:67], v[8:11]
    ds_read_b128 v[80:83], v1 offset:55296
    buffer_load_dwordx4 v1, s[16:19], s42 offen offset:1024 sc1 lds
    v_mfma_f32_16x16x32_bf16 v[16:19], a[200:203], v[68:71], v[16:19]
    v_mul_f32 v133, v112, v93
    v_fmac_f32 v133, v114, v105
    v_mfma_f32_16x16x32_bf16 v[20:23], a[204:207], v[68:71], v[20:23]
    ds_read_b128 v[84:87], v1 offset:56320
    v_mul_f32 v134, v112, v94
    v_mfma_f32_16x16x32_bf16 v[12:15], a[204:207], v[64:67], v[12:15]
    s_waitcnt lgkmcnt(2)
    v_fmac_f32 v134, v114, v106
    v_mul_f32 v135, v112, v95
    v_mfma_f32_16x16x32_bf16 v[8:11], a[208:211], v[72:75], v[8:11]
    ds_read_b128 v[56:59], v1 offset:57344
    buffer_load_dwordx4 v1, s[16:19], s42 offen offset:2048 sc1 lds
    v_mfma_f32_16x16x32_bf16 v[16:19], a[208:211], v[76:79], v[16:19]
    v_fmac_f32 v135, v114, v107
    v_mul_f32 v136, v113, v88
    v_mfma_f32_16x16x32_bf16 v[20:23], a[212:215], v[76:79], v[20:23]
    ds_read_b128 v[60:63], v1 offset:58368
    v_fmac_f32 v136, v115, v100
    v_mfma_f32_16x16x32_bf16 v[12:15], a[212:215], v[72:75], v[12:15]
    s_waitcnt lgkmcnt(2)
    v_mul_f32 v137, v113, v89
    v_fmac_f32 v137, v115, v101
    v_mfma_f32_16x16x32_bf16 v[8:11], a[216:219], v[80:83], v[8:11]
    ds_read_b128 v[64:67], v1 offset:59392
    buffer_load_dwordx4 v1, s[16:19], s42 offen offset:3072 sc1 lds
    v_mfma_f32_16x16x32_bf16 v[16:19], a[216:219], v[84:87], v[16:19]
    s_add_u32 s45, s45, 65536
    v_mul_f32 v138, v113, v90
    v_fmac_f32 v138, v115, v102
    v_mfma_f32_16x16x32_bf16 v[20:23], a[220:223], v[84:87], v[20:23]
    ds_read_b128 v[68:71], v1 offset:60416
    v_mul_f32 v139, v113, v91
    v_mfma_f32_16x16x32_bf16 v[12:15], a[220:223], v[80:83], v[12:15]
    s_waitcnt lgkmcnt(2)
    v_fmac_f32 v139, v115, v103
    v_mul_f32 v140, v113, v92
    v_mfma_f32_16x16x32_bf16 v[8:11], a[224:227], v[56:59], v[8:11]
    ds_read_b128 v[72:75], v1 offset:61440
    v_fmac_f32 v140, v115, v104
    v_mfma_f32_16x16x32_bf16 v[16:19], a[224:227], v[60:63], v[16:19]
    v_mul_f32 v141, v113, v93
    v_fmac_f32 v141, v115, v105
    v_mfma_f32_16x16x32_bf16 v[20:23], a[228:231], v[60:63], v[20:23]
    ds_read_b128 v[76:79], v1 offset:62464
    v_mul_f32 v142, v113, v94
    v_mfma_f32_16x16x32_bf16 v[12:15], a[228:231], v[56:59], v[12:15]
    s_waitcnt lgkmcnt(2)
    v_fmac_f32 v142, v115, v106
    v_mul_f32 v143, v113, v95
    v_mfma_f32_16x16x32_bf16 v[8:11], a[232:235], v[64:67], v[8:11]
    ds_read_b128 v[80:83], v1 offset:63488
    v_fmac_f32 v143, v115, v107
    v_mfma_f32_16x16x32_bf16 v[16:19], a[232:235], v[68:71], v[16:19]
    v_mfma_f32_16x16x32_bf16 v[20:23], a[236:239], v[68:71], v[20:23]
    ds_read_b128 v[84:87], v1 offset:64512
    v_mfma_f32_16x16x32_bf16 v[12:15], a[236:239], v[64:67], v[12:15]
    s_waitcnt vmcnt(4) lgkmcnt(2)
    s_barrier
    v_mfma_f32_16x16x32_bf16 v[8:11], a[240:243], v[72:75], v[8:11]
    ds_read_b128 v[56:59], v2 offset:0
    v_mfma_f32_16x16x32_bf16 v[16:19], a[240:243], v[76:79], v[16:19]
    v_mfma_f32_16x16x32_bf16 v[20:23], a[244:247], v[76:79], v[20:23]
    ds_read_b128 v[60:63], v2 offset:1024
    v_mfma_f32_16x16x32_bf16 v[12:15], a[244:247], v[72:75], v[12:15]
    s_waitcnt lgkmcnt(2)
    v_mfma_f32_16x16x32_bf16 v[8:11], a[248:251], v[80:83], v[8:11]
    ds_read_b128 v[64:67], v2 offset:2048
    v_mfma_f32_16x16x32_bf16 v[16:19], a[248:251], v[84:87], v[16:19]
    v_mfma_f32_16x16x32_bf16 v[20:23], a[252:255], v[84:87], v[20:23]
    ds_read_b128 v[68:71], v2 offset:3072
    v_mfma_f32_16x16x32_bf16 v[12:15], a[252:255], v[80:83], v[12:15]
    s_add_u32 s36, s36, 1
L_l_b1:
    s_waitcnt lgkmcnt(2)
    v_mfma_f32_16x16x32_bf16 v[32:35], a[0:3], v[56:59], 0
    s_add_u32 m0, s52, 73728
    ds_read_b128 v[72:75], v2 offset:4096
    s_add_u32 s42, s46, s52
    v_mfma_f32_16x16x32_bf16 v[40:43], a[0:3], v[60:63], 0
    buffer_load_dwordx4 v1, s[16:19], s42 offen sc1 lds
    v_mfma_f32_16x16x32_bf16 v[44:47], a[4:7], v[60:63], 0
    s_add_u32 m0, s43, 131072
    ds_read_b128 v[76:79], v2 offset:5120
    s_add_u32 s42, s41, 32768
    v_mfma_f32_16x16x32_bf16 v[36:39], a[4:7], v[56:59], 0
    s_waitcnt lgkmcnt(2)
    buffer_load_dwordx4 v1, s[16:19], s42 offen offset:0 sc1 lds
    v_mfma_f32_16x16x32_bf16 v[32:35], a[8:11], v[64:67], v[32:35]
    s_and_b32 s44, s90, 0xffffffff
    ds_read_b128 v[80:83], v2 offset:6144
    s_cmp_lt_i32 s36, 1
    v_mfma_f32_16x16x32_bf16 v[40:43], a[8:11], v[68:71], v[40:43]
    buffer_load_dwordx4 v1, s[16:19], s42 offen offset:1024 sc1 lds
    v_mfma_f32_16x16x32_bf16 v[44:47], a[12:15], v[68:71], v[44:47]
    s_cselect_b32 s44, 0x5e00000, s44
    ds_read_b128 v[84:87], v2 offset:7168
    s_add_u32 s90, s90, 262144
    v_mfma_f32_16x16x32_bf16 v[36:39], a[12:15], v[64:67], v[36:39]
    s_waitcnt lgkmcnt(2)
    buffer_load_dwordx4 v1, s[16:19], s42 offen offset:2048 sc1 lds
    v_mfma_f32_16x16x32_bf16 v[32:35], a[16:19], v[72:75], v[32:35]
    ds_read_b128 v[56:59], v2 offset:8192
    v_add_f32 v8, v8, v128
    v_mfma_f32_16x16x32_bf16 v[40:43], a[16:19], v[76:79], v[40:43]
    buffer_load_dwordx4 v1, s[16:19], s42 offen offset:3072 sc1 lds
    v_mfma_f32_16x16x32_bf16 v[44:47], a[20:23], v[76:79], v[44:47]
    s_add_u32 m0, s43, 147456
    ds_read_b128 v[60:63], v2 offset:9216
    v_add_f32 v9, v9, v129
    v_mfma_f32_16x16x32_bf16 v[36:39], a[20:23], v[72:75], v[36:39]
    s_waitcnt lgkmcnt(2)
    v_mul_f32 v120, v8, v116
    v_mul_f32 v121, v9, v116
    v_mfma_f32_16x16x32_bf16 v[32:35], a[24:27], v[80:83], v[32:35]
    s_add_u32 s42, s41, 49152
    ds_read_b128 v[64:67], v2 offset:10240
    buffer_load_dwordx4 v1, s[16:19], s42 offen offset:0 sc1 lds
    v_mfma_f32_16x16x32_bf16 v[40:43], a[24:27], v[84:87], v[40:43]
    v_mul_f32 v120, v120, abs(v8)
    v_mul_f32 v121, v121, abs(v9)
    v_mfma_f32_16x16x32_bf16 v[44:47], a[28:31], v[84:87], v[44:47]
    ds_read_b128 v[68:71], v2 offset:11264
    buffer_load_dwordx4 v1, s[16:19], s42 offen offset:1024 sc1 lds
    v_mfma_f32_16x16x32_bf16 v[36:39], a[28:31], v[80:83], v[36:39]
    s_waitcnt lgkmcnt(2)
    v_cvt_pk_bf16_f32 v8, v120, v121
    v_pk_max_i16 v8, v8, 0
    v_mfma_f32_16x16x32_bf16 v[32:35], a[32:35], v[56:59], v[32:35]
    ds_read_b128 v[72:75], v2 offset:12288
    buffer_load_dwordx4 v1, s[16:19], s42 offen offset:2048 sc1 lds
    v_mfma_f32_16x16x32_bf16 v[40:43], a[32:35], v[60:63], v[40:43]
    v_add_f32 v10, v10, v130
    v_add_f32 v11, v11, v131
    v_mfma_f32_16x16x32_bf16 v[44:47], a[36:39], v[60:63], v[44:47]
    ds_read_b128 v[76:79], v2 offset:13312
    buffer_load_dwordx4 v1, s[16:19], s42 offen offset:3072 sc1 lds
    v_mfma_f32_16x16x32_bf16 v[36:39], a[36:39], v[56:59], v[36:39]
    s_waitcnt lgkmcnt(2)
    v_mul_f32 v120, v10, v116
    v_mul_f32 v121, v11, v116
    v_mfma_f32_16x16x32_bf16 v[32:35], a[40:43], v[64:67], v[32:35]
    s_add_u32 s98, s98, 65536
    ds_read_b128 v[80:83], v2 offset:14336
    v_mul_f32 v120, v120, abs(v10)
    v_mfma_f32_16x16x32_bf16 v[40:43], a[40:43], v[68:71], v[40:43]
    s_min_i32 s98, s98, s96
    v_mul_f32 v121, v121, abs(v11)
    v_cvt_pk_bf16_f32 v9, v120, v121
    v_mfma_f32_16x16x32_bf16 v[44:47], a[44:47], v[68:71], v[44:47]
    s_and_b32 s41, s98, 0xffffffff
    ds_read_b128 v[84:87], v2 offset:15360
    v_pk_max_i16 v9, v9, 0
    v_mfma_f32_16x16x32_bf16 v[36:39], a[44:47], v[64:67], v[36:39]
    s_waitcnt vmcnt(9) lgkmcnt(2)
    s_barrier
    v_add_f32 v12, v12, v132
    v_mfma_f32_16x16x32_bf16 v[32:35], a[48:51], v[72:75], v[32:35]
    ds_read_b128 v[56:59], v2 offset:16384
    v_add_f32 v13, v13, v133
    v_mfma_f32_16x16x32_bf16 v[40:43], a[48:51], v[76:79], v[40:43]
    v_mul_f32 v120, v12, v116
    v_mul_f32 v121, v13, v116
    v_mfma_f32_16x16x32_bf16 v[44:47], a[52:55], v[76:79], v[44:47]
    ds_read_b128 v[60:63], v2 offset:17408
    v_mul_f32 v120, v120, abs(v12)
    v_mfma_f32_16x16x32_bf16 v[36:39], a[52:55], v[72:75], v[36:39]
    s_waitcnt lgkmcnt(2)
    v_mul_f32 v121, v121, abs(v13)
    v_cvt_pk_bf16_f32 v10, v120, v121
    v_mfma_f32_16x16x32_bf16 v[32:35], a[56:59], v[80:83], v[32:35]
    ds_read_b128 v[64:67], v2 offset:18432
    v_pk_max_i16 v10, v10, 0
    v_mfma_f32_16x16x32_bf16 v[40:43], a[56:59], v[84:87], v[40:43]
    v_add_f32 v14, v14, v134
    v_add_f32 v15, v15, v135
    v_mfma_f32_16x16x32_bf16 v[44:47], a[60:63], v[84:87], v[44:47]
    ds_read_b128 v[68:71], v2 offset:19456
    v_mul_f32 v120, v14, v116
    v_mfma_f32_16x16x32_bf16 v[36:39], a[60:63], v[80:83], v[36:39]
    s_waitcnt lgkmcnt(2)
    v_mul_f32 v121, v15, v116
    v_mul_f32 v120, v120, abs(v14)
    v_mfma_f32_16x16x32_bf16 v[32:35], a[64:67], v[56:59], v[32:35]
    ds_read_b128 v[72:75], v2 offset:20480
    v_mul_f32 v121, v121, abs(v15)
    v_mfma_f32_16x16x32_bf16 v[40:43], a[64:67], v[60:63], v[40:43]
    v_cvt_pk_bf16_f32 v11, v120, v121
    v_pk_max_i16 v11, v11, 0
    v_mfma_f32_16x16x32_bf16 v[44:47], a[68:71], v[60:63], v[44:47]
    ds_read_b128 v[76:79], v2 offset:21504
    buffer_store_dwordx4 v[8:11], v1, s[16:19], s44 offen offset:0 sc1
    v_mfma_f32_16x16x32_bf16 v[36:39], a[68:71], v[56:59], v[36:39]
    s_waitcnt lgkmcnt(2)
    v_add_f32 v16, v16, v136
    v_add_f32 v17, v17, v137
    v_mfma_f32_16x16x32_bf16 v[32:35], a[72:75], v[64:67], v[32:35]
    ds_read_b128 v[80:83], v2 offset:22528
    v_mul_f32 v120, v16, v117
    v_mfma_f32_16x16x32_bf16 v[40:43], a[72:75], v[68:71], v[40:43]
    v_mul_f32 v121, v17, v117
    v_mul_f32 v120, v120, abs(v16)
    v_mfma_f32_16x16x32_bf16 v[44:47], a[76:79], v[68:71], v[44:47]
    ds_read_b128 v[84:87], v2 offset:23552
    v_mul_f32 v121, v121, abs(v17)
    v_mfma_f32_16x16x32_bf16 v[36:39], a[76:79], v[64:67], v[36:39]
    s_waitcnt lgkmcnt(2)
    v_cvt_pk_bf16_f32 v16, v120, v121
    v_pk_max_i16 v16, v16, 0
    v_mfma_f32_16x16x32_bf16 v[32:35], a[80:83], v[72:75], v[32:35]
    ds_read_b128 v[56:59], v2 offset:24576
    v_add_f32 v18, v18, v138
    v_mfma_f32_16x16x32_bf16 v[40:43], a[80:83], v[76:79], v[40:43]
    v_add_f32 v19, v19, v139
    v_mul_f32 v120, v18, v117
    v_mfma_f32_16x16x32_bf16 v[44:47], a[84:87], v[76:79], v[44:47]
    ds_read_b128 v[60:63], v2 offset:25600
    v_mul_f32 v121, v19, v117
    v_mfma_f32_16x16x32_bf16 v[36:39], a[84:87], v[72:75], v[36:39]
    s_waitcnt lgkmcnt(2)
    v_mul_f32 v120, v120, abs(v18)
    v_mul_f32 v121, v121, abs(v19)
    v_mfma_f32_16x16x32_bf16 v[32:35], a[88:91], v[80:83], v[32:35]
    ds_read_b128 v[64:67], v2 offset:26624
    v_cvt_pk_bf16_f32 v17, v120, v121
    v_mfma_f32_16x16x32_bf16 v[40:43], a[88:91], v[84:87], v[40:43]
    v_pk_max_i16 v17, v17, 0
    v_add_f32 v20, v20, v140
    v_mfma_f32_16x16x32_bf16 v[44:47], a[92:95], v[84:87], v[44:47]
    ds_read_b128 v[68:71], v2 offset:27648
    v_add_f32 v21, v21, v141
    v_mfma_f32_16x16x32_bf16 v[36:39], a[92:95], v[80:83], v[36:39]
    s_waitcnt lgkmcnt(2)
    v_mul_f32 v120, v20, v117
    v_mul_f32 v121, v21, v117
    v_mfma_f32_16x16x32_bf16 v[32:35], a[96:99], v[56:59], v[32:35]
    ds_read_b128 v[72:75], v2 offset:28672
    v_mul_f32 v120, v120, abs(v20)
    v_mfma_f32_16x16x32_bf16 v[40:43], a[96:99], v[60:63], v[40:43]
    v_mul_f32 v121, v121, abs(v21)
    v_cvt_pk_bf16_f32 v18, v120, v121
    v_mfma_f32_16x16x32_bf16 v[44:47], a[100:103], v[60:63], v[44:47]
    ds_read_b128 v[76:79], v2 offset:29696
    buffer_load_dword v7, v5, s[16:19], s45 offen sc1
    v_mfma_f32_16x16x32_bf16 v[36:39], a[100:103], v[56:59], v[36:39]
    s_waitcnt lgkmcnt(2)
    v_pk_max_i16 v18, v18, 0
    v_add_f32 v22, v22, v142
    v_mfma_f32_16x16x32_bf16 v[32:35], a[104:107], v[64:67], v[32:35]
    ds_read_b128 v[80:83], v2 offset:30720
    v_add_f32 v23, v23, v143
    v_mfma_f32_16x16x32_bf16 v[40:43], a[104:107], v[68:71], v[40:43]
    v_mul_f32 v120, v22, v117
    v_mul_f32 v121, v23, v117
    v_mfma_f32_16x16x32_bf16 v[44:47], a[108:111], v[68:71], v[44:47]
    ds_read_b128 v[84:87], v2 offset:31744
    v_mul_f32 v120, v120, abs(v22)
    v_mfma_f32_16x16x32_bf16 v[36:39], a[108:111], v[64:67], v[36:39]
    s_waitcnt vmcnt(6) lgkmcnt(2)
    s_barrier
    v_mul_f32 v121, v121, abs(v23)
    v_mfma_f32_16x16x32_bf16 v[32:35], a[112:115], v[72:75], v[32:35]
    ds_read_b128 v[56:59], v2 offset:32768
    v_cvt_pk_bf16_f32 v19, v120, v121
    v_mfma_f32_16x16x32_bf16 v[40:43], a[112:115], v[76:79], v[40:43]
    v_pk_max_i16 v19, v19, 0
    buffer_store_dwordx4 v[16:19], v1, s[16:19], s44 offen offset:1024 sc1
    v_mfma_f32_16x16x32_bf16 v[44:47], a[116:119], v[76:79], v[44:47]
    s_add_u32 m0, s43, 0
    ds_read_b128 v[60:63], v2 offset:33792
    ds_read_b64 v[144:145], v118 offset:0
    v_mfma_f32_16x16x32_bf16 v[36:39], a[116:119], v[72:75], v[36:39]
    s_waitcnt lgkmcnt(3)
    ds_read_b64 v[146:147], v118 offset:128
    ds_read_b64 v[148:149], v118 offset:256
    v_mfma_f32_16x16x32_bf16 v[32:35], a[120:123], v[80:83], v[32:35]
    s_add_u32 s42, s41, 0
    ds_read_b128 v[64:67], v2 offset:34816
    ds_read_b64 v[150:151], v118 offset:384
    v_mfma_f32_16x16x32_bf16 v[40:43], a[120:123], v[84:87], v[40:43]
    v_mfma_f32_16x16x32_bf16 v[44:47], a[124:127], v[84:87], v[44:47]
    ds_read_b128 v[68:71], v2 offset:35840
    v_mfma_f32_16x16x32_bf16 v[36:39], a[124:127], v[80:83], v[36:39]
    s_waitcnt lgkmcnt(6)
    v_mfma_f32_16x16x32_bf16 v[32:35], a[128:131], v[56:59], v[32:35]
    ds_read_b128 v[72:75], v2 offset:36864
    v_mfma_f32_16x16x32_bf16 v[40:43], a[128:131], v[60:63], v[40:43]
    s_waitcnt lgkmcnt(2)
    v_max3_u32 v152, v144, v145, v146
    v_max3_u32 v153, v147, v148, v149
    v_mfma_f32_16x16x32_bf16 v[44:47], a[132:135], v[60:63], v[44:47]
    ds_read_b128 v[76:79], v2 offset:37888
    v_max3_u32 v152, v152, v150, v151
    v_mfma_f32_16x16x32_bf16 v[36:39], a[132:135], v[56:59], v[36:39]
    s_waitcnt lgkmcnt(2)
    v_max_u32 v152, v152, v153
    v_cmp_eq_u32 vcc, -1, v152
    v_mfma_f32_16x16x32_bf16 v[32:35], a[136:139], v[64:67], v[32:35]
    ds_read_b128 v[80:83], v2 offset:38912
    v_mfma_f32_16x16x32_bf16 v[40:43], a[136:139], v[68:71], v[40:43]
    s_cbranch_vccnz L_sspin55
L_sback56:
    v_add_f32 v152, v148, v150
    v_add_f32 v153, v149, v151
    v_mfma_f32_16x16x32_bf16 v[44:47], a[140:143], v[68:71], v[44:47]
    ds_read_b128 v[84:87], v2 offset:39936
    v_add_f32 v144, v144, v146
    v_mfma_f32_16x16x32_bf16 v[36:39], a[140:143], v[64:67], v[36:39]
    s_waitcnt lgkmcnt(2)
    v_add_f32 v145, v145, v147
    v_add_f32 v144, v144, v152
    v_mfma_f32_16x16x32_bf16 v[32:35], a[144:147], v[72:75], v[32:35]
    ds_read_b128 v[56:59], v2 offset:40960
    v_add_f32 v145, v145, v153
    v_mfma_f32_16x16x32_bf16 v[40:43], a[144:147], v[76:79], v[40:43]
    v_mov_b32 v152, v144
    v_mov_b32 v153, v145
    v_mfma_f32_16x16x32_bf16 v[44:47], a[148:151], v[76:79], v[44:47]
    ds_read_b128 v[60:63], v2 offset:41984
    v_permlane32_swap_b32 v144, v152
    v_mfma_f32_16x16x32_bf16 v[36:39], a[148:151], v[72:75], v[36:39]
    s_waitcnt lgkmcnt(2)
    v_permlane32_swap_b32 v145, v153
    v_mfma_f32_16x16x32_bf16 v[32:35], a[152:155], v[80:83], v[32:35]
    ds_read_b128 v[64:67], v2 offset:43008
    v_add_f32 v144, v144, v152
    v_mfma_f32_16x16x32_bf16 v[40:43], a[152:155], v[84:87], v[40:43]
    v_add_f32 v145, v145, v153
    v_mul_f32 v112, 0xba800000, v144
    v_mfma_f32_16x16x32_bf16 v[44:47], a[156:159], v[84:87], v[44:47]
    ds_read_b128 v[68:71], v2 offset:44032
    v_mul_f32 v145, 0x3a800000, v145
    v_mfma_f32_16x16x32_bf16 v[36:39], a[156:159], v[80:83], v[36:39]
    s_waitcnt lgkmcnt(2)
    v_fma_f32 v145, -v112, v112, v145
    v_mov_b32 v113, v112
    v_mfma_f32_16x16x32_bf16 v[32:35], a[160:163], v[56:59], v[32:35]
    ds_read_b128 v[72:75], v2 offset:45056
    v_max_f32 v145, 0, v145
    v_mfma_f32_16x16x32_bf16 v[40:43], a[160:163], v[60:63], v[40:43]
    v_add_f32 v145, 0x3727c5ac, v145
    v_rsq_f32 v116, v145
    v_mfma_f32_16x16x32_bf16 v[44:47], a[164:167], v[60:63], v[44:47]
    ds_read_b128 v[76:79], v2 offset:46080
    v_permlane16_swap_b32 v112, v113
    v_mfma_f32_16x16x32_bf16 v[36:39], a[164:167], v[56:59], v[36:39]
    s_waitcnt lgkmcnt(2)
    v_mul_f32 v114, v145, v116
    v_mul_f32 v116, v116, v116
    v_mfma_f32_16x16x32_bf16 v[32:35], a[168:171], v[64:67], v[32:35]
    s_waitcnt vmcnt(0)
    ds_read_b128 v[80:83], v2 offset:47104
    v_mov_b32 v115, v114
    v_mfma_f32_16x16x32_bf16 v[40:43], a[168:171], v[68:71], v[40:43]
    s_barrier
    buffer_store_dword v124, v124, s[16:19], s91 offen sc1
    v_mfma_f32_16x16x32_bf16 v[44:47], a[172:175], v[68:71], v[44:47]
    s_add_u32 s91, s91, 65536
    ds_read_b128 v[84:87], v2 offset:48128
    v_cmp_ne_u32 vcc, 0, v7
    v_mfma_f32_16x16x32_bf16 v[36:39], a[172:175], v[64:67], v[36:39]
    s_waitcnt lgkmcnt(2)
    v_mov_b32 v117, v116
    v_permlane16_swap_b32 v114, v115
    v_mfma_f32_16x16x32_bf16 v[32:35], a[176:179], v[72:75], v[32:35]
    s_cbranch_vccnz L_spin53
L_back54:
    ds_read_b128 v[56:59], v2 offset:49152
    v_permlane16_swap_b32 v116, v117
    v_mfma_f32_16x16x32_bf16 v[40:43], a[176:179], v[76:79], v[40:43]
    s_barrier
    buffer_load_dwordx4 v1, s[16:19], s42 offen offset:0 sc1 lds
    v_mfma_f32_16x16x32_bf16 v[44:47], a[180:183], v[76:79], v[44:47]
    s_add_u32 s46, s46, 2048
    ds_read_b128 v[60:63], v2 offset:50176
    buffer_load_dwordx4 v1, s[16:19], s42 offen offset:1024 sc1 lds
    v_mfma_f32_16x16x32_bf16 v[36:39], a[180:183], v[72:75], v[36:39]
    s_waitcnt lgkmcnt(2)
    buffer_load_dwordx4 v1, s[16:19], s42 offen offset:2048 sc1 lds
    v_mfma_f32_16x16x32_bf16 v[32:35], a[184:187], v[80:83], v[32:35]
    ds_read_b128 v[64:67], v2 offset:51200
    buffer_load_dwordx4 v1, s[16:19], s42 offen offset:3072 sc1 lds
    v_mfma_f32_16x16x32_bf16 v[40:43], a[184:187], v[84:87], v[40:43]
    s_add_u32 m0, s43, 16384
    v_mul_f32 v128, v112, v88
    v_fmac_f32 v128, v114, v100
    v_mfma_f32_16x16x32_bf16 v[44:47], a[188:191], v[84:87], v[44:47]
    s_add_u32 s42, s41, 16384
    ds_read_b128 v[68:71], v2 offset:52224
    v_mul_f32 v129, v112, v89
    v_mfma_f32_16x16x32_bf16 v[36:39], a[188:191], v[80:83], v[36:39]
    s_waitcnt lgkmcnt(2)
    v_fmac_f32 v129, v114, v101
    v_mul_f32 v130, v112, v90
    v_mfma_f32_16x16x32_bf16 v[32:35], a[192:195], v[56:59], v[32:35]
    ds_read_b128 v[72:75], v2 offset:53248
    buffer_load_dwordx4 v1, s[16:19], s42 offen offset:0 sc1 lds
    v_mfma_f32_16x16x32_bf16 v[40:43], a[192:195], v[60:63], v[40:43]
    v_fmac_f32 v130, v114, v102
    v_mul_f32 v131, v112, v91
    v_mfma_f32_16x16x32_bf16 v[44:47], a[196:199], v[60:63], v[44:47]
    ds_read_b128 v[76:79], v2 offset:54272
    v_fmac_f32 v131, v114, v103
    v_mfma_f32_16x16x32_bf16 v[36:39], a[196:199], v[56:59], v[36:39]
    s_waitcnt lgkmcnt(2)
    v_mul_f32 v132, v112, v92
    v_fmac_f32 v132, v114, v104
    v_mfma_f32_16x16x32_bf16 v[32:35], a[200:203], v[64:67], v[32:35]
    ds_read_b128 v[80:83], v2 offset:55296
    buffer_load_dwordx4 v1, s[16:19], s42 offen offset:1024 sc1 lds
    v_mfma_f32_16x16x32_bf16 v[40:43], a[200:203], v[68:71], v[40:43]
    v_mul_f32 v133, v112, v93
    v_fmac_f32 v133, v114, v105
    v_mfma_f32_16x16x32_bf16 v[44:47], a[204:207], v[68:71], v[44:47]
    ds_read_b128 v[84:87], v2 offset:56320
    v_mul_f32 v134, v112, v94
    v_mfma_f32_16x16x32_bf16 v[36:39], a[204:207], v[64:67], v[36:39]
    s_waitcnt lgkmcnt(2)
    v_fmac_f32 v134, v114, v106
    v_mul_f32 v135, v112, v95
    v_mfma_f32_16x16x32_bf16 v[32:35], a[208:211], v[72:75], v[32:35]
    ds_read_b128 v[56:59], v2 offset:57344
    buffer_load_dwordx4 v1, s[16:19], s42 offen offset:2048 sc1 lds
    v_mfma_f32_16x16x32_bf16 v[40:43], a[208:211], v[76:79], v[40:43]
    v_fmac_f32 v135, v114, v107
    v_mul_f32 v136, v113, v88
    v_mfma_f32_16x16x32_bf16 v[44:47], a[212:215], v[76:79], v[44:47]
    ds_read_b128 v[60:63], v2 offset:58368
    v_fmac_f32 v136, v115, v100
    v_mfma_f32_16x16x32_bf16 v[36:39], a[212:215], v[72:75], v[36:39]
    s_waitcnt lgkmcnt(2)
    v_mul_f32 v137, v113, v89
    v_fmac_f32 v137, v115, v101
    v_mfma_f32_16x16x32_bf16 v[32:35], a[216:219], v[80:83], v[32:35]
    ds_read_b128 v[64:67], v2 offset:59392
    buffer_load_dwordx4 v1, s[16:19], s42 offen offset:3072 sc1 lds
    v_mfma_f32_16x16x32_bf16 v[40:43], a[216:219], v[84:87], v[40:43]
    s_add_u32 s45, s45, 65536
    v_mul_f32 v138, v113, v90
    v_fmac_f32 v138, v115, v102
    v_mfma_f32_16x16x32_bf16 v[44:47], a[220:223], v[84:87], v[44:47]
    ds_read_b128 v[68:71], v2 offset:60416
    v_mul_f32 v139, v113, v91
    v_mfma_f32_16x16x32_bf16 v[36:39], a[220:223], v[80:83], v[36:39]
    s_waitcnt lgkmcnt(2)
    v_fmac_f32 v139, v115, v103
    v_mul_f32 v140, v113, v92
    v_mfma_f32_16x16x32_bf16 v[32:35], a[224:227], v[56:59], v[32:35]
    ds_read_b128 v[72:75], v2 offset:61440
    v_fmac_f32 v140, v115, v104
    v_mfma_f32_16x16x32_bf16 v[40:43], a[224:227], v[60:63], v[40:43]
    v_mul_f32 v141, v113, v93
    v_fmac_f32 v141, v115, v105
    v_mfma_f32_16x16x32_bf16 v[44:47], a[228:231], v[60:63], v[44:47]
    ds_read_b128 v[76:79], v2 offset:62464
    v_mul_f32 v142, v113, v94
    v_mfma_f32_16x16x32_bf16 v[36:39], a[228:231], v[56:59], v[36:39]
    s_waitcnt lgkmcnt(2)
    v_fmac_f32 v142, v115, v106
    v_mul_f32 v143, v113, v95
    v_mfma_f32_16x16x32_bf16 v[32:35], a[232:235], v[64:67], v[32:35]
    ds_read_b128 v[80:83], v2 offset:63488
    v_fmac_f32 v143, v115, v107
    v_mfma_f32_16x16x32_bf16 v[40:43], a[232:235], v[68:71], v[40:43]
    v_mfma_f32_16x16x32_bf16 v[44:47], a[236:239], v[68:71], v[44:47]
    ds_read_b128 v[84:87], v2 offset:64512
    v_mfma_f32_16x16x32_bf16 v[36:39], a[236:239], v[64:67], v[36:39]
    s_waitcnt vmcnt(4) lgkmcnt(2)
    s_barrier
    v_mfma_f32_16x16x32_bf16 v[32:35], a[240:243], v[72:75], v[32:35]
    ds_read_b128 v[56:59], v1 offset:0
    v_mfma_f32_16x16x32_bf16 v[40:43], a[240:243], v[76:79], v[40:43]
    v_mfma_f32_16x16x32_bf16 v[44:47], a[244:247], v[76:79], v[44:47]
    ds_read_b128 v[60:63], v1 offset:1024
    v_mfma_f32_16x16x32_bf16 v[36:39], a[244:247], v[72:75], v[36:39]
    s_waitcnt lgkmcnt(2)
    v_mfma_f32_16x16x32_bf16 v[32:35], a[248:251], v[80:83], v[32:35]
    ds_read_b128 v[64:67], v1 offset:2048
    v_mfma_f32_16x16x32_bf16 v[40:43], a[248:251], v[84:87], v[40:43]
    v_mfma_f32_16x16x32_bf16 v[44:47], a[252:255], v[84:87], v[44:47]
    ds_read_b128 v[68:71], v1 offset:3072
    v_mfma_f32_16x16x32_bf16 v[36:39], a[252:255], v[80:83], v[36:39]
    s_add_u32 s36, s36, 1
    s_cmp_lt_u32 s36, 32
    s_cbranch_scc1 L_l_b0
    s_nop 7
    s_and_b32 s44, s90, 0xffffffff
    s_cmp_lt_i32 s36, 1
    s_cselect_b32 s44, 0x5e00000, s44
    s_add_u32 s90, s90, 262144
    v_add_f32 v32, v32, v128
    v_add_f32 v33, v33, v129
    v_mul_f32 v120, v32, v116
    v_mul_f32 v121, v33, v116
    v_mul_f32 v120, v120, abs(v32)
    v_mul_f32 v121, v121, abs(v33)
    v_cvt_pk_bf16_f32 v32, v120, v121
    v_pk_max_i16 v32, v32, 0
    v_add_f32 v34, v34, v130
    v_add_f32 v35, v35, v131
    v_mul_f32 v120, v34, v116
    v_mul_f32 v121, v35, v116
    v_mul_f32 v120, v120, abs(v34)
    v_mul_f32 v121, v121, abs(v35)
    v_cvt_pk_bf16_f32 v33, v120, v121
    v_pk_max_i16 v33, v33, 0
    v_add_f32 v36, v36, v132
    v_add_f32 v37, v37, v133
    v_mul_f32 v120, v36, v116
    v_mul_f32 v121, v37, v116
    v_mul_f32 v120, v120, abs(v36)
    v_mul_f32 v121, v121, abs(v37)
    v_cvt_pk_bf16_f32 v34, v120, v121
    v_pk_max_i16 v34, v34, 0
    v_add_f32 v38, v38, v134
    v_add_f32 v39, v39, v135
    v_mul_f32 v120, v38, v116
    v_mul_f32 v121, v39, v116
    v_mul_f32 v120, v120, abs(v38)
    v_mul_f32 v121, v121, abs(v39)
    v_cvt_pk_bf16_f32 v35, v120, v121
    v_pk_max_i16 v35, v35, 0
    buffer_store_dwordx4 v[32:35], v1, s[16:19], s44 offen offset:0 sc1
    v_add_f32 v40, v40, v136
    v_add_f32 v41, v41, v137
    v_mul_f32 v120, v40, v117
    v_mul_f32 v121, v41, v117
    v_mul_f32 v120, v120, abs(v40)
    v_mul_f32 v121, v121, abs(v41)
    v_cvt_pk_bf16_f32 v40, v120, v121
    v_pk_max_i16 v40, v40, 0
    v_add_f32 v42, v42, v138
    v_add_f32 v43, v43, v139
    v_mul_f32 v120, v42, v117
    v_mul_f32 v121, v43, v117
    v_mul_f32 v120, v120, abs(v42)
    v_mul_f32 v121, v121, abs(v43)
    v_cvt_pk_bf16_f32 v41, v120, v121
    v_pk_max_i16 v41, v41, 0
    v_add_f32 v44, v44, v140
    v_add_f32 v45, v45, v141
    v_mul_f32 v120, v44, v117
    v_mul_f32 v121, v45, v117
    v_mul_f32 v120, v120, abs(v44)
    v_mul_f32 v121, v121, abs(v45)
    v_cvt_pk_bf16_f32 v42, v120, v121
    v_pk_max_i16 v42, v42, 0
    v_add_f32 v46, v46, v142
    v_add_f32 v47, v47, v143
    v_mul_f32 v120, v46, v117
    v_mul_f32 v121, v47, v117
    v_mul_f32 v120, v120, abs(v46)
    v_mul_f32 v121, v121, abs(v47)
    v_cvt_pk_bf16_f32 v43, v120, v121
    v_pk_max_i16 v43, v43, 0
    buffer_store_dwordx4 v[40:43], v1, s[16:19], s44 offen offset:1024 sc1
    s_waitcnt vmcnt(0)
    s_barrier
    buffer_store_dword v124, v124, s[16:19], s91 offen sc1
    s_add_u32 s91, s91, 65536
    s_waitcnt vmcnt(0)
    s_endpgm
L_spin45:
    s_mov_b32 s40, 0x20000
L_spin45_l:
    buffer_load_dword v56, v124, s[20:23], 0 offen sc1
    s_sub_u32 s40, s40, 1
    s_waitcnt vmcnt(0)
    v_cmp_eq_u32 vcc, v124, v56
    s_cbranch_scc1 L_back46
    s_cbranch_vccz L_back46
    s_sleep 8
    s_branch L_spin45_l
L_spin47:
    s_mov_b32 s40, 0x20000
L_spin47_l:
    buffer_load_dword v7, v5, s[16:19], s45 offen sc1
    s_sub_u32 s40, s40, 1
    s_waitcnt vmcnt(0)
    v_cmp_ne_u32 vcc, 0, v7
    s_cbranch_scc1 L_back48
    s_cbranch_vccz L_back48
    s_sleep 2
    s_branch L_spin47_l
L_spin49:
    s_mov_b32 s40, 0x20000
L_spin49_l:
    buffer_load_dword v7, v5, s[16:19], s45 offen sc1
    s_sub_u32 s40, s40, 1
    s_waitcnt vmcnt(0)
    v_cmp_ne_u32 vcc, 0, v7
    s_cbranch_scc1 L_back50
    s_cbranch_vccz L_back50
    s_sleep 2
    s_branch L_spin49_l
L_sspin51:
    s_mov_b32 s40, 0x20000
L_sspin51_l:
    buffer_load_dwordx2 v[144:145], v6, s[16:19], s46 offen offset:0 sc1
    buffer_load_dwordx2 v[146:147], v6, s[16:19], s46 offen offset:128 sc1
    buffer_load_dwordx2 v[148:149], v6, s[16:19], s46 offen offset:256 sc1
    buffer_load_dwordx2 v[150:151], v6, s[16:19], s46 offen offset:384 sc1
    s_sub_u32 s40, s40, 1
    s_waitcnt vmcnt(0)
    v_max3_u32 v152, v144, v145, v146
    v_max3_u32 v153, v147, v148, v149
    v_max3_u32 v152, v152, v150, v151
    v_max_u32 v152, v152, v153
    v_cmp_eq_u32 vcc, -1, v152
    s_cbranch_scc1 L_sback52
    s_cbranch_vccz L_sback52
    s_sleep 4
    s_branch L_sspin51_l
L_spin53:
    s_mov_b32 s40, 0x20000
L_spin53_l:
    buffer_load_dword v7, v5, s[16:19], s45 offen sc1
    s_sub_u32 s40, s40, 1
    s_waitcnt vmcnt(0)
    v_cmp_ne_u32 vcc, 0, v7
    s_cbranch_scc1 L_back54
    s_cbranch_vccz L_back54
    s_sleep 2
    s_branch L_spin53_l
L_sspin55:
    s_mov_b32 s40, 0x20000
L_sspin55_l:
    buffer_load_dwordx2 v[144:145], v6, s[16:19], s46 offen offset:0 sc1
    buffer_load_dwordx2 v[146:147], v6, s[16:19], s46 offen offset:128 sc1
    buffer_load_dwordx2 v[148:149], v6, s[16:19], s46 offen offset:256 sc1
    buffer_load_dwordx2 v[150:151], v6, s[16:19], s46 offen offset:384 sc1
    s_sub_u32 s40, s40, 1
    s_waitcnt vmcnt(0)
    v_max3_u32 v152, v144, v145, v146
    v_max3_u32 v153, v147, v148, v149
    v_max3_u32 v152, v152, v150, v151
    v_max_u32 v152, v152, v153
    v_cmp_eq_u32 vcc, -1, v152
    s_cbranch_scc1 L_sback56
    s_cbranch_vccz L_sback56
    s_sleep 4
    s_branch L_sspin55_l
L_role_44:
    s_sub_u32 s35, s34, 44
    s_cmp_ge_u32 s35, 12
    s_cbranch_scc1 L_bf_nost
    s_lshl_b32 s50, s33, 4
    s_add_u32 s50, s50, s35
    s_lshl_b32 s50, s50, 1
    s_lshl_b32 s46, s50, 15
    s_lshl_b32 s37, s32, 9
    s_add_u32 s46, s46, s37
    v_lshrrev_b32 v48, 3, v0
    v_and_b32 v49, 0x70, v1
    v_lshl_add_u32 v48, v48, 11, v49
    v_add_u32 v49, 16384, v48
    s_mov_b32 s8, s64
    s_mov_b32 s9, s65
    s_mov_b32 s10, 0x400000
    s_mov_b32 s11, 0x00020000
    buffer_load_dwordx4 v[16:19], v48, s[8:11], s46 offen offset:0
    buffer_load_dwordx4 v[20:23], v48, s[8:11], s46 offen offset:128
    buffer_load_dwordx4 v[24:27], v48, s[8:11], s46 offen offset:256
    buffer_load_dwordx4 v[28:31], v48, s[8:11], s46 offen offset:384
    buffer_load_dwordx4 v[32:35], v49, s[8:11], s46 offen offset:0
    buffer_load_dwordx4 v[36:39], v49, s[8:11], s46 offen offset:128
    buffer_load_dwordx4 v[40:43], v49, s[8:11], s46 offen offset:256
    buffer_load_dwordx4 v[44:47], v49, s[8:11], s46 offen offset:384
    s_xor_b32 s50, s50, 1
    s_lshl_b32 s46, s50, 15
    s_lshl_b32 s37, s32, 9
    s_add_u32 s46, s46, s37
    v_lshrrev_b32 v96, 3, v0
    v_and_b32 v97, 0x70, v1
    v_lshl_add_u32 v96, v96, 11, v97
    v_add_u32 v97, 16384, v96
    s_mov_b32 s8, s64
    s_mov_b32 s9, s65
    s_mov_b32 s10, 0x400000
    s_mov_b32 s11, 0x00020000
    buffer_load_dwordx4 v[64:67], v96, s[8:11], s46 offen offset:0
    buffer_load_dwordx4 v[68:71], v96, s[8:11], s46 offen offset:128
    buffer_load_dwordx4 v[72:75], v96, s[8:11], s46 offen offset:256
    buffer_load_dwordx4 v[76:79], v96, s[8:11], s46 offen offset:384
    buffer_load_dwordx4 v[80:83], v97, s[8:11], s46 offen offset:0
    buffer_load_dwordx4 v[84:87], v97, s[8:11], s46 offen offset:128
    buffer_load_dwordx4 v[88:91], v97, s[8:11], s46 offen offset:256
    buffer_load_dwordx4 v[92:95], v97, s[8:11], s46 offen offset:384
    s_xor_b32 s50, s50, 1
    s_mov_b32 s86, 0x3f803f80
    v_and_b32 v56, 1, v0
    v_lshlrev_b32 v56, 7, v56
    v_bfe_u32 v57, v0, 1, 1
    v_lshl_add_u32 v56, v57, 6, v56
    v_and_b32 v57, 0x38, v0
    v_add_u32 v56, v57, v56
    s_sub_u32 s46, 127, s50
    s_lshl_b32 s46, s46, 10
    s_lshl_b32 s37, s32, 8
    s_add_u32 s46, s46, s37
    s_add_u32 s46, s46, 0x5400000
    s_waitcnt vmcnt(8)
    v_dot2_f32_bf16 v48, v16, s86, 0
    v_dot2_f32_bf16 v49, v16, v16, 0
    v_dot2_f32_bf16 v50, v24, s86, 0
    v_dot2_f32_bf16 v51, v24, v24, 0
    v_dot2_f32_bf16 v52, v32, s86, 0
    v_dot2_f32_bf16 v53, v32, v32, 0
    v_dot2_f32_bf16 v54, v40, s86, 0
    v_dot2_f32_bf16 v55, v40, v40, 0
    v_dot2_f32_bf16 v48, v17, s86, v48
    v_dot2_f32_bf16 v49, v17, v17, v49
    v_dot2_f32_bf16 v50, v25, s86, v50
    v_dot2_f32_bf16 v51, v25, v25, v51
    v_dot2_f32_bf16 v52, v33, s86, v52
    v_dot2_f32_bf16 v53, v33, v33, v53
    v_dot2_f32_bf16 v54, v41, s86, v54
    v_dot2_f32_bf16 v55, v41, v41, v55
    v_dot2_f32_bf16 v48, v18, s86, v48
    v_dot2_f32_bf16 v49, v18, v18, v49
    v_dot2_f32_bf16 v50, v26, s86, v50
    v_dot2_f32_bf16 v51, v26, v26, v51
    v_dot2_f32_bf16 v52, v34, s86, v52
    v_dot2_f32_bf16 v53, v34, v34, v53
    v_dot2_f32_bf16 v54, v42, s86, v54
    v_dot2_f32_bf16 v55, v42, v42, v55
    v_dot2_f32_bf16 v48, v19, s86, v48
    v_dot2_f32_bf16 v49, v19, v19, v49
    v_dot2_f32_bf16 v50, v27, s86, v50
    v_dot2_f32_bf16 v51, v27, v27, v51
    v_dot2_f32_bf16 v52, v35, s86, v52
    v_dot2_f32_bf16 v53, v35, v35, v53
    v_dot2_f32_bf16 v54, v43, s86, v54
    v_dot2_f32_bf16 v55, v43, v43, v55
    v_dot2_f32_bf16 v48, v20, s86, v48
    v_dot2_f32_bf16 v49, v20, v20, v49
    v_dot2_f32_bf16 v50, v28, s86, v50
    v_dot2_f32_bf16 v51, v28, v28, v51
    v_dot2_f32_bf16 v52, v36, s86, v52
    v_dot2_f32_bf16 v53, v36, v36, v53
    v_dot2_f32_bf16 v54, v44, s86, v54
    v_dot2_f32_bf16 v55, v44, v44, v55
    v_dot2_f32_bf16 v48, v21, s86, v48
    v_dot2_f32_bf16 v49, v21, v21, v49
    v_dot2_f32_bf16 v50, v29, s86, v50
    v_dot2_f32_bf16 v51, v29, v29, v51
    v_dot2_f32_bf16 v52, v37, s86, v52
    v_dot2_f32_bf16 v53, v37, v37, v53
    v_dot2_f32_bf16 v54, v45, s86, v54
    v_dot2_f32_bf16 v55, v45, v45, v55
    v_dot2_f32_bf16 v48, v22, s86, v48
    v_dot2_f32_bf16 v49, v22, v22, v49
    v_dot2_f32_bf16 v50, v30, s86, v50
    v_dot2_f32_bf16 v51, v30, v30, v51
    v_dot2_f32_bf16 v52, v38, s86, v52
    v_dot2_f32_bf16 v53, v38, v38, v53
    v_dot2_f32_bf16 v54, v46, s86, v54
    v_dot2_f32_bf16 v55, v46, v46, v55
    v_dot2_f32_bf16 v48, v23, s86, v48
    v_dot2_f32_bf16 v49, v23, v23, v49
    v_dot2_f32_bf16 v50, v31, s86, v50
    v_dot2_f32_bf16 v51, v31, v31, v51
    v_dot2_f32_bf16 v52, v39, s86, v52
    v_dot2_f32_bf16 v53, v39, v39, v53
    v_dot2_f32_bf16 v54, v47, s86, v54
    v_dot2_f32_bf16 v55, v47, v47, v55
    v_add_f32_dpp v48, v48, v48 quad_perm:[1,0,3,2] row_mask:0xf bank_mask:0xf
    v_add_f32_dpp v49, v49, v49 quad_perm:[1,0,3,2] row_mask:0xf bank_mask:0xf
    v_add_f32_dpp v50, v50, v50 quad_perm:[1,0,3,2] row_mask:0xf bank_mask:0xf
    v_add_f32_dpp v51, v51, v51 quad_perm:[1,0,3,2] row_mask:0xf bank_mask:0xf
    v_add_f32_dpp v52, v52, v52 quad_perm:[1,0,3,2] row_mask:0xf bank_mask:0xf
    v_add_f32_dpp v53, v53, v53 quad_perm:[1,0,3,2] row_mask:0xf bank_mask:0xf
    v_add_f32_dpp v54, v54, v54 quad_perm:[1,0,3,2] row_mask:0xf bank_mask:0xf
    v_add_f32_dpp v55, v55, v55 quad_perm:[1,0,3,2] row_mask:0xf bank_mask:0xf
    v_add_f32_dpp v48, v48, v48 quad_perm:[2,3,0,1] row_mask:0xf bank_mask:0xf
    v_add_f32_dpp v49, v49, v49 quad_perm:[2,3,0,1] row_mask:0xf bank_mask:0xf
    v_add_f32_dpp v50, v50, v50 quad_perm:[2,3,0,1] row_mask:0xf bank_mask:0xf
    v_add_f32_dpp v51, v51, v51 quad_perm:[2,3,0,1] row_mask:0xf bank_mask:0xf
    v_add_f32_dpp v52, v52, v52 quad_perm:[2,3,0,1] row_mask:0xf bank_mask:0xf
    v_add_f32_dpp v53, v53, v53 quad_perm:[2,3,0,1] row_mask:0xf bank_mask:0xf
    v_add_f32_dpp v54, v54, v54 quad_perm:[2,3,0,1] row_mask:0xf bank_mask:0xf
    v_add_f32_dpp v55, v55, v55 quad_perm:[2,3,0,1] row_mask:0xf bank_mask:0xf
    v_add_f32_dpp v48, v48, v48 row_half_mirror row_mask:0xf bank_mask:0xf
    v_add_f32_dpp v49, v49, v49 row_half_mirror row_mask:0xf bank_mask:0xf
    v_add_f32_dpp v50, v50, v50 row_half_mirror row_mask:0xf bank_mask:0xf
    v_add_f32_dpp v51, v51, v51 row_half_mirror row_mask:0xf bank_mask:0xf
    v_add_f32_dpp v52, v52, v52 row_half_mirror row_mask:0xf bank_mask:0xf
    v_add_f32_dpp v53, v53, v53 row_half_mirror row_mask:0xf bank_mask:0xf
    v_add_f32_dpp v54, v54, v54 row_half_mirror row_mask:0xf bank_mask:0xf
    v_add_f32_dpp v55, v55, v55 row_half_mirror row_mask:0xf bank_mask:0xf
    s_mov_b32 exec_lo, 0x2020202
    s_mov_b32 exec_hi, 0x2020202
    v_mov_b32 v48, v50
    v_mov_b32 v49, v51
    s_mov_b32 exec_lo, 0x4040404
    s_mov_b32 exec_hi, 0x4040404
    v_mov_b32 v48, v52
    v_mov_b32 v49, v53
    s_mov_b32 exec_lo, 0x8080808
    s_mov_b32 exec_hi, 0x8080808
    v_mov_b32 v48, v54
    v_mov_b32 v49, v55
    s_mov_b32 exec_lo, 0x0f0f0f0f
    s_mov_b32 exec_hi, 0x0f0f0f0f
    buffer_store_dwordx2 v[48:49], v56, s[16:19], s46 offen sc1
    s_mov_b64 exec, -1
    s_xor_b32 s50, s50, 1
    s_mov_b32 s86, 0x3f803f80
    v_and_b32 v104, 1, v0
    v_lshlrev_b32 v104, 7, v104
    v_bfe_u32 v105, v0, 1, 1
    v_lshl_add_u32 v104, v105, 6, v104
    v_and_b32 v105, 0x38, v0
    v_add_u32 v104, v105, v104
    s_sub_u32 s46, 127, s50
    s_lshl_b32 s46, s46, 10
    s_lshl_b32 s37, s32, 8
    s_add_u32 s46, s46, s37
    s_add_u32 s46, s46, 0x5400000
    s_waitcnt vmcnt(1)
    v_dot2_f32_bf16 v96, v64, s86, 0
    v_dot2_f32_bf16 v97, v64, v64, 0
    v_dot2_f32_bf16 v98, v72, s86, 0
    v_dot2_f32_bf16 v99, v72, v72, 0
    v_dot2_f32_bf16 v100, v80, s86, 0
    v_dot2_f32_bf16 v101, v80, v80, 0
    v_dot2_f32_bf16 v102, v88, s86, 0
    v_dot2_f32_bf16 v103, v88, v88, 0
    v_dot2_f32_bf16 v96, v65, s86, v96
    v_dot2_f32_bf16 v97, v65, v65, v97
    v_dot2_f32_bf16 v98, v73, s86, v98
    v_dot2_f32_bf16 v99, v73, v73, v99
    v_dot2_f32_bf16 v100, v81, s86, v100
    v_dot2_f32_bf16 v101, v81, v81, v101
    v_dot2_f32_bf16 v102, v89, s86, v102
    v_dot2_f32_bf16 v103, v89, v89, v103
    v_dot2_f32_bf16 v96, v66, s86, v96
    v_dot2_f32_bf16 v97, v66, v66, v97
    v_dot2_f32_bf16 v98, v74, s86, v98
    v_dot2_f32_bf16 v99, v74, v74, v99
    v_dot2_f32_bf16 v100, v82, s86, v100
    v_dot2_f32_bf16 v101, v82, v82, v101
    v_dot2_f32_bf16 v102, v90, s86, v102
    v_dot2_f32_bf16 v103, v90, v90, v103
    v_dot2_f32_bf16 v96, v67, s86, v96
    v_dot2_f32_bf16 v97, v67, v67, v97
    v_dot2_f32_bf16 v98, v75, s86, v98
    v_dot2_f32_bf16 v99, v75, v75, v99
    v_dot2_f32_bf16 v100, v83, s86, v100
    v_dot2_f32_bf16 v101, v83, v83, v101
    v_dot2_f32_bf16 v102, v91, s86, v102
    v_dot2_f32_bf16 v103, v91, v91, v103
    v_dot2_f32_bf16 v96, v68, s86, v96
    v_dot2_f32_bf16 v97, v68, v68, v97
    v_dot2_f32_bf16 v98, v76, s86, v98
    v_dot2_f32_bf16 v99, v76, v76, v99
    v_dot2_f32_bf16 v100, v84, s86, v100
    v_dot2_f32_bf16 v101, v84, v84, v101
    v_dot2_f32_bf16 v102, v92, s86, v102
    v_dot2_f32_bf16 v103, v92, v92, v103
    v_dot2_f32_bf16 v96, v69, s86, v96
    v_dot2_f32_bf16 v97, v69, v69, v97
    v_dot2_f32_bf16 v98, v77, s86, v98
    v_dot2_f32_bf16 v99, v77, v77, v99
    v_dot2_f32_bf16 v100, v85, s86, v100
    v_dot2_f32_bf16 v101, v85, v85, v101
    v_dot2_f32_bf16 v102, v93, s86, v102
    v_dot2_f32_bf16 v103, v93, v93, v103
    v_dot2_f32_bf16 v96, v70, s86, v96
    v_dot2_f32_bf16 v97, v70, v70, v97
    v_dot2_f32_bf16 v98, v78, s86, v98
    v_dot2_f32_bf16 v99, v78, v78, v99
    v_dot2_f32_bf16 v100, v86, s86, v100
    v_dot2_f32_bf16 v101, v86, v86, v101
    v_dot2_f32_bf16 v102, v94, s86, v102
    v_dot2_f32_bf16 v103, v94, v94, v103
    v_dot2_f32_bf16 v96, v71, s86, v96
    v_dot2_f32_bf16 v97, v71, v71, v97
    v_dot2_f32_bf16 v98, v79, s86, v98
    v_dot2_f32_bf16 v99, v79, v79, v99
    v_dot2_f32_bf16 v100, v87, s86, v100
    v_dot2_f32_bf16 v101, v87, v87, v101
    v_dot2_f32_bf16 v102, v95, s86, v102
    v_dot2_f32_bf16 v103, v95, v95, v103
    v_add_f32_dpp v96, v96, v96 quad_perm:[1,0,3,2] row_mask:0xf bank_mask:0xf
    v_add_f32_dpp v97, v97, v97 quad_perm:[1,0,3,2] row_mask:0xf bank_mask:0xf
    v_add_f32_dpp v98, v98, v98 quad_perm:[1,0,3,2] row_mask:0xf bank_mask:0xf
    v_add_f32_dpp v99, v99, v99 quad_perm:[1,0,3,2] row_mask:0xf bank_mask:0xf
    v_add_f32_dpp v100, v100, v100 quad_perm:[1,0,3,2] row_mask:0xf bank_mask:0xf
    v_add_f32_dpp v101, v101, v101 quad_perm:[1,0,3,2] row_mask:0xf bank_mask:0xf
    v_add_f32_dpp v102, v102, v102 quad_perm:[1,0,3,2] row_mask:0xf bank_mask:0xf
    v_add_f32_dpp v103, v103, v103 quad_perm:[1,0,3,2] row_mask:0xf bank_mask:0xf
    v_add_f32_dpp v96, v96, v96 quad_perm:[2,3,0,1] row_mask:0xf bank_mask:0xf
    v_add_f32_dpp v97, v97, v97 quad_perm:[2,3,0,1] row_mask:0xf bank_mask:0xf
    v_add_f32_dpp v98, v98, v98 quad_perm:[2,3,0,1] row_mask:0xf bank_mask:0xf
    v_add_f32_dpp v99, v99, v99 quad_perm:[2,3,0,1] row_mask:0xf bank_mask:0xf
    v_add_f32_dpp v100, v100, v100 quad_perm:[2,3,0,1] row_mask:0xf bank_mask:0xf
    v_add_f32_dpp v101, v101, v101 quad_perm:[2,3,0,1] row_mask:0xf bank_mask:0xf
    v_add_f32_dpp v102, v102, v102 quad_perm:[2,3,0,1] row_mask:0xf bank_mask:0xf
    v_add_f32_dpp v103, v103, v103 quad_perm:[2,3,0,1] row_mask:0xf bank_mask:0xf
    v_add_f32_dpp v96, v96, v96 row_half_mirror row_mask:0xf bank_mask:0xf
    v_add_f32_dpp v97, v97, v97 row_half_mirror row_mask:0xf bank_mask:0xf
    v_add_f32_dpp v98, v98, v98 row_half_mirror row_mask:0xf bank_mask:0xf
    v_add_f32_dpp v99, v99, v99 row_half_mirror row_mask:0xf bank_mask:0xf
    v_add_f32_dpp v100, v100, v100 row_half_mirror row_mask:0xf bank_mask:0xf
    v_add_f32_dpp v101, v101, v101 row_half_mirror row_mask:0xf bank_mask:0xf
    v_add_f32_dpp v102, v102, v102 row_half_mirror row_mask:0xf bank_mask:0xf
    v_add_f32_dpp v103, v103, v103 row_half_mirror row_mask:0xf bank_mask:0xf
    s_mov_b32 exec_lo, 0x2020202
    s_mov_b32 exec_hi, 0x2020202
    v_mov_b32 v96, v98
    v_mov_b32 v97, v99
    s_mov_b32 exec_lo, 0x4040404
    s_mov_b32 exec_hi, 0x4040404
    v_mov_b32 v96, v100
    v_mov_b32 v97, v101
    s_mov_b32 exec_lo, 0x8080808
    s_mov_b32 exec_hi, 0x8080808
    v_mov_b32 v96, v102
    v_mov_b32 v97, v103
    s_mov_b32 exec_lo, 0x0f0f0f0f
    s_mov_b32 exec_hi, 0x0f0f0f0f
    buffer_store_dwordx2 v[96:97], v104, s[16:19], s46 offen sc1
    s_mov_b64 exec, -1
    s_xor_b32 s50, s50, 1
L_bf_nost:
    s_cmp_lg_u32 s32, 0
    s_cbranch_scc1 L_arv57
    s_add_u32 s20, s82, 0x80
    s_addc_u32 s21, s83, 0
    s_mov_b32 s22, 0x4
    s_mov_b32 s23, 0x00020000
    buffer_load_dword v8, v124, s[20:23], 0 offen sc1
    s_waitcnt vmcnt(0)
    v_cmp_eq_u32 vcc, v124, v8
    s_cbranch_vccnz L_spin58
L_back59:
L_arv57:
    s_waitcnt vmcnt(0)
    s_barrier
    s_add_u32 s39, s91, 32768
    buffer_store_dword v124, v124, s[16:19], s39 offen sc1
    s_cmp_lt_u32 s35, 12
    s_cbranch_scc1 L_bf_nopf
    s_add_u32 s12, s72, 0x400000
    s_addc_u32 s13, s73, 0
    s_mov_b32 s14, 0x300000
    s_mov_b32 s15, 0x00020000
    s_sub_u32 s37, s35, 12
    s_lshl2_add_u32 s37, s37, s33
    s_lshl2_add_u32 s37, s37, s32
    s_lshl_b32 s37, s37, 13
    v_lshlrev_b32 v6, 7, v0
    buffer_load_dword v240, v6, s[12:15], s37 offen
    s_add_u32 s37, s37, 1048576
    buffer_load_dword v241, v6, s[12:15], s37 offen
    s_add_u32 s37, s37, 1048576
    buffer_load_dword v242, v6, s[12:15], s37 offen
    s_add_u32 s37, s37, 1048576
L_bf_nopf:
    s_lshr_b32 s51, s35, 2
    s_and_b32 s87, s35, 3
    s_mul_i32 s54, s51, 1441792
    s_lshl_b32 s37, s87, 9
    s_add_u32 s54, s54, s37
    s_mov_b32 s12, s76
    s_mov_b32 s13, s77
    s_mov_b32 s14, 0x700000
    s_mov_b32 s15, 0x00020000
    s_mov_b32 s39, 2048
    v_lshrrev_b32 v64, 3, v0
    v_lshlrev_b32 v65, 2, v0
    v_and_b32 v65, 64, v65
    v_and_b32 v66, 0x70, v1
    v_xor_b32 v65, v65, v66
    v_mad_u32_u24 v48, v64, s39, v65
    v_add_u32 v49, 16384, v48
    v_add_u32 v50, 128, v48
    v_add_u32 v51, 16512, v48
    v_add_u32 v52, 256, v48
    v_add_u32 v53, 16640, v48
    v_add_u32 v54, 384, v48
    v_add_u32 v55, 16768, v48
    s_mul_i32 s38, s32, 32768
    s_add_u32 s54, s54, s38
    s_lshl_b32 s42, s32, 11
    s_add_u32 m0, s42, 0
    s_nop 0
    buffer_load_dwordx4 v48, s[12:15], s54 offen lds
    s_add_u32 m0, s42, 1024
    s_nop 0
    buffer_load_dwordx4 v49, s[12:15], s54 offen lds
    s_add_u32 m0, s42, 8192
    s_nop 0
    buffer_load_dwordx4 v50, s[12:15], s54 offen lds
    s_add_u32 m0, s42, 9216
    s_nop 0
    buffer_load_dwordx4 v51, s[12:15], s54 offen lds
    s_add_u32 m0, s42, 16384
    s_nop 0
    buffer_load_dwordx4 v52, s[12:15], s54 offen lds
    s_add_u32 m0, s42, 17408
    s_nop 0
    buffer_load_dwordx4 v53, s[12:15], s54 offen lds
    s_add_u32 m0, s42, 24576
    s_nop 0
    buffer_load_dwordx4 v54, s[12:15], s54 offen lds
    s_add_u32 m0, s42, 25600
    s_nop 0
    buffer_load_dwordx4 v55, s[12:15], s54 offen lds
    s_add_u32 s54, s54, 131072
    s_add_u32 m0, s42, 32768
    s_nop 0
    buffer_load_dwordx4 v48, s[12:15], s54 offen lds
    s_add_u32 m0, s42, 33792
    s_nop 0
    buffer_load_dwordx4 v49, s[12:15], s54 offen lds
    s_add_u32 m0, s42, 40960
    s_nop 0
    buffer_load_dwordx4 v50, s[12:15], s54 offen lds
    s_add_u32 m0, s42, 41984
    s_nop 0
    buffer_load_dwordx4 v51, s[12:15], s54 offen lds
    s_add_u32 m0, s42, 49152
    s_nop 0
    buffer_load_dwordx4 v52, s[12:15], s54 offen lds
    s_add_u32 m0, s42, 50176
    s_nop 0
    buffer_load_dwordx4 v53, s[12:15], s54 offen lds
    s_add_u32 m0, s42, 57344
    s_nop 0
    buffer_load_dwordx4 v54, s[12:15], s54 offen lds
    s_add_u32 m0, s42, 58368
    s_nop 0
    buffer_load_dwordx4 v55, s[12:15], s54 offen lds
    s_add_u32 s54, s54, 131072
    s_add_u32 m0, s42, 65536
    s_nop 0
    buffer_load_dwordx4 v48, s[12:15], s54 offen lds
    s_add_u32 m0, s42, 66560
    s_nop 0
    buffer_load_dwordx4 v49, s[12:15], s54 offen lds
    s_add_u32 m0, s42, 73728
    s_nop 0
    buffer_load_dwordx4 v50, s[12:15], s54 offen lds
    s_add_u32 m0, s42, 74752
    s_nop 0
    buffer_load_dwordx4 v51, s[12:15], s54 offen lds
    s_add_u32 m0, s42, 81920
    s_nop 0
    buffer_load_dwordx4 v52, s[12:15], s54 offen lds
    s_add_u32 m0, s42, 82944
    s_nop 0
    buffer_load_dwordx4 v53, s[12:15], s54 offen lds
    s_add_u32 m0, s42, 90112
    s_nop 0
    buffer_load_dwordx4 v54, s[12:15], s54 offen lds
    s_add_u32 m0, s42, 91136
    s_nop 0
    buffer_load_dwordx4 v55, s[12:15], s54 offen lds
    s_add_u32 s54, s54, 131072
    s_add_u32 m0, s42, 98304
    s_nop 0
    buffer_load_dwordx4 v48, s[12:15], s54 offen lds
    s_add_u32 m0, s42, 99328
    s_nop 0
    buffer_load_dwordx4 v49, s[12:15], s54 offen lds
    s_add_u32 m0, s42, 106496
    s_nop 0
    buffer_load_dwordx4 v50, s[12:15], s54 offen lds
    s_add_u32 m0, s42, 107520
    s_nop 0
    buffer_load_dwordx4 v51, s[12:15], s54 offen lds
    s_add_u32 m0, s42, 114688
    s_nop 0
    buffer_load_dwordx4 v52, s[12:15], s54 offen lds
    s_add_u32 m0, s42, 115712
    s_nop 0
    buffer_load_dwordx4 v53, s[12:15], s54 offen lds
    s_add_u32 m0, s42, 122880
    s_nop 0
    buffer_load_dwordx4 v54, s[12:15], s54 offen lds
    s_add_u32 m0, s42, 123904
    s_nop 0
    buffer_load_dwordx4 v55, s[12:15], s54 offen lds
    s_add_u32 s54, s54, 131072
    v_lshrrev_b32 v64, 4, v0
    v_bfe_u32 v65, v0, 2, 2
    v_lshl_add_u32 v64, v64, 3, v65
    v_lshlrev_b32 v64, 7, v64
    v_lshrrev_b32 v65, 1, v65
    v_lshl_add_u32 v64, v65, 6, v64
    v_and_b32 v65, 3, v0
    v_lshl_add_u32 v64, v65, 4, v64
    s_lshl_b32 s37, s32, 13
    s_and_b32 s38, s51, 2
    s_lshl_b32 s38, s38, 5
    s_xor_b32 s38, s38, 0
    s_add_u32 s37, s37, s38
    v_xor_b32 v56, s37, v64
    s_lshl_b32 s37, s32, 13
    s_and_b32 s38, s51, 2
    s_lshl_b32 s38, s38, 5
    s_xor_b32 s38, s38, 8
    s_add_u32 s37, s37, s38
    v_xor_b32 v57, s37, v64
    s_lshl_b32 s37, s32, 13
    s_and_b32 s38, s51, 2
    s_lshl_b32 s38, s38, 5
    s_xor_b32 s38, s38, 64
    s_add_u32 s37, s37, s38
    v_xor_b32 v58, s37, v64
    s_lshl_b32 s37, s32, 13
    s_and_b32 s38, s51, 2
    s_lshl_b32 s38, s38, 5
    s_xor_b32 s38, s38, 72
    s_add_u32 s37, s37, s38
    v_xor_b32 v59, s37, v64
    s_and_b32 s39, s51, 1
    s_lshl_b32 s37, s39, 10
    v_add_u32 v2, s37, v1
    v_xor_b32 v3, 1024, v2
    v_add_u32 v4, 98304, v2
    v_add_u32 v5, 98304, v3
    s_mul_i32 s38, s51, 11*43
    s_lshr_b32 s38, s38, 7
    s_add_u32 s38, s38, 24
    s_lshl_b32 s37, s33, 6
    s_add_u32 s37, s37, s38
    s_lshl_b32 s37, s37, 7
    v_lshl_add_u32 v6, v0, 7, s37
    s_cmp_eq_u32 s32, 0
    s_cselect_b32 s37, 5, 0
    v_cmp_le_u32 vcc, s37, v0
    s_nop 1
    v_cndmask_b32 v6, v6, 2.0, vcc
    s_mul_i32 s43, s32, 4096
    s_mul_i32 s88, s32, 3072
    s_sub_u32 s89, s88, s43
    s_mul_i32 s41, s33, 8388608
    s_add_u32 s41, s41, 0x1000000
    s_mul_i32 s37, s51, 45056
    s_add_u32 s41, s41, s37
    s_add_u32 s41, s41, s43
    s_mul_i32 s90, s33, 8388608
    s_add_u32 s90, s90, 0x2fc0000
    s_lshl_b32 s37, s87, 16
    s_add_u32 s90, s90, s37
    s_lshl_b32 s37, s32, 12
    s_add_u32 s90, s90, s37
    s_and_b32 s37, s51, 3
    s_lshl_b32 s37, s37, 14
    s_add_u32 s90, s90, s37
    v_mov_b32 v104, 0
    v_mov_b32 v105, 0
    v_mov_b32 v106, 0
    v_mov_b32 v107, 0
    v_mov_b32 v108, 0
    v_mov_b32 v109, 0
    v_mov_b32 v110, 0
    v_mov_b32 v111, 0
    v_mov_b32 v17, 0x3f80
    v_and_b32 v16, 1, v0
    v_lshlrev_b32 v16, 4, v16
    v_lshlrev_b32 v16, v16, v17
    s_mov_b32 exec_lo, 0x300003
    s_mov_b32 exec_hi, 0x30000300
    v_mov_b32 v104, v16
    v_mov_b32 v110, v16
    s_mov_b32 exec_lo, 0xc0000c
    s_mov_b32 exec_hi, 0xc0000c00
    v_mov_b32 v105, v16
    v_mov_b32 v111, v16
    s_mov_b64 exec, -1
    s_add_u32 s38, s87, 44
    s_lshl_b32 s37, s33, 6
    s_add_u32 s37, s37, s38
    s_lshl_b32 s37, s37, 7
    v_lshl_add_u32 v8, v0, 9, s37
    v_cmp_le_u32 vcc, 5, v0
    s_nop 1
    v_cndmask_b32 v8, v8, 2.0, vcc
    s_lshl_b32 s38, s87, 2
    s_add_u32 s38, s38, s32
    s_lshl_b32 s38, s38, 1
    s_lshr_b32 s37, s51, 1
    s_add_u32 s38, s38, s37
    s_mul_i32 s53, s33, 2097152
    s_add_u32 s53, s53, 0x7f0000
    s_lshl_b32 s37, s38, 11
    s_add_u32 s53, s53, s37
    s_lshl_b32 s37, s39, 10
    s_add_u32 s53, s53, s37
    v_and_b32 v16, 15, v0
    v_and_b32 v17, 0x30, v0
    s_lshl_b32 s38, s38, 6
    s_mov_b32 s8, s78
    s_mov_b32 s9, s79
    s_mov_b32 s10, 0x800
    s_mov_b32 s11, 0x00020000
    buffer_load_dwordx4 v[24:27], v17, s[8:11], s38 offen
    v_lshl_add_u32 v9, v16, 11, v17
    v_add_u32 v9, s38, v9
    s_lshl_b32 s50, s33, 5
    s_add_u32 s50, s50, 31
    s_sub_u32 s50, s50, s39
    v_bfe_u32 v17, v0, 4, 1
    v_lshl_add_u32 v16, v16, 1, v17
    s_lshl_b32 s37, s32, 2
    s_add_u32 s37, s37, 65536
    v_lshl_add_u32 v10, v16, 4, s37
    v_and_b32 v16, 31, v0
    v_lshrrev_b32 v12, 5, v0
    v_lshlrev_b32 v12, 30, v12
    v_lshl_add_u32 v12, v16, 2, v12
    v_lshlrev_b32 v16, 4, v16
    v_add_u32 v11, 65536, v16
    s_lshl_b32 s37, s87, 1
    s_lshr_b32 s38, s51, 1
    s_add_u32 s37, s37, s38
    s_lshl_b32 s37, s37, 7
    s_add_u32 s55, s37, 0x543fc00
    s_cmp_eq_u32 s32, 2
    s_cselect_b32 s55, s55, 0x5f00000
    v_add_u32 v60, 0, v56
    v_add_u32 v61, 0, v57
    v_add_u32 v62, 0, v58
    v_add_u32 v63, 0, v59
    s_waitcnt vmcnt(25)
    s_barrier
    ds_read_b64_tr_b16 a[0:1], v60 offset:0
    ds_read_b64_tr_b16 a[2:3], v60 offset:512
    ds_read_b64_tr_b16 a[4:5], v61 offset:0
    ds_read_b64_tr_b16 a[6:7], v61 offset:512
    ds_read_b64_tr_b16 a[8:9], v62 offset:0
    ds_read_b64_tr_b16 a[10:11], v62 offset:512
    ds_read_b64_tr_b16 a[12:13], v63 offset:0
    ds_read_b64_tr_b16 a[14:15], v63 offset:512
    ds_read_b64_tr_b16 a[16:17], v60 offset:4096
    ds_read_b64_tr_b16 a[18:19], v60 offset:4608
    ds_read_b64_tr_b16 a[20:21], v61 offset:4096
    ds_read_b64_tr_b16 a[22:23], v61 offset:4608
    ds_read_b64_tr_b16 a[24:25], v62 offset:4096
    ds_read_b64_tr_b16 a[26:27], v62 offset:4608
    ds_read_b64_tr_b16 a[28:29], v63 offset:4096
    ds_read_b64_tr_b16 a[30:31], v63 offset:4608
    s_add_u32 m0, s42, 131072
    s_nop 0
    buffer_load_dwordx4 v48, s[12:15], s54 offen lds
    s_add_u32 m0, s42, 132096
    s_nop 0
    buffer_load_dwordx4 v49, s[12:15], s54 offen lds
    s_add_u32 m0, s42, 139264
    s_nop 0
    buffer_load_dwordx4 v50, s[12:15], s54 offen lds
    s_add_u32 m0, s42, 140288
    s_nop 0
    buffer_load_dwordx4 v51, s[12:15], s54 offen lds
    s_add_u32 m0, s42, 147456
    s_nop 0
    buffer_load_dwordx4 v52, s[12:15], s54 offen lds
    s_add_u32 m0, s42, 148480
    s_nop 0
    buffer_load_dwordx4 v53, s[12:15], s54 offen lds
    s_add_u32 m0, s42, 155648
    s_nop 0
    buffer_load_dwordx4 v54, s[12:15], s54 offen lds
    s_add_u32 m0, s42, 156672
    s_nop 0
    buffer_load_dwordx4 v55, s[12:15], s54 offen lds
    s_add_u32 s54, s54, 131072
    s_waitcnt lgkmcnt(0)
    v_add_u32 v60, 32768, v56
    v_add_u32 v61, 32768, v57
    v_add_u32 v62, 32768, v58
    v_add_u32 v63, 32768, v59
    s_waitcnt vmcnt(25)
    s_barrier
    ds_read_b64_tr_b16 a[32:33], v60 offset:0
    ds_read_b64_tr_b16 a[34:35], v60 offset:512
    ds_read_b64_tr_b16 a[36:37], v61 offset:0
    ds_read_b64_tr_b16 a[38:39], v61 offset:512
    ds_read_b64_tr_b16 a[40:41], v62 offset:0
    ds_read_b64_tr_b16 a[42:43], v62 offset:512
    ds_read_b64_tr_b16 a[44:45], v63 offset:0
    ds_read_b64_tr_b16 a[46:47], v63 offset:512
    ds_read_b64_tr_b16 a[48:49], v60 offset:4096
    ds_read_b64_tr_b16 a[50:51], v60 offset:4608
    ds_read_b64_tr_b16 a[52:53], v61 offset:4096
    ds_read_b64_tr_b16 a[54:55], v61 offset:4608
    ds_read_b64_tr_b16 a[56:57], v62 offset:4096
    ds_read_b64_tr_b16 a[58:59], v62 offset:4608
    ds_read_b64_tr_b16 a[60:61], v63 offset:4096
    ds_read_b64_tr_b16 a[62:63], v63 offset:4608
    s_add_u32 m0, s42, 0
    s_nop 0
    buffer_load_dwordx4 v48, s[12:15], s54 offen lds
    s_add_u32 m0, s42, 1024
    s_nop 0
    buffer_load_dwordx4 v49, s[12:15], s54 offen lds
    s_add_u32 m0, s42, 8192
    s_nop 0
    buffer_load_dwordx4 v50, s[12:15], s54 offen lds
    s_add_u32 m0, s42, 9216
    s_nop 0
    buffer_load_dwordx4 v51, s[12:15], s54 offen lds
    s_add_u32 m0, s42, 16384
    s_nop 0
    buffer_load_dwordx4 v52, s[12:15], s54 offen lds
    s_add_u32 m0, s42, 17408
    s_nop 0
    buffer_load_dwordx4 v53, s[12:15], s54 offen lds
    s_add_u32 m0, s42, 24576
    s_nop 0
    buffer_load_dwordx4 v54, s[12:15], s54 offen lds
    s_add_u32 m0, s42, 25600
    s_nop 0
    buffer_load_dwordx4 v55, s[12:15], s54 offen lds
    s_add_u32 s54, s54, 131072
    s_waitcnt lgkmcnt(0)
    v_add_u32 v60, 65536, v56
    v_add_u32 v61, 65536, v57
    v_add_u32 v62, 65536, v58
    v_add_u32 v63, 65536, v59
    s_waitcnt vmcnt(25)
    s_barrier
    ds_read_b64_tr_b16 a[64:65], v60 offset:0
    ds_read_b64_tr_b16 a[66:67], v60 offset:512
    ds_read_b64_tr_b16 a[68:69], v61 offset:0
    ds_read_b64_tr_b16 a[70:71], v61 offset:512
    ds_read_b64_tr_b16 a[72:73], v62 offset:0
    ds_read_b64_tr_b16 a[74:75], v62 offset:512
    ds_read_b64_tr_b16 a[76:77], v63 offset:0
    ds_read_b64_tr_b16 a[78:79], v63 offset:512
    ds_read_b64_tr_b16 a[80:81], v60 offset:4096
    ds_read_b64_tr_b16 a[82:83], v60 offset:4608
    ds_read_b64_tr_b16 a[84:85], v61 offset:4096
    ds_read_b64_tr_b16 a[86:87], v61 offset:4608
    ds_read_b64_tr_b16 a[88:89], v62 offset:4096
    ds_read_b64_tr_b16 a[90:91], v62 offset:4608
    ds_read_b64_tr_b16 a[92:93], v63 offset:4096
    ds_read_b64_tr_b16 a[94:95], v63 offset:4608
    s_add_u32 m0, s42, 32768
    s_nop 0
    buffer_load_dwordx4 v48, s[12:15], s54 offen lds
    s_add_u32 m0, s42, 33792
    s_nop 0
    buffer_load_dwordx4 v49, s[12:15], s54 offen lds
    s_add_u32 m0, s42, 40960
    s_nop 0
    buffer_load_dwordx4 v50, s[12:15], s54 offen lds
    s_add_u32 m0, s42, 41984
    s_nop 0
    buffer_load_dwordx4 v51, s[12:15], s54 offen lds
    s_add_u32 m0, s42, 49152
    s_nop 0
    buffer_load_dwordx4 v52, s[12:15], s54 offen lds
    s_add_u32 m0, s42, 50176
    s_nop 0
    buffer_load_dwordx4 v53, s[12:15], s54 offen lds
    s_add_u32 m0, s42, 57344
    s_nop 0
    buffer_load_dwordx4 v54, s[12:15], s54 offen lds
    s_add_u32 m0, s42, 58368
    s_nop 0
    buffer_load_dwordx4 v55, s[12:15], s54 offen lds
    s_add_u32 s54, s54, 131072
    s_waitcnt lgkmcnt(0)
    v_add_u32 v60, 98304, v56
    v_add_u32 v61, 98304, v57
    v_add_u32 v62, 98304, v58
    v_add_u32 v63, 98304, v59
    s_waitcnt vmcnt(25)
    s_barrier
    ds_read_b64_tr_b16 a[96:97], v60 offset:0
    ds_read_b64_tr_b16 a[98:99], v60 offset:512
    ds_read_b64_tr_b16 a[100:101], v61 offset:0
    ds_read_b64_tr_b16 a[102:103], v61 offset:512
    ds_read_b64_tr_b16 a[104:105], v62 offset:0
    ds_read_b64_tr_b16 a[106:107], v62 offset:512
    ds_read_b64_tr_b16 a[108:109], v63 offset:0
    ds_read_b64_tr_b16 a[110:111], v63 offset:512
    ds_read_b64_tr_b16 a[112:113], v60 offset:4096
    ds_read_b64_tr_b16 a[114:115], v60 offset:4608
    ds_read_b64_tr_b16 a[116:117], v61 offset:4096
    ds_read_b64_tr_b16 a[118:119], v61 offset:4608
    ds_read_b64_tr_b16 a[120:121], v62 offset:4096
    ds_read_b64_tr_b16 a[122:123], v62 offset:4608
    ds_read_b64_tr_b16 a[124:125], v63 offset:4096
    ds_read_b64_tr_b16 a[126:127], v63 offset:4608
    s_add_u32 m0, s42, 65536
    s_nop 0
    buffer_load_dwordx4 v48, s[12:15], s54 offen lds
    s_add_u32 m0, s42, 66560
    s_nop 0
    buffer_load_dwordx4 v49, s[12:15], s54 offen lds
    s_add_u32 m0, s42, 73728
    s_nop 0
    buffer_load_dwordx4 v50, s[12:15], s54 offen lds
    s_add_u32 m0, s42, 74752
    s_nop 0
    buffer_load_dwordx4 v51, s[12:15], s54 offen lds
    s_add_u32 m0, s42, 81920
    s_nop 0
    buffer_load_dwordx4 v52, s[12:15], s54 offen lds
    s_add_u32 m0, s42, 82944
    s_nop 0
    buffer_load_dwordx4 v53, s[12:15], s54 offen lds
    s_add_u32 m0, s42, 90112
    s_nop 0
    buffer_load_dwordx4 v54, s[12:15], s54 offen lds
    s_add_u32 m0, s42, 91136
    s_nop 0
    buffer_load_dwordx4 v55, s[12:15], s54 offen lds
    s_add_u32 s54, s54, 131072
    s_waitcnt lgkmcnt(0)
    v_add_u32 v60, 131072, v56
    v_add_u32 v61, 131072, v57
    v_add_u32 v62, 131072, v58
    v_add_u32 v63, 131072, v59
    s_waitcnt vmcnt(24)
    s_barrier
    ds_read_b64_tr_b16 a[128:129], v60 offset:0
    ds_read_b64_tr_b16 a[130:131], v60 offset:512
    ds_read_b64_tr_b16 a[132:133], v61 offset:0
    ds_read_b64_tr_b16 a[134:135], v61 offset:512
    ds_read_b64_tr_b16 a[136:137], v62 offset:0
    ds_read_b64_tr_b16 a[138:139], v62 offset:512
    ds_read_b64_tr_b16 a[140:141], v63 offset:0
    ds_read_b64_tr_b16 a[142:143], v63 offset:512
    ds_read_b64_tr_b16 a[144:145], v60 offset:4096
    ds_read_b64_tr_b16 a[146:147], v60 offset:4608
    ds_read_b64_tr_b16 a[148:149], v61 offset:4096
    ds_read_b64_tr_b16 a[150:151], v61 offset:4608
    ds_read_b64_tr_b16 a[152:153], v62 offset:4096
    ds_read_b64_tr_b16 a[154:155], v62 offset:4608
    ds_read_b64_tr_b16 a[156:157], v63 offset:4096
    ds_read_b64_tr_b16 a[158:159], v63 offset:4608
    s_add_u32 m0, s42, 98304
    s_nop 0
    buffer_load_dwordx4 v48, s[12:15], s54 offen lds
    s_add_u32 m0, s42, 99328
    s_nop 0
    buffer_load_dwordx4 v49, s[12:15], s54 offen lds
    s_add_u32 m0, s42, 106496
    s_nop 0
    buffer_load_dwordx4 v50, s[12:15], s54 offen lds
    s_add_u32 m0, s42, 107520
    s_nop 0
    buffer_load_dwordx4 v51, s[12:15], s54 offen lds
    s_add_u32 m0, s42, 114688
    s_nop 0
    buffer_load_dwordx4 v52, s[12:15], s54 offen lds
    s_add_u32 m0, s42, 115712
    s_nop 0
    buffer_load_dwordx4 v53, s[12:15], s54 offen lds
    s_add_u32 m0, s42, 122880
    s_nop 0
    buffer_load_dwordx4 v54, s[12:15], s54 offen lds
    s_add_u32 m0, s42, 123904
    s_nop 0
    buffer_load_dwordx4 v55, s[12:15], s54 offen lds
    s_add_u32 s54, s54, 131072
    s_waitcnt lgkmcnt(0)
    v_add_u32 v60, 0, v56
    v_add_u32 v61, 0, v57
    v_add_u32 v62, 0, v58
    v_add_u32 v63, 0, v59
    s_waitcnt vmcnt(24)
    s_barrier
    ds_read_b64_tr_b16 a[160:161], v60 offset:0
    ds_read_b64_tr_b16 a[162:163], v60 offset:512
    ds_read_b64_tr_b16 a[164:165], v61 offset:0
    ds_read_b64_tr_b16 a[166:167], v61 offset:512
    ds_read_b64_tr_b16 a[168:169], v62 offset:0
    ds_read_b64_tr_b16 a[170:171], v62 offset:512
    ds_read_b64_tr_b16 a[172:173], v63 offset:0
    ds_read_b64_tr_b16 a[174:175], v63 offset:512
    ds_read_b64_tr_b16 a[176:177], v60 offset:4096
    ds_read_b64_tr_b16 a[178:179], v60 offset:4608
    ds_read_b64_tr_b16 a[180:181], v61 offset:4096
    ds_read_b64_tr_b16 a[182:183], v61 offset:4608
    ds_read_b64_tr_b16 a[184:185], v62 offset:4096
    ds_read_b64_tr_b16 a[186:187], v62 offset:4608
    ds_read_b64_tr_b16 a[188:189], v63 offset:4096
    ds_read_b64_tr_b16 a[190:191], v63 offset:4608
    s_add_u32 m0, s42, 131072
    s_nop 0
    buffer_load_dwordx4 v48, s[12:15], s54 offen lds
    s_add_u32 m0, s42, 132096
    s_nop 0
    buffer_load_dwordx4 v49, s[12:15], s54 offen lds
    s_add_u32 m0, s42, 139264
    s_nop 0
    buffer_load_dwordx4 v50, s[12:15], s54 offen lds
    s_add_u32 m0, s42, 140288
    s_nop 0
    buffer_load_dwordx4 v51, s[12:15], s54 offen lds
    s_add_u32 m0, s42, 147456
    s_nop 0
    buffer_load_dwordx4 v52, s[12:15], s54 offen lds
    s_add_u32 m0, s42, 148480
    s_nop 0
    buffer_load_dwordx4 v53, s[12:15], s54 offen lds
    s_add_u32 m0, s42, 155648
    s_nop 0
    buffer_load_dwordx4 v54, s[12:15], s54 offen lds
    s_add_u32 m0, s42, 156672
    s_nop 0
    buffer_load_dwordx4 v55, s[12:15], s54 offen lds
    s_add_u32 s54, s54, 131072
    s_waitcnt lgkmcnt(0)
    v_add_u32 v60, 32768, v56
    v_add_u32 v61, 32768, v57
    v_add_u32 v62, 32768, v58
    v_add_u32 v63, 32768, v59
    s_waitcnt vmcnt(24)
    s_barrier
    ds_read_b64_tr_b16 a[192:193], v60 offset:0
    ds_read_b64_tr_b16 a[194:195], v60 offset:512
    ds_read_b64_tr_b16 a[196:197], v61 offset:0
    ds_read_b64_tr_b16 a[198:199], v61 offset:512
    ds_read_b64_tr_b16 a[200:201], v62 offset:0
    ds_read_b64_tr_b16 a[202:203], v62 offset:512
    ds_read_b64_tr_b16 a[204:205], v63 offset:0
    ds_read_b64_tr_b16 a[206:207], v63 offset:512
    ds_read_b64_tr_b16 a[208:209], v60 offset:4096
    ds_read_b64_tr_b16 a[210:211], v60 offset:4608
    ds_read_b64_tr_b16 a[212:213], v61 offset:4096
    ds_read_b64_tr_b16 a[214:215], v61 offset:4608
    ds_read_b64_tr_b16 a[216:217], v62 offset:4096
    ds_read_b64_tr_b16 a[218:219], v62 offset:4608
    ds_read_b64_tr_b16 a[220:221], v63 offset:4096
    ds_read_b64_tr_b16 a[222:223], v63 offset:4608
    s_add_u32 m0, s42, 0
    s_nop 0
    buffer_load_dwordx4 v48, s[12:15], s54 offen lds
    s_add_u32 m0, s42, 1024
    s_nop 0
    buffer_load_dwordx4 v49, s[12:15], s54 offen lds
    s_add_u32 m0, s42, 8192
    s_nop 0
    buffer_load_dwordx4 v50, s[12:15], s54 offen lds
    s_add_u32 m0, s42, 9216
    s_nop 0
    buffer_load_dwordx4 v51, s[12:15], s54 offen lds
    s_add_u32 m0, s42, 16384
    s_nop 0
    buffer_load_dwordx4 v52, s[12:15], s54 offen lds
    s_add_u32 m0, s42, 17408
    s_nop 0
    buffer_load_dwordx4 v53, s[12:15], s54 offen lds
    s_add_u32 m0, s42, 24576
    s_nop 0
    buffer_load_dwordx4 v54, s[12:15], s54 offen lds
    s_add_u32 m0, s42, 25600
    s_nop 0
    buffer_load_dwordx4 v55, s[12:15], s54 offen lds
    s_add_u32 s54, s54, 131072
    s_waitcnt lgkmcnt(0)
    v_add_u32 v60, 65536, v56
    v_add_u32 v61, 65536, v57
    v_add_u32 v62, 65536, v58
    v_add_u32 v63, 65536, v59
    s_waitcnt vmcnt(24)
    s_barrier
    ds_read_b64_tr_b16 a[224:225], v60 offset:0
    ds_read_b64_tr_b16 a[226:227], v60 offset:512
    ds_read_b64_tr_b16 a[228:229], v61 offset:0
    ds_read_b64_tr_b16 a[230:231], v61 offset:512
    ds_read_b64_tr_b16 a[232:233], v62 offset:0
    ds_read_b64_tr_b16 a[234:235], v62 offset:512
    ds_read_b64_tr_b16 a[236:237], v63 offset:0
    ds_read_b64_tr_b16 a[238:239], v63 offset:512
    ds_read_b64_tr_b16 a[240:241], v60 offset:4096
    ds_read_b64_tr_b16 a[242:243], v60 offset:4608
    ds_read_b64_tr_b16 a[244:245], v61 offset:4096
    ds_read_b64_tr_b16 a[246:247], v61 offset:4608
    ds_read_b64_tr_b16 a[248:249], v62 offset:4096
    ds_read_b64_tr_b16 a[250:251], v62 offset:4608
    ds_read_b64_tr_b16 a[252:253], v63 offset:4096
    ds_read_b64_tr_b16 a[254:255], v63 offset:4608
    s_waitcnt lgkmcnt(0)
    v_add_u32 v60, 98304, v56
    v_add_u32 v61, 98304, v57
    v_add_u32 v62, 98304, v58
    v_add_u32 v63, 98304, v59
    s_waitcnt vmcnt(16)
    s_barrier
    ds_read_b64_tr_b16 v[160:161], v60 offset:0
    ds_read_b64_tr_b16 v[162:163], v60 offset:512
    ds_read_b64_tr_b16 v[164:165], v61 offset:0
    ds_read_b64_tr_b16 v[166:167], v61 offset:512
    ds_read_b64_tr_b16 v[168:169], v62 offset:0
    ds_read_b64_tr_b16 v[170:171], v62 offset:512
    ds_read_b64_tr_b16 v[172:173], v63 offset:0
    ds_read_b64_tr_b16 v[174:175], v63 offset:512
    ds_read_b64_tr_b16 v[176:177], v60 offset:4096
    ds_read_b64_tr_b16 v[178:179], v60 offset:4608
    ds_read_b64_tr_b16 v[180:181], v61 offset:4096
    ds_read_b64_tr_b16 v[182:183], v61 offset:4608
    ds_read_b64_tr_b16 v[184:185], v62 offset:4096
    ds_read_b64_tr_b16 v[186:187], v62 offset:4608
    ds_read_b64_tr_b16 v[188:189], v63 offset:4096
    ds_read_b64_tr_b16 v[190:191], v63 offset:4608
    s_waitcnt lgkmcnt(0)
    v_add_u32 v60, 131072, v56
    v_add_u32 v61, 131072, v57
    v_add_u32 v62, 131072, v58
    v_add_u32 v63, 131072, v59
    s_waitcnt vmcnt(8)
    s_barrier
    ds_read_b64_tr_b16 v[192:193], v60 offset:0
    ds_read_b64_tr_b16 v[194:195], v60 offset:512
    ds_read_b64_tr_b16 v[196:197], v61 offset:0
    ds_read_b64_tr_b16 v[198:199], v61 offset:512
    ds_read_b64_tr_b16 v[200:201], v62 offset:0
    ds_read_b64_tr_b16 v[202:203], v62 offset:512
    ds_read_b64_tr_b16 v[204:205], v63 offset:0
    ds_read_b64_tr_b16 v[206:207], v63 offset:512
    ds_read_b64_tr_b16 v[208:209], v60 offset:4096
    ds_read_b64_tr_b16 v[210:211], v60 offset:4608
    ds_read_b64_tr_b16 v[212:213], v61 offset:4096
    ds_read_b64_tr_b16 v[214:215], v61 offset:4608
    ds_read_b64_tr_b16 v[216:217], v62 offset:4096
    ds_read_b64_tr_b16 v[218:219], v62 offset:4608
    ds_read_b64_tr_b16 v[220:221], v63 offset:4096
    ds_read_b64_tr_b16 v[222:223], v63 offset:4608
    s_waitcnt lgkmcnt(0)
    v_add_u32 v60, 0, v56
    v_add_u32 v61, 0, v57
    v_add_u32 v62, 0, v58
    v_add_u32 v63, 0, v59
    s_waitcnt vmcnt(0)
    s_barrier
    ds_read_b64_tr_b16 v[224:225], v60 offset:0
    ds_read_b64_tr_b16 v[226:227], v60 offset:512
    ds_read_b64_tr_b16 v[228:229], v61 offset:0
    ds_read_b64_tr_b16 v[230:231], v61 offset:512
    ds_read_b64_tr_b16 v[232:233], v62 offset:0
    ds_read_b64_tr_b16 v[234:235], v62 offset:512
    ds_read_b64_tr_b16 v[236:237], v63 offset:0
    ds_read_b64_tr_b16 v[238:239], v63 offset:512
    ds_read_b64_tr_b16 v[240:241], v60 offset:4096
    ds_read_b64_tr_b16 v[242:243], v60 offset:4608
    ds_read_b64_tr_b16 v[244:245], v61 offset:4096
    ds_read_b64_tr_b16 v[246:247], v61 offset:4608
    ds_read_b64_tr_b16 v[248:249], v62 offset:4096
    ds_read_b64_tr_b16 v[250:251], v62 offset:4608
    ds_read_b64_tr_b16 v[252:253], v63 offset:4096
    ds_read_b64_tr_b16 v[254:255], v63 offset:4608
    s_waitcnt lgkmcnt(0)
    s_barrier
    s_mov_b32 s37, 0xffff0000
    v_lshlrev_b32 v112, 16, v24
    v_and_b32 v113, s37, v24
    v_lshlrev_b32 v114, 16, v25
    v_and_b32 v115, s37, v25
    v_lshlrev_b32 v116, 16, v26
    v_and_b32 v117, s37, v26
    v_lshlrev_b32 v118, 16, v27
    v_and_b32 v119, s37, v27
    s_add_u32 s37, s90, 8388608
    v_mov_b32 v16, -1
    v_mov_b32 v17, -1
    v_mov_b32 v18, -1
    v_mov_b32 v19, -1
    buffer_store_dwordx4 v[16:19], v1, s[16:19], s37 offen offset:0 sc1
    buffer_store_dwordx4 v[16:19], v1, s[16:19], s37 offen offset:1024 sc1
    buffer_store_dwordx4 v[16:19], v1, s[16:19], s37 offen offset:2048 sc1
    buffer_store_dwordx4 v[16:19], v1, s[16:19], s37 offen offset:3072 sc1
    s_cmp_lg_u32 s32, 0
    s_cbranch_scc1 L_arv60
    s_add_u32 s20, s82, 0x80
    s_addc_u32 s21, s83, 0
    s_mov_b32 s22, 0x4
    s_mov_b32 s23, 0x00020000
    buffer_load_dword v80, v124, s[20:23], 0 offen sc1
    s_waitcnt vmcnt(0)
    v_cmp_eq_u32 vcc, v124, v80
    s_cbranch_vccnz L_spin61
L_back62:
L_arv60:
    s_add_u32 s96, s41, 8126464
    s_mov_b32 s98, s41
    s_mov_b32 s45, 0x5530000
    buffer_load_dword v96, v6, s[16:19], s45 offen sc1
    s_waitcnt vmcnt(0)
    v_cmp_ne_u32 vcc, 0, v96
    s_cbranch_vccnz L_spin63
L_back64:
    s_barrier
    s_add_u32 m0, s43, 0
    s_add_u32 s42, s41, 0
    buffer_load_dwordx4 v1, s[16:19], s42 offen offset:0 sc1 lds
    buffer_load_dwordx4 v1, s[16:19], s42 offen offset:1024 sc1 lds
    buffer_load_dwordx4 v1, s[16:19], s42 offen offset:2048 sc1 lds
    buffer_load_dwordx4 v1, s[16:19], s42 offen offset:3072 sc1 lds
    s_add_u32 m0, s88, 16384
    s_add_u32 s42, s41, 16384
    s_add_u32 s42, s42, s89
    buffer_load_dwordx4 v1, s[16:19], s42 offen offset:0 sc1 lds
    buffer_load_dwordx4 v1, s[16:19], s42 offen offset:1024 sc1 lds
    buffer_load_dwordx4 v1, s[16:19], s42 offen offset:2048 sc1 lds
    s_add_u32 m0, s43, 28672
    s_add_u32 s42, s41, 28672
    buffer_load_dwordx4 v1, s[16:19], s42 offen offset:0 sc1 lds
    buffer_load_dwordx4 v1, s[16:19], s42 offen offset:1024 sc1 lds
    buffer_load_dwordx4 v1, s[16:19], s42 offen offset:2048 sc1 lds
    buffer_load_dwordx4 v1, s[16:19], s42 offen offset:3072 sc1 lds
    s_add_u32 s45, s45, 65536
    s_waitcnt vmcnt(0) lgkmcnt(0)
    s_barrier
    s_mov_b32 s52, 0x5e00000
    s_mov_b32 s46, 0x5e00000
    s_add_u32 s20, s84, 0x5e00000
    s_addc_u32 s21, s85, 0
    s_mov_b32 s22, 0x400000
    s_mov_b32 s23, 0x00020000
    ds_read_b128 v[80:83], v2 offset:0
    ds_read_b128 v[84:87], v3 offset:0
    s_mov_b32 s36, 0
    s_waitcnt lgkmcnt(0)
    s_nop 7
L_bf_b0:
    v_mfma_f32_16x16x32_bf16 v[16:19], a[0:3], v[80:83], v[112:115]
    s_sub_u32 s47, s45, 196608
    ds_read_b128 v[88:91], v2 offset:2048
    s_max_u32 s47, s47, 0x5500000
    v_mfma_f32_16x16x32_bf16 v[24:27], a[0:3], v[84:87], 0
    buffer_load_dword v13, v8, s[16:19], s47 offen sc1
    v_mfma_f32_16x16x32_bf16 v[28:31], a[4:7], v[84:87], 0
    s_and_b32 s38, s53, 0xffffffff
    ds_read_b128 v[92:95], v3 offset:2048
    s_cmp_lt_i32 s36, 1
    v_mfma_f32_16x16x32_bf16 v[20:23], a[4:7], v[80:83], v[116:119]
    s_cselect_b32 s38, 0x5e00000, s38
    v_mfma_f32_16x16x32_bf16 v[32:35], a[8:11], v[80:83], 0
    buffer_load_dwordx4 v[136:139], v1, s[16:19], s38 offen sc1
    v_mfma_f32_16x16x32_bf16 v[40:43], a[8:11], v[84:87], 0
    s_add_u32 s53, s53, 65536
    ds_read_b128 v[144:147], v11 offset:0
    s_and_b32 s44, s90, 0xffffffff
    v_mfma_f32_16x16x32_bf16 v[44:47], a[12:15], v[84:87], 0
    s_cmp_lt_i32 s36, 1
    s_cselect_b32 s44, 0x5e00000, s44
    s_xor_b32 s49, s44, 16384
    v_mfma_f32_16x16x32_bf16 v[36:39], a[12:15], v[80:83], 0
    s_waitcnt lgkmcnt(1)
    v_cvt_pk_bf16_f32 v56, v56, v57
    v_cvt_pk_bf16_f32 v57, v58, v59
    v_mfma_f32_16x16x32_bf16 v[16:19], a[16:19], v[88:91], v[16:19]
    ds_read_b128 v[80:83], v2 offset:4096
    v_cvt_pk_bf16_f32 v58, v60, v61
    v_mfma_f32_16x16x32_bf16 v[24:27], a[16:19], v[92:95], v[24:27]
    v_cvt_pk_bf16_f32 v59, v62, v63
    v_mfma_f32_16x16x32_bf16 v[28:31], a[20:23], v[92:95], v[28:31]
    s_waitcnt lgkmcnt(1)
    ds_read_b128 v[84:87], v3 offset:4096
    v_add_f32 v144, v144, v145
    v_mfma_f32_16x16x32_bf16 v[20:23], a[20:23], v[88:91], v[20:23]
    buffer_store_dwordx4 v[56:59], v1, s[16:19], s49 offen offset:0 sc1
    v_mfma_f32_16x16x32_bf16 v[32:35], a[24:27], v[88:91], v[32:35]
    s_xor_b32 s49, s44, 32768
    v_cvt_pk_bf16_f32 v64, v64, v65
    v_cvt_pk_bf16_f32 v65, v66, v67
    v_mfma_f32_16x16x32_bf16 v[40:43], a[24:27], v[92:95], v[40:43]
    v_cvt_pk_bf16_f32 v66, v68, v69
    v_cvt_pk_bf16_f32 v67, v70, v71
    v_mfma_f32_16x16x32_bf16 v[44:47], a[28:31], v[92:95], v[44:47]
    buffer_store_dwordx4 v[64:67], v1, s[16:19], s49 offen offset:1024 sc1
    v_mfma_f32_16x16x32_bf16 v[36:39], a[28:31], v[88:91], v[36:39]
    s_waitcnt lgkmcnt(0)
    v_add_f32 v146, v146, v147
    v_add_f32 v144, v144, v146
    v_mfma_f32_16x16x32_bf16 v[16:19], a[32:35], v[80:83], v[16:19]
    s_xor_b32 s49, s44, 49152
    ds_read_b128 v[88:91], v2 offset:6144
    v_cvt_pk_bf16_f32 v72, v72, v73
    v_mfma_f32_16x16x32_bf16 v[24:27], a[32:35], v[84:87], v[24:27]
    v_cvt_pk_bf16_f32 v73, v74, v75
    v_cvt_pk_bf16_f32 v74, v76, v77
    v_mfma_f32_16x16x32_bf16 v[28:31], a[36:39], v[84:87], v[28:31]
    ds_read_b128 v[92:95], v3 offset:6144
    v_cvt_pk_bf16_f32 v75, v78, v79
    v_mfma_f32_16x16x32_bf16 v[20:23], a[36:39], v[80:83], v[20:23]
    buffer_store_dwordx4 v[72:75], v1, s[16:19], s49 offen offset:2048 sc1
    v_mfma_f32_16x16x32_bf16 v[32:35], a[40:43], v[80:83], v[32:35]
    s_add_u32 s90, s90, 262144
    v_mfma_f32_16x16x32_bf16 v[40:43], a[40:43], v[84:87], v[40:43]
    v_mfma_f32_16x16x32_bf16 v[44:47], a[44:47], v[84:87], v[44:47]
    buffer_store_dword v144, v12, s[16:19], s46 offen sc1
    v_mfma_f32_16x16x32_bf16 v[36:39], a[44:47], v[80:83], v[36:39]
    s_waitcnt lgkmcnt(0)
    v_mfma_f32_16x16x32_bf16 v[16:19], a[48:51], v[88:91], v[16:19]
    s_add_u32 s98, s98, 262144
    ds_read_b128 v[80:83], v2 offset:8192
    s_min_i32 s98, s98, s96
    v_mfma_f32_16x16x32_bf16 v[24:27], a[48:51], v[92:95], v[24:27]
    s_and_b32 s41, s98, 0xffffffff
    s_add_u32 m0, s43, 98304
    s_add_u32 s42, s41, 0
    v_mfma_f32_16x16x32_bf16 v[28:31], a[52:55], v[92:95], v[28:31]
    ds_read_b128 v[84:87], v3 offset:8192
    v_mfma_f32_16x16x32_bf16 v[20:23], a[52:55], v[88:91], v[20:23]
    v_mfma_f32_16x16x32_bf16 v[32:35], a[56:59], v[88:91], v[32:35]
    v_mfma_f32_16x16x32_bf16 v[40:43], a[56:59], v[92:95], v[40:43]
    v_mfma_f32_16x16x32_bf16 v[44:47], a[60:63], v[92:95], v[44:47]
    v_mfma_f32_16x16x32_bf16 v[36:39], a[60:63], v[88:91], v[36:39]
    s_waitcnt lgkmcnt(0)
    v_mfma_f32_16x16x32_bf16 v[16:19], a[64:67], v[80:83], v[16:19]
    ds_read_b128 v[88:91], v2 offset:10240
    v_mfma_f32_16x16x32_bf16 v[24:27], a[64:67], v[84:87], v[24:27]
    v_mfma_f32_16x16x32_bf16 v[28:31], a[68:71], v[84:87], v[28:31]
    ds_read_b128 v[92:95], v3 offset:10240
    v_mfma_f32_16x16x32_bf16 v[20:23], a[68:71], v[80:83], v[20:23]
    v_mfma_f32_16x16x32_bf16 v[32:35], a[72:75], v[80:83], v[32:35]
    v_mfma_f32_16x16x32_bf16 v[40:43], a[72:75], v[84:87], v[40:43]
    v_mfma_f32_16x16x32_bf16 v[44:47], a[76:79], v[84:87], v[44:47]
    v_mfma_f32_16x16x32_bf16 v[36:39], a[76:79], v[80:83], v[36:39]
    s_waitcnt lgkmcnt(0)
    v_mfma_f32_16x16x32_bf16 v[16:19], a[80:83], v[88:91], v[16:19]
    ds_read_b128 v[80:83], v2 offset:12288
    v_mfma_f32_16x16x32_bf16 v[24:27], a[80:83], v[92:95], v[24:27]
    v_mfma_f32_16x16x32_bf16 v[28:31], a[84:87], v[92:95], v[28:31]
    ds_read_b128 v[84:87], v3 offset:12288
    v_mfma_f32_16x16x32_bf16 v[20:23], a[84:87], v[88:91], v[20:23]
    v_mfma_f32_16x16x32_bf16 v[32:35], a[88:91], v[88:91], v[32:35]
    s_waitcnt vmcnt(5)
    v_cmp_ne_u32 vcc, 0, v13
    v_mfma_f32_16x16x32_bf16 v[40:43], a[88:91], v[92:95], v[40:43]
    v_mfma_f32_16x16x32_bf16 v[44:47], a[92:95], v[92:95], v[44:47]
    s_cbranch_vccnz L_spin65
L_back66:
    s_sub_u32 s48, s90, 524288
    s_and_b32 s48, s48, 0xffffffff
    v_mfma_f32_16x16x32_bf16 v[36:39], a[92:95], v[88:91], v[36:39]
    s_waitcnt lgkmcnt(0)
    s_cmp_lt_i32 s36, 2
    s_cselect_b32 s48, s52, s48
    v_mfma_f32_16x16x32_bf16 v[16:19], a[96:99], v[80:83], v[16:19]
    ds_read_b128 v[88:91], v2 offset:14336
    v_mfma_f32_16x16x32_bf16 v[24:27], a[96:99], v[84:87], v[24:27]
    buffer_load_dwordx4 v[140:143], v1, s[16:19], s48 offen offset:0 sc1
    v_mfma_f32_16x16x32_bf16 v[28:31], a[100:103], v[84:87], v[28:31]
    ds_read_b128 v[92:95], v3 offset:14336
    v_mfma_f32_16x16x32_bf16 v[20:23], a[100:103], v[80:83], v[20:23]
    v_mfma_f32_16x16x32_bf16 v[32:35], a[104:107], v[80:83], v[32:35]
    buffer_load_dword v96, v6, s[16:19], s45 offen sc1
    v_mfma_f32_16x16x32_bf16 v[40:43], a[104:107], v[84:87], v[40:43]
    v_mfma_f32_16x16x32_bf16 v[44:47], a[108:111], v[84:87], v[44:47]
    v_mfma_f32_16x16x32_bf16 v[36:39], a[108:111], v[80:83], v[36:39]
    s_waitcnt lgkmcnt(0)
    v_mfma_f32_16x16x32_bf16 v[16:19], a[112:115], v[88:91], v[16:19]
    ds_read_b128 v[80:83], v2 offset:16384
    v_mfma_f32_16x16x32_bf16 v[24:27], a[112:115], v[92:95], v[24:27]
    buffer_load_dwordx4 v[144:147], v1, s[16:19], s48 offen offset:1024 sc1
    v_mfma_f32_16x16x32_bf16 v[28:31], a[116:119], v[92:95], v[28:31]
    ds_read_b128 v[84:87], v3 offset:16384
    v_mfma_f32_16x16x32_bf16 v[20:23], a[116:119], v[88:91], v[20:23]
    v_mfma_f32_16x16x32_bf16 v[32:35], a[120:123], v[88:91], v[32:35]
    buffer_load_dwordx4 v[148:151], v1, s[16:19], s48 offen offset:2048 sc1
    v_mfma_f32_16x16x32_bf16 v[40:43], a[120:123], v[92:95], v[40:43]
    v_mfma_f32_16x16x32_bf16 v[44:47], a[124:127], v[92:95], v[44:47]
    v_mfma_f32_16x16x32_bf16 v[36:39], a[124:127], v[88:91], v[36:39]
    s_waitcnt lgkmcnt(0)
    v_mfma_f32_16x16x32_bf16 v[16:19], a[128:131], v[80:83], v[16:19]
    ds_read_b128 v[88:91], v2 offset:18432
    v_mfma_f32_16x16x32_bf16 v[24:27], a[128:131], v[84:87], v[24:27]
    buffer_load_dwordx4 v[152:155], v1, s[16:19], s48 offen offset:3072 sc1
    v_mfma_f32_16x16x32_bf16 v[28:31], a[132:135], v[84:87], v[28:31]
    s_sub_u32 s47, s36, 2
    ds_read_b128 v[92:95], v3 offset:18432
    s_cmp_lt_u32 s47, 16
    v_mfma_f32_16x16x32_bf16 v[20:23], a[132:135], v[80:83], v[20:23]
    s_cselect_b32 s48, 0x5000000, s52
    s_add_u32 s20, s84, s48
    s_addc_u32 s21, s85, 0
    v_mfma_f32_16x16x32_bf16 v[32:35], a[136:139], v[80:83], v[32:35]
    s_cmp_ge_i32 s47, 16
    s_cselect_b32 s20, s80, s20
    s_cselect_b32 s21, s81, s21
    v_mfma_f32_16x16x32_bf16 v[40:43], a[136:139], v[84:87], v[40:43]
    s_and_b32 s48, s47, 15
    s_lshl_b32 s48, s48, 1
    s_sub_u32 s48, s50, s48
    v_mfma_f32_16x16x32_bf16 v[44:47], a[140:143], v[84:87], v[44:47]
    s_lshl_b32 s46, s48, 10
    s_sub_u32 s46, s55, s46
    s_cmp_lt_u32 s47, 16
    v_mfma_f32_16x16x32_bf16 v[36:39], a[140:143], v[80:83], v[36:39]
    s_waitcnt lgkmcnt(0)
    s_cselect_b32 s46, s46, s52
    s_lshl_b32 s48, s48, 15
    v_mfma_f32_16x16x32_bf16 v[16:19], a[144:147], v[88:91], v[16:19]
    ds_read_b128 v[80:83], v2 offset:20480
    v_mfma_f32_16x16x32_bf16 v[24:27], a[144:147], v[92:95], v[24:27]
    v_mfma_f32_16x16x32_bf16 v[28:31], a[148:151], v[92:95], v[28:31]
    ds_read_b128 v[84:87], v3 offset:20480
    v_mfma_f32_16x16x32_bf16 v[20:23], a[148:151], v[88:91], v[20:23]
    v_mfma_f32_16x16x32_bf16 v[32:35], a[152:155], v[88:91], v[32:35]
    v_mfma_f32_16x16x32_bf16 v[40:43], a[152:155], v[92:95], v[40:43]
    v_mfma_f32_16x16x32_bf16 v[44:47], a[156:159], v[92:95], v[44:47]
    v_mfma_f32_16x16x32_bf16 v[36:39], a[156:159], v[88:91], v[36:39]
    s_waitcnt lgkmcnt(0)
    v_mfma_f32_16x16x32_bf16 v[16:19], a[160:163], v[80:83], v[16:19]
    ds_read_b128 v[88:91], v2 offset:22528
    v_mfma_f32_16x16x32_bf16 v[24:27], a[160:163], v[84:87], v[24:27]
    v_mfma_f32_16x16x32_bf16 v[28:31], a[164:167], v[84:87], v[28:31]
    ds_read_b128 v[92:95], v3 offset:22528
    v_mfma_f32_16x16x32_bf16 v[20:23], a[164:167], v[80:83], v[20:23]
    v_mfma_f32_16x16x32_bf16 v[32:35], a[168:171], v[80:83], v[32:35]
    v_mfma_f32_16x16x32_bf16 v[40:43], a[168:171], v[84:87], v[40:43]
    v_mfma_f32_16x16x32_bf16 v[44:47], a[172:175], v[84:87], v[44:47]
    v_mfma_f32_16x16x32_bf16 v[36:39], a[172:175], v[80:83], v[36:39]
    s_waitcnt lgkmcnt(0)
    v_mfma_f32_16x16x32_bf16 v[16:19], a[176:179], v[88:91], v[16:19]
    ds_read_b128 v[80:83], v2 offset:24576
    v_mfma_f32_16x16x32_bf16 v[24:27], a[176:179], v[92:95], v[24:27]
    v_mfma_f32_16x16x32_bf16 v[28:31], a[180:183], v[92:95], v[28:31]
    ds_read_b128 v[84:87], v3 offset:24576
    v_mfma_f32_16x16x32_bf16 v[20:23], a[180:183], v[88:91], v[20:23]
    v_mfma_f32_16x16x32_bf16 v[32:35], a[184:187], v[88:91], v[32:35]
    v_mfma_f32_16x16x32_bf16 v[40:43], a[184:187], v[92:95], v[40:43]
    v_mfma_f32_16x16x32_bf16 v[44:47], a[188:191], v[92:95], v[44:47]
    s_waitcnt vmcnt(3)
    v_cmp_ne_u32 vcc, 0, v96
    v_mfma_f32_16x16x32_bf16 v[36:39], a[188:191], v[88:91], v[36:39]
    s_waitcnt lgkmcnt(0)
    v_mfma_f32_16x16x32_bf16 v[16:19], a[192:195], v[80:83], v[16:19]
    s_cbranch_vccnz L_spin67
L_back68:
    ds_read_b128 v[88:91], v2 offset:26624
    s_barrier
    v_mfma_f32_16x16x32_bf16 v[24:27], a[192:195], v[84:87], v[24:27]
    buffer_load_dwordx4 v1, s[16:19], s42 offen offset:0 sc1 lds
    v_mfma_f32_16x16x32_bf16 v[28:31], a[196:199], v[84:87], v[28:31]
    ds_read_b128 v[92:95], v3 offset:26624
    v_mfma_f32_16x16x32_bf16 v[20:23], a[196:199], v[80:83], v[20:23]
    v_mfma_f32_16x16x32_bf16 v[32:35], a[200:203], v[80:83], v[32:35]
    v_mfma_f32_16x16x32_bf16 v[40:43], a[200:203], v[84:87], v[40:43]
    buffer_load_dwordx4 v1, s[16:19], s42 offen offset:1024 sc1 lds
    v_mfma_f32_16x16x32_bf16 v[44:47], a[204:207], v[84:87], v[44:47]
    v_mfma_f32_16x16x32_bf16 v[36:39], a[204:207], v[80:83], v[36:39]
    s_waitcnt lgkmcnt(0)
    v_mfma_f32_16x16x32_bf16 v[16:19], a[208:211], v[88:91], v[16:19]
    ds_read_b128 v[80:83], v2 offset:28672
    v_mfma_f32_16x16x32_bf16 v[24:27], a[208:211], v[92:95], v[24:27]
    buffer_load_dwordx4 v1, s[16:19], s42 offen offset:2048 sc1 lds
    v_mfma_f32_16x16x32_bf16 v[28:31], a[212:215], v[92:95], v[28:31]
    ds_read_b128 v[84:87], v3 offset:28672
    v_mfma_f32_16x16x32_bf16 v[20:23], a[212:215], v[88:91], v[20:23]
    v_mfma_f32_16x16x32_bf16 v[32:35], a[216:219], v[88:91], v[32:35]
    v_mfma_f32_16x16x32_bf16 v[40:43], a[216:219], v[92:95], v[40:43]
    buffer_load_dwordx4 v1, s[16:19], s42 offen offset:3072 sc1 lds
    v_mfma_f32_16x16x32_bf16 v[44:47], a[220:223], v[92:95], v[44:47]
    s_add_u32 m0, s88, 114688
    s_add_u32 s42, s41, 16384
    s_add_u32 s42, s42, s89
    v_mfma_f32_16x16x32_bf16 v[36:39], a[220:223], v[88:91], v[36:39]
    s_waitcnt lgkmcnt(0)
    v_mfma_f32_16x16x32_bf16 v[16:19], a[224:227], v[80:83], v[16:19]
    ds_read_b128 v[88:91], v2 offset:30720
    v_mfma_f32_16x16x32_bf16 v[24:27], a[224:227], v[84:87], v[24:27]
    buffer_load_dwordx4 v1, s[16:19], s42 offen offset:0 sc1 lds
    v_mfma_f32_16x16x32_bf16 v[28:31], a[228:231], v[84:87], v[28:31]
    ds_read_b128 v[92:95], v3 offset:30720
    v_mfma_f32_16x16x32_bf16 v[20:23], a[228:231], v[80:83], v[20:23]
    v_mfma_f32_16x16x32_bf16 v[32:35], a[232:235], v[80:83], v[32:35]
    s_waitcnt vmcnt(5)
    v_mfma_f32_16x16x32_bf16 v[128:131], v[104:107], v[140:143], v[128:131]
    v_mfma_f32_16x16x32_bf16 v[132:135], v[108:111], v[140:143], v[132:135]
    v_mfma_f32_16x16x32_bf16 v[128:131], v[104:107], v[144:147], v[128:131]
    v_mfma_f32_16x16x32_bf16 v[132:135], v[108:111], v[144:147], v[132:135]
    v_mfma_f32_16x16x32_bf16 v[128:131], v[104:107], v[148:151], v[128:131]
    v_mfma_f32_16x16x32_bf16 v[132:135], v[108:111], v[148:151], v[132:135]
    v_mfma_f32_16x16x32_bf16 v[128:131], v[104:107], v[152:155], v[128:131]
    v_mfma_f32_16x16x32_bf16 v[132:135], v[108:111], v[152:155], v[132:135]
    v_mfma_f32_16x16x32_bf16 v[40:43], a[232:235], v[84:87], v[40:43]
    buffer_load_dwordx4 v1, s[16:19], s42 offen offset:1024 sc1 lds
    v_mfma_f32_16x16x32_bf16 v[44:47], a[236:239], v[84:87], v[44:47]
    s_nop 0
    v_cvt_pk_bf16_f32 v140, v128, v129
    v_cvt_pk_bf16_f32 v141, v130, v131
    v_mfma_f32_16x16x32_bf16 v[36:39], a[236:239], v[80:83], v[36:39]
    s_waitcnt lgkmcnt(0)
    v_cvt_pk_bf16_f32 v142, v132, v133
    v_cvt_pk_bf16_f32 v143, v134, v135
    v_mfma_f32_16x16x32_bf16 v[16:19], a[240:243], v[88:91], v[16:19]
    ds_read_b128 v[80:83], v2 offset:32768
    v_mfma_f32_16x16x32_bf16 v[24:27], a[240:243], v[92:95], v[24:27]
    buffer_load_dwordx4 v1, s[16:19], s42 offen offset:2048 sc1 lds
    v_mfma_f32_16x16x32_bf16 v[28:31], a[244:247], v[92:95], v[28:31]
    ds_read_b128 v[84:87], v3 offset:32768
    v_mfma_f32_16x16x32_bf16 v[20:23], a[244:247], v[88:91], v[20:23]
    v_mfma_f32_16x16x32_bf16 v[32:35], a[248:251], v[88:91], v[32:35]
    buffer_store_dword v124, v124, s[16:19], s91 offen sc1
    v_mfma_f32_16x16x32_bf16 v[40:43], a[248:251], v[92:95], v[40:43]
    s_add_u32 s91, s91, 65536
    s_add_u32 s39, s91, -163840
    v_mfma_f32_16x16x32_bf16 v[44:47], a[252:255], v[92:95], v[44:47]
    v_mfma_f32_16x16x32_bf16 v[36:39], a[252:255], v[88:91], v[36:39]
    s_waitcnt lgkmcnt(0)
    v_mfma_f32_16x16x32_bf16 v[16:19], v[160:163], v[80:83], v[16:19]
    ds_read_b128 v[88:91], v2 offset:34816
    v_mfma_f32_16x16x32_bf16 v[24:27], v[160:163], v[84:87], v[24:27]
    buffer_store_dword v124, v124, s[16:19], s39 offen sc1
    v_mfma_f32_16x16x32_bf16 v[28:31], v[164:167], v[84:87], v[28:31]
    ds_read_b128 v[92:95], v3 offset:34816
    v_mfma_f32_16x16x32_bf16 v[20:23], v[164:167], v[80:83], v[20:23]
    v_mfma_f32_16x16x32_bf16 v[32:35], v[168:171], v[80:83], v[32:35]
    buffer_store_dwordx4 v[140:143], v9, s[20:23], s48 offen sc1
    v_mfma_f32_16x16x32_bf16 v[40:43], v[168:171], v[84:87], v[40:43]
    v_add_f32 v100, v128, v129
    v_mul_f32 v101, v128, v128
    v_mfma_f32_16x16x32_bf16 v[44:47], v[172:175], v[84:87], v[44:47]
    v_fmac_f32 v101, v129, v129
    v_add_f32 v100, v100, v130
    v_mfma_f32_16x16x32_bf16 v[36:39], v[172:175], v[80:83], v[36:39]
    s_waitcnt lgkmcnt(0)
    v_fmac_f32 v101, v130, v130
    v_add_f32 v100, v100, v131
    v_mfma_f32_16x16x32_bf16 v[16:19], v[176:179], v[88:91], v[16:19]
    ds_read_b128 v[80:83], v2 offset:36864
    v_fmac_f32 v101, v131, v131
    v_mfma_f32_16x16x32_bf16 v[24:27], v[176:179], v[92:95], v[24:27]
    v_add_f32 v100, v100, v132
    v_fmac_f32 v101, v132, v132
    v_mfma_f32_16x16x32_bf16 v[28:31], v[180:183], v[92:95], v[28:31]
    ds_read_b128 v[84:87], v3 offset:36864
    v_add_f32 v100, v100, v133
    v_mfma_f32_16x16x32_bf16 v[20:23], v[180:183], v[88:91], v[20:23]
    v_fmac_f32 v101, v133, v133
    v_add_f32 v100, v100, v134
    v_mfma_f32_16x16x32_bf16 v[32:35], v[184:187], v[88:91], v[32:35]
    v_fmac_f32 v101, v134, v134
    v_add_f32 v100, v100, v135
    v_mfma_f32_16x16x32_bf16 v[40:43], v[184:187], v[92:95], v[40:43]
    v_fmac_f32 v101, v135, v135
    v_mfma_f32_16x16x32_bf16 v[44:47], v[188:191], v[92:95], v[44:47]
    v_permlane16_swap_b32 v100, v101
    v_mfma_f32_16x16x32_bf16 v[36:39], v[188:191], v[88:91], v[36:39]
    s_waitcnt lgkmcnt(0)
    v_add_f32 v100, v100, v101
    v_mov_b32 v102, v100
    v_mfma_f32_16x16x32_bf16 v[16:19], v[192:195], v[80:83], v[16:19]
    ds_read_b128 v[88:91], v2 offset:38912
    v_mfma_f32_16x16x32_bf16 v[24:27], v[192:195], v[84:87], v[24:27]
    v_permlane32_swap_b32 v100, v102
    v_mfma_f32_16x16x32_bf16 v[28:31], v[196:199], v[84:87], v[28:31]
    ds_read_b128 v[92:95], v3 offset:38912
    v_add_f32 v100, v100, v102
    v_mfma_f32_16x16x32_bf16 v[20:23], v[196:199], v[80:83], v[20:23]
    ds_write_b32 v10, v100 offset:512
    v_mfma_f32_16x16x32_bf16 v[32:35], v[200:203], v[80:83], v[32:35]
    s_waitcnt vmcnt(19)
    v_mfma_f32_16x16x32_bf16 v[128:131], v[104:107], v[136:139], v[48:51]
    v_mfma_f32_16x16x32_bf16 v[132:135], v[108:111], v[136:139], v[52:55]
    v_mfma_f32_16x16x32_bf16 v[40:43], v[200:203], v[84:87], v[40:43]
    v_mfma_f32_16x16x32_bf16 v[44:47], v[204:207], v[84:87], v[44:47]
    s_add_u32 m0, s43, 126976
    s_add_u32 s42, s41, 28672
    v_mfma_f32_16x16x32_bf16 v[36:39], v[204:207], v[80:83], v[36:39]
    s_waitcnt lgkmcnt(1)
    v_mfma_f32_16x16x32_bf16 v[16:19], v[208:211], v[88:91], v[16:19]
    ds_read_b128 v[80:83], v2 offset:40960
    v_mfma_f32_16x16x32_bf16 v[24:27], v[208:211], v[92:95], v[24:27]
    buffer_load_dwordx4 v1, s[16:19], s42 offen offset:0 sc1 lds
    v_mfma_f32_16x16x32_bf16 v[28:31], v[212:215], v[92:95], v[28:31]
    ds_read_b128 v[84:87], v3 offset:40960
    v_mfma_f32_16x16x32_bf16 v[20:23], v[212:215], v[88:91], v[20:23]
    v_mfma_f32_16x16x32_bf16 v[32:35], v[216:219], v[88:91], v[32:35]
    v_mfma_f32_16x16x32_bf16 v[40:43], v[216:219], v[92:95], v[40:43]
    v_mfma_f32_16x16x32_bf16 v[44:47], v[220:223], v[92:95], v[44:47]
    buffer_load_dwordx4 v1, s[16:19], s42 offen offset:1024 sc1 lds
    v_mfma_f32_16x16x32_bf16 v[36:39], v[220:223], v[88:91], v[36:39]
    s_waitcnt lgkmcnt(0)
    v_mfma_f32_16x16x32_bf16 v[16:19], v[224:227], v[80:83], v[16:19]
    ds_read_b128 v[88:91], v2 offset:43008
    v_mfma_f32_16x16x32_bf16 v[24:27], v[224:227], v[84:87], v[24:27]
    v_mfma_f32_16x16x32_bf16 v[28:31], v[228:231], v[84:87], v[28:31]
    ds_read_b128 v[92:95], v3 offset:43008
    v_mfma_f32_16x16x32_bf16 v[20:23], v[228:231], v[80:83], v[20:23]
    buffer_load_dwordx4 v1, s[16:19], s42 offen offset:2048 sc1 lds
    v_mfma_f32_16x16x32_bf16 v[32:35], v[232:235], v[80:83], v[32:35]
    v_mfma_f32_16x16x32_bf16 v[40:43], v[232:235], v[84:87], v[40:43]
    v_mfma_f32_16x16x32_bf16 v[44:47], v[236:239], v[84:87], v[44:47]
    v_mfma_f32_16x16x32_bf16 v[36:39], v[236:239], v[80:83], v[36:39]
    s_waitcnt vmcnt(6) lgkmcnt(0)
    s_barrier
    v_mfma_f32_16x16x32_bf16 v[16:19], v[240:243], v[88:91], v[16:19]
    ds_read_b128 v[80:83], v4 offset:0
    v_mfma_f32_16x16x32_bf16 v[24:27], v[240:243], v[92:95], v[24:27]
    buffer_load_dwordx4 v1, s[16:19], s42 offen offset:3072 sc1 lds
    v_mfma_f32_16x16x32_bf16 v[28:31], v[244:247], v[92:95], v[28:31]
    s_add_u32 s45, s45, 65536
    ds_read_b128 v[84:87], v5 offset:0
    v_mfma_f32_16x16x32_bf16 v[20:23], v[244:247], v[88:91], v[20:23]
    v_mfma_f32_16x16x32_bf16 v[32:35], v[248:251], v[88:91], v[32:35]
    v_mfma_f32_16x16x32_bf16 v[40:43], v[248:251], v[92:95], v[40:43]
    v_mfma_f32_16x16x32_bf16 v[44:47], v[252:255], v[92:95], v[44:47]
    s_add_u32 s36, s36, 1
    v_mfma_f32_16x16x32_bf16 v[36:39], v[252:255], v[88:91], v[36:39]
    s_waitcnt lgkmcnt(0)
L_bf_b1:
    v_mfma_f32_16x16x32_bf16 v[48:51], a[0:3], v[80:83], v[112:115]
    s_sub_u32 s47, s45, 196608
    ds_read_b128 v[88:91], v4 offset:2048
    s_max_u32 s47, s47, 0x5500000
    v_mfma_f32_16x16x32_bf16 v[56:59], a[0:3], v[84:87], 0
    buffer_load_dword v13, v8, s[16:19], s47 offen sc1
    v_mfma_f32_16x16x32_bf16 v[60:63], a[4:7], v[84:87], 0
    s_and_b32 s38, s53, 0xffffffff
    ds_read_b128 v[92:95], v5 offset:2048
    s_cmp_lt_i32 s36, 1
    v_mfma_f32_16x16x32_bf16 v[52:55], a[4:7], v[80:83], v[116:119]
    s_cselect_b32 s38, 0x5e00000, s38
    v_mfma_f32_16x16x32_bf16 v[64:67], a[8:11], v[80:83], 0
    buffer_load_dwordx4 v[136:139], v1, s[16:19], s38 offen sc1
    v_mfma_f32_16x16x32_bf16 v[72:75], a[8:11], v[84:87], 0
    s_add_u32 s53, s53, 65536
    ds_read_b128 v[144:147], v11 offset:512
    s_and_b32 s44, s90, 0xffffffff
    v_mfma_f32_16x16x32_bf16 v[76:79], a[12:15], v[84:87], 0
    s_cmp_lt_i32 s36, 1
    s_cselect_b32 s44, 0x5e00000, s44
    s_xor_b32 s49, s44, 16384
    v_mfma_f32_16x16x32_bf16 v[68:71], a[12:15], v[80:83], 0
    s_waitcnt lgkmcnt(1)
    v_cvt_pk_bf16_f32 v24, v24, v25
    v_cvt_pk_bf16_f32 v25, v26, v27
    v_mfma_f32_16x16x32_bf16 v[48:51], a[16:19], v[88:91], v[48:51]
    ds_read_b128 v[80:83], v4 offset:4096
    v_cvt_pk_bf16_f32 v26, v28, v29
    v_mfma_f32_16x16x32_bf16 v[56:59], a[16:19], v[92:95], v[56:59]
    v_cvt_pk_bf16_f32 v27, v30, v31
    v_mfma_f32_16x16x32_bf16 v[60:63], a[20:23], v[92:95], v[60:63]
    s_waitcnt lgkmcnt(1)
    ds_read_b128 v[84:87], v5 offset:4096
    v_add_f32 v144, v144, v145
    v_mfma_f32_16x16x32_bf16 v[52:55], a[20:23], v[88:91], v[52:55]
    buffer_store_dwordx4 v[24:27], v1, s[16:19], s49 offen offset:0 sc1
    v_mfma_f32_16x16x32_bf16 v[64:67], a[24:27], v[88:91], v[64:67]
    s_xor_b32 s49, s44, 32768
    v_cvt_pk_bf16_f32 v32, v32, v33
    v_cvt_pk_bf16_f32 v33, v34, v35
    v_mfma_f32_16x16x32_bf16 v[72:75], a[24:27], v[92:95], v[72:75]
    v_cvt_pk_bf16_f32 v34, v36, v37
    v_cvt_pk_bf16_f32 v35, v38, v39
    v_mfma_f32_16x16x32_bf16 v[76:79], a[28:31], v[92:95], v[76:79]
    buffer_store_dwordx4 v[32:35], v1, s[16:19], s49 offen offset:1024 sc1
    v_mfma_f32_16x16x32_bf16 v[68:71], a[28:31], v[88:91], v[68:71]
    s_waitcnt lgkmcnt(0)
    v_add_f32 v146, v146, v147
    v_add_f32 v144, v144, v146
    v_mfma_f32_16x16x32_bf16 v[48:51], a[32:35], v[80:83], v[48:51]
    s_xor_b32 s49, s44, 49152
    ds_read_b128 v[88:91], v4 offset:6144
    v_cvt_pk_bf16_f32 v40, v40, v41
    v_mfma_f32_16x16x32_bf16 v[56:59], a[32:35], v[84:87], v[56:59]
    v_cvt_pk_bf16_f32 v41, v42, v43
    v_cvt_pk_bf16_f32 v42, v44, v45
    v_mfma_f32_16x16x32_bf16 v[60:63], a[36:39], v[84:87], v[60:63]
    ds_read_b128 v[92:95], v5 offset:6144
    v_cvt_pk_bf16_f32 v43, v46, v47
    v_mfma_f32_16x16x32_bf16 v[52:55], a[36:39], v[80:83], v[52:55]
    buffer_store_dwordx4 v[40:43], v1, s[16:19], s49 offen offset:2048 sc1
    v_mfma_f32_16x16x32_bf16 v[64:67], a[40:43], v[80:83], v[64:67]
    s_add_u32 s90, s90, 262144
    v_mfma_f32_16x16x32_bf16 v[72:75], a[40:43], v[84:87], v[72:75]
    v_mfma_f32_16x16x32_bf16 v[76:79], a[44:47], v[84:87], v[76:79]
    buffer_store_dword v144, v12, s[16:19], s46 offen sc1
    v_mfma_f32_16x16x32_bf16 v[68:71], a[44:47], v[80:83], v[68:71]
    s_waitcnt lgkmcnt(0)
    v_mfma_f32_16x16x32_bf16 v[48:51], a[48:51], v[88:91], v[48:51]
    s_add_u32 s98, s98, 262144
    ds_read_b128 v[80:83], v4 offset:8192
    s_min_i32 s98, s98, s96
    v_mfma_f32_16x16x32_bf16 v[56:59], a[48:51], v[92:95], v[56:59]
    s_and_b32 s41, s98, 0xffffffff
    s_add_u32 m0, s43, 0
    s_add_u32 s42, s41, 0
    v_mfma_f32_16x16x32_bf16 v[60:63], a[52:55], v[92:95], v[60:63]
    ds_read_b128 v[84:87], v5 offset:8192
    v_mfma_f32_16x16x32_bf16 v[52:55], a[52:55], v[88:91], v[52:55]
    v_mfma_f32_16x16x32_bf16 v[64:67], a[56:59], v[88:91], v[64:67]
    v_mfma_f32_16x16x32_bf16 v[72:75], a[56:59], v[92:95], v[72:75]
    v_mfma_f32_16x16x32_bf16 v[76:79], a[60:63], v[92:95], v[76:79]
    v_mfma_f32_16x16x32_bf16 v[68:71], a[60:63], v[88:91], v[68:71]
    s_waitcnt lgkmcnt(0)
    v_mfma_f32_16x16x32_bf16 v[48:51], a[64:67], v[80:83], v[48:51]
    ds_read_b128 v[88:91], v4 offset:10240
    v_mfma_f32_16x16x32_bf16 v[56:59], a[64:67], v[84:87], v[56:59]
    v_mfma_f32_16x16x32_bf16 v[60:63], a[68:71], v[84:87], v[60:63]
    ds_read_b128 v[92:95], v5 offset:10240
    v_mfma_f32_16x16x32_bf16 v[52:55], a[68:71], v[80:83], v[52:55]
    v_mfma_f32_16x16x32_bf16 v[64:67], a[72:75], v[80:83], v[64:67]
    v_mfma_f32_16x16x32_bf16 v[72:75], a[72:75], v[84:87], v[72:75]
    v_mfma_f32_16x16x32_bf16 v[76:79], a[76:79], v[84:87], v[76:79]
    v_mfma_f32_16x16x32_bf16 v[68:71], a[76:79], v[80:83], v[68:71]
    s_waitcnt lgkmcnt(0)
    v_mfma_f32_16x16x32_bf16 v[48:51], a[80:83], v[88:91], v[48:51]
    ds_read_b128 v[80:83], v4 offset:12288
    v_mfma_f32_16x16x32_bf16 v[56:59], a[80:83], v[92:95], v[56:59]
    v_mfma_f32_16x16x32_bf16 v[60:63], a[84:87], v[92:95], v[60:63]
    ds_read_b128 v[84:87], v5 offset:12288
    v_mfma_f32_16x16x32_bf16 v[52:55], a[84:87], v[88:91], v[52:55]
    v_mfma_f32_16x16x32_bf16 v[64:67], a[88:91], v[88:91], v[64:67]
    s_waitcnt vmcnt(5)
    v_cmp_ne_u32 vcc, 0, v13
    v_mfma_f32_16x16x32_bf16 v[72:75], a[88:91], v[92:95], v[72:75]
    v_mfma_f32_16x16x32_bf16 v[76:79], a[92:95], v[92:95], v[76:79]
    s_cbranch_vccnz L_spin69
L_back70:
    s_sub_u32 s48, s90, 524288
    s_and_b32 s48, s48, 0xffffffff
    v_mfma_f32_16x16x32_bf16 v[68:71], a[92:95], v[88:91], v[68:71]
    s_waitcnt lgkmcnt(0)
    s_cmp_lt_i32 s36, 2
    s_cselect_b32 s48, s52, s48
    v_mfma_f32_16x16x32_bf16 v[48:51], a[96:99], v[80:83], v[48:51]
    ds_read_b128 v[88:91], v4 offset:14336
    v_mfma_f32_16x16x32_bf16 v[56:59], a[96:99], v[84:87], v[56:59]
    buffer_load_dwordx4 v[140:143], v1, s[16:19], s48 offen offset:0 sc1
    v_mfma_f32_16x16x32_bf16 v[60:63], a[100:103], v[84:87], v[60:63]
    ds_read_b128 v[92:95], v5 offset:14336
    v_mfma_f32_16x16x32_bf16 v[52:55], a[100:103], v[80:83], v[52:55]
    v_mfma_f32_16x16x32_bf16 v[64:67], a[104:107], v[80:83], v[64:67]
    buffer_load_dword v96, v6, s[16:19], s45 offen sc1
    v_mfma_f32_16x16x32_bf16 v[72:75], a[104:107], v[84:87], v[72:75]
    v_mfma_f32_16x16x32_bf16 v[76:79], a[108:111], v[84:87], v[76:79]
    v_mfma_f32_16x16x32_bf16 v[68:71], a[108:111], v[80:83], v[68:71]
    s_waitcnt lgkmcnt(0)
    v_mfma_f32_16x16x32_bf16 v[48:51], a[112:115], v[88:91], v[48:51]
    ds_read_b128 v[80:83], v4 offset:16384
    v_mfma_f32_16x16x32_bf16 v[56:59], a[112:115], v[92:95], v[56:59]
    buffer_load_dwordx4 v[144:147], v1, s[16:19], s48 offen offset:1024 sc1
    v_mfma_f32_16x16x32_bf16 v[60:63], a[116:119], v[92:95], v[60:63]
    ds_read_b128 v[84:87], v5 offset:16384
    v_mfma_f32_16x16x32_bf16 v[52:55], a[116:119], v[88:91], v[52:55]
    v_mfma_f32_16x16x32_bf16 v[64:67], a[120:123], v[88:91], v[64:67]
    buffer_load_dwordx4 v[148:151], v1, s[16:19], s48 offen offset:2048 sc1
    v_mfma_f32_16x16x32_bf16 v[72:75], a[120:123], v[92:95], v[72:75]
    v_mfma_f32_16x16x32_bf16 v[76:79], a[124:127], v[92:95], v[76:79]
    v_mfma_f32_16x16x32_bf16 v[68:71], a[124:127], v[88:91], v[68:71]
    s_waitcnt lgkmcnt(0)
    v_mfma_f32_16x16x32_bf16 v[48:51], a[128:131], v[80:83], v[48:51]
    ds_read_b128 v[88:91], v4 offset:18432
    v_mfma_f32_16x16x32_bf16 v[56:59], a[128:131], v[84:87], v[56:59]
    buffer_load_dwordx4 v[152:155], v1, s[16:19], s48 offen offset:3072 sc1
    v_mfma_f32_16x16x32_bf16 v[60:63], a[132:135], v[84:87], v[60:63]
    s_sub_u32 s47, s36, 2
    ds_read_b128 v[92:95], v5 offset:18432
    s_cmp_lt_u32 s47, 16
    v_mfma_f32_16x16x32_bf16 v[52:55], a[132:135], v[80:83], v[52:55]
    s_cselect_b32 s48, 0x5000000, s52
    s_add_u32 s20, s84, s48
    s_addc_u32 s21, s85, 0
    v_mfma_f32_16x16x32_bf16 v[64:67], a[136:139], v[80:83], v[64:67]
    s_cmp_ge_i32 s47, 16
    s_cselect_b32 s20, s80, s20
    s_cselect_b32 s21, s81, s21
    v_mfma_f32_16x16x32_bf16 v[72:75], a[136:139], v[84:87], v[72:75]
    s_and_b32 s48, s47, 15
    s_lshl_b32 s48, s48, 1
    s_sub_u32 s48, s50, s48
    v_mfma_f32_16x16x32_bf16 v[76:79], a[140:143], v[84:87], v[76:79]
    s_lshl_b32 s46, s48, 10
    s_sub_u32 s46, s55, s46
    s_cmp_lt_u32 s47, 16
    v_mfma_f32_16x16x32_bf16 v[68:71], a[140:143], v[80:83], v[68:71]
    s_waitcnt lgkmcnt(0)
    s_cselect_b32 s46, s46, s52
    s_lshl_b32 s48, s48, 15
    v_mfma_f32_16x16x32_bf16 v[48:51], a[144:147], v[88:91], v[48:51]
    ds_read_b128 v[80:83], v4 offset:20480
    v_mfma_f32_16x16x32_bf16 v[56:59], a[144:147], v[92:95], v[56:59]
    v_mfma_f32_16x16x32_bf16 v[60:63], a[148:151], v[92:95], v[60:63]
    ds_read_b128 v[84:87], v5 offset:20480
    v_mfma_f32_16x16x32_bf16 v[52:55], a[148:151], v[88:91], v[52:55]
    v_mfma_f32_16x16x32_bf16 v[64:67], a[152:155], v[88:91], v[64:67]
    v_mfma_f32_16x16x32_bf16 v[72:75], a[152:155], v[92:95], v[72:75]
    v_mfma_f32_16x16x32_bf16 v[76:79], a[156:159], v[92:95], v[76:79]
    v_mfma_f32_16x16x32_bf16 v[68:71], a[156:159], v[88:91], v[68:71]
    s_waitcnt lgkmcnt(0)
    v_mfma_f32_16x16x32_bf16 v[48:51], a[160:163], v[80:83], v[48:51]
    ds_read_b128 v[88:91], v4 offset:22528
    v_mfma_f32_16x16x32_bf16 v[56:59], a[160:163], v[84:87], v[56:59]
    v_mfma_f32_16x16x32_bf16 v[60:63], a[164:167], v[84:87], v[60:63]
    ds_read_b128 v[92:95], v5 offset:22528
    v_mfma_f32_16x16x32_bf16 v[52:55], a[164:167], v[80:83], v[52:55]
    v_mfma_f32_16x16x32_bf16 v[64:67], a[168:171], v[80:83], v[64:67]
    v_mfma_f32_16x16x32_bf16 v[72:75], a[168:171], v[84:87], v[72:75]
    v_mfma_f32_16x16x32_bf16 v[76:79], a[172:175], v[84:87], v[76:79]
    v_mfma_f32_16x16x32_bf16 v[68:71], a[172:175], v[80:83], v[68:71]
    s_waitcnt lgkmcnt(0)
    v_mfma_f32_16x16x32_bf16 v[48:51], a[176:179], v[88:91], v[48:51]
    ds_read_b128 v[80:83], v4 offset:24576
    v_mfma_f32_16x16x32_bf16 v[56:59], a[176:179], v[92:95], v[56:59]
    v_mfma_f32_16x16x32_bf16 v[60:63], a[180:183], v[92:95], v[60:63]
    ds_read_b128 v[84:87], v5 offset:24576
    v_mfma_f32_16x16x32_bf16 v[52:55], a[180:183], v[88:91], v[52:55]
    v_mfma_f32_16x16x32_bf16 v[64:67], a[184:187], v[88:91], v[64:67]
    v_mfma_f32_16x16x32_bf16 v[72:75], a[184:187], v[92:95], v[72:75]
    v_mfma_f32_16x16x32_bf16 v[76:79], a[188:191], v[92:95], v[76:79]
    s_waitcnt vmcnt(3)
    v_cmp_ne_u32 vcc, 0, v96
    v_mfma_f32_16x16x32_bf16 v[68:71], a[188:191], v[88:91], v[68:71]
    s_waitcnt lgkmcnt(0)
    v_mfma_f32_16x16x32_bf16 v[48:51], a[192:195], v[80:83], v[48:51]
    s_cbranch_vccnz L_spin71
L_back72:
    ds_read_b128 v[88:91], v4 offset:26624
    s_barrier
    v_mfma_f32_16x16x32_bf16 v[56:59], a[192:195], v[84:87], v[56:59]
    buffer_load_dwordx4 v1, s[16:19], s42 offen offset:0 sc1 lds
    v_mfma_f32_16x16x32_bf16 v[60:63], a[196:199], v[84:87], v[60:63]
    ds_read_b128 v[92:95], v5 offset:26624
    v_mfma_f32_16x16x32_bf16 v[52:55], a[196:199], v[80:83], v[52:55]
    v_mfma_f32_16x16x32_bf16 v[64:67], a[200:203], v[80:83], v[64:67]
    v_mfma_f32_16x16x32_bf16 v[72:75], a[200:203], v[84:87], v[72:75]
    buffer_load_dwordx4 v1, s[16:19], s42 offen offset:1024 sc1 lds
    v_mfma_f32_16x16x32_bf16 v[76:79], a[204:207], v[84:87], v[76:79]
    v_mfma_f32_16x16x32_bf16 v[68:71], a[204:207], v[80:83], v[68:71]
    s_waitcnt lgkmcnt(0)
    v_mfma_f32_16x16x32_bf16 v[48:51], a[208:211], v[88:91], v[48:51]
    ds_read_b128 v[80:83], v4 offset:28672
    v_mfma_f32_16x16x32_bf16 v[56:59], a[208:211], v[92:95], v[56:59]
    buffer_load_dwordx4 v1, s[16:19], s42 offen offset:2048 sc1 lds
    v_mfma_f32_16x16x32_bf16 v[60:63], a[212:215], v[92:95], v[60:63]
    ds_read_b128 v[84:87], v5 offset:28672
    v_mfma_f32_16x16x32_bf16 v[52:55], a[212:215], v[88:91], v[52:55]
    v_mfma_f32_16x16x32_bf16 v[64:67], a[216:219], v[88:91], v[64:67]
    v_mfma_f32_16x16x32_bf16 v[72:75], a[216:219], v[92:95], v[72:75]
    buffer_load_dwordx4 v1, s[16:19], s42 offen offset:3072 sc1 lds
    v_mfma_f32_16x16x32_bf16 v[76:79], a[220:223], v[92:95], v[76:79]
    s_add_u32 m0, s88, 16384
    s_add_u32 s42, s41, 16384
    s_add_u32 s42, s42, s89
    v_mfma_f32_16x16x32_bf16 v[68:71], a[220:223], v[88:91], v[68:71]
    s_waitcnt lgkmcnt(0)
    v_mfma_f32_16x16x32_bf16 v[48:51], a[224:227], v[80:83], v[48:51]
    ds_read_b128 v[88:91], v4 offset:30720
    v_mfma_f32_16x16x32_bf16 v[56:59], a[224:227], v[84:87], v[56:59]
    buffer_load_dwordx4 v1, s[16:19], s42 offen offset:0 sc1 lds
    v_mfma_f32_16x16x32_bf16 v[60:63], a[228:231], v[84:87], v[60:63]
    ds_read_b128 v[92:95], v5 offset:30720
    v_mfma_f32_16x16x32_bf16 v[52:55], a[228:231], v[80:83], v[52:55]
    v_mfma_f32_16x16x32_bf16 v[64:67], a[232:235], v[80:83], v[64:67]
    s_waitcnt vmcnt(5)
    v_mfma_f32_16x16x32_bf16 v[128:131], v[104:107], v[140:143], v[128:131]
    v_mfma_f32_16x16x32_bf16 v[132:135], v[108:111], v[140:143], v[132:135]
    v_mfma_f32_16x16x32_bf16 v[128:131], v[104:107], v[144:147], v[128:131]
    v_mfma_f32_16x16x32_bf16 v[132:135], v[108:111], v[144:147], v[132:135]
    v_mfma_f32_16x16x32_bf16 v[128:131], v[104:107], v[148:151], v[128:131]
    v_mfma_f32_16x16x32_bf16 v[132:135], v[108:111], v[148:151], v[132:135]
    v_mfma_f32_16x16x32_bf16 v[128:131], v[104:107], v[152:155], v[128:131]
    v_mfma_f32_16x16x32_bf16 v[132:135], v[108:111], v[152:155], v[132:135]
    v_mfma_f32_16x16x32_bf16 v[72:75], a[232:235], v[84:87], v[72:75]
    buffer_load_dwordx4 v1, s[16:19], s42 offen offset:1024 sc1 lds
    v_mfma_f32_16x16x32_bf16 v[76:79], a[236:239], v[84:87], v[76:79]
    s_nop 0
    v_cvt_pk_bf16_f32 v140, v128, v129
    v_cvt_pk_bf16_f32 v141, v130, v131
    v_mfma_f32_16x16x32_bf16 v[68:71], a[236:239], v[80:83], v[68:71]
    s_waitcnt lgkmcnt(0)
    v_cvt_pk_bf16_f32 v142, v132, v133
    v_cvt_pk_bf16_f32 v143, v134, v135
    v_mfma_f32_16x16x32_bf16 v[48:51], a[240:243], v[88:91], v[48:51]
    ds_read_b128 v[80:83], v4 offset:32768
    v_mfma_f32_16x16x32_bf16 v[56:59], a[240:243], v[92:95], v[56:59]
    buffer_load_dwordx4 v1, s[16:19], s42 offen offset:2048 sc1 lds
    v_mfma_f32_16x16x32_bf16 v[60:63], a[244:247], v[92:95], v[60:63]
    ds_read_b128 v[84:87], v5 offset:32768
    v_mfma_f32_16x16x32_bf16 v[52:55], a[244:247], v[88:91], v[52:55]
    v_mfma_f32_16x16x32_bf16 v[64:67], a[248:251], v[88:91], v[64:67]
    buffer_store_dword v124, v124, s[16:19], s91 offen sc1
    v_mfma_f32_16x16x32_bf16 v[72:75], a[248:251], v[92:95], v[72:75]
    s_add_u32 s91, s91, 65536
    s_add_u32 s39, s91, -163840
    v_mfma_f32_16x16x32_bf16 v[76:79], a[252:255], v[92:95], v[76:79]
    v_mfma_f32_16x16x32_bf16 v[68:71], a[252:255], v[88:91], v[68:71]
    s_waitcnt lgkmcnt(0)
    v_mfma_f32_16x16x32_bf16 v[48:51], v[160:163], v[80:83], v[48:51]
    ds_read_b128 v[88:91], v4 offset:34816
    v_mfma_f32_16x16x32_bf16 v[56:59], v[160:163], v[84:87], v[56:59]
    buffer_store_dword v124, v124, s[16:19], s39 offen sc1
    v_mfma_f32_16x16x32_bf16 v[60:63], v[164:167], v[84:87], v[60:63]
    ds_read_b128 v[92:95], v5 offset:34816
    v_mfma_f32_16x16x32_bf16 v[52:55], v[164:167], v[80:83], v[52:55]
    v_mfma_f32_16x16x32_bf16 v[64:67], v[168:171], v[80:83], v[64:67]
    buffer_store_dwordx4 v[140:143], v9, s[20:23], s48 offen sc1
    v_mfma_f32_16x16x32_bf16 v[72:75], v[168:171], v[84:87], v[72:75]
    v_add_f32 v100, v128, v129
    v_mul_f32 v101, v128, v128
    v_mfma_f32_16x16x32_bf16 v[76:79], v[172:175], v[84:87], v[76:79]
    v_fmac_f32 v101, v129, v129
    v_add_f32 v100, v100, v130
    v_mfma_f32_16x16x32_bf16 v[68:71], v[172:175], v[80:83], v[68:71]
    s_waitcnt lgkmcnt(0)
    v_fmac_f32 v101, v130, v130
    v_add_f32 v100, v100, v131
    v_mfma_f32_16x16x32_bf16 v[48:51], v[176:179], v[88:91], v[48:51]
    ds_read_b128 v[80:83], v4 offset:36864
    v_fmac_f32 v101, v131, v131
    v_mfma_f32_16x16x32_bf16 v[56:59], v[176:179], v[92:95], v[56:59]
    v_add_f32 v100, v100, v132
    v_fmac_f32 v101, v132, v132
    v_mfma_f32_16x16x32_bf16 v[60:63], v[180:183], v[92:95], v[60:63]
    ds_read_b128 v[84:87], v5 offset:36864
    v_add_f32 v100, v100, v133
    v_mfma_f32_16x16x32_bf16 v[52:55], v[180:183], v[88:91], v[52:55]
    v_fmac_f32 v101, v133, v133
    v_add_f32 v100, v100, v134
    v_mfma_f32_16x16x32_bf16 v[64:67], v[184:187], v[88:91], v[64:67]
    v_fmac_f32 v101, v134, v134
    v_add_f32 v100, v100, v135
    v_mfma_f32_16x16x32_bf16 v[72:75], v[184:187], v[92:95], v[72:75]
    v_fmac_f32 v101, v135, v135
    v_mfma_f32_16x16x32_bf16 v[76:79], v[188:191], v[92:95], v[76:79]
    v_permlane16_swap_b32 v100, v101
    v_mfma_f32_16x16x32_bf16 v[68:71], v[188:191], v[88:91], v[68:71]
    s_waitcnt lgkmcnt(0)
    v_add_f32 v100, v100, v101
    v_mov_b32 v102, v100
    v_mfma_f32_16x16x32_bf16 v[48:51], v[192:195], v[80:83], v[48:51]
    ds_read_b128 v[88:91], v4 offset:38912
    v_mfma_f32_16x16x32_bf16 v[56:59], v[192:195], v[84:87], v[56:59]
    v_permlane32_swap_b32 v100, v102
    v_mfma_f32_16x16x32_bf16 v[60:63], v[196:199], v[84:87], v[60:63]
    ds_read_b128 v[92:95], v5 offset:38912
    v_add_f32 v100, v100, v102
    v_mfma_f32_16x16x32_bf16 v[52:55], v[196:199], v[80:83], v[52:55]
    ds_write_b32 v10, v100 offset:0
    v_mfma_f32_16x16x32_bf16 v[64:67], v[200:203], v[80:83], v[64:67]
    s_waitcnt vmcnt(19)
    v_mfma_f32_16x16x32_bf16 v[128:131], v[104:107], v[136:139], v[16:19]
    v_mfma_f32_16x16x32_bf16 v[132:135], v[108:111], v[136:139], v[20:23]
    v_mfma_f32_16x16x32_bf16 v[72:75], v[200:203], v[84:87], v[72:75]
    v_mfma_f32_16x16x32_bf16 v[76:79], v[204:207], v[84:87], v[76:79]
    s_add_u32 m0, s43, 28672
    s_add_u32 s42, s41, 28672
    v_mfma_f32_16x16x32_bf16 v[68:71], v[204:207], v[80:83], v[68:71]
    s_waitcnt lgkmcnt(1)
    v_mfma_f32_16x16x32_bf16 v[48:51], v[208:211], v[88:91], v[48:51]
    ds_read_b128 v[80:83], v4 offset:40960
    v_mfma_f32_16x16x32_bf16 v[56:59], v[208:211], v[92:95], v[56:59]
    buffer_load_dwordx4 v1, s[16:19], s42 offen offset:0 sc1 lds
    v_mfma_f32_16x16x32_bf16 v[60:63], v[212:215], v[92:95], v[60:63]
    ds_read_b128 v[84:87], v5 offset:40960
    v_mfma_f32_16x16x32_bf16 v[52:55], v[212:215], v[88:91], v[52:55]
    v_mfma_f32_16x16x32_bf16 v[64:67], v[216:219], v[88:91], v[64:67]
    v_mfma_f32_16x16x32_bf16 v[72:75], v[216:219], v[92:95], v[72:75]
    v_mfma_f32_16x16x32_bf16 v[76:79], v[220:223], v[92:95], v[76:79]
    buffer_load_dwordx4 v1, s[16:19], s42 offen offset:1024 sc1 lds
    v_mfma_f32_16x16x32_bf16 v[68:71], v[220:223], v[88:91], v[68:71]
    s_waitcnt lgkmcnt(0)
    v_mfma_f32_16x16x32_bf16 v[48:51], v[224:227], v[80:83], v[48:51]
    ds_read_b128 v[88:91], v4 offset:43008
    v_mfma_f32_16x16x32_bf16 v[56:59], v[224:227], v[84:87], v[56:59]
    v_mfma_f32_16x16x32_bf16 v[60:63], v[228:231], v[84:87], v[60:63]
    ds_read_b128 v[92:95], v5 offset:43008
    v_mfma_f32_16x16x32_bf16 v[52:55], v[228:231], v[80:83], v[52:55]
    buffer_load_dwordx4 v1, s[16:19], s42 offen offset:2048 sc1 lds
    v_mfma_f32_16x16x32_bf16 v[64:67], v[232:235], v[80:83], v[64:67]
    v_mfma_f32_16x16x32_bf16 v[72:75], v[232:235], v[84:87], v[72:75]
    v_mfma_f32_16x16x32_bf16 v[76:79], v[236:239], v[84:87], v[76:79]
    v_mfma_f32_16x16x32_bf16 v[68:71], v[236:239], v[80:83], v[68:71]
    s_waitcnt vmcnt(6) lgkmcnt(0)
    s_barrier
    v_mfma_f32_16x16x32_bf16 v[48:51], v[240:243], v[88:91], v[48:51]
    ds_read_b128 v[80:83], v2 offset:0
    v_mfma_f32_16x16x32_bf16 v[56:59], v[240:243], v[92:95], v[56:59]
    buffer_load_dwordx4 v1, s[16:19], s42 offen offset:3072 sc1 lds
    v_mfma_f32_16x16x32_bf16 v[60:63], v[244:247], v[92:95], v[60:63]
    s_add_u32 s45, s45, 65536
    ds_read_b128 v[84:87], v3 offset:0
    v_mfma_f32_16x16x32_bf16 v[52:55], v[244:247], v[88:91], v[52:55]
    v_mfma_f32_16x16x32_bf16 v[64:67], v[248:251], v[88:91], v[64:67]
    v_mfma_f32_16x16x32_bf16 v[72:75], v[248:251], v[92:95], v[72:75]
    v_mfma_f32_16x16x32_bf16 v[76:79], v[252:255], v[92:95], v[76:79]
    s_add_u32 s36, s36, 1
    v_mfma_f32_16x16x32_bf16 v[68:71], v[252:255], v[88:91], v[68:71]
    s_waitcnt lgkmcnt(0)
    s_cmp_lt_u32 s36, 32
    s_cbranch_scc1 L_bf_b0
    s_nop 7
    s_sub_u32 s47, s45, 196608
    s_max_u32 s47, s47, 0x5500000
    buffer_load_dword v13, v8, s[16:19], s47 offen sc1
    s_and_b32 s38, s53, 0xffffffff
    s_cmp_lt_i32 s36, 1
    s_cselect_b32 s38, 0x5e00000, s38
    buffer_load_dwordx4 v[136:139], v1, s[16:19], s38 offen sc1
    s_add_u32 s53, s53, 65536
    s_and_b32 s44, s90, 0xffffffff
    s_cmp_lt_i32 s36, 1
    s_cselect_b32 s44, 0x5e00000, s44
    s_xor_b32 s49, s44, 16384
    v_cvt_pk_bf16_f32 v56, v56, v57
    v_cvt_pk_bf16_f32 v57, v58, v59
    v_cvt_pk_bf16_f32 v58, v60, v61
    v_cvt_pk_bf16_f32 v59, v62, v63
    v_min_u32 v56, -2, v56
    v_min_u32 v57, -2, v57
    v_min_u32 v58, -2, v58
    v_min_u32 v59, -2, v59
    buffer_store_dwordx4 v[56:59], v1, s[16:19], s49 offen offset:0 sc1
    s_xor_b32 s49, s44, 32768
    v_cvt_pk_bf16_f32 v64, v64, v65
    v_cvt_pk_bf16_f32 v65, v66, v67
    v_cvt_pk_bf16_f32 v66, v68, v69
    v_cvt_pk_bf16_f32 v67, v70, v71
    v_min_u32 v64, -2, v64
    v_min_u32 v65, -2, v65
    v_min_u32 v66, -2, v66
    v_min_u32 v67, -2, v67
    buffer_store_dwordx4 v[64:67], v1, s[16:19], s49 offen offset:1024 sc1
    s_xor_b32 s49, s44, 49152
    v_cvt_pk_bf16_f32 v72, v72, v73
    v_cvt_pk_bf16_f32 v73, v74, v75
    v_cvt_pk_bf16_f32 v74, v76, v77
    v_cvt_pk_bf16_f32 v75, v78, v79
    v_min_u32 v72, -2, v72
    v_min_u32 v73, -2, v73
    v_min_u32 v74, -2, v74
    v_min_u32 v75, -2, v75
    buffer_store_dwordx4 v[72:75], v1, s[16:19], s49 offen offset:2048 sc1
    s_add_u32 s90, s90, 262144
    s_waitcnt vmcnt(4)
    v_cmp_ne_u32 vcc, 0, v13
    s_cbranch_vccnz L_spin73
L_back74:
    s_barrier
    s_sub_u32 s48, s90, 524288
    s_and_b32 s48, s48, 0xffffffff
    s_cmp_lt_i32 s36, 2
    s_cselect_b32 s48, s52, s48
    buffer_load_dwordx4 v[140:143], v1, s[16:19], s48 offen offset:0 sc1
    buffer_load_dwordx4 v[144:147], v1, s[16:19], s48 offen offset:1024 sc1
    buffer_load_dwordx4 v[148:151], v1, s[16:19], s48 offen offset:2048 sc1
    buffer_load_dwordx4 v[152:155], v1, s[16:19], s48 offen offset:3072 sc1
    s_sub_u32 s47, s36, 2
    s_cmp_lt_u32 s47, 16
    s_cselect_b32 s48, 0x5000000, s52
    s_add_u32 s20, s84, s48
    s_addc_u32 s21, s85, 0
    s_cmp_ge_i32 s47, 16
    s_cselect_b32 s20, s80, s20
    s_cselect_b32 s21, s81, s21
    s_and_b32 s48, s47, 15
    s_lshl_b32 s48, s48, 1
    s_sub_u32 s48, s50, s48
    s_lshl_b32 s46, s48, 10
    s_sub_u32 s46, s55, s46
    s_cmp_lt_u32 s47, 16
    s_cselect_b32 s46, s46, s52
    s_lshl_b32 s48, s48, 15
    s_waitcnt vmcnt(7)
    v_mfma_f32_16x16x32_bf16 v[48:51], v[104:107], v[136:139], v[48:51]
    v_mfma_f32_16x16x32_bf16 v[52:55], v[108:111], v[136:139], v[52:55]
    s_waitcnt vmcnt(4)
    buffer_load_dwordx4 v[160:163], v1, s[16:19], s44 offen offset:0 sc1
    buffer_load_dwordx4 v[164:167], v1, s[16:19], s44 offen offset:1024 sc1
    buffer_load_dwordx4 v[168:171], v1, s[16:19], s44 offen offset:2048 sc1
    buffer_load_dwordx4 v[172:175], v1, s[16:19], s44 offen offset:3072 sc1
    s_waitcnt vmcnt(4)
    v_mfma_f32_16x16x32_bf16 v[128:131], v[104:107], v[140:143], v[128:131]
    v_mfma_f32_16x16x32_bf16 v[132:135], v[108:111], v[140:143], v[132:135]
    v_mfma_f32_16x16x32_bf16 v[128:131], v[104:107], v[144:147], v[128:131]
    v_mfma_f32_16x16x32_bf16 v[132:135], v[108:111], v[144:147], v[132:135]
    v_mfma_f32_16x16x32_bf16 v[128:131], v[104:107], v[148:151], v[128:131]
    v_mfma_f32_16x16x32_bf16 v[132:135], v[108:111], v[148:151], v[132:135]
    v_mfma_f32_16x16x32_bf16 v[128:131], v[104:107], v[152:155], v[128:131]
    v_mfma_f32_16x16x32_bf16 v[132:135], v[108:111], v[152:155], v[132:135]
    s_nop 5
    v_cvt_pk_bf16_f32 v140, v128, v129
    v_cvt_pk_bf16_f32 v141, v130, v131
    v_cvt_pk_bf16_f32 v142, v132, v133
    v_cvt_pk_bf16_f32 v143, v134, v135
    s_waitcnt vmcnt(0)
    v_max3_u32 v176, v160, v161, v162
    v_max3_u32 v177, v163, v164, v165
    v_max3_u32 v178, v166, v167, v168
    v_max3_u32 v179, v169, v170, v171
    v_max3_u32 v180, v172, v173, v174
    v_max3_u32 v176, v176, v177, v178
    v_max3_u32 v179, v179, v180, v175
    v_max_u32 v176, v176, v179
    v_cmp_eq_u32 vcc, -1, v176
    s_cbranch_vccnz L_gspin75
L_gback76:
    buffer_store_dwordx4 v[140:143], v9, s[20:23], s48 offen sc1
    v_mfma_f32_16x16x32_bf16 v[48:51], v[104:107], v[160:163], v[48:51]
    v_mfma_f32_16x16x32_bf16 v[52:55], v[108:111], v[160:163], v[52:55]
    v_mfma_f32_16x16x32_bf16 v[48:51], v[104:107], v[164:167], v[48:51]
    v_mfma_f32_16x16x32_bf16 v[52:55], v[108:111], v[164:167], v[52:55]
    v_mfma_f32_16x16x32_bf16 v[48:51], v[104:107], v[168:171], v[48:51]
    v_mfma_f32_16x16x32_bf16 v[52:55], v[108:111], v[168:171], v[52:55]
    v_mfma_f32_16x16x32_bf16 v[48:51], v[104:107], v[172:175], v[48:51]
    v_mfma_f32_16x16x32_bf16 v[52:55], v[108:111], v[172:175], v[52:55]
    s_sub_u32 s48, s48, 65536
    s_nop 4
    v_cvt_pk_bf16_f32 v160, v48, v49
    v_cvt_pk_bf16_f32 v161, v50, v51
    v_cvt_pk_bf16_f32 v162, v52, v53
    v_cvt_pk_bf16_f32 v163, v54, v55
    buffer_store_dwordx4 v[160:163], v9, s[20:23], s48 offen sc1
    s_waitcnt vmcnt(0)
    s_endpgm
L_spin58:
    s_mov_b32 s40, 0x20000
L_spin58_l:
    buffer_load_dword v8, v124, s[20:23], 0 offen sc1
    s_sub_u32 s40, s40, 1
    s_waitcnt vmcnt(0)
    v_cmp_eq_u32 vcc, v124, v8
    s_cbranch_scc1 L_back59
    s_cbranch_vccz L_back59
    s_sleep 8
    s_branch L_spin58_l
L_spin61:
    s_mov_b32 s40, 0x20000
L_spin61_l:
    buffer_load_dword v80, v124, s[20:23], 0 offen sc1
    s_sub_u32 s40, s40, 1
    s_waitcnt vmcnt(0)
    v_cmp_eq_u32 vcc, v124, v80
    s_cbranch_scc1 L_back62
    s_cbranch_vccz L_back62
    s_sleep 8
    s_branch L_spin61_l
L_spin63:
    s_mov_b32 s40, 0x20000
L_spin63_l:
    buffer_load_dword v96, v6, s[16:19], s45 offen sc1
    s_sub_u32 s40, s40, 1
    s_waitcnt vmcnt(0)
    v_cmp_ne_u32 vcc, 0, v96
    s_cbranch_scc1 L_back64
    s_cbranch_vccz L_back64
    s_sleep 2
    s_branch L_spin63_l
L_spin65:
    s_mov_b32 s40, 0x20000
L_spin65_l:
    buffer_load_dword v13, v8, s[16:19], s47 offen sc1
    s_sub_u32 s40, s40, 1
    s_waitcnt vmcnt(0)
    v_cmp_ne_u32 vcc, 0, v13
    s_cbranch_scc1 L_back66
    s_cbranch_vccz L_back66
    s_sleep 2
    s_branch L_spin65_l
L_spin67:
    s_mov_b32 s40, 0x20000
L_spin67_l:
    buffer_load_dword v96, v6, s[16:19], s45 offen sc1
    s_sub_u32 s40, s40, 1
    s_waitcnt vmcnt(0)
    v_cmp_ne_u32 vcc, 0, v96
    s_cbranch_scc1 L_back68
    s_cbranch_vccz L_back68
    s_sleep 2
    s_branch L_spin67_l
L_spin69:
    s_mov_b32 s40, 0x20000
L_spin69_l:
    buffer_load_dword v13, v8, s[16:19], s47 offen sc1
    s_sub_u32 s40, s40, 1
    s_waitcnt vmcnt(0)
    v_cmp_ne_u32 vcc, 0, v13
    s_cbranch_scc1 L_back70
    s_cbranch_vccz L_back70
    s_sleep 2
    s_branch L_spin69_l
L_spin71:
    s_mov_b32 s40, 0x20000
L_spin71_l:
    buffer_load_dword v96, v6, s[16:19], s45 offen sc1
    s_sub_u32 s40, s40, 1
    s_waitcnt vmcnt(0)
    v_cmp_ne_u32 vcc, 0, v96
    s_cbranch_scc1 L_back72
    s_cbranch_vccz L_back72
    s_sleep 2
    s_branch L_spin71_l
L_spin73:
    s_mov_b32 s40, 0x20000
L_spin73_l:
    buffer_load_dword v13, v8, s[16:19], s47 offen sc1
    s_sub_u32 s40, s40, 1
    s_waitcnt vmcnt(0)
    v_cmp_ne_u32 vcc, 0, v13
    s_cbranch_scc1 L_back74
    s_cbranch_vccz L_back74
    s_sleep 2
    s_branch L_spin73_l
L_gspin75:
    s_mov_b32 s40, 0x20000
L_gspin75_l:
    buffer_load_dwordx4 v[160:163], v1, s[16:19], s44 offen offset:0 sc1
    buffer_load_dwordx4 v[164:167], v1, s[16:19], s44 offen offset:1024 sc1
    buffer_load_dwordx4 v[168:171], v1, s[16:19], s44 offen offset:2048 sc1
    buffer_load_dwordx4 v[172:175], v1, s[16:19], s44 offen offset:3072 sc1
    s_sub_u32 s40, s40, 1
    s_waitcnt vmcnt(0)
    v_max3_u32 v176, v160, v161, v162
    v_max3_u32 v177, v163, v164, v165
    v_max3_u32 v178, v166, v167, v168
    v_max3_u32 v179, v169, v170, v171
    v_max3_u32 v180, v172, v173, v174
    v_max3_u32 v176, v176, v177, v178
    v_max3_u32 v179, v179, v180, v175
    v_max_u32 v176, v176, v179
    v_cmp_eq_u32 vcc, -1, v176
    s_cbranch_scc1 L_gback76
    s_cbranch_vccz L_gback76
    s_sleep 2
    s_branch L_gspin75_l
L_role_60:
    s_sub_u32 s35, s34, 44
    s_barrier
    s_add_u32 s12, s72, 0x400000
    s_addc_u32 s13, s73, 0
    s_mov_b32 s14, 0x300000
    s_mov_b32 s15, 0x00020000
    s_sub_u32 s37, s35, 12
    s_lshl2_add_u32 s37, s37, s33
    s_lshl2_add_u32 s37, s37, s32
    s_lshl_b32 s37, s37, 13
    v_lshlrev_b32 v6, 7, v0
    buffer_load_dword v240, v6, s[12:15], s37 offen
    s_add_u32 s37, s37, 1048576
    buffer_load_dword v241, v6, s[12:15], s37 offen
    s_add_u32 s37, s37, 1048576
    buffer_load_dword v242, v6, s[12:15], s37 offen
    s_add_u32 s37, s37, 1048576
    s_lshr_b32 s51, s35, 2
    s_and_b32 s87, s35, 3
    s_mul_i32 s54, s51, 1441792
    s_lshl_b32 s37, s87, 9
    s_add_u32 s54, s54, s37
    s_mov_b32 s12, s76
    s_mov_b32 s13, s77
    s_mov_b32 s14, 0x700000
    s_mov_b32 s15, 0x00020000
    s_mov_b32 s39, 2048
    v_lshrrev_b32 v64, 3, v0
    v_lshlrev_b32 v65, 2, v0
    v_and_b32 v65, 64, v65
    v_and_b32 v66, 0x70, v1
    v_xor_b32 v65, v65, v66
    v_mad_u32_u24 v48, v64, s39, v65
    v_add_u32 v49, 16384, v48
    v_add_u32 v50, 128, v48
    v_add_u32 v51, 16512, v48
    v_add_u32 v52, 256, v48
    v_add_u32 v53, 16640, v48
    v_add_u32 v54, 384, v48
    v_add_u32 v55, 16768, v48
    s_mul_i32 s38, s32, 32768
    s_add_u32 s54, s54, s38
    s_lshl_b32 s42, s32, 11
    s_add_u32 m0, s42, 0
    s_nop 0
    buffer_load_dwordx4 v48, s[12:15], s54 offen lds
    s_add_u32 m0, s42, 1024
    s_nop 0
    buffer_load_dwordx4 v49, s[12:15], s54 offen lds
    s_add_u32 m0, s42, 8192
    s_nop 0
    buffer_load_dwordx4 v50, s[12:15], s54 offen lds
    s_add_u32 m0, s42, 9216
    s_nop 0
    buffer_load_dwordx4 v51, s[12:15], s54 offen lds
    s_add_u32 m0, s42, 16384
    s_nop 0
    buffer_load_dwordx4 v52, s[12:15], s54 offen lds
    s_add_u32 m0, s42, 17408
    s_nop 0
    buffer_load_dwordx4 v53, s[12:15], s54 offen lds
    s_add_u32 m0, s42, 24576
    s_nop 0
    buffer_load_dwordx4 v54, s[12:15], s54 offen lds
    s_add_u32 m0, s42, 25600
    s_nop 0
    buffer_load_dwordx4 v55, s[12:15], s54 offen lds
    s_add_u32 s54, s54, 131072
    s_add_u32 m0, s42, 32768
    s_nop 0
    buffer_load_dwordx4 v48, s[12:15], s54 offen lds
    s_add_u32 m0, s42, 33792
    s_nop 0
    buffer_load_dwordx4 v49, s[12:15], s54 offen lds
    s_add_u32 m0, s42, 40960
    s_nop 0
    buffer_load_dwordx4 v50, s[12:15], s54 offen lds
    s_add_u32 m0, s42, 41984
    s_nop 0
    buffer_load_dwordx4 v51, s[12:15], s54 offen lds
    s_add_u32 m0, s42, 49152
    s_nop 0
    buffer_load_dwordx4 v52, s[12:15], s54 offen lds
    s_add_u32 m0, s42, 50176
    s_nop 0
    buffer_load_dwordx4 v53, s[12:15], s54 offen lds
    s_add_u32 m0, s42, 57344
    s_nop 0
    buffer_load_dwordx4 v54, s[12:15], s54 offen lds
    s_add_u32 m0, s42, 58368
    s_nop 0
    buffer_load_dwordx4 v55, s[12:15], s54 offen lds
    s_add_u32 s54, s54, 131072
    s_add_u32 m0, s42, 65536
    s_nop 0
    buffer_load_dwordx4 v48, s[12:15], s54 offen lds
    s_add_u32 m0, s42, 66560
    s_nop 0
    buffer_load_dwordx4 v49, s[12:15], s54 offen lds
    s_add_u32 m0, s42, 73728
    s_nop 0
    buffer_load_dwordx4 v50, s[12:15], s54 offen lds
    s_add_u32 m0, s42, 74752
    s_nop 0
    buffer_load_dwordx4 v51, s[12:15], s54 offen lds
    s_add_u32 m0, s42, 81920
    s_nop 0
    buffer_load_dwordx4 v52, s[12:15], s54 offen lds
    s_add_u32 m0, s42, 82944
    s_nop 0
    buffer_load_dwordx4 v53, s[12:15], s54 offen lds
    s_add_u32 m0, s42, 90112
    s_nop 0
    buffer_load_dwordx4 v54, s[12:15], s54 offen lds
    s_add_u32 m0, s42, 91136
    s_nop 0
    buffer_load_dwordx4 v55, s[12:15], s54 offen lds
    s_add_u32 s54, s54, 131072
    s_add_u32 m0, s42, 98304
    s_nop 0
    buffer_load_dwordx4 v48, s[12:15], s54 offen lds
    s_add_u32 m0, s42, 99328
    s_nop 0
    buffer_load_dwordx4 v49, s[12:15], s54 offen lds
    s_add_u32 m0, s42, 106496
    s_nop 0
    buffer_load_dwordx4 v50, s[12:15], s54 offen lds
    s_add_u32 m0, s42, 107520
    s_nop 0
    buffer_load_dwordx4 v51, s[12:15], s54 offen lds
    s_add_u32 m0, s42, 114688
    s_nop 0
    buffer_load_dwordx4 v52, s[12:15], s54 offen lds
    s_add_u32 m0, s42, 115712
    s_nop 0
    buffer_load_dwordx4 v53, s[12:15], s54 offen lds
    s_add_u32 m0, s42, 122880
    s_nop 0
    buffer_load_dwordx4 v54, s[12:15], s54 offen lds
    s_add_u32 m0, s42, 123904
    s_nop 0
    buffer_load_dwordx4 v55, s[12:15], s54 offen lds
    s_add_u32 s54, s54, 131072
    v_lshrrev_b32 v64, 4, v0
    v_bfe_u32 v65, v0, 2, 2
    v_lshl_add_u32 v64, v64, 3, v65
    v_lshlrev_b32 v64, 7, v64
    v_lshrrev_b32 v65, 1, v65
    v_lshl_add_u32 v64, v65, 6, v64
    v_and_b32 v65, 3, v0
    v_lshl_add_u32 v64, v65, 4, v64
    s_lshl_b32 s37, s32, 13
    s_and_b32 s38, s51, 2
    s_lshl_b32 s38, s38, 5
    s_xor_b32 s38, s38, 0
    s_add_u32 s37, s37, s38
    v_xor_b32 v56, s37, v64
    s_lshl_b32 s37, s32, 13
    s_and_b32 s38, s51, 2
    s_lshl_b32 s38, s38, 5
    s_xor_b32 s38, s38, 8
    s_add_u32 s37, s37, s38
    v_xor_b32 v57, s37, v64
    s_lshl_b32 s37, s32, 13
    s_and_b32 s38, s51, 2
    s_lshl_b32 s38, s38, 5
    s_xor_b32 s38, s38, 64
    s_add_u32 s37, s37, s38
    v_xor_b32 v58, s37, v64
    s_lshl_b32 s37, s32, 13
    s_and_b32 s38, s51, 2
    s_lshl_b32 s38, s38, 5
    s_xor_b32 s38, s38, 72
    s_add_u32 s37, s37, s38
    v_xor_b32 v59, s37, v64
    s_and_b32 s39, s51, 1
    s_lshl_b32 s37, s39, 10
    v_add_u32 v2, s37, v1
    v_xor_b32 v3, 1024, v2
    v_add_u32 v4, 98304, v2
    v_add_u32 v5, 98304, v3
    s_mul_i32 s38, s51, 11*43
    s_lshr_b32 s38, s38, 7
    s_add_u32 s38, s38, 24
    s_lshl_b32 s37, s33, 6
    s_add_u32 s37, s37, s38
    s_lshl_b32 s37, s37, 7
    v_lshl_add_u32 v6, v0, 7, s37
    s_cmp_eq_u32 s32, 0
    s_cselect_b32 s37, 6, 0
    v_cmp_le_u32 vcc, s37, v0
    s_nop 1
    v_cndmask_b32 v6, v6, 2.0, vcc
    s_mul_i32 s43, s32, 4096
    s_mul_i32 s88, s32, 3072
    s_sub_u32 s89, s88, s43
    s_mul_i32 s41, s33, 8388608
    s_add_u32 s41, s41, 0x1000000
    s_mul_i32 s37, s51, 45056
    s_add_u32 s41, s41, s37
    s_add_u32 s41, s41, s43
    s_mul_i32 s90, s33, 8388608
    s_add_u32 s90, s90, 0x2fc0000
    s_lshl_b32 s37, s87, 16
    s_add_u32 s90, s90, s37
    s_lshl_b32 s37, s32, 12
    s_add_u32 s90, s90, s37
    s_and_b32 s37, s51, 3
    s_lshl_b32 s37, s37, 14
    s_add_u32 s90, s90, s37
    v_add_u32 v60, 0, v56
    v_add_u32 v61, 0, v57
    v_add_u32 v62, 0, v58
    v_add_u32 v63, 0, v59
    s_waitcnt vmcnt(24)
    s_barrier
    ds_read_b64_tr_b16 a[0:1], v60 offset:0
    ds_read_b64_tr_b16 a[2:3], v60 offset:512
    ds_read_b64_tr_b16 a[4:5], v61 offset:0
    ds_read_b64_tr_b16 a[6:7], v61 offset:512
    ds_read_b64_tr_b16 a[8:9], v62 offset:0
    ds_read_b64_tr_b16 a[10:11], v62 offset:512
    ds_read_b64_tr_b16 a[12:13], v63 offset:0
    ds_read_b64_tr_b16 a[14:15], v63 offset:512
    ds_read_b64_tr_b16 a[16:17], v60 offset:4096
    ds_read_b64_tr_b16 a[18:19], v60 offset:4608
    ds_read_b64_tr_b16 a[20:21], v61 offset:4096
    ds_read_b64_tr_b16 a[22:23], v61 offset:4608
    ds_read_b64_tr_b16 a[24:25], v62 offset:4096
    ds_read_b64_tr_b16 a[26:27], v62 offset:4608
    ds_read_b64_tr_b16 a[28:29], v63 offset:4096
    ds_read_b64_tr_b16 a[30:31], v63 offset:4608
    s_add_u32 m0, s42, 131072
    s_nop 0
    buffer_load_dwordx4 v48, s[12:15], s54 offen lds
    s_add_u32 m0, s42, 132096
    s_nop 0
    buffer_load_dwordx4 v49, s[12:15], s54 offen lds
    s_add_u32 m0, s42, 139264
    s_nop 0
    buffer_load_dwordx4 v50, s[12:15], s54 offen lds
    s_add_u32 m0, s42, 140288
    s_nop 0
    buffer_load_dwordx4 v51, s[12:15], s54 offen lds
    s_add_u32 m0, s42, 147456
    s_nop 0
    buffer_load_dwordx4 v52, s[12:15], s54 offen lds
    s_add_u32 m0, s42, 148480
    s_nop 0
    buffer_load_dwordx4 v53, s[12:15], s54 offen lds
    s_add_u32 m0, s42, 155648
    s_nop 0
    buffer_load_dwordx4 v54, s[12:15], s54 offen lds
    s_add_u32 m0, s42, 156672
    s_nop 0
    buffer_load_dwordx4 v55, s[12:15], s54 offen lds
    s_add_u32 s54, s54, 131072
    s_waitcnt lgkmcnt(0)
    v_add_u32 v60, 32768, v56
    v_add_u32 v61, 32768, v57
    v_add_u32 v62, 32768, v58
    v_add_u32 v63, 32768, v59
    s_waitcnt vmcnt(24)
    s_barrier
    ds_read_b64_tr_b16 a[32:33], v60 offset:0
    ds_read_b64_tr_b16 a[34:35], v60 offset:512
    ds_read_b64_tr_b16 a[36:37], v61 offset:0
    ds_read_b64_tr_b16 a[38:39], v61 offset:512
    ds_read_b64_tr_b16 a[40:41], v62 offset:0
    ds_read_b64_tr_b16 a[42:43], v62 offset:512
    ds_read_b64_tr_b16 a[44:45], v63 offset:0
    ds_read_b64_tr_b16 a[46:47], v63 offset:512
    ds_read_b64_tr_b16 a[48:49], v60 offset:4096
    ds_read_b64_tr_b16 a[50:51], v60 offset:4608
    ds_read_b64_tr_b16 a[52:53], v61 offset:4096
    ds_read_b64_tr_b16 a[54:55], v61 offset:4608
    ds_read_b64_tr_b16 a[56:57], v62 offset:4096
    ds_read_b64_tr_b16 a[58:59], v62 offset:4608
    ds_read_b64_tr_b16 a[60:61], v63 offset:4096
    ds_read_b64_tr_b16 a[62:63], v63 offset:4608
    s_add_u32 m0, s42, 0
    s_nop 0
    buffer_load_dwordx4 v48, s[12:15], s54 offen lds
    s_add_u32 m0, s42, 1024
    s_nop 0
    buffer_load_dwordx4 v49, s[12:15], s54 offen lds
    s_add_u32 m0, s42, 8192
    s_nop 0
    buffer_load_dwordx4 v50, s[12:15], s54 offen lds
    s_add_u32 m0, s42, 9216
    s_nop 0
    buffer_load_dwordx4 v51, s[12:15], s54 offen lds
    s_add_u32 m0, s42, 16384
    s_nop 0
    buffer_load_dwordx4 v52, s[12:15], s54 offen lds
    s_add_u32 m0, s42, 17408
    s_nop 0
    buffer_load_dwordx4 v53, s[12:15], s54 offen lds
    s_add_u32 m0, s42, 24576
    s_nop 0
    buffer_load_dwordx4 v54, s[12:15], s54 offen lds
    s_add_u32 m0, s42, 25600
    s_nop 0
    buffer_load_dwordx4 v55, s[12:15], s54 offen lds
    s_add_u32 s54, s54, 131072
    s_waitcnt lgkmcnt(0)
    v_add_u32 v60, 65536, v56
    v_add_u32 v61, 65536, v57
    v_add_u32 v62, 65536, v58
    v_add_u32 v63, 65536, v59
    s_waitcnt vmcnt(24)
    s_barrier
    ds_read_b64_tr_b16 a[64:65], v60 offset:0
    ds_read_b64_tr_b16 a[66:67], v60 offset:512
    ds_read_b64_tr_b16 a[68:69], v61 offset:0
    ds_read_b64_tr_b16 a[70:71], v61 offset:512
    ds_read_b64_tr_b16 a[72:73], v62 offset:0
    ds_read_b64_tr_b16 a[74:75], v62 offset:512
    ds_read_b64_tr_b16 a[76:77], v63 offset:0
    ds_read_b64_tr_b16 a[78:79], v63 offset:512
    ds_read_b64_tr_b16 a[80:81], v60 offset:4096
    ds_read_b64_tr_b16 a[82:83], v60 offset:4608
    ds_read_b64_tr_b16 a[84:85], v61 offset:4096
    ds_read_b64_tr_b16 a[86:87], v61 offset:4608
    ds_read_b64_tr_b16 a[88:89], v62 offset:4096
    ds_read_b64_tr_b16 a[90:91], v62 offset:4608
    ds_read_b64_tr_b16 a[92:93], v63 offset:4096
    ds_read_b64_tr_b16 a[94:95], v63 offset:4608
    s_add_u32 m0, s42, 32768
    s_nop 0
    buffer_load_dwordx4 v48, s[12:15], s54 offen lds
    s_add_u32 m0, s42, 33792
    s_nop 0
    buffer_load_dwordx4 v49, s[12:15], s54 offen lds
    s_add_u32 m0, s42, 40960
    s_nop 0
    buffer_load_dwordx4 v50, s[12:15], s54 offen lds
    s_add_u32 m0, s42, 41984
    s_nop 0
    buffer_load_dwordx4 v51, s[12:15], s54 offen lds
    s_add_u32 m0, s42, 49152
    s_nop 0
    buffer_load_dwordx4 v52, s[12:15], s54 offen lds
    s_add_u32 m0, s42, 50176
    s_nop 0
    buffer_load_dwordx4 v53, s[12:15], s54 offen lds
    s_add_u32 m0, s42, 57344
    s_nop 0
    buffer_load_dwordx4 v54, s[12:15], s54 offen lds
    s_add_u32 m0, s42, 58368
    s_nop 0
    buffer_load_dwordx4 v55, s[12:15], s54 offen lds
    s_add_u32 s54, s54, 131072
    s_waitcnt lgkmcnt(0)
    v_add_u32 v60, 98304, v56
    v_add_u32 v61, 98304, v57
    v_add_u32 v62, 98304, v58
    v_add_u32 v63, 98304, v59
    s_waitcnt vmcnt(24)
    s_barrier
    ds_read_b64_tr_b16 a[96:97], v60 offset:0
    ds_read_b64_tr_b16 a[98:99], v60 offset:512
    ds_read_b64_tr_b16 a[100:101], v61 offset:0
    ds_read_b64_tr_b16 a[102:103], v61 offset:512
    ds_read_b64_tr_b16 a[104:105], v62 offset:0
    ds_read_b64_tr_b16 a[106:107], v62 offset:512
    ds_read_b64_tr_b16 a[108:109], v63 offset:0
    ds_read_b64_tr_b16 a[110:111], v63 offset:512
    ds_read_b64_tr_b16 a[112:113], v60 offset:4096
    ds_read_b64_tr_b16 a[114:115], v60 offset:4608
    ds_read_b64_tr_b16 a[116:117], v61 offset:4096
    ds_read_b64_tr_b16 a[118:119], v61 offset:4608
    ds_read_b64_tr_b16 a[120:121], v62 offset:4096
    ds_read_b64_tr_b16 a[122:123], v62 offset:4608
    ds_read_b64_tr_b16 a[124:125], v63 offset:4096
    ds_read_b64_tr_b16 a[126:127], v63 offset:4608
    s_add_u32 m0, s42, 65536
    s_nop 0
    buffer_load_dwordx4 v48, s[12:15], s54 offen lds
    s_add_u32 m0, s42, 66560
    s_nop 0
    buffer_load_dwordx4 v49, s[12:15], s54 offen lds
    s_add_u32 m0, s42, 73728
    s_nop 0
    buffer_load_dwordx4 v50, s[12:15], s54 offen lds
    s_add_u32 m0, s42, 74752
    s_nop 0
    buffer_load_dwordx4 v51, s[12:15], s54 offen lds
    s_add_u32 m0, s42, 81920
    s_nop 0
    buffer_load_dwordx4 v52, s[12:15], s54 offen lds
    s_add_u32 m0, s42, 82944
    s_nop 0
    buffer_load_dwordx4 v53, s[12:15], s54 offen lds
    s_add_u32 m0, s42, 90112
    s_nop 0
    buffer_load_dwordx4 v54, s[12:15], s54 offen lds
    s_add_u32 m0, s42, 91136
    s_nop 0
    buffer_load_dwordx4 v55, s[12:15], s54 offen lds
    s_add_u32 s54, s54, 131072
    s_waitcnt lgkmcnt(0)
    v_add_u32 v60, 131072, v56
    v_add_u32 v61, 131072, v57
    v_add_u32 v62, 131072, v58
    v_add_u32 v63, 131072, v59
    s_waitcnt vmcnt(24)
    s_barrier
    ds_read_b64_tr_b16 a[128:129], v60 offset:0
    ds_read_b64_tr_b16 a[130:131], v60 offset:512
    ds_read_b64_tr_b16 a[132:133], v61 offset:0
    ds_read_b64_tr_b16 a[134:135], v61 offset:512
    ds_read_b64_tr_b16 a[136:137], v62 offset:0
    ds_read_b64_tr_b16 a[138:139], v62 offset:512
    ds_read_b64_tr_b16 a[140:141], v63 offset:0
    ds_read_b64_tr_b16 a[142:143], v63 offset:512
    ds_read_b64_tr_b16 a[144:145], v60 offset:4096
    ds_read_b64_tr_b16 a[146:147], v60 offset:4608
    ds_read_b64_tr_b16 a[148:149], v61 offset:4096
    ds_read_b64_tr_b16 a[150:151], v61 offset:4608
    ds_read_b64_tr_b16 a[152:153], v62 offset:4096
    ds_read_b64_tr_b16 a[154:155], v62 offset:4608
    ds_read_b64_tr_b16 a[156:157], v63 offset:4096
    ds_read_b64_tr_b16 a[158:159], v63 offset:4608
    s_add_u32 m0, s42, 98304
    s_nop 0
    buffer_load_dwordx4 v48, s[12:15], s54 offen lds
    s_add_u32 m0, s42, 99328
    s_nop 0
    buffer_load_dwordx4 v49, s[12:15], s54 offen lds
    s_add_u32 m0, s42, 106496
    s_nop 0
    buffer_load_dwordx4 v50, s[12:15], s54 offen lds
    s_add_u32 m0, s42, 107520
    s_nop 0
    buffer_load_dwordx4 v51, s[12:15], s54 offen lds
    s_add_u32 m0, s42, 114688
    s_nop 0
    buffer_load_dwordx4 v52, s[12:15], s54 offen lds
    s_add_u32 m0, s42, 115712
    s_nop 0
    buffer_load_dwordx4 v53, s[12:15], s54 offen lds
    s_add_u32 m0, s42, 122880
    s_nop 0
    buffer_load_dwordx4 v54, s[12:15], s54 offen lds
    s_add_u32 m0, s42, 123904
    s_nop 0
    buffer_load_dwordx4 v55, s[12:15], s54 offen lds
    s_add_u32 s54, s54, 131072
    s_waitcnt lgkmcnt(0)
    v_add_u32 v60, 0, v56
    v_add_u32 v61, 0, v57
    v_add_u32 v62, 0, v58
    v_add_u32 v63, 0, v59
    s_waitcnt vmcnt(24)
    s_barrier
    ds_read_b64_tr_b16 a[160:161], v60 offset:0
    ds_read_b64_tr_b16 a[162:163], v60 offset:512
    ds_read_b64_tr_b16 a[164:165], v61 offset:0
    ds_read_b64_tr_b16 a[166:167], v61 offset:512
    ds_read_b64_tr_b16 a[168:169], v62 offset:0
    ds_read_b64_tr_b16 a[170:171], v62 offset:512
    ds_read_b64_tr_b16 a[172:173], v63 offset:0
    ds_read_b64_tr_b16 a[174:175], v63 offset:512
    ds_read_b64_tr_b16 a[176:177], v60 offset:4096
    ds_read_b64_tr_b16 a[178:179], v60 offset:4608
    ds_read_b64_tr_b16 a[180:181], v61 offset:4096
    ds_read_b64_tr_b16 a[182:183], v61 offset:4608
    ds_read_b64_tr_b16 a[184:185], v62 offset:4096
    ds_read_b64_tr_b16 a[186:187], v62 offset:4608
    ds_read_b64_tr_b16 a[188:189], v63 offset:4096
    ds_read_b64_tr_b16 a[190:191], v63 offset:4608
    s_add_u32 m0, s42, 131072
    s_nop 0
    buffer_load_dwordx4 v48, s[12:15], s54 offen lds
    s_add_u32 m0, s42, 132096
    s_nop 0
    buffer_load_dwordx4 v49, s[12:15], s54 offen lds
    s_add_u32 m0, s42, 139264
    s_nop 0
    buffer_load_dwordx4 v50, s[12:15], s54 offen lds
    s_add_u32 m0, s42, 140288
    s_nop 0
    buffer_load_dwordx4 v51, s[12:15], s54 offen lds
    s_add_u32 m0, s42, 147456
    s_nop 0
    buffer_load_dwordx4 v52, s[12:15], s54 offen lds
    s_add_u32 m0, s42, 148480
    s_nop 0
    buffer_load_dwordx4 v53, s[12:15], s54 offen lds
    s_add_u32 m0, s42, 155648
    s_nop 0
    buffer_load_dwordx4 v54, s[12:15], s54 offen lds
    s_add_u32 m0, s42, 156672
    s_nop 0
    buffer_load_dwordx4 v55, s[12:15], s54 offen lds
    s_add_u32 s54, s54, 131072
    s_waitcnt lgkmcnt(0)
    v_add_u32 v60, 32768, v56
    v_add_u32 v61, 32768, v57
    v_add_u32 v62, 32768, v58
    v_add_u32 v63, 32768, v59
    s_waitcnt vmcnt(24)
    s_barrier
    ds_read_b64_tr_b16 a[192:193], v60 offset:0
    ds_read_b64_tr_b16 a[194:195], v60 offset:512
    ds_read_b64_tr_b16 a[196:197], v61 offset:0
    ds_read_b64_tr_b16 a[198:199], v61 offset:512
    ds_read_b64_tr_b16 a[200:201], v62 offset:0
    ds_read_b64_tr_b16 a[202:203], v62 offset:512
    ds_read_b64_tr_b16 a[204:205], v63 offset:0
    ds_read_b64_tr_b16 a[206:207], v63 offset:512
    ds_read_b64_tr_b16 a[208:209], v60 offset:4096
    ds_read_b64_tr_b16 a[210:211], v60 offset:4608
    ds_read_b64_tr_b16 a[212:213], v61 offset:4096
    ds_read_b64_tr_b16 a[214:215], v61 offset:4608
    ds_read_b64_tr_b16 a[216:217], v62 offset:4096
    ds_read_b64_tr_b16 a[218:219], v62 offset:4608
    ds_read_b64_tr_b16 a[220:221], v63 offset:4096
    ds_read_b64_tr_b16 a[222:223], v63 offset:4608
    s_add_u32 m0, s42, 0
    s_nop 0
    buffer_load_dwordx4 v48, s[12:15], s54 offen lds
    s_add_u32 m0, s42, 1024
    s_nop 0
    buffer_load_dwordx4 v49, s[12:15], s54 offen lds
    s_add_u32 m0, s42, 8192
    s_nop 0
    buffer_load_dwordx4 v50, s[12:15], s54 offen lds
    s_add_u32 m0, s42, 9216
    s_nop 0
    buffer_load_dwordx4 v51, s[12:15], s54 offen lds
    s_add_u32 m0, s42, 16384
    s_nop 0
    buffer_load_dwordx4 v52, s[12:15], s54 offen lds
    s_add_u32 m0, s42, 17408
    s_nop 0
    buffer_load_dwordx4 v53, s[12:15], s54 offen lds
    s_add_u32 m0, s42, 24576
    s_nop 0
    buffer_load_dwordx4 v54, s[12:15], s54 offen lds
    s_add_u32 m0, s42, 25600
    s_nop 0
    buffer_load_dwordx4 v55, s[12:15], s54 offen lds
    s_add_u32 s54, s54, 131072
    s_waitcnt lgkmcnt(0)
    v_add_u32 v60, 65536, v56
    v_add_u32 v61, 65536, v57
    v_add_u32 v62, 65536, v58
    v_add_u32 v63, 65536, v59
    s_waitcnt vmcnt(24)
    s_barrier
    ds_read_b64_tr_b16 a[224:225], v60 offset:0
    ds_read_b64_tr_b16 a[226:227], v60 offset:512
    ds_read_b64_tr_b16 a[228:229], v61 offset:0
    ds_read_b64_tr_b16 a[230:231], v61 offset:512
    ds_read_b64_tr_b16 a[232:233], v62 offset:0
    ds_read_b64_tr_b16 a[234:235], v62 offset:512
    ds_read_b64_tr_b16 a[236:237], v63 offset:0
    ds_read_b64_tr_b16 a[238:239], v63 offset:512
    ds_read_b64_tr_b16 a[240:241], v60 offset:4096
    ds_read_b64_tr_b16 a[242:243], v60 offset:4608
    ds_read_b64_tr_b16 a[244:245], v61 offset:4096
    ds_read_b64_tr_b16 a[246:247], v61 offset:4608
    ds_read_b64_tr_b16 a[248:249], v62 offset:4096
    ds_read_b64_tr_b16 a[250:251], v62 offset:4608
    ds_read_b64_tr_b16 a[252:253], v63 offset:4096
    ds_read_b64_tr_b16 a[254:255], v63 offset:4608
    s_add_u32 m0, s42, 32768
    s_nop 0
    buffer_load_dwordx4 v48, s[12:15], s54 offen lds
    s_add_u32 m0, s42, 33792
    s_nop 0
    buffer_load_dwordx4 v49, s[12:15], s54 offen lds
    s_add_u32 m0, s42, 40960
    s_nop 0
    buffer_load_dwordx4 v50, s[12:15], s54 offen lds
    s_add_u32 m0, s42, 41984
    s_nop 0
    buffer_load_dwordx4 v51, s[12:15], s54 offen lds
    s_add_u32 m0, s42, 49152
    s_nop 0
    buffer_load_dwordx4 v52, s[12:15], s54 offen lds
    s_add_u32 m0, s42, 50176
    s_nop 0
    buffer_load_dwordx4 v53, s[12:15], s54 offen lds
    s_add_u32 m0, s42, 57344
    s_nop 0
    buffer_load_dwordx4 v54, s[12:15], s54 offen lds
    s_add_u32 m0, s42, 58368
    s_nop 0
    buffer_load_dwordx4 v55, s[12:15], s54 offen lds
    s_add_u32 s54, s54, 131072
    s_waitcnt lgkmcnt(0)
    v_add_u32 v60, 98304, v56
    v_add_u32 v61, 98304, v57
    v_add_u32 v62, 98304, v58
    v_add_u32 v63, 98304, v59
    s_waitcnt vmcnt(24)
    s_barrier
    ds_read_b64_tr_b16 v[128:129], v60 offset:0
    ds_read_b64_tr_b16 v[130:131], v60 offset:512
    ds_read_b64_tr_b16 v[132:133], v61 offset:0
    ds_read_b64_tr_b16 v[134:135], v61 offset:512
    ds_read_b64_tr_b16 v[136:137], v62 offset:0
    ds_read_b64_tr_b16 v[138:139], v62 offset:512
    ds_read_b64_tr_b16 v[140:141], v63 offset:0
    ds_read_b64_tr_b16 v[142:143], v63 offset:512
    ds_read_b64_tr_b16 v[144:145], v60 offset:4096
    ds_read_b64_tr_b16 v[146:147], v60 offset:4608
    ds_read_b64_tr_b16 v[148:149], v61 offset:4096
    ds_read_b64_tr_b16 v[150:151], v61 offset:4608
    ds_read_b64_tr_b16 v[152:153], v62 offset:4096
    ds_read_b64_tr_b16 v[154:155], v62 offset:4608
    ds_read_b64_tr_b16 v[156:157], v63 offset:4096
    ds_read_b64_tr_b16 v[158:159], v63 offset:4608
    s_waitcnt lgkmcnt(0)
    v_add_u32 v60, 131072, v56
    v_add_u32 v61, 131072, v57
    v_add_u32 v62, 131072, v58
    v_add_u32 v63, 131072, v59
    s_waitcnt vmcnt(16)
    s_barrier
    ds_read_b64_tr_b16 v[160:161], v60 offset:0
    ds_read_b64_tr_b16 v[162:163], v60 offset:512
    ds_read_b64_tr_b16 v[164:165], v61 offset:0
    ds_read_b64_tr_b16 v[166:167], v61 offset:512
    ds_read_b64_tr_b16 v[168:169], v62 offset:0
    ds_read_b64_tr_b16 v[170:171], v62 offset:512
    ds_read_b64_tr_b16 v[172:173], v63 offset:0
    ds_read_b64_tr_b16 v[174:175], v63 offset:512
    ds_read_b64_tr_b16 v[176:177], v60 offset:4096
    ds_read_b64_tr_b16 v[178:179], v60 offset:4608
    ds_read_b64_tr_b16 v[180:181], v61 offset:4096
    ds_read_b64_tr_b16 v[182:183], v61 offset:4608
    ds_read_b64_tr_b16 v[184:185], v62 offset:4096
    ds_read_b64_tr_b16 v[186:187], v62 offset:4608
    ds_read_b64_tr_b16 v[188:189], v63 offset:4096
    ds_read_b64_tr_b16 v[190:191], v63 offset:4608
    s_waitcnt lgkmcnt(0)
    v_add_u32 v60, 0, v56
    v_add_u32 v61, 0, v57
    v_add_u32 v62, 0, v58
    v_add_u32 v63, 0, v59
    s_waitcnt vmcnt(8)
    s_barrier
    ds_read_b64_tr_b16 v[192:193], v60 offset:0
    ds_read_b64_tr_b16 v[194:195], v60 offset:512
    ds_read_b64_tr_b16 v[196:197], v61 offset:0
    ds_read_b64_tr_b16 v[198:199], v61 offset:512
    ds_read_b64_tr_b16 v[200:201], v62 offset:0
    ds_read_b64_tr_b16 v[202:203], v62 offset:512
    ds_read_b64_tr_b16 v[204:205], v63 offset:0
    ds_read_b64_tr_b16 v[206:207], v63 offset:512
    ds_read_b64_tr_b16 v[208:209], v60 offset:4096
    ds_read_b64_tr_b16 v[210:211], v60 offset:4608
    ds_read_b64_tr_b16 v[212:213], v61 offset:4096
    ds_read_b64_tr_b16 v[214:215], v61 offset:4608
    ds_read_b64_tr_b16 v[216:217], v62 offset:4096
    ds_read_b64_tr_b16 v[218:219], v62 offset:4608
    ds_read_b64_tr_b16 v[220:221], v63 offset:4096
    ds_read_b64_tr_b16 v[222:223], v63 offset:4608
    s_waitcnt lgkmcnt(0)
    v_add_u32 v60, 32768, v56
    v_add_u32 v61, 32768, v57
    v_add_u32 v62, 32768, v58
    v_add_u32 v63, 32768, v59
    s_waitcnt vmcnt(0)
    s_barrier
    ds_read_b64_tr_b16 v[224:225], v60 offset:0
    ds_read_b64_tr_b16 v[226:227], v60 offset:512
    ds_read_b64_tr_b16 v[228:229], v61 offset:0
    ds_read_b64_tr_b16 v[230:231], v61 offset:512
    ds_read_b64_tr_b16 v[232:233], v62 offset:0
    ds_read_b64_tr_b16 v[234:235], v62 offset:512
    ds_read_b64_tr_b16 v[236:237], v63 offset:0
    ds_read_b64_tr_b16 v[238:239], v63 offset:512
    ds_read_b64_tr_b16 v[240:241], v60 offset:4096
    ds_read_b64_tr_b16 v[242:243], v60 offset:4608
    ds_read_b64_tr_b16 v[244:245], v61 offset:4096
    ds_read_b64_tr_b16 v[246:247], v61 offset:4608
    ds_read_b64_tr_b16 v[248:249], v62 offset:4096
    ds_read_b64_tr_b16 v[250:251], v62 offset:4608
    ds_read_b64_tr_b16 v[252:253], v63 offset:4096
    ds_read_b64_tr_b16 v[254:255], v63 offset:4608
    s_waitcnt lgkmcnt(0)
    s_barrier
    s_cmp_lg_u32 s32, 0
    s_cbranch_scc1 L_arv77
    s_add_u32 s20, s82, 0x80
    s_addc_u32 s21, s83, 0
    s_mov_b32 s22, 0x4
    s_mov_b32 s23, 0x00020000
    buffer_load_dword v80, v124, s[20:23], 0 offen sc1
    s_waitcnt vmcnt(0)
    v_cmp_eq_u32 vcc, v124, v80
    s_cbranch_vccnz L_spin78
L_back79:
L_arv77:
    s_add_u32 s96, s41, 8126464
    s_mov_b32 s98, s41
    s_mov_b32 s45, 0x5530000
    buffer_load_dword v96, v6, s[16:19], s45 offen sc1
    s_waitcnt vmcnt(0)
    v_cmp_ne_u32 vcc, 0, v96
    s_cbranch_vccnz L_spin80
L_back81:
    s_barrier
    s_add_u32 m0, s43, 0
    s_add_u32 s42, s41, 0
    buffer_load_dwordx4 v1, s[16:19], s42 offen offset:0 sc1 lds
    buffer_load_dwordx4 v1, s[16:19], s42 offen offset:1024 sc1 lds
    buffer_load_dwordx4 v1, s[16:19], s42 offen offset:2048 sc1 lds
    buffer_load_dwordx4 v1, s[16:19], s42 offen offset:3072 sc1 lds
    s_add_u32 m0, s43, 16384
    s_add_u32 s42, s41, 16384
    buffer_load_dwordx4 v1, s[16:19], s42 offen offset:0 sc1 lds
    buffer_load_dwordx4 v1, s[16:19], s42 offen offset:1024 sc1 lds
    buffer_load_dwordx4 v1, s[16:19], s42 offen offset:2048 sc1 lds
    buffer_load_dwordx4 v1, s[16:19], s42 offen offset:3072 sc1 lds
    s_add_u32 m0, s43, 32768
    s_add_u32 s42, s41, 32768
    buffer_load_dwordx4 v1, s[16:19], s42 offen offset:0 sc1 lds
    buffer_load_dwordx4 v1, s[16:19], s42 offen offset:1024 sc1 lds
    buffer_load_dwordx4 v1, s[16:19], s42 offen offset:2048 sc1 lds
    buffer_load_dwordx4 v1, s[16:19], s42 offen offset:3072 sc1 lds
    s_add_u32 s45, s45, 65536
    s_waitcnt vmcnt(0) lgkmcnt(0)
    s_barrier
    s_mov_b32 s52, 0x5e00000
    s_mov_b32 s46, 0x5e00000
    s_add_u32 s20, s84, 0x5e00000
    s_addc_u32 s21, s85, 0
    s_mov_b32 s22, 0x400000
    s_mov_b32 s23, 0x00020000
    ds_read_b128 v[80:83], v2 offset:0
    ds_read_b128 v[84:87], v3 offset:0
    s_mov_b32 s36, 0
    s_waitcnt lgkmcnt(0)
    s_nop 7
L_bs_b0:
    v_mfma_f32_16x16x32_bf16 v[16:19], a[0:3], v[80:83], 0
    s_and_b32 s44, s90, 0xffffffff
    ds_read_b128 v[88:91], v2 offset:2048
    s_cmp_lt_i32 s36, 1
    v_mfma_f32_16x16x32_bf16 v[24:27], a[0:3], v[84:87], 0
    s_cselect_b32 s44, 0x5e00000, s44
    s_xor_b32 s49, s44, 0
    v_cvt_pk_bf16_f32 v48, v48, v49
    v_mfma_f32_16x16x32_bf16 v[28:31], a[4:7], v[84:87], 0
    ds_read_b128 v[92:95], v3 offset:2048
    v_cvt_pk_bf16_f32 v49, v50, v51
    v_mfma_f32_16x16x32_bf16 v[20:23], a[4:7], v[80:83], 0
    v_cvt_pk_bf16_f32 v50, v52, v53
    v_cvt_pk_bf16_f32 v51, v54, v55
    v_mfma_f32_16x16x32_bf16 v[32:35], a[8:11], v[80:83], 0
    buffer_store_dwordx4 v[48:51], v1, s[16:19], s49 offen offset:3072 sc1
    v_mfma_f32_16x16x32_bf16 v[40:43], a[8:11], v[84:87], 0
    s_xor_b32 s49, s44, 16384
    v_cvt_pk_bf16_f32 v56, v56, v57
    v_cvt_pk_bf16_f32 v57, v58, v59
    v_mfma_f32_16x16x32_bf16 v[44:47], a[12:15], v[84:87], 0
    v_cvt_pk_bf16_f32 v58, v60, v61
    v_cvt_pk_bf16_f32 v59, v62, v63
    v_mfma_f32_16x16x32_bf16 v[36:39], a[12:15], v[80:83], 0
    s_waitcnt lgkmcnt(0)
    v_mfma_f32_16x16x32_bf16 v[16:19], a[16:19], v[88:91], v[16:19]
    ds_read_b128 v[80:83], v2 offset:4096
    v_mfma_f32_16x16x32_bf16 v[24:27], a[16:19], v[92:95], v[24:27]
    buffer_store_dwordx4 v[56:59], v1, s[16:19], s49 offen offset:3072 sc1
    v_mfma_f32_16x16x32_bf16 v[28:31], a[20:23], v[92:95], v[28:31]
    s_xor_b32 s49, s44, 32768
    ds_read_b128 v[84:87], v3 offset:4096
    v_cvt_pk_bf16_f32 v64, v64, v65
    v_mfma_f32_16x16x32_bf16 v[20:23], a[20:23], v[88:91], v[20:23]
    v_cvt_pk_bf16_f32 v65, v66, v67
    v_cvt_pk_bf16_f32 v66, v68, v69
    v_mfma_f32_16x16x32_bf16 v[32:35], a[24:27], v[88:91], v[32:35]
    v_cvt_pk_bf16_f32 v67, v70, v71
    v_mfma_f32_16x16x32_bf16 v[40:43], a[24:27], v[92:95], v[40:43]
    buffer_store_dwordx4 v[64:67], v1, s[16:19], s49 offen offset:3072 sc1
    v_mfma_f32_16x16x32_bf16 v[44:47], a[28:31], v[92:95], v[44:47]
    s_xor_b32 s49, s44, 49152
    v_cvt_pk_bf16_f32 v72, v72, v73
    v_cvt_pk_bf16_f32 v73, v74, v75
    v_mfma_f32_16x16x32_bf16 v[36:39], a[28:31], v[88:91], v[36:39]
    s_waitcnt lgkmcnt(0)
    v_cvt_pk_bf16_f32 v74, v76, v77
    v_cvt_pk_bf16_f32 v75, v78, v79
    v_mfma_f32_16x16x32_bf16 v[16:19], a[32:35], v[80:83], v[16:19]
    ds_read_b128 v[88:91], v2 offset:6144
    v_mfma_f32_16x16x32_bf16 v[24:27], a[32:35], v[84:87], v[24:27]
    buffer_store_dwordx4 v[72:75], v1, s[16:19], s49 offen offset:3072 sc1
    v_mfma_f32_16x16x32_bf16 v[28:31], a[36:39], v[84:87], v[28:31]
    s_add_u32 s90, s90, 262144
    ds_read_b128 v[92:95], v3 offset:6144
    v_mfma_f32_16x16x32_bf16 v[20:23], a[36:39], v[80:83], v[20:23]
    v_mfma_f32_16x16x32_bf16 v[32:35], a[40:43], v[80:83], v[32:35]
    v_mfma_f32_16x16x32_bf16 v[40:43], a[40:43], v[84:87], v[40:43]
    v_mfma_f32_16x16x32_bf16 v[44:47], a[44:47], v[84:87], v[44:47]
    v_mfma_f32_16x16x32_bf16 v[36:39], a[44:47], v[80:83], v[36:39]
    s_waitcnt lgkmcnt(0)
    v_mfma_f32_16x16x32_bf16 v[16:19], a[48:51], v[88:91], v[16:19]
    s_add_u32 s98, s98, 262144
    ds_read_b128 v[80:83], v2 offset:8192
    s_min_i32 s98, s98, s96
    v_mfma_f32_16x16x32_bf16 v[24:27], a[48:51], v[92:95], v[24:27]
    s_and_b32 s41, s98, 0xffffffff
    s_add_u32 m0, s43, 98304
    s_add_u32 s42, s41, 0
    v_mfma_f32_16x16x32_bf16 v[28:31], a[52:55], v[92:95], v[28:31]
    ds_read_b128 v[84:87], v3 offset:8192
    v_mfma_f32_16x16x32_bf16 v[20:23], a[52:55], v[88:91], v[20:23]
    v_mfma_f32_16x16x32_bf16 v[32:35], a[56:59], v[88:91], v[32:35]
    v_mfma_f32_16x16x32_bf16 v[40:43], a[56:59], v[92:95], v[40:43]
    v_mfma_f32_16x16x32_bf16 v[44:47], a[60:63], v[92:95], v[44:47]
    v_mfma_f32_16x16x32_bf16 v[36:39], a[60:63], v[88:91], v[36:39]
    s_waitcnt lgkmcnt(0)
    v_mfma_f32_16x16x32_bf16 v[16:19], a[64:67], v[80:83], v[16:19]
    ds_read_b128 v[88:91], v2 offset:10240
    v_mfma_f32_16x16x32_bf16 v[24:27], a[64:67], v[84:87], v[24:27]
    v_mfma_f32_16x16x32_bf16 v[28:31], a[68:71], v[84:87], v[28:31]
    ds_read_b128 v[92:95], v3 offset:10240
    v_mfma_f32_16x16x32_bf16 v[20:23], a[68:71], v[80:83], v[20:23]
    v_mfma_f32_16x16x32_bf16 v[32:35], a[72:75], v[80:83], v[32:35]
    v_mfma_f32_16x16x32_bf16 v[40:43], a[72:75], v[84:87], v[40:43]
    v_mfma_f32_16x16x32_bf16 v[44:47], a[76:79], v[84:87], v[44:47]
    v_mfma_f32_16x16x32_bf16 v[36:39], a[76:79], v[80:83], v[36:39]
    s_waitcnt lgkmcnt(0)
    v_mfma_f32_16x16x32_bf16 v[16:19], a[80:83], v[88:91], v[16:19]
    ds_read_b128 v[80:83], v2 offset:12288
    v_mfma_f32_16x16x32_bf16 v[24:27], a[80:83], v[92:95], v[24:27]
    v_mfma_f32_16x16x32_bf16 v[28:31], a[84:87], v[92:95], v[28:31]
    ds_read_b128 v[84:87], v3 offset:12288
    v_mfma_f32_16x16x32_bf16 v[20:23], a[84:87], v[88:91], v[20:23]
    v_mfma_f32_16x16x32_bf16 v[32:35], a[88:91], v[88:91], v[32:35]
    v_mfma_f32_16x16x32_bf16 v[40:43], a[88:91], v[92:95], v[40:43]
    v_mfma_f32_16x16x32_bf16 v[44:47], a[92:95], v[92:95], v[44:47]
    v_mfma_f32_16x16x32_bf16 v[36:39], a[92:95], v[88:91], v[36:39]
    s_waitcnt lgkmcnt(0)
    v_mfma_f32_16x16x32_bf16 v[16:19], a[96:99], v[80:83], v[16:19]
    ds_read_b128 v[88:91], v2 offset:14336
    v_mfma_f32_16x16x32_bf16 v[24:27], a[96:99], v[84:87], v[24:27]
    v_mfma_f32_16x16x32_bf16 v[28:31], a[100:103], v[84:87], v[28:31]
    ds_read_b128 v[92:95], v3 offset:14336
    v_mfma_f32_16x16x32_bf16 v[20:23], a[100:103], v[80:83], v[20:23]
    v_mfma_f32_16x16x32_bf16 v[32:35], a[104:107], v[80:83], v[32:35]
    v_mfma_f32_16x16x32_bf16 v[40:43], a[104:107], v[84:87], v[40:43]
    v_mfma_f32_16x16x32_bf16 v[44:47], a[108:111], v[84:87], v[44:47]
    v_mfma_f32_16x16x32_bf16 v[36:39], a[108:111], v[80:83], v[36:39]
    s_waitcnt lgkmcnt(0)
    v_mfma_f32_16x16x32_bf16 v[16:19], a[112:115], v[88:91], v[16:19]
    ds_read_b128 v[80:83], v2 offset:16384
    v_mfma_f32_16x16x32_bf16 v[24:27], a[112:115], v[92:95], v[24:27]
    v_mfma_f32_16x16x32_bf16 v[28:31], a[116:119], v[92:95], v[28:31]
    ds_read_b128 v[84:87], v3 offset:16384
    v_mfma_f32_16x16x32_bf16 v[20:23], a[116:119], v[88:91], v[20:23]
    v_mfma_f32_16x16x32_bf16 v[32:35], a[120:123], v[88:91], v[32:35]
    v_mfma_f32_16x16x32_bf16 v[40:43], a[120:123], v[92:95], v[40:43]
    v_mfma_f32_16x16x32_bf16 v[44:47], a[124:127], v[92:95], v[44:47]
    buffer_load_dword v96, v6, s[16:19], s45 offen sc1
    v_mfma_f32_16x16x32_bf16 v[36:39], a[124:127], v[88:91], v[36:39]
    s_waitcnt lgkmcnt(0)
    v_mfma_f32_16x16x32_bf16 v[16:19], a[128:131], v[80:83], v[16:19]
    ds_read_b128 v[88:91], v2 offset:18432
    v_mfma_f32_16x16x32_bf16 v[24:27], a[128:131], v[84:87], v[24:27]
    v_mfma_f32_16x16x32_bf16 v[28:31], a[132:135], v[84:87], v[28:31]
    ds_read_b128 v[92:95], v3 offset:18432
    v_mfma_f32_16x16x32_bf16 v[20:23], a[132:135], v[80:83], v[20:23]
    v_mfma_f32_16x16x32_bf16 v[32:35], a[136:139], v[80:83], v[32:35]
    v_mfma_f32_16x16x32_bf16 v[40:43], a[136:139], v[84:87], v[40:43]
    v_mfma_f32_16x16x32_bf16 v[44:47], a[140:143], v[84:87], v[44:47]
    v_mfma_f32_16x16x32_bf16 v[36:39], a[140:143], v[80:83], v[36:39]
    s_waitcnt lgkmcnt(0)
    v_mfma_f32_16x16x32_bf16 v[16:19], a[144:147], v[88:91], v[16:19]
    ds_read_b128 v[80:83], v2 offset:20480
    v_mfma_f32_16x16x32_bf16 v[24:27], a[144:147], v[92:95], v[24:27]
    v_mfma_f32_16x16x32_bf16 v[28:31], a[148:151], v[92:95], v[28:31]
    ds_read_b128 v[84:87], v3 offset:20480
    v_mfma_f32_16x16x32_bf16 v[20:23], a[148:151], v[88:91], v[20:23]
    v_mfma_f32_16x16x32_bf16 v[32:35], a[152:155], v[88:91], v[32:35]
    v_mfma_f32_16x16x32_bf16 v[40:43], a[152:155], v[92:95], v[40:43]
    v_mfma_f32_16x16x32_bf16 v[44:47], a[156:159], v[92:95], v[44:47]
    v_mfma_f32_16x16x32_bf16 v[36:39], a[156:159], v[88:91], v[36:39]
    s_waitcnt lgkmcnt(0)
    v_mfma_f32_16x16x32_bf16 v[16:19], a[160:163], v[80:83], v[16:19]
    ds_read_b128 v[88:91], v2 offset:22528
    v_mfma_f32_16x16x32_bf16 v[24:27], a[160:163], v[84:87], v[24:27]
    v_mfma_f32_16x16x32_bf16 v[28:31], a[164:167], v[84:87], v[28:31]
    ds_read_b128 v[92:95], v3 offset:22528
    v_mfma_f32_16x16x32_bf16 v[20:23], a[164:167], v[80:83], v[20:23]
    v_mfma_f32_16x16x32_bf16 v[32:35], a[168:171], v[80:83], v[32:35]
    v_mfma_f32_16x16x32_bf16 v[40:43], a[168:171], v[84:87], v[40:43]
    v_mfma_f32_16x16x32_bf16 v[44:47], a[172:175], v[84:87], v[44:47]
    v_mfma_f32_16x16x32_bf16 v[36:39], a[172:175], v[80:83], v[36:39]
    s_waitcnt lgkmcnt(0)
    v_mfma_f32_16x16x32_bf16 v[16:19], a[176:179], v[88:91], v[16:19]
    ds_read_b128 v[80:83], v2 offset:24576
    v_mfma_f32_16x16x32_bf16 v[24:27], a[176:179], v[92:95], v[24:27]
    v_mfma_f32_16x16x32_bf16 v[28:31], a[180:183], v[92:95], v[28:31]
    ds_read_b128 v[84:87], v3 offset:24576
    v_mfma_f32_16x16x32_bf16 v[20:23], a[180:183], v[88:91], v[20:23]
    v_mfma_f32_16x16x32_bf16 v[32:35], a[184:187], v[88:91], v[32:35]
    v_mfma_f32_16x16x32_bf16 v[40:43], a[184:187], v[92:95], v[40:43]
    v_mfma_f32_16x16x32_bf16 v[44:47], a[188:191], v[92:95], v[44:47]
    v_mfma_f32_16x16x32_bf16 v[36:39], a[188:191], v[88:91], v[36:39]
    s_waitcnt lgkmcnt(0)
    v_mfma_f32_16x16x32_bf16 v[16:19], a[192:195], v[80:83], v[16:19]
    ds_read_b128 v[88:91], v2 offset:26624
    v_mfma_f32_16x16x32_bf16 v[24:27], a[192:195], v[84:87], v[24:27]
    v_mfma_f32_16x16x32_bf16 v[28:31], a[196:199], v[84:87], v[28:31]
    ds_read_b128 v[92:95], v3 offset:26624
    v_mfma_f32_16x16x32_bf16 v[20:23], a[196:199], v[80:83], v[20:23]
    v_mfma_f32_16x16x32_bf16 v[32:35], a[200:203], v[80:83], v[32:35]
    v_mfma_f32_16x16x32_bf16 v[40:43], a[200:203], v[84:87], v[40:43]
    v_mfma_f32_16x16x32_bf16 v[44:47], a[204:207], v[84:87], v[44:47]
    v_mfma_f32_16x16x32_bf16 v[36:39], a[204:207], v[80:83], v[36:39]
    s_waitcnt lgkmcnt(0)
    v_mfma_f32_16x16x32_bf16 v[16:19], a[208:211], v[88:91], v[16:19]
    ds_read_b128 v[80:83], v2 offset:28672
    v_mfma_f32_16x16x32_bf16 v[24:27], a[208:211], v[92:95], v[24:27]
    v_mfma_f32_16x16x32_bf16 v[28:31], a[212:215], v[92:95], v[28:31]
    s_waitcnt vmcnt(0)
    ds_read_b128 v[84:87], v3 offset:28672
    v_cmp_ne_u32 vcc, 0, v96
    v_mfma_f32_16x16x32_bf16 v[20:23], a[212:215], v[88:91], v[20:23]
    v_mfma_f32_16x16x32_bf16 v[32:35], a[216:219], v[88:91], v[32:35]
    s_cbranch_vccnz L_spin82
L_back83:
    s_barrier
    v_mfma_f32_16x16x32_bf16 v[40:43], a[216:219], v[92:95], v[40:43]
    buffer_load_dwordx4 v1, s[16:19], s42 offen offset:0 sc1 lds
    v_mfma_f32_16x16x32_bf16 v[44:47], a[220:223], v[92:95], v[44:47]
    v_mfma_f32_16x16x32_bf16 v[36:39], a[220:223], v[88:91], v[36:39]
    s_waitcnt lgkmcnt(0)
    v_mfma_f32_16x16x32_bf16 v[16:19], a[224:227], v[80:83], v[16:19]
    ds_read_b128 v[88:91], v2 offset:30720
    v_mfma_f32_16x16x32_bf16 v[24:27], a[224:227], v[84:87], v[24:27]
    buffer_load_dwordx4 v1, s[16:19], s42 offen offset:1024 sc1 lds
    v_mfma_f32_16x16x32_bf16 v[28:31], a[228:231], v[84:87], v[28:31]
    ds_read_b128 v[92:95], v3 offset:30720
    v_mfma_f32_16x16x32_bf16 v[20:23], a[228:231], v[80:83], v[20:23]
    v_mfma_f32_16x16x32_bf16 v[32:35], a[232:235], v[80:83], v[32:35]
    v_mfma_f32_16x16x32_bf16 v[40:43], a[232:235], v[84:87], v[40:43]
    buffer_load_dwordx4 v1, s[16:19], s42 offen offset:2048 sc1 lds
    v_mfma_f32_16x16x32_bf16 v[44:47], a[236:239], v[84:87], v[44:47]
    v_mfma_f32_16x16x32_bf16 v[36:39], a[236:239], v[80:83], v[36:39]
    s_waitcnt lgkmcnt(0)
    v_mfma_f32_16x16x32_bf16 v[16:19], a[240:243], v[88:91], v[16:19]
    ds_read_b128 v[80:83], v2 offset:32768
    v_mfma_f32_16x16x32_bf16 v[24:27], a[240:243], v[92:95], v[24:27]
    buffer_load_dwordx4 v1, s[16:19], s42 offen offset:3072 sc1 lds
    v_mfma_f32_16x16x32_bf16 v[28:31], a[244:247], v[92:95], v[28:31]
    s_add_u32 m0, s43, 114688
    ds_read_b128 v[84:87], v3 offset:32768
    s_add_u32 s42, s41, 16384
    v_mfma_f32_16x16x32_bf16 v[20:23], a[244:247], v[88:91], v[20:23]
    v_mfma_f32_16x16x32_bf16 v[32:35], a[248:251], v[88:91], v[32:35]
    v_mfma_f32_16x16x32_bf16 v[40:43], a[248:251], v[92:95], v[40:43]
    buffer_load_dwordx4 v1, s[16:19], s42 offen offset:0 sc1 lds
    v_mfma_f32_16x16x32_bf16 v[44:47], a[252:255], v[92:95], v[44:47]
    v_mfma_f32_16x16x32_bf16 v[36:39], a[252:255], v[88:91], v[36:39]
    s_waitcnt lgkmcnt(0)
    v_mfma_f32_16x16x32_bf16 v[16:19], v[128:131], v[80:83], v[16:19]
    ds_read_b128 v[88:91], v2 offset:34816
    v_mfma_f32_16x16x32_bf16 v[24:27], v[128:131], v[84:87], v[24:27]
    buffer_load_dwordx4 v1, s[16:19], s42 offen offset:1024 sc1 lds
    v_mfma_f32_16x16x32_bf16 v[28:31], v[132:135], v[84:87], v[28:31]
    ds_read_b128 v[92:95], v3 offset:34816
    v_mfma_f32_16x16x32_bf16 v[20:23], v[132:135], v[80:83], v[20:23]
    v_mfma_f32_16x16x32_bf16 v[32:35], v[136:139], v[80:83], v[32:35]
    v_mfma_f32_16x16x32_bf16 v[40:43], v[136:139], v[84:87], v[40:43]
    buffer_load_dwordx4 v1, s[16:19], s42 offen offset:2048 sc1 lds
    v_mfma_f32_16x16x32_bf16 v[44:47], v[140:143], v[84:87], v[44:47]
    v_mfma_f32_16x16x32_bf16 v[36:39], v[140:143], v[80:83], v[36:39]
    s_waitcnt lgkmcnt(0)
    v_mfma_f32_16x16x32_bf16 v[16:19], v[144:147], v[88:91], v[16:19]
    ds_read_b128 v[80:83], v2 offset:36864
    v_mfma_f32_16x16x32_bf16 v[24:27], v[144:147], v[92:95], v[24:27]
    buffer_load_dwordx4 v1, s[16:19], s42 offen offset:3072 sc1 lds
    v_mfma_f32_16x16x32_bf16 v[28:31], v[148:151], v[92:95], v[28:31]
    ds_read_b128 v[84:87], v3 offset:36864
    v_mfma_f32_16x16x32_bf16 v[20:23], v[148:151], v[88:91], v[20:23]
    v_mfma_f32_16x16x32_bf16 v[32:35], v[152:155], v[88:91], v[32:35]
    buffer_store_dword v124, v124, s[16:19], s91 offen sc1
    v_mfma_f32_16x16x32_bf16 v[40:43], v[152:155], v[92:95], v[40:43]
    s_add_u32 s91, s91, 65536
    v_mfma_f32_16x16x32_bf16 v[44:47], v[156:159], v[92:95], v[44:47]
    v_mfma_f32_16x16x32_bf16 v[36:39], v[156:159], v[88:91], v[36:39]
    s_waitcnt lgkmcnt(0)
    v_mfma_f32_16x16x32_bf16 v[16:19], v[160:163], v[80:83], v[16:19]
    ds_read_b128 v[88:91], v2 offset:38912
    v_mfma_f32_16x16x32_bf16 v[24:27], v[160:163], v[84:87], v[24:27]
    v_mfma_f32_16x16x32_bf16 v[28:31], v[164:167], v[84:87], v[28:31]
    ds_read_b128 v[92:95], v3 offset:38912
    v_mfma_f32_16x16x32_bf16 v[20:23], v[164:167], v[80:83], v[20:23]
    v_mfma_f32_16x16x32_bf16 v[32:35], v[168:171], v[80:83], v[32:35]
    v_mfma_f32_16x16x32_bf16 v[40:43], v[168:171], v[84:87], v[40:43]
    v_mfma_f32_16x16x32_bf16 v[44:47], v[172:175], v[84:87], v[44:47]
    v_mfma_f32_16x16x32_bf16 v[36:39], v[172:175], v[80:83], v[36:39]
    s_waitcnt lgkmcnt(0)
    v_mfma_f32_16x16x32_bf16 v[16:19], v[176:179], v[88:91], v[16:19]
    ds_read_b128 v[80:83], v2 offset:40960
    v_mfma_f32_16x16x32_bf16 v[24:27], v[176:179], v[92:95], v[24:27]
    v_mfma_f32_16x16x32_bf16 v[28:31], v[180:183], v[92:95], v[28:31]
    ds_read_b128 v[84:87], v3 offset:40960
    v_mfma_f32_16x16x32_bf16 v[20:23], v[180:183], v[88:91], v[20:23]
    v_mfma_f32_16x16x32_bf16 v[32:35], v[184:187], v[88:91], v[32:35]
    v_mfma_f32_16x16x32_bf16 v[40:43], v[184:187], v[92:95], v[40:43]
    v_mfma_f32_16x16x32_bf16 v[44:47], v[188:191], v[92:95], v[44:47]
    v_mfma_f32_16x16x32_bf16 v[36:39], v[188:191], v[88:91], v[36:39]
    s_waitcnt lgkmcnt(0)
    v_mfma_f32_16x16x32_bf16 v[16:19], v[192:195], v[80:83], v[16:19]
    ds_read_b128 v[88:91], v2 offset:43008
    v_mfma_f32_16x16x32_bf16 v[24:27], v[192:195], v[84:87], v[24:27]
    v_mfma_f32_16x16x32_bf16 v[28:31], v[196:199], v[84:87], v[28:31]
    s_add_u32 m0, s43, 131072
    ds_read_b128 v[92:95], v3 offset:43008
    s_add_u32 s42, s41, 32768
    v_mfma_f32_16x16x32_bf16 v[20:23], v[196:199], v[80:83], v[20:23]
    buffer_load_dwordx4 v1, s[16:19], s42 offen offset:0 sc1 lds
    v_mfma_f32_16x16x32_bf16 v[32:35], v[200:203], v[80:83], v[32:35]
    v_mfma_f32_16x16x32_bf16 v[40:43], v[200:203], v[84:87], v[40:43]
    v_mfma_f32_16x16x32_bf16 v[44:47], v[204:207], v[84:87], v[44:47]
    v_mfma_f32_16x16x32_bf16 v[36:39], v[204:207], v[80:83], v[36:39]
    s_waitcnt lgkmcnt(0)
    v_mfma_f32_16x16x32_bf16 v[16:19], v[208:211], v[88:91], v[16:19]
    ds_read_b128 v[80:83], v2 offset:45056
    v_mfma_f32_16x16x32_bf16 v[24:27], v[208:211], v[92:95], v[24:27]
    buffer_load_dwordx4 v1, s[16:19], s42 offen offset:1024 sc1 lds
    v_mfma_f32_16x16x32_bf16 v[28:31], v[212:215], v[92:95], v[28:31]
    ds_read_b128 v[84:87], v3 offset:45056
    v_mfma_f32_16x16x32_bf16 v[20:23], v[212:215], v[88:91], v[20:23]
    v_mfma_f32_16x16x32_bf16 v[32:35], v[216:219], v[88:91], v[32:35]
    v_mfma_f32_16x16x32_bf16 v[40:43], v[216:219], v[92:95], v[40:43]
    v_mfma_f32_16x16x32_bf16 v[44:47], v[220:223], v[92:95], v[44:47]
    buffer_load_dwordx4 v1, s[16:19], s42 offen offset:2048 sc1 lds
    v_mfma_f32_16x16x32_bf16 v[36:39], v[220:223], v[88:91], v[36:39]
    s_waitcnt lgkmcnt(0)
    v_mfma_f32_16x16x32_bf16 v[16:19], v[224:227], v[80:83], v[16:19]
    ds_read_b128 v[88:91], v2 offset:47104
    v_mfma_f32_16x16x32_bf16 v[24:27], v[224:227], v[84:87], v[24:27]
    v_mfma_f32_16x16x32_bf16 v[28:31], v[228:231], v[84:87], v[28:31]
    ds_read_b128 v[92:95], v3 offset:47104
    v_mfma_f32_16x16x32_bf16 v[20:23], v[228:231], v[80:83], v[20:23]
    buffer_load_dwordx4 v1, s[16:19], s42 offen offset:3072 sc1 lds
    v_mfma_f32_16x16x32_bf16 v[32:35], v[232:235], v[80:83], v[32:35]
    s_add_u32 s45, s45, 65536
    v_mfma_f32_16x16x32_bf16 v[40:43], v[232:235], v[84:87], v[40:43]
    v_mfma_f32_16x16x32_bf16 v[44:47], v[236:239], v[84:87], v[44:47]
    v_mfma_f32_16x16x32_bf16 v[36:39], v[236:239], v[80:83], v[36:39]
    s_waitcnt vmcnt(5) lgkmcnt(0)
    s_barrier
    v_mfma_f32_16x16x32_bf16 v[16:19], v[240:243], v[88:91], v[16:19]
    ds_read_b128 v[80:83], v4 offset:0
    v_mfma_f32_16x16x32_bf16 v[24:27], v[240:243], v[92:95], v[24:27]
    v_mfma_f32_16x16x32_bf16 v[28:31], v[244:247], v[92:95], v[28:31]
    ds_read_b128 v[84:87], v5 offset:0
    v_mfma_f32_16x16x32_bf16 v[20:23], v[244:247], v[88:91], v[20:23]
    v_mfma_f32_16x16x32_bf16 v[32:35], v[248:251], v[88:91], v[32:35]
    v_mfma_f32_16x16x32_bf16 v[40:43], v[248:251], v[92:95], v[40:43]
    v_mfma_f32_16x16x32_bf16 v[44:47], v[252:255], v[92:95], v[44:47]
    s_add_u32 s36, s36, 1
    v_mfma_f32_16x16x32_bf16 v[36:39], v[252:255], v[88:91], v[36:39]
    s_waitcnt lgkmcnt(0)
L_bs_b1:
    v_mfma_f32_16x16x32_bf16 v[48:51], a[0:3], v[80:83], 0
    s_and_b32 s44, s90, 0xffffffff
    ds_read_b128 v[88:91], v4 offset:2048
    s_cmp_lt_i32 s36, 1
    v_mfma_f32_16x16x32_bf16 v[56:59], a[0:3], v[84:87], 0
    s_cselect_b32 s44, 0x5e00000, s44
    s_xor_b32 s49, s44, 0
    v_cvt_pk_bf16_f32 v16, v16, v17
    v_mfma_f32_16x16x32_bf16 v[60:63], a[4:7], v[84:87], 0
    ds_read_b128 v[92:95], v5 offset:2048
    v_cvt_pk_bf16_f32 v17, v18, v19
    v_mfma_f32_16x16x32_bf16 v[52:55], a[4:7], v[80:83], 0
    v_cvt_pk_bf16_f32 v18, v20, v21
    v_cvt_pk_bf16_f32 v19, v22, v23
    v_mfma_f32_16x16x32_bf16 v[64:67], a[8:11], v[80:83], 0
    buffer_store_dwordx4 v[16:19], v1, s[16:19], s49 offen offset:3072 sc1
    v_mfma_f32_16x16x32_bf16 v[72:75], a[8:11], v[84:87], 0
    s_xor_b32 s49, s44, 16384
    v_cvt_pk_bf16_f32 v24, v24, v25
    v_cvt_pk_bf16_f32 v25, v26, v27
    v_mfma_f32_16x16x32_bf16 v[76:79], a[12:15], v[84:87], 0
    v_cvt_pk_bf16_f32 v26, v28, v29
    v_cvt_pk_bf16_f32 v27, v30, v31
    v_mfma_f32_16x16x32_bf16 v[68:71], a[12:15], v[80:83], 0
    s_waitcnt lgkmcnt(0)
    v_mfma_f32_16x16x32_bf16 v[48:51], a[16:19], v[88:91], v[48:51]
    ds_read_b128 v[80:83], v4 offset:4096
    v_mfma_f32_16x16x32_bf16 v[56:59], a[16:19], v[92:95], v[56:59]
    buffer_store_dwordx4 v[24:27], v1, s[16:19], s49 offen offset:3072 sc1
    v_mfma_f32_16x16x32_bf16 v[60:63], a[20:23], v[92:95], v[60:63]
    s_xor_b32 s49, s44, 32768
    ds_read_b128 v[84:87], v5 offset:4096
    v_cvt_pk_bf16_f32 v32, v32, v33
    v_mfma_f32_16x16x32_bf16 v[52:55], a[20:23], v[88:91], v[52:55]
    v_cvt_pk_bf16_f32 v33, v34, v35
    v_cvt_pk_bf16_f32 v34, v36, v37
    v_mfma_f32_16x16x32_bf16 v[64:67], a[24:27], v[88:91], v[64:67]
    v_cvt_pk_bf16_f32 v35, v38, v39
    v_mfma_f32_16x16x32_bf16 v[72:75], a[24:27], v[92:95], v[72:75]
    buffer_store_dwordx4 v[32:35], v1, s[16:19], s49 offen offset:3072 sc1
    v_mfma_f32_16x16x32_bf16 v[76:79], a[28:31], v[92:95], v[76:79]
    s_xor_b32 s49, s44, 49152
    v_cvt_pk_bf16_f32 v40, v40, v41
    v_cvt_pk_bf16_f32 v41, v42, v43
    v_mfma_f32_16x16x32_bf16 v[68:71], a[28:31], v[88:91], v[68:71]
    s_waitcnt lgkmcnt(0)
    v_cvt_pk_bf16_f32 v42, v44, v45
    v_cvt_pk_bf16_f32 v43, v46, v47
    v_mfma_f32_16x16x32_bf16 v[48:51], a[32:35], v[80:83], v[48:51]
    ds_read_b128 v[88:91], v4 offset:6144
    v_mfma_f32_16x16x32_bf16 v[56:59], a[32:35], v[84:87], v[56:59]
    buffer_store_dwordx4 v[40:43], v1, s[16:19], s49 offen offset:3072 sc1
    v_mfma_f32_16x16x32_bf16 v[60:63], a[36:39], v[84:87], v[60:63]
    s_add_u32 s90, s90, 262144
    ds_read_b128 v[92:95], v5 offset:6144
    v_mfma_f32_16x16x32_bf16 v[52:55], a[36:39], v[80:83], v[52:55]
    v_mfma_f32_16x16x32_bf16 v[64:67], a[40:43], v[80:83], v[64:67]
    v_mfma_f32_16x16x32_bf16 v[72:75], a[40:43], v[84:87], v[72:75]
    v_mfma_f32_16x16x32_bf16 v[76:79], a[44:47], v[84:87], v[76:79]
    v_mfma_f32_16x16x32_bf16 v[68:71], a[44:47], v[80:83], v[68:71]
    s_waitcnt lgkmcnt(0)
    v_mfma_f32_16x16x32_bf16 v[48:51], a[48:51], v[88:91], v[48:51]
    s_add_u32 s98, s98, 262144
    ds_read_b128 v[80:83], v4 offset:8192
    s_min_i32 s98, s98, s96
    v_mfma_f32_16x16x32_bf16 v[56:59], a[48:51], v[92:95], v[56:59]
    s_and_b32 s41, s98, 0xffffffff
    s_add_u32 m0, s43, 0
    s_add_u32 s42, s41, 0
    v_mfma_f32_16x16x32_bf16 v[60:63], a[52:55], v[92:95], v[60:63]
    ds_read_b128 v[84:87], v5 offset:8192
    v_mfma_f32_16x16x32_bf16 v[52:55], a[52:55], v[88:91], v[52:55]
    v_mfma_f32_16x16x32_bf16 v[64:67], a[56:59], v[88:91], v[64:67]
    v_mfma_f32_16x16x32_bf16 v[72:75], a[56:59], v[92:95], v[72:75]
    v_mfma_f32_16x16x32_bf16 v[76:79], a[60:63], v[92:95], v[76:79]
    v_mfma_f32_16x16x32_bf16 v[68:71], a[60:63], v[88:91], v[68:71]
    s_waitcnt lgkmcnt(0)
    v_mfma_f32_16x16x32_bf16 v[48:51], a[64:67], v[80:83], v[48:51]
    ds_read_b128 v[88:91], v4 offset:10240
    v_mfma_f32_16x16x32_bf16 v[56:59], a[64:67], v[84:87], v[56:59]
    v_mfma_f32_16x16x32_bf16 v[60:63], a[68:71], v[84:87], v[60:63]
    ds_read_b128 v[92:95], v5 offset:10240
    v_mfma_f32_16x16x32_bf16 v[52:55], a[68:71], v[80:83], v[52:55]
    v_mfma_f32_16x16x32_bf16 v[64:67], a[72:75], v[80:83], v[64:67]
    v_mfma_f32_16x16x32_bf16 v[72:75], a[72:75], v[84:87], v[72:75]
    v_mfma_f32_16x16x32_bf16 v[76:79], a[76:79], v[84:87], v[76:79]
    v_mfma_f32_16x16x32_bf16 v[68:71], a[76:79], v[80:83], v[68:71]
    s_waitcnt lgkmcnt(0)
    v_mfma_f32_16x16x32_bf16 v[48:51], a[80:83], v[88:91], v[48:51]
    ds_read_b128 v[80:83], v4 offset:12288
    v_mfma_f32_16x16x32_bf16 v[56:59], a[80:83], v[92:95], v[56:59]
    v_mfma_f32_16x16x32_bf16 v[60:63], a[84:87], v[92:95], v[60:63]
    ds_read_b128 v[84:87], v5 offset:12288
    v_mfma_f32_16x16x32_bf16 v[52:55], a[84:87], v[88:91], v[52:55]
    v_mfma_f32_16x16x32_bf16 v[64:67], a[88:91], v[88:91], v[64:67]
    v_mfma_f32_16x16x32_bf16 v[72:75], a[88:91], v[92:95], v[72:75]
    v_mfma_f32_16x16x32_bf16 v[76:79], a[92:95], v[92:95], v[76:79]
    v_mfma_f32_16x16x32_bf16 v[68:71], a[92:95], v[88:91], v[68:71]
    s_waitcnt lgkmcnt(0)
    v_mfma_f32_16x16x32_bf16 v[48:51], a[96:99], v[80:83], v[48:51]
    ds_read_b128 v[88:91], v4 offset:14336
    v_mfma_f32_16x16x32_bf16 v[56:59], a[96:99], v[84:87], v[56:59]
    v_mfma_f32_16x16x32_bf16 v[60:63], a[100:103], v[84:87], v[60:63]
    ds_read_b128 v[92:95], v5 offset:14336
    v_mfma_f32_16x16x32_bf16 v[52:55], a[100:103], v[80:83], v[52:55]
    v_mfma_f32_16x16x32_bf16 v[64:67], a[104:107], v[80:83], v[64:67]
    v_mfma_f32_16x16x32_bf16 v[72:75], a[104:107], v[84:87], v[72:75]
    v_mfma_f32_16x16x32_bf16 v[76:79], a[108:111], v[84:87], v[76:79]
    v_mfma_f32_16x16x32_bf16 v[68:71], a[108:111], v[80:83], v[68:71]
    s_waitcnt lgkmcnt(0)
    v_mfma_f32_16x16x32_bf16 v[48:51], a[112:115], v[88:91], v[48:51]
    ds_read_b128 v[80:83], v4 offset:16384
    v_mfma_f32_16x16x32_bf16 v[56:59], a[112:115], v[92:95], v[56:59]
    v_mfma_f32_16x16x32_bf16 v[60:63], a[116:119], v[92:95], v[60:63]
    ds_read_b128 v[84:87], v5 offset:16384
    v_mfma_f32_16x16x32_bf16 v[52:55], a[116:119], v[88:91], v[52:55]
    v_mfma_f32_16x16x32_bf16 v[64:67], a[120:123], v[88:91], v[64:67]
    v_mfma_f32_16x16x32_bf16 v[72:75], a[120:123], v[92:95], v[72:75]
    v_mfma_f32_16x16x32_bf16 v[76:79], a[124:127], v[92:95], v[76:79]
    buffer_load_dword v96, v6, s[16:19], s45 offen sc1
    v_mfma_f32_16x16x32_bf16 v[68:71], a[124:127], v[88:91], v[68:71]
    s_waitcnt lgkmcnt(0)
    v_mfma_f32_16x16x32_bf16 v[48:51], a[128:131], v[80:83], v[48:51]
    ds_read_b128 v[88:91], v4 offset:18432
    v_mfma_f32_16x16x32_bf16 v[56:59], a[128:131], v[84:87], v[56:59]
    v_mfma_f32_16x16x32_bf16 v[60:63], a[132:135], v[84:87], v[60:63]
    ds_read_b128 v[92:95], v5 offset:18432
    v_mfma_f32_16x16x32_bf16 v[52:55], a[132:135], v[80:83], v[52:55]
    v_mfma_f32_16x16x32_bf16 v[64:67], a[136:139], v[80:83], v[64:67]
    v_mfma_f32_16x16x32_bf16 v[72:75], a[136:139], v[84:87], v[72:75]
    v_mfma_f32_16x16x32_bf16 v[76:79], a[140:143], v[84:87], v[76:79]
    v_mfma_f32_16x16x32_bf16 v[68:71], a[140:143], v[80:83], v[68:71]
    s_waitcnt lgkmcnt(0)
    v_mfma_f32_16x16x32_bf16 v[48:51], a[144:147], v[88:91], v[48:51]
    ds_read_b128 v[80:83], v4 offset:20480
    v_mfma_f32_16x16x32_bf16 v[56:59], a[144:147], v[92:95], v[56:59]
    v_mfma_f32_16x16x32_bf16 v[60:63], a[148:151], v[92:95], v[60:63]
    ds_read_b128 v[84:87], v5 offset:20480
    v_mfma_f32_16x16x32_bf16 v[52:55], a[148:151], v[88:91], v[52:55]
    v_mfma_f32_16x16x32_bf16 v[64:67], a[152:155], v[88:91], v[64:67]
    v_mfma_f32_16x16x32_bf16 v[72:75], a[152:155], v[92:95], v[72:75]
    v_mfma_f32_16x16x32_bf16 v[76:79], a[156:159], v[92:95], v[76:79]
    v_mfma_f32_16x16x32_bf16 v[68:71], a[156:159], v[88:91], v[68:71]
    s_waitcnt lgkmcnt(0)
    v_mfma_f32_16x16x32_bf16 v[48:51], a[160:163], v[80:83], v[48:51]
    ds_read_b128 v[88:91], v4 offset:22528
    v_mfma_f32_16x16x32_bf16 v[56:59], a[160:163], v[84:87], v[56:59]
    v_mfma_f32_16x16x32_bf16 v[60:63], a[164:167], v[84:87], v[60:63]
    ds_read_b128 v[92:95], v5 offset:22528
    v_mfma_f32_16x16x32_bf16 v[52:55], a[164:167], v[80:83], v[52:55]
    v_mfma_f32_16x16x32_bf16 v[64:67], a[168:171], v[80:83], v[64:67]
    v_mfma_f32_16x16x32_bf16 v[72:75], a[168:171], v[84:87], v[72:75]
    v_mfma_f32_16x16x32_bf16 v[76:79], a[172:175], v[84:87], v[76:79]
    v_mfma_f32_16x16x32_bf16 v[68:71], a[172:175], v[80:83], v[68:71]
    s_waitcnt lgkmcnt(0)
    v_mfma_f32_16x16x32_bf16 v[48:51], a[176:179], v[88:91], v[48:51]
    ds_read_b128 v[80:83], v4 offset:24576
    v_mfma_f32_16x16x32_bf16 v[56:59], a[176:179], v[92:95], v[56:59]
    v_mfma_f32_16x16x32_bf16 v[60:63], a[180:183], v[92:95], v[60:63]
    ds_read_b128 v[84:87], v5 offset:24576
    v_mfma_f32_16x16x32_bf16 v[52:55], a[180:183], v[88:91], v[52:55]
    v_mfma_f32_16x16x32_bf16 v[64:67], a[184:187], v[88:91], v[64:67]
    v_mfma_f32_16x16x32_bf16 v[72:75], a[184:187], v[92:95], v[72:75]
    v_mfma_f32_16x16x32_bf16 v[76:79], a[188:191], v[92:95], v[76:79]
    v_mfma_f32_16x16x32_bf16 v[68:71], a[188:191], v[88:91], v[68:71]
    s_waitcnt lgkmcnt(0)
    v_mfma_f32_16x16x32_bf16 v[48:51], a[192:195], v[80:83], v[48:51]
    ds_read_b128 v[88:91], v4 offset:26624
    v_mfma_f32_16x16x32_bf16 v[56:59], a[192:195], v[84:87], v[56:59]
    v_mfma_f32_16x16x32_bf16 v[60:63], a[196:199], v[84:87], v[60:63]
    ds_read_b128 v[92:95], v5 offset:26624
    v_mfma_f32_16x16x32_bf16 v[52:55], a[196:199], v[80:83], v[52:55]
    v_mfma_f32_16x16x32_bf16 v[64:67], a[200:203], v[80:83], v[64:67]
    v_mfma_f32_16x16x32_bf16 v[72:75], a[200:203], v[84:87], v[72:75]
    v_mfma_f32_16x16x32_bf16 v[76:79], a[204:207], v[84:87], v[76:79]
    v_mfma_f32_16x16x32_bf16 v[68:71], a[204:207], v[80:83], v[68:71]
    s_waitcnt lgkmcnt(0)
    v_mfma_f32_16x16x32_bf16 v[48:51], a[208:211], v[88:91], v[48:51]
    ds_read_b128 v[80:83], v4 offset:28672
    v_mfma_f32_16x16x32_bf16 v[56:59], a[208:211], v[92:95], v[56:59]
    v_mfma_f32_16x16x32_bf16 v[60:63], a[212:215], v[92:95], v[60:63]
    s_waitcnt vmcnt(0)
    ds_read_b128 v[84:87], v5 offset:28672
    v_cmp_ne_u32 vcc, 0, v96
    v_mfma_f32_16x16x32_bf16 v[52:55], a[212:215], v[88:91], v[52:55]
    v_mfma_f32_16x16x32_bf16 v[64:67], a[216:219], v[88:91], v[64:67]
    s_cbranch_vccnz L_spin84
L_back85:
    s_barrier
    v_mfma_f32_16x16x32_bf16 v[72:75], a[216:219], v[92:95], v[72:75]
    buffer_load_dwordx4 v1, s[16:19], s42 offen offset:0 sc1 lds
    v_mfma_f32_16x16x32_bf16 v[76:79], a[220:223], v[92:95], v[76:79]
    v_mfma_f32_16x16x32_bf16 v[68:71], a[220:223], v[88:91], v[68:71]
    s_waitcnt lgkmcnt(0)
    v_mfma_f32_16x16x32_bf16 v[48:51], a[224:227], v[80:83], v[48:51]
    ds_read_b128 v[88:91], v4 offset:30720
    v_mfma_f32_16x16x32_bf16 v[56:59], a[224:227], v[84:87], v[56:59]
    buffer_load_dwordx4 v1, s[16:19], s42 offen offset:1024 sc1 lds
    v_mfma_f32_16x16x32_bf16 v[60:63], a[228:231], v[84:87], v[60:63]
    ds_read_b128 v[92:95], v5 offset:30720
    v_mfma_f32_16x16x32_bf16 v[52:55], a[228:231], v[80:83], v[52:55]
    v_mfma_f32_16x16x32_bf16 v[64:67], a[232:235], v[80:83], v[64:67]
    v_mfma_f32_16x16x32_bf16 v[72:75], a[232:235], v[84:87], v[72:75]
    buffer_load_dwordx4 v1, s[16:19], s42 offen offset:2048 sc1 lds
    v_mfma_f32_16x16x32_bf16 v[76:79], a[236:239], v[84:87], v[76:79]
    v_mfma_f32_16x16x32_bf16 v[68:71], a[236:239], v[80:83], v[68:71]
    s_waitcnt lgkmcnt(0)
    v_mfma_f32_16x16x32_bf16 v[48:51], a[240:243], v[88:91], v[48:51]
    ds_read_b128 v[80:83], v4 offset:32768
    v_mfma_f32_16x16x32_bf16 v[56:59], a[240:243], v[92:95], v[56:59]
    buffer_load_dwordx4 v1, s[16:19], s42 offen offset:3072 sc1 lds
    v_mfma_f32_16x16x32_bf16 v[60:63], a[244:247], v[92:95], v[60:63]
    s_add_u32 m0, s43, 16384
    ds_read_b128 v[84:87], v5 offset:32768
    s_add_u32 s42, s41, 16384
    v_mfma_f32_16x16x32_bf16 v[52:55], a[244:247], v[88:91], v[52:55]
    v_mfma_f32_16x16x32_bf16 v[64:67], a[248:251], v[88:91], v[64:67]
    v_mfma_f32_16x16x32_bf16 v[72:75], a[248:251], v[92:95], v[72:75]
    buffer_load_dwordx4 v1, s[16:19], s42 offen offset:0 sc1 lds
    v_mfma_f32_16x16x32_bf16 v[76:79], a[252:255], v[92:95], v[76:79]
    v_mfma_f32_16x16x32_bf16 v[68:71], a[252:255], v[88:91], v[68:71]
    s_waitcnt lgkmcnt(0)
    v_mfma_f32_16x16x32_bf16 v[48:51], v[128:131], v[80:83], v[48:51]
    ds_read_b128 v[88:91], v4 offset:34816
    v_mfma_f32_16x16x32_bf16 v[56:59], v[128:131], v[84:87], v[56:59]
    buffer_load_dwordx4 v1, s[16:19], s42 offen offset:1024 sc1 lds
    v_mfma_f32_16x16x32_bf16 v[60:63], v[132:135], v[84:87], v[60:63]
    ds_read_b128 v[92:95], v5 offset:34816
    v_mfma_f32_16x16x32_bf16 v[52:55], v[132:135], v[80:83], v[52:55]
    v_mfma_f32_16x16x32_bf16 v[64:67], v[136:139], v[80:83], v[64:67]
    v_mfma_f32_16x16x32_bf16 v[72:75], v[136:139], v[84:87], v[72:75]
    buffer_load_dwordx4 v1, s[16:19], s42 offen offset:2048 sc1 lds
    v_mfma_f32_16x16x32_bf16 v[76:79], v[140:143], v[84:87], v[76:79]
    v_mfma_f32_16x16x32_bf16 v[68:71], v[140:143], v[80:83], v[68:71]
    s_waitcnt lgkmcnt(0)
    v_mfma_f32_16x16x32_bf16 v[48:51], v[144:147], v[88:91], v[48:51]
    ds_read_b128 v[80:83], v4 offset:36864
    v_mfma_f32_16x16x32_bf16 v[56:59], v[144:147], v[92:95], v[56:59]
    buffer_load_dwordx4 v1, s[16:19], s42 offen offset:3072 sc1 lds
    v_mfma_f32_16x16x32_bf16 v[60:63], v[148:151], v[92:95], v[60:63]
    ds_read_b128 v[84:87], v5 offset:36864
    v_mfma_f32_16x16x32_bf16 v[52:55], v[148:151], v[88:91], v[52:55]
    v_mfma_f32_16x16x32_bf16 v[64:67], v[152:155], v[88:91], v[64:67]
    buffer_store_dword v124, v124, s[16:19], s91 offen sc1
    v_mfma_f32_16x16x32_bf16 v[72:75], v[152:155], v[92:95], v[72:75]
    s_add_u32 s91, s91, 65536
    v_mfma_f32_16x16x32_bf16 v[76:79], v[156:159], v[92:95], v[76:79]
    v_mfma_f32_16x16x32_bf16 v[68:71], v[156:159], v[88:91], v[68:71]
    s_waitcnt lgkmcnt(0)
    v_mfma_f32_16x16x32_bf16 v[48:51], v[160:163], v[80:83], v[48:51]
    ds_read_b128 v[88:91], v4 offset:38912
    v_mfma_f32_16x16x32_bf16 v[56:59], v[160:163], v[84:87], v[56:59]
    v_mfma_f32_16x16x32_bf16 v[60:63], v[164:167], v[84:87], v[60:63]
    ds_read_b128 v[92:95], v5 offset:38912
    v_mfma_f32_16x16x32_bf16 v[52:55], v[164:167], v[80:83], v[52:55]
    v_mfma_f32_16x16x32_bf16 v[64:67], v[168:171], v[80:83], v[64:67]
    v_mfma_f32_16x16x32_bf16 v[72:75], v[168:171], v[84:87], v[72:75]
    v_mfma_f32_16x16x32_bf16 v[76:79], v[172:175], v[84:87], v[76:79]
    v_mfma_f32_16x16x32_bf16 v[68:71], v[172:175], v[80:83], v[68:71]
    s_waitcnt lgkmcnt(0)
    v_mfma_f32_16x16x32_bf16 v[48:51], v[176:179], v[88:91], v[48:51]
    ds_read_b128 v[80:83], v4 offset:40960
    v_mfma_f32_16x16x32_bf16 v[56:59], v[176:179], v[92:95], v[56:59]
    v_mfma_f32_16x16x32_bf16 v[60:63], v[180:183], v[92:95], v[60:63]
    ds_read_b128 v[84:87], v5 offset:40960
    v_mfma_f32_16x16x32_bf16 v[52:55], v[180:183], v[88:91], v[52:55]
    v_mfma_f32_16x16x32_bf16 v[64:67], v[184:187], v[88:91], v[64:67]
    v_mfma_f32_16x16x32_bf16 v[72:75], v[184:187], v[92:95], v[72:75]
    v_mfma_f32_16x16x32_bf16 v[76:79], v[188:191], v[92:95], v[76:79]
    v_mfma_f32_16x16x32_bf16 v[68:71], v[188:191], v[88:91], v[68:71]
    s_waitcnt lgkmcnt(0)
    v_mfma_f32_16x16x32_bf16 v[48:51], v[192:195], v[80:83], v[48:51]
    ds_read_b128 v[88:91], v4 offset:43008
    v_mfma_f32_16x16x32_bf16 v[56:59], v[192:195], v[84:87], v[56:59]
    v_mfma_f32_16x16x32_bf16 v[60:63], v[196:199], v[84:87], v[60:63]
    s_add_u32 m0, s43, 32768
    ds_read_b128 v[92:95], v5 offset:43008
    s_add_u32 s42, s41, 32768
    v_mfma_f32_16x16x32_bf16 v[52:55], v[196:199], v[80:83], v[52:55]
    buffer_load_dwordx4 v1, s[16:19], s42 offen offset:0 sc1 lds
    v_mfma_f32_16x16x32_bf16 v[64:67], v[200:203], v[80:83], v[64:67]
    v_mfma_f32_16x16x32_bf16 v[72:75], v[200:203], v[84:87], v[72:75]
    v_mfma_f32_16x16x32_bf16 v[76:79], v[204:207], v[84:87], v[76:79]
    v_mfma_f32_16x16x32_bf16 v[68:71], v[204:207], v[80:83], v[68:71]
    s_waitcnt lgkmcnt(0)
    v_mfma_f32_16x16x32_bf16 v[48:51], v[208:211], v[88:91], v[48:51]
    ds_read_b128 v[80:83], v4 offset:45056
    v_mfma_f32_16x16x32_bf16 v[56:59], v[208:211], v[92:95], v[56:59]
    buffer_load_dwordx4 v1, s[16:19], s42 offen offset:1024 sc1 lds
    v_mfma_f32_16x16x32_bf16 v[60:63], v[212:215], v[92:95], v[60:63]
    ds_read_b128 v[84:87], v5 offset:45056
    v_mfma_f32_16x16x32_bf16 v[52:55], v[212:215], v[88:91], v[52:55]
    v_mfma_f32_16x16x32_bf16 v[64:67], v[216:219], v[88:91], v[64:67]
    v_mfma_f32_16x16x32_bf16 v[72:75], v[216:219], v[92:95], v[72:75]
    v_mfma_f32_16x16x32_bf16 v[76:79], v[220:223], v[92:95], v[76:79]
    buffer_load_dwordx4 v1, s[16:19], s42 offen offset:2048 sc1 lds
    v_mfma_f32_16x16x32_bf16 v[68:71], v[220:223], v[88:91], v[68:71]
    s_waitcnt lgkmcnt(0)
    v_mfma_f32_16x16x32_bf16 v[48:51], v[224:227], v[80:83], v[48:51]
    ds_read_b128 v[88:91], v4 offset:47104
    v_mfma_f32_16x16x32_bf16 v[56:59], v[224:227], v[84:87], v[56:59]
    v_mfma_f32_16x16x32_bf16 v[60:63], v[228:231], v[84:87], v[60:63]
    ds_read_b128 v[92:95], v5 offset:47104
    v_mfma_f32_16x16x32_bf16 v[52:55], v[228:231], v[80:83], v[52:55]
    buffer_load_dwordx4 v1, s[16:19], s42 offen offset:3072 sc1 lds
    v_mfma_f32_16x16x32_bf16 v[64:67], v[232:235], v[80:83], v[64:67]
    s_add_u32 s45, s45, 65536
    v_mfma_f32_16x16x32_bf16 v[72:75], v[232:235], v[84:87], v[72:75]
    v_mfma_f32_16x16x32_bf16 v[76:79], v[236:239], v[84:87], v[76:79]
    v_mfma_f32_16x16x32_bf16 v[68:71], v[236:239], v[80:83], v[68:71]
    s_waitcnt vmcnt(5) lgkmcnt(0)
    s_barrier
    v_mfma_f32_16x16x32_bf16 v[48:51], v[240:243], v[88:91], v[48:51]
    ds_read_b128 v[80:83], v2 offset:0
    v_mfma_f32_16x16x32_bf16 v[56:59], v[240:243], v[92:95], v[56:59]
    v_mfma_f32_16x16x32_bf16 v[60:63], v[244:247], v[92:95], v[60:63]
    ds_read_b128 v[84:87], v3 offset:0
    v_mfma_f32_16x16x32_bf16 v[52:55], v[244:247], v[88:91], v[52:55]
    v_mfma_f32_16x16x32_bf16 v[64:67], v[248:251], v[88:91], v[64:67]
    v_mfma_f32_16x16x32_bf16 v[72:75], v[248:251], v[92:95], v[72:75]
    v_mfma_f32_16x16x32_bf16 v[76:79], v[252:255], v[92:95], v[76:79]
    s_add_u32 s36, s36, 1
    v_mfma_f32_16x16x32_bf16 v[68:71], v[252:255], v[88:91], v[68:71]
    s_waitcnt lgkmcnt(0)
    s_cmp_lt_u32 s36, 32
    s_cbranch_scc1 L_bs_b0
    s_nop 7
    s_and_b32 s44, s90, 0xffffffff
    s_cmp_lt_i32 s36, 1
    s_cselect_b32 s44, 0x5e00000, s44
    s_xor_b32 s49, s44, 0
    v_cvt_pk_bf16_f32 v48, v48, v49
    v_cvt_pk_bf16_f32 v49, v50, v51
    v_cvt_pk_bf16_f32 v50, v52, v53
    v_cvt_pk_bf16_f32 v51, v54, v55
    v_min_u32 v48, -2, v48
    v_min_u32 v49, -2, v49
    v_min_u32 v50, -2, v50
    v_min_u32 v51, -2, v51
    buffer_store_dwordx4 v[48:51], v1, s[16:19], s49 offen offset:3072 sc1
    s_xor_b32 s49, s44, 16384
    v_cvt_pk_bf16_f32 v56, v56, v57
    v_cvt_pk_bf16_f32 v57, v58, v59
    v_cvt_pk_bf16_f32 v58, v60, v61
    v_cvt_pk_bf16_f32 v59, v62, v63
    v_min_u32 v56, -2, v56
    v_min_u32 v57, -2, v57
    v_min_u32 v58, -2, v58
    v_min_u32 v59, -2, v59
    buffer_store_dwordx4 v[56:59], v1, s[16:19], s49 offen offset:3072 sc1
    s_xor_b32 s49, s44, 32768
    v_cvt_pk_bf16_f32 v64, v64, v65
    v_cvt_pk_bf16_f32 v65, v66, v67
    v_cvt_pk_bf16_f32 v66, v68, v69
    v_cvt_pk_bf16_f32 v67, v70, v71
    v_min_u32 v64, -2, v64
    v_min_u32 v65, -2, v65
    v_min_u32 v66, -2, v66
    v_min_u32 v67, -2, v67
    buffer_store_dwordx4 v[64:67], v1, s[16:19], s49 offen offset:3072 sc1
    s_xor_b32 s49, s44, 49152
    v_cvt_pk_bf16_f32 v72, v72, v73
    v_cvt_pk_bf16_f32 v73, v74, v75
    v_cvt_pk_bf16_f32 v74, v76, v77
    v_cvt_pk_bf16_f32 v75, v78, v79
    v_min_u32 v72, -2, v72
    v_min_u32 v73, -2, v73
    v_min_u32 v74, -2, v74
    v_min_u32 v75, -2, v75
    buffer_store_dwordx4 v[72:75], v1, s[16:19], s49 offen offset:3072 sc1
    s_add_u32 s90, s90, 262144
    s_waitcnt vmcnt(0)
    s_endpgm
L_spin78:
    s_mov_b32 s40, 0x20000
L_spin78_l:
    buffer_load_dword v80, v124, s[20:23], 0 offen sc1
    s_sub_u32 s40, s40, 1
    s_waitcnt vmcnt(0)
    v_cmp_eq_u32 vcc, v124, v80
    s_cbranch_scc1 L_back79
    s_cbranch_vccz L_back79
    s_sleep 8
    s_branch L_spin78_l
L_spin80:
    s_mov_b32 s40, 0x20000
L_spin80_l:
    buffer_load_dword v96, v6, s[16:19], s45 offen sc1
    s_sub_u32 s40, s40, 1
    s_waitcnt vmcnt(0)
    v_cmp_ne_u32 vcc, 0, v96
    s_cbranch_scc1 L_back81
    s_cbranch_vccz L_back81
    s_sleep 2
    s_branch L_spin80_l
L_spin82:
    s_mov_b32 s40, 0x20000
L_spin82_l:
    buffer_load_dword v96, v6, s[16:19], s45 offen sc1
    s_sub_u32 s40, s40, 1
    s_waitcnt vmcnt(0)
    v_cmp_ne_u32 vcc, 0, v96
    s_cbranch_scc1 L_back83
    s_cbranch_vccz L_back83
    s_sleep 2
    s_branch L_spin82_l
L_spin84:
    s_mov_b32 s40, 0x20000
L_spin84_l:
    buffer_load_dword v96, v6, s[16:19], s45 offen sc1
    s_sub_u32 s40, s40, 1
    s_waitcnt vmcnt(0)
    v_cmp_ne_u32 vcc, 0, v96
    s_cbranch_scc1 L_back85
    s_cbranch_vccz L_back85
    s_sleep 2
    s_branch L_spin84_l
L_restart:
    s_waitcnt vmcnt(0) lgkmcnt(0)
    s_barrier
    s_xor_b32 s2, s2, 1
    s_xor_b32 s3, s3, 3
    s_branch L_dispatch
L_code_end:
    s_endpgm
.section .rodata,"a"
.p2align 6
.amdhsa_kernel interleave_layers__sliding_local_dilated__dense_activation_squared_relu__prompt_kernel
  .amdhsa_next_free_vgpr 512
  .amdhsa_next_free_sgpr 102
  .amdhsa_accum_offset 256
  .amdhsa_group_segment_fixed_size 0
  .amdhsa_kernarg_size 88
  .amdhsa_user_sgpr_count 2
  .amdhsa_user_sgpr_kernarg_segment_ptr 1
  .amdhsa_system_sgpr_workgroup_id_x 1
.end_amdhsa_kernel
```

```asm
; @launch grid=(256,1,1) block=(256,1,1) lds=163840
.amdgcn_target "amdgcn-amd-amdhsa--gfx950"
.text
.globl interleave_layers__sliding_local_dilated__dense_activation_squared_relu__prompt_kernel
.p2align 8
.type interleave_layers__sliding_local_dilated__dense_activation_squared_relu__prompt_kernel,@function
interleave_layers__sliding_local_dilated__dense_activation_squared_relu__prompt_kernel:
    s_load_dwordx16 s[64:79], s[0:1], 0x0
    s_load_dwordx4 s[80:83], s[0:1], 0x40
    s_load_dwordx2 s[84:85], s[0:1], 0x50
    v_lshrrev_b32 v1, 6, v0
    s_cmp_ge_u32 s2, 256
    s_cbranch_scc1 L_code_end
    s_getpc_b64 s[20:21]
L_pc:
    s_mov_b32 s22, L_code_end-L_pc
    s_mov_b32 s23, 0x00020000
    v_lshlrev_b32 v7, 12, v0
    s_lshl_b32 s37, s2, 4
    buffer_load_dword v252, v7, s[20:23], s37 offen
    v_readfirstlane_b32 s32, v1
    v_and_b32 v0, 63, v0
    v_lshlrev_b32 v1, 4, v0
    s_getreg_b32 s3, hwreg(HW_REG_XCC_ID)
    s_xor_b32 s3, s3, s2
    s_and_b32 s3, s3, 1
    s_lshl2_add_u32 s37, s2, s32
    s_xor_b32 s2, s2, s3
    s_add_u32 s3, s3, 1
    s_cmp_eq_u32 s37, 514
    s_cbranch_scc0 L_dispatch
    s_waitcnt lgkmcnt(0)
    s_add_u32 s20, s82, 0xa0
    s_addc_u32 s21, s83, 0
    s_mov_b32 s22, 0x4
    s_mov_b32 s23, 0x00020000
    v_mov_b32 v2, s3
    buffer_store_dword v2, v1, s[20:23], 0 offen sc1
L_dispatch:
    s_bfe_u32 s47, s2, 0x20001
    s_and_b32 s37, s2, 0x81
    s_cmp_lg_u32 s37, 0
    s_cbranch_scc1 L_other
    s_bfe_u32 s33, s2, 0x20003
    s_lshr_b32 s34, s2, 5
    s_lshl2_add_u32 s34, s47, s34
    s_mov_b32 s35, s34
    s_movk_i32 s39, 6144
    s_lshl_b32 s54, s35, 7
    v_lshrrev_b32 v32, 3, v0
    v_lshlrev_b32 v33, 2, v0
    v_and_b32 v33, 64, v33
    v_and_b32 v34, 0x70, v1
    v_xor_b32 v33, v33, v34
    v_mad_u32_u24 v20, v32, s39, v33
    v_add_u32 v21, 49152, v20
    v_add_u32 v22, 2048, v20
    v_add_u32 v23, 51200, v20
    v_add_u32 v24, 4096, v20
    v_add_u32 v25, 53248, v20
    s_mul_i32 s38, s32, 98304
    s_add_u32 s54, s54, s38
    s_lshl_b32 s42, s32, 11
    s_lshr_b32 s51, s32, 1
    s_lshl_b32 s50, s33, 5
    s_add_u32 s53, s50, 31
    s_lshl_b32 s53, s53, 8
    s_add_u32 s53, s53, s51
    s_lshl_b32 s53, s53, 7
    s_add_u32 s50, s50, 30
    s_sub_u32 s50, s50, s51
    s_lshl_b32 s41, s50, 15
    s_lshl_b32 s43, s32, 10
    v_lshlrev_b32 v37, 1, v0
    v_and_b32 v37, 0x60, v37
    v_xor_b32 v37, v37, v34
    s_and_b32 s37, s32, 1
    s_lshl_b32 s37, s37, 14
    v_lshl_add_u32 v6, v32, 11, v37
    v_add_u32 v6, s37, v6
    s_waitcnt lgkmcnt(0)
    s_mov_b32 s12, s66
    s_mov_b32 s13, s67
    s_mov_b32 s14, 0x600000
    s_mov_b32 s15, 0x00020000
    s_mov_b32 s8, s64
    s_mov_b32 s9, s65
    s_mov_b32 s10, 0x400000
    s_mov_b32 s11, 0x00020000
    s_add_u32 m0, s43, 131072
    s_nop 0
    buffer_load_dwordx4 v6, s[8:11], s53 offen offset:0 sc1 lds
    s_add_u32 m0, s43, 98304
    s_nop 0
    buffer_load_dwordx4 v6, s[8:11], s41 offen offset:0 sc1 lds
    s_add_u32 m0, s42, 73728
    s_nop 0
    buffer_load_dwordx4 v20, s[12:15], s54 offen lds
    s_add_u32 m0, s42, 74752
    s_nop 0
    buffer_load_dwordx4 v21, s[12:15], s54 offen lds
    s_add_u32 m0, s42, 81920
    s_nop 0
    buffer_load_dwordx4 v22, s[12:15], s54 offen lds
    s_add_u32 m0, s42, 82944
    s_nop 0
    buffer_load_dwordx4 v23, s[12:15], s54 offen lds
    s_add_u32 m0, s42, 90112
    s_nop 0
    buffer_load_dwordx4 v24, s[12:15], s54 offen lds
    s_add_u32 m0, s42, 91136
    s_nop 0
    buffer_load_dwordx4 v25, s[12:15], s54 offen lds
    s_add_u32 s54, s54, 393216
    v_lshrrev_b32 v32, 4, v0
    v_bfe_u32 v33, v0, 2, 2
    v_lshl_add_u32 v32, v32, 3, v33
    v_lshlrev_b32 v32, 7, v32
    v_lshrrev_b32 v33, 1, v33
    v_lshl_add_u32 v32, v33, 6, v32
    v_and_b32 v33, 3, v0
    v_lshl_add_u32 v32, v33, 4, v32
    s_lshl_b32 s37, s51, 6
    s_and_b32 s38, s32, 1
    s_lshl_b32 s38, s38, 3
    s_add_u32 s37, s37, s38
    s_add_u32 s37, s37, 0
    v_xor_b32 v26, s37, v32
    s_lshl_b32 s37, s51, 6
    s_and_b32 s38, s32, 1
    s_lshl_b32 s38, s38, 3
    s_add_u32 s37, s37, s38
    s_add_u32 s37, s37, 8192
    v_xor_b32 v27, s37, v32
    s_lshl_b32 s37, s51, 6
    s_and_b32 s38, s32, 1
    s_lshl_b32 s38, s38, 3
    s_add_u32 s37, s37, s38
    s_add_u32 s37, s37, 16384
    v_xor_b32 v28, s37, v32
    v_mov_b32 v32, 0x3f803f80
    v_mov_b32 v33, 0x3f803f80
    v_mov_b32 v34, 0x3f803f80
    v_mov_b32 v35, 0x3f803f80
    v_and_b32 v36, 15, v0
    v_lshrrev_b32 v37, 4, v0
    v_and_b32 v38, 6, v36
    v_xor_b32 v38, v37, v38
    v_lshlrev_b32 v38, 4, v38
    v_lshl_add_u32 v2, v36, 7, v38
    v_xor_b32 v3, 64, v2
    v_add_u32 v4, 98304, v2
    v_add_u32 v5, 98304, v3
    s_add_u32 m0, s43, 102272
    s_nop 0
    buffer_load_dwordx4 v6, s[8:11], s41 offen offset:128 sc1 lds
    s_add_u32 m0, s42, 0
    s_nop 0
    buffer_load_dwordx4 v20, s[12:15], s54 offen lds
    s_add_u32 m0, s42, 1024
    s_nop 0
    buffer_load_dwordx4 v21, s[12:15], s54 offen lds
    s_add_u32 m0, s42, 8192
    s_nop 0
    buffer_load_dwordx4 v22, s[12:15], s54 offen lds
    s_add_u32 m0, s42, 9216
    s_nop 0
    buffer_load_dwordx4 v23, s[12:15], s54 offen lds
    s_add_u32 m0, s42, 16384
    s_nop 0
    buffer_load_dwordx4 v24, s[12:15], s54 offen lds
    s_add_u32 m0, s42, 17408
    s_nop 0
    buffer_load_dwordx4 v25, s[12:15], s54 offen lds
    s_add_u32 s54, s54, 393216
    s_add_u32 m0, s43, 134912
    s_nop 0
    buffer_load_dwordx4 v6, s[8:11], s53 offen offset:256 sc1 lds
    s_add_u32 m0, s43, 106240
    s_nop 0
    buffer_load_dwordx4 v6, s[8:11], s41 offen offset:256 sc1 lds
    s_add_u32 m0, s42, 24576
    s_nop 0
    buffer_load_dwordx4 v20, s[12:15], s54 offen lds
    s_add_u32 m0, s42, 25600
    s_nop 0
    buffer_load_dwordx4 v21, s[12:15], s54 offen lds
    s_add_u32 m0, s42, 32768
    s_nop 0
    buffer_load_dwordx4 v22, s[12:15], s54 offen lds
    s_add_u32 m0, s42, 33792
    s_nop 0
    buffer_load_dwordx4 v23, s[12:15], s54 offen lds
    s_add_u32 m0, s42, 40960
    s_nop 0
    buffer_load_dwordx4 v24, s[12:15], s54 offen lds
    s_add_u32 m0, s42, 41984
    s_nop 0
    buffer_load_dwordx4 v25, s[12:15], s54 offen lds
    s_add_u32 s54, s54, 393216
    s_mov_b32 s36, -1
    v_add_u32 v29, 73728, v26
    v_add_u32 v30, 73728, v27
    v_add_u32 v31, 73728, v28
    s_waitcnt vmcnt(15) lgkmcnt(0)
    s_barrier
    ds_read_b128 v[68:71], v4 offset:0
    s_add_u32 m0, s43, 110208
    ds_read_b128 v[72:75], v4 offset:2048
    buffer_load_dwordx4 v6, s[8:11], s41 offen offset:384 sc1 lds
    ds_read_b128 v[76:79], v4 offset:32768
    s_add_u32 m0, s42, 49152
    ds_read_b64_tr_b16 a[0:1], v29 offset:0
    buffer_load_dwordx4 v20, s[12:15], s54 offen lds
    ds_read_b64_tr_b16 a[2:3], v29 offset:512
    s_add_u32 m0, s42, 50176
    ds_read_b64_tr_b16 a[4:5], v30 offset:0
    buffer_load_dwordx4 v21, s[12:15], s54 offen lds
    ds_read_b64_tr_b16 a[6:7], v30 offset:512
    s_add_u32 m0, s42, 57344
    ds_read_b64_tr_b16 a[8:9], v31 offset:0
    buffer_load_dwordx4 v22, s[12:15], s54 offen lds
    ds_read_b64_tr_b16 a[10:11], v31 offset:512
    s_waitcnt lgkmcnt(4)
    v_mfma_f32_16x16x32_bf16 v[44:47], a[0:3], v[68:71], 0
    s_add_u32 m0, s42, 58368
    ds_read_b128 v[80:83], v5 offset:0
    v_mfma_f32_16x16x32_bf16 v[48:51], a[0:3], v[72:75], 0
    ds_read_b128 v[84:87], v5 offset:2048
    v_mfma_f32_16x16x32_bf16 v[92:95], a[0:3], v[76:79], 0
    ds_read_b128 v[88:91], v5 offset:32768
    s_waitcnt lgkmcnt(5)
    v_mfma_f32_16x16x32_bf16 v[52:55], a[4:7], v[68:71], 0
    ds_read_b64_tr_b16 a[12:13], v29 offset:4096
    v_mfma_f32_16x16x32_bf16 v[56:59], a[4:7], v[72:75], 0
    ds_read_b64_tr_b16 a[14:15], v29 offset:4608
    v_mfma_f32_16x16x32_bf16 v[96:99], a[4:7], v[76:79], 0
    ds_read_b64_tr_b16 a[16:17], v30 offset:4096
    s_waitcnt lgkmcnt(6)
    v_mfma_f32_16x16x32_bf16 v[60:63], a[8:11], v[68:71], 0
    ds_read_b64_tr_b16 a[18:19], v30 offset:4608
    v_mfma_f32_16x16x32_bf16 v[64:67], a[8:11], v[72:75], 0
    ds_read_b64_tr_b16 a[20:21], v31 offset:4096
    v_mfma_f32_16x16x32_bf16 v[118:121], a[8:11], v[76:79], 0
    ds_read_b64_tr_b16 a[22:23], v31 offset:4608
    v_mfma_f32_16x16x32_bf16 v[100:103], a[0:3], v[32:35], 0
    buffer_load_dwordx4 v23, s[12:15], s54 offen lds
    v_mfma_f32_16x16x32_bf16 v[104:107], a[4:7], v[32:35], 0
    s_add_u32 m0, s42, 65536
    s_nop 0
    buffer_load_dwordx4 v24, s[12:15], s54 offen lds
    v_mfma_f32_16x16x32_bf16 v[108:111], a[8:11], v[32:35], 0
    s_add_u32 m0, s42, 66560
    s_nop 0
    buffer_load_dwordx4 v25, s[12:15], s54 offen lds
    s_add_u32 s54, s54, 393216
    s_mov_b32 s16, s84
    s_mov_b32 s17, s85
    s_mov_b32 s18, 0x5e00000
    s_mov_b32 s19, 0x00020000
    v_min_u32 v124, 1, v0
    v_lshlrev_b32 v124, 30, v124
    s_lshl_b32 s91, s33, 6
    s_add_u32 s91, s91, s34
    s_lshl_b32 s91, s91, 7
    s_add_u32 s91, s91, 0x5520000
    s_cmp_eq_u32 s32, 1
    s_cselect_b32 s91, s91, 0x5f00000
    s_add_u32 s88, s84, 0x5000000
    s_addc_u32 s89, s85, 0
    s_sub_u32 s97, 14, s51
    s_and_b32 s38, s32, 1
    v_lshlrev_b32 v40, 1, v0
    v_and_b32 v40, 0x30, v40
    v_xor_b32 v40, v40, v1
    s_mul_i32 s37, s51, 3072
    s_add_u32 s37, s37, 65536
    s_lshl_b32 s39, s38, 3
    s_add_u32 s39, s39, s37
    v_add_u32 v7, s39, v40
    v_bfe_u32 v38, v0, 1, 2
    v_xor_b32 v38, v38, v37
    v_lshlrev_b32 v38, 4, v38
    v_lshl_add_u32 v38, v36, 6, v38
    v_add_u32 v8, s39, v38
    s_waitcnt vmcnt(15) lgkmcnt(0)
    s_barrier
    v_mfma_f32_16x16x32_bf16 v[44:47], a[12:15], v[80:83], v[44:47]
    s_add_u32 m0, s43, 138752
    ds_read_b128 v[68:71], v4 offset:4096
    ds_read_b128 v[72:75], v4 offset:6144
    v_mfma_f32_16x16x32_bf16 v[48:51], a[12:15], v[84:87], v[48:51]
    ds_read_b128 v[76:79], v4 offset:34816
    ds_read_b64_tr_b16 a[24:25], v26 offset:0
    v_mfma_f32_16x16x32_bf16 v[92:95], a[12:15], v[88:91], v[92:95]
    buffer_load_dwordx4 v6, s[8:11], s53 offen offset:512 sc1 lds
    v_mfma_f32_16x16x32_bf16 v[52:55], a[16:19], v[80:83], v[52:55]
    s_add_u32 m0, s43, 114176
    ds_read_b64_tr_b16 a[26:27], v26 offset:512
    v_mfma_f32_16x16x32_bf16 v[56:59], a[16:19], v[84:87], v[56:59]
    buffer_load_dwordx4 v6, s[8:11], s41 offen offset:512 sc1 lds
    v_mfma_f32_16x16x32_bf16 v[96:99], a[16:19], v[88:91], v[96:99]
    s_add_u32 m0, s42, 73728
    ds_read_b64_tr_b16 a[28:29], v27 offset:0
    v_mfma_f32_16x16x32_bf16 v[60:63], a[20:23], v[80:83], v[60:63]
    ds_read_b64_tr_b16 a[30:31], v27 offset:512
    v_mfma_f32_16x16x32_bf16 v[64:67], a[20:23], v[84:87], v[64:67]
    buffer_load_dwordx4 v20, s[12:15], s54 offen lds
    v_mfma_f32_16x16x32_bf16 v[118:121], a[20:23], v[88:91], v[118:121]
    s_add_u32 m0, s42, 74752
    ds_read_b64_tr_b16 a[32:33], v28 offset:0
    v_mfma_f32_16x16x32_bf16 v[100:103], a[12:15], v[32:35], v[100:103]
    buffer_load_dwordx4 v21, s[12:15], s54 offen lds
    v_mfma_f32_16x16x32_bf16 v[104:107], a[16:19], v[32:35], v[104:107]
    s_add_u32 m0, s42, 81920
    ds_read_b64_tr_b16 a[34:35], v28 offset:512
    v_mfma_f32_16x16x32_bf16 v[108:111], a[20:23], v[32:35], v[108:111]
    buffer_load_dwordx4 v22, s[12:15], s54 offen lds
    s_waitcnt lgkmcnt(4)
    v_mfma_f32_16x16x32_bf16 v[44:47], a[24:27], v[68:71], v[44:47]
    s_add_u32 m0, s42, 82944
    ds_read_b128 v[80:83], v5 offset:4096
    v_mfma_f32_16x16x32_bf16 v[48:51], a[24:27], v[72:75], v[48:51]
    ds_read_b128 v[84:87], v5 offset:6144
    v_mfma_f32_16x16x32_bf16 v[92:95], a[24:27], v[76:79], v[92:95]
    ds_read_b128 v[88:91], v5 offset:34816
    s_waitcnt lgkmcnt(5)
    v_mfma_f32_16x16x32_bf16 v[52:55], a[28:31], v[68:71], v[52:55]
    ds_read_b64_tr_b16 a[36:37], v26 offset:4096
    v_mfma_f32_16x16x32_bf16 v[56:59], a[28:31], v[72:75], v[56:59]
    ds_read_b64_tr_b16 a[38:39], v26 offset:4608
    v_mfma_f32_16x16x32_bf16 v[96:99], a[28:31], v[76:79], v[96:99]
    ds_read_b64_tr_b16 a[40:41], v27 offset:4096
    s_waitcnt lgkmcnt(6)
    v_mfma_f32_16x16x32_bf16 v[60:63], a[32:35], v[68:71], v[60:63]
    ds_read_b64_tr_b16 a[42:43], v27 offset:4608
    v_mfma_f32_16x16x32_bf16 v[64:67], a[32:35], v[72:75], v[64:67]
    ds_read_b64_tr_b16 a[44:45], v28 offset:4096
    v_mfma_f32_16x16x32_bf16 v[118:121], a[32:35], v[76:79], v[118:121]
    ds_read_b64_tr_b16 a[46:47], v28 offset:4608
    v_mfma_f32_16x16x32_bf16 v[100:103], a[24:27], v[32:35], v[100:103]
    buffer_load_dwordx4 v23, s[12:15], s54 offen lds
    v_mfma_f32_16x16x32_bf16 v[104:107], a[28:31], v[32:35], v[104:107]
    s_add_u32 m0, s42, 90112
    s_nop 0
    buffer_load_dwordx4 v24, s[12:15], s54 offen lds
    v_mfma_f32_16x16x32_bf16 v[108:111], a[32:35], v[32:35], v[108:111]
    s_add_u32 m0, s42, 91136
    s_nop 0
    buffer_load_dwordx4 v25, s[12:15], s54 offen lds
    s_add_u32 s54, s54, 393216
    s_mul_i32 s39, s38, 6144
    s_add_u32 s39, s39, s37
    v_add_u32 v9, s39, v40
    s_cmp_eq_u32 s38, 0
    s_cselect_b32 s39, 18432, 0
    s_add_u32 s39, s39, s37
    v_add_u32 v10, s39, v40
    s_sub_u32 s39, s33, 1
    s_max_i32 s39, s39, 0
    v_mov_b32 v38, s33
    v_mov_b32 v39, s39
    v_mov_b32 v12, 1048576
    v_mov_b32 v41, 131072
    v_cmp_lt_u32 vcc, 15, v0
    s_nop 1
    v_cndmask_b32 v38, v38, v39, vcc
    v_cndmask_b32 v12, v12, v41, vcc
    v_lshl_add_u32 v38, v38, 6, v36
    v_add_u32 v38, 697644, v38
    v_lshlrev_b32 v11, 7, v38
    s_cmp_eq_u32 s32, 0
    s_cselect_b32 s37, 32, 0
    v_cmp_le_u32 vcc, s37, v0
    s_nop 1
    v_cndmask_b32 v11, v11, 2.0, vcc
    s_mov_b32 s45, -720896
    v_and_b32 v13, 15, v0
    v_lshlrev_b32 v13, 3, v13
    v_lshrrev_b32 v38, 5, v0
    v_lshl_add_u32 v13, v38, 9, v13
    v_and_b32 v38, 16, v0
    s_waitcnt vmcnt(15) lgkmcnt(0)
    s_barrier
    v_mfma_f32_16x16x32_bf16 v[44:47], a[36:39], v[80:83], v[44:47]
    s_add_u32 m0, s43, 118144
    ds_read_b128 v[68:71], v4 offset:8192
    ds_read_b128 v[72:75], v4 offset:10240
    v_mfma_f32_16x16x32_bf16 v[48:51], a[36:39], v[84:87], v[48:51]
    ds_read_b128 v[76:79], v4 offset:36864
    v_mfma_f32_16x16x32_bf16 v[92:95], a[36:39], v[88:91], v[92:95]
    buffer_load_dwordx4 v6, s[8:11], s41 offen offset:640 sc1 lds
    v_mfma_f32_16x16x32_bf16 v[52:55], a[40:43], v[80:83], v[52:55]
    s_add_u32 m0, s42, 0
    ds_read_b64_tr_b16 a[48:49], v26 offset:24576
    v_mfma_f32_16x16x32_bf16 v[56:59], a[40:43], v[84:87], v[56:59]
    buffer_load_dwordx4 v20, s[12:15], s54 offen lds
    v_mfma_f32_16x16x32_bf16 v[96:99], a[40:43], v[88:91], v[96:99]
    s_add_u32 m0, s42, 1024
    ds_read_b64_tr_b16 a[50:51], v26 offset:25088
    v_mfma_f32_16x16x32_bf16 v[60:63], a[44:47], v[80:83], v[60:63]
    ds_read_b64_tr_b16 a[52:53], v27 offset:24576
    v_mfma_f32_16x16x32_bf16 v[64:67], a[44:47], v[84:87], v[64:67]
    buffer_load_dwordx4 v21, s[12:15], s54 offen lds
    v_mfma_f32_16x16x32_bf16 v[118:121], a[44:47], v[88:91], v[118:121]
    s_add_u32 m0, s42, 8192
    ds_read_b64_tr_b16 a[54:55], v27 offset:25088
    v_mfma_f32_16x16x32_bf16 v[100:103], a[36:39], v[32:35], v[100:103]
    buffer_load_dwordx4 v22, s[12:15], s54 offen lds
    v_mfma_f32_16x16x32_bf16 v[104:107], a[40:43], v[32:35], v[104:107]
    ds_read_b64_tr_b16 a[56:57], v28 offset:24576
    v_mfma_f32_16x16x32_bf16 v[108:111], a[44:47], v[32:35], v[108:111]
    ds_read_b64_tr_b16 a[58:59], v28 offset:25088
    s_waitcnt lgkmcnt(4)
    v_mfma_f32_16x16x32_bf16 v[44:47], a[48:51], v[68:71], v[44:47]
    s_add_u32 m0, s42, 9216
    ds_read_b128 v[80:83], v5 offset:8192
    v_mfma_f32_16x16x32_bf16 v[48:51], a[48:51], v[72:75], v[48:51]
    ds_read_b128 v[84:87], v5 offset:10240
    v_mfma_f32_16x16x32_bf16 v[92:95], a[48:51], v[76:79], v[92:95]
    ds_read_b128 v[88:91], v5 offset:36864
    s_waitcnt lgkmcnt(5)
    v_mfma_f32_16x16x32_bf16 v[52:55], a[52:55], v[68:71], v[52:55]
    ds_read_b64_tr_b16 a[60:61], v26 offset:28672
    v_mfma_f32_16x16x32_bf16 v[56:59], a[52:55], v[72:75], v[56:59]
    ds_read_b64_tr_b16 a[62:63], v26 offset:29184
    v_mfma_f32_16x16x32_bf16 v[96:99], a[52:55], v[76:79], v[96:99]
    ds_read_b64_tr_b16 a[64:65], v27 offset:28672
    s_waitcnt lgkmcnt(6)
    v_mfma_f32_16x16x32_bf16 v[60:63], a[56:59], v[68:71], v[60:63]
    ds_read_b64_tr_b16 a[66:67], v27 offset:29184
    v_mfma_f32_16x16x32_bf16 v[64:67], a[56:59], v[72:75], v[64:67]
    ds_read_b64_tr_b16 a[68:69], v28 offset:28672
    v_mfma_f32_16x16x32_bf16 v[118:121], a[56:59], v[76:79], v[118:121]
    ds_read_b64_tr_b16 a[70:71], v28 offset:29184
    v_mfma_f32_16x16x32_bf16 v[100:103], a[48:51], v[32:35], v[100:103]
    buffer_load_dwordx4 v23, s[12:15], s54 offen lds
    v_mfma_f32_16x16x32_bf16 v[104:107], a[52:55], v[32:35], v[104:107]
    s_add_u32 m0, s42, 16384
    s_nop 0
    buffer_load_dwordx4 v24, s[12:15], s54 offen lds
    v_mfma_f32_16x16x32_bf16 v[108:111], a[56:59], v[32:35], v[108:111]
    s_add_u32 m0, s42, 17408
    s_nop 0
    buffer_load_dwordx4 v25, s[12:15], s54 offen lds
    s_add_u32 s54, s54, 393216
    v_lshl_add_u32 v13, v38, 6, v13
    v_add_u32 v13, 90112, v13
    s_lshl_b32 s52, s51, 10
    s_or_b32 s96, s50, 31
    s_mov_b32 s55, 0x541fc00
    s_lshl_b32 s46, s50, 10
    s_sub_u32 s46, s55, s46
    s_mov_b32 s56, 0xaaaaaaaa
    s_mov_b32 s57, 0xaaaaaaaa
    s_mov_b32 s58, 0xfff0ffff
    s_mov_b32 s59, 0xf000ff00
    s_mov_b32 s60, 0xffc0fffc
    s_mov_b32 s61, 0xc000fc00
    s_mov_b32 s86, 0x3e8293ee
    v_mov_b32 v38, 0x0c0c0c0c
    v_mov_b32 v36, 0xc0c0100
    v_mov_b32 v37, 0x1000c0c
    v_cndmask_b32 v36, v36, v37, s[56:57]
    v_cndmask_b32 v14, v36, v38, s[58:59]
    v_cndmask_b32 v16, v38, v36, s[58:59]
    v_mov_b32 v36, 0xc0c0302
    v_mov_b32 v37, 0x3020c0c
    v_cndmask_b32 v36, v36, v37, s[56:57]
    v_cndmask_b32 v15, v36, v38, s[60:61]
    v_cndmask_b32 v17, v38, v36, s[60:61]
    v_mov_b32 v18, 0xff800000
    s_mul_i32 s90, s33, 2097152
    s_add_u32 s90, s90, 0xffff0000
    s_lshl_b32 s37, s35, 1
    s_waitcnt vmcnt(15) lgkmcnt(0)
    s_barrier
    v_mfma_f32_16x16x32_bf16 v[44:47], a[60:63], v[80:83], v[44:47]
    s_add_u32 m0, s43, 142592
    ds_read_b128 v[68:71], v4 offset:12288
    ds_read_b128 v[72:75], v4 offset:14336
    v_mfma_f32_16x16x32_bf16 v[48:51], a[60:63], v[84:87], v[48:51]
    ds_read_b128 v[76:79], v4 offset:38912
    ds_read_b64_tr_b16 a[72:73], v26 offset:49152
    v_mfma_f32_16x16x32_bf16 v[92:95], a[60:63], v[88:91], v[92:95]
    buffer_load_dwordx4 v6, s[8:11], s53 offen offset:768 sc1 lds
    v_mfma_f32_16x16x32_bf16 v[52:55], a[64:67], v[80:83], v[52:55]
    s_add_u32 m0, s43, 122112
    ds_read_b64_tr_b16 a[74:75], v26 offset:49664
    v_mfma_f32_16x16x32_bf16 v[56:59], a[64:67], v[84:87], v[56:59]
    buffer_load_dwordx4 v6, s[8:11], s41 offen offset:768 sc1 lds
    v_mfma_f32_16x16x32_bf16 v[96:99], a[64:67], v[88:91], v[96:99]
    s_add_u32 m0, s42, 24576
    ds_read_b64_tr_b16 a[76:77], v27 offset:49152
    v_mfma_f32_16x16x32_bf16 v[60:63], a[68:71], v[80:83], v[60:63]
    ds_read_b64_tr_b16 a[78:79], v27 offset:49664
    v_mfma_f32_16x16x32_bf16 v[64:67], a[68:71], v[84:87], v[64:67]
    buffer_load_dwordx4 v20, s[12:15], s54 offen lds
    v_mfma_f32_16x16x32_bf16 v[118:121], a[68:71], v[88:91], v[118:121]
    s_add_u32 m0, s42, 25600
    ds_read_b64_tr_b16 a[80:81], v28 offset:49152
    v_mfma_f32_16x16x32_bf16 v[100:103], a[60:63], v[32:35], v[100:103]
    buffer_load_dwordx4 v21, s[12:15], s54 offen lds
    v_mfma_f32_16x16x32_bf16 v[104:107], a[64:67], v[32:35], v[104:107]
    s_add_u32 m0, s42, 32768
    ds_read_b64_tr_b16 a[82:83], v28 offset:49664
    v_mfma_f32_16x16x32_bf16 v[108:111], a[68:71], v[32:35], v[108:111]
    buffer_load_dwordx4 v22, s[12:15], s54 offen lds
    s_waitcnt lgkmcnt(4)
    v_mfma_f32_16x16x32_bf16 v[44:47], a[72:75], v[68:71], v[44:47]
    s_add_u32 m0, s42, 33792
    ds_read_b128 v[80:83], v5 offset:12288
    v_mfma_f32_16x16x32_bf16 v[48:51], a[72:75], v[72:75], v[48:51]
    ds_read_b128 v[84:87], v5 offset:14336
    v_mfma_f32_16x16x32_bf16 v[92:95], a[72:75], v[76:79], v[92:95]
    ds_read_b128 v[88:91], v5 offset:38912
    s_waitcnt lgkmcnt(5)
    v_mfma_f32_16x16x32_bf16 v[52:55], a[76:79], v[68:71], v[52:55]
    ds_read_b64_tr_b16 a[84:85], v26 offset:53248
    v_mfma_f32_16x16x32_bf16 v[56:59], a[76:79], v[72:75], v[56:59]
    ds_read_b64_tr_b16 a[86:87], v26 offset:53760
    v_mfma_f32_16x16x32_bf16 v[96:99], a[76:79], v[76:79], v[96:99]
    ds_read_b64_tr_b16 a[88:89], v27 offset:53248
    s_waitcnt lgkmcnt(6)
    v_mfma_f32_16x16x32_bf16 v[60:63], a[80:83], v[68:71], v[60:63]
    ds_read_b64_tr_b16 a[90:91], v27 offset:53760
    v_mfma_f32_16x16x32_bf16 v[64:67], a[80:83], v[72:75], v[64:67]
    ds_read_b64_tr_b16 a[92:93], v28 offset:53248
    v_mfma_f32_16x16x32_bf16 v[118:121], a[80:83], v[76:79], v[118:121]
    ds_read_b64_tr_b16 a[94:95], v28 offset:53760
    v_mfma_f32_16x16x32_bf16 v[100:103], a[72:75], v[32:35], v[100:103]
    buffer_load_dwordx4 v23, s[12:15], s54 offen lds
    v_mfma_f32_16x16x32_bf16 v[104:107], a[76:79], v[32:35], v[104:107]
    s_add_u32 m0, s42, 40960
    s_nop 0
    buffer_load_dwordx4 v24, s[12:15], s54 offen lds
    v_mfma_f32_16x16x32_bf16 v[108:111], a[80:83], v[32:35], v[108:111]
    s_add_u32 m0, s42, 41984
    s_nop 0
    buffer_load_dwordx4 v25, s[12:15], s54 offen lds
    s_add_u32 s54, s54, 393216
    s_add_u32 s37, s37, s51
    s_lshl_b32 s37, s37, 11
    s_add_u32 s90, s90, s37
    s_mul_i32 s37, s38, 1024
    s_add_u32 s90, s90, s37
    s_mul_i32 s26, s38, 0x80008000
    s_mul_i32 s87, s51, -1024
    s_add_u32 s87, s87, 21504
    s_mul_i32 s87, s87, s38
    s_sub_u32 s87, s87, 1024
    s_sub_u32 s39, s33, 1
    s_max_i32 s39, s39, 0
    s_lshl_b32 s24, s39, 4
    s_add_u32 s24, s24, s35
    s_lshl_b32 s24, s24, 12
    s_add_u32 s24, s24, s43
    s_add_u32 s24, s24, 0x5b00000
    s_lshl_b32 s25, s33, 4
    s_add_u32 s25, s25, s35
    s_lshl_b32 s25, s25, 12
    s_add_u32 s25, s25, s43
    s_add_u32 s25, s25, 0x5b00000
    s_add_u32 s87, s87, 1024
    s_cmp_eq_u32 s33, 0
    s_cselect_b64 s[26:27], s[26:27], 0
    s_add_u32 s20, s82, 0x80
    s_addc_u32 s21, s83, 0
    s_mov_b32 s22, 0x80
    s_mov_b32 s23, 0x00020000
    v_lshl_add_u32 v36, s32, 7, v124
    v_mov_b32 v116, v36
    s_waitcnt vmcnt(15) lgkmcnt(0)
    s_barrier
    v_mfma_f32_16x16x32_bf16 v[44:47], a[84:87], v[80:83], v[44:47]
    s_add_u32 m0, s43, 126080
    ds_read_b128 v[68:71], v4 offset:16384
    ds_read_b128 v[72:75], v4 offset:18432
    v_mfma_f32_16x16x32_bf16 v[48:51], a[84:87], v[84:87], v[48:51]
    ds_read_b128 v[76:79], v4 offset:40960
    v_mfma_f32_16x16x32_bf16 v[92:95], a[84:87], v[88:91], v[92:95]
    buffer_load_dwordx4 v6, s[8:11], s41 offen offset:896 sc1 lds
    v_mfma_f32_16x16x32_bf16 v[52:55], a[88:91], v[80:83], v[52:55]
    s_add_u32 m0, s42, 49152
    ds_read_b64_tr_b16 a[96:97], v29 offset:0
    v_mfma_f32_16x16x32_bf16 v[56:59], a[88:91], v[84:87], v[56:59]
    buffer_load_dwordx4 v20, s[12:15], s54 offen lds
    v_mfma_f32_16x16x32_bf16 v[96:99], a[88:91], v[88:91], v[96:99]
    s_add_u32 m0, s42, 50176
    ds_read_b64_tr_b16 a[98:99], v29 offset:512
    v_mfma_f32_16x16x32_bf16 v[60:63], a[92:95], v[80:83], v[60:63]
    ds_read_b64_tr_b16 a[100:101], v30 offset:0
    v_mfma_f32_16x16x32_bf16 v[64:67], a[92:95], v[84:87], v[64:67]
    buffer_load_dwordx4 v21, s[12:15], s54 offen lds
    v_mfma_f32_16x16x32_bf16 v[118:121], a[92:95], v[88:91], v[118:121]
    s_add_u32 m0, s42, 57344
    ds_read_b64_tr_b16 a[102:103], v30 offset:512
    v_mfma_f32_16x16x32_bf16 v[100:103], a[84:87], v[32:35], v[100:103]
    buffer_load_dwordx4 v22, s[12:15], s54 offen lds
    v_mfma_f32_16x16x32_bf16 v[104:107], a[88:91], v[32:35], v[104:107]
    ds_read_b64_tr_b16 a[104:105], v31 offset:0
    v_mfma_f32_16x16x32_bf16 v[108:111], a[92:95], v[32:35], v[108:111]
    ds_read_b64_tr_b16 a[106:107], v31 offset:512
    s_waitcnt lgkmcnt(4)
    v_mfma_f32_16x16x32_bf16 v[44:47], a[96:99], v[68:71], v[44:47]
    s_add_u32 m0, s42, 58368
    ds_read_b128 v[80:83], v5 offset:16384
    v_mfma_f32_16x16x32_bf16 v[48:51], a[96:99], v[72:75], v[48:51]
    ds_read_b128 v[84:87], v5 offset:18432
    v_mfma_f32_16x16x32_bf16 v[92:95], a[96:99], v[76:79], v[92:95]
    ds_read_b128 v[88:91], v5 offset:40960
    s_waitcnt lgkmcnt(5)
    v_mfma_f32_16x16x32_bf16 v[52:55], a[100:103], v[68:71], v[52:55]
    ds_read_b64_tr_b16 a[108:109], v29 offset:4096
    v_mfma_f32_16x16x32_bf16 v[56:59], a[100:103], v[72:75], v[56:59]
    ds_read_b64_tr_b16 a[110:111], v29 offset:4608
    v_mfma_f32_16x16x32_bf16 v[96:99], a[100:103], v[76:79], v[96:99]
    ds_read_b64_tr_b16 a[112:113], v30 offset:4096
    s_waitcnt lgkmcnt(6)
    v_mfma_f32_16x16x32_bf16 v[60:63], a[104:107], v[68:71], v[60:63]
    ds_read_b64_tr_b16 a[114:115], v30 offset:4608
    v_mfma_f32_16x16x32_bf16 v[64:67], a[104:107], v[72:75], v[64:67]
    ds_read_b64_tr_b16 a[116:117], v31 offset:4096
    v_mfma_f32_16x16x32_bf16 v[118:121], a[104:107], v[76:79], v[118:121]
    ds_read_b64_tr_b16 a[118:119], v31 offset:4608
    v_mfma_f32_16x16x32_bf16 v[100:103], a[96:99], v[32:35], v[100:103]
    buffer_load_dwordx4 v23, s[12:15], s54 offen lds
    v_mfma_f32_16x16x32_bf16 v[104:107], a[100:103], v[32:35], v[104:107]
    s_add_u32 m0, s42, 65536
    s_nop 0
    buffer_load_dwordx4 v24, s[12:15], s54 offen lds
    v_mfma_f32_16x16x32_bf16 v[108:111], a[104:107], v[32:35], v[108:111]
    s_add_u32 m0, s42, 66560
    s_nop 0
    buffer_load_dwordx4 v25, s[12:15], s54 offen lds
    s_add_u32 s54, s54, 393216
    s_waitcnt vmcnt(15) lgkmcnt(0)
    s_barrier
    v_mfma_f32_16x16x32_bf16 v[44:47], a[108:111], v[80:83], v[44:47]
    s_add_u32 m0, s43, 146432
    ds_read_b128 v[68:71], v4 offset:20480
    ds_read_b128 v[72:75], v4 offset:22528
    v_mfma_f32_16x16x32_bf16 v[48:51], a[108:111], v[84:87], v[48:51]
    ds_read_b128 v[76:79], v4 offset:43008
    ds_read_b64_tr_b16 a[120:121], v26 offset:0
    v_mfma_f32_16x16x32_bf16 v[92:95], a[108:111], v[88:91], v[92:95]
    buffer_load_dwordx4 v6, s[8:11], s53 offen offset:1024 sc1 lds
    v_mfma_f32_16x16x32_bf16 v[52:55], a[112:115], v[80:83], v[52:55]
    s_add_u32 m0, s43, 97280
    ds_read_b64_tr_b16 a[122:123], v26 offset:512
    v_mfma_f32_16x16x32_bf16 v[56:59], a[112:115], v[84:87], v[56:59]
    buffer_load_dwordx4 v6, s[8:11], s41 offen offset:1024 sc1 lds
    v_mfma_f32_16x16x32_bf16 v[96:99], a[112:115], v[88:91], v[96:99]
    s_add_u32 m0, s42, 73728
    ds_read_b64_tr_b16 a[124:125], v27 offset:0
    v_mfma_f32_16x16x32_bf16 v[60:63], a[116:119], v[80:83], v[60:63]
    ds_read_b64_tr_b16 a[126:127], v27 offset:512
    v_mfma_f32_16x16x32_bf16 v[64:67], a[116:119], v[84:87], v[64:67]
    buffer_load_dwordx4 v20, s[12:15], s54 offen lds
    v_mfma_f32_16x16x32_bf16 v[118:121], a[116:119], v[88:91], v[118:121]
    s_add_u32 m0, s42, 74752
    ds_read_b64_tr_b16 a[128:129], v28 offset:0
    v_mfma_f32_16x16x32_bf16 v[100:103], a[108:111], v[32:35], v[100:103]
    buffer_load_dwordx4 v21, s[12:15], s54 offen lds
    v_mfma_f32_16x16x32_bf16 v[104:107], a[112:115], v[32:35], v[104:107]
    s_add_u32 m0, s42, 81920
    ds_read_b64_tr_b16 a[130:131], v28 offset:512
    v_mfma_f32_16x16x32_bf16 v[108:111], a[116:119], v[32:35], v[108:111]
    buffer_load_dwordx4 v22, s[12:15], s54 offen lds
    s_waitcnt lgkmcnt(4)
    v_mfma_f32_16x16x32_bf16 v[44:47], a[120:123], v[68:71], v[44:47]
    s_add_u32 m0, s42, 82944
    ds_read_b128 v[80:83], v5 offset:20480
    v_mfma_f32_16x16x32_bf16 v[48:51], a[120:123], v[72:75], v[48:51]
    ds_read_b128 v[84:87], v5 offset:22528
    v_mfma_f32_16x16x32_bf16 v[92:95], a[120:123], v[76:79], v[92:95]
    ds_read_b128 v[88:91], v5 offset:43008
    s_waitcnt lgkmcnt(5)
    v_mfma_f32_16x16x32_bf16 v[52:55], a[124:127], v[68:71], v[52:55]
    ds_read_b64_tr_b16 a[132:133], v26 offset:4096
    v_mfma_f32_16x16x32_bf16 v[56:59], a[124:127], v[72:75], v[56:59]
    ds_read_b64_tr_b16 a[134:135], v26 offset:4608
    v_mfma_f32_16x16x32_bf16 v[96:99], a[124:127], v[76:79], v[96:99]
    ds_read_b64_tr_b16 a[136:137], v27 offset:4096
    s_waitcnt lgkmcnt(6)
    v_mfma_f32_16x16x32_bf16 v[60:63], a[128:131], v[68:71], v[60:63]
    ds_read_b64_tr_b16 a[138:139], v27 offset:4608
    v_mfma_f32_16x16x32_bf16 v[64:67], a[128:131], v[72:75], v[64:67]
    ds_read_b64_tr_b16 a[140:141], v28 offset:4096
    v_mfma_f32_16x16x32_bf16 v[118:121], a[128:131], v[76:79], v[118:121]
    ds_read_b64_tr_b16 a[142:143], v28 offset:4608
    v_mfma_f32_16x16x32_bf16 v[100:103], a[120:123], v[32:35], v[100:103]
    buffer_load_dwordx4 v23, s[12:15], s54 offen lds
    v_mfma_f32_16x16x32_bf16 v[104:107], a[124:127], v[32:35], v[104:107]
    s_add_u32 m0, s42, 90112
    s_nop 0
    buffer_load_dwordx4 v24, s[12:15], s54 offen lds
    v_mfma_f32_16x16x32_bf16 v[108:111], a[128:131], v[32:35], v[108:111]
    s_add_u32 m0, s42, 91136
    s_nop 0
    buffer_load_dwordx4 v25, s[12:15], s54 offen lds
    s_add_u32 s54, s54, 393216
    s_waitcnt vmcnt(15) lgkmcnt(0)
    s_barrier
    v_mfma_f32_16x16x32_bf16 v[44:47], a[132:135], v[80:83], v[44:47]
    s_add_u32 m0, s43, 101248
    ds_read_b128 v[68:71], v4 offset:24576
    ds_read_b128 v[72:75], v4 offset:26624
    v_mfma_f32_16x16x32_bf16 v[48:51], a[132:135], v[84:87], v[48:51]
    ds_read_b128 v[76:79], v4 offset:45056
    v_mfma_f32_16x16x32_bf16 v[92:95], a[132:135], v[88:91], v[92:95]
    buffer_load_dwordx4 v6, s[8:11], s41 offen offset:1152 sc1 lds
    v_mfma_f32_16x16x32_bf16 v[52:55], a[136:139], v[80:83], v[52:55]
    s_add_u32 m0, s42, 0
    ds_read_b64_tr_b16 a[144:145], v26 offset:24576
    v_mfma_f32_16x16x32_bf16 v[56:59], a[136:139], v[84:87], v[56:59]
    buffer_load_dwordx4 v20, s[12:15], s54 offen lds
    v_mfma_f32_16x16x32_bf16 v[96:99], a[136:139], v[88:91], v[96:99]
    s_add_u32 m0, s42, 1024
    ds_read_b64_tr_b16 a[146:147], v26 offset:25088
    v_mfma_f32_16x16x32_bf16 v[60:63], a[140:143], v[80:83], v[60:63]
    ds_read_b64_tr_b16 a[148:149], v27 offset:24576
    v_mfma_f32_16x16x32_bf16 v[64:67], a[140:143], v[84:87], v[64:67]
    buffer_load_dwordx4 v21, s[12:15], s54 offen lds
    v_mfma_f32_16x16x32_bf16 v[118:121], a[140:143], v[88:91], v[118:121]
    s_add_u32 m0, s42, 8192
    ds_read_b64_tr_b16 a[150:151], v27 offset:25088
    v_mfma_f32_16x16x32_bf16 v[100:103], a[132:135], v[32:35], v[100:103]
    buffer_load_dwordx4 v22, s[12:15], s54 offen lds
    v_mfma_f32_16x16x32_bf16 v[104:107], a[136:139], v[32:35], v[104:107]
    ds_read_b64_tr_b16 a[152:153], v28 offset:24576
    v_mfma_f32_16x16x32_bf16 v[108:111], a[140:143], v[32:35], v[108:111]
    ds_read_b64_tr_b16 a[154:155], v28 offset:25088
    s_waitcnt lgkmcnt(4)
    v_mfma_f32_16x16x32_bf16 v[44:47], a[144:147], v[68:71], v[44:47]
    s_add_u32 m0, s42, 9216
    ds_read_b128 v[80:83], v5 offset:24576
    v_mfma_f32_16x16x32_bf16 v[48:51], a[144:147], v[72:75], v[48:51]
    ds_read_b128 v[84:87], v5 offset:26624
    v_mfma_f32_16x16x32_bf16 v[92:95], a[144:147], v[76:79], v[92:95]
    ds_read_b128 v[88:91], v5 offset:45056
    s_waitcnt lgkmcnt(5)
    v_mfma_f32_16x16x32_bf16 v[52:55], a[148:151], v[68:71], v[52:55]
    ds_read_b64_tr_b16 a[156:157], v26 offset:28672
    v_mfma_f32_16x16x32_bf16 v[56:59], a[148:151], v[72:75], v[56:59]
    ds_read_b64_tr_b16 a[158:159], v26 offset:29184
    v_mfma_f32_16x16x32_bf16 v[96:99], a[148:151], v[76:79], v[96:99]
    ds_read_b64_tr_b16 a[160:161], v27 offset:28672
    s_waitcnt lgkmcnt(6)
    v_mfma_f32_16x16x32_bf16 v[60:63], a[152:155], v[68:71], v[60:63]
    ds_read_b64_tr_b16 a[162:163], v27 offset:29184
    v_mfma_f32_16x16x32_bf16 v[64:67], a[152:155], v[72:75], v[64:67]
    ds_read_b64_tr_b16 a[164:165], v28 offset:28672
    v_mfma_f32_16x16x32_bf16 v[118:121], a[152:155], v[76:79], v[118:121]
    ds_read_b64_tr_b16 a[166:167], v28 offset:29184
    v_mfma_f32_16x16x32_bf16 v[100:103], a[144:147], v[32:35], v[100:103]
    buffer_load_dwordx4 v23, s[12:15], s54 offen lds
    v_mfma_f32_16x16x32_bf16 v[104:107], a[148:151], v[32:35], v[104:107]
    s_add_u32 m0, s42, 16384
    s_nop 0
    buffer_load_dwordx4 v24, s[12:15], s54 offen lds
    v_mfma_f32_16x16x32_bf16 v[108:111], a[152:155], v[32:35], v[108:111]
    s_add_u32 m0, s42, 17408
    s_nop 0
    buffer_load_dwordx4 v25, s[12:15], s54 offen lds
    s_add_u32 s54, s54, 393216
    s_waitcnt vmcnt(15) lgkmcnt(0)
    s_barrier
    v_mfma_f32_16x16x32_bf16 v[44:47], a[156:159], v[80:83], v[44:47]
    s_add_u32 m0, s43, 150272
    ds_read_b128 v[68:71], v4 offset:28672
    ds_read_b128 v[72:75], v4 offset:30720
    v_mfma_f32_16x16x32_bf16 v[48:51], a[156:159], v[84:87], v[48:51]
    ds_read_b128 v[76:79], v4 offset:47104
    ds_read_b64_tr_b16 a[168:169], v26 offset:49152
    v_mfma_f32_16x16x32_bf16 v[92:95], a[156:159], v[88:91], v[92:95]
    buffer_load_dwordx4 v6, s[8:11], s53 offen offset:1280 sc1 lds
    v_mfma_f32_16x16x32_bf16 v[52:55], a[160:163], v[80:83], v[52:55]
    s_add_u32 m0, s43, 105216
    ds_read_b64_tr_b16 a[170:171], v26 offset:49664
    v_mfma_f32_16x16x32_bf16 v[56:59], a[160:163], v[84:87], v[56:59]
    buffer_load_dwordx4 v6, s[8:11], s41 offen offset:1280 sc1 lds
    v_mfma_f32_16x16x32_bf16 v[96:99], a[160:163], v[88:91], v[96:99]
    s_add_u32 m0, s42, 24576
    ds_read_b64_tr_b16 a[172:173], v27 offset:49152
    v_mfma_f32_16x16x32_bf16 v[60:63], a[164:167], v[80:83], v[60:63]
    ds_read_b64_tr_b16 a[174:175], v27 offset:49664
    v_mfma_f32_16x16x32_bf16 v[64:67], a[164:167], v[84:87], v[64:67]
    buffer_load_dwordx4 v20, s[12:15], s54 offen lds
    v_mfma_f32_16x16x32_bf16 v[118:121], a[164:167], v[88:91], v[118:121]
    s_add_u32 m0, s42, 25600
    ds_read_b64_tr_b16 a[176:177], v28 offset:49152
    v_mfma_f32_16x16x32_bf16 v[100:103], a[156:159], v[32:35], v[100:103]
    buffer_load_dwordx4 v21, s[12:15], s54 offen lds
    v_mfma_f32_16x16x32_bf16 v[104:107], a[160:163], v[32:35], v[104:107]
    s_add_u32 m0, s42, 32768
    ds_read_b64_tr_b16 a[178:179], v28 offset:49664
    v_mfma_f32_16x16x32_bf16 v[108:111], a[164:167], v[32:35], v[108:111]
    buffer_load_dwordx4 v22, s[12:15], s54 offen lds
    s_waitcnt lgkmcnt(4)
    v_mfma_f32_16x16x32_bf16 v[44:47], a[168:171], v[68:71], v[44:47]
    s_add_u32 m0, s42, 33792
    ds_read_b128 v[80:83], v5 offset:28672
    v_mfma_f32_16x16x32_bf16 v[48:51], a[168:171], v[72:75], v[48:51]
    ds_read_b128 v[84:87], v5 offset:30720
    v_mfma_f32_16x16x32_bf16 v[92:95], a[168:171], v[76:79], v[92:95]
    ds_read_b128 v[88:91], v5 offset:47104
    s_waitcnt lgkmcnt(5)
    v_mfma_f32_16x16x32_bf16 v[52:55], a[172:175], v[68:71], v[52:55]
    ds_read_b64_tr_b16 a[180:181], v26 offset:53248
    v_mfma_f32_16x16x32_bf16 v[56:59], a[172:175], v[72:75], v[56:59]
    ds_read_b64_tr_b16 a[182:183], v26 offset:53760
    v_mfma_f32_16x16x32_bf16 v[96:99], a[172:175], v[76:79], v[96:99]
    ds_read_b64_tr_b16 a[184:185], v27 offset:53248
    s_waitcnt lgkmcnt(6)
    v_mfma_f32_16x16x32_bf16 v[60:63], a[176:179], v[68:71], v[60:63]
    ds_read_b64_tr_b16 a[186:187], v27 offset:53760
    v_mfma_f32_16x16x32_bf16 v[64:67], a[176:179], v[72:75], v[64:67]
    ds_read_b64_tr_b16 a[188:189], v28 offset:53248
    v_mfma_f32_16x16x32_bf16 v[118:121], a[176:179], v[76:79], v[118:121]
    ds_read_b64_tr_b16 a[190:191], v28 offset:53760
    v_mfma_f32_16x16x32_bf16 v[100:103], a[168:171], v[32:35], v[100:103]
    buffer_load_dwordx4 v23, s[12:15], s54 offen lds
    v_mfma_f32_16x16x32_bf16 v[104:107], a[172:175], v[32:35], v[104:107]
    s_add_u32 m0, s42, 40960
    s_nop 0
    buffer_load_dwordx4 v24, s[12:15], s54 offen lds
    v_mfma_f32_16x16x32_bf16 v[108:111], a[176:179], v[32:35], v[108:111]
    s_add_u32 m0, s42, 41984
    s_nop 0
    buffer_load_dwordx4 v25, s[12:15], s54 offen lds
    s_add_u32 s54, s54, 393216
    s_waitcnt vmcnt(15) lgkmcnt(0)
    s_barrier
    v_mfma_f32_16x16x32_bf16 v[44:47], a[180:183], v[80:83], v[44:47]
    ds_read_b128 v[68:71], v4 offset:0
    ds_read_b128 v[72:75], v4 offset:2048
    v_mfma_f32_16x16x32_bf16 v[48:51], a[180:183], v[84:87], v[48:51]
    ds_read_b128 v[76:79], v4 offset:49152
    ds_read_b64_tr_b16 a[192:193], v29 offset:0
    v_mfma_f32_16x16x32_bf16 v[92:95], a[180:183], v[88:91], v[92:95]
    buffer_load_dword v38, v124, s[20:23], 0 offen offset:32 sc1
    v_mfma_f32_16x16x32_bf16 v[52:55], a[184:187], v[80:83], v[52:55]
    s_add_u32 m0, s43, 109184
    ds_read_b64_tr_b16 a[194:195], v29 offset:512
    v_mfma_f32_16x16x32_bf16 v[56:59], a[184:187], v[84:87], v[56:59]
    buffer_load_dwordx4 v6, s[8:11], s41 offen offset:1408 sc1 lds
    v_mfma_f32_16x16x32_bf16 v[96:99], a[184:187], v[88:91], v[96:99]
    s_add_u32 m0, s42, 49152
    ds_read_b64_tr_b16 a[196:197], v30 offset:0
    v_mfma_f32_16x16x32_bf16 v[60:63], a[188:191], v[80:83], v[60:63]
    ds_read_b64_tr_b16 a[198:199], v30 offset:512
    v_mfma_f32_16x16x32_bf16 v[64:67], a[188:191], v[84:87], v[64:67]
    buffer_load_dwordx4 v20, s[12:15], s54 offen lds
    v_mfma_f32_16x16x32_bf16 v[118:121], a[188:191], v[88:91], v[118:121]
    s_add_u32 m0, s42, 50176
    ds_read_b64_tr_b16 a[200:201], v31 offset:0
    v_mfma_f32_16x16x32_bf16 v[100:103], a[180:183], v[32:35], v[100:103]
    buffer_load_dwordx4 v21, s[12:15], s54 offen lds
    v_mfma_f32_16x16x32_bf16 v[104:107], a[184:187], v[32:35], v[104:107]
    s_add_u32 m0, s42, 57344
    ds_read_b64_tr_b16 a[202:203], v31 offset:512
    v_mfma_f32_16x16x32_bf16 v[108:111], a[188:191], v[32:35], v[108:111]
    buffer_load_dwordx4 v22, s[12:15], s54 offen lds
    s_waitcnt lgkmcnt(4)
    v_mfma_f32_16x16x32_bf16 v[44:47], a[192:195], v[68:71], v[44:47]
    s_add_u32 m0, s42, 58368
    ds_read_b128 v[80:83], v5 offset:0
    v_mfma_f32_16x16x32_bf16 v[48:51], a[192:195], v[72:75], v[48:51]
    ds_read_b128 v[84:87], v5 offset:2048
    v_mfma_f32_16x16x32_bf16 v[92:95], a[192:195], v[76:79], v[92:95]
    ds_read_b128 v[88:91], v5 offset:49152
    s_waitcnt lgkmcnt(5)
    v_mfma_f32_16x16x32_bf16 v[52:55], a[196:199], v[68:71], v[52:55]
    ds_read_b64_tr_b16 a[204:205], v29 offset:4096
    v_mfma_f32_16x16x32_bf16 v[56:59], a[196:199], v[72:75], v[56:59]
    ds_read_b64_tr_b16 a[206:207], v29 offset:4608
    v_mfma_f32_16x16x32_bf16 v[96:99], a[196:199], v[76:79], v[96:99]
    ds_read_b64_tr_b16 a[208:209], v30 offset:4096
    s_waitcnt lgkmcnt(6)
    v_mfma_f32_16x16x32_bf16 v[60:63], a[200:203], v[68:71], v[60:63]
    ds_read_b64_tr_b16 a[210:211], v30 offset:4608
    v_mfma_f32_16x16x32_bf16 v[64:67], a[200:203], v[72:75], v[64:67]
    ds_read_b64_tr_b16 a[212:213], v31 offset:4096
    v_mfma_f32_16x16x32_bf16 v[118:121], a[200:203], v[76:79], v[118:121]
    ds_read_b64_tr_b16 a[214:215], v31 offset:4608
    v_mfma_f32_16x16x32_bf16 v[100:103], a[192:195], v[32:35], v[100:103]
    buffer_load_dwordx4 v23, s[12:15], s54 offen lds
    v_mfma_f32_16x16x32_bf16 v[104:107], a[196:199], v[32:35], v[104:107]
    s_add_u32 m0, s42, 65536
    s_nop 0
    buffer_load_dwordx4 v24, s[12:15], s54 offen lds
    v_mfma_f32_16x16x32_bf16 v[108:111], a[200:203], v[32:35], v[108:111]
    s_add_u32 m0, s42, 66560
    s_nop 0
    buffer_load_dwordx4 v25, s[12:15], s54 offen lds
    s_add_u32 s54, s54, 393216
    s_waitcnt vmcnt(16) lgkmcnt(0)
    s_barrier
    v_mfma_f32_16x16x32_bf16 v[44:47], a[204:207], v[80:83], v[44:47]
    s_add_u32 m0, s43, 154112
    ds_read_b128 v[68:71], v4 offset:4096
    ds_read_b128 v[72:75], v4 offset:6144
    v_mfma_f32_16x16x32_bf16 v[48:51], a[204:207], v[84:87], v[48:51]
    ds_read_b128 v[76:79], v4 offset:51200
    ds_read_b64_tr_b16 a[216:217], v26 offset:0
    v_mfma_f32_16x16x32_bf16 v[92:95], a[204:207], v[88:91], v[92:95]
    buffer_load_dwordx4 v6, s[8:11], s53 offen offset:1536 sc1 lds
    v_mfma_f32_16x16x32_bf16 v[52:55], a[208:211], v[80:83], v[52:55]
    s_add_u32 m0, s43, 113152
    ds_read_b64_tr_b16 a[218:219], v26 offset:512
    v_mfma_f32_16x16x32_bf16 v[56:59], a[208:211], v[84:87], v[56:59]
    buffer_load_dwordx4 v6, s[8:11], s41 offen offset:1536 sc1 lds
    v_mfma_f32_16x16x32_bf16 v[96:99], a[208:211], v[88:91], v[96:99]
    s_add_u32 m0, s42, 73728
    ds_read_b64_tr_b16 a[220:221], v27 offset:0
    v_mfma_f32_16x16x32_bf16 v[60:63], a[212:215], v[80:83], v[60:63]
    ds_read_b64_tr_b16 a[222:223], v27 offset:512
    v_mfma_f32_16x16x32_bf16 v[64:67], a[212:215], v[84:87], v[64:67]
    buffer_load_dwordx4 v20, s[12:15], s54 offen lds
    v_mfma_f32_16x16x32_bf16 v[118:121], a[212:215], v[88:91], v[118:121]
    s_add_u32 m0, s42, 74752
    ds_read_b64_tr_b16 a[224:225], v28 offset:0
    v_mfma_f32_16x16x32_bf16 v[100:103], a[204:207], v[32:35], v[100:103]
    buffer_load_dwordx4 v21, s[12:15], s54 offen lds
    v_mfma_f32_16x16x32_bf16 v[104:107], a[208:211], v[32:35], v[104:107]
    s_add_u32 m0, s42, 81920
    ds_read_b64_tr_b16 a[226:227], v28 offset:512
    v_mfma_f32_16x16x32_bf16 v[108:111], a[212:215], v[32:35], v[108:111]
    buffer_load_dwordx4 v22, s[12:15], s54 offen lds
    s_waitcnt lgkmcnt(4)
    v_mfma_f32_16x16x32_bf16 v[44:47], a[216:219], v[68:71], v[44:47]
    s_add_u32 m0, s42, 82944
    ds_read_b128 v[80:83], v5 offset:4096
    v_mfma_f32_16x16x32_bf16 v[48:51], a[216:219], v[72:75], v[48:51]
    ds_read_b128 v[84:87], v5 offset:6144
    v_mfma_f32_16x16x32_bf16 v[92:95], a[216:219], v[76:79], v[92:95]
    ds_read_b128 v[88:91], v5 offset:51200
    s_waitcnt lgkmcnt(5)
    v_mfma_f32_16x16x32_bf16 v[52:55], a[220:223], v[68:71], v[52:55]
    ds_read_b64_tr_b16 a[228:229], v26 offset:4096
    v_mfma_f32_16x16x32_bf16 v[56:59], a[220:223], v[72:75], v[56:59]
    ds_read_b64_tr_b16 a[230:231], v26 offset:4608
    v_mfma_f32_16x16x32_bf16 v[96:99], a[220:223], v[76:79], v[96:99]
    ds_read_b64_tr_b16 a[232:233], v27 offset:4096
    s_waitcnt lgkmcnt(6)
    v_mfma_f32_16x16x32_bf16 v[60:63], a[224:227], v[68:71], v[60:63]
    ds_read_b64_tr_b16 a[234:235], v27 offset:4608
    v_mfma_f32_16x16x32_bf16 v[64:67], a[224:227], v[72:75], v[64:67]
    ds_read_b64_tr_b16 a[236:237], v28 offset:4096
    v_mfma_f32_16x16x32_bf16 v[118:121], a[224:227], v[76:79], v[118:121]
    ds_read_b64_tr_b16 a[238:239], v28 offset:4608
    v_mfma_f32_16x16x32_bf16 v[100:103], a[216:219], v[32:35], v[100:103]
    buffer_load_dwordx4 v23, s[12:15], s54 offen lds
    v_mfma_f32_16x16x32_bf16 v[104:107], a[220:223], v[32:35], v[104:107]
    s_add_u32 m0, s42, 90112
    s_nop 0
    buffer_load_dwordx4 v24, s[12:15], s54 offen lds
    v_mfma_f32_16x16x32_bf16 v[108:111], a[224:227], v[32:35], v[108:111]
    s_add_u32 m0, s42, 91136
    s_nop 0
    buffer_load_dwordx4 v25, s[12:15], s54 offen lds
    s_add_u32 s54, s54, 393216
    s_waitcnt vmcnt(16) lgkmcnt(0)
    s_barrier
    v_mfma_f32_16x16x32_bf16 v[44:47], a[228:231], v[80:83], v[44:47]
    s_add_u32 m0, s43, 117120
    ds_read_b128 v[68:71], v4 offset:8192
    ds_read_b128 v[72:75], v4 offset:10240
    v_mfma_f32_16x16x32_bf16 v[48:51], a[228:231], v[84:87], v[48:51]
    ds_read_b128 v[76:79], v4 offset:53248
    v_mfma_f32_16x16x32_bf16 v[92:95], a[228:231], v[88:91], v[92:95]
    buffer_load_dwordx4 v6, s[8:11], s41 offen offset:1664 sc1 lds
    v_mfma_f32_16x16x32_bf16 v[52:55], a[232:235], v[80:83], v[52:55]
    s_add_u32 m0, s42, 0
    ds_read_b64_tr_b16 a[240:241], v26 offset:24576
    v_mfma_f32_16x16x32_bf16 v[56:59], a[232:235], v[84:87], v[56:59]
    buffer_load_dwordx4 v20, s[12:15], s54 offen lds
    v_mfma_f32_16x16x32_bf16 v[96:99], a[232:235], v[88:91], v[96:99]
    s_add_u32 m0, s42, 1024
    ds_read_b64_tr_b16 a[242:243], v26 offset:25088
    v_mfma_f32_16x16x32_bf16 v[60:63], a[236:239], v[80:83], v[60:63]
    ds_read_b64_tr_b16 a[244:245], v27 offset:24576
    v_mfma_f32_16x16x32_bf16 v[64:67], a[236:239], v[84:87], v[64:67]
    buffer_load_dwordx4 v21, s[12:15], s54 offen lds
    v_mfma_f32_16x16x32_bf16 v[118:121], a[236:239], v[88:91], v[118:121]
    s_add_u32 m0, s42, 8192
    ds_read_b64_tr_b16 a[246:247], v27 offset:25088
    v_mfma_f32_16x16x32_bf16 v[100:103], a[228:231], v[32:35], v[100:103]
    buffer_load_dwordx4 v22, s[12:15], s54 offen lds
    v_mfma_f32_16x16x32_bf16 v[104:107], a[232:235], v[32:35], v[104:107]
    ds_read_b64_tr_b16 a[248:249], v28 offset:24576
    v_mfma_f32_16x16x32_bf16 v[108:111], a[236:239], v[32:35], v[108:111]
    ds_read_b64_tr_b16 a[250:251], v28 offset:25088
    s_waitcnt lgkmcnt(4)
    v_mfma_f32_16x16x32_bf16 v[44:47], a[240:243], v[68:71], v[44:47]
    s_add_u32 m0, s42, 9216
    ds_read_b128 v[80:83], v5 offset:8192
    v_mfma_f32_16x16x32_bf16 v[48:51], a[240:243], v[72:75], v[48:51]
    ds_read_b128 v[84:87], v5 offset:10240
    v_mfma_f32_16x16x32_bf16 v[92:95], a[240:243], v[76:79], v[92:95]
    ds_read_b128 v[88:91], v5 offset:53248
    s_waitcnt lgkmcnt(5)
    v_mfma_f32_16x16x32_bf16 v[52:55], a[244:247], v[68:71], v[52:55]
    ds_read_b64_tr_b16 a[252:253], v26 offset:28672
    v_mfma_f32_16x16x32_bf16 v[56:59], a[244:247], v[72:75], v[56:59]
    ds_read_b64_tr_b16 a[254:255], v26 offset:29184
    v_mfma_f32_16x16x32_bf16 v[96:99], a[244:247], v[76:79], v[96:99]
    ds_read_b64_tr_b16 v[128:129], v27 offset:28672
    s_waitcnt lgkmcnt(6)
    v_mfma_f32_16x16x32_bf16 v[60:63], a[248:251], v[68:71], v[60:63]
    ds_read_b64_tr_b16 v[130:131], v27 offset:29184
    v_mfma_f32_16x16x32_bf16 v[64:67], a[248:251], v[72:75], v[64:67]
    ds_read_b64_tr_b16 v[132:133], v28 offset:28672
    v_mfma_f32_16x16x32_bf16 v[118:121], a[248:251], v[76:79], v[118:121]
    ds_read_b64_tr_b16 v[134:135], v28 offset:29184
    v_mfma_f32_16x16x32_bf16 v[100:103], a[240:243], v[32:35], v[100:103]
    buffer_load_dwordx4 v23, s[12:15], s54 offen lds
    v_mfma_f32_16x16x32_bf16 v[104:107], a[244:247], v[32:35], v[104:107]
    s_add_u32 m0, s42, 16384
    s_nop 0
    buffer_load_dwordx4 v24, s[12:15], s54 offen lds
    v_mfma_f32_16x16x32_bf16 v[108:111], a[248:251], v[32:35], v[108:111]
    s_add_u32 m0, s42, 17408
    s_nop 0
    buffer_load_dwordx4 v25, s[12:15], s54 offen lds
    s_add_u32 s54, s54, 393216
    s_waitcnt vmcnt(15) lgkmcnt(0)
    s_barrier
    v_mfma_f32_16x16x32_bf16 v[44:47], a[252:255], v[80:83], v[44:47]
    buffer_load_dword v37, v36, s[20:23], 64 offen sc1
    v_mfma_f32_16x16x32_bf16 v[48:51], a[252:255], v[84:87], v[48:51]
    s_add_u32 m0, s43, 157952
    ds_read_b128 v[68:71], v4 offset:12288
    ds_read_b128 v[72:75], v4 offset:14336
    v_mfma_f32_16x16x32_bf16 v[92:95], a[252:255], v[88:91], v[92:95]
    buffer_load_dwordx4 v6, s[8:11], s53 offen offset:1792 sc1 lds
    v_mfma_f32_16x16x32_bf16 v[52:55], v[128:131], v[80:83], v[52:55]
    s_add_u32 m0, s43, 121088
    ds_read_b128 v[76:79], v4 offset:55296
    ds_read_b64_tr_b16 v[136:137], v26 offset:49152
    v_mfma_f32_16x16x32_bf16 v[56:59], v[128:131], v[84:87], v[56:59]
    buffer_load_dwordx4 v6, s[8:11], s41 offen offset:1792 sc1 lds
    v_mfma_f32_16x16x32_bf16 v[96:99], v[128:131], v[88:91], v[96:99]
    s_add_u32 m0, s42, 24576
    ds_read_b64_tr_b16 v[138:139], v26 offset:49664
    ds_read_b64_tr_b16 v[140:141], v27 offset:49152
    v_mfma_f32_16x16x32_bf16 v[60:63], v[132:135], v[80:83], v[60:63]
    ds_read_b64_tr_b16 v[142:143], v27 offset:49664
    v_mfma_f32_16x16x32_bf16 v[64:67], v[132:135], v[84:87], v[64:67]
    buffer_load_dwordx4 v20, s[12:15], s54 offen lds
    v_mfma_f32_16x16x32_bf16 v[118:121], v[132:135], v[88:91], v[118:121]
    s_add_u32 m0, s42, 25600
    ds_read_b64_tr_b16 v[144:145], v28 offset:49152
    v_mfma_f32_16x16x32_bf16 v[100:103], a[252:255], v[32:35], v[100:103]
    buffer_load_dwordx4 v21, s[12:15], s54 offen lds
    v_mfma_f32_16x16x32_bf16 v[104:107], v[128:131], v[32:35], v[104:107]
    s_add_u32 m0, s42, 32768
    ds_read_b64_tr_b16 v[146:147], v28 offset:49664
    v_mfma_f32_16x16x32_bf16 v[108:111], v[132:135], v[32:35], v[108:111]
    buffer_load_dwordx4 v22, s[12:15], s54 offen lds
    s_waitcnt lgkmcnt(4)
    v_mfma_f32_16x16x32_bf16 v[44:47], v[136:139], v[68:71], v[44:47]
    s_add_u32 m0, s42, 33792
    ds_read_b128 v[80:83], v5 offset:12288
    v_mfma_f32_16x16x32_bf16 v[48:51], v[136:139], v[72:75], v[48:51]
    ds_read_b128 v[84:87], v5 offset:14336
    v_mfma_f32_16x16x32_bf16 v[92:95], v[136:139], v[76:79], v[92:95]
    ds_read_b128 v[88:91], v5 offset:55296
    s_waitcnt lgkmcnt(5)
    v_mfma_f32_16x16x32_bf16 v[52:55], v[140:143], v[68:71], v[52:55]
    ds_read_b64_tr_b16 v[148:149], v26 offset:53248
    v_mfma_f32_16x16x32_bf16 v[56:59], v[140:143], v[72:75], v[56:59]
    ds_read_b64_tr_b16 v[150:151], v26 offset:53760
    v_mfma_f32_16x16x32_bf16 v[96:99], v[140:143], v[76:79], v[96:99]
    ds_read_b64_tr_b16 v[152:153], v27 offset:53248
    s_waitcnt lgkmcnt(6)
    v_mfma_f32_16x16x32_bf16 v[60:63], v[144:147], v[68:71], v[60:63]
    ds_read_b64_tr_b16 v[154:155], v27 offset:53760
    v_mfma_f32_16x16x32_bf16 v[64:67], v[144:147], v[72:75], v[64:67]
    ds_read_b64_tr_b16 v[156:157], v28 offset:53248
    v_mfma_f32_16x16x32_bf16 v[118:121], v[144:147], v[76:79], v[118:121]
    ds_read_b64_tr_b16 v[158:159], v28 offset:53760
    v_mfma_f32_16x16x32_bf16 v[100:103], v[136:139], v[32:35], v[100:103]
    buffer_load_dwordx4 v23, s[12:15], s54 offen lds
    v_mfma_f32_16x16x32_bf16 v[104:107], v[140:143], v[32:35], v[104:107]
    s_add_u32 m0, s42, 40960
    s_nop 0
    buffer_load_dwordx4 v24, s[12:15], s54 offen lds
    v_mfma_f32_16x16x32_bf16 v[108:111], v[144:147], v[32:35], v[108:111]
    s_add_u32 m0, s42, 41984
    s_nop 0
    buffer_load_dwordx4 v25, s[12:15], s54 offen lds
    s_add_u32 s54, s54, 393216
    s_waitcnt vmcnt(16) lgkmcnt(0)
    s_barrier
    v_mfma_f32_16x16x32_bf16 v[44:47], v[148:151], v[80:83], v[44:47]
    s_add_u32 m0, s43, 125056
    ds_read_b128 v[68:71], v4 offset:16384
    ds_read_b128 v[72:75], v4 offset:18432
    v_mfma_f32_16x16x32_bf16 v[48:51], v[148:151], v[84:87], v[48:51]
    ds_read_b128 v[76:79], v4 offset:57344
    v_mfma_f32_16x16x32_bf16 v[92:95], v[148:151], v[88:91], v[92:95]
    buffer_load_dwordx4 v6, s[8:11], s41 offen offset:1920 sc1 lds
    v_mfma_f32_16x16x32_bf16 v[52:55], v[152:155], v[80:83], v[52:55]
    s_add_u32 m0, s42, 49152
    ds_read_b64_tr_b16 v[160:161], v29 offset:0
    v_mfma_f32_16x16x32_bf16 v[56:59], v[152:155], v[84:87], v[56:59]
    buffer_load_dwordx4 v20, s[12:15], s54 offen lds
    v_mfma_f32_16x16x32_bf16 v[96:99], v[152:155], v[88:91], v[96:99]
    s_add_u32 m0, s42, 50176
    ds_read_b64_tr_b16 v[162:163], v29 offset:512
    v_mfma_f32_16x16x32_bf16 v[60:63], v[156:159], v[80:83], v[60:63]
    ds_read_b64_tr_b16 v[164:165], v30 offset:0
    v_mfma_f32_16x16x32_bf16 v[64:67], v[156:159], v[84:87], v[64:67]
    buffer_load_dwordx4 v21, s[12:15], s54 offen lds
    v_mfma_f32_16x16x32_bf16 v[118:121], v[156:159], v[88:91], v[118:121]
    s_add_u32 m0, s42, 57344
    ds_read_b64_tr_b16 v[166:167], v30 offset:512
    v_mfma_f32_16x16x32_bf16 v[100:103], v[148:151], v[32:35], v[100:103]
    buffer_load_dwordx4 v22, s[12:15], s54 offen lds
    v_mfma_f32_16x16x32_bf16 v[104:107], v[152:155], v[32:35], v[104:107]
    ds_read_b64_tr_b16 v[168:169], v31 offset:0
    v_mfma_f32_16x16x32_bf16 v[108:111], v[156:159], v[32:35], v[108:111]
    ds_read_b64_tr_b16 v[170:171], v31 offset:512
    s_waitcnt lgkmcnt(4)
    v_mfma_f32_16x16x32_bf16 v[44:47], v[160:163], v[68:71], v[44:47]
    s_add_u32 m0, s42, 58368
    ds_read_b128 v[80:83], v5 offset:16384
    v_mfma_f32_16x16x32_bf16 v[48:51], v[160:163], v[72:75], v[48:51]
    ds_read_b128 v[84:87], v5 offset:18432
    v_mfma_f32_16x16x32_bf16 v[92:95], v[160:163], v[76:79], v[92:95]
    ds_read_b128 v[88:91], v5 offset:57344
    s_waitcnt lgkmcnt(5)
    v_mfma_f32_16x16x32_bf16 v[52:55], v[164:167], v[68:71], v[52:55]
    ds_read_b64_tr_b16 v[172:173], v29 offset:4096
    v_mfma_f32_16x16x32_bf16 v[56:59], v[164:167], v[72:75], v[56:59]
    ds_read_b64_tr_b16 v[174:175], v29 offset:4608
    v_mfma_f32_16x16x32_bf16 v[96:99], v[164:167], v[76:79], v[96:99]
    ds_read_b64_tr_b16 v[176:177], v30 offset:4096
    s_waitcnt lgkmcnt(6)
    v_mfma_f32_16x16x32_bf16 v[60:63], v[168:171], v[68:71], v[60:63]
    ds_read_b64_tr_b16 v[178:179], v30 offset:4608
    v_mfma_f32_16x16x32_bf16 v[64:67], v[168:171], v[72:75], v[64:67]
    ds_read_b64_tr_b16 v[180:181], v31 offset:4096
    v_mfma_f32_16x16x32_bf16 v[118:121], v[168:171], v[76:79], v[118:121]
    ds_read_b64_tr_b16 v[182:183], v31 offset:4608
    v_mfma_f32_16x16x32_bf16 v[100:103], v[160:163], v[32:35], v[100:103]
    buffer_load_dwordx4 v23, s[12:15], s54 offen lds
    v_mfma_f32_16x16x32_bf16 v[104:107], v[164:167], v[32:35], v[104:107]
    s_add_u32 m0, s42, 65536
    s_nop 0
    buffer_load_dwordx4 v24, s[12:15], s54 offen lds
    v_mfma_f32_16x16x32_bf16 v[108:111], v[168:171], v[32:35], v[108:111]
    s_add_u32 m0, s42, 66560
    s_nop 0
    buffer_load_dwordx4 v25, s[12:15], s54 offen lds
    s_add_u32 s54, s54, 393216
    s_waitcnt vmcnt(15) lgkmcnt(0)
    v_readfirstlane_b32 s37, v38
    s_nop 0
    s_cmp_lg_u32 s37, s3
    s_cbranch_scc1 L_vspin5
L_vback6:
    v_cmp_eq_u32 vcc, v36, v37
    s_cbranch_vccnz L_spin1
L_back2:
    s_barrier
    v_mfma_f32_16x16x32_bf16 v[44:47], v[172:175], v[80:83], v[44:47]
    s_lshl_b32 s53, s33, 15
    s_sub_u32 s53, 0x5418000, s53
    s_add_u32 m0, s52, 94208
    ds_read_b128 v[68:71], v4 offset:20480
    v_mfma_f32_16x16x32_bf16 v[48:51], v[172:175], v[84:87], v[48:51]
    ds_read_b128 v[72:75], v4 offset:22528
    v_mfma_f32_16x16x32_bf16 v[92:95], v[172:175], v[88:91], v[92:95]
    buffer_load_dwordx4 v1, s[16:19], s53 offen sc1 lds
    v_mfma_f32_16x16x32_bf16 v[52:55], v[176:179], v[80:83], v[52:55]
    ds_read_b128 v[76:79], v4 offset:59392
    v_mfma_f32_16x16x32_bf16 v[56:59], v[176:179], v[84:87], v[56:59]
    ds_read_b64_tr_b16 v[184:185], v26 offset:0
    v_mfma_f32_16x16x32_bf16 v[96:99], v[176:179], v[88:91], v[96:99]
    ds_read_b64_tr_b16 v[186:187], v26 offset:512
    v_mfma_f32_16x16x32_bf16 v[60:63], v[180:183], v[80:83], v[60:63]
    ds_read_b64_tr_b16 v[188:189], v27 offset:0
    v_mfma_f32_16x16x32_bf16 v[64:67], v[180:183], v[84:87], v[64:67]
    ds_read_b64_tr_b16 v[190:191], v27 offset:512
    v_mfma_f32_16x16x32_bf16 v[118:121], v[180:183], v[88:91], v[118:121]
    ds_read_b64_tr_b16 v[192:193], v28 offset:0
    v_mfma_f32_16x16x32_bf16 v[100:103], v[172:175], v[32:35], v[100:103]
    ds_read_b64_tr_b16 v[194:195], v28 offset:512
    v_mfma_f32_16x16x32_bf16 v[104:107], v[176:179], v[32:35], v[104:107]
    v_mfma_f32_16x16x32_bf16 v[108:111], v[180:183], v[32:35], v[108:111]
    s_waitcnt lgkmcnt(4)
    v_mfma_f32_16x16x32_bf16 v[44:47], v[184:187], v[68:71], v[44:47]
    s_add_u32 m0, s52, 92160
    ds_read_b128 v[80:83], v5 offset:20480
    v_mfma_f32_16x16x32_bf16 v[48:51], v[184:187], v[72:75], v[48:51]
    ds_read_b128 v[84:87], v5 offset:22528
    v_mfma_f32_16x16x32_bf16 v[92:95], v[184:187], v[76:79], v[92:95]
    ds_read_b128 v[88:91], v5 offset:59392
    s_waitcnt lgkmcnt(5)
    v_mfma_f32_16x16x32_bf16 v[52:55], v[188:191], v[68:71], v[52:55]
    ds_read_b64_tr_b16 v[196:197], v26 offset:4096
    v_mfma_f32_16x16x32_bf16 v[56:59], v[188:191], v[72:75], v[56:59]
    ds_read_b64_tr_b16 v[198:199], v26 offset:4608
    v_mfma_f32_16x16x32_bf16 v[96:99], v[188:191], v[76:79], v[96:99]
    ds_read_b64_tr_b16 v[200:201], v27 offset:4096
    s_waitcnt lgkmcnt(6)
    v_mfma_f32_16x16x32_bf16 v[60:63], v[192:195], v[68:71], v[60:63]
    ds_read_b64_tr_b16 v[202:203], v27 offset:4608
    v_mfma_f32_16x16x32_bf16 v[64:67], v[192:195], v[72:75], v[64:67]
    ds_read_b64_tr_b16 v[204:205], v28 offset:4096
    v_mfma_f32_16x16x32_bf16 v[118:121], v[192:195], v[76:79], v[118:121]
    ds_read_b64_tr_b16 v[206:207], v28 offset:4608
    v_mfma_f32_16x16x32_bf16 v[100:103], v[184:187], v[32:35], v[100:103]
    v_mfma_f32_16x16x32_bf16 v[104:107], v[188:191], v[32:35], v[104:107]
    buffer_load_dwordx4 v1, s[16:19], s46 offen sc1 lds
    v_mfma_f32_16x16x32_bf16 v[108:111], v[192:195], v[32:35], v[108:111]
    s_cmp_eq_u32 s36, s97
    s_cselect_b32 s47, 30, -2
    s_cselect_b64 s[8:9], s[88:89], s[8:9]
    s_cselect_b32 s55, 0x543fc00, s55
    s_add_u32 s50, s50, s47
    s_max_i32 s47, s50, 0
    s_min_i32 s47, s47, s96
    s_lshl_b32 s41, s47, 15
    s_lshl_b32 s46, s47, 10
    s_sub_u32 s46, s55, s46
    s_add_u32 m0, s52, 90112
    s_nop 0
    buffer_load_dwordx4 v1, s[16:19], s46 offen sc1 lds
    s_add_u32 s91, s91, 65536
    s_waitcnt vmcnt(10) lgkmcnt(0)
    s_barrier
    v_mfma_f32_16x16x32_bf16 v[44:47], v[196:199], v[80:83], v[44:47]
    ds_read_b128 v[68:71], v4 offset:24576
    ds_read_b128 v[72:75], v4 offset:26624
    v_mfma_f32_16x16x32_bf16 v[48:51], v[196:199], v[84:87], v[48:51]
    ds_read_b128 v[76:79], v4 offset:61440
    v_mfma_f32_16x16x32_bf16 v[92:95], v[196:199], v[88:91], v[92:95]
    buffer_load_dword v117, v116, s[20:23], 0 offen sc1
    v_mfma_f32_16x16x32_bf16 v[52:55], v[200:203], v[80:83], v[52:55]
    s_add_u32 m0, s43, 0
    ds_read_b64_tr_b16 v[208:209], v26 offset:24576
    v_mfma_f32_16x16x32_bf16 v[56:59], v[200:203], v[84:87], v[56:59]
    buffer_load_dwordx4 v6, s[8:11], s41 offen offset:0 sc1 lds
    v_mfma_f32_16x16x32_bf16 v[96:99], v[200:203], v[88:91], v[96:99]
    s_add_u32 m0, s43, 3968
    ds_read_b64_tr_b16 v[210:211], v26 offset:25088
    v_mfma_f32_16x16x32_bf16 v[60:63], v[204:207], v[80:83], v[60:63]
    ds_read_b64_tr_b16 v[212:213], v27 offset:24576
    v_mfma_f32_16x16x32_bf16 v[64:67], v[204:207], v[84:87], v[64:67]
    buffer_load_dwordx4 v6, s[8:11], s41 offen offset:128 sc1 lds
    v_mfma_f32_16x16x32_bf16 v[118:121], v[204:207], v[88:91], v[118:121]
    s_add_u32 m0, s43, 7936
    ds_read_b64_tr_b16 v[214:215], v27 offset:25088
    v_mfma_f32_16x16x32_bf16 v[100:103], v[196:199], v[32:35], v[100:103]
    buffer_load_dwordx4 v6, s[8:11], s41 offen offset:256 sc1 lds
    v_mfma_f32_16x16x32_bf16 v[104:107], v[200:203], v[32:35], v[104:107]
    ds_read_b64_tr_b16 v[216:217], v28 offset:24576
    v_mfma_f32_16x16x32_bf16 v[108:111], v[204:207], v[32:35], v[108:111]
    ds_read_b64_tr_b16 v[218:219], v28 offset:25088
    s_waitcnt lgkmcnt(4)
    v_mfma_f32_16x16x32_bf16 v[44:47], v[208:211], v[68:71], v[44:47]
    s_add_u32 m0, s43, 11904
    ds_read_b128 v[80:83], v5 offset:24576
    v_mfma_f32_16x16x32_bf16 v[48:51], v[208:211], v[72:75], v[48:51]
    ds_read_b128 v[84:87], v5 offset:26624
    v_mfma_f32_16x16x32_bf16 v[92:95], v[208:211], v[76:79], v[92:95]
    ds_read_b128 v[88:91], v5 offset:61440
    s_waitcnt lgkmcnt(5)
    v_mfma_f32_16x16x32_bf16 v[52:55], v[212:215], v[68:71], v[52:55]
    ds_read_b64_tr_b16 v[220:221], v26 offset:28672
    v_mfma_f32_16x16x32_bf16 v[56:59], v[212:215], v[72:75], v[56:59]
    ds_read_b64_tr_b16 v[222:223], v26 offset:29184
    v_mfma_f32_16x16x32_bf16 v[96:99], v[212:215], v[76:79], v[96:99]
    ds_read_b64_tr_b16 v[224:225], v27 offset:28672
    s_waitcnt lgkmcnt(6)
    v_mfma_f32_16x16x32_bf16 v[60:63], v[216:219], v[68:71], v[60:63]
    ds_read_b64_tr_b16 v[226:227], v27 offset:29184
    v_mfma_f32_16x16x32_bf16 v[64:67], v[216:219], v[72:75], v[64:67]
    ds_read_b64_tr_b16 v[228:229], v28 offset:28672
    v_mfma_f32_16x16x32_bf16 v[118:121], v[216:219], v[76:79], v[118:121]
    ds_read_b64_tr_b16 v[230:231], v28 offset:29184
    v_mfma_f32_16x16x32_bf16 v[100:103], v[208:211], v[32:35], v[100:103]
    buffer_load_dwordx4 v6, s[8:11], s41 offen offset:384 sc1 lds
    v_mfma_f32_16x16x32_bf16 v[104:107], v[212:215], v[32:35], v[104:107]
    s_add_u32 m0, s43, 15872
    s_nop 0
    buffer_load_dwordx4 v6, s[8:11], s41 offen offset:512 sc1 lds
    v_mfma_f32_16x16x32_bf16 v[108:111], v[216:219], v[32:35], v[108:111]
    s_add_u32 m0, s43, 19840
    s_nop 0
    buffer_load_dwordx4 v6, s[8:11], s41 offen offset:640 sc1 lds
    s_waitcnt vmcnt(8) lgkmcnt(0)
    s_barrier
    v_mfma_f32_16x16x32_bf16 v[44:47], v[220:223], v[80:83], v[44:47]
    ds_read_b64 v[20:21], v13 offset:4096
    s_add_u32 m0, s43, 23808
    v_mfma_f32_16x16x32_bf16 v[48:51], v[220:223], v[84:87], v[48:51]
    ds_read_b64 v[22:23], v13 offset:4224
    buffer_load_dwordx4 v6, s[8:11], s41 offen offset:768 sc1 lds
    v_mfma_f32_16x16x32_bf16 v[92:95], v[220:223], v[88:91], v[92:95]
    ds_read_b64 v[24:25], v13 offset:4352
    s_add_u32 m0, s43, 27776
    v_mfma_f32_16x16x32_bf16 v[52:55], v[224:227], v[80:83], v[52:55]
    ds_read_b64 v[36:37], v13 offset:4480
    buffer_load_dwordx4 v6, s[8:11], s41 offen offset:896 sc1 lds
    v_mfma_f32_16x16x32_bf16 v[56:59], v[224:227], v[84:87], v[56:59]
    ds_read_b128 v[68:71], v4 offset:28672
    s_add_u32 m0, s43, 31744
    v_mfma_f32_16x16x32_bf16 v[96:99], v[224:227], v[88:91], v[96:99]
    ds_read_b128 v[72:75], v4 offset:30720
    buffer_load_dwordx4 v6, s[8:11], s41 offen offset:1024 sc1 lds
    v_mfma_f32_16x16x32_bf16 v[60:63], v[228:231], v[80:83], v[60:63]
    ds_read_b128 v[76:79], v4 offset:63488
    v_mfma_f32_16x16x32_bf16 v[64:67], v[228:231], v[84:87], v[64:67]
    ds_read_b64_tr_b16 v[232:233], v26 offset:49152
    v_mfma_f32_16x16x32_bf16 v[118:121], v[228:231], v[88:91], v[118:121]
    ds_read_b64_tr_b16 v[234:235], v26 offset:49664
    v_mfma_f32_16x16x32_bf16 v[100:103], v[220:223], v[32:35], v[100:103]
    ds_read_b64_tr_b16 v[236:237], v27 offset:49152
    v_mfma_f32_16x16x32_bf16 v[104:107], v[224:227], v[32:35], v[104:107]
    ds_read_b64_tr_b16 v[238:239], v27 offset:49664
    v_mfma_f32_16x16x32_bf16 v[108:111], v[228:231], v[32:35], v[108:111]
    ds_read_b64_tr_b16 v[240:241], v28 offset:49152
    ds_read_b64_tr_b16 v[242:243], v28 offset:49664
    s_waitcnt lgkmcnt(0)
    v_mfma_f32_16x16x32_bf16 v[44:47], v[232:235], v[68:71], v[44:47]
    ds_read_b64 v[30:31], v13 offset:2048
    s_add_u32 m0, s43, 35712
    v_add_f32 v42, v24, v36
    v_add_f32 v43, v25, v37
    v_mfma_f32_16x16x32_bf16 v[48:51], v[232:235], v[72:75], v[48:51]
    ds_read_b64 v[112:113], v13 offset:2176
    buffer_load_dwordx4 v6, s[8:11], s41 offen offset:1152 sc1 lds
    v_add_f32 v20, v20, v22
    v_add_f32 v21, v21, v23
    v_mfma_f32_16x16x32_bf16 v[92:95], v[232:235], v[76:79], v[92:95]
    ds_read_b64 v[114:115], v13 offset:2304
    s_add_u32 m0, s43, 39680
    v_add_f32 v20, v20, v42
    v_add_f32 v21, v21, v43
    v_mfma_f32_16x16x32_bf16 v[52:55], v[236:239], v[68:71], v[52:55]
    ds_read_b64 v[122:123], v13 offset:2432
    buffer_load_dwordx4 v6, s[8:11], s41 offen offset:1280 sc1 lds
    v_mov_b32 v42, v20
    v_mov_b32 v43, v21
    v_mfma_f32_16x16x32_bf16 v[56:59], v[236:239], v[72:75], v[56:59]
    ds_read_b128 v[80:83], v5 offset:28672
    s_add_u32 m0, s43, 43648
    v_permlane32_swap_b32 v20, v42
    v_permlane32_swap_b32 v21, v43
    v_mfma_f32_16x16x32_bf16 v[96:99], v[236:239], v[76:79], v[96:99]
    ds_read_b128 v[84:87], v5 offset:30720
    buffer_load_dwordx4 v6, s[8:11], s41 offen offset:1408 sc1 lds
    v_add_f32 v20, v20, v42
    v_add_f32 v21, v21, v43
    v_mfma_f32_16x16x32_bf16 v[60:63], v[240:243], v[68:71], v[60:63]
    ds_read_b128 v[88:91], v5 offset:63488
    v_mul_f32 v38, 0xba800000, v20
    v_mul_f32 v21, 0x3a800000, v21
    v_mfma_f32_16x16x32_bf16 v[64:67], v[240:243], v[72:75], v[64:67]
    ds_read_b64_tr_b16 v[244:245], v26 offset:53248
    v_fma_f32 v21, -v38, v38, v21
    v_mov_b32 v39, v38
    v_mfma_f32_16x16x32_bf16 v[118:121], v[240:243], v[76:79], v[118:121]
    ds_read_b64_tr_b16 v[246:247], v26 offset:53760
    v_max_f32 v21, 0, v21
    v_add_f32 v21, 0x3727c5ac, v21
    v_mfma_f32_16x16x32_bf16 v[100:103], v[232:235], v[32:35], v[100:103]
    ds_read_b64_tr_b16 v[248:249], v27 offset:53248
    v_rsq_f32 v40, v21
    v_permlane16_swap_b32 v38, v39
    v_mfma_f32_16x16x32_bf16 v[104:107], v[236:239], v[32:35], v[104:107]
    ds_read_b64_tr_b16 v[250:251], v27 offset:53760
    v_mov_b32 v41, v40
    s_nop 1
    v_permlane16_swap_b32 v40, v41
    v_mfma_f32_16x16x32_bf16 v[108:111], v[240:243], v[32:35], v[108:111]
    ds_read_b64_tr_b16 v[252:253], v28 offset:53248
    ds_read_b64_tr_b16 v[254:255], v28 offset:53760
    s_waitcnt vmcnt(12) lgkmcnt(0)
    v_cmp_eq_u32 vcc, v116, v117
    s_cbranch_vccnz L_spin3
L_back4:
    s_barrier
    v_mfma_f32_16x16x32_bf16 v[44:47], v[244:247], v[80:83], v[44:47]
    s_add_u32 m0, s43, 47616
    v_add_f32 v29, v114, v122
    v_add_f32 v19, v115, v123
    v_mfma_f32_16x16x32_bf16 v[48:51], v[244:247], v[84:87], v[48:51]
    buffer_load_dwordx4 v6, s[8:11], s41 offen offset:1536 sc1 lds
    v_add_f32 v30, v30, v112
    v_add_f32 v31, v31, v113
    v_mfma_f32_16x16x32_bf16 v[92:95], v[244:247], v[88:91], v[92:95]
    s_add_u32 m0, s43, 51584
    v_add_f32 v30, v30, v29
    v_add_f32 v31, v31, v19
    v_mfma_f32_16x16x32_bf16 v[52:55], v[248:251], v[80:83], v[52:55]
    buffer_load_dwordx4 v6, s[8:11], s41 offen offset:1664 sc1 lds
    v_mov_b32 v29, v30
    v_mov_b32 v19, v31
    v_mfma_f32_16x16x32_bf16 v[56:59], v[248:251], v[84:87], v[56:59]
    s_add_u32 m0, s43, 55552
    v_permlane32_swap_b32 v30, v29
    v_permlane32_swap_b32 v31, v19
    v_mfma_f32_16x16x32_bf16 v[96:99], v[248:251], v[88:91], v[96:99]
    buffer_load_dwordx4 v6, s[8:11], s41 offen offset:1792 sc1 lds
    v_add_f32 v30, v30, v29
    v_add_f32 v31, v31, v19
    v_mfma_f32_16x16x32_bf16 v[60:63], v[252:255], v[80:83], v[60:63]
    s_add_u32 m0, s43, 59520
    v_mul_f32 v112, 0xba800000, v30
    v_mul_f32 v31, 0x3a800000, v31
    v_mfma_f32_16x16x32_bf16 v[64:67], v[252:255], v[84:87], v[64:67]
    buffer_load_dwordx4 v6, s[8:11], s41 offen offset:1920 sc1 lds
    v_fma_f32 v31, -v112, v112, v31
    v_mov_b32 v113, v112
    v_mfma_f32_16x16x32_bf16 v[118:121], v[252:255], v[88:91], v[118:121]
    s_add_u32 s91, s91, 65536
    v_max_f32 v31, 0, v31
    v_add_f32 v31, 0x3727c5ac, v31
    v_mfma_f32_16x16x32_bf16 v[100:103], v[244:247], v[32:35], v[100:103]
    v_rsq_f32 v114, v31
    v_permlane16_swap_b32 v112, v113
    v_mfma_f32_16x16x32_bf16 v[104:107], v[248:251], v[32:35], v[104:107]
    v_mov_b32 v115, v114
    s_nop 1
    v_permlane16_swap_b32 v114, v115
    v_mfma_f32_16x16x32_bf16 v[108:111], v[252:255], v[32:35], v[108:111]
    s_mov_b32 s36, 0
    v_mov_b32 v116, 0
    v_mov_b32 v117, v11
    s_cmp_eq_u32 s36, s97
    s_cselect_b32 s47, 30, -2
    s_cselect_b64 s[8:9], s[88:89], s[8:9]
    s_cselect_b32 s55, 0x543fc00, s55
    s_add_u32 s50, s50, s47
    s_max_i32 s47, s50, 0
    s_min_i32 s47, s47, s96
    s_lshl_b32 s41, s47, 15
    s_lshl_b32 s46, s47, 10
    s_sub_u32 s46, s55, s46
    s_add_u32 s90, s90, 0x10000
    s_and_b32 s44, s90, 0xffffffff
    s_bitcmp1_b32 s26, s36
    s_cselect_b64 s[62:63], 0, -1
    v_fmac_f32 v92, v38, v100
    v_fmac_f32 v93, v38, v101
    v_fmac_f32 v94, v38, v102
    v_fmac_f32 v95, v38, v103
    v_mul_f32 v92, v92, v40
    v_mul_f32 v93, v93, v40
    v_mul_f32 v94, v94, v40
    v_mul_f32 v95, v95, v40
    v_cvt_pk_bf16_f32 v92, v92, v93
    v_cvt_pk_bf16_f32 v93, v94, v95
    ds_write_b64 v7, v[92:93] offset:6144
    v_fmac_f32 v96, v38, v104
    v_fmac_f32 v97, v38, v105
    v_fmac_f32 v98, v38, v106
    v_fmac_f32 v99, v38, v107
    v_mul_f32 v96, v96, v40
    v_mul_f32 v97, v97, v40
    v_mul_f32 v98, v98, v40
    v_mul_f32 v99, v99, v40
    v_cvt_pk_bf16_f32 v96, v96, v97
    v_cvt_pk_bf16_f32 v97, v98, v99
    ds_write_b64 v7, v[96:97] offset:7168
    v_fmac_f32 v118, v38, v108
    v_fmac_f32 v119, v38, v109
    v_fmac_f32 v120, v38, v110
    v_fmac_f32 v121, v38, v111
    v_mul_f32 v118, v118, v40
    v_mul_f32 v119, v119, v40
    v_mul_f32 v120, v120, v40
    v_mul_f32 v121, v121, v40
    v_cvt_pk_bf16_f32 v118, v118, v119
    v_cvt_pk_bf16_f32 v119, v120, v121
    ds_write_b64 v8, v[118:119] offset:8192
    v_fmac_f32 v44, v112, v100
    v_fmac_f32 v45, v112, v101
    v_fmac_f32 v46, v112, v102
    v_fmac_f32 v47, v112, v103
    v_fmac_f32 v48, v113, v100
    v_fmac_f32 v49, v113, v101
    v_fmac_f32 v50, v113, v102
    v_fmac_f32 v51, v113, v103
    v_fmac_f32 v52, v112, v104
    v_fmac_f32 v53, v112, v105
    v_fmac_f32 v54, v112, v106
    v_fmac_f32 v55, v112, v107
    v_fmac_f32 v56, v113, v104
    v_fmac_f32 v57, v113, v105
    v_fmac_f32 v58, v113, v106
    v_fmac_f32 v59, v113, v107
    v_fmac_f32 v60, v112, v108
    v_fmac_f32 v61, v112, v109
    v_fmac_f32 v62, v112, v110
    v_fmac_f32 v63, v112, v111
    v_fmac_f32 v64, v113, v108
    v_fmac_f32 v65, v113, v109
    v_fmac_f32 v66, v113, v110
    v_fmac_f32 v67, v113, v111
    s_waitcnt vmcnt(4) lgkmcnt(0)
    s_barrier
    ds_read_b128 v[68:71], v2 offset:0
    ds_read_b128 v[72:75], v2 offset:2048
    ds_read_b128 v[76:79], v3 offset:0
    ds_read_b128 v[80:83], v3 offset:2048
    s_mul_i32 s37, s51, 1024
    s_add_u32 s37, s37, s43
    s_add_u32 s37, s37, 72704
    v_add_u32 v24, s37, v1
    ds_read_b128 v[118:121], v24
    s_waitcnt lgkmcnt(0)
    buffer_store_dwordx4 v[118:121], v1, s[16:19], s25 offen sc1
    s_mov_b32 s36, 1
    s_waitcnt lgkmcnt(0)
    s_nop 7
L_q_b0:
    v_mfma_f32_16x16x32_bf16 v[20:23], a[0:3], v[68:71], 0
    ds_read_b128 v[84:87], v2 offset:4096
    v_mul_f32 v44, v44, v114
    v_mfma_f32_16x16x32_bf16 v[24:27], a[0:3], v[72:75], 0
    v_mul_f32 v45, v45, v114
    v_mul_f32 v46, v46, v114
    v_mfma_f32_16x16x32_bf16 v[32:35], a[4:7], v[72:75], 0
    v_mul_f32 v47, v47, v114
    v_cvt_pk_bf16_f32 v44, v44, v45
    v_mfma_f32_16x16x32_bf16 v[28:31], a[4:7], v[68:71], 0
    ds_read_b128 v[88:91], v2 offset:6144
    v_cvt_pk_bf16_f32 v45, v46, v47
    v_mfma_f32_16x16x32_bf16 v[36:39], a[8:11], v[68:71], 0
    ds_write_b64 v7, v[44:45] offset:12288
    v_mfma_f32_16x16x32_bf16 v[40:43], a[8:11], v[72:75], 0
    s_waitcnt lgkmcnt(3)
    v_mul_f32 v48, v48, v115
    v_mul_f32 v49, v49, v115
    v_mfma_f32_16x16x32_bf16 v[20:23], a[12:15], v[76:79], v[20:23]
    ds_read_b128 v[92:95], v3 offset:4096
    v_mul_f32 v50, v50, v115
    v_mfma_f32_16x16x32_bf16 v[24:27], a[12:15], v[80:83], v[24:27]
    v_mul_f32 v51, v51, v115
    v_cvt_pk_bf16_f32 v48, v48, v49
    v_mfma_f32_16x16x32_bf16 v[32:35], a[16:19], v[80:83], v[32:35]
    v_cvt_pk_bf16_f32 v49, v50, v51
    v_mfma_f32_16x16x32_bf16 v[28:31], a[16:19], v[76:79], v[28:31]
    ds_read_b128 v[96:99], v3 offset:6144
    v_mfma_f32_16x16x32_bf16 v[36:39], a[20:23], v[76:79], v[36:39]
    ds_write_b64 v7, v[48:49] offset:18432
    v_mfma_f32_16x16x32_bf16 v[40:43], a[20:23], v[80:83], v[40:43]
    s_waitcnt lgkmcnt(4)
    v_mul_f32 v52, v52, v114
    v_mul_f32 v53, v53, v114
    v_mfma_f32_16x16x32_bf16 v[20:23], a[24:27], v[84:87], v[20:23]
    ds_read_b128 v[68:71], v2 offset:8192
    v_mul_f32 v54, v54, v114
    v_mfma_f32_16x16x32_bf16 v[24:27], a[24:27], v[88:91], v[24:27]
    v_mul_f32 v55, v55, v114
    v_cvt_pk_bf16_f32 v52, v52, v53
    v_mfma_f32_16x16x32_bf16 v[32:35], a[28:31], v[88:91], v[32:35]
    v_cvt_pk_bf16_f32 v53, v54, v55
    v_mfma_f32_16x16x32_bf16 v[28:31], a[28:31], v[84:87], v[28:31]
    ds_read_b128 v[72:75], v2 offset:10240
    v_mfma_f32_16x16x32_bf16 v[36:39], a[32:35], v[84:87], v[36:39]
    ds_write_b64 v7, v[52:53] offset:13312
    v_mfma_f32_16x16x32_bf16 v[40:43], a[32:35], v[88:91], v[40:43]
    s_waitcnt lgkmcnt(4)
    v_mul_f32 v56, v56, v115
    v_mul_f32 v57, v57, v115
    v_mfma_f32_16x16x32_bf16 v[20:23], a[36:39], v[92:95], v[20:23]
    ds_read_b128 v[76:79], v3 offset:8192
    v_mul_f32 v58, v58, v115
    v_mfma_f32_16x16x32_bf16 v[24:27], a[36:39], v[96:99], v[24:27]
    v_mul_f32 v59, v59, v115
    v_cvt_pk_bf16_f32 v56, v56, v57
    v_mfma_f32_16x16x32_bf16 v[32:35], a[40:43], v[96:99], v[32:35]
    v_cvt_pk_bf16_f32 v57, v58, v59
    v_mfma_f32_16x16x32_bf16 v[28:31], a[40:43], v[92:95], v[28:31]
    ds_read_b128 v[80:83], v3 offset:10240
    v_mfma_f32_16x16x32_bf16 v[36:39], a[44:47], v[92:95], v[36:39]
    ds_write_b64 v7, v[56:57] offset:19456
    v_mfma_f32_16x16x32_bf16 v[40:43], a[44:47], v[96:99], v[40:43]
    s_waitcnt lgkmcnt(4)
    v_mul_f32 v60, v60, v114
    v_mul_f32 v61, v61, v114
    v_mfma_f32_16x16x32_bf16 v[20:23], a[48:51], v[68:71], v[20:23]
    s_waitcnt vmcnt(1)
    ds_read_b128 v[84:87], v2 offset:12288
    v_cmp_ne_u32 vcc, 0, v116
    v_mfma_f32_16x16x32_bf16 v[24:27], a[48:51], v[72:75], v[24:27]
    v_mul_f32 v62, v62, v114
    v_mul_f32 v63, v63, v114
    v_mfma_f32_16x16x32_bf16 v[32:35], a[52:55], v[72:75], v[32:35]
    s_cbranch_vccnz L_spin7
L_back8:
    v_cvt_pk_bf16_f32 v60, v60, v61
    v_cvt_pk_bf16_f32 v61, v62, v63
    v_mfma_f32_16x16x32_bf16 v[28:31], a[52:55], v[68:71], v[28:31]
    ds_read_b128 v[88:91], v2 offset:14336
    v_mfma_f32_16x16x32_bf16 v[36:39], a[56:59], v[68:71], v[36:39]
    ds_write_b64 v8, v[60:61] offset:14336
    v_mfma_f32_16x16x32_bf16 v[40:43], a[56:59], v[72:75], v[40:43]
    s_waitcnt lgkmcnt(4)
    v_mul_f32 v64, v64, v115
    v_mul_f32 v65, v65, v115
    v_mfma_f32_16x16x32_bf16 v[20:23], a[60:63], v[76:79], v[20:23]
    ds_read_b128 v[92:95], v3 offset:12288
    v_mul_f32 v66, v66, v115
    v_mfma_f32_16x16x32_bf16 v[24:27], a[60:63], v[80:83], v[24:27]
    v_mul_f32 v67, v67, v115
    v_cvt_pk_bf16_f32 v64, v64, v65
    v_mfma_f32_16x16x32_bf16 v[32:35], a[64:67], v[80:83], v[32:35]
    v_cvt_pk_bf16_f32 v65, v66, v67
    v_mfma_f32_16x16x32_bf16 v[28:31], a[64:67], v[76:79], v[28:31]
    ds_read_b128 v[96:99], v3 offset:14336
    v_mfma_f32_16x16x32_bf16 v[36:39], a[68:71], v[76:79], v[36:39]
    ds_write_b64 v8, v[64:65] offset:20480
    v_mfma_f32_16x16x32_bf16 v[40:43], a[68:71], v[80:83], v[40:43]
    s_waitcnt lgkmcnt(4)
    v_mfma_f32_16x16x32_bf16 v[20:23], a[72:75], v[84:87], v[20:23]
    ds_read_b128 v[68:71], v2 offset:16384
    v_mfma_f32_16x16x32_bf16 v[24:27], a[72:75], v[88:91], v[24:27]
    v_mfma_f32_16x16x32_bf16 v[32:35], a[76:79], v[88:91], v[32:35]
    s_waitcnt lgkmcnt(1)
    s_barrier
    v_mfma_f32_16x16x32_bf16 v[28:31], a[76:79], v[84:87], v[28:31]
    ds_read_b128 v[72:75], v2 offset:18432
    v_mfma_f32_16x16x32_bf16 v[36:39], a[80:83], v[84:87], v[36:39]
    ds_read_b128 v[44:47], v9 offset:6144
    v_mfma_f32_16x16x32_bf16 v[40:43], a[80:83], v[88:91], v[40:43]
    s_waitcnt lgkmcnt(4)
    ds_read_b128 v[48:51], v9 offset:13312
    v_mfma_f32_16x16x32_bf16 v[20:23], a[84:87], v[92:95], v[20:23]
    ds_read_b128 v[76:79], v3 offset:16384
    v_mfma_f32_16x16x32_bf16 v[24:27], a[84:87], v[96:99], v[24:27]
    ds_read_b128 v[52:55], v9 offset:7168
    s_add_u32 m0, s43, 98304
    v_mfma_f32_16x16x32_bf16 v[32:35], a[88:91], v[96:99], v[32:35]
    buffer_load_dwordx4 v6, s[8:11], s41 offen offset:0 sc1 lds
    v_mfma_f32_16x16x32_bf16 v[28:31], a[88:91], v[92:95], v[28:31]
    s_add_u32 m0, s43, 102272
    ds_read_b128 v[80:83], v3 offset:18432
    v_mfma_f32_16x16x32_bf16 v[36:39], a[92:95], v[92:95], v[36:39]
    ds_read_b64_tr_b16 v[56:57], v9 offset:14336
    v_mfma_f32_16x16x32_bf16 v[40:43], a[92:95], v[96:99], v[40:43]
    s_waitcnt lgkmcnt(6)
    ds_read_b64_tr_b16 v[58:59], v9 offset:8192
    s_waitcnt lgkmcnt(3)
    v_mfma_f32_16x16x32_bf16 v[20:23], a[96:99], v[68:71], v[20:23]
    ds_read_b128 v[84:87], v2 offset:20480
    v_mfma_f32_16x16x32_bf16 v[64:67], v[48:51], v[44:47], 0
    ds_read_b64_tr_b16 v[60:61], v9 offset:14344
    v_mfma_f32_16x16x32_bf16 v[118:121], v[52:55], v[44:47], 0
    ds_read_b64_tr_b16 v[62:63], v9 offset:8200
    v_mfma_f32_16x16x32_bf16 v[24:27], a[96:99], v[72:75], v[24:27]
    v_mfma_f32_16x16x32_bf16 v[32:35], a[100:103], v[72:75], v[32:35]
    buffer_load_dwordx4 v6, s[8:11], s41 offen offset:128 sc1 lds
    v_mfma_f32_16x16x32_bf16 v[28:31], a[100:103], v[68:71], v[28:31]
    s_add_u32 m0, s43, 106240
    ds_read_b128 v[88:91], v2 offset:22528
    v_cndmask_b32 v64, v64, v65, s[56:57]
    v_mfma_f32_16x16x32_bf16 v[36:39], a[104:107], v[68:71], v[36:39]
    v_cndmask_b32 v66, v66, v67, s[56:57]
    v_cndmask_b32 v118, v118, v119, s[56:57]
    v_mfma_f32_16x16x32_bf16 v[40:43], a[104:107], v[72:75], v[40:43]
    s_waitcnt lgkmcnt(6)
    v_cndmask_b32 v120, v120, v121, s[56:57]
    v_cndmask_b32 v64, v18, v64, s[62:63]
    v_mfma_f32_16x16x32_bf16 v[20:23], a[108:111], v[76:79], v[20:23]
    ds_read_b128 v[92:95], v3 offset:20480
    v_cndmask_b32 v66, v18, v66, s[62:63]
    v_mfma_f32_16x16x32_bf16 v[24:27], a[108:111], v[80:83], v[24:27]
    v_cndmask_b32 v46, v64, v118, s[58:59]
    v_cndmask_b32 v47, v66, v120, s[60:61]
    v_mfma_f32_16x16x32_bf16 v[32:35], a[112:115], v[80:83], v[32:35]
    buffer_load_dwordx4 v6, s[8:11], s41 offen offset:256 sc1 lds
    v_mfma_f32_16x16x32_bf16 v[28:31], a[112:115], v[76:79], v[28:31]
    s_add_u32 m0, s43, 110208
    ds_read_b128 v[96:99], v3 offset:22528
    v_max_f32 v44, v46, v47
    v_mfma_f32_16x16x32_bf16 v[36:39], a[116:119], v[76:79], v[36:39]
    v_mov_b32 v45, v44
    v_mfma_f32_16x16x32_bf16 v[40:43], a[116:119], v[80:83], v[40:43]
    s_waitcnt lgkmcnt(2)
    v_permlane16_swap_b32 v44, v45
    v_mfma_f32_16x16x32_bf16 v[20:23], a[120:123], v[84:87], v[20:23]
    ds_read_b128 v[68:71], v2 offset:24576
    v_max_f32 v44, v44, v45
    v_mfma_f32_16x16x32_bf16 v[24:27], a[120:123], v[88:91], v[24:27]
    v_mov_b32 v45, v44
    v_mfma_f32_16x16x32_bf16 v[32:35], a[124:127], v[88:91], v[32:35]
    buffer_load_dwordx4 v6, s[8:11], s41 offen offset:384 sc1 lds
    v_mfma_f32_16x16x32_bf16 v[28:31], a[124:127], v[84:87], v[28:31]
    s_add_u32 m0, s43, 114176
    ds_read_b128 v[72:75], v2 offset:26624
    v_mfma_f32_16x16x32_bf16 v[36:39], a[128:131], v[84:87], v[36:39]
    v_permlane32_swap_b32 v44, v45
    v_mfma_f32_16x16x32_bf16 v[40:43], a[128:131], v[88:91], v[40:43]
    s_waitcnt lgkmcnt(2)
    v_max_f32 v44, v44, v45
    v_mul_f32 v44, s86, v44
    v_mfma_f32_16x16x32_bf16 v[20:23], a[132:135], v[92:95], v[20:23]
    ds_read_b128 v[76:79], v3 offset:24576
    v_fma_f32 v46, v46, s86, -v44
    v_mfma_f32_16x16x32_bf16 v[24:27], a[132:135], v[96:99], v[24:27]
    v_fma_f32 v47, v47, s86, -v44
    v_mfma_f32_16x16x32_bf16 v[32:35], a[136:139], v[96:99], v[32:35]
    buffer_load_dwordx4 v6, s[8:11], s41 offen offset:512 sc1 lds
    v_mfma_f32_16x16x32_bf16 v[28:31], a[136:139], v[92:95], v[28:31]
    s_add_u32 m0, s43, 118144
    ds_read_b128 v[80:83], v3 offset:26624
    v_mfma_f32_16x16x32_bf16 v[36:39], a[140:143], v[92:95], v[36:39]
    v_exp_f32 v46, v46
    v_mfma_f32_16x16x32_bf16 v[40:43], a[140:143], v[96:99], v[40:43]
    s_waitcnt lgkmcnt(2)
    v_exp_f32 v47, v47
    v_mfma_f32_16x16x32_bf16 v[20:23], a[144:147], v[68:71], v[20:23]
    ds_read_b128 v[84:87], v2 offset:28672
    v_cvt_pk_bf16_f32 v52, v46, v47
    v_mfma_f32_16x16x32_bf16 v[24:27], a[144:147], v[72:75], v[24:27]
    v_perm_b32 v48, v52, v52, v14
    v_perm_b32 v49, v52, v52, v15
    v_mfma_f32_16x16x32_bf16 v[32:35], a[148:151], v[72:75], v[32:35]
    buffer_load_dwordx4 v6, s[8:11], s41 offen offset:640 sc1 lds
    v_mfma_f32_16x16x32_bf16 v[28:31], a[148:151], v[68:71], v[28:31]
    s_add_u32 m0, s43, 122112
    ds_read_b128 v[88:91], v2 offset:30720
    v_perm_b32 v50, v52, v52, v16
    v_mfma_f32_16x16x32_bf16 v[36:39], a[152:155], v[68:71], v[36:39]
    v_perm_b32 v51, v52, v52, v17
    v_add_f32 v44, v46, v47
    v_mfma_f32_16x16x32_bf16 v[40:43], a[152:155], v[72:75], v[40:43]
    s_waitcnt lgkmcnt(2)
    v_mov_b32 v45, v44
    s_waitcnt lgkmcnt(9)
    v_mfma_f32_16x16x32_bf16 v[20:23], a[156:159], v[76:79], v[20:23]
    ds_read_b128 v[92:95], v3 offset:28672
    v_mfma_f32_16x16x32_bf16 v[64:67], v[56:59], v[48:51], 0
    v_mfma_f32_16x16x32_bf16 v[118:121], v[60:63], v[48:51], 0
    v_permlane16_swap_b32 v44, v45
    v_mfma_f32_16x16x32_bf16 v[24:27], a[156:159], v[80:83], v[24:27]
    v_add_f32 v44, v44, v45
    v_mov_b32 v45, v44
    v_mfma_f32_16x16x32_bf16 v[32:35], a[160:163], v[80:83], v[32:35]
    buffer_load_dwordx4 v6, s[8:11], s41 offen offset:768 sc1 lds
    v_mfma_f32_16x16x32_bf16 v[28:31], a[160:163], v[76:79], v[28:31]
    s_add_u32 m0, s43, 126080
    ds_read_b128 v[96:99], v3 offset:30720
    v_mfma_f32_16x16x32_bf16 v[36:39], a[164:167], v[76:79], v[36:39]
    v_permlane32_swap_b32 v44, v45
    v_mfma_f32_16x16x32_bf16 v[40:43], a[164:167], v[80:83], v[40:43]
    s_waitcnt lgkmcnt(2)
    v_add_f32 v44, v44, v45
    v_mfma_f32_16x16x32_bf16 v[20:23], a[168:171], v[84:87], v[20:23]
    ds_read_b128 v[68:71], v2 offset:32768
    v_mfma_f32_16x16x32_bf16 v[24:27], a[168:171], v[88:91], v[24:27]
    v_rcp_f32 v44, v44
    v_mfma_f32_16x16x32_bf16 v[32:35], a[172:175], v[88:91], v[32:35]
    buffer_load_dwordx4 v6, s[8:11], s41 offen offset:896 sc1 lds
    v_mfma_f32_16x16x32_bf16 v[28:31], a[172:175], v[84:87], v[28:31]
    s_add_u32 m0, s43, 130048
    ds_read_b128 v[72:75], v2 offset:34816
    v_mul_f32 v64, v64, v44
    v_mfma_f32_16x16x32_bf16 v[36:39], a[176:179], v[84:87], v[36:39]
    v_mul_f32 v65, v65, v44
    v_mul_f32 v66, v66, v44
    v_mfma_f32_16x16x32_bf16 v[40:43], a[176:179], v[88:91], v[40:43]
    s_waitcnt lgkmcnt(2)
    v_mul_f32 v67, v67, v44
    v_cvt_pk_bf16_f32 v52, v64, v65
    v_mfma_f32_16x16x32_bf16 v[20:23], a[180:183], v[92:95], v[20:23]
    ds_read_b128 v[76:79], v3 offset:32768
    v_cvt_pk_bf16_f32 v53, v66, v67
    v_mfma_f32_16x16x32_bf16 v[24:27], a[180:183], v[96:99], v[24:27]
    v_mul_f32 v118, v118, v44
    v_mul_f32 v119, v119, v44
    v_mfma_f32_16x16x32_bf16 v[32:35], a[184:187], v[96:99], v[32:35]
    buffer_load_dwordx4 v6, s[8:11], s41 offen offset:1024 sc1 lds
    v_mfma_f32_16x16x32_bf16 v[28:31], a[184:187], v[92:95], v[28:31]
    s_add_u32 m0, s43, 134016
    ds_read_b128 v[80:83], v3 offset:34816
    v_mul_f32 v120, v120, v44
    v_mfma_f32_16x16x32_bf16 v[36:39], a[188:191], v[92:95], v[36:39]
    v_mul_f32 v121, v121, v44
    v_cvt_pk_bf16_f32 v54, v118, v119
    v_mfma_f32_16x16x32_bf16 v[40:43], a[188:191], v[96:99], v[40:43]
    s_waitcnt lgkmcnt(2)
    v_cvt_pk_bf16_f32 v55, v120, v121
    v_mfma_f32_16x16x32_bf16 v[20:23], a[192:195], v[68:71], v[20:23]
    ds_read_b128 v[84:87], v2 offset:36864
    v_mfma_f32_16x16x32_bf16 v[24:27], a[192:195], v[72:75], v[24:27]
    buffer_store_dwordx4 v[52:55], v1, s[16:19], s44 offen sc1
    v_mfma_f32_16x16x32_bf16 v[32:35], a[196:199], v[72:75], v[32:35]
    buffer_load_dwordx4 v6, s[8:11], s41 offen offset:1152 sc1 lds
    v_mfma_f32_16x16x32_bf16 v[28:31], a[196:199], v[68:71], v[28:31]
    s_add_u32 m0, s43, 137984
    ds_read_b128 v[88:91], v2 offset:38912
    s_add_u32 s90, s90, 0x10000
    v_mfma_f32_16x16x32_bf16 v[36:39], a[200:203], v[68:71], v[36:39]
    s_and_b32 s44, s90, 0xffffffff
    ds_read_b64 v[56:57], v13 offset:0
    s_bitcmp1_b32 s26, s36
    v_mfma_f32_16x16x32_bf16 v[40:43], a[200:203], v[72:75], v[40:43]
    s_waitcnt lgkmcnt(3)
    ds_read_b64 v[58:59], v13 offset:128
    s_cselect_b64 s[62:63], 0, -1
    v_mfma_f32_16x16x32_bf16 v[20:23], a[204:207], v[76:79], v[20:23]
    s_cmp_eq_u32 s36, 15
    ds_read_b128 v[92:95], v3 offset:36864
    s_cselect_b32 s49, s87, 0
    v_mfma_f32_16x16x32_bf16 v[24:27], a[204:207], v[80:83], v[24:27]
    ds_read_b64 v[60:61], v13 offset:256
    v_add_u32 v9, s49, v9
    v_mfma_f32_16x16x32_bf16 v[32:35], a[208:211], v[80:83], v[32:35]
    buffer_load_dwordx4 v6, s[8:11], s41 offen offset:1280 sc1 lds
    v_mfma_f32_16x16x32_bf16 v[28:31], a[208:211], v[76:79], v[28:31]
    s_add_u32 m0, s43, 141952
    ds_read_b128 v[96:99], v3 offset:38912
    v_mfma_f32_16x16x32_bf16 v[36:39], a[212:215], v[76:79], v[36:39]
    ds_read_b64 v[62:63], v13 offset:384
    v_mfma_f32_16x16x32_bf16 v[40:43], a[212:215], v[80:83], v[40:43]
    s_waitcnt lgkmcnt(6)
    v_mfma_f32_16x16x32_bf16 v[20:23], a[216:219], v[84:87], v[20:23]
    ds_read_b128 v[68:71], v2 offset:40960
    v_mfma_f32_16x16x32_bf16 v[24:27], a[216:219], v[88:91], v[24:27]
    v_mfma_f32_16x16x32_bf16 v[32:35], a[220:223], v[88:91], v[32:35]
    buffer_load_dwordx4 v6, s[8:11], s41 offen offset:1408 sc1 lds
    v_mfma_f32_16x16x32_bf16 v[28:31], a[220:223], v[84:87], v[28:31]
    s_add_u32 m0, s43, 145920
    ds_read_b128 v[72:75], v2 offset:43008
    s_waitcnt lgkmcnt(2)
    v_mfma_f32_16x16x32_bf16 v[36:39], a[224:227], v[84:87], v[36:39]
    v_add_f32 v64, v60, v62
    v_add_f32 v65, v61, v63
    v_mfma_f32_16x16x32_bf16 v[40:43], a[224:227], v[88:91], v[40:43]
    s_waitcnt lgkmcnt(3)
    v_add_f32 v56, v56, v58
    v_add_f32 v57, v57, v59
    v_mfma_f32_16x16x32_bf16 v[20:23], a[228:231], v[92:95], v[20:23]
    ds_read_b128 v[76:79], v3 offset:40960
    v_add_f32 v56, v56, v64
    v_mfma_f32_16x16x32_bf16 v[24:27], a[228:231], v[96:99], v[24:27]
    v_add_f32 v57, v57, v65
    v_mov_b32 v64, v56
    v_mfma_f32_16x16x32_bf16 v[32:35], a[232:235], v[96:99], v[32:35]
    buffer_load_dwordx4 v6, s[8:11], s41 offen offset:1536 sc1 lds
    v_mfma_f32_16x16x32_bf16 v[28:31], a[232:235], v[92:95], v[28:31]
    s_add_u32 m0, s43, 149888
    ds_read_b128 v[80:83], v3 offset:43008
    v_mov_b32 v65, v57
    v_mfma_f32_16x16x32_bf16 v[36:39], a[236:239], v[92:95], v[36:39]
    v_permlane32_swap_b32 v56, v64
    v_mfma_f32_16x16x32_bf16 v[40:43], a[236:239], v[96:99], v[40:43]
    s_waitcnt lgkmcnt(2)
    v_permlane32_swap_b32 v57, v65
    v_mfma_f32_16x16x32_bf16 v[20:23], a[240:243], v[68:71], v[20:23]
    ds_read_b128 v[84:87], v2 offset:45056
    v_add_f32 v56, v56, v64
    v_mfma_f32_16x16x32_bf16 v[24:27], a[240:243], v[72:75], v[24:27]
    v_add_f32 v57, v57, v65
    v_mul_f32 v112, 0xba800000, v56
    v_mfma_f32_16x16x32_bf16 v[32:35], a[244:247], v[72:75], v[32:35]
    buffer_load_dwordx4 v6, s[8:11], s41 offen offset:1664 sc1 lds
    v_mfma_f32_16x16x32_bf16 v[28:31], a[244:247], v[68:71], v[28:31]
    s_add_u32 m0, s43, 153856
    ds_read_b128 v[88:91], v2 offset:47104
    v_mul_f32 v57, 0x3a800000, v57
    v_mfma_f32_16x16x32_bf16 v[36:39], a[248:251], v[68:71], v[36:39]
    v_fma_f32 v57, -v112, v112, v57
    v_mov_b32 v113, v112
    v_mfma_f32_16x16x32_bf16 v[40:43], a[248:251], v[72:75], v[40:43]
    s_waitcnt lgkmcnt(2)
    v_max_f32 v57, 0, v57
    v_add_f32 v57, 0x3727c5ac, v57
    v_mfma_f32_16x16x32_bf16 v[20:23], a[252:255], v[76:79], v[20:23]
    ds_read_b128 v[92:95], v3 offset:45056
    v_mfma_f32_16x16x32_bf16 v[24:27], a[252:255], v[80:83], v[24:27]
    v_rsq_f32 v114, v57
    v_mfma_f32_16x16x32_bf16 v[32:35], v[128:131], v[80:83], v[32:35]
    buffer_load_dwordx4 v6, s[8:11], s41 offen offset:1792 sc1 lds
    v_mfma_f32_16x16x32_bf16 v[28:31], v[128:131], v[76:79], v[28:31]
    s_add_u32 m0, s43, 157824
    ds_read_b128 v[96:99], v3 offset:47104
    v_mfma_f32_16x16x32_bf16 v[36:39], v[132:135], v[76:79], v[36:39]
    v_permlane16_swap_b32 v112, v113
    v_mfma_f32_16x16x32_bf16 v[40:43], v[132:135], v[80:83], v[40:43]
    s_waitcnt lgkmcnt(2)
    v_mov_b32 v115, v114
    v_fmac_f32 v24, v113, v100
    v_mfma_f32_16x16x32_bf16 v[20:23], v[136:139], v[84:87], v[20:23]
    ds_read_b128 v[68:71], v2 offset:49152
    v_fmac_f32 v28, v112, v104
    v_mfma_f32_16x16x32_bf16 v[24:27], v[136:139], v[88:91], v[24:27]
    v_permlane16_swap_b32 v114, v115
    v_mfma_f32_16x16x32_bf16 v[32:35], v[140:143], v[88:91], v[32:35]
    buffer_load_dwordx4 v6, s[8:11], s41 offen offset:1920 sc1 lds
    v_mfma_f32_16x16x32_bf16 v[28:31], v[140:143], v[84:87], v[28:31]
    s_add_u32 m0, s52, 92160
    ds_read_b128 v[72:75], v2 offset:51200
    v_fmac_f32 v20, v112, v100
    v_mfma_f32_16x16x32_bf16 v[36:39], v[144:147], v[84:87], v[36:39]
    v_fmac_f32 v21, v112, v101
    v_fmac_f32 v22, v112, v102
    v_mfma_f32_16x16x32_bf16 v[40:43], v[144:147], v[88:91], v[40:43]
    s_waitcnt lgkmcnt(2)
    v_fmac_f32 v25, v113, v101
    v_fmac_f32 v26, v113, v102
    v_mfma_f32_16x16x32_bf16 v[20:23], v[148:151], v[92:95], v[20:23]
    ds_read_b128 v[76:79], v3 offset:49152
    v_fmac_f32 v29, v112, v105
    v_mfma_f32_16x16x32_bf16 v[24:27], v[148:151], v[96:99], v[24:27]
    v_fmac_f32 v30, v112, v106
    v_fmac_f32 v31, v112, v107
    v_mfma_f32_16x16x32_bf16 v[32:35], v[152:155], v[96:99], v[32:35]
    buffer_load_dwordx4 v1, s[16:19], s46 offen sc1 lds
    v_mfma_f32_16x16x32_bf16 v[28:31], v[152:155], v[92:95], v[28:31]
    s_add_u32 m0, s43, 94208
    ds_read_b128 v[80:83], v3 offset:51200
    v_fmac_f32 v23, v112, v103
    v_mfma_f32_16x16x32_bf16 v[36:39], v[156:159], v[92:95], v[36:39]
    s_cmp_eq_u32 s36, 15
    v_fmac_f32 v27, v113, v103
    v_fmac_f32 v32, v113, v104
    v_mfma_f32_16x16x32_bf16 v[40:43], v[156:159], v[96:99], v[40:43]
    s_waitcnt lgkmcnt(2)
    v_fmac_f32 v33, v113, v105
    v_fmac_f32 v34, v113, v106
    v_mfma_f32_16x16x32_bf16 v[20:23], v[160:163], v[68:71], v[20:23]
    s_cselect_b32 s38, s24, 0x5e00000
    ds_read_b128 v[84:87], v2 offset:53248
    v_fmac_f32 v35, v113, v107
    v_mfma_f32_16x16x32_bf16 v[24:27], v[160:163], v[72:75], v[24:27]
    buffer_load_dwordx4 v1, s[16:19], s38 offen sc1 lds
    v_mfma_f32_16x16x32_bf16 v[32:35], v[164:167], v[72:75], v[32:35]
    s_cmp_eq_u32 s36, s97
    v_med3_i32 v117, s45, 0, v12
    v_add_u32 v117, v117, v11
    v_mfma_f32_16x16x32_bf16 v[28:31], v[164:167], v[68:71], v[28:31]
    s_cselect_b32 s47, 30, -2
    ds_read_b128 v[88:91], v2 offset:55296
    v_fmac_f32 v40, v113, v108
    v_mfma_f32_16x16x32_bf16 v[36:39], v[168:171], v[68:71], v[36:39]
    s_cselect_b64 s[8:9], s[88:89], s[8:9]
    s_cselect_b32 s55, 0x543fc00, s55
    s_add_u32 s45, s45, 65536
    v_mfma_f32_16x16x32_bf16 v[40:43], v[168:171], v[72:75], v[40:43]
    s_waitcnt lgkmcnt(2)
    s_add_u32 s50, s50, s47
    s_max_i32 s47, s50, 0
    v_mfma_f32_16x16x32_bf16 v[20:23], v[172:175], v[76:79], v[20:23]
    s_min_i32 s47, s47, s96
    ds_read_b128 v[92:95], v3 offset:53248
    v_fmac_f32 v36, v112, v108
    v_mfma_f32_16x16x32_bf16 v[24:27], v[172:175], v[80:83], v[24:27]
    buffer_load_dword v116, v117, s[16:19], 0 offen sc1
    v_mfma_f32_16x16x32_bf16 v[32:35], v[176:179], v[80:83], v[32:35]
    s_lshl_b32 s41, s47, 15
    v_fmac_f32 v37, v112, v109
    v_fmac_f32 v38, v112, v110
    v_mfma_f32_16x16x32_bf16 v[28:31], v[176:179], v[76:79], v[28:31]
    s_lshl_b32 s46, s47, 10
    ds_read_b128 v[96:99], v3 offset:55296
    v_fmac_f32 v41, v113, v109
    v_mfma_f32_16x16x32_bf16 v[36:39], v[180:183], v[76:79], v[36:39]
    s_sub_u32 s46, s55, s46
    v_mfma_f32_16x16x32_bf16 v[40:43], v[180:183], v[80:83], v[40:43]
    s_waitcnt lgkmcnt(2)
    v_mfma_f32_16x16x32_bf16 v[20:23], v[184:187], v[84:87], v[20:23]
    s_nop 0
    ds_read_b128 v[68:71], v2 offset:57344
    v_fmac_f32 v39, v112, v111
    v_mfma_f32_16x16x32_bf16 v[24:27], v[184:187], v[88:91], v[24:27]
    v_fmac_f32 v42, v113, v110
    v_fmac_f32 v43, v113, v111
    v_mfma_f32_16x16x32_bf16 v[32:35], v[188:191], v[88:91], v[32:35]
    v_mfma_f32_16x16x32_bf16 v[28:31], v[188:191], v[84:87], v[28:31]
    ds_read_b128 v[72:75], v2 offset:59392
    v_mfma_f32_16x16x32_bf16 v[36:39], v[192:195], v[84:87], v[36:39]
    s_waitcnt vmcnt(10)
    s_barrier
    v_mfma_f32_16x16x32_bf16 v[40:43], v[192:195], v[88:91], v[40:43]
    s_waitcnt lgkmcnt(2)
    v_mfma_f32_16x16x32_bf16 v[20:23], v[196:199], v[92:95], v[20:23]
    ds_read_b128 v[76:79], v3 offset:57344
    v_mfma_f32_16x16x32_bf16 v[24:27], v[196:199], v[96:99], v[24:27]
    buffer_store_dword v124, v124, s[16:19], s91 offen sc1
    v_mfma_f32_16x16x32_bf16 v[32:35], v[200:203], v[96:99], v[32:35]
    s_add_u32 s91, s91, 65536
    v_mfma_f32_16x16x32_bf16 v[28:31], v[200:203], v[92:95], v[28:31]
    ds_read_b128 v[80:83], v3 offset:59392
    v_mfma_f32_16x16x32_bf16 v[36:39], v[204:207], v[92:95], v[36:39]
    v_mfma_f32_16x16x32_bf16 v[40:43], v[204:207], v[96:99], v[40:43]
    s_waitcnt lgkmcnt(2)
    v_mfma_f32_16x16x32_bf16 v[20:23], v[208:211], v[68:71], v[20:23]
    ds_read_b128 v[84:87], v2 offset:61440
    v_mfma_f32_16x16x32_bf16 v[24:27], v[208:211], v[72:75], v[24:27]
    v_mfma_f32_16x16x32_bf16 v[32:35], v[212:215], v[72:75], v[32:35]
    v_mfma_f32_16x16x32_bf16 v[28:31], v[212:215], v[68:71], v[28:31]
    ds_read_b128 v[88:91], v2 offset:63488
    v_mfma_f32_16x16x32_bf16 v[36:39], v[216:219], v[68:71], v[36:39]
    v_mfma_f32_16x16x32_bf16 v[40:43], v[216:219], v[72:75], v[40:43]
    s_waitcnt lgkmcnt(2)
    v_mfma_f32_16x16x32_bf16 v[20:23], v[220:223], v[76:79], v[20:23]
    ds_read_b128 v[92:95], v3 offset:61440
    v_mfma_f32_16x16x32_bf16 v[24:27], v[220:223], v[80:83], v[24:27]
    v_mfma_f32_16x16x32_bf16 v[32:35], v[224:227], v[80:83], v[32:35]
    v_mfma_f32_16x16x32_bf16 v[28:31], v[224:227], v[76:79], v[28:31]
    ds_read_b128 v[96:99], v3 offset:63488
    v_mfma_f32_16x16x32_bf16 v[36:39], v[228:231], v[76:79], v[36:39]
    v_mfma_f32_16x16x32_bf16 v[40:43], v[228:231], v[80:83], v[40:43]
    s_waitcnt lgkmcnt(2)
    v_mfma_f32_16x16x32_bf16 v[20:23], v[232:235], v[84:87], v[20:23]
    ds_read_b128 v[68:71], v4 offset:0
    v_mfma_f32_16x16x32_bf16 v[24:27], v[232:235], v[88:91], v[24:27]
    v_mfma_f32_16x16x32_bf16 v[32:35], v[236:239], v[88:91], v[32:35]
    v_mfma_f32_16x16x32_bf16 v[28:31], v[236:239], v[84:87], v[28:31]
    ds_read_b128 v[72:75], v4 offset:2048
    v_mfma_f32_16x16x32_bf16 v[36:39], v[240:243], v[84:87], v[36:39]
    v_mfma_f32_16x16x32_bf16 v[40:43], v[240:243], v[88:91], v[40:43]
    s_waitcnt lgkmcnt(2)
    v_mfma_f32_16x16x32_bf16 v[20:23], v[244:247], v[92:95], v[20:23]
    ds_read_b128 v[76:79], v5 offset:0
    v_mfma_f32_16x16x32_bf16 v[24:27], v[244:247], v[96:99], v[24:27]
    v_mfma_f32_16x16x32_bf16 v[32:35], v[248:251], v[96:99], v[32:35]
    v_mfma_f32_16x16x32_bf16 v[28:31], v[248:251], v[92:95], v[28:31]
    ds_read_b128 v[80:83], v5 offset:2048
    v_mfma_f32_16x16x32_bf16 v[36:39], v[252:255], v[92:95], v[36:39]
    s_add_u32 s36, s36, 1
    v_mfma_f32_16x16x32_bf16 v[40:43], v[252:255], v[96:99], v[40:43]
    s_waitcnt lgkmcnt(2)
    s_cmp_eq_u32 s36, 32
    s_cbranch_scc1 L_q_done
L_q_b1:
    v_mfma_f32_16x16x32_bf16 v[44:47], a[0:3], v[68:71], 0
    ds_read_b128 v[84:87], v4 offset:4096
    v_mul_f32 v20, v20, v114
    v_mfma_f32_16x16x32_bf16 v[48:51], a[0:3], v[72:75], 0
    v_mul_f32 v21, v21, v114
    v_mul_f32 v22, v22, v114
    v_mfma_f32_16x16x32_bf16 v[56:59], a[4:7], v[72:75], 0
    v_mul_f32 v23, v23, v114
    v_cvt_pk_bf16_f32 v20, v20, v21
    v_mfma_f32_16x16x32_bf16 v[52:55], a[4:7], v[68:71], 0
    ds_read_b128 v[88:91], v4 offset:6144
    v_cvt_pk_bf16_f32 v21, v22, v23
    v_mfma_f32_16x16x32_bf16 v[60:63], a[8:11], v[68:71], 0
    ds_write_b64 v7, v[20:21] offset:0
    v_mfma_f32_16x16x32_bf16 v[64:67], a[8:11], v[72:75], 0
    s_waitcnt lgkmcnt(3)
    v_mul_f32 v24, v24, v115
    v_mul_f32 v25, v25, v115
    v_mfma_f32_16x16x32_bf16 v[44:47], a[12:15], v[76:79], v[44:47]
    ds_read_b128 v[92:95], v5 offset:4096
    v_mul_f32 v26, v26, v115
    v_mfma_f32_16x16x32_bf16 v[48:51], a[12:15], v[80:83], v[48:51]
    v_mul_f32 v27, v27, v115
    v_cvt_pk_bf16_f32 v24, v24, v25
    v_mfma_f32_16x16x32_bf16 v[56:59], a[16:19], v[80:83], v[56:59]
    v_cvt_pk_bf16_f32 v25, v26, v27
    v_mfma_f32_16x16x32_bf16 v[52:55], a[16:19], v[76:79], v[52:55]
    ds_read_b128 v[96:99], v5 offset:6144
    v_mfma_f32_16x16x32_bf16 v[60:63], a[20:23], v[76:79], v[60:63]
    ds_write_b64 v7, v[24:25] offset:6144
    v_mfma_f32_16x16x32_bf16 v[64:67], a[20:23], v[80:83], v[64:67]
    s_waitcnt lgkmcnt(4)
    v_mul_f32 v28, v28, v114
    v_mul_f32 v29, v29, v114
    v_mfma_f32_16x16x32_bf16 v[44:47], a[24:27], v[84:87], v[44:47]
    ds_read_b128 v[68:71], v4 offset:8192
    v_mul_f32 v30, v30, v114
    v_mfma_f32_16x16x32_bf16 v[48:51], a[24:27], v[88:91], v[48:51]
    v_mul_f32 v31, v31, v114
    v_cvt_pk_bf16_f32 v28, v28, v29
    v_mfma_f32_16x16x32_bf16 v[56:59], a[28:31], v[88:91], v[56:59]
    v_cvt_pk_bf16_f32 v29, v30, v31
    v_mfma_f32_16x16x32_bf16 v[52:55], a[28:31], v[84:87], v[52:55]
    ds_read_b128 v[72:75], v4 offset:10240
    v_mfma_f32_16x16x32_bf16 v[60:63], a[32:35], v[84:87], v[60:63]
    ds_write_b64 v7, v[28:29] offset:1024
    v_mfma_f32_16x16x32_bf16 v[64:67], a[32:35], v[88:91], v[64:67]
    s_waitcnt lgkmcnt(4)
    v_mul_f32 v32, v32, v115
    v_mul_f32 v33, v33, v115
    v_mfma_f32_16x16x32_bf16 v[44:47], a[36:39], v[92:95], v[44:47]
    ds_read_b128 v[76:79], v5 offset:8192
    v_mul_f32 v34, v34, v115
    v_mfma_f32_16x16x32_bf16 v[48:51], a[36:39], v[96:99], v[48:51]
    v_mul_f32 v35, v35, v115
    v_cvt_pk_bf16_f32 v32, v32, v33
    v_mfma_f32_16x16x32_bf16 v[56:59], a[40:43], v[96:99], v[56:59]
    v_cvt_pk_bf16_f32 v33, v34, v35
    v_mfma_f32_16x16x32_bf16 v[52:55], a[40:43], v[92:95], v[52:55]
    ds_read_b128 v[80:83], v5 offset:10240
    v_mfma_f32_16x16x32_bf16 v[60:63], a[44:47], v[92:95], v[60:63]
    ds_write_b64 v7, v[32:33] offset:7168
    v_mfma_f32_16x16x32_bf16 v[64:67], a[44:47], v[96:99], v[64:67]
    s_waitcnt lgkmcnt(4)
    v_mul_f32 v36, v36, v114
    v_mul_f32 v37, v37, v114
    v_mfma_f32_16x16x32_bf16 v[44:47], a[48:51], v[68:71], v[44:47]
    s_waitcnt vmcnt(1)
    ds_read_b128 v[84:87], v4 offset:12288
    v_cmp_ne_u32 vcc, 0, v116
    v_mfma_f32_16x16x32_bf16 v[48:51], a[48:51], v[72:75], v[48:51]
    v_mul_f32 v38, v38, v114
    v_mul_f32 v39, v39, v114
    v_mfma_f32_16x16x32_bf16 v[56:59], a[52:55], v[72:75], v[56:59]
    s_cbranch_vccnz L_spin9
L_back10:
    v_cvt_pk_bf16_f32 v36, v36, v37
    v_cvt_pk_bf16_f32 v37, v38, v39
    v_mfma_f32_16x16x32_bf16 v[52:55], a[52:55], v[68:71], v[52:55]
    ds_read_b128 v[88:91], v4 offset:14336
    v_mfma_f32_16x16x32_bf16 v[60:63], a[56:59], v[68:71], v[60:63]
    ds_write_b64 v8, v[36:37] offset:2048
    v_mfma_f32_16x16x32_bf16 v[64:67], a[56:59], v[72:75], v[64:67]
    s_waitcnt lgkmcnt(4)
    v_mul_f32 v40, v40, v115
    v_mul_f32 v41, v41, v115
    v_mfma_f32_16x16x32_bf16 v[44:47], a[60:63], v[76:79], v[44:47]
    ds_read_b128 v[92:95], v5 offset:12288
    v_mul_f32 v42, v42, v115
    v_mfma_f32_16x16x32_bf16 v[48:51], a[60:63], v[80:83], v[48:51]
    v_mul_f32 v43, v43, v115
    v_cvt_pk_bf16_f32 v40, v40, v41
    v_mfma_f32_16x16x32_bf16 v[56:59], a[64:67], v[80:83], v[56:59]
    v_cvt_pk_bf16_f32 v41, v42, v43
    v_mfma_f32_16x16x32_bf16 v[52:55], a[64:67], v[76:79], v[52:55]
    ds_read_b128 v[96:99], v5 offset:14336
    v_mfma_f32_16x16x32_bf16 v[60:63], a[68:71], v[76:79], v[60:63]
    ds_write_b64 v8, v[40:41] offset:8192
    v_mfma_f32_16x16x32_bf16 v[64:67], a[68:71], v[80:83], v[64:67]
    s_waitcnt lgkmcnt(4)
    v_mfma_f32_16x16x32_bf16 v[44:47], a[72:75], v[84:87], v[44:47]
    ds_read_b128 v[68:71], v4 offset:16384
    v_mfma_f32_16x16x32_bf16 v[48:51], a[72:75], v[88:91], v[48:51]
    v_mfma_f32_16x16x32_bf16 v[56:59], a[76:79], v[88:91], v[56:59]
    s_waitcnt lgkmcnt(1)
    s_barrier
    v_mfma_f32_16x16x32_bf16 v[52:55], a[76:79], v[84:87], v[52:55]
    ds_read_b128 v[72:75], v4 offset:18432
    v_mfma_f32_16x16x32_bf16 v[60:63], a[80:83], v[84:87], v[60:63]
    ds_read_b128 v[20:23], v10 offset:0
    v_mfma_f32_16x16x32_bf16 v[64:67], a[80:83], v[88:91], v[64:67]
    s_waitcnt lgkmcnt(4)
    ds_read_b128 v[24:27], v9 offset:1024
    v_mfma_f32_16x16x32_bf16 v[44:47], a[84:87], v[92:95], v[44:47]
    ds_read_b128 v[76:79], v5 offset:16384
    v_mfma_f32_16x16x32_bf16 v[48:51], a[84:87], v[96:99], v[48:51]
    ds_read_b128 v[28:31], v10 offset:1024
    s_add_u32 m0, s43, 0
    v_mfma_f32_16x16x32_bf16 v[56:59], a[88:91], v[96:99], v[56:59]
    buffer_load_dwordx4 v6, s[8:11], s41 offen offset:0 sc1 lds
    v_mfma_f32_16x16x32_bf16 v[52:55], a[88:91], v[92:95], v[52:55]
    s_add_u32 m0, s43, 3968
    ds_read_b128 v[80:83], v5 offset:18432
    v_mfma_f32_16x16x32_bf16 v[60:63], a[92:95], v[92:95], v[60:63]
    ds_read_b64_tr_b16 v[32:33], v9 offset:2048
    v_mfma_f32_16x16x32_bf16 v[64:67], a[92:95], v[96:99], v[64:67]
    s_waitcnt lgkmcnt(6)
    ds_read_b64_tr_b16 v[34:35], v10 offset:2048
    s_waitcnt lgkmcnt(3)
    v_mfma_f32_16x16x32_bf16 v[44:47], a[96:99], v[68:71], v[44:47]
    ds_read_b128 v[84:87], v4 offset:20480
    v_mfma_f32_16x16x32_bf16 v[40:43], v[24:27], v[20:23], 0
    ds_read_b64_tr_b16 v[36:37], v9 offset:2056
    v_mfma_f32_16x16x32_bf16 v[118:121], v[28:31], v[20:23], 0
    ds_read_b64_tr_b16 v[38:39], v10 offset:2056
    v_mfma_f32_16x16x32_bf16 v[48:51], a[96:99], v[72:75], v[48:51]
    v_mfma_f32_16x16x32_bf16 v[56:59], a[100:103], v[72:75], v[56:59]
    buffer_load_dwordx4 v6, s[8:11], s41 offen offset:128 sc1 lds
    v_mfma_f32_16x16x32_bf16 v[52:55], a[100:103], v[68:71], v[52:55]
    s_add_u32 m0, s43, 7936
    ds_read_b128 v[88:91], v4 offset:22528
    v_cndmask_b32 v40, v40, v41, s[56:57]
    v_mfma_f32_16x16x32_bf16 v[60:63], a[104:107], v[68:71], v[60:63]
    v_cndmask_b32 v42, v42, v43, s[56:57]
    v_cndmask_b32 v118, v118, v119, s[56:57]
    v_mfma_f32_16x16x32_bf16 v[64:67], a[104:107], v[72:75], v[64:67]
    s_waitcnt lgkmcnt(6)
    v_cndmask_b32 v120, v120, v121, s[56:57]
    v_cndmask_b32 v40, v18, v40, s[62:63]
    v_mfma_f32_16x16x32_bf16 v[44:47], a[108:111], v[76:79], v[44:47]
    ds_read_b128 v[92:95], v5 offset:20480
    v_cndmask_b32 v42, v18, v42, s[62:63]
    v_mfma_f32_16x16x32_bf16 v[48:51], a[108:111], v[80:83], v[48:51]
    v_cndmask_b32 v22, v40, v118, s[58:59]
    v_cndmask_b32 v23, v42, v120, s[60:61]
    v_mfma_f32_16x16x32_bf16 v[56:59], a[112:115], v[80:83], v[56:59]
    buffer_load_dwordx4 v6, s[8:11], s41 offen offset:256 sc1 lds
    v_mfma_f32_16x16x32_bf16 v[52:55], a[112:115], v[76:79], v[52:55]
    s_add_u32 m0, s43, 11904
    ds_read_b128 v[96:99], v5 offset:22528
    v_max_f32 v20, v22, v23
    v_mfma_f32_16x16x32_bf16 v[60:63], a[116:119], v[76:79], v[60:63]
    v_mov_b32 v21, v20
    v_mfma_f32_16x16x32_bf16 v[64:67], a[116:119], v[80:83], v[64:67]
    s_waitcnt lgkmcnt(2)
    v_permlane16_swap_b32 v20, v21
    v_mfma_f32_16x16x32_bf16 v[44:47], a[120:123], v[84:87], v[44:47]
    ds_read_b128 v[68:71], v4 offset:24576
    v_max_f32 v20, v20, v21
    v_mfma_f32_16x16x32_bf16 v[48:51], a[120:123], v[88:91], v[48:51]
    v_mov_b32 v21, v20
    v_mfma_f32_16x16x32_bf16 v[56:59], a[124:127], v[88:91], v[56:59]
    buffer_load_dwordx4 v6, s[8:11], s41 offen offset:384 sc1 lds
    v_mfma_f32_16x16x32_bf16 v[52:55], a[124:127], v[84:87], v[52:55]
    s_add_u32 m0, s43, 15872
    ds_read_b128 v[72:75], v4 offset:26624
    v_mfma_f32_16x16x32_bf16 v[60:63], a[128:131], v[84:87], v[60:63]
    v_permlane32_swap_b32 v20, v21
    v_mfma_f32_16x16x32_bf16 v[64:67], a[128:131], v[88:91], v[64:67]
    s_waitcnt lgkmcnt(2)
    v_max_f32 v20, v20, v21
    v_mul_f32 v20, s86, v20
    v_mfma_f32_16x16x32_bf16 v[44:47], a[132:135], v[92:95], v[44:47]
    ds_read_b128 v[76:79], v5 offset:24576
    v_fma_f32 v22, v22, s86, -v20
    v_mfma_f32_16x16x32_bf16 v[48:51], a[132:135], v[96:99], v[48:51]
    v_fma_f32 v23, v23, s86, -v20
    v_mfma_f32_16x16x32_bf16 v[56:59], a[136:139], v[96:99], v[56:59]
    buffer_load_dwordx4 v6, s[8:11], s41 offen offset:512 sc1 lds
    v_mfma_f32_16x16x32_bf16 v[52:55], a[136:139], v[92:95], v[52:55]
    s_add_u32 m0, s43, 19840
    ds_read_b128 v[80:83], v5 offset:26624
    v_mfma_f32_16x16x32_bf16 v[60:63], a[140:143], v[92:95], v[60:63]
    v_exp_f32 v22, v22
    v_mfma_f32_16x16x32_bf16 v[64:67], a[140:143], v[96:99], v[64:67]
    s_waitcnt lgkmcnt(2)
    v_exp_f32 v23, v23
    v_mfma_f32_16x16x32_bf16 v[44:47], a[144:147], v[68:71], v[44:47]
    ds_read_b128 v[84:87], v4 offset:28672
    v_cvt_pk_bf16_f32 v28, v22, v23
    v_mfma_f32_16x16x32_bf16 v[48:51], a[144:147], v[72:75], v[48:51]
    v_perm_b32 v24, v28, v28, v14
    v_perm_b32 v25, v28, v28, v15
    v_mfma_f32_16x16x32_bf16 v[56:59], a[148:151], v[72:75], v[56:59]
    buffer_load_dwordx4 v6, s[8:11], s41 offen offset:640 sc1 lds
    v_mfma_f32_16x16x32_bf16 v[52:55], a[148:151], v[68:71], v[52:55]
    s_add_u32 m0, s43, 23808
    ds_read_b128 v[88:91], v4 offset:30720
    v_perm_b32 v26, v28, v28, v16
    v_mfma_f32_16x16x32_bf16 v[60:63], a[152:155], v[68:71], v[60:63]
    v_perm_b32 v27, v28, v28, v17
    v_add_f32 v20, v22, v23
    v_mfma_f32_16x16x32_bf16 v[64:67], a[152:155], v[72:75], v[64:67]
    s_waitcnt lgkmcnt(2)
    v_mov_b32 v21, v20
    s_waitcnt lgkmcnt(9)
    v_mfma_f32_16x16x32_bf16 v[44:47], a[156:159], v[76:79], v[44:47]
    ds_read_b128 v[92:95], v5 offset:28672
    v_mfma_f32_16x16x32_bf16 v[40:43], v[32:35], v[24:27], 0
    v_mfma_f32_16x16x32_bf16 v[118:121], v[36:39], v[24:27], 0
    v_permlane16_swap_b32 v20, v21
    v_mfma_f32_16x16x32_bf16 v[48:51], a[156:159], v[80:83], v[48:51]
    v_add_f32 v20, v20, v21
    v_mov_b32 v21, v20
    v_mfma_f32_16x16x32_bf16 v[56:59], a[160:163], v[80:83], v[56:59]
    buffer_load_dwordx4 v6, s[8:11], s41 offen offset:768 sc1 lds
    v_mfma_f32_16x16x32_bf16 v[52:55], a[160:163], v[76:79], v[52:55]
    s_add_u32 m0, s43, 27776
    ds_read_b128 v[96:99], v5 offset:30720
    v_mfma_f32_16x16x32_bf16 v[60:63], a[164:167], v[76:79], v[60:63]
    v_permlane32_swap_b32 v20, v21
    v_mfma_f32_16x16x32_bf16 v[64:67], a[164:167], v[80:83], v[64:67]
    s_waitcnt lgkmcnt(2)
    v_add_f32 v20, v20, v21
    v_mfma_f32_16x16x32_bf16 v[44:47], a[168:171], v[84:87], v[44:47]
    ds_read_b128 v[68:71], v4 offset:32768
    v_mfma_f32_16x16x32_bf16 v[48:51], a[168:171], v[88:91], v[48:51]
    v_rcp_f32 v20, v20
    v_mfma_f32_16x16x32_bf16 v[56:59], a[172:175], v[88:91], v[56:59]
    buffer_load_dwordx4 v6, s[8:11], s41 offen offset:896 sc1 lds
    v_mfma_f32_16x16x32_bf16 v[52:55], a[172:175], v[84:87], v[52:55]
    s_add_u32 m0, s43, 31744
    ds_read_b128 v[72:75], v4 offset:34816
    v_mul_f32 v40, v40, v20
    v_mfma_f32_16x16x32_bf16 v[60:63], a[176:179], v[84:87], v[60:63]
    v_mul_f32 v41, v41, v20
    v_mul_f32 v42, v42, v20
    v_mfma_f32_16x16x32_bf16 v[64:67], a[176:179], v[88:91], v[64:67]
    s_waitcnt lgkmcnt(2)
    v_mul_f32 v43, v43, v20
    v_cvt_pk_bf16_f32 v28, v40, v41
    v_mfma_f32_16x16x32_bf16 v[44:47], a[180:183], v[92:95], v[44:47]
    ds_read_b128 v[76:79], v5 offset:32768
    v_cvt_pk_bf16_f32 v29, v42, v43
    v_mfma_f32_16x16x32_bf16 v[48:51], a[180:183], v[96:99], v[48:51]
    v_mul_f32 v118, v118, v20
    v_mul_f32 v119, v119, v20
    v_mfma_f32_16x16x32_bf16 v[56:59], a[184:187], v[96:99], v[56:59]
    buffer_load_dwordx4 v6, s[8:11], s41 offen offset:1024 sc1 lds
    v_mfma_f32_16x16x32_bf16 v[52:55], a[184:187], v[92:95], v[52:55]
    s_add_u32 m0, s43, 35712
    ds_read_b128 v[80:83], v5 offset:34816
    v_mul_f32 v120, v120, v20
    v_mfma_f32_16x16x32_bf16 v[60:63], a[188:191], v[92:95], v[60:63]
    v_mul_f32 v121, v121, v20
    v_cvt_pk_bf16_f32 v30, v118, v119
    v_mfma_f32_16x16x32_bf16 v[64:67], a[188:191], v[96:99], v[64:67]
    s_waitcnt lgkmcnt(2)
    v_cvt_pk_bf16_f32 v31, v120, v121
    v_mfma_f32_16x16x32_bf16 v[44:47], a[192:195], v[68:71], v[44:47]
    ds_read_b128 v[84:87], v4 offset:36864
    v_mfma_f32_16x16x32_bf16 v[48:51], a[192:195], v[72:75], v[48:51]
    buffer_store_dwordx4 v[28:31], v1, s[16:19], s44 offen sc1
    v_mfma_f32_16x16x32_bf16 v[56:59], a[196:199], v[72:75], v[56:59]
    buffer_load_dwordx4 v6, s[8:11], s41 offen offset:1152 sc1 lds
    v_mfma_f32_16x16x32_bf16 v[52:55], a[196:199], v[68:71], v[52:55]
    s_add_u32 m0, s43, 39680
    ds_read_b128 v[88:91], v4 offset:38912
    s_add_u32 s90, s90, 0x10000
    v_mfma_f32_16x16x32_bf16 v[60:63], a[200:203], v[68:71], v[60:63]
    s_and_b32 s44, s90, 0xffffffff
    ds_read_b64 v[32:33], v13 offset:2048
    s_bitcmp1_b32 s26, s36
    v_mfma_f32_16x16x32_bf16 v[64:67], a[200:203], v[72:75], v[64:67]
    s_waitcnt lgkmcnt(3)
    ds_read_b64 v[34:35], v13 offset:2176
    s_cselect_b64 s[62:63], 0, -1
    v_mfma_f32_16x16x32_bf16 v[44:47], a[204:207], v[76:79], v[44:47]
    s_cmp_eq_u32 s36, 16
    ds_read_b128 v[92:95], v5 offset:36864
    s_cselect_b32 s49, s87, 0
    v_mfma_f32_16x16x32_bf16 v[48:51], a[204:207], v[80:83], v[48:51]
    ds_read_b64 v[36:37], v13 offset:2304
    v_subrev_u32 v9, s49, v9
    v_mfma_f32_16x16x32_bf16 v[56:59], a[208:211], v[80:83], v[56:59]
    buffer_load_dwordx4 v6, s[8:11], s41 offen offset:1280 sc1 lds
    v_mfma_f32_16x16x32_bf16 v[52:55], a[208:211], v[76:79], v[52:55]
    s_add_u32 m0, s43, 43648
    ds_read_b128 v[96:99], v5 offset:38912
    v_mfma_f32_16x16x32_bf16 v[60:63], a[212:215], v[76:79], v[60:63]
    ds_read_b64 v[38:39], v13 offset:2432
    v_mfma_f32_16x16x32_bf16 v[64:67], a[212:215], v[80:83], v[64:67]
    s_waitcnt lgkmcnt(6)
    v_mfma_f32_16x16x32_bf16 v[44:47], a[216:219], v[84:87], v[44:47]
    ds_read_b128 v[68:71], v4 offset:40960
    v_mfma_f32_16x16x32_bf16 v[48:51], a[216:219], v[88:91], v[48:51]
    v_mfma_f32_16x16x32_bf16 v[56:59], a[220:223], v[88:91], v[56:59]
    buffer_load_dwordx4 v6, s[8:11], s41 offen offset:1408 sc1 lds
    v_mfma_f32_16x16x32_bf16 v[52:55], a[220:223], v[84:87], v[52:55]
    s_add_u32 m0, s43, 47616
    ds_read_b128 v[72:75], v4 offset:43008
    s_waitcnt lgkmcnt(2)
    v_mfma_f32_16x16x32_bf16 v[60:63], a[224:227], v[84:87], v[60:63]
    v_add_f32 v40, v36, v38
    v_add_f32 v41, v37, v39
    v_mfma_f32_16x16x32_bf16 v[64:67], a[224:227], v[88:91], v[64:67]
    s_waitcnt lgkmcnt(3)
    v_add_f32 v32, v32, v34
    v_add_f32 v33, v33, v35
    v_mfma_f32_16x16x32_bf16 v[44:47], a[228:231], v[92:95], v[44:47]
    ds_read_b128 v[76:79], v5 offset:40960
    v_add_f32 v32, v32, v40
    v_mfma_f32_16x16x32_bf16 v[48:51], a[228:231], v[96:99], v[48:51]
    v_add_f32 v33, v33, v41
    v_mov_b32 v40, v32
    v_mfma_f32_16x16x32_bf16 v[56:59], a[232:235], v[96:99], v[56:59]
    buffer_load_dwordx4 v6, s[8:11], s41 offen offset:1536 sc1 lds
    v_mfma_f32_16x16x32_bf16 v[52:55], a[232:235], v[92:95], v[52:55]
    s_add_u32 m0, s43, 51584
    ds_read_b128 v[80:83], v5 offset:43008
    v_mov_b32 v41, v33
    v_mfma_f32_16x16x32_bf16 v[60:63], a[236:239], v[92:95], v[60:63]
    v_permlane32_swap_b32 v32, v40
    v_mfma_f32_16x16x32_bf16 v[64:67], a[236:239], v[96:99], v[64:67]
    s_waitcnt lgkmcnt(2)
    v_permlane32_swap_b32 v33, v41
    v_mfma_f32_16x16x32_bf16 v[44:47], a[240:243], v[68:71], v[44:47]
    ds_read_b128 v[84:87], v4 offset:45056
    v_add_f32 v32, v32, v40
    v_mfma_f32_16x16x32_bf16 v[48:51], a[240:243], v[72:75], v[48:51]
    v_add_f32 v33, v33, v41
    v_mul_f32 v112, 0xba800000, v32
    v_mfma_f32_16x16x32_bf16 v[56:59], a[244:247], v[72:75], v[56:59]
    buffer_load_dwordx4 v6, s[8:11], s41 offen offset:1664 sc1 lds
    v_mfma_f32_16x16x32_bf16 v[52:55], a[244:247], v[68:71], v[52:55]
    s_add_u32 m0, s43, 55552
    ds_read_b128 v[88:91], v4 offset:47104
    v_mul_f32 v33, 0x3a800000, v33
    v_mfma_f32_16x16x32_bf16 v[60:63], a[248:251], v[68:71], v[60:63]
    v_fma_f32 v33, -v112, v112, v33
    v_mov_b32 v113, v112
    v_mfma_f32_16x16x32_bf16 v[64:67], a[248:251], v[72:75], v[64:67]
    s_waitcnt lgkmcnt(2)
    v_max_f32 v33, 0, v33
    v_add_f32 v33, 0x3727c5ac, v33
    v_mfma_f32_16x16x32_bf16 v[44:47], a[252:255], v[76:79], v[44:47]
    ds_read_b128 v[92:95], v5 offset:45056
    v_mfma_f32_16x16x32_bf16 v[48:51], a[252:255], v[80:83], v[48:51]
    v_rsq_f32 v114, v33
    v_mfma_f32_16x16x32_bf16 v[56:59], v[128:131], v[80:83], v[56:59]
    buffer_load_dwordx4 v6, s[8:11], s41 offen offset:1792 sc1 lds
    v_mfma_f32_16x16x32_bf16 v[52:55], v[128:131], v[76:79], v[52:55]
    s_add_u32 m0, s43, 59520
    ds_read_b128 v[96:99], v5 offset:47104
    v_mfma_f32_16x16x32_bf16 v[60:63], v[132:135], v[76:79], v[60:63]
    v_permlane16_swap_b32 v112, v113
    v_mfma_f32_16x16x32_bf16 v[64:67], v[132:135], v[80:83], v[64:67]
    s_waitcnt lgkmcnt(2)
    v_mov_b32 v115, v114
    v_fmac_f32 v48, v113, v100
    v_mfma_f32_16x16x32_bf16 v[44:47], v[136:139], v[84:87], v[44:47]
    ds_read_b128 v[68:71], v4 offset:49152
    v_fmac_f32 v52, v112, v104
    v_mfma_f32_16x16x32_bf16 v[48:51], v[136:139], v[88:91], v[48:51]
    v_permlane16_swap_b32 v114, v115
    v_mfma_f32_16x16x32_bf16 v[56:59], v[140:143], v[88:91], v[56:59]
    buffer_load_dwordx4 v6, s[8:11], s41 offen offset:1920 sc1 lds
    v_mfma_f32_16x16x32_bf16 v[52:55], v[140:143], v[84:87], v[52:55]
    s_add_u32 m0, s52, 90112
    ds_read_b128 v[72:75], v4 offset:51200
    v_fmac_f32 v44, v112, v100
    v_mfma_f32_16x16x32_bf16 v[60:63], v[144:147], v[84:87], v[60:63]
    v_fmac_f32 v45, v112, v101
    v_fmac_f32 v46, v112, v102
    v_mfma_f32_16x16x32_bf16 v[64:67], v[144:147], v[88:91], v[64:67]
    s_waitcnt lgkmcnt(2)
    v_fmac_f32 v49, v113, v101
    v_fmac_f32 v50, v113, v102
    v_mfma_f32_16x16x32_bf16 v[44:47], v[148:151], v[92:95], v[44:47]
    ds_read_b128 v[76:79], v5 offset:49152
    v_fmac_f32 v53, v112, v105
    v_mfma_f32_16x16x32_bf16 v[48:51], v[148:151], v[96:99], v[48:51]
    v_fmac_f32 v54, v112, v106
    v_fmac_f32 v55, v112, v107
    v_mfma_f32_16x16x32_bf16 v[56:59], v[152:155], v[96:99], v[56:59]
    buffer_load_dwordx4 v1, s[16:19], s46 offen sc1 lds
    v_mfma_f32_16x16x32_bf16 v[52:55], v[152:155], v[92:95], v[52:55]
    s_cmp_eq_u32 s36, s97
    ds_read_b128 v[80:83], v5 offset:51200
    v_med3_i32 v117, s45, 0, v12
    v_mfma_f32_16x16x32_bf16 v[60:63], v[156:159], v[92:95], v[60:63]
    s_cselect_b32 s47, 30, -2
    v_add_u32 v117, v117, v11
    v_fmac_f32 v47, v112, v103
    v_mfma_f32_16x16x32_bf16 v[64:67], v[156:159], v[96:99], v[64:67]
    s_waitcnt lgkmcnt(2)
    v_fmac_f32 v51, v113, v103
    v_fmac_f32 v56, v113, v104
    v_mfma_f32_16x16x32_bf16 v[44:47], v[160:163], v[68:71], v[44:47]
    s_cselect_b64 s[8:9], s[88:89], s[8:9]
    ds_read_b128 v[84:87], v4 offset:53248
    v_fmac_f32 v57, v113, v105
    v_mfma_f32_16x16x32_bf16 v[48:51], v[160:163], v[72:75], v[48:51]
    s_cselect_b32 s55, 0x543fc00, s55
    v_fmac_f32 v60, v112, v108
    v_fmac_f32 v61, v112, v109
    v_mfma_f32_16x16x32_bf16 v[56:59], v[164:167], v[72:75], v[56:59]
    s_add_u32 s45, s45, 65536
    v_fmac_f32 v62, v112, v110
    v_fmac_f32 v63, v112, v111
    v_mfma_f32_16x16x32_bf16 v[52:55], v[164:167], v[68:71], v[52:55]
    s_add_u32 s50, s50, s47
    ds_read_b128 v[88:91], v4 offset:55296
    v_fmac_f32 v64, v113, v108
    v_mfma_f32_16x16x32_bf16 v[60:63], v[168:171], v[68:71], v[60:63]
    buffer_load_dword v116, v117, s[16:19], 0 offen sc1
    v_mfma_f32_16x16x32_bf16 v[64:67], v[168:171], v[72:75], v[64:67]
    s_waitcnt lgkmcnt(2)
    v_fmac_f32 v58, v113, v106
    v_fmac_f32 v59, v113, v107
    v_mfma_f32_16x16x32_bf16 v[44:47], v[172:175], v[76:79], v[44:47]
    s_max_i32 s47, s50, 0
    ds_read_b128 v[92:95], v5 offset:53248
    s_min_i32 s47, s47, s96
    v_mfma_f32_16x16x32_bf16 v[48:51], v[172:175], v[80:83], v[48:51]
    s_lshl_b32 s41, s47, 15
    v_fmac_f32 v65, v113, v109
    v_fmac_f32 v66, v113, v110
    v_mfma_f32_16x16x32_bf16 v[56:59], v[176:179], v[80:83], v[56:59]
    s_lshl_b32 s46, s47, 10
    v_fmac_f32 v67, v113, v111
    s_sub_u32 s46, s55, s46
    v_mfma_f32_16x16x32_bf16 v[52:55], v[176:179], v[76:79], v[52:55]
    ds_read_b128 v[96:99], v5 offset:55296
    v_mfma_f32_16x16x32_bf16 v[60:63], v[180:183], v[76:79], v[60:63]
    v_mfma_f32_16x16x32_bf16 v[64:67], v[180:183], v[80:83], v[64:67]
    s_waitcnt lgkmcnt(2)
    v_mfma_f32_16x16x32_bf16 v[44:47], v[184:187], v[84:87], v[44:47]
    ds_read_b128 v[68:71], v4 offset:57344
    v_mfma_f32_16x16x32_bf16 v[48:51], v[184:187], v[88:91], v[48:51]
    v_mfma_f32_16x16x32_bf16 v[56:59], v[188:191], v[88:91], v[56:59]
    v_mfma_f32_16x16x32_bf16 v[52:55], v[188:191], v[84:87], v[52:55]
    ds_read_b128 v[72:75], v4 offset:59392
    v_mfma_f32_16x16x32_bf16 v[60:63], v[192:195], v[84:87], v[60:63]
    s_waitcnt vmcnt(9)
    s_barrier
    v_mfma_f32_16x16x32_bf16 v[64:67], v[192:195], v[88:91], v[64:67]
    s_waitcnt lgkmcnt(2)
    v_mfma_f32_16x16x32_bf16 v[44:47], v[196:199], v[92:95], v[44:47]
    ds_read_b128 v[76:79], v5 offset:57344
    v_mfma_f32_16x16x32_bf16 v[48:51], v[196:199], v[96:99], v[48:51]
    buffer_store_dword v124, v124, s[16:19], s91 offen sc1
    v_mfma_f32_16x16x32_bf16 v[56:59], v[200:203], v[96:99], v[56:59]
    s_add_u32 s91, s91, 65536
    v_mfma_f32_16x16x32_bf16 v[52:55], v[200:203], v[92:95], v[52:55]
    ds_read_b128 v[80:83], v5 offset:59392
    v_mfma_f32_16x16x32_bf16 v[60:63], v[204:207], v[92:95], v[60:63]
    v_mfma_f32_16x16x32_bf16 v[64:67], v[204:207], v[96:99], v[64:67]
    s_waitcnt lgkmcnt(2)
    v_mfma_f32_16x16x32_bf16 v[44:47], v[208:211], v[68:71], v[44:47]
    ds_read_b128 v[84:87], v4 offset:61440
    v_mfma_f32_16x16x32_bf16 v[48:51], v[208:211], v[72:75], v[48:51]
    v_mfma_f32_16x16x32_bf16 v[56:59], v[212:215], v[72:75], v[56:59]
    v_mfma_f32_16x16x32_bf16 v[52:55], v[212:215], v[68:71], v[52:55]
    ds_read_b128 v[88:91], v4 offset:63488
    v_mfma_f32_16x16x32_bf16 v[60:63], v[216:219], v[68:71], v[60:63]
    v_mfma_f32_16x16x32_bf16 v[64:67], v[216:219], v[72:75], v[64:67]
    s_waitcnt lgkmcnt(2)
    v_mfma_f32_16x16x32_bf16 v[44:47], v[220:223], v[76:79], v[44:47]
    ds_read_b128 v[92:95], v5 offset:61440
    v_mfma_f32_16x16x32_bf16 v[48:51], v[220:223], v[80:83], v[48:51]
    v_mfma_f32_16x16x32_bf16 v[56:59], v[224:227], v[80:83], v[56:59]
    v_mfma_f32_16x16x32_bf16 v[52:55], v[224:227], v[76:79], v[52:55]
    ds_read_b128 v[96:99], v5 offset:63488
    v_mfma_f32_16x16x32_bf16 v[60:63], v[228:231], v[76:79], v[60:63]
    v_mfma_f32_16x16x32_bf16 v[64:67], v[228:231], v[80:83], v[64:67]
    s_waitcnt lgkmcnt(2)
    v_mfma_f32_16x16x32_bf16 v[44:47], v[232:235], v[84:87], v[44:47]
    ds_read_b128 v[68:71], v2 offset:0
    v_mfma_f32_16x16x32_bf16 v[48:51], v[232:235], v[88:91], v[48:51]
    v_mfma_f32_16x16x32_bf16 v[56:59], v[236:239], v[88:91], v[56:59]
    v_mfma_f32_16x16x32_bf16 v[52:55], v[236:239], v[84:87], v[52:55]
    ds_read_b128 v[72:75], v2 offset:2048
    v_mfma_f32_16x16x32_bf16 v[60:63], v[240:243], v[84:87], v[60:63]
    v_mfma_f32_16x16x32_bf16 v[64:67], v[240:243], v[88:91], v[64:67]
    s_waitcnt lgkmcnt(2)
    v_mfma_f32_16x16x32_bf16 v[44:47], v[244:247], v[92:95], v[44:47]
    ds_read_b128 v[76:79], v3 offset:0
    v_mfma_f32_16x16x32_bf16 v[48:51], v[244:247], v[96:99], v[48:51]
    v_mfma_f32_16x16x32_bf16 v[56:59], v[248:251], v[96:99], v[56:59]
    v_mfma_f32_16x16x32_bf16 v[52:55], v[248:251], v[92:95], v[52:55]
    ds_read_b128 v[80:83], v3 offset:2048
    v_mfma_f32_16x16x32_bf16 v[60:63], v[252:255], v[92:95], v[60:63]
    s_add_u32 s36, s36, 1
    v_mfma_f32_16x16x32_bf16 v[64:67], v[252:255], v[96:99], v[64:67]
    s_waitcnt lgkmcnt(2)
    s_cmp_lt_u32 s36, 32
    s_cbranch_scc1 L_q_b0
L_q_done:
    s_nop 7
    v_mul_f32 v20, v20, v114
    v_mul_f32 v21, v21, v114
    v_mul_f32 v22, v22, v114
    v_mul_f32 v23, v23, v114
    v_cvt_pk_bf16_f32 v20, v20, v21
    v_cvt_pk_bf16_f32 v21, v22, v23
    ds_write_b64 v7, v[20:21] offset:0
    v_mul_f32 v24, v24, v115
    v_mul_f32 v25, v25, v115
    v_mul_f32 v26, v26, v115
    v_mul_f32 v27, v27, v115
    v_cvt_pk_bf16_f32 v24, v24, v25
    v_cvt_pk_bf16_f32 v25, v26, v27
    ds_write_b64 v7, v[24:25] offset:6144
    v_mul_f32 v28, v28, v114
    v_mul_f32 v29, v29, v114
    v_mul_f32 v30, v30, v114
    v_mul_f32 v31, v31, v114
    v_cvt_pk_bf16_f32 v28, v28, v29
    v_cvt_pk_bf16_f32 v29, v30, v31
    ds_write_b64 v7, v[28:29] offset:1024
    v_mul_f32 v32, v32, v115
    v_mul_f32 v33, v33, v115
    v_mul_f32 v34, v34, v115
    v_mul_f32 v35, v35, v115
    v_cvt_pk_bf16_f32 v32, v32, v33
    v_cvt_pk_bf16_f32 v33, v34, v35
    ds_write_b64 v7, v[32:33] offset:7168
    v_mul_f32 v36, v36, v114
    v_mul_f32 v37, v37, v114
    v_mul_f32 v38, v38, v114
    v_mul_f32 v39, v39, v114
    v_cvt_pk_bf16_f32 v36, v36, v37
    v_cvt_pk_bf16_f32 v37, v38, v39
    ds_write_b64 v8, v[36:37] offset:2048
    v_mul_f32 v40, v40, v115
    v_mul_f32 v41, v41, v115
    v_mul_f32 v42, v42, v115
    v_mul_f32 v43, v43, v115
    v_cvt_pk_bf16_f32 v40, v40, v41
    v_cvt_pk_bf16_f32 v41, v42, v43
    ds_write_b64 v8, v[40:41] offset:8192
    s_waitcnt lgkmcnt(0)
    s_barrier
    ds_read_b128 v[20:23], v10 offset:0
    ds_read_b128 v[24:27], v9 offset:1024
    ds_read_b128 v[28:31], v10 offset:1024
    ds_read_b64_tr_b16 v[32:33], v9 offset:2048
    ds_read_b64_tr_b16 v[34:35], v10 offset:2048
    ds_read_b64_tr_b16 v[36:37], v9 offset:2056
    ds_read_b64_tr_b16 v[38:39], v10 offset:2056
    s_waitcnt lgkmcnt(4)
    v_mfma_f32_16x16x32_bf16 v[40:43], v[24:27], v[20:23], 0
    v_mfma_f32_16x16x32_bf16 v[118:121], v[28:31], v[20:23], 0
    s_nop 5
    v_cndmask_b32 v40, v40, v41, s[56:57]
    v_cndmask_b32 v42, v42, v43, s[56:57]
    v_cndmask_b32 v118, v118, v119, s[56:57]
    v_cndmask_b32 v120, v120, v121, s[56:57]
    v_cndmask_b32 v40, v18, v40, s[62:63]
    v_cndmask_b32 v42, v18, v42, s[62:63]
    v_cndmask_b32 v22, v40, v118, s[58:59]
    v_cndmask_b32 v23, v42, v120, s[60:61]
    v_max_f32 v20, v22, v23
    v_mov_b32 v21, v20
    s_nop 1
    v_permlane16_swap_b32 v20, v21
    v_max_f32 v20, v20, v21
    v_mov_b32 v21, v20
    s_nop 1
    v_permlane32_swap_b32 v20, v21
    v_max_f32 v20, v20, v21
    v_mul_f32 v20, s86, v20
    v_fma_f32 v22, v22, s86, -v20
    v_fma_f32 v23, v23, s86, -v20
    v_exp_f32 v22, v22
    v_exp_f32 v23, v23
    s_nop 0
    v_cvt_pk_bf16_f32 v28, v22, v23
    v_perm_b32 v24, v28, v28, v14
    v_perm_b32 v25, v28, v28, v15
    v_perm_b32 v26, v28, v28, v16
    v_perm_b32 v27, v28, v28, v17
    s_waitcnt lgkmcnt(0)
    v_add_f32 v20, v22, v23
    v_mfma_f32_16x16x32_bf16 v[40:43], v[32:35], v[24:27], 0
    v_mfma_f32_16x16x32_bf16 v[118:121], v[36:39], v[24:27], 0
    v_mov_b32 v21, v20
    s_nop 1
    v_permlane16_swap_b32 v20, v21
    v_add_f32 v20, v20, v21
    v_mov_b32 v21, v20
    s_nop 1
    v_permlane32_swap_b32 v20, v21
    v_add_f32 v20, v20, v21
    v_rcp_f32 v20, v20
    s_nop 0
    v_mul_f32 v40, v40, v20
    v_mul_f32 v41, v41, v20
    v_mul_f32 v42, v42, v20
    v_mul_f32 v43, v43, v20
    v_cvt_pk_bf16_f32 v28, v40, v41
    v_cvt_pk_bf16_f32 v29, v42, v43
    v_mul_f32 v118, v118, v20
    v_mul_f32 v119, v119, v20
    v_mul_f32 v120, v120, v20
    v_mul_f32 v121, v121, v20
    v_cvt_pk_bf16_f32 v30, v118, v119
    v_cvt_pk_bf16_f32 v31, v120, v121
    buffer_store_dwordx4 v[28:31], v1, s[16:19], s44 offen sc1
    s_waitcnt vmcnt(0)
    s_barrier
    buffer_store_dword v124, v124, s[16:19], s91 offen sc1
    s_add_u32 s91, s91, 65536
    s_waitcnt vmcnt(0)
    s_endpgm
L_spin1:
    s_mov_b32 s40, 0x20000
L_spin1_l:
    buffer_load_dword v37, v36, s[20:23], 64 offen sc1
    s_sub_u32 s40, s40, 1
    s_waitcnt vmcnt(0)
    v_cmp_eq_u32 vcc, v36, v37
    s_cbranch_scc1 L_back2
    s_cbranch_vccz L_back2
    s_sleep 8
    s_branch L_spin1_l
L_spin3:
    s_mov_b32 s40, 0x20000
L_spin3_l:
    buffer_load_dword v117, v116, s[20:23], 0 offen sc1
    s_sub_u32 s40, s40, 1
    s_waitcnt vmcnt(0)
    v_cmp_eq_u32 vcc, v116, v117
    s_cbranch_scc1 L_back4
    s_cbranch_vccz L_back4
    s_sleep 8
    s_branch L_spin3_l
L_vspin5:
    s_mov_b32 s40, 0x20000
L_vspin5_l:
    s_cmp_lg_u32 s37, 0
    s_cbranch_scc1 L_restart
    s_sleep 4
    buffer_load_dword v38, v124, s[20:23], 0 offen offset:32 sc1
    s_waitcnt vmcnt(0)
    v_readfirstlane_b32 s37, v38
    s_sub_u32 s40, s40, 1
    s_cbranch_scc1 L_vback6
    s_cmp_lg_u32 s37, s3
    s_cbranch_scc1 L_vspin5_l
    s_branch L_vback6
L_spin7:
    s_mov_b32 s40, 0x20000
L_spin7_l:
    buffer_load_dword v116, v117, s[16:19], 0 offen sc1
    s_sub_u32 s40, s40, 1
    s_waitcnt vmcnt(0)
    v_cmp_ne_u32 vcc, 0, v116
    s_cbranch_scc1 L_back8
    s_cbranch_vccz L_back8
    s_sleep 2
    s_branch L_spin7_l
L_spin9:
    s_mov_b32 s40, 0x20000
L_spin9_l:
    buffer_load_dword v116, v117, s[16:19], 0 offen sc1
    s_sub_u32 s40, s40, 1
    s_waitcnt vmcnt(0)
    v_cmp_ne_u32 vcc, 0, v116
    s_cbranch_scc1 L_back10
    s_cbranch_vccz L_back10
    s_sleep 2
    s_branch L_spin9_l
L_other:
    s_lshr_b32 s48, s2, 3
    s_bitcmp1_b32 s2, 0
    s_cbranch_scc1 L_odd
    v_lshrrev_b32 v6, 2, v0
    v_and_b32 v7, 3, v0
    v_lshlrev_b32 v7, 7, v7
    v_lshl_add_u32 v6, v6, 11, v7
    s_and_b32 s48, s48, 15
    s_lshl2_add_u32 s39, s48, s32
    s_lshl_b32 s39, s39, 15
    s_lshl_b32 s37, s47, 9
    s_add_u32 s39, s39, s37
    s_lshr_b32 s37, s48, 2
    s_lshl_b32 s37, s37, 20
    s_and_b32 s38, s48, 3
    s_lshl2_add_u32 s38, s38, s32
    s_lshl_b32 s38, s38, 13
    s_add_u32 s37, s37, s38
    v_lshlrev_b32 v5, 7, v0
    s_waitcnt lgkmcnt(0)
    s_add_u32 s8, s64, 0xe0000
    s_addc_u32 s9, s65, 0
    s_mov_b32 s10, 0x320000
    s_mov_b32 s11, 0x00020000
    buffer_load_dword v251, v5, s[8:11], s37 offen
    s_mov_b32 s12, s66
    s_mov_b32 s13, s67
    s_mov_b32 s14, 0x600000
    s_mov_b32 s15, 0x00020000
    buffer_load_dword v248, v6, s[12:15], s39 offen
    s_add_u32 s39, s39, 2097152
    buffer_load_dword v249, v6, s[12:15], s39 offen
    s_add_u32 s39, s39, 2097152
    buffer_load_dword v250, v6, s[12:15], s39 offen
    s_add_u32 s39, s39, 2097152
    s_mov_b32 s16, s84
    s_mov_b32 s17, s85
    s_mov_b32 s18, 0x5e00000
    s_mov_b32 s19, 0x00020000
    v_min_u32 v124, 1, v0
    v_lshlrev_b32 v124, 30, v124
    s_lshr_b32 s33, s47, 1
    s_lshl_b32 s33, s33, 1
    s_and_b32 s37, s48, 1
    s_add_u32 s33, s33, s37
    s_and_b32 s35, s47, 1
    s_lshl_b32 s35, s35, 3
    s_lshr_b32 s37, s48, 1
    s_add_u32 s35, s35, s37
    s_add_u32 s34, s35, 24
    s_lshl_b32 s91, s33, 6
    s_add_u32 s91, s91, s34
    s_lshl_b32 s91, s91, 7
    s_add_u32 s91, s91, 0x5520000
    s_cmp_eq_u32 s32, 1
    s_cselect_b32 s91, s91, 0x5f00000
    s_mul_i32 s51, s35, 6
    s_min_u32 s51, s51, 106
    s_lshl_b32 s54, s51, 6
    s_mov_b32 s12, s72
    s_mov_b32 s13, s73
    s_mov_b32 s14, 0x700000
    s_mov_b32 s15, 0x00020000
    s_mov_b32 s39, 7168
    v_lshrrev_b32 v68, 3, v0
    v_lshlrev_b32 v69, 2, v0
    v_and_b32 v69, 64, v69
    v_and_b32 v70, 0x70, v1
    v_xor_b32 v69, v69, v70
    v_mad_u32_u24 v56, v68, s39, v69
    v_add_u32 v57, 57344, v56
    v_add_u32 v58, 128, v56
    v_add_u32 v59, 57472, v56
    v_add_u32 v60, 256, v56
    v_add_u32 v61, 57600, v56
    s_mul_i32 s38, s32, 114688
    s_add_u32 s54, s54, s38
    s_lshl_b32 s42, s32, 11
    s_add_u32 m0, s42, 0
    s_nop 0
    buffer_load_dwordx4 v56, s[12:15], s54 offen lds
    s_add_u32 m0, s42, 1024
    s_nop 0
    buffer_load_dwordx4 v57, s[12:15], s54 offen lds
    s_add_u32 m0, s42, 8192
    s_nop 0
    buffer_load_dwordx4 v58, s[12:15], s54 offen lds
    s_add_u32 m0, s42, 9216
    s_nop 0
    buffer_load_dwordx4 v59, s[12:15], s54 offen lds
    s_add_u32 m0, s42, 16384
    s_nop 0
    buffer_load_dwordx4 v60, s[12:15], s54 offen lds
    s_add_u32 m0, s42, 17408
    s_nop 0
    buffer_load_dwordx4 v61, s[12:15], s54 offen lds
    s_add_u32 s54, s54, 458752
    s_add_u32 m0, s42, 24576
    s_nop 0
    buffer_load_dwordx4 v56, s[12:15], s54 offen lds
    s_add_u32 m0, s42, 25600
    s_nop 0
    buffer_load_dwordx4 v57, s[12:15], s54 offen lds
    s_add_u32 m0, s42, 32768
    s_nop 0
    buffer_load_dwordx4 v58, s[12:15], s54 offen lds
    s_add_u32 m0, s42, 33792
    s_nop 0
    buffer_load_dwordx4 v59, s[12:15], s54 offen lds
    s_add_u32 m0, s42, 40960
    s_nop 0
    buffer_load_dwordx4 v60, s[12:15], s54 offen lds
    s_add_u32 m0, s42, 41984
    s_nop 0
    buffer_load_dwordx4 v61, s[12:15], s54 offen lds
    s_add_u32 s54, s54, 458752
    s_add_u32 m0, s42, 49152
    s_nop 0
    buffer_load_dwordx4 v56, s[12:15], s54 offen lds
    s_add_u32 m0, s42, 50176
    s_nop 0
    buffer_load_dwordx4 v57, s[12:15], s54 offen lds
    s_add_u32 m0, s42, 57344
    s_nop 0
    buffer_load_dwordx4 v58, s[12:15], s54 offen lds
    s_add_u32 m0, s42, 58368
    s_nop 0
    buffer_load_dwordx4 v59, s[12:15], s54 offen lds
    s_add_u32 m0, s42, 65536
    s_nop 0
    buffer_load_dwordx4 v60, s[12:15], s54 offen lds
    s_add_u32 m0, s42, 66560
    s_nop 0
    buffer_load_dwordx4 v61, s[12:15], s54 offen lds
    s_add_u32 s54, s54, 458752
    s_add_u32 m0, s42, 73728
    s_nop 0
    buffer_load_dwordx4 v56, s[12:15], s54 offen lds
    s_add_u32 m0, s42, 74752
    s_nop 0
    buffer_load_dwordx4 v57, s[12:15], s54 offen lds
    s_add_u32 m0, s42, 81920
    s_nop 0
    buffer_load_dwordx4 v58, s[12:15], s54 offen lds
    s_add_u32 m0, s42, 82944
    s_nop 0
    buffer_load_dwordx4 v59, s[12:15], s54 offen lds
    s_add_u32 m0, s42, 90112
    s_nop 0
    buffer_load_dwordx4 v60, s[12:15], s54 offen lds
    s_add_u32 m0, s42, 91136
    s_nop 0
    buffer_load_dwordx4 v61, s[12:15], s54 offen lds
    s_add_u32 s54, s54, 458752
    s_add_u32 m0, s42, 98304
    s_nop 0
    buffer_load_dwordx4 v56, s[12:15], s54 offen lds
    s_add_u32 m0, s42, 99328
    s_nop 0
    buffer_load_dwordx4 v57, s[12:15], s54 offen lds
    s_add_u32 m0, s42, 106496
    s_nop 0
    buffer_load_dwordx4 v58, s[12:15], s54 offen lds
    s_add_u32 m0, s42, 107520
    s_nop 0
    buffer_load_dwordx4 v59, s[12:15], s54 offen lds
    s_add_u32 m0, s42, 114688
    s_nop 0
    buffer_load_dwordx4 v60, s[12:15], s54 offen lds
    s_add_u32 m0, s42, 115712
    s_nop 0
    buffer_load_dwordx4 v61, s[12:15], s54 offen lds
    s_add_u32 s54, s54, 458752
    v_lshrrev_b32 v68, 4, v0
    v_bfe_u32 v69, v0, 2, 2
    v_lshl_add_u32 v68, v68, 3, v69
    v_lshlrev_b32 v68, 7, v68
    v_lshrrev_b32 v69, 1, v69
    v_lshl_add_u32 v68, v69, 6, v68
    v_and_b32 v69, 3, v0
    v_lshl_add_u32 v68, v69, 4, v68
    s_lshr_b32 s37, s32, 1
    s_lshl_b32 s37, s37, 13
    s_and_b32 s38, s32, 1
    s_lshl_b32 s38, s38, 6
    s_add_u32 s37, s37, s38
    s_add_u32 s37, s37, 0
    v_xor_b32 v62, s37, v68
    s_lshr_b32 s37, s32, 1
    s_lshl_b32 s37, s37, 13
    s_and_b32 s38, s32, 1
    s_lshl_b32 s38, s38, 6
    s_add_u32 s37, s37, s38
    s_add_u32 s37, s37, 8
    v_xor_b32 v63, s37, v68
    s_lshr_b32 s37, s32, 1
    s_lshl_b32 s37, s37, 6
    s_and_b32 s38, s32, 1
    s_lshl_b32 s38, s38, 3
    s_add_u32 s37, s37, s38
    s_add_u32 s37, s37, 16384
    v_xor_b32 v64, s37, v68
    v_mov_b32 v68, 0x3f803f80
    v_mov_b32 v69, 0x3f803f80
    v_mov_b32 v70, 0x3f803f80
    v_mov_b32 v71, 0x3f803f80
    v_add_u32 v2, 98304, v1
    s_lshl_b32 s37, s33, 6
    s_add_u32 s37, s37, 16
    s_lshl_b32 s37, s37, 7
    v_lshl_add_u32 v5, v0, 7, s37
    s_cmp_eq_u32 s32, 0
    s_cselect_b32 s37, 8, 0
    v_cmp_le_u32 vcc, s37, v0
    s_nop 1
    v_cndmask_b32 v5, v5, 2.0, vcc
    s_lshl_b32 s43, s32, 12
    s_mul_i32 s41, s33, 2097152
    s_add_u32 s41, s41, 0x800000
    s_add_u32 s41, s41, s43
    s_mul_i32 s90, s33, 8388608
    s_add_u32 s90, s90, 0xfc0000
    s_add_u32 s37, s51, s32
    s_lshl_b32 s37, s37, 11
    s_add_u32 s90, s90, s37
    s_lshl_b32 s37, s32, 10
    s_sub_u32 s87, 8192, s37
    s_lshl_b32 s38, s35, 1
    s_lshr_b32 s39, s32, 1
    s_add_u32 s38, s38, s39
    s_cmp_eq_u32 s38, 36
    s_cselect_b32 s88, 0x5e00000, 0
    s_and_b32 s38, s32, 1
    s_lshl_b32 s38, s38, 3
    s_and_b32 s39, s32, 2
    s_lshl_b32 s39, s39, 10
    s_add_u32 s38, s38, s39
    s_add_u32 s38, s38, 65536
    v_add_u32 v3, s38, v1
    s_add_u32 s37, s37, 65536
    v_add_u32 v4, s37, v1
    v_and_b32 v6, 15, v0
    v_lshlrev_b32 v6, 3, v6
    v_lshrrev_b32 v8, 5, v0
    v_lshl_add_u32 v6, v8, 9, v6
    v_and_b32 v8, 16, v0
    v_lshl_add_u32 v6, v8, 6, v6
    v_add_u32 v118, 73728, v6
    s_mul_i32 s46, s33, 65536
    s_add_u32 s46, s46, 0x5440000
    s_add_u32 s55, s46, 63488
    s_and_b32 s52, s32, 1
    s_lshl_b32 s52, s52, 10
    s_mov_b32 s8, s74
    s_mov_b32 s9, s75
    s_mov_b32 s10, 0x1c00
    s_mov_b32 s11, 0x00020000
    v_and_b32 v8, 0x30, v0
    s_add_u32 s37, s51, s32
    s_lshl_b32 s37, s37, 6
    buffer_load_dwordx4 v[16:19], v8, s[8:11], s37 offen
    s_lshr_b32 s37, s32, 1
    s_add_u32 s37, s37, s51
    s_lshl_b32 s37, s37, 6
    s_and_b32 s38, s32, 1
    s_lshl_b32 s38, s38, 3
    s_add_u32 s37, s37, s38
    buffer_load_dwordx2 v[20:21], v8, s[8:11], s37 offen offset:256
    v_add_u32 v65, 0, v62
    v_add_u32 v66, 0, v63
    v_add_u32 v67, 0, v64
    s_waitcnt vmcnt(26)
    s_barrier
    ds_read_b64_tr_b16 a[0:1], v65 offset:0
    ds_read_b64_tr_b16 a[2:3], v65 offset:512
    ds_read_b64_tr_b16 a[4:5], v66 offset:0
    ds_read_b64_tr_b16 a[6:7], v66 offset:512
    ds_read_b64_tr_b16 a[8:9], v67 offset:0
    ds_read_b64_tr_b16 a[10:11], v67 offset:512
    ds_read_b64_tr_b16 a[12:13], v65 offset:4096
    ds_read_b64_tr_b16 a[14:15], v65 offset:4608
    ds_read_b64_tr_b16 a[16:17], v66 offset:4096
    ds_read_b64_tr_b16 a[18:19], v66 offset:4608
    ds_read_b64_tr_b16 a[20:21], v67 offset:4096
    ds_read_b64_tr_b16 a[22:23], v67 offset:4608
    s_add_u32 m0, s42, 122880
    s_nop 0
    buffer_load_dwordx4 v56, s[12:15], s54 offen lds
    s_add_u32 m0, s42, 123904
    s_nop 0
    buffer_load_dwordx4 v57, s[12:15], s54 offen lds
    s_add_u32 m0, s42, 131072
    s_nop 0
    buffer_load_dwordx4 v58, s[12:15], s54 offen lds
    s_add_u32 m0, s42, 132096
    s_nop 0
    buffer_load_dwordx4 v59, s[12:15], s54 offen lds
    s_add_u32 m0, s42, 139264
    s_nop 0
    buffer_load_dwordx4 v60, s[12:15], s54 offen lds
    s_add_u32 m0, s42, 140288
    s_nop 0
    buffer_load_dwordx4 v61, s[12:15], s54 offen lds
    s_add_u32 s54, s54, 458752
    s_waitcnt lgkmcnt(0)
    v_mfma_f32_16x16x32_bf16 v[88:91], a[0:3], v[68:71], 0
    v_mfma_f32_16x16x32_bf16 v[92:95], a[4:7], v[68:71], 0
    v_mfma_f32_16x16x32_bf16 v[96:99], a[8:11], v[68:71], 0
    v_mfma_f32_16x16x32_bf16 v[88:91], a[12:15], v[68:71], v[88:91]
    v_mfma_f32_16x16x32_bf16 v[92:95], a[16:19], v[68:71], v[92:95]
    v_mfma_f32_16x16x32_bf16 v[96:99], a[20:23], v[68:71], v[96:99]
    v_add_u32 v65, 24576, v62
    v_add_u32 v66, 24576, v63
    v_add_u32 v67, 24576, v64
    s_waitcnt vmcnt(26)
    s_barrier
    ds_read_b64_tr_b16 a[24:25], v65 offset:0
    ds_read_b64_tr_b16 a[26:27], v65 offset:512
    ds_read_b64_tr_b16 a[28:29], v66 offset:0
    ds_read_b64_tr_b16 a[30:31], v66 offset:512
    ds_read_b64_tr_b16 a[32:33], v67 offset:0
    ds_read_b64_tr_b16 a[34:35], v67 offset:512
    ds_read_b64_tr_b16 a[36:37], v65 offset:4096
    ds_read_b64_tr_b16 a[38:39], v65 offset:4608
    ds_read_b64_tr_b16 a[40:41], v66 offset:4096
    ds_read_b64_tr_b16 a[42:43], v66 offset:4608
    ds_read_b64_tr_b16 a[44:45], v67 offset:4096
    ds_read_b64_tr_b16 a[46:47], v67 offset:4608
    s_add_u32 m0, s42, 0
    s_nop 0
    buffer_load_dwordx4 v56, s[12:15], s54 offen lds
    s_add_u32 m0, s42, 1024
    s_nop 0
    buffer_load_dwordx4 v57, s[12:15], s54 offen lds
    s_add_u32 m0, s42, 8192
    s_nop 0
    buffer_load_dwordx4 v58, s[12:15], s54 offen lds
    s_add_u32 m0, s42, 9216
    s_nop 0
    buffer_load_dwordx4 v59, s[12:15], s54 offen lds
    s_add_u32 m0, s42, 16384
    s_nop 0
    buffer_load_dwordx4 v60, s[12:15], s54 offen lds
    s_add_u32 m0, s42, 17408
    s_nop 0
    buffer_load_dwordx4 v61, s[12:15], s54 offen lds
    s_add_u32 s54, s54, 458752
    s_waitcnt lgkmcnt(0)
    v_mfma_f32_16x16x32_bf16 v[88:91], a[24:27], v[68:71], v[88:91]
    v_mfma_f32_16x16x32_bf16 v[92:95], a[28:31], v[68:71], v[92:95]
    v_mfma_f32_16x16x32_bf16 v[96:99], a[32:35], v[68:71], v[96:99]
    v_mfma_f32_16x16x32_bf16 v[88:91], a[36:39], v[68:71], v[88:91]
    v_mfma_f32_16x16x32_bf16 v[92:95], a[40:43], v[68:71], v[92:95]
    v_mfma_f32_16x16x32_bf16 v[96:99], a[44:47], v[68:71], v[96:99]
    v_add_u32 v65, 49152, v62
    v_add_u32 v66, 49152, v63
    v_add_u32 v67, 49152, v64
    s_waitcnt vmcnt(26)
    s_barrier
    ds_read_b64_tr_b16 a[48:49], v65 offset:0
    ds_read_b64_tr_b16 a[50:51], v65 offset:512
    ds_read_b64_tr_b16 a[52:53], v66 offset:0
    ds_read_b64_tr_b16 a[54:55], v66 offset:512
    ds_read_b64_tr_b16 a[56:57], v67 offset:0
    ds_read_b64_tr_b16 a[58:59], v67 offset:512
    ds_read_b64_tr_b16 a[60:61], v65 offset:4096
    ds_read_b64_tr_b16 a[62:63], v65 offset:4608
    ds_read_b64_tr_b16 a[64:65], v66 offset:4096
    ds_read_b64_tr_b16 a[66:67], v66 offset:4608
    ds_read_b64_tr_b16 a[68:69], v67 offset:4096
    ds_read_b64_tr_b16 a[70:71], v67 offset:4608
    s_add_u32 m0, s42, 24576
    s_nop 0
    buffer_load_dwordx4 v56, s[12:15], s54 offen lds
    s_add_u32 m0, s42, 25600
    s_nop 0
    buffer_load_dwordx4 v57, s[12:15], s54 offen lds
    s_add_u32 m0, s42, 32768
    s_nop 0
    buffer_load_dwordx4 v58, s[12:15], s54 offen lds
    s_add_u32 m0, s42, 33792
    s_nop 0
    buffer_load_dwordx4 v59, s[12:15], s54 offen lds
    s_add_u32 m0, s42, 40960
    s_nop 0
    buffer_load_dwordx4 v60, s[12:15], s54 offen lds
    s_add_u32 m0, s42, 41984
    s_nop 0
    buffer_load_dwordx4 v61, s[12:15], s54 offen lds
    s_add_u32 s54, s54, 458752
    s_waitcnt lgkmcnt(0)
    v_mfma_f32_16x16x32_bf16 v[88:91], a[48:51], v[68:71], v[88:91]
    v_mfma_f32_16x16x32_bf16 v[92:95], a[52:55], v[68:71], v[92:95]
    v_mfma_f32_16x16x32_bf16 v[96:99], a[56:59], v[68:71], v[96:99]
    v_mfma_f32_16x16x32_bf16 v[88:91], a[60:63], v[68:71], v[88:91]
    v_mfma_f32_16x16x32_bf16 v[92:95], a[64:67], v[68:71], v[92:95]
    v_mfma_f32_16x16x32_bf16 v[96:99], a[68:71], v[68:71], v[96:99]
    v_add_u32 v65, 73728, v62
    v_add_u32 v66, 73728, v63
    v_add_u32 v67, 73728, v64
    s_waitcnt vmcnt(26)
    s_barrier
    ds_read_b64_tr_b16 a[72:73], v65 offset:0
    ds_read_b64_tr_b16 a[74:75], v65 offset:512
    ds_read_b64_tr_b16 a[76:77], v66 offset:0
    ds_read_b64_tr_b16 a[78:79], v66 offset:512
    ds_read_b64_tr_b16 a[80:81], v67 offset:0
    ds_read_b64_tr_b16 a[82:83], v67 offset:512
    ds_read_b64_tr_b16 a[84:85], v65 offset:4096
    ds_read_b64_tr_b16 a[86:87], v65 offset:4608
    ds_read_b64_tr_b16 a[88:89], v66 offset:4096
    ds_read_b64_tr_b16 a[90:91], v66 offset:4608
    ds_read_b64_tr_b16 a[92:93], v67 offset:4096
    ds_read_b64_tr_b16 a[94:95], v67 offset:4608
    s_add_u32 m0, s42, 49152
    s_nop 0
    buffer_load_dwordx4 v56, s[12:15], s54 offen lds
    s_add_u32 m0, s42, 50176
    s_nop 0
    buffer_load_dwordx4 v57, s[12:15], s54 offen lds
    s_add_u32 m0, s42, 57344
    s_nop 0
    buffer_load_dwordx4 v58, s[12:15], s54 offen lds
    s_add_u32 m0, s42, 58368
    s_nop 0
    buffer_load_dwordx4 v59, s[12:15], s54 offen lds
    s_add_u32 m0, s42, 65536
    s_nop 0
    buffer_load_dwordx4 v60, s[12:15], s54 offen lds
    s_add_u32 m0, s42, 66560
    s_nop 0
    buffer_load_dwordx4 v61, s[12:15], s54 offen lds
    s_add_u32 s54, s54, 458752
    s_waitcnt lgkmcnt(0)
    v_mfma_f32_16x16x32_bf16 v[88:91], a[72:75], v[68:71], v[88:91]
    v_mfma_f32_16x16x32_bf16 v[92:95], a[76:79], v[68:71], v[92:95]
    v_mfma_f32_16x16x32_bf16 v[96:99], a[80:83], v[68:71], v[96:99]
    v_mfma_f32_16x16x32_bf16 v[88:91], a[84:87], v[68:71], v[88:91]
    v_mfma_f32_16x16x32_bf16 v[92:95], a[88:91], v[68:71], v[92:95]
    v_mfma_f32_16x16x32_bf16 v[96:99], a[92:95], v[68:71], v[96:99]
    v_add_u32 v65, 98304, v62
    v_add_u32 v66, 98304, v63
    v_add_u32 v67, 98304, v64
    s_waitcnt vmcnt(26)
    s_barrier
    ds_read_b64_tr_b16 a[96:97], v65 offset:0
    ds_read_b64_tr_b16 a[98:99], v65 offset:512
    ds_read_b64_tr_b16 a[100:101], v66 offset:0
    ds_read_b64_tr_b16 a[102:103], v66 offset:512
    ds_read_b64_tr_b16 a[104:105], v67 offset:0
    ds_read_b64_tr_b16 a[106:107], v67 offset:512
    ds_read_b64_tr_b16 a[108:109], v65 offset:4096
    ds_read_b64_tr_b16 a[110:111], v65 offset:4608
    ds_read_b64_tr_b16 a[112:113], v66 offset:4096
    ds_read_b64_tr_b16 a[114:115], v66 offset:4608
    ds_read_b64_tr_b16 a[116:117], v67 offset:4096
    ds_read_b64_tr_b16 a[118:119], v67 offset:4608
    s_add_u32 m0, s42, 73728
    s_nop 0
    buffer_load_dwordx4 v56, s[12:15], s54 offen lds
    s_add_u32 m0, s42, 74752
    s_nop 0
    buffer_load_dwordx4 v57, s[12:15], s54 offen lds
    s_add_u32 m0, s42, 81920
    s_nop 0
    buffer_load_dwordx4 v58, s[12:15], s54 offen lds
    s_add_u32 m0, s42, 82944
    s_nop 0
    buffer_load_dwordx4 v59, s[12:15], s54 offen lds
    s_add_u32 m0, s42, 90112
    s_nop 0
    buffer_load_dwordx4 v60, s[12:15], s54 offen lds
    s_add_u32 m0, s42, 91136
    s_nop 0
    buffer_load_dwordx4 v61, s[12:15], s54 offen lds
    s_add_u32 s54, s54, 458752
    s_waitcnt lgkmcnt(0)
    v_mfma_f32_16x16x32_bf16 v[88:91], a[96:99], v[68:71], v[88:91]
    v_mfma_f32_16x16x32_bf16 v[92:95], a[100:103], v[68:71], v[92:95]
    v_mfma_f32_16x16x32_bf16 v[96:99], a[104:107], v[68:71], v[96:99]
    v_mfma_f32_16x16x32_bf16 v[88:91], a[108:111], v[68:71], v[88:91]
    v_mfma_f32_16x16x32_bf16 v[92:95], a[112:115], v[68:71], v[92:95]
    v_mfma_f32_16x16x32_bf16 v[96:99], a[116:119], v[68:71], v[96:99]
    v_add_u32 v65, 122880, v62
    v_add_u32 v66, 122880, v63
    v_add_u32 v67, 122880, v64
    s_waitcnt vmcnt(24)
    s_barrier
    ds_read_b64_tr_b16 a[120:121], v65 offset:0
    ds_read_b64_tr_b16 a[122:123], v65 offset:512
    ds_read_b64_tr_b16 a[124:125], v66 offset:0
    ds_read_b64_tr_b16 a[126:127], v66 offset:512
    ds_read_b64_tr_b16 a[128:129], v67 offset:0
    ds_read_b64_tr_b16 a[130:131], v67 offset:512
    ds_read_b64_tr_b16 a[132:133], v65 offset:4096
    ds_read_b64_tr_b16 a[134:135], v65 offset:4608
    ds_read_b64_tr_b16 a[136:137], v66 offset:4096
    ds_read_b64_tr_b16 a[138:139], v66 offset:4608
    ds_read_b64_tr_b16 a[140:141], v67 offset:4096
    ds_read_b64_tr_b16 a[142:143], v67 offset:4608
    s_add_u32 m0, s42, 98304
    s_nop 0
    buffer_load_dwordx4 v56, s[12:15], s54 offen lds
    s_add_u32 m0, s42, 99328
    s_nop 0
    buffer_load_dwordx4 v57, s[12:15], s54 offen lds
    s_add_u32 m0, s42, 106496
    s_nop 0
    buffer_load_dwordx4 v58, s[12:15], s54 offen lds
    s_add_u32 m0, s42, 107520
    s_nop 0
    buffer_load_dwordx4 v59, s[12:15], s54 offen lds
    s_add_u32 m0, s42, 114688
    s_nop 0
    buffer_load_dwordx4 v60, s[12:15], s54 offen lds
    s_add_u32 m0, s42, 115712
    s_nop 0
    buffer_load_dwordx4 v61, s[12:15], s54 offen lds
    s_add_u32 s54, s54, 458752
    s_waitcnt lgkmcnt(0)
    v_mfma_f32_16x16x32_bf16 v[88:91], a[120:123], v[68:71], v[88:91]
    v_mfma_f32_16x16x32_bf16 v[92:95], a[124:127], v[68:71], v[92:95]
    v_mfma_f32_16x16x32_bf16 v[96:99], a[128:131], v[68:71], v[96:99]
    v_mfma_f32_16x16x32_bf16 v[88:91], a[132:135], v[68:71], v[88:91]
    v_mfma_f32_16x16x32_bf16 v[92:95], a[136:139], v[68:71], v[92:95]
    v_mfma_f32_16x16x32_bf16 v[96:99], a[140:143], v[68:71], v[96:99]
    v_add_u32 v65, 0, v62
    v_add_u32 v66, 0, v63
    v_add_u32 v67, 0, v64
    s_waitcnt vmcnt(24)
    s_barrier
    ds_read_b64_tr_b16 a[144:145], v65 offset:0
    ds_read_b64_tr_b16 a[146:147], v65 offset:512
    ds_read_b64_tr_b16 a[148:149], v66 offset:0
    ds_read_b64_tr_b16 a[150:151], v66 offset:512
    ds_read_b64_tr_b16 a[152:153], v67 offset:0
    ds_read_b64_tr_b16 a[154:155], v67 offset:512
    ds_read_b64_tr_b16 a[156:157], v65 offset:4096
    ds_read_b64_tr_b16 a[158:159], v65 offset:4608
    ds_read_b64_tr_b16 a[160:161], v66 offset:4096
    ds_read_b64_tr_b16 a[162:163], v66 offset:4608
    ds_read_b64_tr_b16 a[164:165], v67 offset:4096
    ds_read_b64_tr_b16 a[166:167], v67 offset:4608
    s_add_u32 m0, s42, 122880
    s_nop 0
    buffer_load_dwordx4 v56, s[12:15], s54 offen lds
    s_add_u32 m0, s42, 123904
    s_nop 0
    buffer_load_dwordx4 v57, s[12:15], s54 offen lds
    s_add_u32 m0, s42, 131072
    s_nop 0
    buffer_load_dwordx4 v58, s[12:15], s54 offen lds
    s_add_u32 m0, s42, 132096
    s_nop 0
    buffer_load_dwordx4 v59, s[12:15], s54 offen lds
    s_add_u32 m0, s42, 139264
    s_nop 0
    buffer_load_dwordx4 v60, s[12:15], s54 offen lds
    s_add_u32 m0, s42, 140288
    s_nop 0
    buffer_load_dwordx4 v61, s[12:15], s54 offen lds
    s_add_u32 s54, s54, 458752
    s_waitcnt lgkmcnt(0)
    v_mfma_f32_16x16x32_bf16 v[88:91], a[144:147], v[68:71], v[88:91]
    v_mfma_f32_16x16x32_bf16 v[92:95], a[148:151], v[68:71], v[92:95]
    v_mfma_f32_16x16x32_bf16 v[96:99], a[152:155], v[68:71], v[96:99]
    v_mfma_f32_16x16x32_bf16 v[88:91], a[156:159], v[68:71], v[88:91]
    v_mfma_f32_16x16x32_bf16 v[92:95], a[160:163], v[68:71], v[92:95]
    v_mfma_f32_16x16x32_bf16 v[96:99], a[164:167], v[68:71], v[96:99]
    v_add_u32 v65, 24576, v62
    v_add_u32 v66, 24576, v63
    v_add_u32 v67, 24576, v64
    s_waitcnt vmcnt(24)
    s_barrier
    ds_read_b64_tr_b16 a[168:169], v65 offset:0
    ds_read_b64_tr_b16 a[170:171], v65 offset:512
    ds_read_b64_tr_b16 a[172:173], v66 offset:0
    ds_read_b64_tr_b16 a[174:175], v66 offset:512
    ds_read_b64_tr_b16 a[176:177], v67 offset:0
    ds_read_b64_tr_b16 a[178:179], v67 offset:512
    ds_read_b64_tr_b16 a[180:181], v65 offset:4096
    ds_read_b64_tr_b16 a[182:183], v65 offset:4608
    ds_read_b64_tr_b16 a[184:185], v66 offset:4096
    ds_read_b64_tr_b16 a[186:187], v66 offset:4608
    ds_read_b64_tr_b16 a[188:189], v67 offset:4096
    ds_read_b64_tr_b16 a[190:191], v67 offset:4608
    s_add_u32 m0, s42, 0
    s_nop 0
    buffer_load_dwordx4 v56, s[12:15], s54 offen lds
    s_add_u32 m0, s42, 1024
    s_nop 0
    buffer_load_dwordx4 v57, s[12:15], s54 offen lds
    s_add_u32 m0, s42, 8192
    s_nop 0
    buffer_load_dwordx4 v58, s[12:15], s54 offen lds
    s_add_u32 m0, s42, 9216
    s_nop 0
    buffer_load_dwordx4 v59, s[12:15], s54 offen lds
    s_add_u32 m0, s42, 16384
    s_nop 0
    buffer_load_dwordx4 v60, s[12:15], s54 offen lds
    s_add_u32 m0, s42, 17408
    s_nop 0
    buffer_load_dwordx4 v61, s[12:15], s54 offen lds
    s_add_u32 s54, s54, 458752
    s_waitcnt lgkmcnt(0)
    v_mfma_f32_16x16x32_bf16 v[88:91], a[168:171], v[68:71], v[88:91]
    v_mfma_f32_16x16x32_bf16 v[92:95], a[172:175], v[68:71], v[92:95]
    v_mfma_f32_16x16x32_bf16 v[96:99], a[176:179], v[68:71], v[96:99]
    v_mfma_f32_16x16x32_bf16 v[88:91], a[180:183], v[68:71], v[88:91]
    v_mfma_f32_16x16x32_bf16 v[92:95], a[184:187], v[68:71], v[92:95]
    v_mfma_f32_16x16x32_bf16 v[96:99], a[188:191], v[68:71], v[96:99]
    v_add_u32 v65, 49152, v62
    v_add_u32 v66, 49152, v63
    v_add_u32 v67, 49152, v64
    s_waitcnt vmcnt(24)
    s_barrier
    ds_read_b64_tr_b16 a[192:193], v65 offset:0
    ds_read_b64_tr_b16 a[194:195], v65 offset:512
    ds_read_b64_tr_b16 a[196:197], v66 offset:0
    ds_read_b64_tr_b16 a[198:199], v66 offset:512
    ds_read_b64_tr_b16 a[200:201], v67 offset:0
    ds_read_b64_tr_b16 a[202:203], v67 offset:512
    ds_read_b64_tr_b16 a[204:205], v65 offset:4096
    ds_read_b64_tr_b16 a[206:207], v65 offset:4608
    ds_read_b64_tr_b16 a[208:209], v66 offset:4096
    ds_read_b64_tr_b16 a[210:211], v66 offset:4608
    ds_read_b64_tr_b16 a[212:213], v67 offset:4096
    ds_read_b64_tr_b16 a[214:215], v67 offset:4608
    s_add_u32 m0, s42, 24576
    s_nop 0
    buffer_load_dwordx4 v56, s[12:15], s54 offen lds
    s_add_u32 m0, s42, 25600
    s_nop 0
    buffer_load_dwordx4 v57, s[12:15], s54 offen lds
    s_add_u32 m0, s42, 32768
    s_nop 0
    buffer_load_dwordx4 v58, s[12:15], s54 offen lds
    s_add_u32 m0, s42, 33792
    s_nop 0
    buffer_load_dwordx4 v59, s[12:15], s54 offen lds
    s_add_u32 m0, s42, 40960
    s_nop 0
    buffer_load_dwordx4 v60, s[12:15], s54 offen lds
    s_add_u32 m0, s42, 41984
    s_nop 0
    buffer_load_dwordx4 v61, s[12:15], s54 offen lds
    s_add_u32 s54, s54, 458752
    s_waitcnt lgkmcnt(0)
    v_mfma_f32_16x16x32_bf16 v[88:91], a[192:195], v[68:71], v[88:91]
    v_mfma_f32_16x16x32_bf16 v[92:95], a[196:199], v[68:71], v[92:95]
    v_mfma_f32_16x16x32_bf16 v[96:99], a[200:203], v[68:71], v[96:99]
    v_mfma_f32_16x16x32_bf16 v[88:91], a[204:207], v[68:71], v[88:91]
    v_mfma_f32_16x16x32_bf16 v[92:95], a[208:211], v[68:71], v[92:95]
    v_mfma_f32_16x16x32_bf16 v[96:99], a[212:215], v[68:71], v[96:99]
    v_add_u32 v65, 73728, v62
    v_add_u32 v66, 73728, v63
    v_add_u32 v67, 73728, v64
    s_waitcnt vmcnt(24)
    s_barrier
    ds_read_b64_tr_b16 a[216:217], v65 offset:0
    ds_read_b64_tr_b16 a[218:219], v65 offset:512
    ds_read_b64_tr_b16 a[220:221], v66 offset:0
    ds_read_b64_tr_b16 a[222:223], v66 offset:512
    ds_read_b64_tr_b16 a[224:225], v67 offset:0
    ds_read_b64_tr_b16 a[226:227], v67 offset:512
    ds_read_b64_tr_b16 a[228:229], v65 offset:4096
    ds_read_b64_tr_b16 a[230:231], v65 offset:4608
    ds_read_b64_tr_b16 a[232:233], v66 offset:4096
    ds_read_b64_tr_b16 a[234:235], v66 offset:4608
    ds_read_b64_tr_b16 a[236:237], v67 offset:4096
    ds_read_b64_tr_b16 a[238:239], v67 offset:4608
    s_add_u32 m0, s42, 49152
    s_nop 0
    buffer_load_dwordx4 v56, s[12:15], s54 offen lds
    s_add_u32 m0, s42, 50176
    s_nop 0
    buffer_load_dwordx4 v57, s[12:15], s54 offen lds
    s_add_u32 m0, s42, 57344
    s_nop 0
    buffer_load_dwordx4 v58, s[12:15], s54 offen lds
    s_add_u32 m0, s42, 58368
    s_nop 0
    buffer_load_dwordx4 v59, s[12:15], s54 offen lds
    s_add_u32 m0, s42, 65536
    s_nop 0
    buffer_load_dwordx4 v60, s[12:15], s54 offen lds
    s_add_u32 m0, s42, 66560
    s_nop 0
    buffer_load_dwordx4 v61, s[12:15], s54 offen lds
    s_add_u32 s54, s54, 458752
    s_waitcnt lgkmcnt(0)
    v_mfma_f32_16x16x32_bf16 v[88:91], a[216:219], v[68:71], v[88:91]
    v_mfma_f32_16x16x32_bf16 v[92:95], a[220:223], v[68:71], v[92:95]
    v_mfma_f32_16x16x32_bf16 v[96:99], a[224:227], v[68:71], v[96:99]
    v_mfma_f32_16x16x32_bf16 v[88:91], a[228:231], v[68:71], v[88:91]
    v_mfma_f32_16x16x32_bf16 v[92:95], a[232:235], v[68:71], v[92:95]
    v_mfma_f32_16x16x32_bf16 v[96:99], a[236:239], v[68:71], v[96:99]
    v_add_u32 v65, 98304, v62
    v_add_u32 v66, 98304, v63
    v_add_u32 v67, 98304, v64
    s_waitcnt vmcnt(24)
    s_barrier
    ds_read_b64_tr_b16 a[240:241], v65 offset:0
    ds_read_b64_tr_b16 a[242:243], v65 offset:512
    ds_read_b64_tr_b16 a[244:245], v66 offset:0
    ds_read_b64_tr_b16 a[246:247], v66 offset:512
    ds_read_b64_tr_b16 a[248:249], v67 offset:0
    ds_read_b64_tr_b16 a[250:251], v67 offset:512
    ds_read_b64_tr_b16 a[252:253], v65 offset:4096
    ds_read_b64_tr_b16 a[254:255], v65 offset:4608
    ds_read_b64_tr_b16 v[128:129], v66 offset:4096
    ds_read_b64_tr_b16 v[130:131], v66 offset:4608
    ds_read_b64_tr_b16 v[132:133], v67 offset:4096
    ds_read_b64_tr_b16 v[134:135], v67 offset:4608
    s_add_u32 m0, s42, 73728
    s_nop 0
    buffer_load_dwordx4 v56, s[12:15], s54 offen lds
    s_add_u32 m0, s42, 74752
    s_nop 0
    buffer_load_dwordx4 v57, s[12:15], s54 offen lds
    s_add_u32 m0, s42, 81920
    s_nop 0
    buffer_load_dwordx4 v58, s[12:15], s54 offen lds
    s_add_u32 m0, s42, 82944
    s_nop 0
    buffer_load_dwordx4 v59, s[12:15], s54 offen lds
    s_add_u32 m0, s42, 90112
    s_nop 0
    buffer_load_dwordx4 v60, s[12:15], s54 offen lds
    s_add_u32 m0, s42, 91136
    s_nop 0
    buffer_load_dwordx4 v61, s[12:15], s54 offen lds
    s_add_u32 s54, s54, 458752
    s_waitcnt lgkmcnt(0)
    v_mfma_f32_16x16x32_bf16 v[88:91], a[240:243], v[68:71], v[88:91]
    v_mfma_f32_16x16x32_bf16 v[92:95], a[244:247], v[68:71], v[92:95]
    v_mfma_f32_16x16x32_bf16 v[96:99], a[248:251], v[68:71], v[96:99]
    v_mfma_f32_16x16x32_bf16 v[88:91], a[252:255], v[68:71], v[88:91]
    v_mfma_f32_16x16x32_bf16 v[92:95], v[128:131], v[68:71], v[92:95]
    v_mfma_f32_16x16x32_bf16 v[96:99], v[132:135], v[68:71], v[96:99]
    v_add_u32 v65, 122880, v62
    v_add_u32 v66, 122880, v63
    v_add_u32 v67, 122880, v64
    s_waitcnt vmcnt(24)
    s_barrier
    ds_read_b64_tr_b16 v[136:137], v65 offset:0
    ds_read_b64_tr_b16 v[138:139], v65 offset:512
    ds_read_b64_tr_b16 v[140:141], v66 offset:0
    ds_read_b64_tr_b16 v[142:143], v66 offset:512
    ds_read_b64_tr_b16 v[144:145], v67 offset:0
    ds_read_b64_tr_b16 v[146:147], v67 offset:512
    ds_read_b64_tr_b16 v[148:149], v65 offset:4096
    ds_read_b64_tr_b16 v[150:151], v65 offset:4608
    ds_read_b64_tr_b16 v[152:153], v66 offset:4096
    ds_read_b64_tr_b16 v[154:155], v66 offset:4608
    ds_read_b64_tr_b16 v[156:157], v67 offset:4096
    ds_read_b64_tr_b16 v[158:159], v67 offset:4608
    s_waitcnt lgkmcnt(0)
    v_mfma_f32_16x16x32_bf16 v[88:91], v[136:139], v[68:71], v[88:91]
    v_mfma_f32_16x16x32_bf16 v[92:95], v[140:143], v[68:71], v[92:95]
    v_mfma_f32_16x16x32_bf16 v[96:99], v[144:147], v[68:71], v[96:99]
    v_mfma_f32_16x16x32_bf16 v[88:91], v[148:151], v[68:71], v[88:91]
    v_mfma_f32_16x16x32_bf16 v[92:95], v[152:155], v[68:71], v[92:95]
    v_mfma_f32_16x16x32_bf16 v[96:99], v[156:159], v[68:71], v[96:99]
    v_add_u32 v65, 0, v62
    v_add_u32 v66, 0, v63
    v_add_u32 v67, 0, v64
    s_waitcnt vmcnt(18)
    s_barrier
    ds_read_b64_tr_b16 v[160:161], v65 offset:0
    ds_read_b64_tr_b16 v[162:163], v65 offset:512
    ds_read_b64_tr_b16 v[164:165], v66 offset:0
    ds_read_b64_tr_b16 v[166:167], v66 offset:512
    ds_read_b64_tr_b16 v[168:169], v67 offset:0
    ds_read_b64_tr_b16 v[170:171], v67 offset:512
    ds_read_b64_tr_b16 v[172:173], v65 offset:4096
    ds_read_b64_tr_b16 v[174:175], v65 offset:4608
    ds_read_b64_tr_b16 v[176:177], v66 offset:4096
    ds_read_b64_tr_b16 v[178:179], v66 offset:4608
    ds_read_b64_tr_b16 v[180:181], v67 offset:4096
    ds_read_b64_tr_b16 v[182:183], v67 offset:4608
    s_waitcnt lgkmcnt(0)
    v_mfma_f32_16x16x32_bf16 v[88:91], v[160:163], v[68:71], v[88:91]
    v_mfma_f32_16x16x32_bf16 v[92:95], v[164:167], v[68:71], v[92:95]
    v_mfma_f32_16x16x32_bf16 v[96:99], v[168:171], v[68:71], v[96:99]
    v_mfma_f32_16x16x32_bf16 v[88:91], v[172:175], v[68:71], v[88:91]
    v_mfma_f32_16x16x32_bf16 v[92:95], v[176:179], v[68:71], v[92:95]
    v_mfma_f32_16x16x32_bf16 v[96:99], v[180:183], v[68:71], v[96:99]
    v_add_u32 v65, 24576, v62
    v_add_u32 v66, 24576, v63
    v_add_u32 v67, 24576, v64
    s_waitcnt vmcnt(12)
    s_barrier
    ds_read_b64_tr_b16 v[184:185], v65 offset:0
    ds_read_b64_tr_b16 v[186:187], v65 offset:512
    ds_read_b64_tr_b16 v[188:189], v66 offset:0
    ds_read_b64_tr_b16 v[190:191], v66 offset:512
    ds_read_b64_tr_b16 v[192:193], v67 offset:0
    ds_read_b64_tr_b16 v[194:195], v67 offset:512
    ds_read_b64_tr_b16 v[196:197], v65 offset:4096
    ds_read_b64_tr_b16 v[198:199], v65 offset:4608
    ds_read_b64_tr_b16 v[200:201], v66 offset:4096
    ds_read_b64_tr_b16 v[202:203], v66 offset:4608
    ds_read_b64_tr_b16 v[204:205], v67 offset:4096
    ds_read_b64_tr_b16 v[206:207], v67 offset:4608
    s_waitcnt lgkmcnt(0)
    v_mfma_f32_16x16x32_bf16 v[88:91], v[184:187], v[68:71], v[88:91]
    v_mfma_f32_16x16x32_bf16 v[92:95], v[188:191], v[68:71], v[92:95]
    v_mfma_f32_16x16x32_bf16 v[96:99], v[192:195], v[68:71], v[96:99]
    v_mfma_f32_16x16x32_bf16 v[88:91], v[196:199], v[68:71], v[88:91]
    v_mfma_f32_16x16x32_bf16 v[92:95], v[200:203], v[68:71], v[92:95]
    v_mfma_f32_16x16x32_bf16 v[96:99], v[204:207], v[68:71], v[96:99]
    v_add_u32 v65, 49152, v62
    v_add_u32 v66, 49152, v63
    v_add_u32 v67, 49152, v64
    s_waitcnt vmcnt(6)
    s_barrier
    ds_read_b64_tr_b16 v[208:209], v65 offset:0
    ds_read_b64_tr_b16 v[210:211], v65 offset:512
    ds_read_b64_tr_b16 v[212:213], v66 offset:0
    ds_read_b64_tr_b16 v[214:215], v66 offset:512
    ds_read_b64_tr_b16 v[216:217], v67 offset:0
    ds_read_b64_tr_b16 v[218:219], v67 offset:512
    ds_read_b64_tr_b16 v[220:221], v65 offset:4096
    ds_read_b64_tr_b16 v[222:223], v65 offset:4608
    ds_read_b64_tr_b16 v[224:225], v66 offset:4096
    ds_read_b64_tr_b16 v[226:227], v66 offset:4608
    ds_read_b64_tr_b16 v[228:229], v67 offset:4096
    ds_read_b64_tr_b16 v[230:231], v67 offset:4608
    s_waitcnt lgkmcnt(0)
    v_mfma_f32_16x16x32_bf16 v[88:91], v[208:211], v[68:71], v[88:91]
    v_mfma_f32_16x16x32_bf16 v[92:95], v[212:215], v[68:71], v[92:95]
    v_mfma_f32_16x16x32_bf16 v[96:99], v[216:219], v[68:71], v[96:99]
    v_mfma_f32_16x16x32_bf16 v[88:91], v[220:223], v[68:71], v[88:91]
    v_mfma_f32_16x16x32_bf16 v[92:95], v[224:227], v[68:71], v[92:95]
    v_mfma_f32_16x16x32_bf16 v[96:99], v[228:231], v[68:71], v[96:99]
    v_add_u32 v65, 73728, v62
    v_add_u32 v66, 73728, v63
    v_add_u32 v67, 73728, v64
    s_waitcnt vmcnt(0)
    s_barrier
    ds_read_b64_tr_b16 v[232:233], v65 offset:0
    ds_read_b64_tr_b16 v[234:235], v65 offset:512
    ds_read_b64_tr_b16 v[236:237], v66 offset:0
    ds_read_b64_tr_b16 v[238:239], v66 offset:512
    ds_read_b64_tr_b16 v[240:241], v67 offset:0
    ds_read_b64_tr_b16 v[242:243], v67 offset:512
    ds_read_b64_tr_b16 v[244:245], v65 offset:4096
    ds_read_b64_tr_b16 v[246:247], v65 offset:4608
    ds_read_b64_tr_b16 v[248:249], v66 offset:4096
    ds_read_b64_tr_b16 v[250:251], v66 offset:4608
    ds_read_b64_tr_b16 v[252:253], v67 offset:4096
    ds_read_b64_tr_b16 v[254:255], v67 offset:4608
    s_waitcnt lgkmcnt(0)
    v_mfma_f32_16x16x32_bf16 v[88:91], v[232:235], v[68:71], v[88:91]
    v_mfma_f32_16x16x32_bf16 v[92:95], v[236:239], v[68:71], v[92:95]
    v_mfma_f32_16x16x32_bf16 v[96:99], v[240:243], v[68:71], v[96:99]
    v_mfma_f32_16x16x32_bf16 v[88:91], v[244:247], v[68:71], v[88:91]
    v_mfma_f32_16x16x32_bf16 v[92:95], v[248:251], v[68:71], v[92:95]
    v_mfma_f32_16x16x32_bf16 v[96:99], v[252:255], v[68:71], v[96:99]
    s_barrier
    s_mov_b32 s37, 0xffff0000
    v_lshlrev_b32 v100, 16, v16
    v_and_b32 v101, s37, v16
    v_lshlrev_b32 v102, 16, v17
    v_and_b32 v103, s37, v17
    v_lshlrev_b32 v104, 16, v18
    v_and_b32 v105, s37, v18
    v_lshlrev_b32 v106, 16, v19
    v_and_b32 v107, s37, v19
    v_lshlrev_b32 v108, 16, v20
    v_and_b32 v109, s37, v20
    v_lshlrev_b32 v110, 16, v21
    v_and_b32 v111, s37, v21
    s_add_u32 s20, s82, 128
    s_addc_u32 s21, s83, 0
    s_mov_b32 s22, 128
    s_mov_b32 s23, 0x00020000
    buffer_load_dword v56, v124, s[20:23], 0 offen offset:32 sc1
    s_waitcnt vmcnt(0)
    v_readfirstlane_b32 s37, v56
    s_nop 0
    s_cmp_lg_u32 s37, s3
    s_cbranch_scc1 L_vspin11
L_vback12:
    s_cmp_lg_u32 s32, 0
    s_cbranch_scc1 L_arv13
    s_add_u32 s20, s82, 0x80
    s_addc_u32 s21, s83, 0
    s_mov_b32 s22, 0x4
    s_mov_b32 s23, 0x00020000
    buffer_load_dword v56, v124, s[20:23], 0 offen sc1
    s_waitcnt vmcnt(0)
    v_cmp_eq_u32 vcc, v124, v56
    s_cbranch_vccnz L_spin14
L_back15:
L_arv13:
    s_add_u32 s96, s41, 2031616
    s_mov_b32 s98, s41
    s_mov_b32 s45, 0x5530000
    buffer_load_dword v7, v5, s[16:19], s45 offen sc1
    s_waitcnt vmcnt(0)
    v_cmp_ne_u32 vcc, 0, v7
    s_cbranch_vccnz L_spin16
L_back17:
    s_barrier
    s_mov_b32 s39, 0x5e00000
    s_add_u32 m0, s43, 0
    s_add_u32 s42, s41, 0
    buffer_load_dwordx4 v1, s[16:19], s42 offen offset:0 sc1 lds
    buffer_load_dwordx4 v1, s[16:19], s42 offen offset:1024 sc1 lds
    buffer_load_dwordx4 v1, s[16:19], s42 offen offset:2048 sc1 lds
    buffer_load_dwordx4 v1, s[16:19], s42 offen offset:3072 sc1 lds
    s_add_u32 m0, s43, 16384
    s_add_u32 s42, s41, 16384
    buffer_load_dwordx4 v1, s[16:19], s42 offen offset:0 sc1 lds
    buffer_load_dwordx4 v1, s[16:19], s42 offen offset:1024 sc1 lds
    buffer_load_dwordx4 v1, s[16:19], s42 offen offset:2048 sc1 lds
    buffer_load_dwordx4 v1, s[16:19], s42 offen offset:3072 sc1 lds
    s_add_u32 m0, s43, 32768
    s_add_u32 s42, s41, 32768
    buffer_load_dwordx4 v1, s[16:19], s42 offen offset:0 sc1 lds
    buffer_load_dwordx4 v1, s[16:19], s42 offen offset:1024 sc1 lds
    buffer_load_dwordx4 v1, s[16:19], s42 offen offset:2048 sc1 lds
    buffer_store_dword v124, v124, s[16:19], s39 offen
    buffer_load_dwordx4 v1, s[16:19], s42 offen offset:3072 sc1 lds
    s_add_u32 m0, s43, 49152
    s_add_u32 s42, s41, 49152
    buffer_load_dwordx4 v1, s[16:19], s42 offen offset:0 sc1 lds
    buffer_load_dwordx4 v1, s[16:19], s42 offen offset:1024 sc1 lds
    buffer_load_dwordx4 v1, s[16:19], s42 offen offset:2048 sc1 lds
    buffer_load_dwordx4 v1, s[16:19], s42 offen offset:3072 sc1 lds
    s_add_u32 m0, s52, 73728
    s_add_u32 s42, s46, s52
    buffer_load_dwordx4 v1, s[16:19], s42 offen sc1 lds
    s_add_u32 s38, s45, 65536
    buffer_load_dword v7, v5, s[16:19], s38 offen sc1
    s_add_u32 s45, s45, 65536
    s_waitcnt vmcnt(15) lgkmcnt(0)
    s_barrier
    ds_read_b128 v[56:59], v1 offset:0
    ds_read_b128 v[60:63], v1 offset:1024
    ds_read_b128 v[64:67], v1 offset:2048
    ds_read_b128 v[68:71], v1 offset:3072
    s_mov_b32 s36, 0
    s_waitcnt lgkmcnt(0)
    s_nop 7
L_a_b0:
    v_mfma_f32_16x16x32_bf16 v[8:11], a[0:3], v[56:59], 0
    s_and_b32 s44, s90, 0xffffffff
    ds_read_b128 v[72:75], v1 offset:4096
    v_mul_f32 v120, v48, v116
    v_mfma_f32_16x16x32_bf16 v[16:19], a[0:3], v[60:63], 0
    s_cmp_lt_i32 s36, 1
    v_mul_f32 v121, v49, v116
    v_mul_f32 v120, v120, abs(v48)
    v_mfma_f32_16x16x32_bf16 v[20:23], a[4:7], v[60:63], 0
    s_cselect_b32 s44, 0x5e00000, s44
    v_mul_f32 v121, v121, abs(v49)
    v_cvt_pk_bf16_f32 v48, v120, v121
    v_mfma_f32_16x16x32_bf16 v[12:15], a[4:7], v[56:59], 0
    s_add_u32 s49, s44, s87
    ds_read_b128 v[76:79], v1 offset:5120
    v_pk_max_i16 v48, v48, 0
    v_mfma_f32_16x16x32_bf16 v[24:27], a[8:11], v[56:59], 0
    s_max_u32 s44, s44, s88
    v_mul_f32 v120, v50, v116
    v_mul_f32 v121, v51, v116
    v_mfma_f32_16x16x32_bf16 v[28:31], a[8:11], v[60:63], 0
    s_waitcnt lgkmcnt(2)
    v_mul_f32 v120, v120, abs(v50)
    v_mul_f32 v121, v121, abs(v51)
    v_mfma_f32_16x16x32_bf16 v[8:11], a[12:15], v[64:67], v[8:11]
    s_add_u32 s90, s90, 262144
    ds_read_b128 v[80:83], v1 offset:6144
    v_cvt_pk_bf16_f32 v49, v120, v121
    v_mfma_f32_16x16x32_bf16 v[16:19], a[12:15], v[68:71], v[16:19]
    s_add_u32 s98, s98, 65536
    v_pk_max_i16 v49, v49, 0
    s_min_i32 s98, s98, s96
    v_mfma_f32_16x16x32_bf16 v[20:23], a[16:19], v[68:71], v[20:23]
    s_and_b32 s41, s98, 0xffffffff
    ds_write_b64 v3, v[48:49] offset:4096
    v_mfma_f32_16x16x32_bf16 v[12:15], a[16:19], v[64:67], v[12:15]
    ds_read_b128 v[84:87], v1 offset:7168
    v_mul_f32 v120, v52, v117
    v_mfma_f32_16x16x32_bf16 v[24:27], a[20:23], v[64:67], v[24:27]
    v_mul_f32 v121, v53, v117
    v_mul_f32 v120, v120, abs(v52)
    v_mfma_f32_16x16x32_bf16 v[28:31], a[20:23], v[68:71], v[28:31]
    s_waitcnt lgkmcnt(3)
    v_mul_f32 v121, v121, abs(v53)
    v_cvt_pk_bf16_f32 v52, v120, v121
    v_mfma_f32_16x16x32_bf16 v[8:11], a[24:27], v[72:75], v[8:11]
    ds_read_b128 v[56:59], v1 offset:8192
    v_pk_max_i16 v52, v52, 0
    v_mfma_f32_16x16x32_bf16 v[16:19], a[24:27], v[76:79], v[16:19]
    v_mul_f32 v120, v54, v117
    v_mul_f32 v121, v55, v117
    v_mfma_f32_16x16x32_bf16 v[20:23], a[28:31], v[76:79], v[20:23]
    v_mul_f32 v120, v120, abs(v54)
    v_mul_f32 v121, v121, abs(v55)
    v_mfma_f32_16x16x32_bf16 v[12:15], a[28:31], v[72:75], v[12:15]
    ds_read_b128 v[60:63], v1 offset:9216
    v_cvt_pk_bf16_f32 v53, v120, v121
    v_mfma_f32_16x16x32_bf16 v[24:27], a[32:35], v[72:75], v[24:27]
    v_pk_max_i16 v53, v53, 0
    v_mfma_f32_16x16x32_bf16 v[28:31], a[32:35], v[76:79], v[28:31]
    s_waitcnt lgkmcnt(2)
    ds_write_b64 v3, v[52:53] offset:5120
    v_mfma_f32_16x16x32_bf16 v[8:11], a[36:39], v[80:83], v[8:11]
    ds_read_b128 v[64:67], v1 offset:10240
    v_mul_f32 v120, v32, v116
    v_mfma_f32_16x16x32_bf16 v[16:19], a[36:39], v[84:87], v[16:19]
    v_mul_f32 v121, v33, v116
    v_mul_f32 v120, v120, abs(v32)
    v_mfma_f32_16x16x32_bf16 v[20:23], a[40:43], v[84:87], v[20:23]
    v_mul_f32 v121, v121, abs(v33)
    v_cvt_pk_bf16_f32 v32, v120, v121
    v_mfma_f32_16x16x32_bf16 v[12:15], a[40:43], v[80:83], v[12:15]
    ds_read_b128 v[68:71], v1 offset:11264
    v_pk_max_i16 v32, v32, 0
    v_mfma_f32_16x16x32_bf16 v[24:27], a[44:47], v[80:83], v[24:27]
    v_mul_f32 v120, v34, v116
    v_mul_f32 v121, v35, v116
    v_mfma_f32_16x16x32_bf16 v[28:31], a[44:47], v[84:87], v[28:31]
    s_waitcnt lgkmcnt(3)
    v_mul_f32 v120, v120, abs(v34)
    v_mul_f32 v121, v121, abs(v35)
    v_mfma_f32_16x16x32_bf16 v[8:11], a[48:51], v[56:59], v[8:11]
    ds_read_b128 v[72:75], v1 offset:12288
    v_cvt_pk_bf16_f32 v33, v120, v121
    v_mfma_f32_16x16x32_bf16 v[16:19], a[48:51], v[60:63], v[16:19]
    s_waitcnt vmcnt(0)
    v_cmp_ne_u32 vcc, 0, v7
    v_pk_max_i16 v33, v33, 0
    v_mfma_f32_16x16x32_bf16 v[20:23], a[52:55], v[60:63], v[20:23]
    v_mul_f32 v120, v36, v116
    v_mul_f32 v121, v37, v116
    v_mfma_f32_16x16x32_bf16 v[12:15], a[52:55], v[56:59], v[12:15]
    s_cbranch_vccnz L_spin18
L_back19:
    ds_read_b128 v[76:79], v1 offset:13312
    v_mul_f32 v120, v120, abs(v36)
    v_mfma_f32_16x16x32_bf16 v[24:27], a[56:59], v[56:59], v[24:27]
    s_waitcnt lgkmcnt(4)
    v_mul_f32 v121, v121, abs(v37)
    v_cvt_pk_bf16_f32 v34, v120, v121
    v_mfma_f32_16x16x32_bf16 v[28:31], a[56:59], v[60:63], v[28:31]
    s_waitcnt lgkmcnt(2)
    v_pk_max_i16 v34, v34, 0
    v_mul_f32 v120, v38, v116
    v_mfma_f32_16x16x32_bf16 v[8:11], a[60:63], v[64:67], v[8:11]
    s_barrier
    ds_read_b128 v[80:83], v1 offset:14336
    v_mul_f32 v121, v39, v116
    v_mfma_f32_16x16x32_bf16 v[16:19], a[60:63], v[68:71], v[16:19]
    s_add_u32 s45, s45, 65536
    ds_read_b128 v[48:51], v4 offset:4096
    v_mul_f32 v120, v120, abs(v38)
    v_mfma_f32_16x16x32_bf16 v[20:23], a[64:67], v[68:71], v[20:23]
    v_mul_f32 v121, v121, abs(v39)
    v_cvt_pk_bf16_f32 v35, v120, v121
    v_mfma_f32_16x16x32_bf16 v[12:15], a[64:67], v[64:67], v[12:15]
    ds_read_b128 v[84:87], v1 offset:15360
    v_pk_max_i16 v35, v35, 0
    v_mfma_f32_16x16x32_bf16 v[24:27], a[68:71], v[64:67], v[24:27]
    buffer_store_dwordx4 v[32:35], v1, s[16:19], s44 offen offset:0 sc1
    v_mfma_f32_16x16x32_bf16 v[28:31], a[68:71], v[68:71], v[28:31]
    s_waitcnt lgkmcnt(3)
    v_mul_f32 v120, v40, v117
    v_mul_f32 v121, v41, v117
    v_mfma_f32_16x16x32_bf16 v[8:11], a[72:75], v[72:75], v[8:11]
    s_waitcnt lgkmcnt(1)
    ds_read_b128 v[56:59], v1 offset:16384
    v_mul_f32 v120, v120, abs(v40)
    v_mfma_f32_16x16x32_bf16 v[16:19], a[72:75], v[76:79], v[16:19]
    buffer_store_dwordx4 v[48:51], v1, s[16:19], s49 offen sc1
    v_mfma_f32_16x16x32_bf16 v[20:23], a[76:79], v[76:79], v[20:23]
    v_mul_f32 v121, v121, abs(v41)
    v_cvt_pk_bf16_f32 v40, v120, v121
    v_mfma_f32_16x16x32_bf16 v[12:15], a[76:79], v[72:75], v[12:15]
    ds_read_b128 v[60:63], v1 offset:17408
    v_pk_max_i16 v40, v40, 0
    v_mfma_f32_16x16x32_bf16 v[24:27], a[80:83], v[72:75], v[24:27]
    v_mul_f32 v120, v42, v117
    v_mul_f32 v121, v43, v117
    v_mfma_f32_16x16x32_bf16 v[28:31], a[80:83], v[76:79], v[28:31]
    s_waitcnt lgkmcnt(2)
    v_mul_f32 v120, v120, abs(v42)
    v_mul_f32 v121, v121, abs(v43)
    v_mfma_f32_16x16x32_bf16 v[8:11], a[84:87], v[80:83], v[8:11]
    ds_read_b128 v[64:67], v1 offset:18432
    v_cvt_pk_bf16_f32 v41, v120, v121
    v_mfma_f32_16x16x32_bf16 v[16:19], a[84:87], v[84:87], v[16:19]
    v_pk_max_i16 v41, v41, 0
    v_mul_f32 v120, v44, v117
    v_mfma_f32_16x16x32_bf16 v[20:23], a[88:91], v[84:87], v[20:23]
    v_mul_f32 v121, v45, v117
    v_mul_f32 v120, v120, abs(v44)
    v_mfma_f32_16x16x32_bf16 v[12:15], a[88:91], v[80:83], v[12:15]
    ds_read_b128 v[68:71], v1 offset:19456
    v_mul_f32 v121, v121, abs(v45)
    v_mfma_f32_16x16x32_bf16 v[24:27], a[92:95], v[80:83], v[24:27]
    v_cvt_pk_bf16_f32 v42, v120, v121
    v_pk_max_i16 v42, v42, 0
    v_mfma_f32_16x16x32_bf16 v[28:31], a[92:95], v[84:87], v[28:31]
    s_waitcnt lgkmcnt(2)
    v_mul_f32 v120, v46, v117
    v_mul_f32 v121, v47, v117
    v_mfma_f32_16x16x32_bf16 v[8:11], a[96:99], v[56:59], v[8:11]
    ds_read_b128 v[72:75], v1 offset:20480
    v_mul_f32 v120, v120, abs(v46)
    v_mfma_f32_16x16x32_bf16 v[16:19], a[96:99], v[60:63], v[16:19]
    v_mul_f32 v121, v121, abs(v47)
    v_cvt_pk_bf16_f32 v43, v120, v121
    v_mfma_f32_16x16x32_bf16 v[20:23], a[100:103], v[60:63], v[20:23]
    v_pk_max_i16 v43, v43, 0
    v_mfma_f32_16x16x32_bf16 v[12:15], a[100:103], v[56:59], v[12:15]
    ds_read_b128 v[76:79], v1 offset:21504
    v_mfma_f32_16x16x32_bf16 v[24:27], a[104:107], v[56:59], v[24:27]
    buffer_store_dwordx4 v[40:43], v1, s[16:19], s44 offen offset:1024 sc1
    v_mfma_f32_16x16x32_bf16 v[28:31], a[104:107], v[60:63], v[28:31]
    s_waitcnt lgkmcnt(2)
    ds_read_b64 v[36:37], v118 offset:0
    s_add_u32 m0, s43, 98304
    v_mfma_f32_16x16x32_bf16 v[8:11], a[108:111], v[64:67], v[8:11]
    s_add_u32 s42, s41, 0
    ds_read_b128 v[80:83], v1 offset:22528
    v_mfma_f32_16x16x32_bf16 v[16:19], a[108:111], v[68:71], v[16:19]
    buffer_load_dwordx4 v1, s[16:19], s42 offen offset:0 sc1 lds
    v_mfma_f32_16x16x32_bf16 v[20:23], a[112:115], v[68:71], v[20:23]
    ds_read_b64 v[38:39], v118 offset:128
    v_mfma_f32_16x16x32_bf16 v[12:15], a[112:115], v[64:67], v[12:15]
    ds_read_b128 v[84:87], v1 offset:23552
    v_mfma_f32_16x16x32_bf16 v[24:27], a[116:119], v[64:67], v[24:27]
    ds_read_b64 v[40:41], v118 offset:256
    v_mfma_f32_16x16x32_bf16 v[28:31], a[116:119], v[68:71], v[28:31]
    s_waitcnt lgkmcnt(5)
    ds_read_b64 v[42:43], v118 offset:384
    v_mfma_f32_16x16x32_bf16 v[8:11], a[120:123], v[72:75], v[8:11]
    ds_read_b128 v[56:59], v1 offset:24576
    v_mfma_f32_16x16x32_bf16 v[16:19], a[120:123], v[76:79], v[16:19]
    buffer_load_dwordx4 v1, s[16:19], s42 offen offset:1024 sc1 lds
    v_mfma_f32_16x16x32_bf16 v[20:23], a[124:127], v[76:79], v[20:23]
    v_mfma_f32_16x16x32_bf16 v[12:15], a[124:127], v[72:75], v[12:15]
    ds_read_b128 v[60:63], v1 offset:25600
    v_mfma_f32_16x16x32_bf16 v[24:27], a[128:131], v[72:75], v[24:27]
    s_waitcnt lgkmcnt(2)
    v_max3_u32 v44, v36, v37, v38
    v_max3_u32 v45, v39, v40, v41
    v_mfma_f32_16x16x32_bf16 v[28:31], a[128:131], v[76:79], v[28:31]
    s_waitcnt lgkmcnt(4)
    v_max3_u32 v44, v44, v42, v43
    v_max_u32 v44, v44, v45
    v_mfma_f32_16x16x32_bf16 v[8:11], a[132:135], v[80:83], v[8:11]
    ds_read_b128 v[64:67], v1 offset:26624
    v_cmp_eq_u32 vcc, -1, v44
    v_mfma_f32_16x16x32_bf16 v[16:19], a[132:135], v[84:87], v[16:19]
    buffer_load_dwordx4 v1, s[16:19], s42 offen offset:2048 sc1 lds
    v_mfma_f32_16x16x32_bf16 v[20:23], a[136:139], v[84:87], v[20:23]
    s_cbranch_vccnz L_sspin20
L_sback21:
    v_add_f32 v44, v40, v42
    v_add_f32 v45, v41, v43
    v_mfma_f32_16x16x32_bf16 v[12:15], a[136:139], v[80:83], v[12:15]
    ds_read_b128 v[68:71], v1 offset:27648
    v_add_f32 v36, v36, v38
    v_mfma_f32_16x16x32_bf16 v[24:27], a[140:143], v[80:83], v[24:27]
    v_add_f32 v37, v37, v39
    v_add_f32 v36, v36, v44
    v_mfma_f32_16x16x32_bf16 v[28:31], a[140:143], v[84:87], v[28:31]
    s_waitcnt lgkmcnt(2)
    v_add_f32 v37, v37, v45
    v_mov_b32 v44, v36
    v_mfma_f32_16x16x32_bf16 v[8:11], a[144:147], v[56:59], v[8:11]
    ds_read_b128 v[72:75], v1 offset:28672
    v_mov_b32 v45, v37
    v_mfma_f32_16x16x32_bf16 v[16:19], a[144:147], v[60:63], v[16:19]
    buffer_load_dwordx4 v1, s[16:19], s42 offen offset:3072 sc1 lds
    v_mfma_f32_16x16x32_bf16 v[20:23], a[148:151], v[60:63], v[20:23]
    s_add_u32 m0, s43, 114688
    v_permlane32_swap_b32 v36, v44
    v_mfma_f32_16x16x32_bf16 v[12:15], a[148:151], v[56:59], v[12:15]
    s_add_u32 s42, s41, 16384
    ds_read_b128 v[76:79], v1 offset:29696
    v_mfma_f32_16x16x32_bf16 v[24:27], a[152:155], v[56:59], v[24:27]
    v_permlane32_swap_b32 v37, v45
    v_mfma_f32_16x16x32_bf16 v[28:31], a[152:155], v[60:63], v[28:31]
    s_waitcnt lgkmcnt(2)
    v_add_f32 v36, v36, v44
    v_add_f32 v37, v37, v45
    v_mfma_f32_16x16x32_bf16 v[8:11], a[156:159], v[64:67], v[8:11]
    ds_read_b128 v[80:83], v1 offset:30720
    v_mul_f32 v112, 0xba800000, v36
    v_mfma_f32_16x16x32_bf16 v[16:19], a[156:159], v[68:71], v[16:19]
    buffer_load_dwordx4 v1, s[16:19], s42 offen offset:0 sc1 lds
    v_mfma_f32_16x16x32_bf16 v[20:23], a[160:163], v[68:71], v[20:23]
    v_mul_f32 v37, 0x3a800000, v37
    v_fma_f32 v37, -v112, v112, v37
    v_mfma_f32_16x16x32_bf16 v[12:15], a[160:163], v[64:67], v[12:15]
    ds_read_b128 v[84:87], v1 offset:31744
    v_mov_b32 v113, v112
    v_mfma_f32_16x16x32_bf16 v[24:27], a[164:167], v[64:67], v[24:27]
    v_max_f32 v37, 0, v37
    v_add_f32 v37, 0x3727c5ac, v37
    v_mfma_f32_16x16x32_bf16 v[28:31], a[164:167], v[68:71], v[28:31]
    s_waitcnt lgkmcnt(2)
    v_rsq_f32 v116, v37
    v_mfma_f32_16x16x32_bf16 v[8:11], a[168:171], v[72:75], v[8:11]
    ds_read_b128 v[56:59], v1 offset:32768
    v_mfma_f32_16x16x32_bf16 v[16:19], a[168:171], v[76:79], v[16:19]
    buffer_load_dwordx4 v1, s[16:19], s42 offen offset:1024 sc1 lds
    v_mfma_f32_16x16x32_bf16 v[20:23], a[172:175], v[76:79], v[20:23]
    v_permlane16_swap_b32 v112, v113
    v_mfma_f32_16x16x32_bf16 v[12:15], a[172:175], v[72:75], v[12:15]
    s_nop 0
    ds_read_b128 v[60:63], v1 offset:33792
    v_mul_f32 v114, v37, v116
    v_mfma_f32_16x16x32_bf16 v[24:27], a[176:179], v[72:75], v[24:27]
    v_mul_f32 v116, v116, v116
    v_mov_b32 v115, v114
    v_mfma_f32_16x16x32_bf16 v[28:31], a[176:179], v[76:79], v[28:31]
    s_waitcnt lgkmcnt(2)
    v_mov_b32 v117, v116
    v_fmac_f32 v16, v113, v88
    v_mfma_f32_16x16x32_bf16 v[8:11], a[180:183], v[80:83], v[8:11]
    ds_read_b128 v[64:67], v1 offset:34816
    v_fmac_f32 v12, v112, v92
    v_mfma_f32_16x16x32_bf16 v[16:19], a[180:183], v[84:87], v[16:19]
    buffer_load_dwordx4 v1, s[16:19], s42 offen offset:2048 sc1 lds
    v_mfma_f32_16x16x32_bf16 v[20:23], a[184:187], v[84:87], v[20:23]
    v_permlane16_swap_b32 v114, v115
    v_mfma_f32_16x16x32_bf16 v[12:15], a[184:187], v[80:83], v[12:15]
    s_nop 0
    ds_read_b128 v[68:71], v1 offset:35840
    v_fmac_f32 v8, v112, v88
    v_mfma_f32_16x16x32_bf16 v[24:27], a[188:191], v[80:83], v[24:27]
    v_permlane16_swap_b32 v116, v117
    v_mfma_f32_16x16x32_bf16 v[28:31], a[188:191], v[84:87], v[28:31]
    s_waitcnt lgkmcnt(2)
    v_fmac_f32 v17, v113, v89
    v_fmac_f32 v18, v113, v90
    v_mfma_f32_16x16x32_bf16 v[8:11], a[192:195], v[56:59], v[8:11]
    s_add_u32 s46, s46, 2048
    ds_read_b128 v[72:75], v1 offset:36864
    v_fmac_f32 v13, v112, v93
    v_mfma_f32_16x16x32_bf16 v[16:19], a[192:195], v[60:63], v[16:19]
    buffer_load_dwordx4 v1, s[16:19], s42 offen offset:3072 sc1 lds
    v_mfma_f32_16x16x32_bf16 v[20:23], a[196:199], v[60:63], v[20:23]
    s_add_u32 m0, s43, 131072
    v_fmac_f32 v9, v112, v89
    v_fmac_f32 v10, v112, v90
    v_mfma_f32_16x16x32_bf16 v[12:15], a[196:199], v[56:59], v[12:15]
    s_add_u32 s42, s41, 32768
    ds_read_b128 v[76:79], v1 offset:37888
    v_fmac_f32 v11, v112, v91
    v_mfma_f32_16x16x32_bf16 v[24:27], a[200:203], v[56:59], v[24:27]
    s_min_u32 s46, s46, s55
    v_fmac_f32 v8, v114, v100
    v_fmac_f32 v9, v114, v101
    v_mfma_f32_16x16x32_bf16 v[28:31], a[200:203], v[60:63], v[28:31]
    s_waitcnt lgkmcnt(2)
    v_fmac_f32 v19, v113, v91
    v_fmac_f32 v16, v115, v100
    v_mfma_f32_16x16x32_bf16 v[8:11], a[204:207], v[64:67], v[8:11]
    ds_read_b128 v[80:83], v1 offset:38912
    v_fmac_f32 v14, v112, v94
    v_mfma_f32_16x16x32_bf16 v[16:19], a[204:207], v[68:71], v[16:19]
    buffer_load_dwordx4 v1, s[16:19], s42 offen offset:0 sc1 lds
    v_mfma_f32_16x16x32_bf16 v[20:23], a[208:211], v[68:71], v[20:23]
    v_fmac_f32 v24, v112, v96
    v_fmac_f32 v10, v114, v102
    v_mfma_f32_16x16x32_bf16 v[12:15], a[208:211], v[64:67], v[12:15]
    ds_read_b128 v[84:87], v1 offset:39936
    v_fmac_f32 v11, v114, v103
    v_mfma_f32_16x16x32_bf16 v[24:27], a[212:215], v[64:67], v[24:27]
    v_fmac_f32 v17, v115, v101
    v_fmac_f32 v18, v115, v102
    v_mfma_f32_16x16x32_bf16 v[28:31], a[212:215], v[68:71], v[28:31]
    s_waitcnt lgkmcnt(2)
    v_fmac_f32 v19, v115, v103
    v_fmac_f32 v15, v112, v95
    v_mfma_f32_16x16x32_bf16 v[8:11], a[216:219], v[72:75], v[8:11]
    ds_read_b128 v[56:59], v1 offset:40960
    v_fmac_f32 v12, v114, v104
    v_mfma_f32_16x16x32_bf16 v[16:19], a[216:219], v[76:79], v[16:19]
    buffer_load_dwordx4 v1, s[16:19], s42 offen offset:1024 sc1 lds
    v_mfma_f32_16x16x32_bf16 v[20:23], a[220:223], v[76:79], v[20:23]
    v_fmac_f32 v25, v112, v97
    v_fmac_f32 v26, v112, v98
    v_mfma_f32_16x16x32_bf16 v[12:15], a[220:223], v[72:75], v[12:15]
    ds_read_b128 v[60:63], v1 offset:41984
    v_fmac_f32 v28, v113, v96
    v_mfma_f32_16x16x32_bf16 v[24:27], a[224:227], v[72:75], v[24:27]
    v_fmac_f32 v20, v113, v92
    v_fmac_f32 v21, v113, v93
    v_mfma_f32_16x16x32_bf16 v[28:31], a[224:227], v[76:79], v[28:31]
    s_waitcnt lgkmcnt(2)
    v_fmac_f32 v13, v114, v105
    v_fmac_f32 v14, v114, v106
    v_mfma_f32_16x16x32_bf16 v[8:11], a[228:231], v[80:83], v[8:11]
    ds_read_b128 v[64:67], v1 offset:43008
    v_fmac_f32 v15, v114, v107
    v_mfma_f32_16x16x32_bf16 v[16:19], a[228:231], v[84:87], v[16:19]
    buffer_load_dwordx4 v1, s[16:19], s42 offen offset:2048 sc1 lds
    v_mfma_f32_16x16x32_bf16 v[20:23], a[232:235], v[84:87], v[20:23]
    v_fmac_f32 v27, v112, v99
    v_fmac_f32 v24, v114, v108
    v_mfma_f32_16x16x32_bf16 v[12:15], a[232:235], v[80:83], v[12:15]
    ds_read_b128 v[68:71], v1 offset:44032
    v_fmac_f32 v29, v113, v97
    v_mfma_f32_16x16x32_bf16 v[24:27], a[236:239], v[80:83], v[24:27]
    s_waitcnt vmcnt(7)
    v_fmac_f32 v22, v113, v94
    v_fmac_f32 v23, v113, v95
    v_mfma_f32_16x16x32_bf16 v[28:31], a[236:239], v[84:87], v[28:31]
    s_waitcnt lgkmcnt(2)
    v_fmac_f32 v20, v115, v104
    v_fmac_f32 v21, v115, v105
    v_mfma_f32_16x16x32_bf16 v[8:11], a[240:243], v[56:59], v[8:11]
    s_barrier
    ds_read_b128 v[72:75], v1 offset:45056
    v_fmac_f32 v22, v115, v106
    v_mfma_f32_16x16x32_bf16 v[16:19], a[240:243], v[60:63], v[16:19]
    buffer_store_dword v124, v124, s[16:19], s91 offen sc1
    v_mfma_f32_16x16x32_bf16 v[20:23], a[244:247], v[60:63], v[20:23]
    buffer_load_dwordx4 v1, s[16:19], s42 offen offset:3072 sc1 lds
    v_mfma_f32_16x16x32_bf16 v[12:15], a[244:247], v[56:59], v[12:15]
    s_add_u32 s91, s91, 65536
    ds_read_b128 v[76:79], v1 offset:46080
    v_fmac_f32 v30, v113, v98
    v_mfma_f32_16x16x32_bf16 v[24:27], a[248:251], v[56:59], v[24:27]
    s_add_u32 m0, s43, 147456
    v_fmac_f32 v23, v115, v107
    s_add_u32 s42, s41, 49152
    v_mfma_f32_16x16x32_bf16 v[28:31], a[248:251], v[60:63], v[28:31]
    s_waitcnt lgkmcnt(2)
    v_mfma_f32_16x16x32_bf16 v[8:11], a[252:255], v[64:67], v[8:11]
    ds_read_b128 v[80:83], v1 offset:47104
    v_fmac_f32 v25, v114, v109
    v_mfma_f32_16x16x32_bf16 v[16:19], a[252:255], v[68:71], v[16:19]
    v_fmac_f32 v26, v114, v110
    v_fmac_f32 v27, v114, v111
    v_mfma_f32_16x16x32_bf16 v[20:23], v[128:131], v[68:71], v[20:23]
    buffer_load_dwordx4 v1, s[16:19], s42 offen offset:0 sc1 lds
    v_mfma_f32_16x16x32_bf16 v[12:15], v[128:131], v[64:67], v[12:15]
    ds_read_b128 v[84:87], v1 offset:48128
    v_fmac_f32 v31, v113, v99
    v_mfma_f32_16x16x32_bf16 v[24:27], v[132:135], v[64:67], v[24:27]
    v_mfma_f32_16x16x32_bf16 v[28:31], v[132:135], v[68:71], v[28:31]
    s_waitcnt lgkmcnt(2)
    v_mfma_f32_16x16x32_bf16 v[8:11], v[136:139], v[72:75], v[8:11]
    ds_read_b128 v[56:59], v1 offset:49152
    v_mfma_f32_16x16x32_bf16 v[16:19], v[136:139], v[76:79], v[16:19]
    v_mfma_f32_16x16x32_bf16 v[20:23], v[140:143], v[76:79], v[20:23]
    buffer_load_dwordx4 v1, s[16:19], s42 offen offset:1024 sc1 lds
    v_mfma_f32_16x16x32_bf16 v[12:15], v[140:143], v[72:75], v[12:15]
    ds_read_b128 v[60:63], v1 offset:50176
    v_fmac_f32 v28, v115, v108
    v_mfma_f32_16x16x32_bf16 v[24:27], v[144:147], v[72:75], v[24:27]
    v_mfma_f32_16x16x32_bf16 v[28:31], v[144:147], v[76:79], v[28:31]
    s_waitcnt lgkmcnt(2)
    v_mfma_f32_16x16x32_bf16 v[8:11], v[148:151], v[80:83], v[8:11]
    ds_read_b128 v[64:67], v1 offset:51200
    v_mfma_f32_16x16x32_bf16 v[16:19], v[148:151], v[84:87], v[16:19]
    v_mfma_f32_16x16x32_bf16 v[20:23], v[152:155], v[84:87], v[20:23]
    buffer_load_dwordx4 v1, s[16:19], s42 offen offset:2048 sc1 lds
    v_mfma_f32_16x16x32_bf16 v[12:15], v[152:155], v[80:83], v[12:15]
    ds_read_b128 v[68:71], v1 offset:52224
    v_fmac_f32 v29, v115, v109
    v_mfma_f32_16x16x32_bf16 v[24:27], v[156:159], v[80:83], v[24:27]
    v_mfma_f32_16x16x32_bf16 v[28:31], v[156:159], v[84:87], v[28:31]
    s_waitcnt lgkmcnt(2)
    v_mfma_f32_16x16x32_bf16 v[8:11], v[160:163], v[56:59], v[8:11]
    ds_read_b128 v[72:75], v1 offset:53248
    v_mfma_f32_16x16x32_bf16 v[16:19], v[160:163], v[60:63], v[16:19]
    v_mfma_f32_16x16x32_bf16 v[20:23], v[164:167], v[60:63], v[20:23]
    buffer_load_dwordx4 v1, s[16:19], s42 offen offset:3072 sc1 lds
    v_mfma_f32_16x16x32_bf16 v[12:15], v[164:167], v[56:59], v[12:15]
    s_add_u32 m0, s52, 73728
    ds_read_b128 v[76:79], v1 offset:54272
    v_fmac_f32 v30, v115, v110
    v_mfma_f32_16x16x32_bf16 v[24:27], v[168:171], v[56:59], v[24:27]
    s_add_u32 s42, s46, s52
    v_mfma_f32_16x16x32_bf16 v[28:31], v[168:171], v[60:63], v[28:31]
    s_waitcnt lgkmcnt(2)
    v_mfma_f32_16x16x32_bf16 v[8:11], v[172:175], v[64:67], v[8:11]
    ds_read_b128 v[80:83], v1 offset:55296
    v_mfma_f32_16x16x32_bf16 v[16:19], v[172:175], v[68:71], v[16:19]
    buffer_load_dwordx4 v1, s[16:19], s42 offen sc1 lds
    v_mfma_f32_16x16x32_bf16 v[20:23], v[176:179], v[68:71], v[20:23]
    v_fmac_f32 v31, v115, v111
    v_mfma_f32_16x16x32_bf16 v[12:15], v[176:179], v[64:67], v[12:15]
    ds_read_b128 v[84:87], v1 offset:56320
    v_mfma_f32_16x16x32_bf16 v[24:27], v[180:183], v[64:67], v[24:27]
    v_mfma_f32_16x16x32_bf16 v[28:31], v[180:183], v[68:71], v[28:31]
    s_waitcnt lgkmcnt(2)
    v_mfma_f32_16x16x32_bf16 v[8:11], v[184:187], v[72:75], v[8:11]
    ds_read_b128 v[56:59], v1 offset:57344
    v_mfma_f32_16x16x32_bf16 v[16:19], v[184:187], v[76:79], v[16:19]
    v_mfma_f32_16x16x32_bf16 v[20:23], v[188:191], v[76:79], v[20:23]
    v_mfma_f32_16x16x32_bf16 v[12:15], v[188:191], v[72:75], v[12:15]
    ds_read_b128 v[60:63], v1 offset:58368
    v_mfma_f32_16x16x32_bf16 v[24:27], v[192:195], v[72:75], v[24:27]
    v_mfma_f32_16x16x32_bf16 v[28:31], v[192:195], v[76:79], v[28:31]
    s_waitcnt lgkmcnt(2)
    v_mfma_f32_16x16x32_bf16 v[8:11], v[196:199], v[80:83], v[8:11]
    ds_read_b128 v[64:67], v1 offset:59392
    v_mfma_f32_16x16x32_bf16 v[16:19], v[196:199], v[84:87], v[16:19]
    v_mfma_f32_16x16x32_bf16 v[20:23], v[200:203], v[84:87], v[20:23]
    v_mfma_f32_16x16x32_bf16 v[12:15], v[200:203], v[80:83], v[12:15]
    ds_read_b128 v[68:71], v1 offset:60416
    v_mfma_f32_16x16x32_bf16 v[24:27], v[204:207], v[80:83], v[24:27]
    v_mfma_f32_16x16x32_bf16 v[28:31], v[204:207], v[84:87], v[28:31]
    s_waitcnt lgkmcnt(2)
    v_mfma_f32_16x16x32_bf16 v[8:11], v[208:211], v[56:59], v[8:11]
    ds_read_b128 v[72:75], v1 offset:61440
    v_mfma_f32_16x16x32_bf16 v[16:19], v[208:211], v[60:63], v[16:19]
    v_mfma_f32_16x16x32_bf16 v[20:23], v[212:215], v[60:63], v[20:23]
    buffer_load_dword v7, v5, s[16:19], s45 offen sc1
    v_mfma_f32_16x16x32_bf16 v[12:15], v[212:215], v[56:59], v[12:15]
    ds_read_b128 v[76:79], v1 offset:62464
    v_mfma_f32_16x16x32_bf16 v[24:27], v[216:219], v[56:59], v[24:27]
    v_mfma_f32_16x16x32_bf16 v[28:31], v[216:219], v[60:63], v[28:31]
    s_waitcnt lgkmcnt(2)
    v_mfma_f32_16x16x32_bf16 v[8:11], v[220:223], v[64:67], v[8:11]
    ds_read_b128 v[80:83], v1 offset:63488
    v_mfma_f32_16x16x32_bf16 v[16:19], v[220:223], v[68:71], v[16:19]
    v_mfma_f32_16x16x32_bf16 v[20:23], v[224:227], v[68:71], v[20:23]
    v_mfma_f32_16x16x32_bf16 v[12:15], v[224:227], v[64:67], v[12:15]
    ds_read_b128 v[84:87], v1 offset:64512
    v_mfma_f32_16x16x32_bf16 v[24:27], v[228:231], v[64:67], v[24:27]
    v_mfma_f32_16x16x32_bf16 v[28:31], v[228:231], v[68:71], v[28:31]
    s_waitcnt lgkmcnt(2)
    v_mfma_f32_16x16x32_bf16 v[8:11], v[232:235], v[72:75], v[8:11]
    ds_read_b128 v[56:59], v2 offset:0
    v_mfma_f32_16x16x32_bf16 v[16:19], v[232:235], v[76:79], v[16:19]
    v_mfma_f32_16x16x32_bf16 v[20:23], v[236:239], v[76:79], v[20:23]
    v_mfma_f32_16x16x32_bf16 v[12:15], v[236:239], v[72:75], v[12:15]
    ds_read_b128 v[60:63], v2 offset:1024
    v_mfma_f32_16x16x32_bf16 v[24:27], v[240:243], v[72:75], v[24:27]
    v_mfma_f32_16x16x32_bf16 v[28:31], v[240:243], v[76:79], v[28:31]
    s_waitcnt lgkmcnt(2)
    v_mfma_f32_16x16x32_bf16 v[8:11], v[244:247], v[80:83], v[8:11]
    ds_read_b128 v[64:67], v2 offset:2048
    v_mfma_f32_16x16x32_bf16 v[16:19], v[244:247], v[84:87], v[16:19]
    v_mfma_f32_16x16x32_bf16 v[20:23], v[248:251], v[84:87], v[20:23]
    v_mfma_f32_16x16x32_bf16 v[12:15], v[248:251], v[80:83], v[12:15]
    ds_read_b128 v[68:71], v2 offset:3072
    v_mfma_f32_16x16x32_bf16 v[24:27], v[252:255], v[80:83], v[24:27]
    s_add_u32 s36, s36, 1
    v_mfma_f32_16x16x32_bf16 v[28:31], v[252:255], v[84:87], v[28:31]
    s_waitcnt lgkmcnt(2)
L_a_b1:
    v_mfma_f32_16x16x32_bf16 v[32:35], a[0:3], v[56:59], 0
    s_and_b32 s44, s90, 0xffffffff
    ds_read_b128 v[72:75], v2 offset:4096
    v_mul_f32 v120, v24, v116
    v_mfma_f32_16x16x32_bf16 v[40:43], a[0:3], v[60:63], 0
    s_cmp_lt_i32 s36, 1
    v_mul_f32 v121, v25, v116
    v_mul_f32 v120, v120, abs(v24)
    v_mfma_f32_16x16x32_bf16 v[44:47], a[4:7], v[60:63], 0
    s_cselect_b32 s44, 0x5e00000, s44
    v_mul_f32 v121, v121, abs(v25)
    v_cvt_pk_bf16_f32 v24, v120, v121
    v_mfma_f32_16x16x32_bf16 v[36:39], a[4:7], v[56:59], 0
    s_add_u32 s49, s44, s87
    ds_read_b128 v[76:79], v2 offset:5120
    v_pk_max_i16 v24, v24, 0
    v_mfma_f32_16x16x32_bf16 v[48:51], a[8:11], v[56:59], 0
    s_max_u32 s44, s44, s88
    v_mul_f32 v120, v26, v116
    v_mul_f32 v121, v27, v116
    v_mfma_f32_16x16x32_bf16 v[52:55], a[8:11], v[60:63], 0
    s_waitcnt lgkmcnt(2)
    v_mul_f32 v120, v120, abs(v26)
    v_mul_f32 v121, v121, abs(v27)
    v_mfma_f32_16x16x32_bf16 v[32:35], a[12:15], v[64:67], v[32:35]
    s_add_u32 s90, s90, 262144
    ds_read_b128 v[80:83], v2 offset:6144
    v_cvt_pk_bf16_f32 v25, v120, v121
    v_mfma_f32_16x16x32_bf16 v[40:43], a[12:15], v[68:71], v[40:43]
    s_add_u32 s98, s98, 65536
    v_pk_max_i16 v25, v25, 0
    s_min_i32 s98, s98, s96
    v_mfma_f32_16x16x32_bf16 v[44:47], a[16:19], v[68:71], v[44:47]
    s_and_b32 s41, s98, 0xffffffff
    ds_write_b64 v3, v[24:25] offset:0
    v_mfma_f32_16x16x32_bf16 v[36:39], a[16:19], v[64:67], v[36:39]
    ds_read_b128 v[84:87], v2 offset:7168
    v_mul_f32 v120, v28, v117
    v_mfma_f32_16x16x32_bf16 v[48:51], a[20:23], v[64:67], v[48:51]
    v_mul_f32 v121, v29, v117
    v_mul_f32 v120, v120, abs(v28)
    v_mfma_f32_16x16x32_bf16 v[52:55], a[20:23], v[68:71], v[52:55]
    s_waitcnt lgkmcnt(3)
    v_mul_f32 v121, v121, abs(v29)
    v_cvt_pk_bf16_f32 v28, v120, v121
    v_mfma_f32_16x16x32_bf16 v[32:35], a[24:27], v[72:75], v[32:35]
    ds_read_b128 v[56:59], v2 offset:8192
    v_pk_max_i16 v28, v28, 0
    v_mfma_f32_16x16x32_bf16 v[40:43], a[24:27], v[76:79], v[40:43]
    v_mul_f32 v120, v30, v117
    v_mul_f32 v121, v31, v117
    v_mfma_f32_16x16x32_bf16 v[44:47], a[28:31], v[76:79], v[44:47]
    v_mul_f32 v120, v120, abs(v30)
    v_mul_f32 v121, v121, abs(v31)
    v_mfma_f32_16x16x32_bf16 v[36:39], a[28:31], v[72:75], v[36:39]
    ds_read_b128 v[60:63], v2 offset:9216
    v_cvt_pk_bf16_f32 v29, v120, v121
    v_mfma_f32_16x16x32_bf16 v[48:51], a[32:35], v[72:75], v[48:51]
    v_pk_max_i16 v29, v29, 0
    v_mfma_f32_16x16x32_bf16 v[52:55], a[32:35], v[76:79], v[52:55]
    s_waitcnt lgkmcnt(2)
    ds_write_b64 v3, v[28:29] offset:1024
    v_mfma_f32_16x16x32_bf16 v[32:35], a[36:39], v[80:83], v[32:35]
    ds_read_b128 v[64:67], v2 offset:10240
    v_mul_f32 v120, v8, v116
    v_mfma_f32_16x16x32_bf16 v[40:43], a[36:39], v[84:87], v[40:43]
    v_mul_f32 v121, v9, v116
    v_mul_f32 v120, v120, abs(v8)
    v_mfma_f32_16x16x32_bf16 v[44:47], a[40:43], v[84:87], v[44:47]
    v_mul_f32 v121, v121, abs(v9)
    v_cvt_pk_bf16_f32 v8, v120, v121
    v_mfma_f32_16x16x32_bf16 v[36:39], a[40:43], v[80:83], v[36:39]
    ds_read_b128 v[68:71], v2 offset:11264
    v_pk_max_i16 v8, v8, 0
    v_mfma_f32_16x16x32_bf16 v[48:51], a[44:47], v[80:83], v[48:51]
    v_mul_f32 v120, v10, v116
    v_mul_f32 v121, v11, v116
    v_mfma_f32_16x16x32_bf16 v[52:55], a[44:47], v[84:87], v[52:55]
    s_waitcnt lgkmcnt(3)
    v_mul_f32 v120, v120, abs(v10)
    v_mul_f32 v121, v121, abs(v11)
    v_mfma_f32_16x16x32_bf16 v[32:35], a[48:51], v[56:59], v[32:35]
    ds_read_b128 v[72:75], v2 offset:12288
    v_cvt_pk_bf16_f32 v9, v120, v121
    v_mfma_f32_16x16x32_bf16 v[40:43], a[48:51], v[60:63], v[40:43]
    s_waitcnt vmcnt(0)
    v_cmp_ne_u32 vcc, 0, v7
    v_pk_max_i16 v9, v9, 0
    v_mfma_f32_16x16x32_bf16 v[44:47], a[52:55], v[60:63], v[44:47]
    v_mul_f32 v120, v12, v116
    v_mul_f32 v121, v13, v116
    v_mfma_f32_16x16x32_bf16 v[36:39], a[52:55], v[56:59], v[36:39]
    s_cbranch_vccnz L_spin22
L_back23:
    ds_read_b128 v[76:79], v2 offset:13312
    v_mul_f32 v120, v120, abs(v12)
    v_mfma_f32_16x16x32_bf16 v[48:51], a[56:59], v[56:59], v[48:51]
    s_waitcnt lgkmcnt(4)
    v_mul_f32 v121, v121, abs(v13)
    v_cvt_pk_bf16_f32 v10, v120, v121
    v_mfma_f32_16x16x32_bf16 v[52:55], a[56:59], v[60:63], v[52:55]
    s_waitcnt lgkmcnt(2)
    v_pk_max_i16 v10, v10, 0
    v_mul_f32 v120, v14, v116
    v_mfma_f32_16x16x32_bf16 v[32:35], a[60:63], v[64:67], v[32:35]
    s_barrier
    ds_read_b128 v[80:83], v2 offset:14336
    v_mul_f32 v121, v15, v116
    v_mfma_f32_16x16x32_bf16 v[40:43], a[60:63], v[68:71], v[40:43]
    s_add_u32 s45, s45, 65536
    ds_read_b128 v[24:27], v4 offset:0
    v_mul_f32 v120, v120, abs(v14)
    v_mfma_f32_16x16x32_bf16 v[44:47], a[64:67], v[68:71], v[44:47]
    v_mul_f32 v121, v121, abs(v15)
    v_cvt_pk_bf16_f32 v11, v120, v121
    v_mfma_f32_16x16x32_bf16 v[36:39], a[64:67], v[64:67], v[36:39]
    ds_read_b128 v[84:87], v2 offset:15360
    v_pk_max_i16 v11, v11, 0
    v_mfma_f32_16x16x32_bf16 v[48:51], a[68:71], v[64:67], v[48:51]
    buffer_store_dwordx4 v[8:11], v1, s[16:19], s44 offen offset:0 sc1
    v_mfma_f32_16x16x32_bf16 v[52:55], a[68:71], v[68:71], v[52:55]
    s_waitcnt lgkmcnt(3)
    v_mul_f32 v120, v16, v117
    v_mul_f32 v121, v17, v117
    v_mfma_f32_16x16x32_bf16 v[32:35], a[72:75], v[72:75], v[32:35]
    s_waitcnt lgkmcnt(1)
    ds_read_b128 v[56:59], v2 offset:16384
    v_mul_f32 v120, v120, abs(v16)
    v_mfma_f32_16x16x32_bf16 v[40:43], a[72:75], v[76:79], v[40:43]
    buffer_store_dwordx4 v[24:27], v1, s[16:19], s49 offen sc1
    v_mfma_f32_16x16x32_bf16 v[44:47], a[76:79], v[76:79], v[44:47]
    v_mul_f32 v121, v121, abs(v17)
    v_cvt_pk_bf16_f32 v16, v120, v121
    v_mfma_f32_16x16x32_bf16 v[36:39], a[76:79], v[72:75], v[36:39]
    ds_read_b128 v[60:63], v2 offset:17408
    v_pk_max_i16 v16, v16, 0
    v_mfma_f32_16x16x32_bf16 v[48:51], a[80:83], v[72:75], v[48:51]
    v_mul_f32 v120, v18, v117
    v_mul_f32 v121, v19, v117
    v_mfma_f32_16x16x32_bf16 v[52:55], a[80:83], v[76:79], v[52:55]
    s_waitcnt lgkmcnt(2)
    v_mul_f32 v120, v120, abs(v18)
    v_mul_f32 v121, v121, abs(v19)
    v_mfma_f32_16x16x32_bf16 v[32:35], a[84:87], v[80:83], v[32:35]
    ds_read_b128 v[64:67], v2 offset:18432
    v_cvt_pk_bf16_f32 v17, v120, v121
    v_mfma_f32_16x16x32_bf16 v[40:43], a[84:87], v[84:87], v[40:43]
    v_pk_max_i16 v17, v17, 0
    v_mul_f32 v120, v20, v117
    v_mfma_f32_16x16x32_bf16 v[44:47], a[88:91], v[84:87], v[44:47]
    v_mul_f32 v121, v21, v117
    v_mul_f32 v120, v120, abs(v20)
    v_mfma_f32_16x16x32_bf16 v[36:39], a[88:91], v[80:83], v[36:39]
    ds_read_b128 v[68:71], v2 offset:19456
    v_mul_f32 v121, v121, abs(v21)
    v_mfma_f32_16x16x32_bf16 v[48:51], a[92:95], v[80:83], v[48:51]
    v_cvt_pk_bf16_f32 v18, v120, v121
    v_pk_max_i16 v18, v18, 0
    v_mfma_f32_16x16x32_bf16 v[52:55], a[92:95], v[84:87], v[52:55]
    s_waitcnt lgkmcnt(2)
    v_mul_f32 v120, v22, v117
    v_mul_f32 v121, v23, v117
    v_mfma_f32_16x16x32_bf16 v[32:35], a[96:99], v[56:59], v[32:35]
    ds_read_b128 v[72:75], v2 offset:20480
    v_mul_f32 v120, v120, abs(v22)
    v_mfma_f32_16x16x32_bf16 v[40:43], a[96:99], v[60:63], v[40:43]
    v_mul_f32 v121, v121, abs(v23)
    v_cvt_pk_bf16_f32 v19, v120, v121
    v_mfma_f32_16x16x32_bf16 v[44:47], a[100:103], v[60:63], v[44:47]
    v_pk_max_i16 v19, v19, 0
    v_mfma_f32_16x16x32_bf16 v[36:39], a[100:103], v[56:59], v[36:39]
    ds_read_b128 v[76:79], v2 offset:21504
    v_mfma_f32_16x16x32_bf16 v[48:51], a[104:107], v[56:59], v[48:51]
    buffer_store_dwordx4 v[16:19], v1, s[16:19], s44 offen offset:1024 sc1
    v_mfma_f32_16x16x32_bf16 v[52:55], a[104:107], v[60:63], v[52:55]
    s_waitcnt lgkmcnt(2)
    ds_read_b64 v[12:13], v118 offset:0
    s_add_u32 m0, s43, 0
    v_mfma_f32_16x16x32_bf16 v[32:35], a[108:111], v[64:67], v[32:35]
    s_add_u32 s42, s41, 0
    ds_read_b128 v[80:83], v2 offset:22528
    v_mfma_f32_16x16x32_bf16 v[40:43], a[108:111], v[68:71], v[40:43]
    buffer_load_dwordx4 v1, s[16:19], s42 offen offset:0 sc1 lds
    v_mfma_f32_16x16x32_bf16 v[44:47], a[112:115], v[68:71], v[44:47]
    ds_read_b64 v[14:15], v118 offset:128
    v_mfma_f32_16x16x32_bf16 v[36:39], a[112:115], v[64:67], v[36:39]
    ds_read_b128 v[84:87], v2 offset:23552
    v_mfma_f32_16x16x32_bf16 v[48:51], a[116:119], v[64:67], v[48:51]
    ds_read_b64 v[16:17], v118 offset:256
    v_mfma_f32_16x16x32_bf16 v[52:55], a[116:119], v[68:71], v[52:55]
    s_waitcnt lgkmcnt(5)
    ds_read_b64 v[18:19], v118 offset:384
    v_mfma_f32_16x16x32_bf16 v[32:35], a[120:123], v[72:75], v[32:35]
    ds_read_b128 v[56:59], v2 offset:24576
    v_mfma_f32_16x16x32_bf16 v[40:43], a[120:123], v[76:79], v[40:43]
    buffer_load_dwordx4 v1, s[16:19], s42 offen offset:1024 sc1 lds
    v_mfma_f32_16x16x32_bf16 v[44:47], a[124:127], v[76:79], v[44:47]
    v_mfma_f32_16x16x32_bf16 v[36:39], a[124:127], v[72:75], v[36:39]
    ds_read_b128 v[60:63], v2 offset:25600
    v_mfma_f32_16x16x32_bf16 v[48:51], a[128:131], v[72:75], v[48:51]
    s_waitcnt lgkmcnt(2)
    v_max3_u32 v20, v12, v13, v14
    v_max3_u32 v21, v15, v16, v17
    v_mfma_f32_16x16x32_bf16 v[52:55], a[128:131], v[76:79], v[52:55]
    s_waitcnt lgkmcnt(4)
    v_max3_u32 v20, v20, v18, v19
    v_max_u32 v20, v20, v21
    v_mfma_f32_16x16x32_bf16 v[32:35], a[132:135], v[80:83], v[32:35]
    ds_read_b128 v[64:67], v2 offset:26624
    v_cmp_eq_u32 vcc, -1, v20
    v_mfma_f32_16x16x32_bf16 v[40:43], a[132:135], v[84:87], v[40:43]
    buffer_load_dwordx4 v1, s[16:19], s42 offen offset:2048 sc1 lds
    v_mfma_f32_16x16x32_bf16 v[44:47], a[136:139], v[84:87], v[44:47]
    s_cbranch_vccnz L_sspin24
L_sback25:
    v_add_f32 v20, v16, v18
    v_add_f32 v21, v17, v19
    v_mfma_f32_16x16x32_bf16 v[36:39], a[136:139], v[80:83], v[36:39]
    ds_read_b128 v[68:71], v2 offset:27648
    v_add_f32 v12, v12, v14
    v_mfma_f32_16x16x32_bf16 v[48:51], a[140:143], v[80:83], v[48:51]
    v_add_f32 v13, v13, v15
    v_add_f32 v12, v12, v20
    v_mfma_f32_16x16x32_bf16 v[52:55], a[140:143], v[84:87], v[52:55]
    s_waitcnt lgkmcnt(2)
    v_add_f32 v13, v13, v21
    v_mov_b32 v20, v12
    v_mfma_f32_16x16x32_bf16 v[32:35], a[144:147], v[56:59], v[32:35]
    ds_read_b128 v[72:75], v2 offset:28672
    v_mov_b32 v21, v13
    v_mfma_f32_16x16x32_bf16 v[40:43], a[144:147], v[60:63], v[40:43]
    buffer_load_dwordx4 v1, s[16:19], s42 offen offset:3072 sc1 lds
    v_mfma_f32_16x16x32_bf16 v[44:47], a[148:151], v[60:63], v[44:47]
    s_add_u32 m0, s43, 16384
    v_permlane32_swap_b32 v12, v20
    v_mfma_f32_16x16x32_bf16 v[36:39], a[148:151], v[56:59], v[36:39]
    s_add_u32 s42, s41, 16384
    ds_read_b128 v[76:79], v2 offset:29696
    v_mfma_f32_16x16x32_bf16 v[48:51], a[152:155], v[56:59], v[48:51]
    v_permlane32_swap_b32 v13, v21
    v_mfma_f32_16x16x32_bf16 v[52:55], a[152:155], v[60:63], v[52:55]
    s_waitcnt lgkmcnt(2)
    v_add_f32 v12, v12, v20
    v_add_f32 v13, v13, v21
    v_mfma_f32_16x16x32_bf16 v[32:35], a[156:159], v[64:67], v[32:35]
    ds_read_b128 v[80:83], v2 offset:30720
    v_mul_f32 v112, 0xba800000, v12
    v_mfma_f32_16x16x32_bf16 v[40:43], a[156:159], v[68:71], v[40:43]
    buffer_load_dwordx4 v1, s[16:19], s42 offen offset:0 sc1 lds
    v_mfma_f32_16x16x32_bf16 v[44:47], a[160:163], v[68:71], v[44:47]
    v_mul_f32 v13, 0x3a800000, v13
    v_fma_f32 v13, -v112, v112, v13
    v_mfma_f32_16x16x32_bf16 v[36:39], a[160:163], v[64:67], v[36:39]
    ds_read_b128 v[84:87], v2 offset:31744
    v_mov_b32 v113, v112
    v_mfma_f32_16x16x32_bf16 v[48:51], a[164:167], v[64:67], v[48:51]
    v_max_f32 v13, 0, v13
    v_add_f32 v13, 0x3727c5ac, v13
    v_mfma_f32_16x16x32_bf16 v[52:55], a[164:167], v[68:71], v[52:55]
    s_waitcnt lgkmcnt(2)
    v_rsq_f32 v116, v13
    v_mfma_f32_16x16x32_bf16 v[32:35], a[168:171], v[72:75], v[32:35]
    ds_read_b128 v[56:59], v2 offset:32768
    v_mfma_f32_16x16x32_bf16 v[40:43], a[168:171], v[76:79], v[40:43]
    buffer_load_dwordx4 v1, s[16:19], s42 offen offset:1024 sc1 lds
    v_mfma_f32_16x16x32_bf16 v[44:47], a[172:175], v[76:79], v[44:47]
    v_permlane16_swap_b32 v112, v113
    v_mfma_f32_16x16x32_bf16 v[36:39], a[172:175], v[72:75], v[36:39]
    s_nop 0
    ds_read_b128 v[60:63], v2 offset:33792
    v_mul_f32 v114, v13, v116
    v_mfma_f32_16x16x32_bf16 v[48:51], a[176:179], v[72:75], v[48:51]
    v_mul_f32 v116, v116, v116
    v_mov_b32 v115, v114
    v_mfma_f32_16x16x32_bf16 v[52:55], a[176:179], v[76:79], v[52:55]
    s_waitcnt lgkmcnt(2)
    v_mov_b32 v117, v116
    v_fmac_f32 v40, v113, v88
    v_mfma_f32_16x16x32_bf16 v[32:35], a[180:183], v[80:83], v[32:35]
    ds_read_b128 v[64:67], v2 offset:34816
    v_fmac_f32 v36, v112, v92
    v_mfma_f32_16x16x32_bf16 v[40:43], a[180:183], v[84:87], v[40:43]
    buffer_load_dwordx4 v1, s[16:19], s42 offen offset:2048 sc1 lds
    v_mfma_f32_16x16x32_bf16 v[44:47], a[184:187], v[84:87], v[44:47]
    v_permlane16_swap_b32 v114, v115
    v_mfma_f32_16x16x32_bf16 v[36:39], a[184:187], v[80:83], v[36:39]
    s_nop 0
    ds_read_b128 v[68:71], v2 offset:35840
    v_fmac_f32 v32, v112, v88
    v_mfma_f32_16x16x32_bf16 v[48:51], a[188:191], v[80:83], v[48:51]
    v_permlane16_swap_b32 v116, v117
    v_mfma_f32_16x16x32_bf16 v[52:55], a[188:191], v[84:87], v[52:55]
    s_waitcnt lgkmcnt(2)
    v_fmac_f32 v41, v113, v89
    v_fmac_f32 v42, v113, v90
    v_mfma_f32_16x16x32_bf16 v[32:35], a[192:195], v[56:59], v[32:35]
    s_add_u32 s46, s46, 2048
    ds_read_b128 v[72:75], v2 offset:36864
    v_fmac_f32 v37, v112, v93
    v_mfma_f32_16x16x32_bf16 v[40:43], a[192:195], v[60:63], v[40:43]
    buffer_load_dwordx4 v1, s[16:19], s42 offen offset:3072 sc1 lds
    v_mfma_f32_16x16x32_bf16 v[44:47], a[196:199], v[60:63], v[44:47]
    s_add_u32 m0, s43, 32768
    v_fmac_f32 v33, v112, v89
    v_fmac_f32 v34, v112, v90
    v_mfma_f32_16x16x32_bf16 v[36:39], a[196:199], v[56:59], v[36:39]
    s_add_u32 s42, s41, 32768
    ds_read_b128 v[76:79], v2 offset:37888
    v_fmac_f32 v35, v112, v91
    v_mfma_f32_16x16x32_bf16 v[48:51], a[200:203], v[56:59], v[48:51]
    s_min_u32 s46, s46, s55
    v_fmac_f32 v32, v114, v100
    v_fmac_f32 v33, v114, v101
    v_mfma_f32_16x16x32_bf16 v[52:55], a[200:203], v[60:63], v[52:55]
    s_waitcnt lgkmcnt(2)
    v_fmac_f32 v43, v113, v91
    v_fmac_f32 v40, v115, v100
    v_mfma_f32_16x16x32_bf16 v[32:35], a[204:207], v[64:67], v[32:35]
    ds_read_b128 v[80:83], v2 offset:38912
    v_fmac_f32 v38, v112, v94
    v_mfma_f32_16x16x32_bf16 v[40:43], a[204:207], v[68:71], v[40:43]
    buffer_load_dwordx4 v1, s[16:19], s42 offen offset:0 sc1 lds
    v_mfma_f32_16x16x32_bf16 v[44:47], a[208:211], v[68:71], v[44:47]
    v_fmac_f32 v48, v112, v96
    v_fmac_f32 v34, v114, v102
    v_mfma_f32_16x16x32_bf16 v[36:39], a[208:211], v[64:67], v[36:39]
    ds_read_b128 v[84:87], v2 offset:39936
    v_fmac_f32 v35, v114, v103
    v_mfma_f32_16x16x32_bf16 v[48:51], a[212:215], v[64:67], v[48:51]
    v_fmac_f32 v41, v115, v101
    v_fmac_f32 v42, v115, v102
    v_mfma_f32_16x16x32_bf16 v[52:55], a[212:215], v[68:71], v[52:55]
    s_waitcnt lgkmcnt(2)
    v_fmac_f32 v43, v115, v103
    v_fmac_f32 v39, v112, v95
    v_mfma_f32_16x16x32_bf16 v[32:35], a[216:219], v[72:75], v[32:35]
    ds_read_b128 v[56:59], v2 offset:40960
    v_fmac_f32 v36, v114, v104
    v_mfma_f32_16x16x32_bf16 v[40:43], a[216:219], v[76:79], v[40:43]
    buffer_load_dwordx4 v1, s[16:19], s42 offen offset:1024 sc1 lds
    v_mfma_f32_16x16x32_bf16 v[44:47], a[220:223], v[76:79], v[44:47]
    v_fmac_f32 v49, v112, v97
    v_fmac_f32 v50, v112, v98
    v_mfma_f32_16x16x32_bf16 v[36:39], a[220:223], v[72:75], v[36:39]
    ds_read_b128 v[60:63], v2 offset:41984
    v_fmac_f32 v52, v113, v96
    v_mfma_f32_16x16x32_bf16 v[48:51], a[224:227], v[72:75], v[48:51]
    v_fmac_f32 v44, v113, v92
    v_fmac_f32 v45, v113, v93
    v_mfma_f32_16x16x32_bf16 v[52:55], a[224:227], v[76:79], v[52:55]
    s_waitcnt lgkmcnt(2)
    v_fmac_f32 v37, v114, v105
    v_fmac_f32 v38, v114, v106
    v_mfma_f32_16x16x32_bf16 v[32:35], a[228:231], v[80:83], v[32:35]
    ds_read_b128 v[64:67], v2 offset:43008
    v_fmac_f32 v39, v114, v107
    v_mfma_f32_16x16x32_bf16 v[40:43], a[228:231], v[84:87], v[40:43]
    buffer_load_dwordx4 v1, s[16:19], s42 offen offset:2048 sc1 lds
    v_mfma_f32_16x16x32_bf16 v[44:47], a[232:235], v[84:87], v[44:47]
    v_fmac_f32 v51, v112, v99
    v_fmac_f32 v48, v114, v108
    v_mfma_f32_16x16x32_bf16 v[36:39], a[232:235], v[80:83], v[36:39]
    ds_read_b128 v[68:71], v2 offset:44032
    v_fmac_f32 v53, v113, v97
    v_mfma_f32_16x16x32_bf16 v[48:51], a[236:239], v[80:83], v[48:51]
    s_waitcnt vmcnt(7)
    v_fmac_f32 v46, v113, v94
    v_fmac_f32 v47, v113, v95
    v_mfma_f32_16x16x32_bf16 v[52:55], a[236:239], v[84:87], v[52:55]
    s_waitcnt lgkmcnt(2)
    v_fmac_f32 v44, v115, v104
    v_fmac_f32 v45, v115, v105
    v_mfma_f32_16x16x32_bf16 v[32:35], a[240:243], v[56:59], v[32:35]
    s_barrier
    ds_read_b128 v[72:75], v2 offset:45056
    v_fmac_f32 v46, v115, v106
    v_mfma_f32_16x16x32_bf16 v[40:43], a[240:243], v[60:63], v[40:43]
    buffer_store_dword v124, v124, s[16:19], s91 offen sc1
    v_mfma_f32_16x16x32_bf16 v[44:47], a[244:247], v[60:63], v[44:47]
    buffer_load_dwordx4 v1, s[16:19], s42 offen offset:3072 sc1 lds
    v_mfma_f32_16x16x32_bf16 v[36:39], a[244:247], v[56:59], v[36:39]
    s_add_u32 s91, s91, 65536
    ds_read_b128 v[76:79], v2 offset:46080
    v_fmac_f32 v54, v113, v98
    v_mfma_f32_16x16x32_bf16 v[48:51], a[248:251], v[56:59], v[48:51]
    s_add_u32 m0, s43, 49152
    v_fmac_f32 v47, v115, v107
    s_add_u32 s42, s41, 49152
    v_mfma_f32_16x16x32_bf16 v[52:55], a[248:251], v[60:63], v[52:55]
    s_waitcnt lgkmcnt(2)
    v_mfma_f32_16x16x32_bf16 v[32:35], a[252:255], v[64:67], v[32:35]
    ds_read_b128 v[80:83], v2 offset:47104
    v_fmac_f32 v49, v114, v109
    v_mfma_f32_16x16x32_bf16 v[40:43], a[252:255], v[68:71], v[40:43]
    v_fmac_f32 v50, v114, v110
    v_fmac_f32 v51, v114, v111
    v_mfma_f32_16x16x32_bf16 v[44:47], v[128:131], v[68:71], v[44:47]
    buffer_load_dwordx4 v1, s[16:19], s42 offen offset:0 sc1 lds
    v_mfma_f32_16x16x32_bf16 v[36:39], v[128:131], v[64:67], v[36:39]
    ds_read_b128 v[84:87], v2 offset:48128
    v_fmac_f32 v55, v113, v99
    v_mfma_f32_16x16x32_bf16 v[48:51], v[132:135], v[64:67], v[48:51]
    v_mfma_f32_16x16x32_bf16 v[52:55], v[132:135], v[68:71], v[52:55]
    s_waitcnt lgkmcnt(2)
    v_mfma_f32_16x16x32_bf16 v[32:35], v[136:139], v[72:75], v[32:35]
    ds_read_b128 v[56:59], v2 offset:49152
    v_mfma_f32_16x16x32_bf16 v[40:43], v[136:139], v[76:79], v[40:43]
    v_mfma_f32_16x16x32_bf16 v[44:47], v[140:143], v[76:79], v[44:47]
    buffer_load_dwordx4 v1, s[16:19], s42 offen offset:1024 sc1 lds
    v_mfma_f32_16x16x32_bf16 v[36:39], v[140:143], v[72:75], v[36:39]
    ds_read_b128 v[60:63], v2 offset:50176
    v_fmac_f32 v52, v115, v108
    v_mfma_f32_16x16x32_bf16 v[48:51], v[144:147], v[72:75], v[48:51]
    v_mfma_f32_16x16x32_bf16 v[52:55], v[144:147], v[76:79], v[52:55]
    s_waitcnt lgkmcnt(2)
    v_mfma_f32_16x16x32_bf16 v[32:35], v[148:151], v[80:83], v[32:35]
    ds_read_b128 v[64:67], v2 offset:51200
    v_mfma_f32_16x16x32_bf16 v[40:43], v[148:151], v[84:87], v[40:43]
    v_mfma_f32_16x16x32_bf16 v[44:47], v[152:155], v[84:87], v[44:47]
    buffer_load_dwordx4 v1, s[16:19], s42 offen offset:2048 sc1 lds
    v_mfma_f32_16x16x32_bf16 v[36:39], v[152:155], v[80:83], v[36:39]
    ds_read_b128 v[68:71], v2 offset:52224
    v_fmac_f32 v53, v115, v109
    v_mfma_f32_16x16x32_bf16 v[48:51], v[156:159], v[80:83], v[48:51]
    v_mfma_f32_16x16x32_bf16 v[52:55], v[156:159], v[84:87], v[52:55]
    s_waitcnt lgkmcnt(2)
    v_mfma_f32_16x16x32_bf16 v[32:35], v[160:163], v[56:59], v[32:35]
    ds_read_b128 v[72:75], v2 offset:53248
    v_mfma_f32_16x16x32_bf16 v[40:43], v[160:163], v[60:63], v[40:43]
    v_mfma_f32_16x16x32_bf16 v[44:47], v[164:167], v[60:63], v[44:47]
    buffer_load_dwordx4 v1, s[16:19], s42 offen offset:3072 sc1 lds
    v_mfma_f32_16x16x32_bf16 v[36:39], v[164:167], v[56:59], v[36:39]
    s_add_u32 m0, s52, 73728
    ds_read_b128 v[76:79], v2 offset:54272
    v_fmac_f32 v54, v115, v110
    v_mfma_f32_16x16x32_bf16 v[48:51], v[168:171], v[56:59], v[48:51]
    s_add_u32 s42, s46, s52
    v_mfma_f32_16x16x32_bf16 v[52:55], v[168:171], v[60:63], v[52:55]
    s_waitcnt lgkmcnt(2)
    v_mfma_f32_16x16x32_bf16 v[32:35], v[172:175], v[64:67], v[32:35]
    ds_read_b128 v[80:83], v2 offset:55296
    v_mfma_f32_16x16x32_bf16 v[40:43], v[172:175], v[68:71], v[40:43]
    buffer_load_dwordx4 v1, s[16:19], s42 offen sc1 lds
    v_mfma_f32_16x16x32_bf16 v[44:47], v[176:179], v[68:71], v[44:47]
    v_fmac_f32 v55, v115, v111
    v_mfma_f32_16x16x32_bf16 v[36:39], v[176:179], v[64:67], v[36:39]
    ds_read_b128 v[84:87], v2 offset:56320
    v_mfma_f32_16x16x32_bf16 v[48:51], v[180:183], v[64:67], v[48:51]
    v_mfma_f32_16x16x32_bf16 v[52:55], v[180:183], v[68:71], v[52:55]
    s_waitcnt lgkmcnt(2)
    v_mfma_f32_16x16x32_bf16 v[32:35], v[184:187], v[72:75], v[32:35]
    ds_read_b128 v[56:59], v2 offset:57344
    v_mfma_f32_16x16x32_bf16 v[40:43], v[184:187], v[76:79], v[40:43]
    v_mfma_f32_16x16x32_bf16 v[44:47], v[188:191], v[76:79], v[44:47]
    v_mfma_f32_16x16x32_bf16 v[36:39], v[188:191], v[72:75], v[36:39]
    ds_read_b128 v[60:63], v2 offset:58368
    v_mfma_f32_16x16x32_bf16 v[48:51], v[192:195], v[72:75], v[48:51]
    v_mfma_f32_16x16x32_bf16 v[52:55], v[192:195], v[76:79], v[52:55]
    s_waitcnt lgkmcnt(2)
    v_mfma_f32_16x16x32_bf16 v[32:35], v[196:199], v[80:83], v[32:35]
    ds_read_b128 v[64:67], v2 offset:59392
    v_mfma_f32_16x16x32_bf16 v[40:43], v[196:199], v[84:87], v[40:43]
    v_mfma_f32_16x16x32_bf16 v[44:47], v[200:203], v[84:87], v[44:47]
    v_mfma_f32_16x16x32_bf16 v[36:39], v[200:203], v[80:83], v[36:39]
    ds_read_b128 v[68:71], v2 offset:60416
    v_mfma_f32_16x16x32_bf16 v[48:51], v[204:207], v[80:83], v[48:51]
    v_mfma_f32_16x16x32_bf16 v[52:55], v[204:207], v[84:87], v[52:55]
    s_waitcnt lgkmcnt(2)
    v_mfma_f32_16x16x32_bf16 v[32:35], v[208:211], v[56:59], v[32:35]
    ds_read_b128 v[72:75], v2 offset:61440
    v_mfma_f32_16x16x32_bf16 v[40:43], v[208:211], v[60:63], v[40:43]
    v_mfma_f32_16x16x32_bf16 v[44:47], v[212:215], v[60:63], v[44:47]
    buffer_load_dword v7, v5, s[16:19], s45 offen sc1
    v_mfma_f32_16x16x32_bf16 v[36:39], v[212:215], v[56:59], v[36:39]
    ds_read_b128 v[76:79], v2 offset:62464
    v_mfma_f32_16x16x32_bf16 v[48:51], v[216:219], v[56:59], v[48:51]
    v_mfma_f32_16x16x32_bf16 v[52:55], v[216:219], v[60:63], v[52:55]
    s_waitcnt lgkmcnt(2)
    v_mfma_f32_16x16x32_bf16 v[32:35], v[220:223], v[64:67], v[32:35]
    ds_read_b128 v[80:83], v2 offset:63488
    v_mfma_f32_16x16x32_bf16 v[40:43], v[220:223], v[68:71], v[40:43]
    v_mfma_f32_16x16x32_bf16 v[44:47], v[224:227], v[68:71], v[44:47]
    v_mfma_f32_16x16x32_bf16 v[36:39], v[224:227], v[64:67], v[36:39]
    ds_read_b128 v[84:87], v2 offset:64512
    v_mfma_f32_16x16x32_bf16 v[48:51], v[228:231], v[64:67], v[48:51]
    v_mfma_f32_16x16x32_bf16 v[52:55], v[228:231], v[68:71], v[52:55]
    s_waitcnt lgkmcnt(2)
    v_mfma_f32_16x16x32_bf16 v[32:35], v[232:235], v[72:75], v[32:35]
    ds_read_b128 v[56:59], v1 offset:0
    v_mfma_f32_16x16x32_bf16 v[40:43], v[232:235], v[76:79], v[40:43]
    v_mfma_f32_16x16x32_bf16 v[44:47], v[236:239], v[76:79], v[44:47]
    v_mfma_f32_16x16x32_bf16 v[36:39], v[236:239], v[72:75], v[36:39]
    ds_read_b128 v[60:63], v1 offset:1024
    v_mfma_f32_16x16x32_bf16 v[48:51], v[240:243], v[72:75], v[48:51]
    v_mfma_f32_16x16x32_bf16 v[52:55], v[240:243], v[76:79], v[52:55]
    s_waitcnt lgkmcnt(2)
    v_mfma_f32_16x16x32_bf16 v[32:35], v[244:247], v[80:83], v[32:35]
    ds_read_b128 v[64:67], v1 offset:2048
    v_mfma_f32_16x16x32_bf16 v[40:43], v[244:247], v[84:87], v[40:43]
    v_mfma_f32_16x16x32_bf16 v[44:47], v[248:251], v[84:87], v[44:47]
    v_mfma_f32_16x16x32_bf16 v[36:39], v[248:251], v[80:83], v[36:39]
    ds_read_b128 v[68:71], v1 offset:3072
    v_mfma_f32_16x16x32_bf16 v[48:51], v[252:255], v[80:83], v[48:51]
    s_add_u32 s36, s36, 1
    v_mfma_f32_16x16x32_bf16 v[52:55], v[252:255], v[84:87], v[52:55]
    s_waitcnt lgkmcnt(2)
    s_cmp_lt_u32 s36, 32
    s_cbranch_scc1 L_a_b0
    s_nop 7
    s_and_b32 s44, s90, 0xffffffff
    s_cmp_lt_i32 s36, 1
    s_cselect_b32 s44, 0x5e00000, s44
    s_add_u32 s49, s44, s87
    s_max_u32 s44, s44, s88
    s_add_u32 s90, s90, 262144
    v_mul_f32 v120, v48, v116
    v_mul_f32 v121, v49, v116
    v_mul_f32 v120, v120, abs(v48)
    v_mul_f32 v121, v121, abs(v49)
    v_cvt_pk_bf16_f32 v48, v120, v121
    v_pk_max_i16 v48, v48, 0
    v_mul_f32 v120, v50, v116
    v_mul_f32 v121, v51, v116
    v_mul_f32 v120, v120, abs(v50)
    v_mul_f32 v121, v121, abs(v51)
    v_cvt_pk_bf16_f32 v49, v120, v121
    v_pk_max_i16 v49, v49, 0
    ds_write_b64 v3, v[48:49] offset:4096
    v_mul_f32 v120, v52, v117
    v_mul_f32 v121, v53, v117
    v_mul_f32 v120, v120, abs(v52)
    v_mul_f32 v121, v121, abs(v53)
    v_cvt_pk_bf16_f32 v52, v120, v121
    v_pk_max_i16 v52, v52, 0
    v_mul_f32 v120, v54, v117
    v_mul_f32 v121, v55, v117
    v_mul_f32 v120, v120, abs(v54)
    v_mul_f32 v121, v121, abs(v55)
    v_cvt_pk_bf16_f32 v53, v120, v121
    v_pk_max_i16 v53, v53, 0
    ds_write_b64 v3, v[52:53] offset:5120
    v_mul_f32 v120, v32, v116
    v_mul_f32 v121, v33, v116
    v_mul_f32 v120, v120, abs(v32)
    v_mul_f32 v121, v121, abs(v33)
    v_cvt_pk_bf16_f32 v32, v120, v121
    v_pk_max_i16 v32, v32, 0
    v_mul_f32 v120, v34, v116
    v_mul_f32 v121, v35, v116
    v_mul_f32 v120, v120, abs(v34)
    v_mul_f32 v121, v121, abs(v35)
    v_cvt_pk_bf16_f32 v33, v120, v121
    v_pk_max_i16 v33, v33, 0
    v_mul_f32 v120, v36, v116
    v_mul_f32 v121, v37, v116
    v_mul_f32 v120, v120, abs(v36)
    v_mul_f32 v121, v121, abs(v37)
    v_cvt_pk_bf16_f32 v34, v120, v121
    v_pk_max_i16 v34, v34, 0
    v_mul_f32 v120, v38, v116
    v_mul_f32 v121, v39, v116
    v_mul_f32 v120, v120, abs(v38)
    v_mul_f32 v121, v121, abs(v39)
    v_cvt_pk_bf16_f32 v35, v120, v121
    v_pk_max_i16 v35, v35, 0
    buffer_store_dwordx4 v[32:35], v1, s[16:19], s44 offen offset:0 sc1
    v_mul_f32 v120, v40, v117
    v_mul_f32 v121, v41, v117
    v_mul_f32 v120, v120, abs(v40)
    s_waitcnt lgkmcnt(0)
    s_barrier
    ds_read_b128 v[48:51], v4 offset:4096
    v_mul_f32 v121, v121, abs(v41)
    v_cvt_pk_bf16_f32 v40, v120, v121
    v_pk_max_i16 v40, v40, 0
    v_mul_f32 v120, v42, v117
    v_mul_f32 v121, v43, v117
    v_mul_f32 v120, v120, abs(v42)
    v_mul_f32 v121, v121, abs(v43)
    v_cvt_pk_bf16_f32 v41, v120, v121
    v_pk_max_i16 v41, v41, 0
    s_waitcnt lgkmcnt(0)
    buffer_store_dwordx4 v[48:51], v1, s[16:19], s49 offen sc1
    v_mul_f32 v120, v44, v117
    v_mul_f32 v121, v45, v117
    v_mul_f32 v120, v120, abs(v44)
    v_mul_f32 v121, v121, abs(v45)
    v_cvt_pk_bf16_f32 v42, v120, v121
    v_pk_max_i16 v42, v42, 0
    v_mul_f32 v120, v46, v117
    v_mul_f32 v121, v47, v117
    v_mul_f32 v120, v120, abs(v46)
    v_mul_f32 v121, v121, abs(v47)
    v_cvt_pk_bf16_f32 v43, v120, v121
    v_pk_max_i16 v43, v43, 0
    buffer_store_dwordx4 v[40:43], v1, s[16:19], s44 offen offset:1024 sc1
    s_waitcnt vmcnt(0)
    s_barrier
    buffer_store_dword v124, v124, s[16:19], s91 offen sc1
    s_add_u32 s91, s91, 65536
    s_waitcnt vmcnt(0)
    s_endpgm
L_vspin11:
    s_mov_b32 s40, 0x20000
L_vspin11_l:
    s_cmp_lg_u32 s37, 0
    s_cbranch_scc1 L_restart
    s_sleep 4
    buffer_load_dword v56, v124, s[20:23], 0 offen offset:32 sc1
    s_waitcnt vmcnt(0)
    v_readfirstlane_b32 s37, v56
    s_sub_u32 s40, s40, 1
    s_cbranch_scc1 L_vback12
    s_cmp_lg_u32 s37, s3
    s_cbranch_scc1 L_vspin11_l
    s_branch L_vback12
L_spin14:
    s_mov_b32 s40, 0x20000
L_spin14_l:
    buffer_load_dword v56, v124, s[20:23], 0 offen sc1
    s_sub_u32 s40, s40, 1
    s_waitcnt vmcnt(0)
    v_cmp_eq_u32 vcc, v124, v56
    s_cbranch_scc1 L_back15
    s_cbranch_vccz L_back15
    s_sleep 8
    s_branch L_spin14_l
L_spin16:
    s_mov_b32 s40, 0x20000
L_spin16_l:
    buffer_load_dword v7, v5, s[16:19], s45 offen sc1
    s_sub_u32 s40, s40, 1
    s_waitcnt vmcnt(0)
    v_cmp_ne_u32 vcc, 0, v7
    s_cbranch_scc1 L_back17
    s_cbranch_vccz L_back17
    s_sleep 2
    s_branch L_spin16_l
L_spin18:
    s_mov_b32 s40, 0x20000
L_spin18_l:
    buffer_load_dword v7, v5, s[16:19], s45 offen sc1
    s_sub_u32 s40, s40, 1
    s_waitcnt vmcnt(0)
    v_cmp_ne_u32 vcc, 0, v7
    s_cbranch_scc1 L_back19
    s_cbranch_vccz L_back19
    s_sleep 2
    s_branch L_spin18_l
L_sspin20:
    s_mov_b32 s40, 0x20000
L_sspin20_l:
    buffer_load_dwordx2 v[36:37], v6, s[16:19], s46 offen offset:0 sc1
    buffer_load_dwordx2 v[38:39], v6, s[16:19], s46 offen offset:128 sc1
    buffer_load_dwordx2 v[40:41], v6, s[16:19], s46 offen offset:256 sc1
    buffer_load_dwordx2 v[42:43], v6, s[16:19], s46 offen offset:384 sc1
    s_sub_u32 s40, s40, 1
    s_waitcnt vmcnt(0)
    v_max3_u32 v44, v36, v37, v38
    v_max3_u32 v45, v39, v40, v41
    v_max3_u32 v44, v44, v42, v43
    v_max_u32 v44, v44, v45
    v_cmp_eq_u32 vcc, -1, v44
    s_cbranch_scc1 L_sback21
    s_cbranch_vccz L_sback21
    s_sleep 4
    s_branch L_sspin20_l
L_spin22:
    s_mov_b32 s40, 0x20000
L_spin22_l:
    buffer_load_dword v7, v5, s[16:19], s45 offen sc1
    s_sub_u32 s40, s40, 1
    s_waitcnt vmcnt(0)
    v_cmp_ne_u32 vcc, 0, v7
    s_cbranch_scc1 L_back23
    s_cbranch_vccz L_back23
    s_sleep 2
    s_branch L_spin22_l
L_sspin24:
    s_mov_b32 s40, 0x20000
L_sspin24_l:
    buffer_load_dwordx2 v[12:13], v6, s[16:19], s46 offen offset:0 sc1
    buffer_load_dwordx2 v[14:15], v6, s[16:19], s46 offen offset:128 sc1
    buffer_load_dwordx2 v[16:17], v6, s[16:19], s46 offen offset:256 sc1
    buffer_load_dwordx2 v[18:19], v6, s[16:19], s46 offen offset:384 sc1
    s_sub_u32 s40, s40, 1
    s_waitcnt vmcnt(0)
    v_max3_u32 v20, v12, v13, v14
    v_max3_u32 v21, v15, v16, v17
    v_max3_u32 v20, v20, v18, v19
    v_max_u32 v20, v20, v21
    v_cmp_eq_u32 vcc, -1, v20
    s_cbranch_scc1 L_sback25
    s_cbranch_vccz L_sback25
    s_sleep 4
    s_branch L_sspin24_l
L_odd:
    s_mov_b32 s33, s47
    s_lshl2_add_u32 s53, s48, s47
    s_cmp_lt_u32 s48, 8
    s_cselect_b32 s34, 16, 32
    s_add_u32 s34, s34, s48
    s_sub_u32 s37, s48, 8
    s_cmp_lt_u32 s37, 20
    s_cselect_b32 s44, -16, 0
    s_cmp_lt_u32 s37, 4
    s_cselect_b32 s44, 64, s44
    s_add_u32 s44, s44, s53
    s_lshl2_add_u32 s44, s44, s32
    s_lshl_b32 s44, s44, 13
    v_lshlrev_b32 v6, 7, v0
    s_waitcnt lgkmcnt(0)
    s_mov_b32 s12, s66
    s_mov_b32 s13, s67
    s_mov_b32 s14, 0x400000
    s_mov_b32 s15, 0x00020000
    s_mov_b32 s16, s84
    s_mov_b32 s17, s85
    s_mov_b32 s18, 0x5e00000
    s_mov_b32 s19, 0x00020000
    v_min_u32 v124, 1, v0
    v_lshlrev_b32 v124, 30, v124
    s_cmp_lt_u32 s48, 8
    s_cbranch_scc1 L_touch
    s_sub_u32 s37, s48, 12
    s_cmp_lt_u32 s37, 16
    s_cbranch_scc1 L_lines
    s_lshl_b32 s50, s33, 5
    s_or_b32 s37, s48, 16
    s_add_u32 s50, s50, s37
    s_lshl_b32 s46, s50, 15
    s_lshl_b32 s37, s32, 9
    s_add_u32 s46, s46, s37
    v_lshrrev_b32 v48, 3, v0
    v_and_b32 v49, 0x70, v1
    v_lshl_add_u32 v48, v48, 11, v49
    v_add_u32 v49, 16384, v48
    s_mov_b32 s8, s64
    s_mov_b32 s9, s65
    s_mov_b32 s10, 0x400000
    s_mov_b32 s11, 0x00020000
    buffer_load_dwordx4 v[16:19], v48, s[8:11], s46 offen offset:0
    buffer_load_dwordx4 v[20:23], v48, s[8:11], s46 offen offset:128
    buffer_load_dwordx4 v[24:27], v48, s[8:11], s46 offen offset:256
    buffer_load_dwordx4 v[28:31], v48, s[8:11], s46 offen offset:384
    buffer_load_dwordx4 v[32:35], v49, s[8:11], s46 offen offset:0
    buffer_load_dwordx4 v[36:39], v49, s[8:11], s46 offen offset:128
    buffer_load_dwordx4 v[40:43], v49, s[8:11], s46 offen offset:256
    buffer_load_dwordx4 v[44:47], v49, s[8:11], s46 offen offset:384
    s_mov_b32 s86, 0x3f803f80
    v_and_b32 v56, 1, v0
    v_lshlrev_b32 v56, 7, v56
    v_bfe_u32 v57, v0, 1, 1
    v_lshl_add_u32 v56, v57, 6, v56
    v_and_b32 v57, 0x38, v0
    v_add_u32 v56, v57, v56
    s_sub_u32 s46, 127, s50
    s_lshl_b32 s46, s46, 10
    s_lshl_b32 s37, s32, 8
    s_add_u32 s46, s46, s37
    s_add_u32 s46, s46, 0x5400000
    s_waitcnt vmcnt(0)
    v_dot2_f32_bf16 v48, v16, s86, 0
    v_dot2_f32_bf16 v49, v16, v16, 0
    v_dot2_f32_bf16 v50, v24, s86, 0
    v_dot2_f32_bf16 v51, v24, v24, 0
    v_dot2_f32_bf16 v52, v32, s86, 0
    v_dot2_f32_bf16 v53, v32, v32, 0
    v_dot2_f32_bf16 v54, v40, s86, 0
    v_dot2_f32_bf16 v55, v40, v40, 0
    v_dot2_f32_bf16 v48, v17, s86, v48
    v_dot2_f32_bf16 v49, v17, v17, v49
    v_dot2_f32_bf16 v50, v25, s86, v50
    v_dot2_f32_bf16 v51, v25, v25, v51
    v_dot2_f32_bf16 v52, v33, s86, v52
    v_dot2_f32_bf16 v53, v33, v33, v53
    v_dot2_f32_bf16 v54, v41, s86, v54
    v_dot2_f32_bf16 v55, v41, v41, v55
    v_dot2_f32_bf16 v48, v18, s86, v48
    v_dot2_f32_bf16 v49, v18, v18, v49
    v_dot2_f32_bf16 v50, v26, s86, v50
    v_dot2_f32_bf16 v51, v26, v26, v51
    v_dot2_f32_bf16 v52, v34, s86, v52
    v_dot2_f32_bf16 v53, v34, v34, v53
    v_dot2_f32_bf16 v54, v42, s86, v54
    v_dot2_f32_bf16 v55, v42, v42, v55
    v_dot2_f32_bf16 v48, v19, s86, v48
    v_dot2_f32_bf16 v49, v19, v19, v49
    v_dot2_f32_bf16 v50, v27, s86, v50
    v_dot2_f32_bf16 v51, v27, v27, v51
    v_dot2_f32_bf16 v52, v35, s86, v52
    v_dot2_f32_bf16 v53, v35, v35, v53
    v_dot2_f32_bf16 v54, v43, s86, v54
    v_dot2_f32_bf16 v55, v43, v43, v55
    v_dot2_f32_bf16 v48, v20, s86, v48
    v_dot2_f32_bf16 v49, v20, v20, v49
    v_dot2_f32_bf16 v50, v28, s86, v50
    v_dot2_f32_bf16 v51, v28, v28, v51
    v_dot2_f32_bf16 v52, v36, s86, v52
    v_dot2_f32_bf16 v53, v36, v36, v53
    v_dot2_f32_bf16 v54, v44, s86, v54
    v_dot2_f32_bf16 v55, v44, v44, v55
    v_dot2_f32_bf16 v48, v21, s86, v48
    v_dot2_f32_bf16 v49, v21, v21, v49
    v_dot2_f32_bf16 v50, v29, s86, v50
    v_dot2_f32_bf16 v51, v29, v29, v51
    v_dot2_f32_bf16 v52, v37, s86, v52
    v_dot2_f32_bf16 v53, v37, v37, v53
    v_dot2_f32_bf16 v54, v45, s86, v54
    v_dot2_f32_bf16 v55, v45, v45, v55
    v_dot2_f32_bf16 v48, v22, s86, v48
    v_dot2_f32_bf16 v49, v22, v22, v49
    v_dot2_f32_bf16 v50, v30, s86, v50
    v_dot2_f32_bf16 v51, v30, v30, v51
    v_dot2_f32_bf16 v52, v38, s86, v52
    v_dot2_f32_bf16 v53, v38, v38, v53
    v_dot2_f32_bf16 v54, v46, s86, v54
    v_dot2_f32_bf16 v55, v46, v46, v55
    v_dot2_f32_bf16 v48, v23, s86, v48
    v_dot2_f32_bf16 v49, v23, v23, v49
    v_dot2_f32_bf16 v50, v31, s86, v50
    v_dot2_f32_bf16 v51, v31, v31, v51
    v_dot2_f32_bf16 v52, v39, s86, v52
    v_dot2_f32_bf16 v53, v39, v39, v53
    v_dot2_f32_bf16 v54, v47, s86, v54
    v_dot2_f32_bf16 v55, v47, v47, v55
    v_add_f32_dpp v48, v48, v48 quad_perm:[1,0,3,2] row_mask:0xf bank_mask:0xf
    v_add_f32_dpp v49, v49, v49 quad_perm:[1,0,3,2] row_mask:0xf bank_mask:0xf
    v_add_f32_dpp v50, v50, v50 quad_perm:[1,0,3,2] row_mask:0xf bank_mask:0xf
    v_add_f32_dpp v51, v51, v51 quad_perm:[1,0,3,2] row_mask:0xf bank_mask:0xf
    v_add_f32_dpp v52, v52, v52 quad_perm:[1,0,3,2] row_mask:0xf bank_mask:0xf
    v_add_f32_dpp v53, v53, v53 quad_perm:[1,0,3,2] row_mask:0xf bank_mask:0xf
    v_add_f32_dpp v54, v54, v54 quad_perm:[1,0,3,2] row_mask:0xf bank_mask:0xf
    v_add_f32_dpp v55, v55, v55 quad_perm:[1,0,3,2] row_mask:0xf bank_mask:0xf
    v_add_f32_dpp v48, v48, v48 quad_perm:[2,3,0,1] row_mask:0xf bank_mask:0xf
    v_add_f32_dpp v49, v49, v49 quad_perm:[2,3,0,1] row_mask:0xf bank_mask:0xf
    v_add_f32_dpp v50, v50, v50 quad_perm:[2,3,0,1] row_mask:0xf bank_mask:0xf
    v_add_f32_dpp v51, v51, v51 quad_perm:[2,3,0,1] row_mask:0xf bank_mask:0xf
    v_add_f32_dpp v52, v52, v52 quad_perm:[2,3,0,1] row_mask:0xf bank_mask:0xf
    v_add_f32_dpp v53, v53, v53 quad_perm:[2,3,0,1] row_mask:0xf bank_mask:0xf
    v_add_f32_dpp v54, v54, v54 quad_perm:[2,3,0,1] row_mask:0xf bank_mask:0xf
    v_add_f32_dpp v55, v55, v55 quad_perm:[2,3,0,1] row_mask:0xf bank_mask:0xf
    v_add_f32_dpp v48, v48, v48 row_half_mirror row_mask:0xf bank_mask:0xf
    v_add_f32_dpp v49, v49, v49 row_half_mirror row_mask:0xf bank_mask:0xf
    v_add_f32_dpp v50, v50, v50 row_half_mirror row_mask:0xf bank_mask:0xf
    v_add_f32_dpp v51, v51, v51 row_half_mirror row_mask:0xf bank_mask:0xf
    v_add_f32_dpp v52, v52, v52 row_half_mirror row_mask:0xf bank_mask:0xf
    v_add_f32_dpp v53, v53, v53 row_half_mirror row_mask:0xf bank_mask:0xf
    v_add_f32_dpp v54, v54, v54 row_half_mirror row_mask:0xf bank_mask:0xf
    v_add_f32_dpp v55, v55, v55 row_half_mirror row_mask:0xf bank_mask:0xf
    s_mov_b32 exec_lo, 0x2020202
    s_mov_b32 exec_hi, 0x2020202
    v_mov_b32 v48, v50
    v_mov_b32 v49, v51
    s_mov_b32 exec_lo, 0x4040404
    s_mov_b32 exec_hi, 0x4040404
    v_mov_b32 v48, v52
    v_mov_b32 v49, v53
    s_mov_b32 exec_lo, 0x8080808
    s_mov_b32 exec_hi, 0x8080808
    v_mov_b32 v48, v54
    v_mov_b32 v49, v55
    s_mov_b32 exec_lo, 0x0f0f0f0f
    s_mov_b32 exec_hi, 0x0f0f0f0f
    buffer_store_dwordx2 v[48:49], v56, s[16:19], s46 offen sc1
    s_mov_b64 exec, -1
    s_add_u32 s20, s82, 128
    s_addc_u32 s21, s83, 0
    s_mov_b32 s22, 128
    s_mov_b32 s23, 0x00020000
    buffer_load_dword v8, v124, s[20:23], 0 offen offset:32 sc1
    s_waitcnt vmcnt(0)
    v_readfirstlane_b32 s37, v8
    s_nop 0
    s_cmp_lg_u32 s37, s3
    s_cbranch_scc1 L_vspin26
L_vback27:
    s_mov_b32 s38, 64
    s_mov_b32 s39, 31
    s_waitcnt vmcnt(0)
    s_branch L_job_end
L_lines:
    s_add_u32 s20, s82, 128
    s_addc_u32 s21, s83, 0
    s_mov_b32 s22, 128
    s_mov_b32 s23, 0x00020000
    buffer_load_dword v8, v124, s[20:23], 0 offen offset:32 sc1
    s_waitcnt vmcnt(0)
    v_readfirstlane_b32 s37, v8
    s_nop 0
    s_cmp_lg_u32 s37, s3
    s_cbranch_scc1 L_vspin28
L_vback29:
    buffer_load_dword v248, v6, s[12:15], s44 offen
    s_mov_b32 s12, s68
    s_mov_b32 s13, s69
    s_mov_b32 s14, 0x200000
    s_mov_b32 s15, 0x00020000
    s_sub_u32 s39, 0x180, s12
    s_and_b32 s39, s39, 0x380
    s_sub_u32 s37, s48, 12
    s_lshl2_add_u32 s37, s37, s32
    s_lshl_b32 s37, s37, 15
    s_add_u32 s39, s39, s37
    v_and_b32 v7, 31, v0
    v_lshlrev_b32 v7, 10, v7
    buffer_load_dword v247, v7, s[12:15], s39 offen
    s_mov_b32 s14, 0
    s_sub_u32 s53, s53, 48
    s_and_b32 s37, s53, 7
    s_cmp_lt_u32 s37, 2
    s_cselect_b32 s87, 2, 3
    s_cselect_b32 s36, 34, 32
    s_cmp_ge_u32 s53, 32
    s_cselect_b32 s87, 2, s87
    s_cselect_b32 s36, 35, s36
    s_cselect_b32 s38, 5, 0
    s_cmp_lt_u32 s37, s38
    s_cselect_b32 s37, 0x5e00000, 0
    s_lshl_b32 s38, s53, 10
    s_add_u32 s37, s37, s38
    s_lshl_b32 s38, s32, 16
    s_add_u32 s37, s37, s38
    s_add_u32 s37, s37, 0x5500000
    s_sub_u32 s87, s32, s87
    s_cmp_lt_u32 s87, s36
    s_cselect_b32 s38, -1, 0
    v_mov_b32 v16, s38
    s_add_u32 s87, s87, 4
    buffer_store_dwordx4 v[16:19], v1, s[16:19], s37 offen sc1
    s_add_u32 s37, s37, 262144
    s_cmp_lt_u32 s87, s36
    s_cselect_b32 s38, -1, 0
    v_mov_b32 v20, s38
    s_add_u32 s87, s87, 4
    buffer_store_dwordx4 v[20:23], v1, s[16:19], s37 offen sc1
    s_add_u32 s37, s37, 262144
    s_cmp_lt_u32 s87, s36
    s_cselect_b32 s38, -1, 0
    v_mov_b32 v24, s38
    s_add_u32 s87, s87, 4
    buffer_store_dwordx4 v[24:27], v1, s[16:19], s37 offen sc1
    s_add_u32 s37, s37, 262144
    s_cmp_lt_u32 s87, s36
    s_cselect_b32 s38, -1, 0
    v_mov_b32 v28, s38
    s_add_u32 s87, s87, 4
    buffer_store_dwordx4 v[28:31], v1, s[16:19], s37 offen sc1
    s_add_u32 s37, s37, 262144
    s_cmp_lt_u32 s87, s36
    s_cselect_b32 s38, -1, 0
    v_mov_b32 v32, s38
    s_add_u32 s87, s87, 4
    buffer_store_dwordx4 v[32:35], v1, s[16:19], s37 offen sc1
    s_add_u32 s37, s37, 262144
    s_cmp_lt_u32 s87, s36
    s_cselect_b32 s38, -1, 0
    v_mov_b32 v36, s38
    s_add_u32 s87, s87, 4
    buffer_store_dwordx4 v[36:39], v1, s[16:19], s37 offen sc1
    s_add_u32 s37, s37, 262144
    s_cmp_lt_u32 s87, s36
    s_cselect_b32 s38, -1, 0
    v_mov_b32 v40, s38
    s_add_u32 s87, s87, 4
    buffer_store_dwordx4 v[40:43], v1, s[16:19], s37 offen sc1
    s_add_u32 s37, s37, 262144
    s_cmp_lt_u32 s87, s36
    s_cselect_b32 s38, -1, 0
    v_mov_b32 v44, s38
    s_add_u32 s87, s87, 4
    buffer_store_dwordx4 v[44:47], v1, s[16:19], s37 offen sc1
    s_add_u32 s37, s37, 262144
    s_cmp_lt_u32 s87, s36
    s_cselect_b32 s38, -1, 0
    v_mov_b32 v48, s38
    s_add_u32 s87, s87, 4
    buffer_store_dwordx4 v[48:51], v1, s[16:19], s37 offen sc1
    s_add_u32 s37, s37, 262144
    s_cmp_lt_u32 s87, s36
    s_cselect_b32 s38, -1, 0
    v_mov_b32 v52, s38
    s_add_u32 s87, s87, 4
    buffer_store_dwordx4 v[52:55], v1, s[16:19], s37 offen sc1
    s_add_u32 s37, s37, 262144
    v_mov_b32 v8, -1
    v_mov_b32 v9, -1
    v_mov_b32 v10, -1
    v_mov_b32 v11, -1
    s_lshl2_add_u32 s38, s53, s32
    s_lshl_b32 s38, s38, 10
    s_add_u32 s38, s38, 0x5440000
    buffer_store_dwordx4 v[8:11], v1, s[16:19], s38 offen sc1
    s_mov_b32 s38, 0
    s_mov_b32 s39, 63
    s_waitcnt vmcnt(0)
L_job_end:
    s_mov_b32 s8, s82
    s_mov_b32 s9, s83
    s_mov_b32 s10, 0x100
    s_mov_b32 s11, 0x00020000
    v_mov_b32 v123, 1
    s_barrier
    s_cmp_lg_u32 s32, 3
    s_cbranch_scc1 L_arr30
    buffer_atomic_add v123, v124, s[8:11], s38 offen sc0
    s_waitcnt vmcnt(0)
    v_readfirstlane_b32 s37, v123
    s_nop 0
    s_cmp_lg_u32 s37, s39
    s_cbranch_scc1 L_arr30
    buffer_store_dword v123, v124, s[8:11], s38 offen offset:128 sc1
L_arr30:
L_touch:
    buffer_load_dword v248, v6, s[12:15], s44 offen
    s_lshl_b32 s91, s33, 6
    s_add_u32 s91, s91, s34
    s_lshl_b32 s91, s91, 7
    s_add_u32 s91, s91, 0x5520000
    s_cmp_eq_u32 s32, 1
    s_cselect_b32 s91, s91, 0x5f00000
    s_cmp_ge_u32 s34, 60
    s_cbranch_scc1 L_role_60
    s_cmp_ge_u32 s34, 44
    s_cbranch_scc1 L_role_44
    s_cmp_ge_u32 s34, 40
    s_cbranch_scc1 L_role_40
L_role_16:
    s_sub_u32 s35, s34, 16
    s_lshl_b32 s54, s35, 8
    s_mov_b32 s12, s68
    s_mov_b32 s13, s69
    s_mov_b32 s14, 0x200000
    s_mov_b32 s15, 0x00020000
    s_mov_b32 s39, 2048
    v_lshrrev_b32 v52, 3, v0
    v_lshlrev_b32 v53, 2, v0
    v_and_b32 v53, 64, v53
    v_and_b32 v54, 0x70, v1
    v_xor_b32 v53, v53, v54
    v_mad_u32_u24 v44, v52, s39, v53
    v_add_u32 v45, 16384, v44
    v_add_u32 v46, 128, v44
    v_add_u32 v47, 16512, v44
    s_mul_i32 s38, s32, 32768
    s_add_u32 s54, s54, s38
    s_lshl_b32 s42, s32, 11
    s_add_u32 m0, s42, 0
    s_nop 0
    buffer_load_dwordx4 v44, s[12:15], s54 offen lds
    s_add_u32 m0, s42, 1024
    s_nop 0
    buffer_load_dwordx4 v45, s[12:15], s54 offen lds
    s_add_u32 m0, s42, 8192
    s_nop 0
    buffer_load_dwordx4 v46, s[12:15], s54 offen lds
    s_add_u32 m0, s42, 9216
    s_nop 0
    buffer_load_dwordx4 v47, s[12:15], s54 offen lds
    s_add_u32 s54, s54, 131072
    s_add_u32 m0, s42, 16384
    s_nop 0
    buffer_load_dwordx4 v44, s[12:15], s54 offen lds
    s_add_u32 m0, s42, 17408
    s_nop 0
    buffer_load_dwordx4 v45, s[12:15], s54 offen lds
    s_add_u32 m0, s42, 24576
    s_nop 0
    buffer_load_dwordx4 v46, s[12:15], s54 offen lds
    s_add_u32 m0, s42, 25600
    s_nop 0
    buffer_load_dwordx4 v47, s[12:15], s54 offen lds
    s_add_u32 s54, s54, 131072
    s_add_u32 m0, s42, 32768
    s_nop 0
    buffer_load_dwordx4 v44, s[12:15], s54 offen lds
    s_add_u32 m0, s42, 33792
    s_nop 0
    buffer_load_dwordx4 v45, s[12:15], s54 offen lds
    s_add_u32 m0, s42, 40960
    s_nop 0
    buffer_load_dwordx4 v46, s[12:15], s54 offen lds
    s_add_u32 m0, s42, 41984
    s_nop 0
    buffer_load_dwordx4 v47, s[12:15], s54 offen lds
    s_add_u32 s54, s54, 131072
    s_add_u32 m0, s42, 49152
    s_nop 0
    buffer_load_dwordx4 v44, s[12:15], s54 offen lds
    s_add_u32 m0, s42, 50176
    s_nop 0
    buffer_load_dwordx4 v45, s[12:15], s54 offen lds
    s_add_u32 m0, s42, 57344
    s_nop 0
    buffer_load_dwordx4 v46, s[12:15], s54 offen lds
    s_add_u32 m0, s42, 58368
    s_nop 0
    buffer_load_dwordx4 v47, s[12:15], s54 offen lds
    s_add_u32 s54, s54, 131072
    s_add_u32 m0, s42, 65536
    s_nop 0
    buffer_load_dwordx4 v44, s[12:15], s54 offen lds
    s_add_u32 m0, s42, 66560
    s_nop 0
    buffer_load_dwordx4 v45, s[12:15], s54 offen lds
    s_add_u32 m0, s42, 73728
    s_nop 0
    buffer_load_dwordx4 v46, s[12:15], s54 offen lds
    s_add_u32 m0, s42, 74752
    s_nop 0
    buffer_load_dwordx4 v47, s[12:15], s54 offen lds
    s_add_u32 s54, s54, 131072
    v_lshrrev_b32 v52, 4, v0
    v_bfe_u32 v53, v0, 2, 2
    v_lshl_add_u32 v52, v52, 3, v53
    v_lshlrev_b32 v52, 7, v52
    v_lshrrev_b32 v53, 1, v53
    v_lshl_add_u32 v52, v53, 6, v52
    v_and_b32 v53, 3, v0
    v_lshl_add_u32 v52, v53, 4, v52
    s_lshr_b32 s37, s32, 1
    s_lshl_b32 s37, s37, 13
    s_and_b32 s38, s32, 1
    s_lshl_b32 s38, s38, 6
    s_add_u32 s37, s37, s38
    s_add_u32 s37, s37, 0
    v_xor_b32 v48, s37, v52
    s_lshr_b32 s37, s32, 1
    s_lshl_b32 s37, s37, 13
    s_and_b32 s38, s32, 1
    s_lshl_b32 s38, s38, 6
    s_add_u32 s37, s37, s38
    s_add_u32 s37, s37, 8
    v_xor_b32 v49, s37, v52
    v_add_u32 v2, 98304, v1
    v_mov_b32 v108, 0
    v_mov_b32 v109, 0
    v_mov_b32 v110, 0
    v_mov_b32 v111, 0
    v_mov_b32 v112, 0
    v_mov_b32 v113, 0
    v_mov_b32 v114, 0
    v_mov_b32 v115, 0
    v_mov_b32 v13, 0x3f80
    v_and_b32 v12, 1, v0
    v_lshlrev_b32 v12, 4, v12
    v_lshlrev_b32 v12, v12, v13
    s_mov_b32 exec_lo, 0x300003
    s_mov_b32 exec_hi, 0x30000300
    v_mov_b32 v108, v12
    v_mov_b32 v114, v12
    s_mov_b32 exec_lo, 0xc0000c
    s_mov_b32 exec_hi, 0xc0000c00
    v_mov_b32 v109, v12
    v_mov_b32 v115, v12
    s_mov_b64 exec, -1
    s_lshl_b32 s37, s33, 6
    s_add_u32 s37, s37, 0
    s_lshl_b32 s37, s37, 7
    v_lshl_add_u32 v4, v0, 7, s37
    s_cmp_eq_u32 s32, 0
    s_cselect_b32 s37, 16, 0
    v_cmp_le_u32 vcc, s37, v0
    s_nop 1
    v_cndmask_b32 v4, v4, 2.0, vcc
    s_mov_b32 s86, 0x3f803f80
    s_lshl_b32 s43, s32, 12
    s_mul_i32 s41, s33, 2097152
    s_add_u32 s41, s41, 0x0
    s_add_u32 s41, s41, s43
    s_lshl_b32 s38, s35, 2
    s_add_u32 s38, s38, s32
    s_mul_i32 s90, s33, 2097152
    s_add_u32 s90, s90, 0x7f0000
    s_lshl_b32 s37, s38, 11
    s_add_u32 s90, s90, s37
    v_and_b32 v12, 15, v0
    v_and_b32 v13, 0x30, v0
    v_lshl_add_u32 v3, v12, 11, v13
    s_lshl_b32 s37, s38, 6
    v_add_u32 v3, s37, v3
    s_lshl_b32 s50, s33, 20
    s_add_u32 s50, s50, 983040
    s_add_u32 s88, s84, 0x5000000
    s_addc_u32 s89, s85, 0
    s_mov_b32 s8, s64
    s_mov_b32 s9, s65
    s_mov_b32 s10, 0x400000
    s_mov_b32 s11, 0x00020000
    v_bfe_u32 v13, v0, 4, 1
    v_lshl_add_u32 v12, v12, 1, v13
    s_lshl_b32 s37, s32, 2
    s_add_u32 s37, s37, 65536
    v_lshl_add_u32 v6, v12, 4, s37
    v_add_u32 v7, 65536, v1
    v_and_b32 v12, 31, v0
    v_lshrrev_b32 v13, 5, v0
    v_lshlrev_b32 v12, 2, v12
    v_lshl_add_u32 v8, v13, 10, v12
    s_mul_i32 s46, s33, 65536
    s_add_u32 s46, s46, 0x543f800
    s_lshl_b32 s37, s35, 7
    s_add_u32 s46, s46, s37
    s_cmp_eq_u32 s32, 2
    s_cselect_b32 s46, s46, 0x5f00000
    s_mov_b32 s36, -1
    v_add_u32 v50, 0, v48
    v_add_u32 v51, 0, v49
    s_waitcnt vmcnt(16)
    s_barrier
    ds_read_b64_tr_b16 a[0:1], v50 offset:0
    ds_read_b64_tr_b16 a[2:3], v50 offset:512
    ds_read_b64_tr_b16 a[4:5], v51 offset:0
    ds_read_b64_tr_b16 a[6:7], v51 offset:512
    ds_read_b64_tr_b16 a[8:9], v50 offset:4096
    ds_read_b64_tr_b16 a[10:11], v50 offset:4608
    ds_read_b64_tr_b16 a[12:13], v51 offset:4096
    ds_read_b64_tr_b16 a[14:15], v51 offset:4608
    s_add_u32 m0, s42, 81920
    s_nop 0
    buffer_load_dwordx4 v44, s[12:15], s54 offen lds
    s_add_u32 m0, s42, 82944
    s_nop 0
    buffer_load_dwordx4 v45, s[12:15], s54 offen lds
    s_add_u32 m0, s42, 90112
    s_nop 0
    buffer_load_dwordx4 v46, s[12:15], s54 offen lds
    s_add_u32 m0, s42, 91136
    s_nop 0
    buffer_load_dwordx4 v47, s[12:15], s54 offen lds
    s_add_u32 s54, s54, 131072
    s_waitcnt lgkmcnt(0)
    v_add_u32 v50, 16384, v48
    v_add_u32 v51, 16384, v49
    s_waitcnt vmcnt(16)
    s_barrier
    ds_read_b64_tr_b16 a[16:17], v50 offset:0
    ds_read_b64_tr_b16 a[18:19], v50 offset:512
    ds_read_b64_tr_b16 a[20:21], v51 offset:0
    ds_read_b64_tr_b16 a[22:23], v51 offset:512
    ds_read_b64_tr_b16 a[24:25], v50 offset:4096
    ds_read_b64_tr_b16 a[26:27], v50 offset:4608
    ds_read_b64_tr_b16 a[28:29], v51 offset:4096
    ds_read_b64_tr_b16 a[30:31], v51 offset:4608
    s_add_u32 m0, s42, 0
    s_nop 0
    buffer_load_dwordx4 v44, s[12:15], s54 offen lds
    s_add_u32 m0, s42, 1024
    s_nop 0
    buffer_load_dwordx4 v45, s[12:15], s54 offen lds
    s_add_u32 m0, s42, 8192
    s_nop 0
    buffer_load_dwordx4 v46, s[12:15], s54 offen lds
    s_add_u32 m0, s42, 9216
    s_nop 0
    buffer_load_dwordx4 v47, s[12:15], s54 offen lds
    s_add_u32 s54, s54, 131072
    s_waitcnt lgkmcnt(0)
    v_add_u32 v50, 32768, v48
    v_add_u32 v51, 32768, v49
    s_waitcnt vmcnt(16)
    s_barrier
    ds_read_b64_tr_b16 a[32:33], v50 offset:0
    ds_read_b64_tr_b16 a[34:35], v50 offset:512
    ds_read_b64_tr_b16 a[36:37], v51 offset:0
    ds_read_b64_tr_b16 a[38:39], v51 offset:512
    ds_read_b64_tr_b16 a[40:41], v50 offset:4096
    ds_read_b64_tr_b16 a[42:43], v50 offset:4608
    ds_read_b64_tr_b16 a[44:45], v51 offset:4096
    ds_read_b64_tr_b16 a[46:47], v51 offset:4608
    s_add_u32 m0, s42, 16384
    s_nop 0
    buffer_load_dwordx4 v44, s[12:15], s54 offen lds
    s_add_u32 m0, s42, 17408
    s_nop 0
    buffer_load_dwordx4 v45, s[12:15], s54 offen lds
    s_add_u32 m0, s42, 24576
    s_nop 0
    buffer_load_dwordx4 v46, s[12:15], s54 offen lds
    s_add_u32 m0, s42, 25600
    s_nop 0
    buffer_load_dwordx4 v47, s[12:15], s54 offen lds
    s_add_u32 s54, s54, 131072
    s_waitcnt lgkmcnt(0)
    v_add_u32 v50, 49152, v48
    v_add_u32 v51, 49152, v49
    s_waitcnt vmcnt(16)
    s_barrier
    ds_read_b64_tr_b16 a[48:49], v50 offset:0
    ds_read_b64_tr_b16 a[50:51], v50 offset:512
    ds_read_b64_tr_b16 a[52:53], v51 offset:0
    ds_read_b64_tr_b16 a[54:55], v51 offset:512
    ds_read_b64_tr_b16 a[56:57], v50 offset:4096
    ds_read_b64_tr_b16 a[58:59], v50 offset:4608
    ds_read_b64_tr_b16 a[60:61], v51 offset:4096
    ds_read_b64_tr_b16 a[62:63], v51 offset:4608
    s_add_u32 m0, s42, 32768
    s_nop 0
    buffer_load_dwordx4 v44, s[12:15], s54 offen lds
    s_add_u32 m0, s42, 33792
    s_nop 0
    buffer_load_dwordx4 v45, s[12:15], s54 offen lds
    s_add_u32 m0, s42, 40960
    s_nop 0
    buffer_load_dwordx4 v46, s[12:15], s54 offen lds
    s_add_u32 m0, s42, 41984
    s_nop 0
    buffer_load_dwordx4 v47, s[12:15], s54 offen lds
    s_add_u32 s54, s54, 131072
    s_waitcnt lgkmcnt(0)
    v_add_u32 v50, 65536, v48
    v_add_u32 v51, 65536, v49
    s_waitcnt vmcnt(16)
    s_barrier
    ds_read_b64_tr_b16 a[64:65], v50 offset:0
    ds_read_b64_tr_b16 a[66:67], v50 offset:512
    ds_read_b64_tr_b16 a[68:69], v51 offset:0
    ds_read_b64_tr_b16 a[70:71], v51 offset:512
    ds_read_b64_tr_b16 a[72:73], v50 offset:4096
    ds_read_b64_tr_b16 a[74:75], v50 offset:4608
    ds_read_b64_tr_b16 a[76:77], v51 offset:4096
    ds_read_b64_tr_b16 a[78:79], v51 offset:4608
    s_add_u32 m0, s42, 49152
    s_nop 0
    buffer_load_dwordx4 v44, s[12:15], s54 offen lds
    s_add_u32 m0, s42, 50176
    s_nop 0
    buffer_load_dwordx4 v45, s[12:15], s54 offen lds
    s_add_u32 m0, s42, 57344
    s_nop 0
    buffer_load_dwordx4 v46, s[12:15], s54 offen lds
    s_add_u32 m0, s42, 58368
    s_nop 0
    buffer_load_dwordx4 v47, s[12:15], s54 offen lds
    s_add_u32 s54, s54, 131072
    s_waitcnt lgkmcnt(0)
    v_add_u32 v50, 81920, v48
    v_add_u32 v51, 81920, v49
    s_waitcnt vmcnt(16)
    s_barrier
    ds_read_b64_tr_b16 a[80:81], v50 offset:0
    ds_read_b64_tr_b16 a[82:83], v50 offset:512
    ds_read_b64_tr_b16 a[84:85], v51 offset:0
    ds_read_b64_tr_b16 a[86:87], v51 offset:512
    ds_read_b64_tr_b16 a[88:89], v50 offset:4096
    ds_read_b64_tr_b16 a[90:91], v50 offset:4608
    ds_read_b64_tr_b16 a[92:93], v51 offset:4096
    ds_read_b64_tr_b16 a[94:95], v51 offset:4608
    s_add_u32 m0, s42, 65536
    s_nop 0
    buffer_load_dwordx4 v44, s[12:15], s54 offen lds
    s_add_u32 m0, s42, 66560
    s_nop 0
    buffer_load_dwordx4 v45, s[12:15], s54 offen lds
    s_add_u32 m0, s42, 73728
    s_nop 0
    buffer_load_dwordx4 v46, s[12:15], s54 offen lds
    s_add_u32 m0, s42, 74752
    s_nop 0
    buffer_load_dwordx4 v47, s[12:15], s54 offen lds
    s_add_u32 s54, s54, 131072
    s_waitcnt lgkmcnt(0)
    v_add_u32 v50, 0, v48
    v_add_u32 v51, 0, v49
    s_waitcnt vmcnt(16)
    s_barrier
    ds_read_b64_tr_b16 a[96:97], v50 offset:0
    ds_read_b64_tr_b16 a[98:99], v50 offset:512
    ds_read_b64_tr_b16 a[100:101], v51 offset:0
    ds_read_b64_tr_b16 a[102:103], v51 offset:512
    ds_read_b64_tr_b16 a[104:105], v50 offset:4096
    ds_read_b64_tr_b16 a[106:107], v50 offset:4608
    ds_read_b64_tr_b16 a[108:109], v51 offset:4096
    ds_read_b64_tr_b16 a[110:111], v51 offset:4608
    s_add_u32 m0, s42, 81920
    s_nop 0
    buffer_load_dwordx4 v44, s[12:15], s54 offen lds
    s_add_u32 m0, s42, 82944
    s_nop 0
    buffer_load_dwordx4 v45, s[12:15], s54 offen lds
    s_add_u32 m0, s42, 90112
    s_nop 0
    buffer_load_dwordx4 v46, s[12:15], s54 offen lds
    s_add_u32 m0, s42, 91136
    s_nop 0
    buffer_load_dwordx4 v47, s[12:15], s54 offen lds
    s_add_u32 s54, s54, 131072
    s_waitcnt lgkmcnt(0)
    v_add_u32 v50, 16384, v48
    v_add_u32 v51, 16384, v49
    s_waitcnt vmcnt(16)
    s_barrier
    ds_read_b64_tr_b16 a[112:113], v50 offset:0
    ds_read_b64_tr_b16 a[114:115], v50 offset:512
    ds_read_b64_tr_b16 a[116:117], v51 offset:0
    ds_read_b64_tr_b16 a[118:119], v51 offset:512
    ds_read_b64_tr_b16 a[120:121], v50 offset:4096
    ds_read_b64_tr_b16 a[122:123], v50 offset:4608
    ds_read_b64_tr_b16 a[124:125], v51 offset:4096
    ds_read_b64_tr_b16 a[126:127], v51 offset:4608
    s_add_u32 m0, s42, 0
    s_nop 0
    buffer_load_dwordx4 v44, s[12:15], s54 offen lds
    s_add_u32 m0, s42, 1024
    s_nop 0
    buffer_load_dwordx4 v45, s[12:15], s54 offen lds
    s_add_u32 m0, s42, 8192
    s_nop 0
    buffer_load_dwordx4 v46, s[12:15], s54 offen lds
    s_add_u32 m0, s42, 9216
    s_nop 0
    buffer_load_dwordx4 v47, s[12:15], s54 offen lds
    s_add_u32 s54, s54, 131072
    s_waitcnt lgkmcnt(0)
    v_add_u32 v50, 32768, v48
    v_add_u32 v51, 32768, v49
    s_waitcnt vmcnt(16)
    s_barrier
    ds_read_b64_tr_b16 a[128:129], v50 offset:0
    ds_read_b64_tr_b16 a[130:131], v50 offset:512
    ds_read_b64_tr_b16 a[132:133], v51 offset:0
    ds_read_b64_tr_b16 a[134:135], v51 offset:512
    ds_read_b64_tr_b16 a[136:137], v50 offset:4096
    ds_read_b64_tr_b16 a[138:139], v50 offset:4608
    ds_read_b64_tr_b16 a[140:141], v51 offset:4096
    ds_read_b64_tr_b16 a[142:143], v51 offset:4608
    s_add_u32 m0, s42, 16384
    s_nop 0
    buffer_load_dwordx4 v44, s[12:15], s54 offen lds
    s_add_u32 m0, s42, 17408
    s_nop 0
    buffer_load_dwordx4 v45, s[12:15], s54 offen lds
    s_add_u32 m0, s42, 24576
    s_nop 0
    buffer_load_dwordx4 v46, s[12:15], s54 offen lds
    s_add_u32 m0, s42, 25600
    s_nop 0
    buffer_load_dwordx4 v47, s[12:15], s54 offen lds
    s_add_u32 s54, s54, 131072
    s_waitcnt lgkmcnt(0)
    v_add_u32 v50, 49152, v48
    v_add_u32 v51, 49152, v49
    s_waitcnt vmcnt(16)
    s_barrier
    ds_read_b64_tr_b16 a[144:145], v50 offset:0
    ds_read_b64_tr_b16 a[146:147], v50 offset:512
    ds_read_b64_tr_b16 a[148:149], v51 offset:0
    ds_read_b64_tr_b16 a[150:151], v51 offset:512
    ds_read_b64_tr_b16 a[152:153], v50 offset:4096
    ds_read_b64_tr_b16 a[154:155], v50 offset:4608
    ds_read_b64_tr_b16 a[156:157], v51 offset:4096
    ds_read_b64_tr_b16 a[158:159], v51 offset:4608
    s_add_u32 m0, s42, 32768
    s_nop 0
    buffer_load_dwordx4 v44, s[12:15], s54 offen lds
    s_add_u32 m0, s42, 33792
    s_nop 0
    buffer_load_dwordx4 v45, s[12:15], s54 offen lds
    s_add_u32 m0, s42, 40960
    s_nop 0
    buffer_load_dwordx4 v46, s[12:15], s54 offen lds
    s_add_u32 m0, s42, 41984
    s_nop 0
    buffer_load_dwordx4 v47, s[12:15], s54 offen lds
    s_add_u32 s54, s54, 131072
    s_waitcnt lgkmcnt(0)
    v_add_u32 v50, 65536, v48
    v_add_u32 v51, 65536, v49
    s_waitcnt vmcnt(16)
    s_barrier
    ds_read_b64_tr_b16 a[160:161], v50 offset:0
    ds_read_b64_tr_b16 a[162:163], v50 offset:512
    ds_read_b64_tr_b16 a[164:165], v51 offset:0
    ds_read_b64_tr_b16 a[166:167], v51 offset:512
    ds_read_b64_tr_b16 a[168:169], v50 offset:4096
    ds_read_b64_tr_b16 a[170:171], v50 offset:4608
    ds_read_b64_tr_b16 a[172:173], v51 offset:4096
    ds_read_b64_tr_b16 a[174:175], v51 offset:4608
    s_add_u32 m0, s42, 49152
    s_nop 0
    buffer_load_dwordx4 v44, s[12:15], s54 offen lds
    s_add_u32 m0, s42, 50176
    s_nop 0
    buffer_load_dwordx4 v45, s[12:15], s54 offen lds
    s_add_u32 m0, s42, 57344
    s_nop 0
    buffer_load_dwordx4 v46, s[12:15], s54 offen lds
    s_add_u32 m0, s42, 58368
    s_nop 0
    buffer_load_dwordx4 v47, s[12:15], s54 offen lds
    s_add_u32 s54, s54, 131072
    s_waitcnt lgkmcnt(0)
    v_add_u32 v50, 81920, v48
    v_add_u32 v51, 81920, v49
    s_waitcnt vmcnt(16)
    s_barrier
    ds_read_b64_tr_b16 a[176:177], v50 offset:0
    ds_read_b64_tr_b16 a[178:179], v50 offset:512
    ds_read_b64_tr_b16 a[180:181], v51 offset:0
    ds_read_b64_tr_b16 a[182:183], v51 offset:512
    ds_read_b64_tr_b16 a[184:185], v50 offset:4096
    ds_read_b64_tr_b16 a[186:187], v50 offset:4608
    ds_read_b64_tr_b16 a[188:189], v51 offset:4096
    ds_read_b64_tr_b16 a[190:191], v51 offset:4608
    s_waitcnt lgkmcnt(0)
    v_add_u32 v50, 0, v48
    v_add_u32 v51, 0, v49
    s_waitcnt vmcnt(12)
    s_barrier
    ds_read_b64_tr_b16 a[192:193], v50 offset:0
    ds_read_b64_tr_b16 a[194:195], v50 offset:512
    ds_read_b64_tr_b16 a[196:197], v51 offset:0
    ds_read_b64_tr_b16 a[198:199], v51 offset:512
    ds_read_b64_tr_b16 a[200:201], v50 offset:4096
    ds_read_b64_tr_b16 a[202:203], v50 offset:4608
    ds_read_b64_tr_b16 a[204:205], v51 offset:4096
    ds_read_b64_tr_b16 a[206:207], v51 offset:4608
    s_waitcnt lgkmcnt(0)
    v_add_u32 v50, 16384, v48
    v_add_u32 v51, 16384, v49
    s_waitcnt vmcnt(8)
    s_barrier
    ds_read_b64_tr_b16 a[208:209], v50 offset:0
    ds_read_b64_tr_b16 a[210:211], v50 offset:512
    ds_read_b64_tr_b16 a[212:213], v51 offset:0
    ds_read_b64_tr_b16 a[214:215], v51 offset:512
    ds_read_b64_tr_b16 a[216:217], v50 offset:4096
    ds_read_b64_tr_b16 a[218:219], v50 offset:4608
    ds_read_b64_tr_b16 a[220:221], v51 offset:4096
    ds_read_b64_tr_b16 a[222:223], v51 offset:4608
    s_waitcnt lgkmcnt(0)
    v_add_u32 v50, 32768, v48
    v_add_u32 v51, 32768, v49
    s_waitcnt vmcnt(4)
    s_barrier
    ds_read_b64_tr_b16 a[224:225], v50 offset:0
    ds_read_b64_tr_b16 a[226:227], v50 offset:512
    ds_read_b64_tr_b16 a[228:229], v51 offset:0
    ds_read_b64_tr_b16 a[230:231], v51 offset:512
    ds_read_b64_tr_b16 a[232:233], v50 offset:4096
    ds_read_b64_tr_b16 a[234:235], v50 offset:4608
    ds_read_b64_tr_b16 a[236:237], v51 offset:4096
    ds_read_b64_tr_b16 a[238:239], v51 offset:4608
    s_waitcnt lgkmcnt(0)
    v_add_u32 v50, 49152, v48
    v_add_u32 v51, 49152, v49
    s_waitcnt vmcnt(0)
    s_barrier
    ds_read_b64_tr_b16 a[240:241], v50 offset:0
    ds_read_b64_tr_b16 a[242:243], v50 offset:512
    ds_read_b64_tr_b16 a[244:245], v51 offset:0
    ds_read_b64_tr_b16 a[246:247], v51 offset:512
    ds_read_b64_tr_b16 a[248:249], v50 offset:4096
    ds_read_b64_tr_b16 a[250:251], v50 offset:4608
    ds_read_b64_tr_b16 a[252:253], v51 offset:4096
    ds_read_b64_tr_b16 a[254:255], v51 offset:4608
    s_waitcnt lgkmcnt(0)
    s_barrier
    s_add_u32 s20, s82, 128
    s_addc_u32 s21, s83, 0
    s_mov_b32 s22, 128
    s_mov_b32 s23, 0x00020000
    buffer_load_dword v12, v124, s[20:23], 0 offen offset:32 sc1
    s_waitcnt vmcnt(0)
    v_readfirstlane_b32 s37, v12
    s_nop 0
    s_cmp_lg_u32 s37, s3
    s_cbranch_scc1 L_vspin31
L_vback32:
    s_cmp_lg_u32 s32, 0
    s_cbranch_scc1 L_arv33
    s_add_u32 s20, s82, 0x80
    s_addc_u32 s21, s83, 0
    s_mov_b32 s22, 0x4
    s_mov_b32 s23, 0x00020000
    buffer_load_dword v12, v124, s[20:23], 0 offen sc1
    s_waitcnt vmcnt(0)
    v_cmp_eq_u32 vcc, v124, v12
    s_cbranch_vccnz L_spin34
L_back35:
L_arv33:
    s_add_u32 s47, s36, 1
    s_min_i32 s47, s47, 31
    s_max_i32 s47, s47, 0
    s_cmp_ge_u32 s47, 16
    s_cselect_b32 s8, s88, s64
    s_cselect_b32 s9, s89, s65
    s_and_b32 s47, s47, 15
    s_lshl_b32 s47, s47, 16
    s_sub_u32 s47, s50, s47
    s_add_u32 s48, s47, 32768
    buffer_load_dwordx4 v[128:131], v3, s[8:11], s48 offen sc1
    buffer_load_dwordx4 v[132:135], v3, s[8:11], s47 offen sc1
    s_add_u32 s96, s41, 2031616
    s_mov_b32 s98, s41
    s_mov_b32 s45, 0x5540000
    buffer_load_dword v136, v4, s[16:19], s45 offen sc1
    s_waitcnt vmcnt(0)
    v_cmp_ne_u32 vcc, 0, v136
    s_cbranch_vccnz L_spin36
L_back37:
    s_barrier
    s_mov_b32 s39, 0x5e00000
    s_add_u32 m0, s43, 0
    s_add_u32 s42, s41, 0
    buffer_load_dwordx4 v1, s[16:19], s42 offen offset:0 sc1 lds
    buffer_load_dwordx4 v1, s[16:19], s42 offen offset:1024 sc1 lds
    buffer_load_dwordx4 v1, s[16:19], s42 offen offset:2048 sc1 lds
    buffer_load_dwordx4 v1, s[16:19], s42 offen offset:3072 sc1 lds
    s_add_u32 m0, s43, 16384
    s_add_u32 s42, s41, 16384
    buffer_load_dwordx4 v1, s[16:19], s42 offen offset:0 sc1 lds
    buffer_load_dwordx4 v1, s[16:19], s42 offen offset:1024 sc1 lds
    buffer_load_dwordx4 v1, s[16:19], s42 offen offset:2048 sc1 lds
    buffer_load_dwordx4 v1, s[16:19], s42 offen offset:3072 sc1 lds
    buffer_store_dword v124, v124, s[16:19], s39 offen
    buffer_store_dword v124, v124, s[16:19], s39 offen
    s_add_u32 m0, s43, 32768
    s_add_u32 s42, s41, 32768
    buffer_load_dwordx4 v1, s[16:19], s42 offen offset:0 sc1 lds
    buffer_load_dwordx4 v1, s[16:19], s42 offen offset:1024 sc1 lds
    buffer_load_dwordx4 v1, s[16:19], s42 offen offset:2048 sc1 lds
    buffer_load_dwordx4 v1, s[16:19], s42 offen offset:3072 sc1 lds
    s_add_u32 s45, s45, 65536
    s_waitcnt vmcnt(10) lgkmcnt(0)
    s_barrier
    v_mfma_f32_16x16x32_bf16 v[12:15], v[108:111], v[128:131], 0
    v_mfma_f32_16x16x32_bf16 v[16:19], v[112:115], v[128:131], 0
    v_mfma_f32_16x16x32_bf16 v[20:23], v[108:111], v[132:135], 0
    v_mfma_f32_16x16x32_bf16 v[24:27], v[112:115], v[132:135], 0
    ds_read_b128 v[44:47], v1 offset:0
    ds_read_b128 v[48:51], v1 offset:1024
    ds_read_b128 v[52:55], v1 offset:2048
    ds_read_b128 v[56:59], v1 offset:3072
    s_mov_b32 s36, 0
    s_waitcnt lgkmcnt(0)
    s_nop 7
L_o_b0:
    s_waitcnt lgkmcnt(2)
    v_mfma_f32_16x16x32_bf16 v[12:15], a[0:3], v[44:47], v[12:15]
    ds_read_b128 v[60:63], v1 offset:4096
    ds_read_b128 v[140:143], v7
    v_mfma_f32_16x16x32_bf16 v[20:23], a[0:3], v[48:51], v[20:23]
    s_cmp_eq_u32 s36, 0
    s_cselect_b32 s49, 0x5e00000, s46
    v_mfma_f32_16x16x32_bf16 v[24:27], a[4:7], v[48:51], v[24:27]
    ds_read_b128 v[64:67], v1 offset:5120
    v_mfma_f32_16x16x32_bf16 v[16:19], a[4:7], v[44:47], v[16:19]
    s_waitcnt lgkmcnt(3)
    v_mfma_f32_16x16x32_bf16 v[12:15], a[8:11], v[52:55], v[12:15]
    s_waitcnt lgkmcnt(1)
    ds_read_b128 v[68:71], v1 offset:6144
    v_add_f32 v140, v140, v141
    v_mfma_f32_16x16x32_bf16 v[20:23], a[8:11], v[56:59], v[20:23]
    v_add_f32 v142, v142, v143
    v_add_f32 v140, v140, v142
    v_mfma_f32_16x16x32_bf16 v[24:27], a[12:15], v[56:59], v[24:27]
    ds_read_b128 v[72:75], v1 offset:7168
    v_min_u32 v140, -2, v140
    v_mfma_f32_16x16x32_bf16 v[16:19], a[12:15], v[52:55], v[16:19]
    s_waitcnt lgkmcnt(2)
    buffer_store_dword v140, v8, s[16:19], s49 offen sc1
    v_mfma_f32_16x16x32_bf16 v[12:15], a[16:19], v[60:63], v[12:15]
    ds_read_b128 v[44:47], v1 offset:8192
    v_mfma_f32_16x16x32_bf16 v[20:23], a[16:19], v[64:67], v[20:23]
    v_mfma_f32_16x16x32_bf16 v[24:27], a[20:23], v[64:67], v[24:27]
    s_add_u32 m0, s43, 49152
    ds_read_b128 v[48:51], v1 offset:9216
    s_add_u32 s42, s41, 49152
    v_mfma_f32_16x16x32_bf16 v[16:19], a[20:23], v[60:63], v[16:19]
    s_waitcnt lgkmcnt(2)
    buffer_load_dwordx4 v1, s[16:19], s42 offen offset:0 sc1 lds
    v_mfma_f32_16x16x32_bf16 v[12:15], a[24:27], v[68:71], v[12:15]
    ds_read_b128 v[52:55], v1 offset:10240
    v_mfma_f32_16x16x32_bf16 v[20:23], a[24:27], v[72:75], v[20:23]
    v_mfma_f32_16x16x32_bf16 v[24:27], a[28:31], v[72:75], v[24:27]
    ds_read_b128 v[56:59], v1 offset:11264
    buffer_load_dwordx4 v1, s[16:19], s42 offen offset:1024 sc1 lds
    v_mfma_f32_16x16x32_bf16 v[16:19], a[28:31], v[68:71], v[16:19]
    s_waitcnt lgkmcnt(2)
    v_mfma_f32_16x16x32_bf16 v[12:15], a[32:35], v[44:47], v[12:15]
    ds_read_b128 v[60:63], v1 offset:12288
    v_mfma_f32_16x16x32_bf16 v[20:23], a[32:35], v[48:51], v[20:23]
    buffer_load_dwordx4 v1, s[16:19], s42 offen offset:2048 sc1 lds
    v_mfma_f32_16x16x32_bf16 v[24:27], a[36:39], v[48:51], v[24:27]
    ds_read_b128 v[64:67], v1 offset:13312
    v_mfma_f32_16x16x32_bf16 v[16:19], a[36:39], v[44:47], v[16:19]
    s_waitcnt lgkmcnt(2)
    v_mfma_f32_16x16x32_bf16 v[12:15], a[40:43], v[52:55], v[12:15]
    ds_read_b128 v[68:71], v1 offset:14336
    buffer_load_dwordx4 v1, s[16:19], s42 offen offset:3072 sc1 lds
    v_mfma_f32_16x16x32_bf16 v[20:23], a[40:43], v[56:59], v[20:23]
    s_add_u32 s98, s98, 65536
    s_min_i32 s98, s98, s96
    s_and_b32 s41, s98, 0xffffffff
    v_mfma_f32_16x16x32_bf16 v[24:27], a[44:47], v[56:59], v[24:27]
    s_add_u32 m0, s43, 98304
    ds_read_b128 v[72:75], v1 offset:15360
    s_add_u32 s42, s41, 0
    v_mfma_f32_16x16x32_bf16 v[16:19], a[44:47], v[52:55], v[16:19]
    s_waitcnt vmcnt(11) lgkmcnt(2)
    s_barrier
    v_mfma_f32_16x16x32_bf16 v[12:15], a[48:51], v[60:63], v[12:15]
    ds_read_b128 v[44:47], v1 offset:16384
    v_mfma_f32_16x16x32_bf16 v[20:23], a[48:51], v[64:67], v[20:23]
    v_mfma_f32_16x16x32_bf16 v[24:27], a[52:55], v[64:67], v[24:27]
    s_add_u32 s47, s36, 1
    ds_read_b128 v[48:51], v1 offset:17408
    s_min_i32 s47, s47, 31
    v_mfma_f32_16x16x32_bf16 v[16:19], a[52:55], v[60:63], v[16:19]
    s_waitcnt lgkmcnt(2)
    s_max_i32 s47, s47, 0
    s_cmp_ge_u32 s47, 16
    v_mfma_f32_16x16x32_bf16 v[12:15], a[56:59], v[68:71], v[12:15]
    s_cselect_b32 s8, s88, s64
    ds_read_b128 v[52:55], v1 offset:18432
    s_cselect_b32 s9, s89, s65
    v_mfma_f32_16x16x32_bf16 v[20:23], a[56:59], v[72:75], v[20:23]
    s_and_b32 s47, s47, 15
    s_lshl_b32 s47, s47, 16
    s_sub_u32 s47, s50, s47
    v_mfma_f32_16x16x32_bf16 v[24:27], a[60:63], v[72:75], v[24:27]
    s_add_u32 s48, s47, 32768
    ds_read_b128 v[56:59], v1 offset:19456
    buffer_load_dwordx4 v[128:131], v3, s[8:11], s48 offen sc1
    v_mfma_f32_16x16x32_bf16 v[16:19], a[60:63], v[68:71], v[16:19]
    s_waitcnt lgkmcnt(2)
    buffer_load_dwordx4 v[132:135], v3, s[8:11], s47 offen sc1
    v_mfma_f32_16x16x32_bf16 v[12:15], a[64:67], v[44:47], v[12:15]
    s_add_u32 s90, s90, 65536
    ds_read_b128 v[60:63], v1 offset:20480
    s_add_u32 s46, s46, 2048
    v_mfma_f32_16x16x32_bf16 v[20:23], a[64:67], v[48:51], v[20:23]
    s_and_b32 s44, s90, 0xffffffff
    v_mfma_f32_16x16x32_bf16 v[24:27], a[68:71], v[48:51], v[24:27]
    ds_read_b128 v[64:67], v1 offset:21504
    buffer_load_dword v136, v4, s[16:19], s45 offen sc1
    v_mfma_f32_16x16x32_bf16 v[16:19], a[68:71], v[44:47], v[16:19]
    s_waitcnt lgkmcnt(2)
    v_mfma_f32_16x16x32_bf16 v[12:15], a[72:75], v[52:55], v[12:15]
    ds_read_b128 v[68:71], v1 offset:22528
    v_mfma_f32_16x16x32_bf16 v[20:23], a[72:75], v[56:59], v[20:23]
    v_mfma_f32_16x16x32_bf16 v[24:27], a[76:79], v[56:59], v[24:27]
    ds_read_b128 v[72:75], v1 offset:23552
    v_mfma_f32_16x16x32_bf16 v[16:19], a[76:79], v[52:55], v[16:19]
    s_waitcnt lgkmcnt(2)
    v_mfma_f32_16x16x32_bf16 v[12:15], a[80:83], v[60:63], v[12:15]
    s_waitcnt vmcnt(12)
    ds_read_b128 v[44:47], v1 offset:24576
    s_barrier
    v_mfma_f32_16x16x32_bf16 v[20:23], a[80:83], v[64:67], v[20:23]
    buffer_store_dword v124, v124, s[16:19], s91 offen sc1
    v_mfma_f32_16x16x32_bf16 v[24:27], a[84:87], v[64:67], v[24:27]
    s_add_u32 s91, s91, 65536
    ds_read_b128 v[48:51], v1 offset:25600
    v_mfma_f32_16x16x32_bf16 v[16:19], a[84:87], v[60:63], v[16:19]
    s_waitcnt lgkmcnt(2)
    v_mfma_f32_16x16x32_bf16 v[12:15], a[88:91], v[68:71], v[12:15]
    ds_read_b128 v[52:55], v1 offset:26624
    v_mfma_f32_16x16x32_bf16 v[20:23], a[88:91], v[72:75], v[20:23]
    v_mfma_f32_16x16x32_bf16 v[24:27], a[92:95], v[72:75], v[24:27]
    ds_read_b128 v[56:59], v1 offset:27648
    v_mfma_f32_16x16x32_bf16 v[16:19], a[92:95], v[68:71], v[16:19]
    s_waitcnt lgkmcnt(2)
    v_mfma_f32_16x16x32_bf16 v[12:15], a[96:99], v[44:47], v[12:15]
    ds_read_b128 v[60:63], v1 offset:28672
    v_mfma_f32_16x16x32_bf16 v[20:23], a[96:99], v[48:51], v[20:23]
    v_mfma_f32_16x16x32_bf16 v[24:27], a[100:103], v[48:51], v[24:27]
    ds_read_b128 v[64:67], v1 offset:29696
    v_mfma_f32_16x16x32_bf16 v[16:19], a[100:103], v[44:47], v[16:19]
    s_waitcnt lgkmcnt(2)
    v_mfma_f32_16x16x32_bf16 v[12:15], a[104:107], v[52:55], v[12:15]
    ds_read_b128 v[68:71], v1 offset:30720
    v_mfma_f32_16x16x32_bf16 v[20:23], a[104:107], v[56:59], v[20:23]
    v_mfma_f32_16x16x32_bf16 v[24:27], a[108:111], v[56:59], v[24:27]
    ds_read_b128 v[72:75], v1 offset:31744
    v_mfma_f32_16x16x32_bf16 v[16:19], a[108:111], v[52:55], v[16:19]
    s_waitcnt vmcnt(9) lgkmcnt(2)
    s_barrier
    v_mfma_f32_16x16x32_bf16 v[12:15], a[112:115], v[60:63], v[12:15]
    ds_read_b128 v[44:47], v1 offset:32768
    v_mfma_f32_16x16x32_bf16 v[20:23], a[112:115], v[64:67], v[20:23]
    v_mfma_f32_16x16x32_bf16 v[24:27], a[116:119], v[64:67], v[24:27]
    ds_read_b128 v[48:51], v1 offset:33792
    v_mfma_f32_16x16x32_bf16 v[16:19], a[116:119], v[60:63], v[16:19]
    s_waitcnt lgkmcnt(2)
    v_mfma_f32_16x16x32_bf16 v[12:15], a[120:123], v[68:71], v[12:15]
    ds_read_b128 v[52:55], v1 offset:34816
    v_mfma_f32_16x16x32_bf16 v[20:23], a[120:123], v[72:75], v[20:23]
    v_mfma_f32_16x16x32_bf16 v[24:27], a[124:127], v[72:75], v[24:27]
    ds_read_b128 v[56:59], v1 offset:35840
    v_mfma_f32_16x16x32_bf16 v[16:19], a[124:127], v[68:71], v[16:19]
    s_waitcnt lgkmcnt(2)
    v_mfma_f32_16x16x32_bf16 v[12:15], a[128:131], v[44:47], v[12:15]
    ds_read_b128 v[60:63], v1 offset:36864
    v_mfma_f32_16x16x32_bf16 v[20:23], a[128:131], v[48:51], v[20:23]
    v_mfma_f32_16x16x32_bf16 v[24:27], a[132:135], v[48:51], v[24:27]
    ds_read_b128 v[64:67], v1 offset:37888
    v_mfma_f32_16x16x32_bf16 v[16:19], a[132:135], v[44:47], v[16:19]
    s_waitcnt lgkmcnt(2)
    v_mfma_f32_16x16x32_bf16 v[12:15], a[136:139], v[52:55], v[12:15]
    ds_read_b128 v[68:71], v1 offset:38912
    v_mfma_f32_16x16x32_bf16 v[20:23], a[136:139], v[56:59], v[20:23]
    v_mfma_f32_16x16x32_bf16 v[24:27], a[140:143], v[56:59], v[24:27]
    ds_read_b128 v[72:75], v1 offset:39936
    v_mfma_f32_16x16x32_bf16 v[16:19], a[140:143], v[52:55], v[16:19]
    s_waitcnt lgkmcnt(2)
    v_mfma_f32_16x16x32_bf16 v[12:15], a[144:147], v[60:63], v[12:15]
    ds_read_b128 v[44:47], v1 offset:40960
    v_mfma_f32_16x16x32_bf16 v[20:23], a[144:147], v[64:67], v[20:23]
    v_mfma_f32_16x16x32_bf16 v[24:27], a[148:151], v[64:67], v[24:27]
    ds_read_b128 v[48:51], v1 offset:41984
    v_mfma_f32_16x16x32_bf16 v[16:19], a[148:151], v[60:63], v[16:19]
    s_waitcnt lgkmcnt(2)
    v_mfma_f32_16x16x32_bf16 v[12:15], a[152:155], v[68:71], v[12:15]
    ds_read_b128 v[52:55], v1 offset:43008
    v_mfma_f32_16x16x32_bf16 v[20:23], a[152:155], v[72:75], v[20:23]
    v_mfma_f32_16x16x32_bf16 v[24:27], a[156:159], v[72:75], v[24:27]
    ds_read_b128 v[56:59], v1 offset:44032
    v_mfma_f32_16x16x32_bf16 v[16:19], a[156:159], v[68:71], v[16:19]
    s_waitcnt lgkmcnt(2)
    v_mfma_f32_16x16x32_bf16 v[12:15], a[160:163], v[44:47], v[12:15]
    ds_read_b128 v[60:63], v1 offset:45056
    v_mfma_f32_16x16x32_bf16 v[20:23], a[160:163], v[48:51], v[20:23]
    v_mfma_f32_16x16x32_bf16 v[24:27], a[164:167], v[48:51], v[24:27]
    ds_read_b128 v[64:67], v1 offset:46080
    v_mfma_f32_16x16x32_bf16 v[16:19], a[164:167], v[44:47], v[16:19]
    s_waitcnt lgkmcnt(2)
    v_mfma_f32_16x16x32_bf16 v[12:15], a[168:171], v[52:55], v[12:15]
    ds_read_b128 v[68:71], v1 offset:47104
    v_mfma_f32_16x16x32_bf16 v[20:23], a[168:171], v[56:59], v[20:23]
    v_mfma_f32_16x16x32_bf16 v[24:27], a[172:175], v[56:59], v[24:27]
    ds_read_b128 v[72:75], v1 offset:48128
    v_mfma_f32_16x16x32_bf16 v[16:19], a[172:175], v[52:55], v[16:19]
    s_waitcnt vmcnt(4) lgkmcnt(2)
    s_barrier
    v_mfma_f32_16x16x32_bf16 v[12:15], a[176:179], v[60:63], v[12:15]
    ds_read_b128 v[44:47], v1 offset:49152
    v_mfma_f32_16x16x32_bf16 v[20:23], a[176:179], v[64:67], v[20:23]
    v_mfma_f32_16x16x32_bf16 v[24:27], a[180:183], v[64:67], v[24:27]
    ds_read_b128 v[48:51], v1 offset:50176
    v_mfma_f32_16x16x32_bf16 v[16:19], a[180:183], v[60:63], v[16:19]
    s_waitcnt lgkmcnt(2)
    v_mfma_f32_16x16x32_bf16 v[12:15], a[184:187], v[68:71], v[12:15]
    s_waitcnt vmcnt(1)
    ds_read_b128 v[52:55], v1 offset:51200
    v_cmp_ne_u32 vcc, 0, v136
    v_mfma_f32_16x16x32_bf16 v[20:23], a[184:187], v[72:75], v[20:23]
    v_mfma_f32_16x16x32_bf16 v[24:27], a[188:191], v[72:75], v[24:27]
    s_cbranch_vccnz L_spin38
L_back39:
    ds_read_b128 v[56:59], v1 offset:52224
    s_barrier
    v_mfma_f32_16x16x32_bf16 v[16:19], a[188:191], v[68:71], v[16:19]
    s_waitcnt lgkmcnt(2)
    s_add_u32 s45, s45, 65536
    buffer_load_dwordx4 v1, s[16:19], s42 offen offset:0 sc1 lds
    v_mfma_f32_16x16x32_bf16 v[12:15], a[192:195], v[44:47], v[12:15]
    s_waitcnt vmcnt(3)
    ds_read_b128 v[60:63], v1 offset:53248
    v_mfma_f32_16x16x32_bf16 v[28:31], v[108:111], v[128:131], 0
    v_mfma_f32_16x16x32_bf16 v[32:35], v[112:115], v[128:131], 0
    v_mfma_f32_16x16x32_bf16 v[36:39], v[108:111], v[132:135], 0
    v_mfma_f32_16x16x32_bf16 v[40:43], v[112:115], v[132:135], 0
    v_mfma_f32_16x16x32_bf16 v[20:23], a[192:195], v[48:51], v[20:23]
    v_mfma_f32_16x16x32_bf16 v[24:27], a[196:199], v[48:51], v[24:27]
    ds_read_b128 v[64:67], v1 offset:54272
    v_mfma_f32_16x16x32_bf16 v[16:19], a[196:199], v[44:47], v[16:19]
    s_waitcnt lgkmcnt(2)
    buffer_load_dwordx4 v1, s[16:19], s42 offen offset:1024 sc1 lds
    v_mfma_f32_16x16x32_bf16 v[12:15], a[200:203], v[52:55], v[12:15]
    ds_read_b128 v[68:71], v1 offset:55296
    v_mfma_f32_16x16x32_bf16 v[20:23], a[200:203], v[56:59], v[20:23]
    v_mfma_f32_16x16x32_bf16 v[24:27], a[204:207], v[56:59], v[24:27]
    ds_read_b128 v[72:75], v1 offset:56320
    v_mfma_f32_16x16x32_bf16 v[16:19], a[204:207], v[52:55], v[16:19]
    s_waitcnt lgkmcnt(2)
    buffer_load_dwordx4 v1, s[16:19], s42 offen offset:2048 sc1 lds
    v_mfma_f32_16x16x32_bf16 v[12:15], a[208:211], v[60:63], v[12:15]
    ds_read_b128 v[44:47], v1 offset:57344
    v_mfma_f32_16x16x32_bf16 v[20:23], a[208:211], v[64:67], v[20:23]
    v_mfma_f32_16x16x32_bf16 v[24:27], a[212:215], v[64:67], v[24:27]
    ds_read_b128 v[48:51], v1 offset:58368
    v_mfma_f32_16x16x32_bf16 v[16:19], a[212:215], v[60:63], v[16:19]
    s_waitcnt lgkmcnt(2)
    buffer_load_dwordx4 v1, s[16:19], s42 offen offset:3072 sc1 lds
    v_mfma_f32_16x16x32_bf16 v[12:15], a[216:219], v[68:71], v[12:15]
    s_add_u32 m0, s43, 114688
    ds_read_b128 v[52:55], v1 offset:59392
    s_add_u32 s42, s41, 16384
    v_mfma_f32_16x16x32_bf16 v[20:23], a[216:219], v[72:75], v[20:23]
    v_mfma_f32_16x16x32_bf16 v[24:27], a[220:223], v[72:75], v[24:27]
    ds_read_b128 v[56:59], v1 offset:60416
    v_mfma_f32_16x16x32_bf16 v[16:19], a[220:223], v[68:71], v[16:19]
    s_waitcnt lgkmcnt(2)
    buffer_load_dwordx4 v1, s[16:19], s42 offen offset:0 sc1 lds
    v_mfma_f32_16x16x32_bf16 v[12:15], a[224:227], v[44:47], v[12:15]
    ds_read_b128 v[60:63], v1 offset:61440
    v_mfma_f32_16x16x32_bf16 v[20:23], a[224:227], v[48:51], v[20:23]
    v_mfma_f32_16x16x32_bf16 v[24:27], a[228:231], v[48:51], v[24:27]
    ds_read_b128 v[64:67], v1 offset:62464
    v_mfma_f32_16x16x32_bf16 v[16:19], a[228:231], v[44:47], v[16:19]
    s_waitcnt lgkmcnt(2)
    buffer_load_dwordx4 v1, s[16:19], s42 offen offset:1024 sc1 lds
    v_mfma_f32_16x16x32_bf16 v[12:15], a[232:235], v[52:55], v[12:15]
    ds_read_b128 v[68:71], v1 offset:63488
    v_mfma_f32_16x16x32_bf16 v[20:23], a[232:235], v[56:59], v[20:23]
    v_mfma_f32_16x16x32_bf16 v[24:27], a[236:239], v[56:59], v[24:27]
    ds_read_b128 v[72:75], v1 offset:64512
    v_mfma_f32_16x16x32_bf16 v[16:19], a[236:239], v[52:55], v[16:19]
    s_waitcnt lgkmcnt(2)
    buffer_load_dwordx4 v1, s[16:19], s42 offen offset:2048 sc1 lds
    v_mfma_f32_16x16x32_bf16 v[12:15], a[240:243], v[60:63], v[12:15]
    v_mfma_f32_16x16x32_bf16 v[20:23], a[240:243], v[64:67], v[20:23]
    v_mfma_f32_16x16x32_bf16 v[24:27], a[244:247], v[64:67], v[24:27]
    v_mfma_f32_16x16x32_bf16 v[16:19], a[244:247], v[60:63], v[16:19]
    s_waitcnt lgkmcnt(0)
    buffer_load_dwordx4 v1, s[16:19], s42 offen offset:3072 sc1 lds
    v_mfma_f32_16x16x32_bf16 v[12:15], a[248:251], v[68:71], v[12:15]
    v_mfma_f32_16x16x32_bf16 v[20:23], a[248:251], v[72:75], v[20:23]
    v_mfma_f32_16x16x32_bf16 v[24:27], a[252:255], v[72:75], v[24:27]
    v_mfma_f32_16x16x32_bf16 v[16:19], a[252:255], v[68:71], v[16:19]
    s_nop 1
    v_cvt_pk_bf16_f32 v148, v12, v13
    v_cvt_pk_bf16_f32 v149, v14, v15
    s_nop 3
    v_cvt_pk_bf16_f32 v150, v16, v17
    v_cvt_pk_bf16_f32 v151, v18, v19
    buffer_store_dwordx4 v[148:151], v1, s[16:19], s44 offen offset:0 sc1
    v_cvt_pk_bf16_f32 v152, v20, v21
    v_cvt_pk_bf16_f32 v153, v22, v23
    v_cvt_pk_bf16_f32 v154, v24, v25
    v_cvt_pk_bf16_f32 v155, v26, v27
    buffer_store_dwordx4 v[152:155], v1, s[16:19], s44 offen offset:1024 sc1
    s_add_u32 m0, s43, 131072
    s_add_u32 s42, s41, 32768
    v_add_f32 v140, v12, v13
    v_add_f32 v144, v20, v21
    v_mul_f32 v141, v12, v12
    v_mul_f32 v145, v20, v20
    buffer_load_dwordx4 v1, s[16:19], s42 offen offset:0 sc1 lds
    v_fmac_f32 v141, v13, v13
    v_fmac_f32 v145, v21, v21
    v_add_f32 v140, v140, v14
    v_add_f32 v144, v144, v22
    v_fmac_f32 v141, v14, v14
    v_fmac_f32 v145, v22, v22
    v_add_f32 v140, v140, v15
    v_add_f32 v144, v144, v23
    buffer_load_dwordx4 v1, s[16:19], s42 offen offset:1024 sc1 lds
    v_fmac_f32 v141, v15, v15
    v_fmac_f32 v145, v23, v23
    v_add_f32 v140, v140, v16
    v_add_f32 v144, v144, v24
    v_fmac_f32 v141, v16, v16
    v_fmac_f32 v145, v24, v24
    v_add_f32 v140, v140, v17
    v_add_f32 v144, v144, v25
    buffer_load_dwordx4 v1, s[16:19], s42 offen offset:2048 sc1 lds
    v_fmac_f32 v141, v17, v17
    v_fmac_f32 v145, v25, v25
    v_add_f32 v140, v140, v18
    v_add_f32 v144, v144, v26
    v_fmac_f32 v141, v18, v18
    v_fmac_f32 v145, v26, v26
    v_add_f32 v140, v140, v19
    v_add_f32 v144, v144, v27
    buffer_load_dwordx4 v1, s[16:19], s42 offen offset:3072 sc1 lds
    v_fmac_f32 v141, v19, v19
    v_fmac_f32 v145, v27, v27
    s_nop 0
    v_permlane16_swap_b32 v140, v141
    v_permlane16_swap_b32 v144, v145
    v_add_f32 v140, v140, v141
    v_add_f32 v144, v144, v145
    v_mov_b32 v142, v140
    v_mov_b32 v146, v144
    s_nop 0
    v_permlane32_swap_b32 v140, v142
    v_permlane32_swap_b32 v144, v146
    v_add_f32 v140, v140, v142
    v_add_f32 v144, v144, v146
    ds_write_b32 v6, v140 offset:0
    ds_write_b32 v6, v144 offset:512
    s_waitcnt vmcnt(10) lgkmcnt(0)
    s_barrier
    ds_read_b128 v[44:47], v2 offset:0
    ds_read_b128 v[48:51], v2 offset:1024
    ds_read_b128 v[52:55], v2 offset:2048
    ds_read_b128 v[56:59], v2 offset:3072
    s_add_u32 s36, s36, 1
L_o_b1:
    s_waitcnt lgkmcnt(2)
    v_mfma_f32_16x16x32_bf16 v[28:31], a[0:3], v[44:47], v[28:31]
    ds_read_b128 v[60:63], v2 offset:4096
    ds_read_b128 v[140:143], v7
    v_mfma_f32_16x16x32_bf16 v[36:39], a[0:3], v[48:51], v[36:39]
    s_cmp_eq_u32 s36, 0
    s_cselect_b32 s49, 0x5e00000, s46
    v_mfma_f32_16x16x32_bf16 v[40:43], a[4:7], v[48:51], v[40:43]
    ds_read_b128 v[64:67], v2 offset:5120
    v_mfma_f32_16x16x32_bf16 v[32:35], a[4:7], v[44:47], v[32:35]
    s_waitcnt lgkmcnt(3)
    v_mfma_f32_16x16x32_bf16 v[28:31], a[8:11], v[52:55], v[28:31]
    s_waitcnt lgkmcnt(1)
    ds_read_b128 v[68:71], v2 offset:6144
    v_add_f32 v140, v140, v141
    v_mfma_f32_16x16x32_bf16 v[36:39], a[8:11], v[56:59], v[36:39]
    v_add_f32 v142, v142, v143
    v_add_f32 v140, v140, v142
    v_mfma_f32_16x16x32_bf16 v[40:43], a[12:15], v[56:59], v[40:43]
    ds_read_b128 v[72:75], v2 offset:7168
    v_min_u32 v140, -2, v140
    v_mfma_f32_16x16x32_bf16 v[32:35], a[12:15], v[52:55], v[32:35]
    s_waitcnt lgkmcnt(2)
    buffer_store_dword v140, v8, s[16:19], s49 offen sc1
    v_mfma_f32_16x16x32_bf16 v[28:31], a[16:19], v[60:63], v[28:31]
    ds_read_b128 v[44:47], v2 offset:8192
    v_mfma_f32_16x16x32_bf16 v[36:39], a[16:19], v[64:67], v[36:39]
    v_mfma_f32_16x16x32_bf16 v[40:43], a[20:23], v[64:67], v[40:43]
    s_add_u32 m0, s43, 147456
    ds_read_b128 v[48:51], v2 offset:9216
    s_add_u32 s42, s41, 49152
    v_mfma_f32_16x16x32_bf16 v[32:35], a[20:23], v[60:63], v[32:35]
    s_waitcnt lgkmcnt(2)
    buffer_load_dwordx4 v1, s[16:19], s42 offen offset:0 sc1 lds
    v_mfma_f32_16x16x32_bf16 v[28:31], a[24:27], v[68:71], v[28:31]
    ds_read_b128 v[52:55], v2 offset:10240
    v_mfma_f32_16x16x32_bf16 v[36:39], a[24:27], v[72:75], v[36:39]
    v_mfma_f32_16x16x32_bf16 v[40:43], a[28:31], v[72:75], v[40:43]
    ds_read_b128 v[56:59], v2 offset:11264
    buffer_load_dwordx4 v1, s[16:19], s42 offen offset:1024 sc1 lds
    v_mfma_f32_16x16x32_bf16 v[32:35], a[28:31], v[68:71], v[32:35]
    s_waitcnt lgkmcnt(2)
    v_mfma_f32_16x16x32_bf16 v[28:31], a[32:35], v[44:47], v[28:31]
    ds_read_b128 v[60:63], v2 offset:12288
    v_mfma_f32_16x16x32_bf16 v[36:39], a[32:35], v[48:51], v[36:39]
    buffer_load_dwordx4 v1, s[16:19], s42 offen offset:2048 sc1 lds
    v_mfma_f32_16x16x32_bf16 v[40:43], a[36:39], v[48:51], v[40:43]
    ds_read_b128 v[64:67], v2 offset:13312
    v_mfma_f32_16x16x32_bf16 v[32:35], a[36:39], v[44:47], v[32:35]
    s_waitcnt lgkmcnt(2)
    v_mfma_f32_16x16x32_bf16 v[28:31], a[40:43], v[52:55], v[28:31]
    ds_read_b128 v[68:71], v2 offset:14336
    buffer_load_dwordx4 v1, s[16:19], s42 offen offset:3072 sc1 lds
    v_mfma_f32_16x16x32_bf16 v[36:39], a[40:43], v[56:59], v[36:39]
    s_add_u32 s98, s98, 65536
    s_min_i32 s98, s98, s96
    s_and_b32 s41, s98, 0xffffffff
    v_mfma_f32_16x16x32_bf16 v[40:43], a[44:47], v[56:59], v[40:43]
    s_add_u32 m0, s43, 0
    ds_read_b128 v[72:75], v2 offset:15360
    s_add_u32 s42, s41, 0
    v_mfma_f32_16x16x32_bf16 v[32:35], a[44:47], v[52:55], v[32:35]
    s_waitcnt vmcnt(11) lgkmcnt(2)
    s_barrier
    v_mfma_f32_16x16x32_bf16 v[28:31], a[48:51], v[60:63], v[28:31]
    ds_read_b128 v[44:47], v2 offset:16384
    v_mfma_f32_16x16x32_bf16 v[36:39], a[48:51], v[64:67], v[36:39]
    v_mfma_f32_16x16x32_bf16 v[40:43], a[52:55], v[64:67], v[40:43]
    s_add_u32 s47, s36, 1
    ds_read_b128 v[48:51], v2 offset:17408
    s_min_i32 s47, s47, 31
    v_mfma_f32_16x16x32_bf16 v[32:35], a[52:55], v[60:63], v[32:35]
    s_waitcnt lgkmcnt(2)
    s_max_i32 s47, s47, 0
    s_cmp_ge_u32 s47, 16
    v_mfma_f32_16x16x32_bf16 v[28:31], a[56:59], v[68:71], v[28:31]
    s_cselect_b32 s8, s88, s64
    ds_read_b128 v[52:55], v2 offset:18432
    s_cselect_b32 s9, s89, s65
    v_mfma_f32_16x16x32_bf16 v[36:39], a[56:59], v[72:75], v[36:39]
    s_and_b32 s47, s47, 15
    s_lshl_b32 s47, s47, 16
    s_sub_u32 s47, s50, s47
    v_mfma_f32_16x16x32_bf16 v[40:43], a[60:63], v[72:75], v[40:43]
    s_add_u32 s48, s47, 32768
    ds_read_b128 v[56:59], v2 offset:19456
    buffer_load_dwordx4 v[128:131], v3, s[8:11], s48 offen sc1
    v_mfma_f32_16x16x32_bf16 v[32:35], a[60:63], v[68:71], v[32:35]
    s_waitcnt lgkmcnt(2)
    buffer_load_dwordx4 v[132:135], v3, s[8:11], s47 offen sc1
    v_mfma_f32_16x16x32_bf16 v[28:31], a[64:67], v[44:47], v[28:31]
    s_add_u32 s90, s90, 65536
    ds_read_b128 v[60:63], v2 offset:20480
    s_add_u32 s46, s46, 2048
    v_mfma_f32_16x16x32_bf16 v[36:39], a[64:67], v[48:51], v[36:39]
    s_and_b32 s44, s90, 0xffffffff
    v_mfma_f32_16x16x32_bf16 v[40:43], a[68:71], v[48:51], v[40:43]
    ds_read_b128 v[64:67], v2 offset:21504
    buffer_load_dword v136, v4, s[16:19], s45 offen sc1
    v_mfma_f32_16x16x32_bf16 v[32:35], a[68:71], v[44:47], v[32:35]
    s_waitcnt lgkmcnt(2)
    v_mfma_f32_16x16x32_bf16 v[28:31], a[72:75], v[52:55], v[28:31]
    ds_read_b128 v[68:71], v2 offset:22528
    v_mfma_f32_16x16x32_bf16 v[36:39], a[72:75], v[56:59], v[36:39]
    v_mfma_f32_16x16x32_bf16 v[40:43], a[76:79], v[56:59], v[40:43]
    ds_read_b128 v[72:75], v2 offset:23552
    v_mfma_f32_16x16x32_bf16 v[32:35], a[76:79], v[52:55], v[32:35]
    s_waitcnt lgkmcnt(2)
    v_mfma_f32_16x16x32_bf16 v[28:31], a[80:83], v[60:63], v[28:31]
    s_waitcnt vmcnt(12)
    ds_read_b128 v[44:47], v2 offset:24576
    s_barrier
    v_mfma_f32_16x16x32_bf16 v[36:39], a[80:83], v[64:67], v[36:39]
    buffer_store_dword v124, v124, s[16:19], s91 offen sc1
    v_mfma_f32_16x16x32_bf16 v[40:43], a[84:87], v[64:67], v[40:43]
    s_add_u32 s91, s91, 65536
    ds_read_b128 v[48:51], v2 offset:25600
    v_mfma_f32_16x16x32_bf16 v[32:35], a[84:87], v[60:63], v[32:35]
    s_waitcnt lgkmcnt(2)
    v_mfma_f32_16x16x32_bf16 v[28:31], a[88:91], v[68:71], v[28:31]
    ds_read_b128 v[52:55], v2 offset:26624
    v_mfma_f32_16x16x32_bf16 v[36:39], a[88:91], v[72:75], v[36:39]
    v_mfma_f32_16x16x32_bf16 v[40:43], a[92:95], v[72:75], v[40:43]
    ds_read_b128 v[56:59], v2 offset:27648
    v_mfma_f32_16x16x32_bf16 v[32:35], a[92:95], v[68:71], v[32:35]
    s_waitcnt lgkmcnt(2)
    v_mfma_f32_16x16x32_bf16 v[28:31], a[96:99], v[44:47], v[28:31]
    ds_read_b128 v[60:63], v2 offset:28672
    v_mfma_f32_16x16x32_bf16 v[36:39], a[96:99], v[48:51], v[36:39]
    v_mfma_f32_16x16x32_bf16 v[40:43], a[100:103], v[48:51], v[40:43]
    ds_read_b128 v[64:67], v2 offset:29696
    v_mfma_f32_16x16x32_bf16 v[32:35], a[100:103], v[44:47], v[32:35]
    s_waitcnt lgkmcnt(2)
    v_mfma_f32_16x16x32_bf16 v[28:31], a[104:107], v[52:55], v[28:31]
    ds_read_b128 v[68:71], v2 offset:30720
    v_mfma_f32_16x16x32_bf16 v[36:39], a[104:107], v[56:59], v[36:39]
    v_mfma_f32_16x16x32_bf16 v[40:43], a[108:111], v[56:59], v[40:43]
    ds_read_b128 v[72:75], v2 offset:31744
    v_mfma_f32_16x16x32_bf16 v[32:35], a[108:111], v[52:55], v[32:35]
    s_waitcnt vmcnt(9) lgkmcnt(2)
    s_barrier
    v_mfma_f32_16x16x32_bf16 v[28:31], a[112:115], v[60:63], v[28:31]
    ds_read_b128 v[44:47], v2 offset:32768
    v_mfma_f32_16x16x32_bf16 v[36:39], a[112:115], v[64:67], v[36:39]
    v_mfma_f32_16x16x32_bf16 v[40:43], a[116:119], v[64:67], v[40:43]
    ds_read_b128 v[48:51], v2 offset:33792
    v_mfma_f32_16x16x32_bf16 v[32:35], a[116:119], v[60:63], v[32:35]
    s_waitcnt lgkmcnt(2)
    v_mfma_f32_16x16x32_bf16 v[28:31], a[120:123], v[68:71], v[28:31]
    ds_read_b128 v[52:55], v2 offset:34816
    v_mfma_f32_16x16x32_bf16 v[36:39], a[120:123], v[72:75], v[36:39]
    v_mfma_f32_16x16x32_bf16 v[40:43], a[124:127], v[72:75], v[40:43]
    ds_read_b128 v[56:59], v2 offset:35840
    v_mfma_f32_16x16x32_bf16 v[32:35], a[124:127], v[68:71], v[32:35]
    s_waitcnt lgkmcnt(2)
    v_mfma_f32_16x16x32_bf16 v[28:31], a[128:131], v[44:47], v[28:31]
    ds_read_b128 v[60:63], v2 offset:36864
    v_mfma_f32_16x16x32_bf16 v[36:39], a[128:131], v[48:51], v[36:39]
    v_mfma_f32_16x16x32_bf16 v[40:43], a[132:135], v[48:51], v[40:43]
    ds_read_b128 v[64:67], v2 offset:37888
    v_mfma_f32_16x16x32_bf16 v[32:35], a[132:135], v[44:47], v[32:35]
    s_waitcnt lgkmcnt(2)
    v_mfma_f32_16x16x32_bf16 v[28:31], a[136:139], v[52:55], v[28:31]
    ds_read_b128 v[68:71], v2 offset:38912
    v_mfma_f32_16x16x32_bf16 v[36:39], a[136:139], v[56:59], v[36:39]
    v_mfma_f32_16x16x32_bf16 v[40:43], a[140:143], v[56:59], v[40:43]
    ds_read_b128 v[72:75], v2 offset:39936
    v_mfma_f32_16x16x32_bf16 v[32:35], a[140:143], v[52:55], v[32:35]
    s_waitcnt lgkmcnt(2)
    v_mfma_f32_16x16x32_bf16 v[28:31], a[144:147], v[60:63], v[28:31]
    ds_read_b128 v[44:47], v2 offset:40960
    v_mfma_f32_16x16x32_bf16 v[36:39], a[144:147], v[64:67], v[36:39]
    v_mfma_f32_16x16x32_bf16 v[40:43], a[148:151], v[64:67], v[40:43]
    ds_read_b128 v[48:51], v2 offset:41984
    v_mfma_f32_16x16x32_bf16 v[32:35], a[148:151], v[60:63], v[32:35]
    s_waitcnt lgkmcnt(2)
    v_mfma_f32_16x16x32_bf16 v[28:31], a[152:155], v[68:71], v[28:31]
    ds_read_b128 v[52:55], v2 offset:43008
    v_mfma_f32_16x16x32_bf16 v[36:39], a[152:155], v[72:75], v[36:39]
    v_mfma_f32_16x16x32_bf16 v[40:43], a[156:159], v[72:75], v[40:43]
    ds_read_b128 v[56:59], v2 offset:44032
    v_mfma_f32_16x16x32_bf16 v[32:35], a[156:159], v[68:71], v[32:35]
    s_waitcnt lgkmcnt(2)
    v_mfma_f32_16x16x32_bf16 v[28:31], a[160:163], v[44:47], v[28:31]
    ds_read_b128 v[60:63], v2 offset:45056
    v_mfma_f32_16x16x32_bf16 v[36:39], a[160:163], v[48:51], v[36:39]
    v_mfma_f32_16x16x32_bf16 v[40:43], a[164:167], v[48:51], v[40:43]
    ds_read_b128 v[64:67], v2 offset:46080
    v_mfma_f32_16x16x32_bf16 v[32:35], a[164:167], v[44:47], v[32:35]
    s_waitcnt lgkmcnt(2)
    v_mfma_f32_16x16x32_bf16 v[28:31], a[168:171], v[52:55], v[28:31]
    ds_read_b128 v[68:71], v2 offset:47104
    v_mfma_f32_16x16x32_bf16 v[36:39], a[168:171], v[56:59], v[36:39]
    v_mfma_f32_16x16x32_bf16 v[40:43], a[172:175], v[56:59], v[40:43]
    ds_read_b128 v[72:75], v2 offset:48128
    v_mfma_f32_16x16x32_bf16 v[32:35], a[172:175], v[52:55], v[32:35]
    s_waitcnt vmcnt(4) lgkmcnt(2)
    s_barrier
    v_mfma_f32_16x16x32_bf16 v[28:31], a[176:179], v[60:63], v[28:31]
    ds_read_b128 v[44:47], v2 offset:49152
    v_mfma_f32_16x16x32_bf16 v[36:39], a[176:179], v[64:67], v[36:39]
    v_mfma_f32_16x16x32_bf16 v[40:43], a[180:183], v[64:67], v[40:43]
    ds_read_b128 v[48:51], v2 offset:50176
    v_mfma_f32_16x16x32_bf16 v[32:35], a[180:183], v[60:63], v[32:35]
    s_waitcnt lgkmcnt(2)
    v_mfma_f32_16x16x32_bf16 v[28:31], a[184:187], v[68:71], v[28:31]
    s_waitcnt vmcnt(1)
    ds_read_b128 v[52:55], v2 offset:51200
    v_cmp_ne_u32 vcc, 0, v136
    v_mfma_f32_16x16x32_bf16 v[36:39], a[184:187], v[72:75], v[36:39]
    v_mfma_f32_16x16x32_bf16 v[40:43], a[188:191], v[72:75], v[40:43]
    s_cbranch_vccnz L_spin40
L_back41:
    ds_read_b128 v[56:59], v2 offset:52224
    s_barrier
    v_mfma_f32_16x16x32_bf16 v[32:35], a[188:191], v[68:71], v[32:35]
    s_waitcnt lgkmcnt(2)
    s_add_u32 s45, s45, 65536
    buffer_load_dwordx4 v1, s[16:19], s42 offen offset:0 sc1 lds
    v_mfma_f32_16x16x32_bf16 v[28:31], a[192:195], v[44:47], v[28:31]
    s_waitcnt vmcnt(3)
    ds_read_b128 v[60:63], v2 offset:53248
    v_mfma_f32_16x16x32_bf16 v[12:15], v[108:111], v[128:131], 0
    v_mfma_f32_16x16x32_bf16 v[16:19], v[112:115], v[128:131], 0
    v_mfma_f32_16x16x32_bf16 v[20:23], v[108:111], v[132:135], 0
    v_mfma_f32_16x16x32_bf16 v[24:27], v[112:115], v[132:135], 0
    v_mfma_f32_16x16x32_bf16 v[36:39], a[192:195], v[48:51], v[36:39]
    v_mfma_f32_16x16x32_bf16 v[40:43], a[196:199], v[48:51], v[40:43]
    ds_read_b128 v[64:67], v2 offset:54272
    v_mfma_f32_16x16x32_bf16 v[32:35], a[196:199], v[44:47], v[32:35]
    s_waitcnt lgkmcnt(2)
    buffer_load_dwordx4 v1, s[16:19], s42 offen offset:1024 sc1 lds
    v_mfma_f32_16x16x32_bf16 v[28:31], a[200:203], v[52:55], v[28:31]
    ds_read_b128 v[68:71], v2 offset:55296
    v_mfma_f32_16x16x32_bf16 v[36:39], a[200:203], v[56:59], v[36:39]
    v_mfma_f32_16x16x32_bf16 v[40:43], a[204:207], v[56:59], v[40:43]
    ds_read_b128 v[72:75], v2 offset:56320
    v_mfma_f32_16x16x32_bf16 v[32:35], a[204:207], v[52:55], v[32:35]
    s_waitcnt lgkmcnt(2)
    buffer_load_dwordx4 v1, s[16:19], s42 offen offset:2048 sc1 lds
    v_mfma_f32_16x16x32_bf16 v[28:31], a[208:211], v[60:63], v[28:31]
    ds_read_b128 v[44:47], v2 offset:57344
    v_mfma_f32_16x16x32_bf16 v[36:39], a[208:211], v[64:67], v[36:39]
    v_mfma_f32_16x16x32_bf16 v[40:43], a[212:215], v[64:67], v[40:43]
    ds_read_b128 v[48:51], v2 offset:58368
    v_mfma_f32_16x16x32_bf16 v[32:35], a[212:215], v[60:63], v[32:35]
    s_waitcnt lgkmcnt(2)
    buffer_load_dwordx4 v1, s[16:19], s42 offen offset:3072 sc1 lds
    v_mfma_f32_16x16x32_bf16 v[28:31], a[216:219], v[68:71], v[28:31]
    s_add_u32 m0, s43, 16384
    ds_read_b128 v[52:55], v2 offset:59392
    s_add_u32 s42, s41, 16384
    v_mfma_f32_16x16x32_bf16 v[36:39], a[216:219], v[72:75], v[36:39]
    v_mfma_f32_16x16x32_bf16 v[40:43], a[220:223], v[72:75], v[40:43]
    ds_read_b128 v[56:59], v2 offset:60416
    v_mfma_f32_16x16x32_bf16 v[32:35], a[220:223], v[68:71], v[32:35]
    s_waitcnt lgkmcnt(2)
    buffer_load_dwordx4 v1, s[16:19], s42 offen offset:0 sc1 lds
    v_mfma_f32_16x16x32_bf16 v[28:31], a[224:227], v[44:47], v[28:31]
    ds_read_b128 v[60:63], v2 offset:61440
    v_mfma_f32_16x16x32_bf16 v[36:39], a[224:227], v[48:51], v[36:39]
    v_mfma_f32_16x16x32_bf16 v[40:43], a[228:231], v[48:51], v[40:43]
    ds_read_b128 v[64:67], v2 offset:62464
    v_mfma_f32_16x16x32_bf16 v[32:35], a[228:231], v[44:47], v[32:35]
    s_waitcnt lgkmcnt(2)
    buffer_load_dwordx4 v1, s[16:19], s42 offen offset:1024 sc1 lds
    v_mfma_f32_16x16x32_bf16 v[28:31], a[232:235], v[52:55], v[28:31]
    ds_read_b128 v[68:71], v2 offset:63488
    v_mfma_f32_16x16x32_bf16 v[36:39], a[232:235], v[56:59], v[36:39]
    v_mfma_f32_16x16x32_bf16 v[40:43], a[236:239], v[56:59], v[40:43]
    ds_read_b128 v[72:75], v2 offset:64512
    v_mfma_f32_16x16x32_bf16 v[32:35], a[236:239], v[52:55], v[32:35]
    s_waitcnt lgkmcnt(2)
    buffer_load_dwordx4 v1, s[16:19], s42 offen offset:2048 sc1 lds
    v_mfma_f32_16x16x32_bf16 v[28:31], a[240:243], v[60:63], v[28:31]
    v_mfma_f32_16x16x32_bf16 v[36:39], a[240:243], v[64:67], v[36:39]
    v_mfma_f32_16x16x32_bf16 v[40:43], a[244:247], v[64:67], v[40:43]
    v_mfma_f32_16x16x32_bf16 v[32:35], a[244:247], v[60:63], v[32:35]
    s_waitcnt lgkmcnt(0)
    buffer_load_dwordx4 v1, s[16:19], s42 offen offset:3072 sc1 lds
    v_mfma_f32_16x16x32_bf16 v[28:31], a[248:251], v[68:71], v[28:31]
    v_mfma_f32_16x16x32_bf16 v[36:39], a[248:251], v[72:75], v[36:39]
    v_mfma_f32_16x16x32_bf16 v[40:43], a[252:255], v[72:75], v[40:43]
    v_mfma_f32_16x16x32_bf16 v[32:35], a[252:255], v[68:71], v[32:35]
    s_nop 1
    v_cvt_pk_bf16_f32 v148, v28, v29
    v_cvt_pk_bf16_f32 v149, v30, v31
    s_nop 3
    v_cvt_pk_bf16_f32 v150, v32, v33
    v_cvt_pk_bf16_f32 v151, v34, v35
    buffer_store_dwordx4 v[148:151], v1, s[16:19], s44 offen offset:0 sc1
    v_cvt_pk_bf16_f32 v152, v36, v37
    v_cvt_pk_bf16_f32 v153, v38, v39
    v_cvt_pk_bf16_f32 v154, v40, v41
    v_cvt_pk_bf16_f32 v155, v42, v43
    buffer_store_dwordx4 v[152:155], v1, s[16:19], s44 offen offset:1024 sc1
    s_add_u32 m0, s43, 32768
    s_add_u32 s42, s41, 32768
    v_add_f32 v140, v28, v29
    v_add_f32 v144, v36, v37
    v_mul_f32 v141, v28, v28
    v_mul_f32 v145, v36, v36
    buffer_load_dwordx4 v1, s[16:19], s42 offen offset:0 sc1 lds
    v_fmac_f32 v141, v29, v29
    v_fmac_f32 v145, v37, v37
    v_add_f32 v140, v140, v30
    v_add_f32 v144, v144, v38
    v_fmac_f32 v141, v30, v30
    v_fmac_f32 v145, v38, v38
    v_add_f32 v140, v140, v31
    v_add_f32 v144, v144, v39
    buffer_load_dwordx4 v1, s[16:19], s42 offen offset:1024 sc1 lds
    v_fmac_f32 v141, v31, v31
    v_fmac_f32 v145, v39, v39
    v_add_f32 v140, v140, v32
    v_add_f32 v144, v144, v40
    v_fmac_f32 v141, v32, v32
    v_fmac_f32 v145, v40, v40
    v_add_f32 v140, v140, v33
    v_add_f32 v144, v144, v41
    buffer_load_dwordx4 v1, s[16:19], s42 offen offset:2048 sc1 lds
    v_fmac_f32 v141, v33, v33
    v_fmac_f32 v145, v41, v41
    v_add_f32 v140, v140, v34
    v_add_f32 v144, v144, v42
    v_fmac_f32 v141, v34, v34
    v_fmac_f32 v145, v42, v42
    v_add_f32 v140, v140, v35
    v_add_f32 v144, v144, v43
    buffer_load_dwordx4 v1, s[16:19], s42 offen offset:3072 sc1 lds
    v_fmac_f32 v141, v35, v35
    v_fmac_f32 v145, v43, v43
    s_nop 0
    v_permlane16_swap_b32 v140, v141
    v_permlane16_swap_b32 v144, v145
    v_add_f32 v140, v140, v141
    v_add_f32 v144, v144, v145
    v_mov_b32 v142, v140
    v_mov_b32 v146, v144
    s_nop 0
    v_permlane32_swap_b32 v140, v142
    v_permlane32_swap_b32 v144, v146
    v_add_f32 v140, v140, v142
    v_add_f32 v144, v144, v146
    ds_write_b32 v6, v140 offset:0
    ds_write_b32 v6, v144 offset:512
    s_waitcnt vmcnt(10) lgkmcnt(0)
    s_barrier
    ds_read_b128 v[44:47], v1 offset:0
    ds_read_b128 v[48:51], v1 offset:1024
    ds_read_b128 v[52:55], v1 offset:2048
    ds_read_b128 v[56:59], v1 offset:3072
    s_add_u32 s36, s36, 1
    s_cmp_lt_u32 s36, 32
    s_cbranch_scc1 L_o_b0
    s_nop 7
    ds_read_b128 v[140:143], v7
    s_cmp_eq_u32 s36, 0
    s_cselect_b32 s49, 0x5e00000, s46
    s_waitcnt lgkmcnt(0)
    v_add_f32 v140, v140, v141
    v_add_f32 v142, v142, v143
    v_add_f32 v140, v140, v142
    v_min_u32 v140, -2, v140
    buffer_store_dword v140, v8, s[16:19], s49 offen sc1
    s_waitcnt vmcnt(5)
    s_barrier
    buffer_store_dword v124, v124, s[16:19], s91 offen sc1
    s_add_u32 s91, s91, 65536
    s_waitcnt vmcnt(0)
    s_endpgm
L_vspin26:
    s_mov_b32 s40, 0x20000
L_vspin26_l:
    s_cmp_lg_u32 s37, 0
    s_cbranch_scc1 L_restart
    s_sleep 4
    buffer_load_dword v8, v124, s[20:23], 0 offen offset:32 sc1
    s_waitcnt vmcnt(0)
    v_readfirstlane_b32 s37, v8
    s_sub_u32 s40, s40, 1
    s_cbranch_scc1 L_vback27
    s_cmp_lg_u32 s37, s3
    s_cbranch_scc1 L_vspin26_l
    s_branch L_vback27
L_vspin28:
    s_mov_b32 s40, 0x20000
L_vspin28_l:
    s_cmp_lg_u32 s37, 0
    s_cbranch_scc1 L_restart
    s_sleep 4
    buffer_load_dword v8, v124, s[20:23], 0 offen offset:32 sc1
    s_waitcnt vmcnt(0)
    v_readfirstlane_b32 s37, v8
    s_sub_u32 s40, s40, 1
    s_cbranch_scc1 L_vback29
    s_cmp_lg_u32 s37, s3
    s_cbranch_scc1 L_vspin28_l
    s_branch L_vback29
L_vspin31:
    s_mov_b32 s40, 0x20000
L_vspin31_l:
    s_cmp_lg_u32 s37, 0
    s_cbranch_scc1 L_restart
    s_sleep 4
    buffer_load_dword v12, v124, s[20:23], 0 offen offset:32 sc1
    s_waitcnt vmcnt(0)
    v_readfirstlane_b32 s37, v12
    s_sub_u32 s40, s40, 1
    s_cbranch_scc1 L_vback32
    s_cmp_lg_u32 s37, s3
    s_cbranch_scc1 L_vspin31_l
    s_branch L_vback32
L_spin34:
    s_mov_b32 s40, 0x20000
L_spin34_l:
    buffer_load_dword v12, v124, s[20:23], 0 offen sc1
    s_sub_u32 s40, s40, 1
    s_waitcnt vmcnt(0)
    v_cmp_eq_u32 vcc, v124, v12
    s_cbranch_scc1 L_back35
    s_cbranch_vccz L_back35
    s_sleep 8
    s_branch L_spin34_l
L_spin36:
    s_mov_b32 s40, 0x20000
L_spin36_l:
    buffer_load_dword v136, v4, s[16:19], s45 offen sc1
    s_sub_u32 s40, s40, 1
    s_waitcnt vmcnt(0)
    v_cmp_ne_u32 vcc, 0, v136
    s_cbranch_scc1 L_back37
    s_cbranch_vccz L_back37
    s_sleep 2
    s_branch L_spin36_l
L_spin38:
    s_mov_b32 s40, 0x20000
L_spin38_l:
    buffer_load_dword v136, v4, s[16:19], s45 offen sc1
    s_sub_u32 s40, s40, 1
    s_waitcnt vmcnt(0)
    v_cmp_ne_u32 vcc, 0, v136
    s_cbranch_scc1 L_back39
    s_cbranch_vccz L_back39
    s_sleep 2
    s_branch L_spin38_l
L_spin40:
    s_mov_b32 s40, 0x20000
L_spin40_l:
    buffer_load_dword v136, v4, s[16:19], s45 offen sc1
    s_sub_u32 s40, s40, 1
    s_waitcnt vmcnt(0)
    v_cmp_ne_u32 vcc, 0, v136
    s_cbranch_scc1 L_back41
    s_cbranch_vccz L_back41
    s_sleep 2
    s_branch L_spin40_l
L_role_40:
    s_sub_u32 s35, s34, 40
    s_lshl_b32 s51, s35, 2
    s_add_u32 s51, s51, 96
    s_lshl_b32 s54, s51, 6
    s_mov_b32 s12, s72
    s_mov_b32 s13, s73
    s_mov_b32 s14, 0x700000
    s_mov_b32 s15, 0x00020000
    s_mov_b32 s39, 7168
    v_lshrrev_b32 v64, 3, v0
    v_lshlrev_b32 v65, 2, v0
    v_and_b32 v65, 64, v65
    v_and_b32 v66, 0x70, v1
    v_xor_b32 v65, v65, v66
    v_mad_u32_u24 v56, v64, s39, v65
    v_add_u32 v57, 57344, v56
    v_add_u32 v58, 128, v56
    v_add_u32 v59, 57472, v56
    s_mul_i32 s38, s32, 114688
    s_add_u32 s54, s54, s38
    s_lshl_b32 s42, s32, 11
    s_add_u32 m0, s42, 0
    s_nop 0
    buffer_load_dwordx4 v56, s[12:15], s54 offen lds
    s_add_u32 m0, s42, 1024
    s_nop 0
    buffer_load_dwordx4 v57, s[12:15], s54 offen lds
    s_add_u32 m0, s42, 8192
    s_nop 0
    buffer_load_dwordx4 v58, s[12:15], s54 offen lds
    s_add_u32 m0, s42, 9216
    s_nop 0
    buffer_load_dwordx4 v59, s[12:15], s54 offen lds
    s_add_u32 s54, s54, 458752
    s_add_u32 m0, s42, 16384
    s_nop 0
    buffer_load_dwordx4 v56, s[12:15], s54 offen lds
    s_add_u32 m0, s42, 17408
    s_nop 0
    buffer_load_dwordx4 v57, s[12:15], s54 offen lds
    s_add_u32 m0, s42, 24576
    s_nop 0
    buffer_load_dwordx4 v58, s[12:15], s54 offen lds
    s_add_u32 m0, s42, 25600
    s_nop 0
    buffer_load_dwordx4 v59, s[12:15], s54 offen lds
    s_add_u32 s54, s54, 458752
    s_add_u32 m0, s42, 32768
    s_nop 0
    buffer_load_dwordx4 v56, s[12:15], s54 offen lds
    s_add_u32 m0, s42, 33792
    s_nop 0
    buffer_load_dwordx4 v57, s[12:15], s54 offen lds
    s_add_u32 m0, s42, 40960
    s_nop 0
    buffer_load_dwordx4 v58, s[12:15], s54 offen lds
    s_add_u32 m0, s42, 41984
    s_nop 0
    buffer_load_dwordx4 v59, s[12:15], s54 offen lds
    s_add_u32 s54, s54, 458752
    s_add_u32 m0, s42, 49152
    s_nop 0
    buffer_load_dwordx4 v56, s[12:15], s54 offen lds
    s_add_u32 m0, s42, 50176
    s_nop 0
    buffer_load_dwordx4 v57, s[12:15], s54 offen lds
    s_add_u32 m0, s42, 57344
    s_nop 0
    buffer_load_dwordx4 v58, s[12:15], s54 offen lds
    s_add_u32 m0, s42, 58368
    s_nop 0
    buffer_load_dwordx4 v59, s[12:15], s54 offen lds
    s_add_u32 s54, s54, 458752
    s_add_u32 m0, s42, 65536
    s_nop 0
    buffer_load_dwordx4 v56, s[12:15], s54 offen lds
    s_add_u32 m0, s42, 66560
    s_nop 0
    buffer_load_dwordx4 v57, s[12:15], s54 offen lds
    s_add_u32 m0, s42, 73728
    s_nop 0
    buffer_load_dwordx4 v58, s[12:15], s54 offen lds
    s_add_u32 m0, s42, 74752
    s_nop 0
    buffer_load_dwordx4 v59, s[12:15], s54 offen lds
    s_add_u32 s54, s54, 458752
    v_lshrrev_b32 v64, 4, v0
    v_bfe_u32 v65, v0, 2, 2
    v_lshl_add_u32 v64, v64, 3, v65
    v_lshlrev_b32 v64, 7, v64
    v_lshrrev_b32 v65, 1, v65
    v_lshl_add_u32 v64, v65, 6, v64
    v_and_b32 v65, 3, v0
    v_lshl_add_u32 v64, v65, 4, v64
    s_lshr_b32 s37, s32, 1
    s_lshl_b32 s37, s37, 13
    s_and_b32 s38, s32, 1
    s_lshl_b32 s38, s38, 6
    s_add_u32 s37, s37, s38
    s_add_u32 s37, s37, 0
    v_xor_b32 v60, s37, v64
    s_lshr_b32 s37, s32, 1
    s_lshl_b32 s37, s37, 13
    s_and_b32 s38, s32, 1
    s_lshl_b32 s38, s38, 6
    s_add_u32 s37, s37, s38
    s_add_u32 s37, s37, 8
    v_xor_b32 v61, s37, v64
    v_mov_b32 v64, 0x3f803f80
    v_mov_b32 v65, 0x3f803f80
    v_mov_b32 v66, 0x3f803f80
    v_mov_b32 v67, 0x3f803f80
    v_add_u32 v2, 98304, v1
    s_lshl_b32 s37, s33, 6
    s_add_u32 s37, s37, 16
    s_lshl_b32 s37, s37, 7
    v_lshl_add_u32 v5, v0, 7, s37
    s_cmp_eq_u32 s32, 0
    s_cselect_b32 s37, 8, 0
    v_cmp_le_u32 vcc, s37, v0
    s_nop 1
    v_cndmask_b32 v5, v5, 2.0, vcc
    s_lshl_b32 s43, s32, 12
    s_mul_i32 s41, s33, 2097152
    s_add_u32 s41, s41, 0x800000
    s_add_u32 s41, s41, s43
    s_mul_i32 s90, s33, 8388608
    s_add_u32 s90, s90, 0xfc0000
    s_add_u32 s37, s51, s32
    s_lshl_b32 s37, s37, 11
    s_add_u32 s90, s90, s37
    s_lshl_b32 s37, s32, 10
    s_sub_u32 s87, 8192, s37
    s_lshl_b32 s38, s35, 1
    s_lshr_b32 s39, s32, 1
    s_add_u32 s38, s38, s39
    s_cmp_eq_u32 s38, 36
    s_cselect_b32 s88, 0x5e00000, 0
    s_and_b32 s38, s32, 1
    s_lshl_b32 s38, s38, 3
    s_and_b32 s39, s32, 2
    s_lshl_b32 s39, s39, 10
    s_add_u32 s38, s38, s39
    s_add_u32 s38, s38, 65536
    v_add_u32 v3, s38, v1
    s_add_u32 s37, s37, 65536
    v_add_u32 v4, s37, v1
    v_and_b32 v6, 15, v0
    v_lshlrev_b32 v6, 3, v6
    v_lshrrev_b32 v8, 5, v0
    v_lshl_add_u32 v6, v8, 9, v6
    v_and_b32 v8, 16, v0
    v_lshl_add_u32 v6, v8, 6, v6
    v_add_u32 v118, 73728, v6
    s_mul_i32 s46, s33, 65536
    s_add_u32 s46, s46, 0x5440000
    s_add_u32 s55, s46, 63488
    s_and_b32 s52, s32, 1
    s_lshl_b32 s52, s52, 10
    s_mov_b32 s8, s74
    s_mov_b32 s9, s75
    s_mov_b32 s10, 0x1c00
    s_mov_b32 s11, 0x00020000
    v_and_b32 v8, 0x30, v0
    s_add_u32 s37, s51, s32
    s_lshl_b32 s37, s37, 6
    buffer_load_dwordx4 v[16:19], v8, s[8:11], s37 offen
    s_lshr_b32 s37, s32, 1
    s_add_u32 s37, s37, s51
    s_lshl_b32 s37, s37, 6
    s_and_b32 s38, s32, 1
    s_lshl_b32 s38, s38, 3
    s_add_u32 s37, s37, s38
    buffer_load_dwordx2 v[20:21], v8, s[8:11], s37 offen offset:256
    v_add_u32 v62, 0, v60
    v_add_u32 v63, 0, v61
    s_waitcnt vmcnt(18)
    s_barrier
    ds_read_b64_tr_b16 a[0:1], v62 offset:0
    ds_read_b64_tr_b16 a[2:3], v62 offset:512
    ds_read_b64_tr_b16 a[4:5], v63 offset:0
    ds_read_b64_tr_b16 a[6:7], v63 offset:512
    ds_read_b64_tr_b16 a[8:9], v62 offset:4096
    ds_read_b64_tr_b16 a[10:11], v62 offset:4608
    ds_read_b64_tr_b16 a[12:13], v63 offset:4096
    ds_read_b64_tr_b16 a[14:15], v63 offset:4608
    s_add_u32 m0, s42, 81920
    s_nop 0
    buffer_load_dwordx4 v56, s[12:15], s54 offen lds
    s_add_u32 m0, s42, 82944
    s_nop 0
    buffer_load_dwordx4 v57, s[12:15], s54 offen lds
    s_add_u32 m0, s42, 90112
    s_nop 0
    buffer_load_dwordx4 v58, s[12:15], s54 offen lds
    s_add_u32 m0, s42, 91136
    s_nop 0
    buffer_load_dwordx4 v59, s[12:15], s54 offen lds
    s_add_u32 s54, s54, 458752
    s_waitcnt lgkmcnt(0)
    v_mfma_f32_16x16x32_bf16 v[88:91], a[0:3], v[64:67], 0
    v_mfma_f32_16x16x32_bf16 v[92:95], a[4:7], v[64:67], 0
    v_mfma_f32_16x16x32_bf16 v[88:91], a[8:11], v[64:67], v[88:91]
    v_mfma_f32_16x16x32_bf16 v[92:95], a[12:15], v[64:67], v[92:95]
    v_add_u32 v62, 16384, v60
    v_add_u32 v63, 16384, v61
    s_waitcnt vmcnt(18)
    s_barrier
    ds_read_b64_tr_b16 a[16:17], v62 offset:0
    ds_read_b64_tr_b16 a[18:19], v62 offset:512
    ds_read_b64_tr_b16 a[20:21], v63 offset:0
    ds_read_b64_tr_b16 a[22:23], v63 offset:512
    ds_read_b64_tr_b16 a[24:25], v62 offset:4096
    ds_read_b64_tr_b16 a[26:27], v62 offset:4608
    ds_read_b64_tr_b16 a[28:29], v63 offset:4096
    ds_read_b64_tr_b16 a[30:31], v63 offset:4608
    s_add_u32 m0, s42, 0
    s_nop 0
    buffer_load_dwordx4 v56, s[12:15], s54 offen lds
    s_add_u32 m0, s42, 1024
    s_nop 0
    buffer_load_dwordx4 v57, s[12:15], s54 offen lds
    s_add_u32 m0, s42, 8192
    s_nop 0
    buffer_load_dwordx4 v58, s[12:15], s54 offen lds
    s_add_u32 m0, s42, 9216
    s_nop 0
    buffer_load_dwordx4 v59, s[12:15], s54 offen lds
    s_add_u32 s54, s54, 458752
    s_waitcnt lgkmcnt(0)
    v_mfma_f32_16x16x32_bf16 v[88:91], a[16:19], v[64:67], v[88:91]
    v_mfma_f32_16x16x32_bf16 v[92:95], a[20:23], v[64:67], v[92:95]
    v_mfma_f32_16x16x32_bf16 v[88:91], a[24:27], v[64:67], v[88:91]
    v_mfma_f32_16x16x32_bf16 v[92:95], a[28:31], v[64:67], v[92:95]
    v_add_u32 v62, 32768, v60
    v_add_u32 v63, 32768, v61
    s_waitcnt vmcnt(18)
    s_barrier
    ds_read_b64_tr_b16 a[32:33], v62 offset:0
    ds_read_b64_tr_b16 a[34:35], v62 offset:512
    ds_read_b64_tr_b16 a[36:37], v63 offset:0
    ds_read_b64_tr_b16 a[38:39], v63 offset:512
    ds_read_b64_tr_b16 a[40:41], v62 offset:4096
    ds_read_b64_tr_b16 a[42:43], v62 offset:4608
    ds_read_b64_tr_b16 a[44:45], v63 offset:4096
    ds_read_b64_tr_b16 a[46:47], v63 offset:4608
    s_add_u32 m0, s42, 16384
    s_nop 0
    buffer_load_dwordx4 v56, s[12:15], s54 offen lds
    s_add_u32 m0, s42, 17408
    s_nop 0
    buffer_load_dwordx4 v57, s[12:15], s54 offen lds
    s_add_u32 m0, s42, 24576
    s_nop 0
    buffer_load_dwordx4 v58, s[12:15], s54 offen lds
    s_add_u32 m0, s42, 25600
    s_nop 0
    buffer_load_dwordx4 v59, s[12:15], s54 offen lds
    s_add_u32 s54, s54, 458752
    s_waitcnt lgkmcnt(0)
    v_mfma_f32_16x16x32_bf16 v[88:91], a[32:35], v[64:67], v[88:91]
    v_mfma_f32_16x16x32_bf16 v[92:95], a[36:39], v[64:67], v[92:95]
    v_mfma_f32_16x16x32_bf16 v[88:91], a[40:43], v[64:67], v[88:91]
    v_mfma_f32_16x16x32_bf16 v[92:95], a[44:47], v[64:67], v[92:95]
    v_add_u32 v62, 49152, v60
    v_add_u32 v63, 49152, v61
    s_waitcnt vmcnt(18)
    s_barrier
    ds_read_b64_tr_b16 a[48:49], v62 offset:0
    ds_read_b64_tr_b16 a[50:51], v62 offset:512
    ds_read_b64_tr_b16 a[52:53], v63 offset:0
    ds_read_b64_tr_b16 a[54:55], v63 offset:512
    ds_read_b64_tr_b16 a[56:57], v62 offset:4096
    ds_read_b64_tr_b16 a[58:59], v62 offset:4608
    ds_read_b64_tr_b16 a[60:61], v63 offset:4096
    ds_read_b64_tr_b16 a[62:63], v63 offset:4608
    s_add_u32 m0, s42, 32768
    s_nop 0
    buffer_load_dwordx4 v56, s[12:15], s54 offen lds
    s_add_u32 m0, s42, 33792
    s_nop 0
    buffer_load_dwordx4 v57, s[12:15], s54 offen lds
    s_add_u32 m0, s42, 40960
    s_nop 0
    buffer_load_dwordx4 v58, s[12:15], s54 offen lds
    s_add_u32 m0, s42, 41984
    s_nop 0
    buffer_load_dwordx4 v59, s[12:15], s54 offen lds
    s_add_u32 s54, s54, 458752
    s_waitcnt lgkmcnt(0)
    v_mfma_f32_16x16x32_bf16 v[88:91], a[48:51], v[64:67], v[88:91]
    v_mfma_f32_16x16x32_bf16 v[92:95], a[52:55], v[64:67], v[92:95]
    v_mfma_f32_16x16x32_bf16 v[88:91], a[56:59], v[64:67], v[88:91]
    v_mfma_f32_16x16x32_bf16 v[92:95], a[60:63], v[64:67], v[92:95]
    v_add_u32 v62, 65536, v60
    v_add_u32 v63, 65536, v61
    s_waitcnt vmcnt(18)
    s_barrier
    ds_read_b64_tr_b16 a[64:65], v62 offset:0
    ds_read_b64_tr_b16 a[66:67], v62 offset:512
    ds_read_b64_tr_b16 a[68:69], v63 offset:0
    ds_read_b64_tr_b16 a[70:71], v63 offset:512
    ds_read_b64_tr_b16 a[72:73], v62 offset:4096
    ds_read_b64_tr_b16 a[74:75], v62 offset:4608
    ds_read_b64_tr_b16 a[76:77], v63 offset:4096
    ds_read_b64_tr_b16 a[78:79], v63 offset:4608
    s_add_u32 m0, s42, 49152
    s_nop 0
    buffer_load_dwordx4 v56, s[12:15], s54 offen lds
    s_add_u32 m0, s42, 50176
    s_nop 0
    buffer_load_dwordx4 v57, s[12:15], s54 offen lds
    s_add_u32 m0, s42, 57344
    s_nop 0
    buffer_load_dwordx4 v58, s[12:15], s54 offen lds
    s_add_u32 m0, s42, 58368
    s_nop 0
    buffer_load_dwordx4 v59, s[12:15], s54 offen lds
    s_add_u32 s54, s54, 458752
    s_waitcnt lgkmcnt(0)
    v_mfma_f32_16x16x32_bf16 v[88:91], a[64:67], v[64:67], v[88:91]
    v_mfma_f32_16x16x32_bf16 v[92:95], a[68:71], v[64:67], v[92:95]
    v_mfma_f32_16x16x32_bf16 v[88:91], a[72:75], v[64:67], v[88:91]
    v_mfma_f32_16x16x32_bf16 v[92:95], a[76:79], v[64:67], v[92:95]
    v_add_u32 v62, 81920, v60
    v_add_u32 v63, 81920, v61
    s_waitcnt vmcnt(16)
    s_barrier
    ds_read_b64_tr_b16 a[80:81], v62 offset:0
    ds_read_b64_tr_b16 a[82:83], v62 offset:512
    ds_read_b64_tr_b16 a[84:85], v63 offset:0
    ds_read_b64_tr_b16 a[86:87], v63 offset:512
    ds_read_b64_tr_b16 a[88:89], v62 offset:4096
    ds_read_b64_tr_b16 a[90:91], v62 offset:4608
    ds_read_b64_tr_b16 a[92:93], v63 offset:4096
    ds_read_b64_tr_b16 a[94:95], v63 offset:4608
    s_add_u32 m0, s42, 65536
    s_nop 0
    buffer_load_dwordx4 v56, s[12:15], s54 offen lds
    s_add_u32 m0, s42, 66560
    s_nop 0
    buffer_load_dwordx4 v57, s[12:15], s54 offen lds
    s_add_u32 m0, s42, 73728
    s_nop 0
    buffer_load_dwordx4 v58, s[12:15], s54 offen lds
    s_add_u32 m0, s42, 74752
    s_nop 0
    buffer_load_dwordx4 v59, s[12:15], s54 offen lds
    s_add_u32 s54, s54, 458752
    s_waitcnt lgkmcnt(0)
    v_mfma_f32_16x16x32_bf16 v[88:91], a[80:83], v[64:67], v[88:91]
    v_mfma_f32_16x16x32_bf16 v[92:95], a[84:87], v[64:67], v[92:95]
    v_mfma_f32_16x16x32_bf16 v[88:91], a[88:91], v[64:67], v[88:91]
    v_mfma_f32_16x16x32_bf16 v[92:95], a[92:95], v[64:67], v[92:95]
    v_add_u32 v62, 0, v60
    v_add_u32 v63, 0, v61
    s_waitcnt vmcnt(16)
    s_barrier
    ds_read_b64_tr_b16 a[96:97], v62 offset:0
    ds_read_b64_tr_b16 a[98:99], v62 offset:512
    ds_read_b64_tr_b16 a[100:101], v63 offset:0
    ds_read_b64_tr_b16 a[102:103], v63 offset:512
    ds_read_b64_tr_b16 a[104:105], v62 offset:4096
    ds_read_b64_tr_b16 a[106:107], v62 offset:4608
    ds_read_b64_tr_b16 a[108:109], v63 offset:4096
    ds_read_b64_tr_b16 a[110:111], v63 offset:4608
    s_add_u32 m0, s42, 81920
    s_nop 0
    buffer_load_dwordx4 v56, s[12:15], s54 offen lds
    s_add_u32 m0, s42, 82944
    s_nop 0
    buffer_load_dwordx4 v57, s[12:15], s54 offen lds
    s_add_u32 m0, s42, 90112
    s_nop 0
    buffer_load_dwordx4 v58, s[12:15], s54 offen lds
    s_add_u32 m0, s42, 91136
    s_nop 0
    buffer_load_dwordx4 v59, s[12:15], s54 offen lds
    s_add_u32 s54, s54, 458752
    s_waitcnt lgkmcnt(0)
    v_mfma_f32_16x16x32_bf16 v[88:91], a[96:99], v[64:67], v[88:91]
    v_mfma_f32_16x16x32_bf16 v[92:95], a[100:103], v[64:67], v[92:95]
    v_mfma_f32_16x16x32_bf16 v[88:91], a[104:107], v[64:67], v[88:91]
    v_mfma_f32_16x16x32_bf16 v[92:95], a[108:111], v[64:67], v[92:95]
    v_add_u32 v62, 16384, v60
    v_add_u32 v63, 16384, v61
    s_waitcnt vmcnt(16)
    s_barrier
    ds_read_b64_tr_b16 a[112:113], v62 offset:0
    ds_read_b64_tr_b16 a[114:115], v62 offset:512
    ds_read_b64_tr_b16 a[116:117], v63 offset:0
    ds_read_b64_tr_b16 a[118:119], v63 offset:512
    ds_read_b64_tr_b16 a[120:121], v62 offset:4096
    ds_read_b64_tr_b16 a[122:123], v62 offset:4608
    ds_read_b64_tr_b16 a[124:125], v63 offset:4096
    ds_read_b64_tr_b16 a[126:127], v63 offset:4608
    s_add_u32 m0, s42, 0
    s_nop 0
    buffer_load_dwordx4 v56, s[12:15], s54 offen lds
    s_add_u32 m0, s42, 1024
    s_nop 0
    buffer_load_dwordx4 v57, s[12:15], s54 offen lds
    s_add_u32 m0, s42, 8192
    s_nop 0
    buffer_load_dwordx4 v58, s[12:15], s54 offen lds
    s_add_u32 m0, s42, 9216
    s_nop 0
    buffer_load_dwordx4 v59, s[12:15], s54 offen lds
    s_add_u32 s54, s54, 458752
    s_waitcnt lgkmcnt(0)
    v_mfma_f32_16x16x32_bf16 v[88:91], a[112:115], v[64:67], v[88:91]
    v_mfma_f32_16x16x32_bf16 v[92:95], a[116:119], v[64:67], v[92:95]
    v_mfma_f32_16x16x32_bf16 v[88:91], a[120:123], v[64:67], v[88:91]
    v_mfma_f32_16x16x32_bf16 v[92:95], a[124:127], v[64:67], v[92:95]
    v_add_u32 v62, 32768, v60
    v_add_u32 v63, 32768, v61
    s_waitcnt vmcnt(16)
    s_barrier
    ds_read_b64_tr_b16 a[128:129], v62 offset:0
    ds_read_b64_tr_b16 a[130:131], v62 offset:512
    ds_read_b64_tr_b16 a[132:133], v63 offset:0
    ds_read_b64_tr_b16 a[134:135], v63 offset:512
    ds_read_b64_tr_b16 a[136:137], v62 offset:4096
    ds_read_b64_tr_b16 a[138:139], v62 offset:4608
    ds_read_b64_tr_b16 a[140:141], v63 offset:4096
    ds_read_b64_tr_b16 a[142:143], v63 offset:4608
    s_add_u32 m0, s42, 16384
    s_nop 0
    buffer_load_dwordx4 v56, s[12:15], s54 offen lds
    s_add_u32 m0, s42, 17408
    s_nop 0
    buffer_load_dwordx4 v57, s[12:15], s54 offen lds
    s_add_u32 m0, s42, 24576
    s_nop 0
    buffer_load_dwordx4 v58, s[12:15], s54 offen lds
    s_add_u32 m0, s42, 25600
    s_nop 0
    buffer_load_dwordx4 v59, s[12:15], s54 offen lds
    s_add_u32 s54, s54, 458752
    s_waitcnt lgkmcnt(0)
    v_mfma_f32_16x16x32_bf16 v[88:91], a[128:131], v[64:67], v[88:91]
    v_mfma_f32_16x16x32_bf16 v[92:95], a[132:135], v[64:67], v[92:95]
    v_mfma_f32_16x16x32_bf16 v[88:91], a[136:139], v[64:67], v[88:91]
    v_mfma_f32_16x16x32_bf16 v[92:95], a[140:143], v[64:67], v[92:95]
    v_add_u32 v62, 49152, v60
    v_add_u32 v63, 49152, v61
    s_waitcnt vmcnt(16)
    s_barrier
    ds_read_b64_tr_b16 a[144:145], v62 offset:0
    ds_read_b64_tr_b16 a[146:147], v62 offset:512
    ds_read_b64_tr_b16 a[148:149], v63 offset:0
    ds_read_b64_tr_b16 a[150:151], v63 offset:512
    ds_read_b64_tr_b16 a[152:153], v62 offset:4096
    ds_read_b64_tr_b16 a[154:155], v62 offset:4608
    ds_read_b64_tr_b16 a[156:157], v63 offset:4096
    ds_read_b64_tr_b16 a[158:159], v63 offset:4608
    s_add_u32 m0, s42, 32768
    s_nop 0
    buffer_load_dwordx4 v56, s[12:15], s54 offen lds
    s_add_u32 m0, s42, 33792
    s_nop 0
    buffer_load_dwordx4 v57, s[12:15], s54 offen lds
    s_add_u32 m0, s42, 40960
    s_nop 0
    buffer_load_dwordx4 v58, s[12:15], s54 offen lds
    s_add_u32 m0, s42, 41984
    s_nop 0
    buffer_load_dwordx4 v59, s[12:15], s54 offen lds
    s_add_u32 s54, s54, 458752
    s_waitcnt lgkmcnt(0)
    v_mfma_f32_16x16x32_bf16 v[88:91], a[144:147], v[64:67], v[88:91]
    v_mfma_f32_16x16x32_bf16 v[92:95], a[148:151], v[64:67], v[92:95]
    v_mfma_f32_16x16x32_bf16 v[88:91], a[152:155], v[64:67], v[88:91]
    v_mfma_f32_16x16x32_bf16 v[92:95], a[156:159], v[64:67], v[92:95]
    v_add_u32 v62, 65536, v60
    v_add_u32 v63, 65536, v61
    s_waitcnt vmcnt(16)
    s_barrier
    ds_read_b64_tr_b16 a[160:161], v62 offset:0
    ds_read_b64_tr_b16 a[162:163], v62 offset:512
    ds_read_b64_tr_b16 a[164:165], v63 offset:0
    ds_read_b64_tr_b16 a[166:167], v63 offset:512
    ds_read_b64_tr_b16 a[168:169], v62 offset:4096
    ds_read_b64_tr_b16 a[170:171], v62 offset:4608
    ds_read_b64_tr_b16 a[172:173], v63 offset:4096
    ds_read_b64_tr_b16 a[174:175], v63 offset:4608
    s_add_u32 m0, s42, 49152
    s_nop 0
    buffer_load_dwordx4 v56, s[12:15], s54 offen lds
    s_add_u32 m0, s42, 50176
    s_nop 0
    buffer_load_dwordx4 v57, s[12:15], s54 offen lds
    s_add_u32 m0, s42, 57344
    s_nop 0
    buffer_load_dwordx4 v58, s[12:15], s54 offen lds
    s_add_u32 m0, s42, 58368
    s_nop 0
    buffer_load_dwordx4 v59, s[12:15], s54 offen lds
    s_add_u32 s54, s54, 458752
    s_waitcnt lgkmcnt(0)
    v_mfma_f32_16x16x32_bf16 v[88:91], a[160:163], v[64:67], v[88:91]
    v_mfma_f32_16x16x32_bf16 v[92:95], a[164:167], v[64:67], v[92:95]
    v_mfma_f32_16x16x32_bf16 v[88:91], a[168:171], v[64:67], v[88:91]
    v_mfma_f32_16x16x32_bf16 v[92:95], a[172:175], v[64:67], v[92:95]
    v_add_u32 v62, 81920, v60
    v_add_u32 v63, 81920, v61
    s_waitcnt vmcnt(16)
    s_barrier
    ds_read_b64_tr_b16 a[176:177], v62 offset:0
    ds_read_b64_tr_b16 a[178:179], v62 offset:512
    ds_read_b64_tr_b16 a[180:181], v63 offset:0
    ds_read_b64_tr_b16 a[182:183], v63 offset:512
    ds_read_b64_tr_b16 a[184:185], v62 offset:4096
    ds_read_b64_tr_b16 a[186:187], v62 offset:4608
    ds_read_b64_tr_b16 a[188:189], v63 offset:4096
    ds_read_b64_tr_b16 a[190:191], v63 offset:4608
    s_waitcnt lgkmcnt(0)
    v_mfma_f32_16x16x32_bf16 v[88:91], a[176:179], v[64:67], v[88:91]
    v_mfma_f32_16x16x32_bf16 v[92:95], a[180:183], v[64:67], v[92:95]
    v_mfma_f32_16x16x32_bf16 v[88:91], a[184:187], v[64:67], v[88:91]
    v_mfma_f32_16x16x32_bf16 v[92:95], a[188:191], v[64:67], v[92:95]
    v_add_u32 v62, 0, v60
    v_add_u32 v63, 0, v61
    s_waitcnt vmcnt(12)
    s_barrier
    ds_read_b64_tr_b16 a[192:193], v62 offset:0
    ds_read_b64_tr_b16 a[194:195], v62 offset:512
    ds_read_b64_tr_b16 a[196:197], v63 offset:0
    ds_read_b64_tr_b16 a[198:199], v63 offset:512
    ds_read_b64_tr_b16 a[200:201], v62 offset:4096
    ds_read_b64_tr_b16 a[202:203], v62 offset:4608
    ds_read_b64_tr_b16 a[204:205], v63 offset:4096
    ds_read_b64_tr_b16 a[206:207], v63 offset:4608
    s_waitcnt lgkmcnt(0)
    v_mfma_f32_16x16x32_bf16 v[88:91], a[192:195], v[64:67], v[88:91]
    v_mfma_f32_16x16x32_bf16 v[92:95], a[196:199], v[64:67], v[92:95]
    v_mfma_f32_16x16x32_bf16 v[88:91], a[200:203], v[64:67], v[88:91]
    v_mfma_f32_16x16x32_bf16 v[92:95], a[204:207], v[64:67], v[92:95]
    v_add_u32 v62, 16384, v60
    v_add_u32 v63, 16384, v61
    s_waitcnt vmcnt(8)
    s_barrier
    ds_read_b64_tr_b16 a[208:209], v62 offset:0
    ds_read_b64_tr_b16 a[210:211], v62 offset:512
    ds_read_b64_tr_b16 a[212:213], v63 offset:0
    ds_read_b64_tr_b16 a[214:215], v63 offset:512
    ds_read_b64_tr_b16 a[216:217], v62 offset:4096
    ds_read_b64_tr_b16 a[218:219], v62 offset:4608
    ds_read_b64_tr_b16 a[220:221], v63 offset:4096
    ds_read_b64_tr_b16 a[222:223], v63 offset:4608
    s_waitcnt lgkmcnt(0)
    v_mfma_f32_16x16x32_bf16 v[88:91], a[208:211], v[64:67], v[88:91]
    v_mfma_f32_16x16x32_bf16 v[92:95], a[212:215], v[64:67], v[92:95]
    v_mfma_f32_16x16x32_bf16 v[88:91], a[216:219], v[64:67], v[88:91]
    v_mfma_f32_16x16x32_bf16 v[92:95], a[220:223], v[64:67], v[92:95]
    v_add_u32 v62, 32768, v60
    v_add_u32 v63, 32768, v61
    s_waitcnt vmcnt(4)
    s_barrier
    ds_read_b64_tr_b16 a[224:225], v62 offset:0
    ds_read_b64_tr_b16 a[226:227], v62 offset:512
    ds_read_b64_tr_b16 a[228:229], v63 offset:0
    ds_read_b64_tr_b16 a[230:231], v63 offset:512
    ds_read_b64_tr_b16 a[232:233], v62 offset:4096
    ds_read_b64_tr_b16 a[234:235], v62 offset:4608
    ds_read_b64_tr_b16 a[236:237], v63 offset:4096
    ds_read_b64_tr_b16 a[238:239], v63 offset:4608
    s_waitcnt lgkmcnt(0)
    v_mfma_f32_16x16x32_bf16 v[88:91], a[224:227], v[64:67], v[88:91]
    v_mfma_f32_16x16x32_bf16 v[92:95], a[228:231], v[64:67], v[92:95]
    v_mfma_f32_16x16x32_bf16 v[88:91], a[232:235], v[64:67], v[88:91]
    v_mfma_f32_16x16x32_bf16 v[92:95], a[236:239], v[64:67], v[92:95]
    v_add_u32 v62, 49152, v60
    v_add_u32 v63, 49152, v61
    s_waitcnt vmcnt(0)
    s_barrier
    ds_read_b64_tr_b16 a[240:241], v62 offset:0
    ds_read_b64_tr_b16 a[242:243], v62 offset:512
    ds_read_b64_tr_b16 a[244:245], v63 offset:0
    ds_read_b64_tr_b16 a[246:247], v63 offset:512
    ds_read_b64_tr_b16 a[248:249], v62 offset:4096
    ds_read_b64_tr_b16 a[250:251], v62 offset:4608
    ds_read_b64_tr_b16 a[252:253], v63 offset:4096
    ds_read_b64_tr_b16 a[254:255], v63 offset:4608
    s_waitcnt lgkmcnt(0)
    v_mfma_f32_16x16x32_bf16 v[88:91], a[240:243], v[64:67], v[88:91]
    v_mfma_f32_16x16x32_bf16 v[92:95], a[244:247], v[64:67], v[92:95]
    v_mfma_f32_16x16x32_bf16 v[88:91], a[248:251], v[64:67], v[88:91]
    v_mfma_f32_16x16x32_bf16 v[92:95], a[252:255], v[64:67], v[92:95]
    s_barrier
    s_mov_b32 s37, 0xffff0000
    v_lshlrev_b32 v100, 16, v16
    v_and_b32 v101, s37, v16
    v_lshlrev_b32 v102, 16, v17
    v_and_b32 v103, s37, v17
    v_lshlrev_b32 v104, 16, v18
    v_and_b32 v105, s37, v18
    v_lshlrev_b32 v106, 16, v19
    v_and_b32 v107, s37, v19
    v_lshlrev_b32 v108, 16, v20
    v_and_b32 v109, s37, v20
    v_lshlrev_b32 v110, 16, v21
    v_and_b32 v111, s37, v21
    s_cmp_lg_u32 s32, 0
    s_cbranch_scc1 L_arv42
    s_add_u32 s20, s82, 0x80
    s_addc_u32 s21, s83, 0
    s_mov_b32 s22, 0x4
    s_mov_b32 s23, 0x00020000
    buffer_load_dword v56, v124, s[20:23], 0 offen sc1
    s_waitcnt vmcnt(0)
    v_cmp_eq_u32 vcc, v124, v56
    s_cbranch_vccnz L_spin43
L_back44:
L_arv42:
    s_add_u32 s96, s41, 2031616
    s_mov_b32 s98, s41
    s_mov_b32 s45, 0x5530000
    buffer_load_dword v7, v5, s[16:19], s45 offen sc1
    s_waitcnt vmcnt(0)
    v_cmp_ne_u32 vcc, 0, v7
    s_cbranch_vccnz L_spin45
L_back46:
    s_barrier
    s_mov_b32 s39, 0x5e00000
    s_add_u32 m0, s43, 0
    s_add_u32 s42, s41, 0
    buffer_load_dwordx4 v1, s[16:19], s42 offen offset:0 sc1 lds
    buffer_load_dwordx4 v1, s[16:19], s42 offen offset:1024 sc1 lds
    buffer_load_dwordx4 v1, s[16:19], s42 offen offset:2048 sc1 lds
    buffer_load_dwordx4 v1, s[16:19], s42 offen offset:3072 sc1 lds
    s_add_u32 m0, s43, 16384
    s_add_u32 s42, s41, 16384
    buffer_load_dwordx4 v1, s[16:19], s42 offen offset:0 sc1 lds
    buffer_load_dwordx4 v1, s[16:19], s42 offen offset:1024 sc1 lds
    buffer_load_dwordx4 v1, s[16:19], s42 offen offset:2048 sc1 lds
    buffer_load_dwordx4 v1, s[16:19], s42 offen offset:3072 sc1 lds
    s_add_u32 s45, s45, 65536
    s_waitcnt vmcnt(4) lgkmcnt(0)
    s_barrier
    ds_read_b128 v[56:59], v1 offset:0
    ds_read_b128 v[60:63], v1 offset:1024
    ds_read_b128 v[64:67], v1 offset:2048
    ds_read_b128 v[68:71], v1 offset:3072
    s_mov_b32 s36, 0
    s_waitcnt lgkmcnt(0)
    s_nop 7
L_l_b0:
    s_waitcnt lgkmcnt(2)
    v_mfma_f32_16x16x32_bf16 v[8:11], a[0:3], v[56:59], 0
    s_add_u32 m0, s52, 73728
    ds_read_b128 v[72:75], v1 offset:4096
    s_add_u32 s42, s46, s52
    v_mfma_f32_16x16x32_bf16 v[16:19], a[0:3], v[60:63], 0
    buffer_load_dwordx4 v1, s[16:19], s42 offen sc1 lds
    v_mfma_f32_16x16x32_bf16 v[20:23], a[4:7], v[60:63], 0
    s_add_u32 m0, s43, 32768
    ds_read_b128 v[76:79], v1 offset:5120
    s_add_u32 s42, s41, 32768
    v_mfma_f32_16x16x32_bf16 v[12:15], a[4:7], v[56:59], 0
    s_waitcnt lgkmcnt(2)
    buffer_load_dwordx4 v1, s[16:19], s42 offen offset:0 sc1 lds
    v_mfma_f32_16x16x32_bf16 v[8:11], a[8:11], v[64:67], v[8:11]
    s_and_b32 s44, s90, 0xffffffff
    ds_read_b128 v[80:83], v1 offset:6144
    s_cmp_lt_i32 s36, 1
    v_mfma_f32_16x16x32_bf16 v[16:19], a[8:11], v[68:71], v[16:19]
    buffer_load_dwordx4 v1, s[16:19], s42 offen offset:1024 sc1 lds
    v_mfma_f32_16x16x32_bf16 v[20:23], a[12:15], v[68:71], v[20:23]
    s_cselect_b32 s44, 0x5e00000, s44
    ds_read_b128 v[84:87], v1 offset:7168
    s_add_u32 s90, s90, 262144
    v_mfma_f32_16x16x32_bf16 v[12:15], a[12:15], v[64:67], v[12:15]
    s_waitcnt lgkmcnt(2)
    buffer_load_dwordx4 v1, s[16:19], s42 offen offset:2048 sc1 lds
    v_mfma_f32_16x16x32_bf16 v[8:11], a[16:19], v[72:75], v[8:11]
    ds_read_b128 v[56:59], v1 offset:8192
    v_add_f32 v32, v32, v128
    v_mfma_f32_16x16x32_bf16 v[16:19], a[16:19], v[76:79], v[16:19]
    buffer_load_dwordx4 v1, s[16:19], s42 offen offset:3072 sc1 lds
    v_mfma_f32_16x16x32_bf16 v[20:23], a[20:23], v[76:79], v[20:23]
    s_add_u32 m0, s43, 49152
    ds_read_b128 v[60:63], v1 offset:9216
    v_add_f32 v33, v33, v129
    v_mfma_f32_16x16x32_bf16 v[12:15], a[20:23], v[72:75], v[12:15]
    s_waitcnt lgkmcnt(2)
    v_mul_f32 v120, v32, v116
    v_mul_f32 v121, v33, v116
    v_mfma_f32_16x16x32_bf16 v[8:11], a[24:27], v[80:83], v[8:11]
    s_add_u32 s42, s41, 49152
    ds_read_b128 v[64:67], v1 offset:10240
    buffer_load_dwordx4 v1, s[16:19], s42 offen offset:0 sc1 lds
    v_mfma_f32_16x16x32_bf16 v[16:19], a[24:27], v[84:87], v[16:19]
    v_mul_f32 v120, v120, abs(v32)
    v_mul_f32 v121, v121, abs(v33)
    v_mfma_f32_16x16x32_bf16 v[20:23], a[28:31], v[84:87], v[20:23]
    ds_read_b128 v[68:71], v1 offset:11264
    buffer_load_dwordx4 v1, s[16:19], s42 offen offset:1024 sc1 lds
    v_mfma_f32_16x16x32_bf16 v[12:15], a[28:31], v[80:83], v[12:15]
    s_waitcnt lgkmcnt(2)
    v_cvt_pk_bf16_f32 v32, v120, v121
    v_pk_max_i16 v32, v32, 0
    v_mfma_f32_16x16x32_bf16 v[8:11], a[32:35], v[56:59], v[8:11]
    ds_read_b128 v[72:75], v1 offset:12288
    buffer_load_dwordx4 v1, s[16:19], s42 offen offset:2048 sc1 lds
    v_mfma_f32_16x16x32_bf16 v[16:19], a[32:35], v[60:63], v[16:19]
    v_add_f32 v34, v34, v130
    v_add_f32 v35, v35, v131
    v_mfma_f32_16x16x32_bf16 v[20:23], a[36:39], v[60:63], v[20:23]
    ds_read_b128 v[76:79], v1 offset:13312
    buffer_load_dwordx4 v1, s[16:19], s42 offen offset:3072 sc1 lds
    v_mfma_f32_16x16x32_bf16 v[12:15], a[36:39], v[56:59], v[12:15]
    s_waitcnt lgkmcnt(2)
    v_mul_f32 v120, v34, v116
    v_mul_f32 v121, v35, v116
    v_mfma_f32_16x16x32_bf16 v[8:11], a[40:43], v[64:67], v[8:11]
    s_add_u32 s98, s98, 65536
    ds_read_b128 v[80:83], v1 offset:14336
    v_mul_f32 v120, v120, abs(v34)
    v_mfma_f32_16x16x32_bf16 v[16:19], a[40:43], v[68:71], v[16:19]
    s_min_i32 s98, s98, s96
    v_mul_f32 v121, v121, abs(v35)
    v_cvt_pk_bf16_f32 v33, v120, v121
    v_mfma_f32_16x16x32_bf16 v[20:23], a[44:47], v[68:71], v[20:23]
    s_and_b32 s41, s98, 0xffffffff
    ds_read_b128 v[84:87], v1 offset:15360
    v_pk_max_i16 v33, v33, 0
    v_mfma_f32_16x16x32_bf16 v[12:15], a[44:47], v[64:67], v[12:15]
    s_waitcnt vmcnt(9) lgkmcnt(2)
    s_barrier
    v_add_f32 v36, v36, v132
    v_mfma_f32_16x16x32_bf16 v[8:11], a[48:51], v[72:75], v[8:11]
    ds_read_b128 v[56:59], v1 offset:16384
    v_add_f32 v37, v37, v133
    v_mfma_f32_16x16x32_bf16 v[16:19], a[48:51], v[76:79], v[16:19]
    v_mul_f32 v120, v36, v116
    v_mul_f32 v121, v37, v116
    v_mfma_f32_16x16x32_bf16 v[20:23], a[52:55], v[76:79], v[20:23]
    ds_read_b128 v[60:63], v1 offset:17408
    v_mul_f32 v120, v120, abs(v36)
    v_mfma_f32_16x16x32_bf16 v[12:15], a[52:55], v[72:75], v[12:15]
    s_waitcnt lgkmcnt(2)
    v_mul_f32 v121, v121, abs(v37)
    v_cvt_pk_bf16_f32 v34, v120, v121
    v_mfma_f32_16x16x32_bf16 v[8:11], a[56:59], v[80:83], v[8:11]
    ds_read_b128 v[64:67], v1 offset:18432
    v_pk_max_i16 v34, v34, 0
    v_mfma_f32_16x16x32_bf16 v[16:19], a[56:59], v[84:87], v[16:19]
    v_add_f32 v38, v38, v134
    v_add_f32 v39, v39, v135
    v_mfma_f32_16x16x32_bf16 v[20:23], a[60:63], v[84:87], v[20:23]
    ds_read_b128 v[68:71], v1 offset:19456
    v_mul_f32 v120, v38, v116
    v_mfma_f32_16x16x32_bf16 v[12:15], a[60:63], v[80:83], v[12:15]
    s_waitcnt lgkmcnt(2)
    v_mul_f32 v121, v39, v116
    v_mul_f32 v120, v120, abs(v38)
    v_mfma_f32_16x16x32_bf16 v[8:11], a[64:67], v[56:59], v[8:11]
    ds_read_b128 v[72:75], v1 offset:20480
    v_mul_f32 v121, v121, abs(v39)
    v_mfma_f32_16x16x32_bf16 v[16:19], a[64:67], v[60:63], v[16:19]
    v_cvt_pk_bf16_f32 v35, v120, v121
    v_pk_max_i16 v35, v35, 0
    v_mfma_f32_16x16x32_bf16 v[20:23], a[68:71], v[60:63], v[20:23]
    ds_read_b128 v[76:79], v1 offset:21504
    buffer_store_dwordx4 v[32:35], v1, s[16:19], s44 offen offset:0 sc1
    v_mfma_f32_16x16x32_bf16 v[12:15], a[68:71], v[56:59], v[12:15]
    s_waitcnt lgkmcnt(2)
    v_add_f32 v40, v40, v136
    v_add_f32 v41, v41, v137
    v_mfma_f32_16x16x32_bf16 v[8:11], a[72:75], v[64:67], v[8:11]
    ds_read_b128 v[80:83], v1 offset:22528
    v_mul_f32 v120, v40, v117
    v_mfma_f32_16x16x32_bf16 v[16:19], a[72:75], v[68:71], v[16:19]
    v_mul_f32 v121, v41, v117
    v_mul_f32 v120, v120, abs(v40)
    v_mfma_f32_16x16x32_bf16 v[20:23], a[76:79], v[68:71], v[20:23]
    ds_read_b128 v[84:87], v1 offset:23552
    v_mul_f32 v121, v121, abs(v41)
    v_mfma_f32_16x16x32_bf16 v[12:15], a[76:79], v[64:67], v[12:15]
    s_waitcnt lgkmcnt(2)
    v_cvt_pk_bf16_f32 v40, v120, v121
    v_pk_max_i16 v40, v40, 0
    v_mfma_f32_16x16x32_bf16 v[8:11], a[80:83], v[72:75], v[8:11]
    ds_read_b128 v[56:59], v1 offset:24576
    v_add_f32 v42, v42, v138
    v_mfma_f32_16x16x32_bf16 v[16:19], a[80:83], v[76:79], v[16:19]
    v_add_f32 v43, v43, v139
    v_mul_f32 v120, v42, v117
    v_mfma_f32_16x16x32_bf16 v[20:23], a[84:87], v[76:79], v[20:23]
    ds_read_b128 v[60:63], v1 offset:25600
    v_mul_f32 v121, v43, v117
    v_mfma_f32_16x16x32_bf16 v[12:15], a[84:87], v[72:75], v[12:15]
    s_waitcnt lgkmcnt(2)
    v_mul_f32 v120, v120, abs(v42)
    v_mul_f32 v121, v121, abs(v43)
    v_mfma_f32_16x16x32_bf16 v[8:11], a[88:91], v[80:83], v[8:11]
    ds_read_b128 v[64:67], v1 offset:26624
    v_cvt_pk_bf16_f32 v41, v120, v121
    v_mfma_f32_16x16x32_bf16 v[16:19], a[88:91], v[84:87], v[16:19]
    v_pk_max_i16 v41, v41, 0
    v_add_f32 v44, v44, v140
    v_mfma_f32_16x16x32_bf16 v[20:23], a[92:95], v[84:87], v[20:23]
    ds_read_b128 v[68:71], v1 offset:27648
    v_add_f32 v45, v45, v141
    v_mfma_f32_16x16x32_bf16 v[12:15], a[92:95], v[80:83], v[12:15]
    s_waitcnt lgkmcnt(2)
    v_mul_f32 v120, v44, v117
    v_mul_f32 v121, v45, v117
    v_mfma_f32_16x16x32_bf16 v[8:11], a[96:99], v[56:59], v[8:11]
    ds_read_b128 v[72:75], v1 offset:28672
    v_mul_f32 v120, v120, abs(v44)
    v_mfma_f32_16x16x32_bf16 v[16:19], a[96:99], v[60:63], v[16:19]
    v_mul_f32 v121, v121, abs(v45)
    v_cvt_pk_bf16_f32 v42, v120, v121
    v_mfma_f32_16x16x32_bf16 v[20:23], a[100:103], v[60:63], v[20:23]
    ds_read_b128 v[76:79], v1 offset:29696
    buffer_load_dword v7, v5, s[16:19], s45 offen sc1
    v_mfma_f32_16x16x32_bf16 v[12:15], a[100:103], v[56:59], v[12:15]
    s_waitcnt lgkmcnt(2)
    v_pk_max_i16 v42, v42, 0
    v_add_f32 v46, v46, v142
    v_mfma_f32_16x16x32_bf16 v[8:11], a[104:107], v[64:67], v[8:11]
    ds_read_b128 v[80:83], v1 offset:30720
    v_add_f32 v47, v47, v143
    v_mfma_f32_16x16x32_bf16 v[16:19], a[104:107], v[68:71], v[16:19]
    v_mul_f32 v120, v46, v117
    v_mul_f32 v121, v47, v117
    v_mfma_f32_16x16x32_bf16 v[20:23], a[108:111], v[68:71], v[20:23]
    ds_read_b128 v[84:87], v1 offset:31744
    v_mul_f32 v120, v120, abs(v46)
    v_mfma_f32_16x16x32_bf16 v[12:15], a[108:111], v[64:67], v[12:15]
    s_waitcnt vmcnt(6) lgkmcnt(2)
    s_barrier
    v_mul_f32 v121, v121, abs(v47)
    v_mfma_f32_16x16x32_bf16 v[8:11], a[112:115], v[72:75], v[8:11]
    ds_read_b128 v[56:59], v1 offset:32768
    v_cvt_pk_bf16_f32 v43, v120, v121
    v_mfma_f32_16x16x32_bf16 v[16:19], a[112:115], v[76:79], v[16:19]
    v_pk_max_i16 v43, v43, 0
    buffer_store_dwordx4 v[40:43], v1, s[16:19], s44 offen offset:1024 sc1
    v_mfma_f32_16x16x32_bf16 v[20:23], a[116:119], v[76:79], v[20:23]
    s_add_u32 m0, s43, 98304
    ds_read_b128 v[60:63], v1 offset:33792
    ds_read_b64 v[144:145], v118 offset:0
    v_mfma_f32_16x16x32_bf16 v[12:15], a[116:119], v[72:75], v[12:15]
    s_waitcnt lgkmcnt(3)
    ds_read_b64 v[146:147], v118 offset:128
    ds_read_b64 v[148:149], v118 offset:256
    v_mfma_f32_16x16x32_bf16 v[8:11], a[120:123], v[80:83], v[8:11]
    s_add_u32 s42, s41, 0
    ds_read_b128 v[64:67], v1 offset:34816
    ds_read_b64 v[150:151], v118 offset:384
    v_mfma_f32_16x16x32_bf16 v[16:19], a[120:123], v[84:87], v[16:19]
    v_mfma_f32_16x16x32_bf16 v[20:23], a[124:127], v[84:87], v[20:23]
    ds_read_b128 v[68:71], v1 offset:35840
    v_mfma_f32_16x16x32_bf16 v[12:15], a[124:127], v[80:83], v[12:15]
    s_waitcnt lgkmcnt(6)
    v_mfma_f32_16x16x32_bf16 v[8:11], a[128:131], v[56:59], v[8:11]
    ds_read_b128 v[72:75], v1 offset:36864
    v_mfma_f32_16x16x32_bf16 v[16:19], a[128:131], v[60:63], v[16:19]
    s_waitcnt lgkmcnt(2)
    v_max3_u32 v152, v144, v145, v146
    v_max3_u32 v153, v147, v148, v149
    v_mfma_f32_16x16x32_bf16 v[20:23], a[132:135], v[60:63], v[20:23]
    ds_read_b128 v[76:79], v1 offset:37888
    v_max3_u32 v152, v152, v150, v151
    v_mfma_f32_16x16x32_bf16 v[12:15], a[132:135], v[56:59], v[12:15]
    s_waitcnt lgkmcnt(2)
    v_max_u32 v152, v152, v153
    v_cmp_eq_u32 vcc, -1, v152
    v_mfma_f32_16x16x32_bf16 v[8:11], a[136:139], v[64:67], v[8:11]
    ds_read_b128 v[80:83], v1 offset:38912
    v_mfma_f32_16x16x32_bf16 v[16:19], a[136:139], v[68:71], v[16:19]
    s_cbranch_vccnz L_sspin49
L_sback50:
    v_add_f32 v152, v148, v150
    v_add_f32 v153, v149, v151
    v_mfma_f32_16x16x32_bf16 v[20:23], a[140:143], v[68:71], v[20:23]
    ds_read_b128 v[84:87], v1 offset:39936
    v_add_f32 v144, v144, v146
    v_mfma_f32_16x16x32_bf16 v[12:15], a[140:143], v[64:67], v[12:15]
    s_waitcnt lgkmcnt(2)
    v_add_f32 v145, v145, v147
    v_add_f32 v144, v144, v152
    v_mfma_f32_16x16x32_bf16 v[8:11], a[144:147], v[72:75], v[8:11]
    ds_read_b128 v[56:59], v1 offset:40960
    v_add_f32 v145, v145, v153
    v_mfma_f32_16x16x32_bf16 v[16:19], a[144:147], v[76:79], v[16:19]
    v_mov_b32 v152, v144
    v_mov_b32 v153, v145
    v_mfma_f32_16x16x32_bf16 v[20:23], a[148:151], v[76:79], v[20:23]
    ds_read_b128 v[60:63], v1 offset:41984
    v_permlane32_swap_b32 v144, v152
    v_mfma_f32_16x16x32_bf16 v[12:15], a[148:151], v[72:75], v[12:15]
    s_waitcnt lgkmcnt(2)
    v_permlane32_swap_b32 v145, v153
    v_mfma_f32_16x16x32_bf16 v[8:11], a[152:155], v[80:83], v[8:11]
    ds_read_b128 v[64:67], v1 offset:43008
    v_add_f32 v144, v144, v152
    v_mfma_f32_16x16x32_bf16 v[16:19], a[152:155], v[84:87], v[16:19]
    v_add_f32 v145, v145, v153
    v_mul_f32 v112, 0xba800000, v144
    v_mfma_f32_16x16x32_bf16 v[20:23], a[156:159], v[84:87], v[20:23]
    ds_read_b128 v[68:71], v1 offset:44032
    v_mul_f32 v145, 0x3a800000, v145
    v_mfma_f32_16x16x32_bf16 v[12:15], a[156:159], v[80:83], v[12:15]
    s_waitcnt lgkmcnt(2)
    v_fma_f32 v145, -v112, v112, v145
    v_mov_b32 v113, v112
    v_mfma_f32_16x16x32_bf16 v[8:11], a[160:163], v[56:59], v[8:11]
    ds_read_b128 v[72:75], v1 offset:45056
    v_max_f32 v145, 0, v145
    v_mfma_f32_16x16x32_bf16 v[16:19], a[160:163], v[60:63], v[16:19]
    v_add_f32 v145, 0x3727c5ac, v145
    v_rsq_f32 v116, v145
    v_mfma_f32_16x16x32_bf16 v[20:23], a[164:167], v[60:63], v[20:23]
    ds_read_b128 v[76:79], v1 offset:46080
    v_permlane16_swap_b32 v112, v113
    v_mfma_f32_16x16x32_bf16 v[12:15], a[164:167], v[56:59], v[12:15]
    s_waitcnt lgkmcnt(2)
    v_mul_f32 v114, v145, v116
    v_mul_f32 v116, v116, v116
    v_mfma_f32_16x16x32_bf16 v[8:11], a[168:171], v[64:67], v[8:11]
    s_waitcnt vmcnt(0)
    ds_read_b128 v[80:83], v1 offset:47104
    v_mov_b32 v115, v114
    v_mfma_f32_16x16x32_bf16 v[16:19], a[168:171], v[68:71], v[16:19]
    s_barrier
    buffer_store_dword v124, v124, s[16:19], s91 offen sc1
    v_mfma_f32_16x16x32_bf16 v[20:23], a[172:175], v[68:71], v[20:23]
    s_add_u32 s91, s91, 65536
    ds_read_b128 v[84:87], v1 offset:48128
    v_cmp_ne_u32 vcc, 0, v7
    v_mfma_f32_16x16x32_bf16 v[12:15], a[172:175], v[64:67], v[12:15]
    s_waitcnt lgkmcnt(2)
    v_mov_b32 v117, v116
    v_permlane16_swap_b32 v114, v115
    v_mfma_f32_16x16x32_bf16 v[8:11], a[176:179], v[72:75], v[8:11]
    s_cbranch_vccnz L_spin47
L_back48:
    ds_read_b128 v[56:59], v1 offset:49152
    v_permlane16_swap_b32 v116, v117
    v_mfma_f32_16x16x32_bf16 v[16:19], a[176:179], v[76:79], v[16:19]
    s_barrier
    buffer_load_dwordx4 v1, s[16:19], s42 offen offset:0 sc1 lds
    v_mfma_f32_16x16x32_bf16 v[20:23], a[180:183], v[76:79], v[20:23]
    s_add_u32 s46, s46, 2048
    ds_read_b128 v[60:63], v1 offset:50176
    buffer_load_dwordx4 v1, s[16:19], s42 offen offset:1024 sc1 lds
    v_mfma_f32_16x16x32_bf16 v[12:15], a[180:183], v[72:75], v[12:15]
    s_waitcnt lgkmcnt(2)
    buffer_load_dwordx4 v1, s[16:19], s42 offen offset:2048 sc1 lds
    v_mfma_f32_16x16x32_bf16 v[8:11], a[184:187], v[80:83], v[8:11]
    ds_read_b128 v[64:67], v1 offset:51200
    buffer_load_dwordx4 v1, s[16:19], s42 offen offset:3072 sc1 lds
    v_mfma_f32_16x16x32_bf16 v[16:19], a[184:187], v[84:87], v[16:19]
    s_add_u32 m0, s43, 114688
    v_mul_f32 v128, v112, v88
    v_fmac_f32 v128, v114, v100
    v_mfma_f32_16x16x32_bf16 v[20:23], a[188:191], v[84:87], v[20:23]
    s_add_u32 s42, s41, 16384
    ds_read_b128 v[68:71], v1 offset:52224
    v_mul_f32 v129, v112, v89
    v_mfma_f32_16x16x32_bf16 v[12:15], a[188:191], v[80:83], v[12:15]
    s_waitcnt lgkmcnt(2)
    v_fmac_f32 v129, v114, v101
    v_mul_f32 v130, v112, v90
    v_mfma_f32_16x16x32_bf16 v[8:11], a[192:195], v[56:59], v[8:11]
    ds_read_b128 v[72:75], v1 offset:53248
    buffer_load_dwordx4 v1, s[16:19], s42 offen offset:0 sc1 lds
    v_mfma_f32_16x16x32_bf16 v[16:19], a[192:195], v[60:63], v[16:19]
    v_fmac_f32 v130, v114, v102
    v_mul_f32 v131, v112, v91
    v_mfma_f32_16x16x32_bf16 v[20:23], a[196:199], v[60:63], v[20:23]
    ds_read_b128 v[76:79], v1 offset:54272
    v_fmac_f32 v131, v114, v103
    v_mfma_f32_16x16x32_bf16 v[12:15], a[196:199], v[56:59], v[12:15]
    s_waitcnt lgkmcnt(2)
    v_mul_f32 v132, v112, v92
    v_fmac_f32 v132, v114, v104
    v_mfma_f32_16x16x32_bf16 v[8:11], a[200:203], v[64:67], v[8:11]
    ds_read_b128 v[80:83], v1 offset:55296
    buffer_load_dwordx4 v1, s[16:19], s42 offen offset:1024 sc1 lds
    v_mfma_f32_16x16x32_bf16 v[16:19], a[200:203], v[68:71], v[16:19]
    v_mul_f32 v133, v112, v93
    v_fmac_f32 v133, v114, v105
    v_mfma_f32_16x16x32_bf16 v[20:23], a[204:207], v[68:71], v[20:23]
    ds_read_b128 v[84:87], v1 offset:56320
    v_mul_f32 v134, v112, v94
    v_mfma_f32_16x16x32_bf16 v[12:15], a[204:207], v[64:67], v[12:15]
    s_waitcnt lgkmcnt(2)
    v_fmac_f32 v134, v114, v106
    v_mul_f32 v135, v112, v95
    v_mfma_f32_16x16x32_bf16 v[8:11], a[208:211], v[72:75], v[8:11]
    ds_read_b128 v[56:59], v1 offset:57344
    buffer_load_dwordx4 v1, s[16:19], s42 offen offset:2048 sc1 lds
    v_mfma_f32_16x16x32_bf16 v[16:19], a[208:211], v[76:79], v[16:19]
    v_fmac_f32 v135, v114, v107
    v_mul_f32 v136, v113, v88
    v_mfma_f32_16x16x32_bf16 v[20:23], a[212:215], v[76:79], v[20:23]
    ds_read_b128 v[60:63], v1 offset:58368
    v_fmac_f32 v136, v115, v100
    v_mfma_f32_16x16x32_bf16 v[12:15], a[212:215], v[72:75], v[12:15]
    s_waitcnt lgkmcnt(2)
    v_mul_f32 v137, v113, v89
    v_fmac_f32 v137, v115, v101
    v_mfma_f32_16x16x32_bf16 v[8:11], a[216:219], v[80:83], v[8:11]
    ds_read_b128 v[64:67], v1 offset:59392
    buffer_load_dwordx4 v1, s[16:19], s42 offen offset:3072 sc1 lds
    v_mfma_f32_16x16x32_bf16 v[16:19], a[216:219], v[84:87], v[16:19]
    s_add_u32 s45, s45, 65536
    v_mul_f32 v138, v113, v90
    v_fmac_f32 v138, v115, v102
    v_mfma_f32_16x16x32_bf16 v[20:23], a[220:223], v[84:87], v[20:23]
    ds_read_b128 v[68:71], v1 offset:60416
    v_mul_f32 v139, v113, v91
    v_mfma_f32_16x16x32_bf16 v[12:15], a[220:223], v[80:83], v[12:15]
    s_waitcnt lgkmcnt(2)
    v_fmac_f32 v139, v115, v103
    v_mul_f32 v140, v113, v92
    v_mfma_f32_16x16x32_bf16 v[8:11], a[224:227], v[56:59], v[8:11]
    ds_read_b128 v[72:75], v1 offset:61440
    v_fmac_f32 v140, v115, v104
    v_mfma_f32_16x16x32_bf16 v[16:19], a[224:227], v[60:63], v[16:19]
    v_mul_f32 v141, v113, v93
    v_fmac_f32 v141, v115, v105
    v_mfma_f32_16x16x32_bf16 v[20:23], a[228:231], v[60:63], v[20:23]
    ds_read_b128 v[76:79], v1 offset:62464
    v_mul_f32 v142, v113, v94
    v_mfma_f32_16x16x32_bf16 v[12:15], a[228:231], v[56:59], v[12:15]
    s_waitcnt lgkmcnt(2)
    v_fmac_f32 v142, v115, v106
    v_mul_f32 v143, v113, v95
    v_mfma_f32_16x16x32_bf16 v[8:11], a[232:235], v[64:67], v[8:11]
    ds_read_b128 v[80:83], v1 offset:63488
    v_fmac_f32 v143, v115, v107
    v_mfma_f32_16x16x32_bf16 v[16:19], a[232:235], v[68:71], v[16:19]
    v_mfma_f32_16x16x32_bf16 v[20:23], a[236:239], v[68:71], v[20:23]
    ds_read_b128 v[84:87], v1 offset:64512
    v_mfma_f32_16x16x32_bf16 v[12:15], a[236:239], v[64:67], v[12:15]
    s_waitcnt vmcnt(4) lgkmcnt(2)
    s_barrier
    v_mfma_f32_16x16x32_bf16 v[8:11], a[240:243], v[72:75], v[8:11]
    ds_read_b128 v[56:59], v2 offset:0
    v_mfma_f32_16x16x32_bf16 v[16:19], a[240:243], v[76:79], v[16:19]
    v_mfma_f32_16x16x32_bf16 v[20:23], a[244:247], v[76:79], v[20:23]
    ds_read_b128 v[60:63], v2 offset:1024
    v_mfma_f32_16x16x32_bf16 v[12:15], a[244:247], v[72:75], v[12:15]
    s_waitcnt lgkmcnt(2)
    v_mfma_f32_16x16x32_bf16 v[8:11], a[248:251], v[80:83], v[8:11]
    ds_read_b128 v[64:67], v2 offset:2048
    v_mfma_f32_16x16x32_bf16 v[16:19], a[248:251], v[84:87], v[16:19]
    v_mfma_f32_16x16x32_bf16 v[20:23], a[252:255], v[84:87], v[20:23]
    ds_read_b128 v[68:71], v2 offset:3072
    v_mfma_f32_16x16x32_bf16 v[12:15], a[252:255], v[80:83], v[12:15]
    s_add_u32 s36, s36, 1
L_l_b1:
    s_waitcnt lgkmcnt(2)
    v_mfma_f32_16x16x32_bf16 v[32:35], a[0:3], v[56:59], 0
    s_add_u32 m0, s52, 73728
    ds_read_b128 v[72:75], v2 offset:4096
    s_add_u32 s42, s46, s52
    v_mfma_f32_16x16x32_bf16 v[40:43], a[0:3], v[60:63], 0
    buffer_load_dwordx4 v1, s[16:19], s42 offen sc1 lds
    v_mfma_f32_16x16x32_bf16 v[44:47], a[4:7], v[60:63], 0
    s_add_u32 m0, s43, 131072
    ds_read_b128 v[76:79], v2 offset:5120
    s_add_u32 s42, s41, 32768
    v_mfma_f32_16x16x32_bf16 v[36:39], a[4:7], v[56:59], 0
    s_waitcnt lgkmcnt(2)
    buffer_load_dwordx4 v1, s[16:19], s42 offen offset:0 sc1 lds
    v_mfma_f32_16x16x32_bf16 v[32:35], a[8:11], v[64:67], v[32:35]
    s_and_b32 s44, s90, 0xffffffff
    ds_read_b128 v[80:83], v2 offset:6144
    s_cmp_lt_i32 s36, 1
    v_mfma_f32_16x16x32_bf16 v[40:43], a[8:11], v[68:71], v[40:43]
    buffer_load_dwordx4 v1, s[16:19], s42 offen offset:1024 sc1 lds
    v_mfma_f32_16x16x32_bf16 v[44:47], a[12:15], v[68:71], v[44:47]
    s_cselect_b32 s44, 0x5e00000, s44
    ds_read_b128 v[84:87], v2 offset:7168
    s_add_u32 s90, s90, 262144
    v_mfma_f32_16x16x32_bf16 v[36:39], a[12:15], v[64:67], v[36:39]
    s_waitcnt lgkmcnt(2)
    buffer_load_dwordx4 v1, s[16:19], s42 offen offset:2048 sc1 lds
    v_mfma_f32_16x16x32_bf16 v[32:35], a[16:19], v[72:75], v[32:35]
    ds_read_b128 v[56:59], v2 offset:8192
    v_add_f32 v8, v8, v128
    v_mfma_f32_16x16x32_bf16 v[40:43], a[16:19], v[76:79], v[40:43]
    buffer_load_dwordx4 v1, s[16:19], s42 offen offset:3072 sc1 lds
    v_mfma_f32_16x16x32_bf16 v[44:47], a[20:23], v[76:79], v[44:47]
    s_add_u32 m0, s43, 147456
    ds_read_b128 v[60:63], v2 offset:9216
    v_add_f32 v9, v9, v129
    v_mfma_f32_16x16x32_bf16 v[36:39], a[20:23], v[72:75], v[36:39]
    s_waitcnt lgkmcnt(2)
    v_mul_f32 v120, v8, v116
    v_mul_f32 v121, v9, v116
    v_mfma_f32_16x16x32_bf16 v[32:35], a[24:27], v[80:83], v[32:35]
    s_add_u32 s42, s41, 49152
    ds_read_b128 v[64:67], v2 offset:10240
    buffer_load_dwordx4 v1, s[16:19], s42 offen offset:0 sc1 lds
    v_mfma_f32_16x16x32_bf16 v[40:43], a[24:27], v[84:87], v[40:43]
    v_mul_f32 v120, v120, abs(v8)
    v_mul_f32 v121, v121, abs(v9)
    v_mfma_f32_16x16x32_bf16 v[44:47], a[28:31], v[84:87], v[44:47]
    ds_read_b128 v[68:71], v2 offset:11264
    buffer_load_dwordx4 v1, s[16:19], s42 offen offset:1024 sc1 lds
    v_mfma_f32_16x16x32_bf16 v[36:39], a[28:31], v[80:83], v[36:39]
    s_waitcnt lgkmcnt(2)
    v_cvt_pk_bf16_f32 v8, v120, v121
    v_pk_max_i16 v8, v8, 0
    v_mfma_f32_16x16x32_bf16 v[32:35], a[32:35], v[56:59], v[32:35]
    ds_read_b128 v[72:75], v2 offset:12288
    buffer_load_dwordx4 v1, s[16:19], s42 offen offset:2048 sc1 lds
    v_mfma_f32_16x16x32_bf16 v[40:43], a[32:35], v[60:63], v[40:43]
    v_add_f32 v10, v10, v130
    v_add_f32 v11, v11, v131
    v_mfma_f32_16x16x32_bf16 v[44:47], a[36:39], v[60:63], v[44:47]
    ds_read_b128 v[76:79], v2 offset:13312
    buffer_load_dwordx4 v1, s[16:19], s42 offen offset:3072 sc1 lds
    v_mfma_f32_16x16x32_bf16 v[36:39], a[36:39], v[56:59], v[36:39]
    s_waitcnt lgkmcnt(2)
    v_mul_f32 v120, v10, v116
    v_mul_f32 v121, v11, v116
    v_mfma_f32_16x16x32_bf16 v[32:35], a[40:43], v[64:67], v[32:35]
    s_add_u32 s98, s98, 65536
    ds_read_b128 v[80:83], v2 offset:14336
    v_mul_f32 v120, v120, abs(v10)
    v_mfma_f32_16x16x32_bf16 v[40:43], a[40:43], v[68:71], v[40:43]
    s_min_i32 s98, s98, s96
    v_mul_f32 v121, v121, abs(v11)
    v_cvt_pk_bf16_f32 v9, v120, v121
    v_mfma_f32_16x16x32_bf16 v[44:47], a[44:47], v[68:71], v[44:47]
    s_and_b32 s41, s98, 0xffffffff
    ds_read_b128 v[84:87], v2 offset:15360
    v_pk_max_i16 v9, v9, 0
    v_mfma_f32_16x16x32_bf16 v[36:39], a[44:47], v[64:67], v[36:39]
    s_waitcnt vmcnt(9) lgkmcnt(2)
    s_barrier
    v_add_f32 v12, v12, v132
    v_mfma_f32_16x16x32_bf16 v[32:35], a[48:51], v[72:75], v[32:35]
    ds_read_b128 v[56:59], v2 offset:16384
    v_add_f32 v13, v13, v133
    v_mfma_f32_16x16x32_bf16 v[40:43], a[48:51], v[76:79], v[40:43]
    v_mul_f32 v120, v12, v116
    v_mul_f32 v121, v13, v116
    v_mfma_f32_16x16x32_bf16 v[44:47], a[52:55], v[76:79], v[44:47]
    ds_read_b128 v[60:63], v2 offset:17408
    v_mul_f32 v120, v120, abs(v12)
    v_mfma_f32_16x16x32_bf16 v[36:39], a[52:55], v[72:75], v[36:39]
    s_waitcnt lgkmcnt(2)
    v_mul_f32 v121, v121, abs(v13)
    v_cvt_pk_bf16_f32 v10, v120, v121
    v_mfma_f32_16x16x32_bf16 v[32:35], a[56:59], v[80:83], v[32:35]
    ds_read_b128 v[64:67], v2 offset:18432
    v_pk_max_i16 v10, v10, 0
    v_mfma_f32_16x16x32_bf16 v[40:43], a[56:59], v[84:87], v[40:43]
    v_add_f32 v14, v14, v134
    v_add_f32 v15, v15, v135
    v_mfma_f32_16x16x32_bf16 v[44:47], a[60:63], v[84:87], v[44:47]
    ds_read_b128 v[68:71], v2 offset:19456
    v_mul_f32 v120, v14, v116
    v_mfma_f32_16x16x32_bf16 v[36:39], a[60:63], v[80:83], v[36:39]
    s_waitcnt lgkmcnt(2)
    v_mul_f32 v121, v15, v116
    v_mul_f32 v120, v120, abs(v14)
    v_mfma_f32_16x16x32_bf16 v[32:35], a[64:67], v[56:59], v[32:35]
    ds_read_b128 v[72:75], v2 offset:20480
    v_mul_f32 v121, v121, abs(v15)
    v_mfma_f32_16x16x32_bf16 v[40:43], a[64:67], v[60:63], v[40:43]
    v_cvt_pk_bf16_f32 v11, v120, v121
    v_pk_max_i16 v11, v11, 0
    v_mfma_f32_16x16x32_bf16 v[44:47], a[68:71], v[60:63], v[44:47]
    ds_read_b128 v[76:79], v2 offset:21504
    buffer_store_dwordx4 v[8:11], v1, s[16:19], s44 offen offset:0 sc1
    v_mfma_f32_16x16x32_bf16 v[36:39], a[68:71], v[56:59], v[36:39]
    s_waitcnt lgkmcnt(2)
    v_add_f32 v16, v16, v136
    v_add_f32 v17, v17, v137
    v_mfma_f32_16x16x32_bf16 v[32:35], a[72:75], v[64:67], v[32:35]
    ds_read_b128 v[80:83], v2 offset:22528
    v_mul_f32 v120, v16, v117
    v_mfma_f32_16x16x32_bf16 v[40:43], a[72:75], v[68:71], v[40:43]
    v_mul_f32 v121, v17, v117
    v_mul_f32 v120, v120, abs(v16)
    v_mfma_f32_16x16x32_bf16 v[44:47], a[76:79], v[68:71], v[44:47]
    ds_read_b128 v[84:87], v2 offset:23552
    v_mul_f32 v121, v121, abs(v17)
    v_mfma_f32_16x16x32_bf16 v[36:39], a[76:79], v[64:67], v[36:39]
    s_waitcnt lgkmcnt(2)
    v_cvt_pk_bf16_f32 v16, v120, v121
    v_pk_max_i16 v16, v16, 0
    v_mfma_f32_16x16x32_bf16 v[32:35], a[80:83], v[72:75], v[32:35]
    ds_read_b128 v[56:59], v2 offset:24576
    v_add_f32 v18, v18, v138
    v_mfma_f32_16x16x32_bf16 v[40:43], a[80:83], v[76:79], v[40:43]
    v_add_f32 v19, v19, v139
    v_mul_f32 v120, v18, v117
    v_mfma_f32_16x16x32_bf16 v[44:47], a[84:87], v[76:79], v[44:47]
    ds_read_b128 v[60:63], v2 offset:25600
    v_mul_f32 v121, v19, v117
    v_mfma_f32_16x16x32_bf16 v[36:39], a[84:87], v[72:75], v[36:39]
    s_waitcnt lgkmcnt(2)
    v_mul_f32 v120, v120, abs(v18)
    v_mul_f32 v121, v121, abs(v19)
    v_mfma_f32_16x16x32_bf16 v[32:35], a[88:91], v[80:83], v[32:35]
    ds_read_b128 v[64:67], v2 offset:26624
    v_cvt_pk_bf16_f32 v17, v120, v121
    v_mfma_f32_16x16x32_bf16 v[40:43], a[88:91], v[84:87], v[40:43]
    v_pk_max_i16 v17, v17, 0
    v_add_f32 v20, v20, v140
    v_mfma_f32_16x16x32_bf16 v[44:47], a[92:95], v[84:87], v[44:47]
    ds_read_b128 v[68:71], v2 offset:27648
    v_add_f32 v21, v21, v141
    v_mfma_f32_16x16x32_bf16 v[36:39], a[92:95], v[80:83], v[36:39]
    s_waitcnt lgkmcnt(2)
    v_mul_f32 v120, v20, v117
    v_mul_f32 v121, v21, v117
    v_mfma_f32_16x16x32_bf16 v[32:35], a[96:99], v[56:59], v[32:35]
    ds_read_b128 v[72:75], v2 offset:28672
    v_mul_f32 v120, v120, abs(v20)
    v_mfma_f32_16x16x32_bf16 v[40:43], a[96:99], v[60:63], v[40:43]
    v_mul_f32 v121, v121, abs(v21)
    v_cvt_pk_bf16_f32 v18, v120, v121
    v_mfma_f32_16x16x32_bf16 v[44:47], a[100:103], v[60:63], v[44:47]
    ds_read_b128 v[76:79], v2 offset:29696
    buffer_load_dword v7, v5, s[16:19], s45 offen sc1
    v_mfma_f32_16x16x32_bf16 v[36:39], a[100:103], v[56:59], v[36:39]
    s_waitcnt lgkmcnt(2)
    v_pk_max_i16 v18, v18, 0
    v_add_f32 v22, v22, v142
    v_mfma_f32_16x16x32_bf16 v[32:35], a[104:107], v[64:67], v[32:35]
    ds_read_b128 v[80:83], v2 offset:30720
    v_add_f32 v23, v23, v143
    v_mfma_f32_16x16x32_bf16 v[40:43], a[104:107], v[68:71], v[40:43]
    v_mul_f32 v120, v22, v117
    v_mul_f32 v121, v23, v117
    v_mfma_f32_16x16x32_bf16 v[44:47], a[108:111], v[68:71], v[44:47]
    ds_read_b128 v[84:87], v2 offset:31744
    v_mul_f32 v120, v120, abs(v22)
    v_mfma_f32_16x16x32_bf16 v[36:39], a[108:111], v[64:67], v[36:39]
    s_waitcnt vmcnt(6) lgkmcnt(2)
    s_barrier
    v_mul_f32 v121, v121, abs(v23)
    v_mfma_f32_16x16x32_bf16 v[32:35], a[112:115], v[72:75], v[32:35]
    ds_read_b128 v[56:59], v2 offset:32768
    v_cvt_pk_bf16_f32 v19, v120, v121
    v_mfma_f32_16x16x32_bf16 v[40:43], a[112:115], v[76:79], v[40:43]
    v_pk_max_i16 v19, v19, 0
    buffer_store_dwordx4 v[16:19], v1, s[16:19], s44 offen offset:1024 sc1
    v_mfma_f32_16x16x32_bf16 v[44:47], a[116:119], v[76:79], v[44:47]
    s_add_u32 m0, s43, 0
    ds_read_b128 v[60:63], v2 offset:33792
    ds_read_b64 v[144:145], v118 offset:0
    v_mfma_f32_16x16x32_bf16 v[36:39], a[116:119], v[72:75], v[36:39]
    s_waitcnt lgkmcnt(3)
    ds_read_b64 v[146:147], v118 offset:128
    ds_read_b64 v[148:149], v118 offset:256
    v_mfma_f32_16x16x32_bf16 v[32:35], a[120:123], v[80:83], v[32:35]
    s_add_u32 s42, s41, 0
    ds_read_b128 v[64:67], v2 offset:34816
    ds_read_b64 v[150:151], v118 offset:384
    v_mfma_f32_16x16x32_bf16 v[40:43], a[120:123], v[84:87], v[40:43]
    v_mfma_f32_16x16x32_bf16 v[44:47], a[124:127], v[84:87], v[44:47]
    ds_read_b128 v[68:71], v2 offset:35840
    v_mfma_f32_16x16x32_bf16 v[36:39], a[124:127], v[80:83], v[36:39]
    s_waitcnt lgkmcnt(6)
    v_mfma_f32_16x16x32_bf16 v[32:35], a[128:131], v[56:59], v[32:35]
    ds_read_b128 v[72:75], v2 offset:36864
    v_mfma_f32_16x16x32_bf16 v[40:43], a[128:131], v[60:63], v[40:43]
    s_waitcnt lgkmcnt(2)
    v_max3_u32 v152, v144, v145, v146
    v_max3_u32 v153, v147, v148, v149
    v_mfma_f32_16x16x32_bf16 v[44:47], a[132:135], v[60:63], v[44:47]
    ds_read_b128 v[76:79], v2 offset:37888
    v_max3_u32 v152, v152, v150, v151
    v_mfma_f32_16x16x32_bf16 v[36:39], a[132:135], v[56:59], v[36:39]
    s_waitcnt lgkmcnt(2)
    v_max_u32 v152, v152, v153
    v_cmp_eq_u32 vcc, -1, v152
    v_mfma_f32_16x16x32_bf16 v[32:35], a[136:139], v[64:67], v[32:35]
    ds_read_b128 v[80:83], v2 offset:38912
    v_mfma_f32_16x16x32_bf16 v[40:43], a[136:139], v[68:71], v[40:43]
    s_cbranch_vccnz L_sspin53
L_sback54:
    v_add_f32 v152, v148, v150
    v_add_f32 v153, v149, v151
    v_mfma_f32_16x16x32_bf16 v[44:47], a[140:143], v[68:71], v[44:47]
    ds_read_b128 v[84:87], v2 offset:39936
    v_add_f32 v144, v144, v146
    v_mfma_f32_16x16x32_bf16 v[36:39], a[140:143], v[64:67], v[36:39]
    s_waitcnt lgkmcnt(2)
    v_add_f32 v145, v145, v147
    v_add_f32 v144, v144, v152
    v_mfma_f32_16x16x32_bf16 v[32:35], a[144:147], v[72:75], v[32:35]
    ds_read_b128 v[56:59], v2 offset:40960
    v_add_f32 v145, v145, v153
    v_mfma_f32_16x16x32_bf16 v[40:43], a[144:147], v[76:79], v[40:43]
    v_mov_b32 v152, v144
    v_mov_b32 v153, v145
    v_mfma_f32_16x16x32_bf16 v[44:47], a[148:151], v[76:79], v[44:47]
    ds_read_b128 v[60:63], v2 offset:41984
    v_permlane32_swap_b32 v144, v152
    v_mfma_f32_16x16x32_bf16 v[36:39], a[148:151], v[72:75], v[36:39]
    s_waitcnt lgkmcnt(2)
    v_permlane32_swap_b32 v145, v153
    v_mfma_f32_16x16x32_bf16 v[32:35], a[152:155], v[80:83], v[32:35]
    ds_read_b128 v[64:67], v2 offset:43008
    v_add_f32 v144, v144, v152
    v_mfma_f32_16x16x32_bf16 v[40:43], a[152:155], v[84:87], v[40:43]
    v_add_f32 v145, v145, v153
    v_mul_f32 v112, 0xba800000, v144
    v_mfma_f32_16x16x32_bf16 v[44:47], a[156:159], v[84:87], v[44:47]
    ds_read_b128 v[68:71], v2 offset:44032
    v_mul_f32 v145, 0x3a800000, v145
    v_mfma_f32_16x16x32_bf16 v[36:39], a[156:159], v[80:83], v[36:39]
    s_waitcnt lgkmcnt(2)
    v_fma_f32 v145, -v112, v112, v145
    v_mov_b32 v113, v112
    v_mfma_f32_16x16x32_bf16 v[32:35], a[160:163], v[56:59], v[32:35]
    ds_read_b128 v[72:75], v2 offset:45056
    v_max_f32 v145, 0, v145
    v_mfma_f32_16x16x32_bf16 v[40:43], a[160:163], v[60:63], v[40:43]
    v_add_f32 v145, 0x3727c5ac, v145
    v_rsq_f32 v116, v145
    v_mfma_f32_16x16x32_bf16 v[44:47], a[164:167], v[60:63], v[44:47]
    ds_read_b128 v[76:79], v2 offset:46080
    v_permlane16_swap_b32 v112, v113
    v_mfma_f32_16x16x32_bf16 v[36:39], a[164:167], v[56:59], v[36:39]
    s_waitcnt lgkmcnt(2)
    v_mul_f32 v114, v145, v116
    v_mul_f32 v116, v116, v116
    v_mfma_f32_16x16x32_bf16 v[32:35], a[168:171], v[64:67], v[32:35]
    s_waitcnt vmcnt(0)
    ds_read_b128 v[80:83], v2 offset:47104
    v_mov_b32 v115, v114
    v_mfma_f32_16x16x32_bf16 v[40:43], a[168:171], v[68:71], v[40:43]
    s_barrier
    buffer_store_dword v124, v124, s[16:19], s91 offen sc1
    v_mfma_f32_16x16x32_bf16 v[44:47], a[172:175], v[68:71], v[44:47]
    s_add_u32 s91, s91, 65536
    ds_read_b128 v[84:87], v2 offset:48128
    v_cmp_ne_u32 vcc, 0, v7
    v_mfma_f32_16x16x32_bf16 v[36:39], a[172:175], v[64:67], v[36:39]
    s_waitcnt lgkmcnt(2)
    v_mov_b32 v117, v116
    v_permlane16_swap_b32 v114, v115
    v_mfma_f32_16x16x32_bf16 v[32:35], a[176:179], v[72:75], v[32:35]
    s_cbranch_vccnz L_spin51
L_back52:
    ds_read_b128 v[56:59], v2 offset:49152
    v_permlane16_swap_b32 v116, v117
    v_mfma_f32_16x16x32_bf16 v[40:43], a[176:179], v[76:79], v[40:43]
    s_barrier
    buffer_load_dwordx4 v1, s[16:19], s42 offen offset:0 sc1 lds
    v_mfma_f32_16x16x32_bf16 v[44:47], a[180:183], v[76:79], v[44:47]
    s_add_u32 s46, s46, 2048
    ds_read_b128 v[60:63], v2 offset:50176
    buffer_load_dwordx4 v1, s[16:19], s42 offen offset:1024 sc1 lds
    v_mfma_f32_16x16x32_bf16 v[36:39], a[180:183], v[72:75], v[36:39]
    s_waitcnt lgkmcnt(2)
    buffer_load_dwordx4 v1, s[16:19], s42 offen offset:2048 sc1 lds
    v_mfma_f32_16x16x32_bf16 v[32:35], a[184:187], v[80:83], v[32:35]
    ds_read_b128 v[64:67], v2 offset:51200
    buffer_load_dwordx4 v1, s[16:19], s42 offen offset:3072 sc1 lds
    v_mfma_f32_16x16x32_bf16 v[40:43], a[184:187], v[84:87], v[40:43]
    s_add_u32 m0, s43, 16384
    v_mul_f32 v128, v112, v88
    v_fmac_f32 v128, v114, v100
    v_mfma_f32_16x16x32_bf16 v[44:47], a[188:191], v[84:87], v[44:47]
    s_add_u32 s42, s41, 16384
    ds_read_b128 v[68:71], v2 offset:52224
    v_mul_f32 v129, v112, v89
    v_mfma_f32_16x16x32_bf16 v[36:39], a[188:191], v[80:83], v[36:39]
    s_waitcnt lgkmcnt(2)
    v_fmac_f32 v129, v114, v101
    v_mul_f32 v130, v112, v90
    v_mfma_f32_16x16x32_bf16 v[32:35], a[192:195], v[56:59], v[32:35]
    ds_read_b128 v[72:75], v2 offset:53248
    buffer_load_dwordx4 v1, s[16:19], s42 offen offset:0 sc1 lds
    v_mfma_f32_16x16x32_bf16 v[40:43], a[192:195], v[60:63], v[40:43]
    v_fmac_f32 v130, v114, v102
    v_mul_f32 v131, v112, v91
    v_mfma_f32_16x16x32_bf16 v[44:47], a[196:199], v[60:63], v[44:47]
    ds_read_b128 v[76:79], v2 offset:54272
    v_fmac_f32 v131, v114, v103
    v_mfma_f32_16x16x32_bf16 v[36:39], a[196:199], v[56:59], v[36:39]
    s_waitcnt lgkmcnt(2)
    v_mul_f32 v132, v112, v92
    v_fmac_f32 v132, v114, v104
    v_mfma_f32_16x16x32_bf16 v[32:35], a[200:203], v[64:67], v[32:35]
    ds_read_b128 v[80:83], v2 offset:55296
    buffer_load_dwordx4 v1, s[16:19], s42 offen offset:1024 sc1 lds
    v_mfma_f32_16x16x32_bf16 v[40:43], a[200:203], v[68:71], v[40:43]
    v_mul_f32 v133, v112, v93
    v_fmac_f32 v133, v114, v105
    v_mfma_f32_16x16x32_bf16 v[44:47], a[204:207], v[68:71], v[44:47]
    ds_read_b128 v[84:87], v2 offset:56320
    v_mul_f32 v134, v112, v94
    v_mfma_f32_16x16x32_bf16 v[36:39], a[204:207], v[64:67], v[36:39]
    s_waitcnt lgkmcnt(2)
    v_fmac_f32 v134, v114, v106
    v_mul_f32 v135, v112, v95
    v_mfma_f32_16x16x32_bf16 v[32:35], a[208:211], v[72:75], v[32:35]
    ds_read_b128 v[56:59], v2 offset:57344
    buffer_load_dwordx4 v1, s[16:19], s42 offen offset:2048 sc1 lds
    v_mfma_f32_16x16x32_bf16 v[40:43], a[208:211], v[76:79], v[40:43]
    v_fmac_f32 v135, v114, v107
    v_mul_f32 v136, v113, v88
    v_mfma_f32_16x16x32_bf16 v[44:47], a[212:215], v[76:79], v[44:47]
    ds_read_b128 v[60:63], v2 offset:58368
    v_fmac_f32 v136, v115, v100
    v_mfma_f32_16x16x32_bf16 v[36:39], a[212:215], v[72:75], v[36:39]
    s_waitcnt lgkmcnt(2)
    v_mul_f32 v137, v113, v89
    v_fmac_f32 v137, v115, v101
    v_mfma_f32_16x16x32_bf16 v[32:35], a[216:219], v[80:83], v[32:35]
    ds_read_b128 v[64:67], v2 offset:59392
    buffer_load_dwordx4 v1, s[16:19], s42 offen offset:3072 sc1 lds
    v_mfma_f32_16x16x32_bf16 v[40:43], a[216:219], v[84:87], v[40:43]
    s_add_u32 s45, s45, 65536
    v_mul_f32 v138, v113, v90
    v_fmac_f32 v138, v115, v102
    v_mfma_f32_16x16x32_bf16 v[44:47], a[220:223], v[84:87], v[44:47]
    ds_read_b128 v[68:71], v2 offset:60416
    v_mul_f32 v139, v113, v91
    v_mfma_f32_16x16x32_bf16 v[36:39], a[220:223], v[80:83], v[36:39]
    s_waitcnt lgkmcnt(2)
    v_fmac_f32 v139, v115, v103
    v_mul_f32 v140, v113, v92
    v_mfma_f32_16x16x32_bf16 v[32:35], a[224:227], v[56:59], v[32:35]
    ds_read_b128 v[72:75], v2 offset:61440
    v_fmac_f32 v140, v115, v104
    v_mfma_f32_16x16x32_bf16 v[40:43], a[224:227], v[60:63], v[40:43]
    v_mul_f32 v141, v113, v93
    v_fmac_f32 v141, v115, v105
    v_mfma_f32_16x16x32_bf16 v[44:47], a[228:231], v[60:63], v[44:47]
    ds_read_b128 v[76:79], v2 offset:62464
    v_mul_f32 v142, v113, v94
    v_mfma_f32_16x16x32_bf16 v[36:39], a[228:231], v[56:59], v[36:39]
    s_waitcnt lgkmcnt(2)
    v_fmac_f32 v142, v115, v106
    v_mul_f32 v143, v113, v95
    v_mfma_f32_16x16x32_bf16 v[32:35], a[232:235], v[64:67], v[32:35]
    ds_read_b128 v[80:83], v2 offset:63488
    v_fmac_f32 v143, v115, v107
    v_mfma_f32_16x16x32_bf16 v[40:43], a[232:235], v[68:71], v[40:43]
    v_mfma_f32_16x16x32_bf16 v[44:47], a[236:239], v[68:71], v[44:47]
    ds_read_b128 v[84:87], v2 offset:64512
    v_mfma_f32_16x16x32_bf16 v[36:39], a[236:239], v[64:67], v[36:39]
    s_waitcnt vmcnt(4) lgkmcnt(2)
    s_barrier
    v_mfma_f32_16x16x32_bf16 v[32:35], a[240:243], v[72:75], v[32:35]
    ds_read_b128 v[56:59], v1 offset:0
    v_mfma_f32_16x16x32_bf16 v[40:43], a[240:243], v[76:79], v[40:43]
    v_mfma_f32_16x16x32_bf16 v[44:47], a[244:247], v[76:79], v[44:47]
    ds_read_b128 v[60:63], v1 offset:1024
    v_mfma_f32_16x16x32_bf16 v[36:39], a[244:247], v[72:75], v[36:39]
    s_waitcnt lgkmcnt(2)
    v_mfma_f32_16x16x32_bf16 v[32:35], a[248:251], v[80:83], v[32:35]
    ds_read_b128 v[64:67], v1 offset:2048
    v_mfma_f32_16x16x32_bf16 v[40:43], a[248:251], v[84:87], v[40:43]
    v_mfma_f32_16x16x32_bf16 v[44:47], a[252:255], v[84:87], v[44:47]
    ds_read_b128 v[68:71], v1 offset:3072
    v_mfma_f32_16x16x32_bf16 v[36:39], a[252:255], v[80:83], v[36:39]
    s_add_u32 s36, s36, 1
    s_cmp_lt_u32 s36, 32
    s_cbranch_scc1 L_l_b0
    s_nop 7
    s_and_b32 s44, s90, 0xffffffff
    s_cmp_lt_i32 s36, 1
    s_cselect_b32 s44, 0x5e00000, s44
    s_add_u32 s90, s90, 262144
    v_add_f32 v32, v32, v128
    v_add_f32 v33, v33, v129
    v_mul_f32 v120, v32, v116
    v_mul_f32 v121, v33, v116
    v_mul_f32 v120, v120, abs(v32)
    v_mul_f32 v121, v121, abs(v33)
    v_cvt_pk_bf16_f32 v32, v120, v121
    v_pk_max_i16 v32, v32, 0
    v_add_f32 v34, v34, v130
    v_add_f32 v35, v35, v131
    v_mul_f32 v120, v34, v116
    v_mul_f32 v121, v35, v116
    v_mul_f32 v120, v120, abs(v34)
    v_mul_f32 v121, v121, abs(v35)
    v_cvt_pk_bf16_f32 v33, v120, v121
    v_pk_max_i16 v33, v33, 0
    v_add_f32 v36, v36, v132
    v_add_f32 v37, v37, v133
    v_mul_f32 v120, v36, v116
    v_mul_f32 v121, v37, v116
    v_mul_f32 v120, v120, abs(v36)
    v_mul_f32 v121, v121, abs(v37)
    v_cvt_pk_bf16_f32 v34, v120, v121
    v_pk_max_i16 v34, v34, 0
    v_add_f32 v38, v38, v134
    v_add_f32 v39, v39, v135
    v_mul_f32 v120, v38, v116
    v_mul_f32 v121, v39, v116
    v_mul_f32 v120, v120, abs(v38)
    v_mul_f32 v121, v121, abs(v39)
    v_cvt_pk_bf16_f32 v35, v120, v121
    v_pk_max_i16 v35, v35, 0
    buffer_store_dwordx4 v[32:35], v1, s[16:19], s44 offen offset:0 sc1
    v_add_f32 v40, v40, v136
    v_add_f32 v41, v41, v137
    v_mul_f32 v120, v40, v117
    v_mul_f32 v121, v41, v117
    v_mul_f32 v120, v120, abs(v40)
    v_mul_f32 v121, v121, abs(v41)
    v_cvt_pk_bf16_f32 v40, v120, v121
    v_pk_max_i16 v40, v40, 0
    v_add_f32 v42, v42, v138
    v_add_f32 v43, v43, v139
    v_mul_f32 v120, v42, v117
    v_mul_f32 v121, v43, v117
    v_mul_f32 v120, v120, abs(v42)
    v_mul_f32 v121, v121, abs(v43)
    v_cvt_pk_bf16_f32 v41, v120, v121
    v_pk_max_i16 v41, v41, 0
    v_add_f32 v44, v44, v140
    v_add_f32 v45, v45, v141
    v_mul_f32 v120, v44, v117
    v_mul_f32 v121, v45, v117
    v_mul_f32 v120, v120, abs(v44)
    v_mul_f32 v121, v121, abs(v45)
    v_cvt_pk_bf16_f32 v42, v120, v121
    v_pk_max_i16 v42, v42, 0
    v_add_f32 v46, v46, v142
    v_add_f32 v47, v47, v143
    v_mul_f32 v120, v46, v117
    v_mul_f32 v121, v47, v117
    v_mul_f32 v120, v120, abs(v46)
    v_mul_f32 v121, v121, abs(v47)
    v_cvt_pk_bf16_f32 v43, v120, v121
    v_pk_max_i16 v43, v43, 0
    buffer_store_dwordx4 v[40:43], v1, s[16:19], s44 offen offset:1024 sc1
    s_waitcnt vmcnt(0)
    s_barrier
    buffer_store_dword v124, v124, s[16:19], s91 offen sc1
    s_add_u32 s91, s91, 65536
    s_waitcnt vmcnt(0)
    s_endpgm
L_spin43:
    s_mov_b32 s40, 0x20000
L_spin43_l:
    buffer_load_dword v56, v124, s[20:23], 0 offen sc1
    s_sub_u32 s40, s40, 1
    s_waitcnt vmcnt(0)
    v_cmp_eq_u32 vcc, v124, v56
    s_cbranch_scc1 L_back44
    s_cbranch_vccz L_back44
    s_sleep 8
    s_branch L_spin43_l
L_spin45:
    s_mov_b32 s40, 0x20000
L_spin45_l:
    buffer_load_dword v7, v5, s[16:19], s45 offen sc1
    s_sub_u32 s40, s40, 1
    s_waitcnt vmcnt(0)
    v_cmp_ne_u32 vcc, 0, v7
    s_cbranch_scc1 L_back46
    s_cbranch_vccz L_back46
    s_sleep 2
    s_branch L_spin45_l
L_spin47:
    s_mov_b32 s40, 0x20000
L_spin47_l:
    buffer_load_dword v7, v5, s[16:19], s45 offen sc1
    s_sub_u32 s40, s40, 1
    s_waitcnt vmcnt(0)
    v_cmp_ne_u32 vcc, 0, v7
    s_cbranch_scc1 L_back48
    s_cbranch_vccz L_back48
    s_sleep 2
    s_branch L_spin47_l
L_sspin49:
    s_mov_b32 s40, 0x20000
L_sspin49_l:
    buffer_load_dwordx2 v[144:145], v6, s[16:19], s46 offen offset:0 sc1
    buffer_load_dwordx2 v[146:147], v6, s[16:19], s46 offen offset:128 sc1
    buffer_load_dwordx2 v[148:149], v6, s[16:19], s46 offen offset:256 sc1
    buffer_load_dwordx2 v[150:151], v6, s[16:19], s46 offen offset:384 sc1
    s_sub_u32 s40, s40, 1
    s_waitcnt vmcnt(0)
    v_max3_u32 v152, v144, v145, v146
    v_max3_u32 v153, v147, v148, v149
    v_max3_u32 v152, v152, v150, v151
    v_max_u32 v152, v152, v153
    v_cmp_eq_u32 vcc, -1, v152
    s_cbranch_scc1 L_sback50
    s_cbranch_vccz L_sback50
    s_sleep 4
    s_branch L_sspin49_l
L_spin51:
    s_mov_b32 s40, 0x20000
L_spin51_l:
    buffer_load_dword v7, v5, s[16:19], s45 offen sc1
    s_sub_u32 s40, s40, 1
    s_waitcnt vmcnt(0)
    v_cmp_ne_u32 vcc, 0, v7
    s_cbranch_scc1 L_back52
    s_cbranch_vccz L_back52
    s_sleep 2
    s_branch L_spin51_l
L_sspin53:
    s_mov_b32 s40, 0x20000
L_sspin53_l:
    buffer_load_dwordx2 v[144:145], v6, s[16:19], s46 offen offset:0 sc1
    buffer_load_dwordx2 v[146:147], v6, s[16:19], s46 offen offset:128 sc1
    buffer_load_dwordx2 v[148:149], v6, s[16:19], s46 offen offset:256 sc1
    buffer_load_dwordx2 v[150:151], v6, s[16:19], s46 offen offset:384 sc1
    s_sub_u32 s40, s40, 1
    s_waitcnt vmcnt(0)
    v_max3_u32 v152, v144, v145, v146
    v_max3_u32 v153, v147, v148, v149
    v_max3_u32 v152, v152, v150, v151
    v_max_u32 v152, v152, v153
    v_cmp_eq_u32 vcc, -1, v152
    s_cbranch_scc1 L_sback54
    s_cbranch_vccz L_sback54
    s_sleep 4
    s_branch L_sspin53_l
L_role_44:
    s_sub_u32 s35, s34, 44
    s_cmp_ge_u32 s35, 12
    s_cbranch_scc1 L_bf_nost
    s_lshl_b32 s50, s33, 4
    s_add_u32 s50, s50, s35
    s_lshl_b32 s50, s50, 1
    s_lshl_b32 s46, s50, 15
    s_lshl_b32 s37, s32, 9
    s_add_u32 s46, s46, s37
    v_lshrrev_b32 v48, 3, v0
    v_and_b32 v49, 0x70, v1
    v_lshl_add_u32 v48, v48, 11, v49
    v_add_u32 v49, 16384, v48
    s_mov_b32 s8, s64
    s_mov_b32 s9, s65
    s_mov_b32 s10, 0x400000
    s_mov_b32 s11, 0x00020000
    buffer_load_dwordx4 v[16:19], v48, s[8:11], s46 offen offset:0
    buffer_load_dwordx4 v[20:23], v48, s[8:11], s46 offen offset:128
    buffer_load_dwordx4 v[24:27], v48, s[8:11], s46 offen offset:256
    buffer_load_dwordx4 v[28:31], v48, s[8:11], s46 offen offset:384
    buffer_load_dwordx4 v[32:35], v49, s[8:11], s46 offen offset:0
    buffer_load_dwordx4 v[36:39], v49, s[8:11], s46 offen offset:128
    buffer_load_dwordx4 v[40:43], v49, s[8:11], s46 offen offset:256
    buffer_load_dwordx4 v[44:47], v49, s[8:11], s46 offen offset:384
    s_xor_b32 s50, s50, 1
    s_lshl_b32 s46, s50, 15
    s_lshl_b32 s37, s32, 9
    s_add_u32 s46, s46, s37
    v_lshrrev_b32 v96, 3, v0
    v_and_b32 v97, 0x70, v1
    v_lshl_add_u32 v96, v96, 11, v97
    v_add_u32 v97, 16384, v96
    s_mov_b32 s8, s64
    s_mov_b32 s9, s65
    s_mov_b32 s10, 0x400000
    s_mov_b32 s11, 0x00020000
    buffer_load_dwordx4 v[64:67], v96, s[8:11], s46 offen offset:0
    buffer_load_dwordx4 v[68:71], v96, s[8:11], s46 offen offset:128
    buffer_load_dwordx4 v[72:75], v96, s[8:11], s46 offen offset:256
    buffer_load_dwordx4 v[76:79], v96, s[8:11], s46 offen offset:384
    buffer_load_dwordx4 v[80:83], v97, s[8:11], s46 offen offset:0
    buffer_load_dwordx4 v[84:87], v97, s[8:11], s46 offen offset:128
    buffer_load_dwordx4 v[88:91], v97, s[8:11], s46 offen offset:256
    buffer_load_dwordx4 v[92:95], v97, s[8:11], s46 offen offset:384
    s_xor_b32 s50, s50, 1
    s_mov_b32 s86, 0x3f803f80
    v_and_b32 v56, 1, v0
    v_lshlrev_b32 v56, 7, v56
    v_bfe_u32 v57, v0, 1, 1
    v_lshl_add_u32 v56, v57, 6, v56
    v_and_b32 v57, 0x38, v0
    v_add_u32 v56, v57, v56
    s_sub_u32 s46, 127, s50
    s_lshl_b32 s46, s46, 10
    s_lshl_b32 s37, s32, 8
    s_add_u32 s46, s46, s37
    s_add_u32 s46, s46, 0x5400000
    s_waitcnt vmcnt(8)
    v_dot2_f32_bf16 v48, v16, s86, 0
    v_dot2_f32_bf16 v49, v16, v16, 0
    v_dot2_f32_bf16 v50, v24, s86, 0
    v_dot2_f32_bf16 v51, v24, v24, 0
    v_dot2_f32_bf16 v52, v32, s86, 0
    v_dot2_f32_bf16 v53, v32, v32, 0
    v_dot2_f32_bf16 v54, v40, s86, 0
    v_dot2_f32_bf16 v55, v40, v40, 0
    v_dot2_f32_bf16 v48, v17, s86, v48
    v_dot2_f32_bf16 v49, v17, v17, v49
    v_dot2_f32_bf16 v50, v25, s86, v50
    v_dot2_f32_bf16 v51, v25, v25, v51
    v_dot2_f32_bf16 v52, v33, s86, v52
    v_dot2_f32_bf16 v53, v33, v33, v53
    v_dot2_f32_bf16 v54, v41, s86, v54
    v_dot2_f32_bf16 v55, v41, v41, v55
    v_dot2_f32_bf16 v48, v18, s86, v48
    v_dot2_f32_bf16 v49, v18, v18, v49
    v_dot2_f32_bf16 v50, v26, s86, v50
    v_dot2_f32_bf16 v51, v26, v26, v51
    v_dot2_f32_bf16 v52, v34, s86, v52
    v_dot2_f32_bf16 v53, v34, v34, v53
    v_dot2_f32_bf16 v54, v42, s86, v54
    v_dot2_f32_bf16 v55, v42, v42, v55
    v_dot2_f32_bf16 v48, v19, s86, v48
    v_dot2_f32_bf16 v49, v19, v19, v49
    v_dot2_f32_bf16 v50, v27, s86, v50
    v_dot2_f32_bf16 v51, v27, v27, v51
    v_dot2_f32_bf16 v52, v35, s86, v52
    v_dot2_f32_bf16 v53, v35, v35, v53
    v_dot2_f32_bf16 v54, v43, s86, v54
    v_dot2_f32_bf16 v55, v43, v43, v55
    v_dot2_f32_bf16 v48, v20, s86, v48
    v_dot2_f32_bf16 v49, v20, v20, v49
    v_dot2_f32_bf16 v50, v28, s86, v50
    v_dot2_f32_bf16 v51, v28, v28, v51
    v_dot2_f32_bf16 v52, v36, s86, v52
    v_dot2_f32_bf16 v53, v36, v36, v53
    v_dot2_f32_bf16 v54, v44, s86, v54
    v_dot2_f32_bf16 v55, v44, v44, v55
    v_dot2_f32_bf16 v48, v21, s86, v48
    v_dot2_f32_bf16 v49, v21, v21, v49
    v_dot2_f32_bf16 v50, v29, s86, v50
    v_dot2_f32_bf16 v51, v29, v29, v51
    v_dot2_f32_bf16 v52, v37, s86, v52
    v_dot2_f32_bf16 v53, v37, v37, v53
    v_dot2_f32_bf16 v54, v45, s86, v54
    v_dot2_f32_bf16 v55, v45, v45, v55
    v_dot2_f32_bf16 v48, v22, s86, v48
    v_dot2_f32_bf16 v49, v22, v22, v49
    v_dot2_f32_bf16 v50, v30, s86, v50
    v_dot2_f32_bf16 v51, v30, v30, v51
    v_dot2_f32_bf16 v52, v38, s86, v52
    v_dot2_f32_bf16 v53, v38, v38, v53
    v_dot2_f32_bf16 v54, v46, s86, v54
    v_dot2_f32_bf16 v55, v46, v46, v55
    v_dot2_f32_bf16 v48, v23, s86, v48
    v_dot2_f32_bf16 v49, v23, v23, v49
    v_dot2_f32_bf16 v50, v31, s86, v50
    v_dot2_f32_bf16 v51, v31, v31, v51
    v_dot2_f32_bf16 v52, v39, s86, v52
    v_dot2_f32_bf16 v53, v39, v39, v53
    v_dot2_f32_bf16 v54, v47, s86, v54
    v_dot2_f32_bf16 v55, v47, v47, v55
    v_add_f32_dpp v48, v48, v48 quad_perm:[1,0,3,2] row_mask:0xf bank_mask:0xf
    v_add_f32_dpp v49, v49, v49 quad_perm:[1,0,3,2] row_mask:0xf bank_mask:0xf
    v_add_f32_dpp v50, v50, v50 quad_perm:[1,0,3,2] row_mask:0xf bank_mask:0xf
    v_add_f32_dpp v51, v51, v51 quad_perm:[1,0,3,2] row_mask:0xf bank_mask:0xf
    v_add_f32_dpp v52, v52, v52 quad_perm:[1,0,3,2] row_mask:0xf bank_mask:0xf
    v_add_f32_dpp v53, v53, v53 quad_perm:[1,0,3,2] row_mask:0xf bank_mask:0xf
    v_add_f32_dpp v54, v54, v54 quad_perm:[1,0,3,2] row_mask:0xf bank_mask:0xf
    v_add_f32_dpp v55, v55, v55 quad_perm:[1,0,3,2] row_mask:0xf bank_mask:0xf
    v_add_f32_dpp v48, v48, v48 quad_perm:[2,3,0,1] row_mask:0xf bank_mask:0xf
    v_add_f32_dpp v49, v49, v49 quad_perm:[2,3,0,1] row_mask:0xf bank_mask:0xf
    v_add_f32_dpp v50, v50, v50 quad_perm:[2,3,0,1] row_mask:0xf bank_mask:0xf
    v_add_f32_dpp v51, v51, v51 quad_perm:[2,3,0,1] row_mask:0xf bank_mask:0xf
    v_add_f32_dpp v52, v52, v52 quad_perm:[2,3,0,1] row_mask:0xf bank_mask:0xf
    v_add_f32_dpp v53, v53, v53 quad_perm:[2,3,0,1] row_mask:0xf bank_mask:0xf
    v_add_f32_dpp v54, v54, v54 quad_perm:[2,3,0,1] row_mask:0xf bank_mask:0xf
    v_add_f32_dpp v55, v55, v55 quad_perm:[2,3,0,1] row_mask:0xf bank_mask:0xf
    v_add_f32_dpp v48, v48, v48 row_half_mirror row_mask:0xf bank_mask:0xf
    v_add_f32_dpp v49, v49, v49 row_half_mirror row_mask:0xf bank_mask:0xf
    v_add_f32_dpp v50, v50, v50 row_half_mirror row_mask:0xf bank_mask:0xf
    v_add_f32_dpp v51, v51, v51 row_half_mirror row_mask:0xf bank_mask:0xf
    v_add_f32_dpp v52, v52, v52 row_half_mirror row_mask:0xf bank_mask:0xf
    v_add_f32_dpp v53, v53, v53 row_half_mirror row_mask:0xf bank_mask:0xf
    v_add_f32_dpp v54, v54, v54 row_half_mirror row_mask:0xf bank_mask:0xf
    v_add_f32_dpp v55, v55, v55 row_half_mirror row_mask:0xf bank_mask:0xf
    s_mov_b32 exec_lo, 0x2020202
    s_mov_b32 exec_hi, 0x2020202
    v_mov_b32 v48, v50
    v_mov_b32 v49, v51
    s_mov_b32 exec_lo, 0x4040404
    s_mov_b32 exec_hi, 0x4040404
    v_mov_b32 v48, v52
    v_mov_b32 v49, v53
    s_mov_b32 exec_lo, 0x8080808
    s_mov_b32 exec_hi, 0x8080808
    v_mov_b32 v48, v54
    v_mov_b32 v49, v55
    s_mov_b32 exec_lo, 0x0f0f0f0f
    s_mov_b32 exec_hi, 0x0f0f0f0f
    buffer_store_dwordx2 v[48:49], v56, s[16:19], s46 offen sc1
    s_mov_b64 exec, -1
    s_xor_b32 s50, s50, 1
    s_mov_b32 s86, 0x3f803f80
    v_and_b32 v104, 1, v0
    v_lshlrev_b32 v104, 7, v104
    v_bfe_u32 v105, v0, 1, 1
    v_lshl_add_u32 v104, v105, 6, v104
    v_and_b32 v105, 0x38, v0
    v_add_u32 v104, v105, v104
    s_sub_u32 s46, 127, s50
    s_lshl_b32 s46, s46, 10
    s_lshl_b32 s37, s32, 8
    s_add_u32 s46, s46, s37
    s_add_u32 s46, s46, 0x5400000
    s_waitcnt vmcnt(1)
    v_dot2_f32_bf16 v96, v64, s86, 0
    v_dot2_f32_bf16 v97, v64, v64, 0
    v_dot2_f32_bf16 v98, v72, s86, 0
    v_dot2_f32_bf16 v99, v72, v72, 0
    v_dot2_f32_bf16 v100, v80, s86, 0
    v_dot2_f32_bf16 v101, v80, v80, 0
    v_dot2_f32_bf16 v102, v88, s86, 0
    v_dot2_f32_bf16 v103, v88, v88, 0
    v_dot2_f32_bf16 v96, v65, s86, v96
    v_dot2_f32_bf16 v97, v65, v65, v97
    v_dot2_f32_bf16 v98, v73, s86, v98
    v_dot2_f32_bf16 v99, v73, v73, v99
    v_dot2_f32_bf16 v100, v81, s86, v100
    v_dot2_f32_bf16 v101, v81, v81, v101
    v_dot2_f32_bf16 v102, v89, s86, v102
    v_dot2_f32_bf16 v103, v89, v89, v103
    v_dot2_f32_bf16 v96, v66, s86, v96
    v_dot2_f32_bf16 v97, v66, v66, v97
    v_dot2_f32_bf16 v98, v74, s86, v98
    v_dot2_f32_bf16 v99, v74, v74, v99
    v_dot2_f32_bf16 v100, v82, s86, v100
    v_dot2_f32_bf16 v101, v82, v82, v101
    v_dot2_f32_bf16 v102, v90, s86, v102
    v_dot2_f32_bf16 v103, v90, v90, v103
    v_dot2_f32_bf16 v96, v67, s86, v96
    v_dot2_f32_bf16 v97, v67, v67, v97
    v_dot2_f32_bf16 v98, v75, s86, v98
    v_dot2_f32_bf16 v99, v75, v75, v99
    v_dot2_f32_bf16 v100, v83, s86, v100
    v_dot2_f32_bf16 v101, v83, v83, v101
    v_dot2_f32_bf16 v102, v91, s86, v102
    v_dot2_f32_bf16 v103, v91, v91, v103
    v_dot2_f32_bf16 v96, v68, s86, v96
    v_dot2_f32_bf16 v97, v68, v68, v97
    v_dot2_f32_bf16 v98, v76, s86, v98
    v_dot2_f32_bf16 v99, v76, v76, v99
    v_dot2_f32_bf16 v100, v84, s86, v100
    v_dot2_f32_bf16 v101, v84, v84, v101
    v_dot2_f32_bf16 v102, v92, s86, v102
    v_dot2_f32_bf16 v103, v92, v92, v103
    v_dot2_f32_bf16 v96, v69, s86, v96
    v_dot2_f32_bf16 v97, v69, v69, v97
    v_dot2_f32_bf16 v98, v77, s86, v98
    v_dot2_f32_bf16 v99, v77, v77, v99
    v_dot2_f32_bf16 v100, v85, s86, v100
    v_dot2_f32_bf16 v101, v85, v85, v101
    v_dot2_f32_bf16 v102, v93, s86, v102
    v_dot2_f32_bf16 v103, v93, v93, v103
    v_dot2_f32_bf16 v96, v70, s86, v96
    v_dot2_f32_bf16 v97, v70, v70, v97
    v_dot2_f32_bf16 v98, v78, s86, v98
    v_dot2_f32_bf16 v99, v78, v78, v99
    v_dot2_f32_bf16 v100, v86, s86, v100
    v_dot2_f32_bf16 v101, v86, v86, v101
    v_dot2_f32_bf16 v102, v94, s86, v102
    v_dot2_f32_bf16 v103, v94, v94, v103
    v_dot2_f32_bf16 v96, v71, s86, v96
    v_dot2_f32_bf16 v97, v71, v71, v97
    v_dot2_f32_bf16 v98, v79, s86, v98
    v_dot2_f32_bf16 v99, v79, v79, v99
    v_dot2_f32_bf16 v100, v87, s86, v100
    v_dot2_f32_bf16 v101, v87, v87, v101
    v_dot2_f32_bf16 v102, v95, s86, v102
    v_dot2_f32_bf16 v103, v95, v95, v103
    v_add_f32_dpp v96, v96, v96 quad_perm:[1,0,3,2] row_mask:0xf bank_mask:0xf
    v_add_f32_dpp v97, v97, v97 quad_perm:[1,0,3,2] row_mask:0xf bank_mask:0xf
    v_add_f32_dpp v98, v98, v98 quad_perm:[1,0,3,2] row_mask:0xf bank_mask:0xf
    v_add_f32_dpp v99, v99, v99 quad_perm:[1,0,3,2] row_mask:0xf bank_mask:0xf
    v_add_f32_dpp v100, v100, v100 quad_perm:[1,0,3,2] row_mask:0xf bank_mask:0xf
    v_add_f32_dpp v101, v101, v101 quad_perm:[1,0,3,2] row_mask:0xf bank_mask:0xf
    v_add_f32_dpp v102, v102, v102 quad_perm:[1,0,3,2] row_mask:0xf bank_mask:0xf
    v_add_f32_dpp v103, v103, v103 quad_perm:[1,0,3,2] row_mask:0xf bank_mask:0xf
    v_add_f32_dpp v96, v96, v96 quad_perm:[2,3,0,1] row_mask:0xf bank_mask:0xf
    v_add_f32_dpp v97, v97, v97 quad_perm:[2,3,0,1] row_mask:0xf bank_mask:0xf
    v_add_f32_dpp v98, v98, v98 quad_perm:[2,3,0,1] row_mask:0xf bank_mask:0xf
    v_add_f32_dpp v99, v99, v99 quad_perm:[2,3,0,1] row_mask:0xf bank_mask:0xf
    v_add_f32_dpp v100, v100, v100 quad_perm:[2,3,0,1] row_mask:0xf bank_mask:0xf
    v_add_f32_dpp v101, v101, v101 quad_perm:[2,3,0,1] row_mask:0xf bank_mask:0xf
    v_add_f32_dpp v102, v102, v102 quad_perm:[2,3,0,1] row_mask:0xf bank_mask:0xf
    v_add_f32_dpp v103, v103, v103 quad_perm:[2,3,0,1] row_mask:0xf bank_mask:0xf
    v_add_f32_dpp v96, v96, v96 row_half_mirror row_mask:0xf bank_mask:0xf
    v_add_f32_dpp v97, v97, v97 row_half_mirror row_mask:0xf bank_mask:0xf
    v_add_f32_dpp v98, v98, v98 row_half_mirror row_mask:0xf bank_mask:0xf
    v_add_f32_dpp v99, v99, v99 row_half_mirror row_mask:0xf bank_mask:0xf
    v_add_f32_dpp v100, v100, v100 row_half_mirror row_mask:0xf bank_mask:0xf
    v_add_f32_dpp v101, v101, v101 row_half_mirror row_mask:0xf bank_mask:0xf
    v_add_f32_dpp v102, v102, v102 row_half_mirror row_mask:0xf bank_mask:0xf
    v_add_f32_dpp v103, v103, v103 row_half_mirror row_mask:0xf bank_mask:0xf
    s_mov_b32 exec_lo, 0x2020202
    s_mov_b32 exec_hi, 0x2020202
    v_mov_b32 v96, v98
    v_mov_b32 v97, v99
    s_mov_b32 exec_lo, 0x4040404
    s_mov_b32 exec_hi, 0x4040404
    v_mov_b32 v96, v100
    v_mov_b32 v97, v101
    s_mov_b32 exec_lo, 0x8080808
    s_mov_b32 exec_hi, 0x8080808
    v_mov_b32 v96, v102
    v_mov_b32 v97, v103
    s_mov_b32 exec_lo, 0x0f0f0f0f
    s_mov_b32 exec_hi, 0x0f0f0f0f
    buffer_store_dwordx2 v[96:97], v104, s[16:19], s46 offen sc1
    s_mov_b64 exec, -1
    s_xor_b32 s50, s50, 1
L_bf_nost:
    s_cmp_lg_u32 s32, 0
    s_cbranch_scc1 L_arv55
    s_add_u32 s20, s82, 0x80
    s_addc_u32 s21, s83, 0
    s_mov_b32 s22, 0x4
    s_mov_b32 s23, 0x00020000
    buffer_load_dword v8, v124, s[20:23], 0 offen sc1
    s_waitcnt vmcnt(0)
    v_cmp_eq_u32 vcc, v124, v8
    s_cbranch_vccnz L_spin56
L_back57:
L_arv55:
    s_waitcnt vmcnt(0)
    s_barrier
    s_add_u32 s39, s91, 32768
    buffer_store_dword v124, v124, s[16:19], s39 offen sc1
    s_cmp_lt_u32 s35, 12
    s_cbranch_scc1 L_bf_nopf
    s_add_u32 s12, s72, 0x400000
    s_addc_u32 s13, s73, 0
    s_mov_b32 s14, 0x300000
    s_mov_b32 s15, 0x00020000
    s_sub_u32 s37, s35, 12
    s_lshl2_add_u32 s37, s37, s33
    s_lshl2_add_u32 s37, s37, s32
    s_lshl_b32 s37, s37, 13
    v_lshlrev_b32 v6, 7, v0
    buffer_load_dword v240, v6, s[12:15], s37 offen
    s_add_u32 s37, s37, 1048576
    buffer_load_dword v241, v6, s[12:15], s37 offen
    s_add_u32 s37, s37, 1048576
    buffer_load_dword v242, v6, s[12:15], s37 offen
    s_add_u32 s37, s37, 1048576
L_bf_nopf:
    s_lshr_b32 s51, s35, 2
    s_and_b32 s87, s35, 3
    s_mul_i32 s54, s51, 1507328
    s_lshl_b32 s37, s87, 9
    s_add_u32 s54, s54, s37
    s_mov_b32 s12, s76
    s_mov_b32 s13, s77
    s_mov_b32 s14, 0x700000
    s_mov_b32 s15, 0x00020000
    s_mov_b32 s39, 2048
    v_lshrrev_b32 v64, 3, v0
    v_lshlrev_b32 v65, 2, v0
    v_and_b32 v65, 64, v65
    v_and_b32 v66, 0x70, v1
    v_xor_b32 v65, v65, v66
    v_mad_u32_u24 v48, v64, s39, v65
    v_add_u32 v49, 16384, v48
    v_add_u32 v50, 128, v48
    v_add_u32 v51, 16512, v48
    v_add_u32 v52, 256, v48
    v_add_u32 v53, 16640, v48
    v_add_u32 v54, 384, v48
    v_add_u32 v55, 16768, v48
    s_mul_i32 s38, s32, 32768
    s_add_u32 s54, s54, s38
    s_lshl_b32 s42, s32, 11
    s_add_u32 m0, s42, 0
    s_nop 0
    buffer_load_dwordx4 v48, s[12:15], s54 offen lds
    s_add_u32 m0, s42, 1024
    s_nop 0
    buffer_load_dwordx4 v49, s[12:15], s54 offen lds
    s_add_u32 m0, s42, 8192
    s_nop 0
    buffer_load_dwordx4 v50, s[12:15], s54 offen lds
    s_add_u32 m0, s42, 9216
    s_nop 0
    buffer_load_dwordx4 v51, s[12:15], s54 offen lds
    s_add_u32 m0, s42, 16384
    s_nop 0
    buffer_load_dwordx4 v52, s[12:15], s54 offen lds
    s_add_u32 m0, s42, 17408
    s_nop 0
    buffer_load_dwordx4 v53, s[12:15], s54 offen lds
    s_add_u32 m0, s42, 24576
    s_nop 0
    buffer_load_dwordx4 v54, s[12:15], s54 offen lds
    s_add_u32 m0, s42, 25600
    s_nop 0
    buffer_load_dwordx4 v55, s[12:15], s54 offen lds
    s_add_u32 s54, s54, 131072
    s_add_u32 m0, s42, 32768
    s_nop 0
    buffer_load_dwordx4 v48, s[12:15], s54 offen lds
    s_add_u32 m0, s42, 33792
    s_nop 0
    buffer_load_dwordx4 v49, s[12:15], s54 offen lds
    s_add_u32 m0, s42, 40960
    s_nop 0
    buffer_load_dwordx4 v50, s[12:15], s54 offen lds
    s_add_u32 m0, s42, 41984
    s_nop 0
    buffer_load_dwordx4 v51, s[12:15], s54 offen lds
    s_add_u32 m0, s42, 49152
    s_nop 0
    buffer_load_dwordx4 v52, s[12:15], s54 offen lds
    s_add_u32 m0, s42, 50176
    s_nop 0
    buffer_load_dwordx4 v53, s[12:15], s54 offen lds
    s_add_u32 m0, s42, 57344
    s_nop 0
    buffer_load_dwordx4 v54, s[12:15], s54 offen lds
    s_add_u32 m0, s42, 58368
    s_nop 0
    buffer_load_dwordx4 v55, s[12:15], s54 offen lds
    s_add_u32 s54, s54, 131072
    s_add_u32 m0, s42, 65536
    s_nop 0
    buffer_load_dwordx4 v48, s[12:15], s54 offen lds
    s_add_u32 m0, s42, 66560
    s_nop 0
    buffer_load_dwordx4 v49, s[12:15], s54 offen lds
    s_add_u32 m0, s42, 73728
    s_nop 0
    buffer_load_dwordx4 v50, s[12:15], s54 offen lds
    s_add_u32 m0, s42, 74752
    s_nop 0
    buffer_load_dwordx4 v51, s[12:15], s54 offen lds
    s_add_u32 m0, s42, 81920
    s_nop 0
    buffer_load_dwordx4 v52, s[12:15], s54 offen lds
    s_add_u32 m0, s42, 82944
    s_nop 0
    buffer_load_dwordx4 v53, s[12:15], s54 offen lds
    s_add_u32 m0, s42, 90112
    s_nop 0
    buffer_load_dwordx4 v54, s[12:15], s54 offen lds
    s_add_u32 m0, s42, 91136
    s_nop 0
    buffer_load_dwordx4 v55, s[12:15], s54 offen lds
    s_add_u32 s54, s54, 131072
    s_add_u32 m0, s42, 98304
    s_nop 0
    buffer_load_dwordx4 v48, s[12:15], s54 offen lds
    s_add_u32 m0, s42, 99328
    s_nop 0
    buffer_load_dwordx4 v49, s[12:15], s54 offen lds
    s_add_u32 m0, s42, 106496
    s_nop 0
    buffer_load_dwordx4 v50, s[12:15], s54 offen lds
    s_add_u32 m0, s42, 107520
    s_nop 0
    buffer_load_dwordx4 v51, s[12:15], s54 offen lds
    s_add_u32 m0, s42, 114688
    s_nop 0
    buffer_load_dwordx4 v52, s[12:15], s54 offen lds
    s_add_u32 m0, s42, 115712
    s_nop 0
    buffer_load_dwordx4 v53, s[12:15], s54 offen lds
    s_add_u32 m0, s42, 122880
    s_nop 0
    buffer_load_dwordx4 v54, s[12:15], s54 offen lds
    s_add_u32 m0, s42, 123904
    s_nop 0
    buffer_load_dwordx4 v55, s[12:15], s54 offen lds
    s_add_u32 s54, s54, 131072
    v_lshrrev_b32 v64, 4, v0
    v_bfe_u32 v65, v0, 2, 2
    v_lshl_add_u32 v64, v64, 3, v65
    v_lshlrev_b32 v64, 7, v64
    v_lshrrev_b32 v65, 1, v65
    v_lshl_add_u32 v64, v65, 6, v64
    v_and_b32 v65, 3, v0
    v_lshl_add_u32 v64, v65, 4, v64
    s_lshl_b32 s37, s32, 13
    s_and_b32 s38, s51, 2
    s_lshl_b32 s38, s38, 5
    s_xor_b32 s38, s38, 0
    s_add_u32 s37, s37, s38
    v_xor_b32 v56, s37, v64
    s_lshl_b32 s37, s32, 13
    s_and_b32 s38, s51, 2
    s_lshl_b32 s38, s38, 5
    s_xor_b32 s38, s38, 8
    s_add_u32 s37, s37, s38
    v_xor_b32 v57, s37, v64
    s_lshl_b32 s37, s32, 13
    s_and_b32 s38, s51, 2
    s_lshl_b32 s38, s38, 5
    s_xor_b32 s38, s38, 64
    s_add_u32 s37, s37, s38
    v_xor_b32 v58, s37, v64
    s_lshl_b32 s37, s32, 13
    s_and_b32 s38, s51, 2
    s_lshl_b32 s38, s38, 5
    s_xor_b32 s38, s38, 72
    s_add_u32 s37, s37, s38
    v_xor_b32 v59, s37, v64
    s_and_b32 s39, s51, 1
    s_lshl_b32 s37, s39, 10
    v_add_u32 v2, s37, v1
    v_xor_b32 v3, 1024, v2
    v_add_u32 v4, 98304, v2
    v_add_u32 v5, 98304, v3
    s_mul_i32 s38, s51, 11*43
    s_lshr_b32 s38, s38, 7
    s_add_u32 s38, s38, 24
    s_lshl_b32 s37, s33, 6
    s_add_u32 s37, s37, s38
    s_lshl_b32 s37, s37, 7
    v_lshl_add_u32 v6, v0, 7, s37
    s_cmp_eq_u32 s32, 0
    s_cselect_b32 s37, 5, 0
    v_cmp_le_u32 vcc, s37, v0
    s_nop 1
    v_cndmask_b32 v6, v6, 2.0, vcc
    s_mul_i32 s43, s32, 4096
    s_mul_i32 s88, s32, 4096
    s_sub_u32 s89, s88, s43
    s_mul_i32 s41, s33, 8388608
    s_add_u32 s41, s41, 0x1000000
    s_mul_i32 s37, s51, 47104
    s_add_u32 s41, s41, s37
    s_add_u32 s41, s41, s43
    s_mul_i32 s90, s33, 8388608
    s_add_u32 s90, s90, 0x2fc0000
    s_lshl_b32 s37, s87, 16
    s_add_u32 s90, s90, s37
    s_lshl_b32 s37, s32, 12
    s_add_u32 s90, s90, s37
    s_and_b32 s37, s51, 3
    s_lshl_b32 s37, s37, 14
    s_add_u32 s90, s90, s37
    s_mov_b32 s86, 0xffff0000
    s_add_u32 s38, s87, 44
    s_lshl_b32 s37, s33, 6
    s_add_u32 s37, s37, s38
    s_lshl_b32 s37, s37, 7
    v_lshl_add_u32 v8, v0, 9, s37
    v_cmp_le_u32 vcc, 5, v0
    s_nop 1
    v_cndmask_b32 v8, v8, 2.0, vcc
    s_lshl_b32 s38, s87, 2
    s_add_u32 s38, s38, s32
    s_lshl_b32 s38, s38, 1
    s_lshr_b32 s37, s51, 1
    s_add_u32 s38, s38, s37
    s_mul_i32 s53, s33, 2097152
    s_add_u32 s53, s53, 0x7f0000
    s_lshl_b32 s37, s38, 11
    s_add_u32 s53, s53, s37
    s_lshl_b32 s37, s39, 10
    s_add_u32 s53, s53, s37
    v_and_b32 v16, 15, v0
    v_and_b32 v17, 0x30, v0
    s_lshl_b32 s38, s38, 6
    s_mov_b32 s8, s78
    s_mov_b32 s9, s79
    s_mov_b32 s10, 0x800
    s_mov_b32 s11, 0x00020000
    buffer_load_dwordx4 v[24:27], v17, s[8:11], s38 offen
    v_lshl_add_u32 v9, v16, 11, v17
    v_add_u32 v9, s38, v9
    s_lshl_b32 s50, s33, 5
    s_add_u32 s50, s50, 31
    s_sub_u32 s50, s50, s39
    v_bfe_u32 v17, v0, 4, 1
    v_lshl_add_u32 v16, v16, 1, v17
    s_lshl_b32 s37, s32, 2
    s_add_u32 s37, s37, 65536
    v_lshl_add_u32 v10, v16, 4, s37
    v_and_b32 v16, 31, v0
    v_lshrrev_b32 v12, 5, v0
    v_lshlrev_b32 v12, 30, v12
    v_lshl_add_u32 v12, v16, 2, v12
    v_lshlrev_b32 v16, 4, v16
    v_add_u32 v11, 65536, v16
    s_lshl_b32 s37, s87, 1
    s_lshr_b32 s38, s51, 1
    s_add_u32 s37, s37, s38
    s_lshl_b32 s37, s37, 7
    s_add_u32 s55, s37, 0x543fc00
    s_cmp_eq_u32 s32, 2
    s_cselect_b32 s55, s55, 0x5f00000
    v_add_u32 v60, 0, v56
    v_add_u32 v61, 0, v57
    v_add_u32 v62, 0, v58
    v_add_u32 v63, 0, v59
    s_waitcnt vmcnt(25)
    s_barrier
    ds_read_b64_tr_b16 a[0:1], v60 offset:0
    ds_read_b64_tr_b16 a[2:3], v60 offset:512
    ds_read_b64_tr_b16 a[4:5], v61 offset:0
    ds_read_b64_tr_b16 a[6:7], v61 offset:512
    ds_read_b64_tr_b16 a[8:9], v62 offset:0
    ds_read_b64_tr_b16 a[10:11], v62 offset:512
    ds_read_b64_tr_b16 a[12:13], v63 offset:0
    ds_read_b64_tr_b16 a[14:15], v63 offset:512
    ds_read_b64_tr_b16 a[16:17], v60 offset:4096
    ds_read_b64_tr_b16 a[18:19], v60 offset:4608
    ds_read_b64_tr_b16 a[20:21], v61 offset:4096
    ds_read_b64_tr_b16 a[22:23], v61 offset:4608
    ds_read_b64_tr_b16 a[24:25], v62 offset:4096
    ds_read_b64_tr_b16 a[26:27], v62 offset:4608
    ds_read_b64_tr_b16 a[28:29], v63 offset:4096
    ds_read_b64_tr_b16 a[30:31], v63 offset:4608
    s_add_u32 m0, s42, 131072
    s_nop 0
    buffer_load_dwordx4 v48, s[12:15], s54 offen lds
    s_add_u32 m0, s42, 132096
    s_nop 0
    buffer_load_dwordx4 v49, s[12:15], s54 offen lds
    s_add_u32 m0, s42, 139264
    s_nop 0
    buffer_load_dwordx4 v50, s[12:15], s54 offen lds
    s_add_u32 m0, s42, 140288
    s_nop 0
    buffer_load_dwordx4 v51, s[12:15], s54 offen lds
    s_add_u32 m0, s42, 147456
    s_nop 0
    buffer_load_dwordx4 v52, s[12:15], s54 offen lds
    s_add_u32 m0, s42, 148480
    s_nop 0
    buffer_load_dwordx4 v53, s[12:15], s54 offen lds
    s_add_u32 m0, s42, 155648
    s_nop 0
    buffer_load_dwordx4 v54, s[12:15], s54 offen lds
    s_add_u32 m0, s42, 156672
    s_nop 0
    buffer_load_dwordx4 v55, s[12:15], s54 offen lds
    s_add_u32 s54, s54, 131072
    s_waitcnt lgkmcnt(0)
    v_add_u32 v60, 32768, v56
    v_add_u32 v61, 32768, v57
    v_add_u32 v62, 32768, v58
    v_add_u32 v63, 32768, v59
    s_waitcnt vmcnt(25)
    s_barrier
    ds_read_b64_tr_b16 a[32:33], v60 offset:0
    ds_read_b64_tr_b16 a[34:35], v60 offset:512
    ds_read_b64_tr_b16 a[36:37], v61 offset:0
    ds_read_b64_tr_b16 a[38:39], v61 offset:512
    ds_read_b64_tr_b16 a[40:41], v62 offset:0
    ds_read_b64_tr_b16 a[42:43], v62 offset:512
    ds_read_b64_tr_b16 a[44:45], v63 offset:0
    ds_read_b64_tr_b16 a[46:47], v63 offset:512
    ds_read_b64_tr_b16 a[48:49], v60 offset:4096
    ds_read_b64_tr_b16 a[50:51], v60 offset:4608
    ds_read_b64_tr_b16 a[52:53], v61 offset:4096
    ds_read_b64_tr_b16 a[54:55], v61 offset:4608
    ds_read_b64_tr_b16 a[56:57], v62 offset:4096
    ds_read_b64_tr_b16 a[58:59], v62 offset:4608
    ds_read_b64_tr_b16 a[60:61], v63 offset:4096
    ds_read_b64_tr_b16 a[62:63], v63 offset:4608
    s_add_u32 m0, s42, 0
    s_nop 0
    buffer_load_dwordx4 v48, s[12:15], s54 offen lds
    s_add_u32 m0, s42, 1024
    s_nop 0
    buffer_load_dwordx4 v49, s[12:15], s54 offen lds
    s_add_u32 m0, s42, 8192
    s_nop 0
    buffer_load_dwordx4 v50, s[12:15], s54 offen lds
    s_add_u32 m0, s42, 9216
    s_nop 0
    buffer_load_dwordx4 v51, s[12:15], s54 offen lds
    s_add_u32 m0, s42, 16384
    s_nop 0
    buffer_load_dwordx4 v52, s[12:15], s54 offen lds
    s_add_u32 m0, s42, 17408
    s_nop 0
    buffer_load_dwordx4 v53, s[12:15], s54 offen lds
    s_add_u32 m0, s42, 24576
    s_nop 0
    buffer_load_dwordx4 v54, s[12:15], s54 offen lds
    s_add_u32 m0, s42, 25600
    s_nop 0
    buffer_load_dwordx4 v55, s[12:15], s54 offen lds
    s_add_u32 s54, s54, 131072
    s_waitcnt lgkmcnt(0)
    v_add_u32 v60, 65536, v56
    v_add_u32 v61, 65536, v57
    v_add_u32 v62, 65536, v58
    v_add_u32 v63, 65536, v59
    s_waitcnt vmcnt(25)
    s_barrier
    ds_read_b64_tr_b16 a[64:65], v60 offset:0
    ds_read_b64_tr_b16 a[66:67], v60 offset:512
    ds_read_b64_tr_b16 a[68:69], v61 offset:0
    ds_read_b64_tr_b16 a[70:71], v61 offset:512
    ds_read_b64_tr_b16 a[72:73], v62 offset:0
    ds_read_b64_tr_b16 a[74:75], v62 offset:512
    ds_read_b64_tr_b16 a[76:77], v63 offset:0
    ds_read_b64_tr_b16 a[78:79], v63 offset:512
    ds_read_b64_tr_b16 a[80:81], v60 offset:4096
    ds_read_b64_tr_b16 a[82:83], v60 offset:4608
    ds_read_b64_tr_b16 a[84:85], v61 offset:4096
    ds_read_b64_tr_b16 a[86:87], v61 offset:4608
    ds_read_b64_tr_b16 a[88:89], v62 offset:4096
    ds_read_b64_tr_b16 a[90:91], v62 offset:4608
    ds_read_b64_tr_b16 a[92:93], v63 offset:4096
    ds_read_b64_tr_b16 a[94:95], v63 offset:4608
    s_add_u32 m0, s42, 32768
    s_nop 0
    buffer_load_dwordx4 v48, s[12:15], s54 offen lds
    s_add_u32 m0, s42, 33792
    s_nop 0
    buffer_load_dwordx4 v49, s[12:15], s54 offen lds
    s_add_u32 m0, s42, 40960
    s_nop 0
    buffer_load_dwordx4 v50, s[12:15], s54 offen lds
    s_add_u32 m0, s42, 41984
    s_nop 0
    buffer_load_dwordx4 v51, s[12:15], s54 offen lds
    s_add_u32 m0, s42, 49152
    s_nop 0
    buffer_load_dwordx4 v52, s[12:15], s54 offen lds
    s_add_u32 m0, s42, 50176
    s_nop 0
    buffer_load_dwordx4 v53, s[12:15], s54 offen lds
    s_add_u32 m0, s42, 57344
    s_nop 0
    buffer_load_dwordx4 v54, s[12:15], s54 offen lds
    s_add_u32 m0, s42, 58368
    s_nop 0
    buffer_load_dwordx4 v55, s[12:15], s54 offen lds
    s_add_u32 s54, s54, 131072
    s_waitcnt lgkmcnt(0)
    v_add_u32 v60, 98304, v56
    v_add_u32 v61, 98304, v57
    v_add_u32 v62, 98304, v58
    v_add_u32 v63, 98304, v59
    s_waitcnt vmcnt(25)
    s_barrier
    ds_read_b64_tr_b16 a[96:97], v60 offset:0
    ds_read_b64_tr_b16 a[98:99], v60 offset:512
    ds_read_b64_tr_b16 a[100:101], v61 offset:0
    ds_read_b64_tr_b16 a[102:103], v61 offset:512
    ds_read_b64_tr_b16 a[104:105], v62 offset:0
    ds_read_b64_tr_b16 a[106:107], v62 offset:512
    ds_read_b64_tr_b16 a[108:109], v63 offset:0
    ds_read_b64_tr_b16 a[110:111], v63 offset:512
    ds_read_b64_tr_b16 a[112:113], v60 offset:4096
    ds_read_b64_tr_b16 a[114:115], v60 offset:4608
    ds_read_b64_tr_b16 a[116:117], v61 offset:4096
    ds_read_b64_tr_b16 a[118:119], v61 offset:4608
    ds_read_b64_tr_b16 a[120:121], v62 offset:4096
    ds_read_b64_tr_b16 a[122:123], v62 offset:4608
    ds_read_b64_tr_b16 a[124:125], v63 offset:4096
    ds_read_b64_tr_b16 a[126:127], v63 offset:4608
    s_add_u32 m0, s42, 65536
    s_nop 0
    buffer_load_dwordx4 v48, s[12:15], s54 offen lds
    s_add_u32 m0, s42, 66560
    s_nop 0
    buffer_load_dwordx4 v49, s[12:15], s54 offen lds
    s_add_u32 m0, s42, 73728
    s_nop 0
    buffer_load_dwordx4 v50, s[12:15], s54 offen lds
    s_add_u32 m0, s42, 74752
    s_nop 0
    buffer_load_dwordx4 v51, s[12:15], s54 offen lds
    s_add_u32 m0, s42, 81920
    s_nop 0
    buffer_load_dwordx4 v52, s[12:15], s54 offen lds
    s_add_u32 m0, s42, 82944
    s_nop 0
    buffer_load_dwordx4 v53, s[12:15], s54 offen lds
    s_add_u32 m0, s42, 90112
    s_nop 0
    buffer_load_dwordx4 v54, s[12:15], s54 offen lds
    s_add_u32 m0, s42, 91136
    s_nop 0
    buffer_load_dwordx4 v55, s[12:15], s54 offen lds
    s_add_u32 s54, s54, 131072
    s_waitcnt lgkmcnt(0)
    v_add_u32 v60, 131072, v56
    v_add_u32 v61, 131072, v57
    v_add_u32 v62, 131072, v58
    v_add_u32 v63, 131072, v59
    s_waitcnt vmcnt(24)
    s_barrier
    ds_read_b64_tr_b16 a[128:129], v60 offset:0
    ds_read_b64_tr_b16 a[130:131], v60 offset:512
    ds_read_b64_tr_b16 a[132:133], v61 offset:0
    ds_read_b64_tr_b16 a[134:135], v61 offset:512
    ds_read_b64_tr_b16 a[136:137], v62 offset:0
    ds_read_b64_tr_b16 a[138:139], v62 offset:512
    ds_read_b64_tr_b16 a[140:141], v63 offset:0
    ds_read_b64_tr_b16 a[142:143], v63 offset:512
    ds_read_b64_tr_b16 a[144:145], v60 offset:4096
    ds_read_b64_tr_b16 a[146:147], v60 offset:4608
    ds_read_b64_tr_b16 a[148:149], v61 offset:4096
    ds_read_b64_tr_b16 a[150:151], v61 offset:4608
    ds_read_b64_tr_b16 a[152:153], v62 offset:4096
    ds_read_b64_tr_b16 a[154:155], v62 offset:4608
    ds_read_b64_tr_b16 a[156:157], v63 offset:4096
    ds_read_b64_tr_b16 a[158:159], v63 offset:4608
    s_add_u32 m0, s42, 98304
    s_nop 0
    buffer_load_dwordx4 v48, s[12:15], s54 offen lds
    s_add_u32 m0, s42, 99328
    s_nop 0
    buffer_load_dwordx4 v49, s[12:15], s54 offen lds
    s_add_u32 m0, s42, 106496
    s_nop 0
    buffer_load_dwordx4 v50, s[12:15], s54 offen lds
    s_add_u32 m0, s42, 107520
    s_nop 0
    buffer_load_dwordx4 v51, s[12:15], s54 offen lds
    s_add_u32 m0, s42, 114688
    s_nop 0
    buffer_load_dwordx4 v52, s[12:15], s54 offen lds
    s_add_u32 m0, s42, 115712
    s_nop 0
    buffer_load_dwordx4 v53, s[12:15], s54 offen lds
    s_add_u32 m0, s42, 122880
    s_nop 0
    buffer_load_dwordx4 v54, s[12:15], s54 offen lds
    s_add_u32 m0, s42, 123904
    s_nop 0
    buffer_load_dwordx4 v55, s[12:15], s54 offen lds
    s_add_u32 s54, s54, 131072
    s_waitcnt lgkmcnt(0)
    v_add_u32 v60, 0, v56
    v_add_u32 v61, 0, v57
    v_add_u32 v62, 0, v58
    v_add_u32 v63, 0, v59
    s_waitcnt vmcnt(24)
    s_barrier
    ds_read_b64_tr_b16 a[160:161], v60 offset:0
    ds_read_b64_tr_b16 a[162:163], v60 offset:512
    ds_read_b64_tr_b16 a[164:165], v61 offset:0
    ds_read_b64_tr_b16 a[166:167], v61 offset:512
    ds_read_b64_tr_b16 a[168:169], v62 offset:0
    ds_read_b64_tr_b16 a[170:171], v62 offset:512
    ds_read_b64_tr_b16 a[172:173], v63 offset:0
    ds_read_b64_tr_b16 a[174:175], v63 offset:512
    ds_read_b64_tr_b16 a[176:177], v60 offset:4096
    ds_read_b64_tr_b16 a[178:179], v60 offset:4608
    ds_read_b64_tr_b16 a[180:181], v61 offset:4096
    ds_read_b64_tr_b16 a[182:183], v61 offset:4608
    ds_read_b64_tr_b16 a[184:185], v62 offset:4096
    ds_read_b64_tr_b16 a[186:187], v62 offset:4608
    ds_read_b64_tr_b16 a[188:189], v63 offset:4096
    ds_read_b64_tr_b16 a[190:191], v63 offset:4608
    s_add_u32 m0, s42, 131072
    s_nop 0
    buffer_load_dwordx4 v48, s[12:15], s54 offen lds
    s_add_u32 m0, s42, 132096
    s_nop 0
    buffer_load_dwordx4 v49, s[12:15], s54 offen lds
    s_add_u32 m0, s42, 139264
    s_nop 0
    buffer_load_dwordx4 v50, s[12:15], s54 offen lds
    s_add_u32 m0, s42, 140288
    s_nop 0
    buffer_load_dwordx4 v51, s[12:15], s54 offen lds
    s_add_u32 m0, s42, 147456
    s_nop 0
    buffer_load_dwordx4 v52, s[12:15], s54 offen lds
    s_add_u32 m0, s42, 148480
    s_nop 0
    buffer_load_dwordx4 v53, s[12:15], s54 offen lds
    s_add_u32 m0, s42, 155648
    s_nop 0
    buffer_load_dwordx4 v54, s[12:15], s54 offen lds
    s_add_u32 m0, s42, 156672
    s_nop 0
    buffer_load_dwordx4 v55, s[12:15], s54 offen lds
    s_add_u32 s54, s54, 131072
    s_waitcnt lgkmcnt(0)
    v_add_u32 v60, 32768, v56
    v_add_u32 v61, 32768, v57
    v_add_u32 v62, 32768, v58
    v_add_u32 v63, 32768, v59
    s_waitcnt vmcnt(24)
    s_barrier
    ds_read_b64_tr_b16 a[192:193], v60 offset:0
    ds_read_b64_tr_b16 a[194:195], v60 offset:512
    ds_read_b64_tr_b16 a[196:197], v61 offset:0
    ds_read_b64_tr_b16 a[198:199], v61 offset:512
    ds_read_b64_tr_b16 a[200:201], v62 offset:0
    ds_read_b64_tr_b16 a[202:203], v62 offset:512
    ds_read_b64_tr_b16 a[204:205], v63 offset:0
    ds_read_b64_tr_b16 a[206:207], v63 offset:512
    ds_read_b64_tr_b16 a[208:209], v60 offset:4096
    ds_read_b64_tr_b16 a[210:211], v60 offset:4608
    ds_read_b64_tr_b16 a[212:213], v61 offset:4096
    ds_read_b64_tr_b16 a[214:215], v61 offset:4608
    ds_read_b64_tr_b16 a[216:217], v62 offset:4096
    ds_read_b64_tr_b16 a[218:219], v62 offset:4608
    ds_read_b64_tr_b16 a[220:221], v63 offset:4096
    ds_read_b64_tr_b16 a[222:223], v63 offset:4608
    s_add_u32 m0, s42, 0
    s_nop 0
    buffer_load_dwordx4 v48, s[12:15], s54 offen lds
    s_add_u32 m0, s42, 1024
    s_nop 0
    buffer_load_dwordx4 v49, s[12:15], s54 offen lds
    s_add_u32 m0, s42, 8192
    s_nop 0
    buffer_load_dwordx4 v50, s[12:15], s54 offen lds
    s_add_u32 m0, s42, 9216
    s_nop 0
    buffer_load_dwordx4 v51, s[12:15], s54 offen lds
    s_add_u32 m0, s42, 16384
    s_nop 0
    buffer_load_dwordx4 v52, s[12:15], s54 offen lds
    s_add_u32 m0, s42, 17408
    s_nop 0
    buffer_load_dwordx4 v53, s[12:15], s54 offen lds
    s_add_u32 m0, s42, 24576
    s_nop 0
    buffer_load_dwordx4 v54, s[12:15], s54 offen lds
    s_add_u32 m0, s42, 25600
    s_nop 0
    buffer_load_dwordx4 v55, s[12:15], s54 offen lds
    s_add_u32 s54, s54, 131072
    s_waitcnt lgkmcnt(0)
    v_add_u32 v60, 65536, v56
    v_add_u32 v61, 65536, v57
    v_add_u32 v62, 65536, v58
    v_add_u32 v63, 65536, v59
    s_waitcnt vmcnt(24)
    s_barrier
    ds_read_b64_tr_b16 a[224:225], v60 offset:0
    ds_read_b64_tr_b16 a[226:227], v60 offset:512
    ds_read_b64_tr_b16 a[228:229], v61 offset:0
    ds_read_b64_tr_b16 a[230:231], v61 offset:512
    ds_read_b64_tr_b16 a[232:233], v62 offset:0
    ds_read_b64_tr_b16 a[234:235], v62 offset:512
    ds_read_b64_tr_b16 a[236:237], v63 offset:0
    ds_read_b64_tr_b16 a[238:239], v63 offset:512
    ds_read_b64_tr_b16 a[240:241], v60 offset:4096
    ds_read_b64_tr_b16 a[242:243], v60 offset:4608
    ds_read_b64_tr_b16 a[244:245], v61 offset:4096
    ds_read_b64_tr_b16 a[246:247], v61 offset:4608
    ds_read_b64_tr_b16 a[248:249], v62 offset:4096
    ds_read_b64_tr_b16 a[250:251], v62 offset:4608
    ds_read_b64_tr_b16 a[252:253], v63 offset:4096
    ds_read_b64_tr_b16 a[254:255], v63 offset:4608
    s_add_u32 m0, s42, 32768
    s_nop 0
    buffer_load_dwordx4 v48, s[12:15], s54 offen lds
    s_add_u32 m0, s42, 33792
    s_nop 0
    buffer_load_dwordx4 v49, s[12:15], s54 offen lds
    s_add_u32 m0, s42, 40960
    s_nop 0
    buffer_load_dwordx4 v50, s[12:15], s54 offen lds
    s_add_u32 m0, s42, 41984
    s_nop 0
    buffer_load_dwordx4 v51, s[12:15], s54 offen lds
    s_add_u32 m0, s42, 49152
    s_nop 0
    buffer_load_dwordx4 v52, s[12:15], s54 offen lds
    s_add_u32 m0, s42, 50176
    s_nop 0
    buffer_load_dwordx4 v53, s[12:15], s54 offen lds
    s_add_u32 m0, s42, 57344
    s_nop 0
    buffer_load_dwordx4 v54, s[12:15], s54 offen lds
    s_add_u32 m0, s42, 58368
    s_nop 0
    buffer_load_dwordx4 v55, s[12:15], s54 offen lds
    s_add_u32 s54, s54, 131072
    s_waitcnt lgkmcnt(0)
    v_add_u32 v60, 98304, v56
    v_add_u32 v61, 98304, v57
    v_add_u32 v62, 98304, v58
    v_add_u32 v63, 98304, v59
    s_waitcnt vmcnt(24)
    s_barrier
    ds_read_b64_tr_b16 v[144:145], v60 offset:0
    ds_read_b64_tr_b16 v[146:147], v60 offset:512
    ds_read_b64_tr_b16 v[148:149], v61 offset:0
    ds_read_b64_tr_b16 v[150:151], v61 offset:512
    ds_read_b64_tr_b16 v[152:153], v62 offset:0
    ds_read_b64_tr_b16 v[154:155], v62 offset:512
    ds_read_b64_tr_b16 v[156:157], v63 offset:0
    ds_read_b64_tr_b16 v[158:159], v63 offset:512
    ds_read_b64_tr_b16 v[160:161], v60 offset:4096
    ds_read_b64_tr_b16 v[162:163], v60 offset:4608
    ds_read_b64_tr_b16 v[164:165], v61 offset:4096
    ds_read_b64_tr_b16 v[166:167], v61 offset:4608
    ds_read_b64_tr_b16 v[168:169], v62 offset:4096
    ds_read_b64_tr_b16 v[170:171], v62 offset:4608
    ds_read_b64_tr_b16 v[172:173], v63 offset:4096
    ds_read_b64_tr_b16 v[174:175], v63 offset:4608
    s_waitcnt lgkmcnt(0)
    v_add_u32 v60, 131072, v56
    v_add_u32 v61, 131072, v57
    v_add_u32 v62, 131072, v58
    v_add_u32 v63, 131072, v59
    s_waitcnt vmcnt(16)
    s_barrier
    ds_read_b64_tr_b16 v[176:177], v60 offset:0
    ds_read_b64_tr_b16 v[178:179], v60 offset:512
    ds_read_b64_tr_b16 v[180:181], v61 offset:0
    ds_read_b64_tr_b16 v[182:183], v61 offset:512
    ds_read_b64_tr_b16 v[184:185], v62 offset:0
    ds_read_b64_tr_b16 v[186:187], v62 offset:512
    ds_read_b64_tr_b16 v[188:189], v63 offset:0
    ds_read_b64_tr_b16 v[190:191], v63 offset:512
    ds_read_b64_tr_b16 v[192:193], v60 offset:4096
    ds_read_b64_tr_b16 v[194:195], v60 offset:4608
    ds_read_b64_tr_b16 v[196:197], v61 offset:4096
    ds_read_b64_tr_b16 v[198:199], v61 offset:4608
    ds_read_b64_tr_b16 v[200:201], v62 offset:4096
    ds_read_b64_tr_b16 v[202:203], v62 offset:4608
    ds_read_b64_tr_b16 v[204:205], v63 offset:4096
    ds_read_b64_tr_b16 v[206:207], v63 offset:4608
    s_waitcnt lgkmcnt(0)
    v_add_u32 v60, 0, v56
    v_add_u32 v61, 0, v57
    v_add_u32 v62, 0, v58
    v_add_u32 v63, 0, v59
    s_waitcnt vmcnt(8)
    s_barrier
    ds_read_b64_tr_b16 v[208:209], v60 offset:0
    ds_read_b64_tr_b16 v[210:211], v60 offset:512
    ds_read_b64_tr_b16 v[212:213], v61 offset:0
    ds_read_b64_tr_b16 v[214:215], v61 offset:512
    ds_read_b64_tr_b16 v[216:217], v62 offset:0
    ds_read_b64_tr_b16 v[218:219], v62 offset:512
    ds_read_b64_tr_b16 v[220:221], v63 offset:0
    ds_read_b64_tr_b16 v[222:223], v63 offset:512
    ds_read_b64_tr_b16 v[224:225], v60 offset:4096
    ds_read_b64_tr_b16 v[226:227], v60 offset:4608
    ds_read_b64_tr_b16 v[228:229], v61 offset:4096
    ds_read_b64_tr_b16 v[230:231], v61 offset:4608
    ds_read_b64_tr_b16 v[232:233], v62 offset:4096
    ds_read_b64_tr_b16 v[234:235], v62 offset:4608
    ds_read_b64_tr_b16 v[236:237], v63 offset:4096
    ds_read_b64_tr_b16 v[238:239], v63 offset:4608
    s_waitcnt lgkmcnt(0)
    v_add_u32 v60, 32768, v56
    v_add_u32 v61, 32768, v57
    v_add_u32 v62, 32768, v58
    v_add_u32 v63, 32768, v59
    s_waitcnt vmcnt(0)
    s_barrier
    ds_read_b64_tr_b16 v[240:241], v60 offset:0
    ds_read_b64_tr_b16 v[242:243], v60 offset:512
    ds_read_b64_tr_b16 v[244:245], v61 offset:0
    ds_read_b64_tr_b16 v[246:247], v61 offset:512
    ds_read_b64_tr_b16 v[248:249], v62 offset:0
    ds_read_b64_tr_b16 v[250:251], v62 offset:512
    ds_read_b64_tr_b16 v[252:253], v63 offset:0
    ds_read_b64_tr_b16 v[254:255], v63 offset:512
    s_waitcnt lgkmcnt(0)
    s_barrier
    s_mov_b32 s37, 0xffff0000
    v_lshlrev_b32 v100, 16, v24
    v_and_b32 v101, s37, v24
    v_lshlrev_b32 v102, 16, v25
    v_and_b32 v103, s37, v25
    v_lshlrev_b32 v104, 16, v26
    v_and_b32 v105, s37, v26
    v_lshlrev_b32 v106, 16, v27
    v_and_b32 v107, s37, v27
    s_add_u32 s37, s90, 8388608
    v_mov_b32 v16, -1
    v_mov_b32 v17, -1
    v_mov_b32 v18, -1
    v_mov_b32 v19, -1
    buffer_store_dwordx4 v[16:19], v1, s[16:19], s37 offen offset:0 sc1
    buffer_store_dwordx4 v[16:19], v1, s[16:19], s37 offen offset:1024 sc1
    buffer_store_dwordx4 v[16:19], v1, s[16:19], s37 offen offset:2048 sc1
    buffer_store_dwordx4 v[16:19], v1, s[16:19], s37 offen offset:3072 sc1
    s_cmp_lg_u32 s32, 0
    s_cbranch_scc1 L_arv58
    s_add_u32 s20, s82, 0x80
    s_addc_u32 s21, s83, 0
    s_mov_b32 s22, 0x4
    s_mov_b32 s23, 0x00020000
    buffer_load_dword v80, v124, s[20:23], 0 offen sc1
    s_waitcnt vmcnt(0)
    v_cmp_eq_u32 vcc, v124, v80
    s_cbranch_vccnz L_spin59
L_back60:
L_arv58:
    s_add_u32 s96, s41, 8126464
    s_mov_b32 s98, s41
    s_mov_b32 s45, 0x5530000
    buffer_load_dword v96, v6, s[16:19], s45 offen sc1
    s_waitcnt vmcnt(0)
    v_cmp_ne_u32 vcc, 0, v96
    s_cbranch_vccnz L_spin61
L_back62:
    s_barrier
    s_mov_b32 s39, 0x5e00000
    s_add_u32 m0, s43, 0
    s_add_u32 s42, s41, 0
    buffer_load_dwordx4 v1, s[16:19], s42 offen offset:0 sc1 lds
    buffer_load_dwordx4 v1, s[16:19], s42 offen offset:1024 sc1 lds
    buffer_load_dwordx4 v1, s[16:19], s42 offen offset:2048 sc1 lds
    buffer_load_dwordx4 v1, s[16:19], s42 offen offset:3072 sc1 lds
    s_add_u32 m0, s43, 16384
    s_add_u32 s42, s41, 16384
    buffer_load_dwordx4 v1, s[16:19], s42 offen offset:0 sc1 lds
    buffer_load_dwordx4 v1, s[16:19], s42 offen offset:1024 sc1 lds
    buffer_load_dwordx4 v1, s[16:19], s42 offen offset:2048 sc1 lds
    buffer_load_dwordx4 v1, s[16:19], s42 offen offset:3072 sc1 lds
    buffer_store_dword v124, v124, s[16:19], s39 offen
    buffer_store_dword v124, v124, s[16:19], s39 offen
    buffer_store_dword v124, v124, s[16:19], s39 offen
    s_add_u32 m0, s43, 32768
    s_add_u32 s42, s41, 32768
    buffer_load_dwordx4 v1, s[16:19], s42 offen offset:0 sc1 lds
    buffer_load_dwordx4 v1, s[16:19], s42 offen offset:1024 sc1 lds
    buffer_load_dwordx4 v1, s[16:19], s42 offen offset:2048 sc1 lds
    buffer_load_dwordx4 v1, s[16:19], s42 offen offset:3072 sc1 lds
    s_add_u32 s45, s45, 65536
    s_waitcnt vmcnt(7) lgkmcnt(0)
    s_barrier
    s_mov_b32 s52, 0x5e00000
    s_mov_b32 s46, 0x5e00000
    s_add_u32 s20, s84, 0x5e00000
    s_addc_u32 s21, s85, 0
    s_mov_b32 s22, 0x400000
    s_mov_b32 s23, 0x00020000
    v_mov_b32 v13, 0
    ds_read_b128 v[80:83], v2 offset:0
    ds_read_b128 v[84:87], v3 offset:0
    s_mov_b32 s36, 0
    s_waitcnt lgkmcnt(0)
    s_nop 7
L_bf_b0:
    v_mfma_f32_16x16x32_bf16 v[16:19], a[0:3], v[80:83], v[100:103]
    s_sub_u32 s47, s45, 196608
    ds_read_b128 v[88:91], v2 offset:2048
    s_max_u32 s47, s47, 0x5500000
    v_mfma_f32_16x16x32_bf16 v[24:27], a[0:3], v[84:87], 0
    buffer_load_dword v13, v8, s[16:19], s47 offen sc1
    v_mfma_f32_16x16x32_bf16 v[28:31], a[4:7], v[84:87], 0
    s_and_b32 s38, s53, 0xffffffff
    ds_read_b128 v[92:95], v3 offset:2048
    s_cmp_lt_i32 s36, 1
    v_mfma_f32_16x16x32_bf16 v[20:23], a[4:7], v[80:83], v[104:107]
    s_cselect_b32 s38, 0x5e00000, s38
    v_mfma_f32_16x16x32_bf16 v[32:35], a[8:11], v[80:83], 0
    buffer_load_dwordx4 v[116:119], v1, s[16:19], s38 offen sc1
    v_mfma_f32_16x16x32_bf16 v[40:43], a[8:11], v[84:87], 0
    s_add_u32 s53, s53, 65536
    ds_read_b128 v[120:123], v11 offset:0
    s_and_b32 s44, s90, 0xffffffff
    v_mfma_f32_16x16x32_bf16 v[44:47], a[12:15], v[84:87], 0
    s_cmp_lt_i32 s36, 1
    s_cselect_b32 s44, 0x5e00000, s44
    s_xor_b32 s49, s44, 16384
    v_mfma_f32_16x16x32_bf16 v[36:39], a[12:15], v[80:83], 0
    s_waitcnt lgkmcnt(1)
    v_cvt_pk_bf16_f32 v56, v56, v57
    v_cvt_pk_bf16_f32 v57, v58, v59
    v_mfma_f32_16x16x32_bf16 v[16:19], a[16:19], v[88:91], v[16:19]
    ds_read_b128 v[80:83], v2 offset:4096
    v_cvt_pk_bf16_f32 v58, v60, v61
    v_mfma_f32_16x16x32_bf16 v[24:27], a[16:19], v[92:95], v[24:27]
    v_cvt_pk_bf16_f32 v59, v62, v63
    v_mfma_f32_16x16x32_bf16 v[28:31], a[20:23], v[92:95], v[28:31]
    s_waitcnt lgkmcnt(1)
    ds_read_b128 v[84:87], v3 offset:4096
    v_add_f32 v120, v120, v121
    v_mfma_f32_16x16x32_bf16 v[20:23], a[20:23], v[88:91], v[20:23]
    buffer_store_dwordx4 v[56:59], v1, s[16:19], s49 offen offset:0 sc1
    v_mfma_f32_16x16x32_bf16 v[32:35], a[24:27], v[88:91], v[32:35]
    s_xor_b32 s49, s44, 32768
    v_cvt_pk_bf16_f32 v64, v64, v65
    v_cvt_pk_bf16_f32 v65, v66, v67
    v_mfma_f32_16x16x32_bf16 v[40:43], a[24:27], v[92:95], v[40:43]
    v_cvt_pk_bf16_f32 v66, v68, v69
    v_cvt_pk_bf16_f32 v67, v70, v71
    v_mfma_f32_16x16x32_bf16 v[44:47], a[28:31], v[92:95], v[44:47]
    buffer_store_dwordx4 v[64:67], v1, s[16:19], s49 offen offset:1024 sc1
    v_mfma_f32_16x16x32_bf16 v[36:39], a[28:31], v[88:91], v[36:39]
    s_waitcnt lgkmcnt(0)
    v_add_f32 v122, v122, v123
    v_add_f32 v120, v120, v122
    v_mfma_f32_16x16x32_bf16 v[16:19], a[32:35], v[80:83], v[16:19]
    s_xor_b32 s49, s44, 49152
    ds_read_b128 v[88:91], v2 offset:6144
    v_cvt_pk_bf16_f32 v72, v72, v73
    v_mfma_f32_16x16x32_bf16 v[24:27], a[32:35], v[84:87], v[24:27]
    v_cvt_pk_bf16_f32 v73, v74, v75
    v_cvt_pk_bf16_f32 v74, v76, v77
    v_mfma_f32_16x16x32_bf16 v[28:31], a[36:39], v[84:87], v[28:31]
    ds_read_b128 v[92:95], v3 offset:6144
    v_cvt_pk_bf16_f32 v75, v78, v79
    v_mfma_f32_16x16x32_bf16 v[20:23], a[36:39], v[80:83], v[20:23]
    buffer_store_dwordx4 v[72:75], v1, s[16:19], s49 offen offset:2048 sc1
    v_mfma_f32_16x16x32_bf16 v[32:35], a[40:43], v[80:83], v[32:35]
    s_add_u32 s90, s90, 262144
    v_mfma_f32_16x16x32_bf16 v[40:43], a[40:43], v[84:87], v[40:43]
    v_mfma_f32_16x16x32_bf16 v[44:47], a[44:47], v[84:87], v[44:47]
    buffer_store_dword v120, v12, s[16:19], s46 offen sc1
    v_mfma_f32_16x16x32_bf16 v[36:39], a[44:47], v[80:83], v[36:39]
    s_waitcnt lgkmcnt(0)
    v_mfma_f32_16x16x32_bf16 v[16:19], a[48:51], v[88:91], v[16:19]
    s_add_u32 s98, s98, 262144
    ds_read_b128 v[80:83], v2 offset:8192
    s_min_i32 s98, s98, s96
    v_mfma_f32_16x16x32_bf16 v[24:27], a[48:51], v[92:95], v[24:27]
    s_and_b32 s41, s98, 0xffffffff
    s_add_u32 m0, s43, 98304
    s_add_u32 s42, s41, 0
    v_mfma_f32_16x16x32_bf16 v[28:31], a[52:55], v[92:95], v[28:31]
    ds_read_b128 v[84:87], v3 offset:8192
    v_mfma_f32_16x16x32_bf16 v[20:23], a[52:55], v[88:91], v[20:23]
    v_mfma_f32_16x16x32_bf16 v[32:35], a[56:59], v[88:91], v[32:35]
    v_mfma_f32_16x16x32_bf16 v[40:43], a[56:59], v[92:95], v[40:43]
    v_mfma_f32_16x16x32_bf16 v[44:47], a[60:63], v[92:95], v[44:47]
    v_mfma_f32_16x16x32_bf16 v[36:39], a[60:63], v[88:91], v[36:39]
    s_waitcnt lgkmcnt(0)
    v_mfma_f32_16x16x32_bf16 v[16:19], a[64:67], v[80:83], v[16:19]
    ds_read_b128 v[88:91], v2 offset:10240
    v_mfma_f32_16x16x32_bf16 v[24:27], a[64:67], v[84:87], v[24:27]
    v_mfma_f32_16x16x32_bf16 v[28:31], a[68:71], v[84:87], v[28:31]
    ds_read_b128 v[92:95], v3 offset:10240
    v_mfma_f32_16x16x32_bf16 v[20:23], a[68:71], v[80:83], v[20:23]
    v_mfma_f32_16x16x32_bf16 v[32:35], a[72:75], v[80:83], v[32:35]
    v_mfma_f32_16x16x32_bf16 v[40:43], a[72:75], v[84:87], v[40:43]
    v_mfma_f32_16x16x32_bf16 v[44:47], a[76:79], v[84:87], v[44:47]
    v_mfma_f32_16x16x32_bf16 v[36:39], a[76:79], v[80:83], v[36:39]
    s_waitcnt lgkmcnt(0)
    v_mfma_f32_16x16x32_bf16 v[16:19], a[80:83], v[88:91], v[16:19]
    ds_read_b128 v[80:83], v2 offset:12288
    v_mfma_f32_16x16x32_bf16 v[24:27], a[80:83], v[92:95], v[24:27]
    v_mfma_f32_16x16x32_bf16 v[28:31], a[84:87], v[92:95], v[28:31]
    ds_read_b128 v[84:87], v3 offset:12288
    v_mfma_f32_16x16x32_bf16 v[20:23], a[84:87], v[88:91], v[20:23]
    v_mfma_f32_16x16x32_bf16 v[32:35], a[88:91], v[88:91], v[32:35]
    s_waitcnt vmcnt(5)
    v_cmp_ne_u32 vcc, 0, v13
    v_mfma_f32_16x16x32_bf16 v[40:43], a[88:91], v[92:95], v[40:43]
    v_mfma_f32_16x16x32_bf16 v[44:47], a[92:95], v[92:95], v[44:47]
    s_cbranch_vccnz L_spin63
L_back64:
    s_sub_u32 s48, s90, 524288
    s_and_b32 s48, s48, 0xffffffff
    v_mfma_f32_16x16x32_bf16 v[36:39], a[92:95], v[88:91], v[36:39]
    s_waitcnt lgkmcnt(0)
    s_cmp_lt_i32 s36, 2
    s_cselect_b32 s48, s52, s48
    v_mfma_f32_16x16x32_bf16 v[16:19], a[96:99], v[80:83], v[16:19]
    ds_read_b128 v[88:91], v2 offset:14336
    v_mfma_f32_16x16x32_bf16 v[24:27], a[96:99], v[84:87], v[24:27]
    buffer_load_dword v96, v6, s[16:19], s45 offen sc1
    v_mfma_f32_16x16x32_bf16 v[28:31], a[100:103], v[84:87], v[28:31]
    ds_read_b128 v[92:95], v3 offset:14336
    v_mfma_f32_16x16x32_bf16 v[20:23], a[100:103], v[80:83], v[20:23]
    v_mfma_f32_16x16x32_bf16 v[32:35], a[104:107], v[80:83], v[32:35]
    buffer_load_dwordx4 v[128:131], v1, s[16:19], s48 offen offset:0 sc1
    v_mfma_f32_16x16x32_bf16 v[40:43], a[104:107], v[84:87], v[40:43]
    v_mfma_f32_16x16x32_bf16 v[44:47], a[108:111], v[84:87], v[44:47]
    v_mfma_f32_16x16x32_bf16 v[36:39], a[108:111], v[80:83], v[36:39]
    s_waitcnt lgkmcnt(0)
    v_mfma_f32_16x16x32_bf16 v[16:19], a[112:115], v[88:91], v[16:19]
    ds_read_b128 v[80:83], v2 offset:16384
    v_mfma_f32_16x16x32_bf16 v[24:27], a[112:115], v[92:95], v[24:27]
    buffer_load_dwordx4 v[132:135], v1, s[16:19], s48 offen offset:1024 sc1
    v_mfma_f32_16x16x32_bf16 v[28:31], a[116:119], v[92:95], v[28:31]
    ds_read_b128 v[84:87], v3 offset:16384
    v_mfma_f32_16x16x32_bf16 v[20:23], a[116:119], v[88:91], v[20:23]
    v_mfma_f32_16x16x32_bf16 v[32:35], a[120:123], v[88:91], v[32:35]
    buffer_load_dwordx4 v[136:139], v1, s[16:19], s48 offen offset:2048 sc1
    v_mfma_f32_16x16x32_bf16 v[40:43], a[120:123], v[92:95], v[40:43]
    v_mfma_f32_16x16x32_bf16 v[44:47], a[124:127], v[92:95], v[44:47]
    v_mfma_f32_16x16x32_bf16 v[36:39], a[124:127], v[88:91], v[36:39]
    s_waitcnt lgkmcnt(0)
    v_mfma_f32_16x16x32_bf16 v[16:19], a[128:131], v[80:83], v[16:19]
    ds_read_b128 v[88:91], v2 offset:18432
    v_mfma_f32_16x16x32_bf16 v[24:27], a[128:131], v[84:87], v[24:27]
    buffer_load_dwordx4 v[140:143], v1, s[16:19], s48 offen offset:3072 sc1
    v_mfma_f32_16x16x32_bf16 v[28:31], a[132:135], v[84:87], v[28:31]
    s_sub_u32 s47, s36, 2
    ds_read_b128 v[92:95], v3 offset:18432
    s_cmp_lt_u32 s47, 16
    v_mfma_f32_16x16x32_bf16 v[20:23], a[132:135], v[80:83], v[20:23]
    s_cselect_b32 s48, 0x5000000, s52
    s_add_u32 s20, s84, s48
    s_addc_u32 s21, s85, 0
    v_mfma_f32_16x16x32_bf16 v[32:35], a[136:139], v[80:83], v[32:35]
    s_cmp_ge_i32 s47, 16
    s_cselect_b32 s20, s80, s20
    s_cselect_b32 s21, s81, s21
    v_mfma_f32_16x16x32_bf16 v[40:43], a[136:139], v[84:87], v[40:43]
    s_and_b32 s48, s47, 15
    s_lshl_b32 s48, s48, 1
    s_sub_u32 s48, s50, s48
    v_mfma_f32_16x16x32_bf16 v[44:47], a[140:143], v[84:87], v[44:47]
    s_lshl_b32 s46, s48, 10
    s_sub_u32 s46, s55, s46
    s_cmp_lt_u32 s47, 16
    v_mfma_f32_16x16x32_bf16 v[36:39], a[140:143], v[80:83], v[36:39]
    s_waitcnt lgkmcnt(0)
    s_cselect_b32 s46, s46, s52
    s_lshl_b32 s48, s48, 15
    v_mfma_f32_16x16x32_bf16 v[16:19], a[144:147], v[88:91], v[16:19]
    s_waitcnt vmcnt(9)
    ds_read_b128 v[80:83], v2 offset:20480
    v_lshlrev_b32 v120, 16, v116
    v_mfma_f32_16x16x32_bf16 v[24:27], a[144:147], v[92:95], v[24:27]
    v_and_b32 v121, s86, v116
    v_add_f32 v48, v48, v120
    v_mfma_f32_16x16x32_bf16 v[28:31], a[148:151], v[92:95], v[28:31]
    ds_read_b128 v[84:87], v3 offset:20480
    v_add_f32 v49, v49, v121
    v_mfma_f32_16x16x32_bf16 v[20:23], a[148:151], v[88:91], v[20:23]
    v_lshlrev_b32 v122, 16, v117
    v_and_b32 v123, s86, v117
    v_mfma_f32_16x16x32_bf16 v[32:35], a[152:155], v[88:91], v[32:35]
    v_add_f32 v50, v50, v122
    v_add_f32 v51, v51, v123
    v_mfma_f32_16x16x32_bf16 v[40:43], a[152:155], v[92:95], v[40:43]
    v_lshlrev_b32 v120, 16, v118
    v_and_b32 v121, s86, v118
    v_mfma_f32_16x16x32_bf16 v[44:47], a[156:159], v[92:95], v[44:47]
    v_add_f32 v52, v52, v120
    v_add_f32 v53, v53, v121
    v_mfma_f32_16x16x32_bf16 v[36:39], a[156:159], v[88:91], v[36:39]
    s_waitcnt lgkmcnt(0)
    v_lshlrev_b32 v122, 16, v119
    v_and_b32 v123, s86, v119
    v_mfma_f32_16x16x32_bf16 v[16:19], a[160:163], v[80:83], v[16:19]
    ds_read_b128 v[88:91], v2 offset:22528
    v_add_f32 v54, v54, v122
    v_mfma_f32_16x16x32_bf16 v[24:27], a[160:163], v[84:87], v[24:27]
    v_add_f32 v55, v55, v123
    v_mfma_f32_16x16x32_bf16 v[28:31], a[164:167], v[84:87], v[28:31]
    ds_read_b128 v[92:95], v3 offset:22528
    v_mfma_f32_16x16x32_bf16 v[20:23], a[164:167], v[80:83], v[20:23]
    v_mfma_f32_16x16x32_bf16 v[32:35], a[168:171], v[80:83], v[32:35]
    v_mfma_f32_16x16x32_bf16 v[40:43], a[168:171], v[84:87], v[40:43]
    v_mfma_f32_16x16x32_bf16 v[44:47], a[172:175], v[84:87], v[44:47]
    v_mfma_f32_16x16x32_bf16 v[36:39], a[172:175], v[80:83], v[36:39]
    s_waitcnt lgkmcnt(0)
    v_mfma_f32_16x16x32_bf16 v[16:19], a[176:179], v[88:91], v[16:19]
    ds_read_b128 v[80:83], v2 offset:24576
    v_mfma_f32_16x16x32_bf16 v[24:27], a[176:179], v[92:95], v[24:27]
    v_mfma_f32_16x16x32_bf16 v[28:31], a[180:183], v[92:95], v[28:31]
    ds_read_b128 v[84:87], v3 offset:24576
    v_mfma_f32_16x16x32_bf16 v[20:23], a[180:183], v[88:91], v[20:23]
    v_mfma_f32_16x16x32_bf16 v[32:35], a[184:187], v[88:91], v[32:35]
    s_waitcnt vmcnt(4)
    v_cmp_ne_u32 vcc, 0, v96
    s_waitcnt vmcnt(3)
    v_mfma_f32_16x16x32_bf16 v[40:43], a[184:187], v[92:95], v[40:43]
    v_lshlrev_b32 v120, 16, v128
    v_and_b32 v121, s86, v128
    v_mfma_f32_16x16x32_bf16 v[44:47], a[188:191], v[92:95], v[44:47]
    s_cbranch_vccnz L_spin65
L_back66:
    v_add_f32 v108, v108, v120
    v_add_f32 v109, v109, v121
    v_mfma_f32_16x16x32_bf16 v[36:39], a[188:191], v[88:91], v[36:39]
    s_waitcnt lgkmcnt(0)
    v_lshlrev_b32 v122, 16, v129
    v_and_b32 v123, s86, v129
    v_mfma_f32_16x16x32_bf16 v[16:19], a[192:195], v[80:83], v[16:19]
    s_barrier
    ds_read_b128 v[88:91], v2 offset:26624
    v_add_f32 v110, v110, v122
    v_mfma_f32_16x16x32_bf16 v[24:27], a[192:195], v[84:87], v[24:27]
    buffer_load_dwordx4 v1, s[16:19], s42 offen offset:0 sc1 lds
    v_mfma_f32_16x16x32_bf16 v[28:31], a[196:199], v[84:87], v[28:31]
    ds_read_b128 v[92:95], v3 offset:26624
    v_add_f32 v111, v111, v123
    v_mfma_f32_16x16x32_bf16 v[20:23], a[196:199], v[80:83], v[20:23]
    v_lshlrev_b32 v120, 16, v130
    v_and_b32 v121, s86, v130
    v_mfma_f32_16x16x32_bf16 v[32:35], a[200:203], v[80:83], v[32:35]
    v_add_f32 v112, v112, v120
    v_add_f32 v113, v113, v121
    v_mfma_f32_16x16x32_bf16 v[40:43], a[200:203], v[84:87], v[40:43]
    buffer_load_dwordx4 v1, s[16:19], s42 offen offset:1024 sc1 lds
    v_mfma_f32_16x16x32_bf16 v[44:47], a[204:207], v[84:87], v[44:47]
    v_lshlrev_b32 v122, 16, v131
    v_and_b32 v123, s86, v131
    v_mfma_f32_16x16x32_bf16 v[36:39], a[204:207], v[80:83], v[36:39]
    s_waitcnt lgkmcnt(0)
    v_add_f32 v114, v114, v122
    v_add_f32 v115, v115, v123
    v_mfma_f32_16x16x32_bf16 v[16:19], a[208:211], v[88:91], v[16:19]
    s_waitcnt vmcnt(4)
    ds_read_b128 v[80:83], v2 offset:28672
    v_lshlrev_b32 v120, 16, v132
    v_mfma_f32_16x16x32_bf16 v[24:27], a[208:211], v[92:95], v[24:27]
    buffer_load_dwordx4 v1, s[16:19], s42 offen offset:2048 sc1 lds
    v_mfma_f32_16x16x32_bf16 v[28:31], a[212:215], v[92:95], v[28:31]
    ds_read_b128 v[84:87], v3 offset:28672
    v_and_b32 v121, s86, v132
    v_mfma_f32_16x16x32_bf16 v[20:23], a[212:215], v[88:91], v[20:23]
    v_add_f32 v108, v108, v120
    v_add_f32 v109, v109, v121
    v_mfma_f32_16x16x32_bf16 v[32:35], a[216:219], v[88:91], v[32:35]
    v_lshlrev_b32 v122, 16, v133
    v_and_b32 v123, s86, v133
    v_mfma_f32_16x16x32_bf16 v[40:43], a[216:219], v[92:95], v[40:43]
    buffer_load_dwordx4 v1, s[16:19], s42 offen offset:3072 sc1 lds
    v_mfma_f32_16x16x32_bf16 v[44:47], a[220:223], v[92:95], v[44:47]
    s_add_u32 m0, s43, 114688
    v_add_f32 v110, v110, v122
    v_add_f32 v111, v111, v123
    v_mfma_f32_16x16x32_bf16 v[36:39], a[220:223], v[88:91], v[36:39]
    s_waitcnt lgkmcnt(0)
    v_lshlrev_b32 v120, 16, v134
    v_and_b32 v121, s86, v134
    v_mfma_f32_16x16x32_bf16 v[16:19], a[224:227], v[80:83], v[16:19]
    s_add_u32 s42, s41, 16384
    ds_read_b128 v[88:91], v2 offset:30720
    v_add_f32 v112, v112, v120
    v_mfma_f32_16x16x32_bf16 v[24:27], a[224:227], v[84:87], v[24:27]
    buffer_load_dwordx4 v1, s[16:19], s42 offen offset:0 sc1 lds
    v_mfma_f32_16x16x32_bf16 v[28:31], a[228:231], v[84:87], v[28:31]
    ds_read_b128 v[92:95], v3 offset:30720
    v_add_f32 v113, v113, v121
    v_mfma_f32_16x16x32_bf16 v[20:23], a[228:231], v[80:83], v[20:23]
    v_lshlrev_b32 v122, 16, v135
    v_and_b32 v123, s86, v135
    v_mfma_f32_16x16x32_bf16 v[32:35], a[232:235], v[80:83], v[32:35]
    v_add_f32 v114, v114, v122
    v_add_f32 v115, v115, v123
    v_mfma_f32_16x16x32_bf16 v[40:43], a[232:235], v[84:87], v[40:43]
    buffer_load_dwordx4 v1, s[16:19], s42 offen offset:1024 sc1 lds
    v_mfma_f32_16x16x32_bf16 v[44:47], a[236:239], v[84:87], v[44:47]
    s_waitcnt vmcnt(7)
    v_lshlrev_b32 v120, 16, v136
    v_and_b32 v121, s86, v136
    v_mfma_f32_16x16x32_bf16 v[36:39], a[236:239], v[80:83], v[36:39]
    s_waitcnt lgkmcnt(0)
    v_add_f32 v108, v108, v120
    v_add_f32 v109, v109, v121
    v_mfma_f32_16x16x32_bf16 v[16:19], a[240:243], v[88:91], v[16:19]
    ds_read_b128 v[80:83], v2 offset:32768
    v_lshlrev_b32 v122, 16, v137
    v_mfma_f32_16x16x32_bf16 v[24:27], a[240:243], v[92:95], v[24:27]
    buffer_load_dwordx4 v1, s[16:19], s42 offen offset:2048 sc1 lds
    v_mfma_f32_16x16x32_bf16 v[28:31], a[244:247], v[92:95], v[28:31]
    ds_read_b128 v[84:87], v3 offset:32768
    v_and_b32 v123, s86, v137
    v_mfma_f32_16x16x32_bf16 v[20:23], a[244:247], v[88:91], v[20:23]
    v_add_f32 v110, v110, v122
    v_add_f32 v111, v111, v123
    v_mfma_f32_16x16x32_bf16 v[32:35], a[248:251], v[88:91], v[32:35]
    v_lshlrev_b32 v120, 16, v138
    v_and_b32 v121, s86, v138
    v_mfma_f32_16x16x32_bf16 v[40:43], a[248:251], v[92:95], v[40:43]
    buffer_load_dwordx4 v1, s[16:19], s42 offen offset:3072 sc1 lds
    v_mfma_f32_16x16x32_bf16 v[44:47], a[252:255], v[92:95], v[44:47]
    v_add_f32 v112, v112, v120
    v_add_f32 v113, v113, v121
    v_mfma_f32_16x16x32_bf16 v[36:39], a[252:255], v[88:91], v[36:39]
    s_waitcnt lgkmcnt(0)
    v_lshlrev_b32 v122, 16, v139
    v_and_b32 v123, s86, v139
    v_mfma_f32_16x16x32_bf16 v[16:19], v[144:147], v[80:83], v[16:19]
    ds_read_b128 v[88:91], v2 offset:34816
    v_add_f32 v114, v114, v122
    v_mfma_f32_16x16x32_bf16 v[24:27], v[144:147], v[84:87], v[24:27]
    buffer_store_dword v124, v124, s[16:19], s91 offen sc1
    v_mfma_f32_16x16x32_bf16 v[28:31], v[148:151], v[84:87], v[28:31]
    s_add_u32 s91, s91, 65536
    ds_read_b128 v[92:95], v3 offset:34816
    v_add_f32 v115, v115, v123
    v_mfma_f32_16x16x32_bf16 v[20:23], v[148:151], v[80:83], v[20:23]
    s_add_u32 s39, s91, -163840
    s_waitcnt vmcnt(9)
    v_lshlrev_b32 v120, 16, v140
    v_mfma_f32_16x16x32_bf16 v[32:35], v[152:155], v[80:83], v[32:35]
    buffer_store_dword v124, v124, s[16:19], s39 offen sc1
    v_mfma_f32_16x16x32_bf16 v[40:43], v[152:155], v[84:87], v[40:43]
    v_and_b32 v121, s86, v140
    v_add_f32 v108, v108, v120
    v_mfma_f32_16x16x32_bf16 v[44:47], v[156:159], v[84:87], v[44:47]
    v_add_f32 v109, v109, v121
    v_lshlrev_b32 v122, 16, v141
    v_mfma_f32_16x16x32_bf16 v[36:39], v[156:159], v[80:83], v[36:39]
    s_waitcnt lgkmcnt(0)
    v_and_b32 v123, s86, v141
    v_add_f32 v110, v110, v122
    v_mfma_f32_16x16x32_bf16 v[16:19], v[160:163], v[88:91], v[16:19]
    ds_read_b128 v[80:83], v2 offset:36864
    v_add_f32 v111, v111, v123
    v_mfma_f32_16x16x32_bf16 v[24:27], v[160:163], v[92:95], v[24:27]
    v_lshlrev_b32 v120, 16, v142
    v_and_b32 v121, s86, v142
    v_mfma_f32_16x16x32_bf16 v[28:31], v[164:167], v[92:95], v[28:31]
    ds_read_b128 v[84:87], v3 offset:36864
    v_add_f32 v112, v112, v120
    v_mfma_f32_16x16x32_bf16 v[20:23], v[164:167], v[88:91], v[20:23]
    v_add_f32 v113, v113, v121
    v_lshlrev_b32 v122, 16, v143
    v_mfma_f32_16x16x32_bf16 v[32:35], v[168:171], v[88:91], v[32:35]
    v_and_b32 v123, s86, v143
    v_add_f32 v114, v114, v122
    v_mfma_f32_16x16x32_bf16 v[40:43], v[168:171], v[92:95], v[40:43]
    v_add_f32 v115, v115, v123
    v_cvt_pk_bf16_f32 v128, v108, v109
    v_mfma_f32_16x16x32_bf16 v[44:47], v[172:175], v[92:95], v[44:47]
    v_cvt_pk_bf16_f32 v129, v110, v111
    v_cvt_pk_bf16_f32 v130, v112, v113
    v_mfma_f32_16x16x32_bf16 v[36:39], v[172:175], v[88:91], v[36:39]
    s_waitcnt lgkmcnt(0)
    v_cvt_pk_bf16_f32 v131, v114, v115
    v_add_f32 v97, v108, v109
    v_mfma_f32_16x16x32_bf16 v[16:19], v[176:179], v[80:83], v[16:19]
    s_add_u32 m0, s43, 131072
    ds_read_b128 v[88:91], v2 offset:38912
    v_mul_f32 v98, v108, v108
    v_mfma_f32_16x16x32_bf16 v[24:27], v[176:179], v[84:87], v[24:27]
    buffer_store_dwordx4 v[128:131], v9, s[20:23], s48 offen sc1
    v_mfma_f32_16x16x32_bf16 v[28:31], v[180:183], v[84:87], v[28:31]
    s_add_u32 s42, s41, 32768
    ds_read_b128 v[92:95], v3 offset:38912
    v_fmac_f32 v98, v109, v109
    v_mfma_f32_16x16x32_bf16 v[20:23], v[180:183], v[80:83], v[20:23]
    v_add_f32 v97, v97, v110
    v_fmac_f32 v98, v110, v110
    v_mfma_f32_16x16x32_bf16 v[32:35], v[184:187], v[80:83], v[32:35]
    buffer_load_dwordx4 v1, s[16:19], s42 offen offset:0 sc1 lds
    v_mfma_f32_16x16x32_bf16 v[40:43], v[184:187], v[84:87], v[40:43]
    v_add_f32 v97, v97, v111
    v_fmac_f32 v98, v111, v111
    v_mfma_f32_16x16x32_bf16 v[44:47], v[188:191], v[84:87], v[44:47]
    v_add_f32 v97, v97, v112
    v_fmac_f32 v98, v112, v112
    v_mfma_f32_16x16x32_bf16 v[36:39], v[188:191], v[80:83], v[36:39]
    s_waitcnt lgkmcnt(0)
    v_add_f32 v97, v97, v113
    v_fmac_f32 v98, v113, v113
    v_mfma_f32_16x16x32_bf16 v[16:19], v[192:195], v[88:91], v[16:19]
    ds_read_b128 v[80:83], v2 offset:40960
    v_add_f32 v97, v97, v114
    v_mfma_f32_16x16x32_bf16 v[24:27], v[192:195], v[92:95], v[24:27]
    buffer_load_dwordx4 v1, s[16:19], s42 offen offset:1024 sc1 lds
    v_mfma_f32_16x16x32_bf16 v[28:31], v[196:199], v[92:95], v[28:31]
    ds_read_b128 v[84:87], v3 offset:40960
    v_fmac_f32 v98, v114, v114
    v_mfma_f32_16x16x32_bf16 v[20:23], v[196:199], v[88:91], v[20:23]
    v_add_f32 v97, v97, v115
    v_fmac_f32 v98, v115, v115
    v_mfma_f32_16x16x32_bf16 v[32:35], v[200:203], v[88:91], v[32:35]
    v_permlane16_swap_b32 v97, v98
    v_mfma_f32_16x16x32_bf16 v[40:43], v[200:203], v[92:95], v[40:43]
    v_add_f32 v97, v97, v98
    v_mov_b32 v99, v97
    v_mfma_f32_16x16x32_bf16 v[44:47], v[204:207], v[92:95], v[44:47]
    buffer_load_dwordx4 v1, s[16:19], s42 offen offset:2048 sc1 lds
    v_mfma_f32_16x16x32_bf16 v[36:39], v[204:207], v[88:91], v[36:39]
    s_waitcnt lgkmcnt(0)
    v_permlane32_swap_b32 v97, v99
    v_mfma_f32_16x16x32_bf16 v[16:19], v[208:211], v[80:83], v[16:19]
    ds_read_b128 v[88:91], v2 offset:43008
    v_add_f32 v97, v97, v99
    v_mfma_f32_16x16x32_bf16 v[24:27], v[208:211], v[84:87], v[24:27]
    ds_write_b32 v10, v97 offset:512
    v_mfma_f32_16x16x32_bf16 v[28:31], v[212:215], v[84:87], v[28:31]
    ds_read_b128 v[92:95], v3 offset:43008
    v_mov_b32 v108, v48
    v_mfma_f32_16x16x32_bf16 v[20:23], v[212:215], v[80:83], v[20:23]
    buffer_load_dwordx4 v1, s[16:19], s42 offen offset:3072 sc1 lds
    v_mfma_f32_16x16x32_bf16 v[32:35], v[216:219], v[80:83], v[32:35]
    s_add_u32 s45, s45, 65536
    v_mov_b32 v109, v49
    v_mov_b32 v110, v50
    v_mfma_f32_16x16x32_bf16 v[40:43], v[216:219], v[84:87], v[40:43]
    v_mov_b32 v111, v51
    v_mov_b32 v112, v52
    v_mfma_f32_16x16x32_bf16 v[44:47], v[220:223], v[84:87], v[44:47]
    v_mov_b32 v113, v53
    v_mov_b32 v114, v54
    v_mfma_f32_16x16x32_bf16 v[36:39], v[220:223], v[80:83], v[36:39]
    s_waitcnt lgkmcnt(0)
    v_mov_b32 v115, v55
    v_mfma_f32_16x16x32_bf16 v[16:19], v[224:227], v[88:91], v[16:19]
    ds_read_b128 v[80:83], v2 offset:45056
    v_mfma_f32_16x16x32_bf16 v[24:27], v[224:227], v[92:95], v[24:27]
    v_mfma_f32_16x16x32_bf16 v[28:31], v[228:231], v[92:95], v[28:31]
    ds_read_b128 v[84:87], v3 offset:45056
    v_mfma_f32_16x16x32_bf16 v[20:23], v[228:231], v[88:91], v[20:23]
    v_mfma_f32_16x16x32_bf16 v[32:35], v[232:235], v[88:91], v[32:35]
    v_mfma_f32_16x16x32_bf16 v[40:43], v[232:235], v[92:95], v[40:43]
    v_mfma_f32_16x16x32_bf16 v[44:47], v[236:239], v[92:95], v[44:47]
    v_mfma_f32_16x16x32_bf16 v[36:39], v[236:239], v[88:91], v[36:39]
    s_waitcnt vmcnt(7) lgkmcnt(0)
    s_barrier
    v_mfma_f32_16x16x32_bf16 v[16:19], v[240:243], v[80:83], v[16:19]
    ds_read_b128 v[88:91], v4 offset:0
    v_mfma_f32_16x16x32_bf16 v[24:27], v[240:243], v[84:87], v[24:27]
    v_mfma_f32_16x16x32_bf16 v[28:31], v[244:247], v[84:87], v[28:31]
    ds_read_b128 v[92:95], v5 offset:0
    v_mfma_f32_16x16x32_bf16 v[20:23], v[244:247], v[80:83], v[20:23]
    v_mfma_f32_16x16x32_bf16 v[32:35], v[248:251], v[80:83], v[32:35]
    v_mfma_f32_16x16x32_bf16 v[40:43], v[248:251], v[84:87], v[40:43]
    v_mfma_f32_16x16x32_bf16 v[44:47], v[252:255], v[84:87], v[44:47]
    s_add_u32 s36, s36, 1
    v_mfma_f32_16x16x32_bf16 v[36:39], v[252:255], v[80:83], v[36:39]
    s_waitcnt lgkmcnt(0)
L_bf_b1:
    v_mfma_f32_16x16x32_bf16 v[48:51], a[0:3], v[88:91], v[100:103]
    s_sub_u32 s47, s45, 196608
    ds_read_b128 v[80:83], v4 offset:2048
    s_max_u32 s47, s47, 0x5500000
    v_mfma_f32_16x16x32_bf16 v[56:59], a[0:3], v[92:95], 0
    buffer_load_dword v13, v8, s[16:19], s47 offen sc1
    v_mfma_f32_16x16x32_bf16 v[60:63], a[4:7], v[92:95], 0
    s_and_b32 s38, s53, 0xffffffff
    ds_read_b128 v[84:87], v5 offset:2048
    s_cmp_lt_i32 s36, 1
    v_mfma_f32_16x16x32_bf16 v[52:55], a[4:7], v[88:91], v[104:107]
    s_cselect_b32 s38, 0x5e00000, s38
    v_mfma_f32_16x16x32_bf16 v[64:67], a[8:11], v[88:91], 0
    buffer_load_dwordx4 v[116:119], v1, s[16:19], s38 offen sc1
    v_mfma_f32_16x16x32_bf16 v[72:75], a[8:11], v[92:95], 0
    s_add_u32 s53, s53, 65536
    ds_read_b128 v[120:123], v11 offset:512
    s_and_b32 s44, s90, 0xffffffff
    v_mfma_f32_16x16x32_bf16 v[76:79], a[12:15], v[92:95], 0
    s_cmp_lt_i32 s36, 1
    s_cselect_b32 s44, 0x5e00000, s44
    s_xor_b32 s49, s44, 16384
    v_mfma_f32_16x16x32_bf16 v[68:71], a[12:15], v[88:91], 0
    s_waitcnt lgkmcnt(1)
    v_cvt_pk_bf16_f32 v24, v24, v25
    v_cvt_pk_bf16_f32 v25, v26, v27
    v_mfma_f32_16x16x32_bf16 v[48:51], a[16:19], v[80:83], v[48:51]
    ds_read_b128 v[88:91], v4 offset:4096
    v_cvt_pk_bf16_f32 v26, v28, v29
    v_mfma_f32_16x16x32_bf16 v[56:59], a[16:19], v[84:87], v[56:59]
    v_cvt_pk_bf16_f32 v27, v30, v31
    v_mfma_f32_16x16x32_bf16 v[60:63], a[20:23], v[84:87], v[60:63]
    s_waitcnt lgkmcnt(1)
    ds_read_b128 v[92:95], v5 offset:4096
    v_add_f32 v120, v120, v121
    v_mfma_f32_16x16x32_bf16 v[52:55], a[20:23], v[80:83], v[52:55]
    buffer_store_dwordx4 v[24:27], v1, s[16:19], s49 offen offset:0 sc1
    v_mfma_f32_16x16x32_bf16 v[64:67], a[24:27], v[80:83], v[64:67]
    s_xor_b32 s49, s44, 32768
    v_cvt_pk_bf16_f32 v32, v32, v33
    v_cvt_pk_bf16_f32 v33, v34, v35
    v_mfma_f32_16x16x32_bf16 v[72:75], a[24:27], v[84:87], v[72:75]
    v_cvt_pk_bf16_f32 v34, v36, v37
    v_cvt_pk_bf16_f32 v35, v38, v39
    v_mfma_f32_16x16x32_bf16 v[76:79], a[28:31], v[84:87], v[76:79]
    buffer_store_dwordx4 v[32:35], v1, s[16:19], s49 offen offset:1024 sc1
    v_mfma_f32_16x16x32_bf16 v[68:71], a[28:31], v[80:83], v[68:71]
    s_waitcnt lgkmcnt(0)
    v_add_f32 v122, v122, v123
    v_add_f32 v120, v120, v122
    v_mfma_f32_16x16x32_bf16 v[48:51], a[32:35], v[88:91], v[48:51]
    s_xor_b32 s49, s44, 49152
    ds_read_b128 v[80:83], v4 offset:6144
    v_cvt_pk_bf16_f32 v40, v40, v41
    v_mfma_f32_16x16x32_bf16 v[56:59], a[32:35], v[92:95], v[56:59]
    v_cvt_pk_bf16_f32 v41, v42, v43
    v_cvt_pk_bf16_f32 v42, v44, v45
    v_mfma_f32_16x16x32_bf16 v[60:63], a[36:39], v[92:95], v[60:63]
    ds_read_b128 v[84:87], v5 offset:6144
    v_cvt_pk_bf16_f32 v43, v46, v47
    v_mfma_f32_16x16x32_bf16 v[52:55], a[36:39], v[88:91], v[52:55]
    buffer_store_dwordx4 v[40:43], v1, s[16:19], s49 offen offset:2048 sc1
    v_mfma_f32_16x16x32_bf16 v[64:67], a[40:43], v[88:91], v[64:67]
    s_add_u32 s90, s90, 262144
    v_mfma_f32_16x16x32_bf16 v[72:75], a[40:43], v[92:95], v[72:75]
    v_mfma_f32_16x16x32_bf16 v[76:79], a[44:47], v[92:95], v[76:79]
    buffer_store_dword v120, v12, s[16:19], s46 offen sc1
    v_mfma_f32_16x16x32_bf16 v[68:71], a[44:47], v[88:91], v[68:71]
    s_waitcnt lgkmcnt(0)
    v_mfma_f32_16x16x32_bf16 v[48:51], a[48:51], v[80:83], v[48:51]
    s_add_u32 s98, s98, 262144
    ds_read_b128 v[88:91], v4 offset:8192
    s_min_i32 s98, s98, s96
    v_mfma_f32_16x16x32_bf16 v[56:59], a[48:51], v[84:87], v[56:59]
    s_and_b32 s41, s98, 0xffffffff
    s_add_u32 m0, s43, 0
    s_add_u32 s42, s41, 0
    v_mfma_f32_16x16x32_bf16 v[60:63], a[52:55], v[84:87], v[60:63]
    ds_read_b128 v[92:95], v5 offset:8192
    v_mfma_f32_16x16x32_bf16 v[52:55], a[52:55], v[80:83], v[52:55]
    v_mfma_f32_16x16x32_bf16 v[64:67], a[56:59], v[80:83], v[64:67]
    v_mfma_f32_16x16x32_bf16 v[72:75], a[56:59], v[84:87], v[72:75]
    v_mfma_f32_16x16x32_bf16 v[76:79], a[60:63], v[84:87], v[76:79]
    v_mfma_f32_16x16x32_bf16 v[68:71], a[60:63], v[80:83], v[68:71]
    s_waitcnt lgkmcnt(0)
    v_mfma_f32_16x16x32_bf16 v[48:51], a[64:67], v[88:91], v[48:51]
    ds_read_b128 v[80:83], v4 offset:10240
    v_mfma_f32_16x16x32_bf16 v[56:59], a[64:67], v[92:95], v[56:59]
    v_mfma_f32_16x16x32_bf16 v[60:63], a[68:71], v[92:95], v[60:63]
    ds_read_b128 v[84:87], v5 offset:10240
    v_mfma_f32_16x16x32_bf16 v[52:55], a[68:71], v[88:91], v[52:55]
    v_mfma_f32_16x16x32_bf16 v[64:67], a[72:75], v[88:91], v[64:67]
    v_mfma_f32_16x16x32_bf16 v[72:75], a[72:75], v[92:95], v[72:75]
    v_mfma_f32_16x16x32_bf16 v[76:79], a[76:79], v[92:95], v[76:79]
    v_mfma_f32_16x16x32_bf16 v[68:71], a[76:79], v[88:91], v[68:71]
    s_waitcnt lgkmcnt(0)
    v_mfma_f32_16x16x32_bf16 v[48:51], a[80:83], v[80:83], v[48:51]
    ds_read_b128 v[88:91], v4 offset:12288
    v_mfma_f32_16x16x32_bf16 v[56:59], a[80:83], v[84:87], v[56:59]
    v_mfma_f32_16x16x32_bf16 v[60:63], a[84:87], v[84:87], v[60:63]
    ds_read_b128 v[92:95], v5 offset:12288
    v_mfma_f32_16x16x32_bf16 v[52:55], a[84:87], v[80:83], v[52:55]
    v_mfma_f32_16x16x32_bf16 v[64:67], a[88:91], v[80:83], v[64:67]
    s_waitcnt vmcnt(5)
    v_cmp_ne_u32 vcc, 0, v13
    v_mfma_f32_16x16x32_bf16 v[72:75], a[88:91], v[84:87], v[72:75]
    v_mfma_f32_16x16x32_bf16 v[76:79], a[92:95], v[84:87], v[76:79]
    s_cbranch_vccnz L_spin67
L_back68:
    s_sub_u32 s48, s90, 524288
    s_and_b32 s48, s48, 0xffffffff
    v_mfma_f32_16x16x32_bf16 v[68:71], a[92:95], v[80:83], v[68:71]
    s_waitcnt lgkmcnt(0)
    s_cmp_lt_i32 s36, 2
    s_cselect_b32 s48, s52, s48
    v_mfma_f32_16x16x32_bf16 v[48:51], a[96:99], v[88:91], v[48:51]
    ds_read_b128 v[80:83], v4 offset:14336
    v_mfma_f32_16x16x32_bf16 v[56:59], a[96:99], v[92:95], v[56:59]
    buffer_load_dword v96, v6, s[16:19], s45 offen sc1
    v_mfma_f32_16x16x32_bf16 v[60:63], a[100:103], v[92:95], v[60:63]
    ds_read_b128 v[84:87], v5 offset:14336
    v_mfma_f32_16x16x32_bf16 v[52:55], a[100:103], v[88:91], v[52:55]
    v_mfma_f32_16x16x32_bf16 v[64:67], a[104:107], v[88:91], v[64:67]
    buffer_load_dwordx4 v[128:131], v1, s[16:19], s48 offen offset:0 sc1
    v_mfma_f32_16x16x32_bf16 v[72:75], a[104:107], v[92:95], v[72:75]
    v_mfma_f32_16x16x32_bf16 v[76:79], a[108:111], v[92:95], v[76:79]
    v_mfma_f32_16x16x32_bf16 v[68:71], a[108:111], v[88:91], v[68:71]
    s_waitcnt lgkmcnt(0)
    v_mfma_f32_16x16x32_bf16 v[48:51], a[112:115], v[80:83], v[48:51]
    ds_read_b128 v[88:91], v4 offset:16384
    v_mfma_f32_16x16x32_bf16 v[56:59], a[112:115], v[84:87], v[56:59]
    buffer_load_dwordx4 v[132:135], v1, s[16:19], s48 offen offset:1024 sc1
    v_mfma_f32_16x16x32_bf16 v[60:63], a[116:119], v[84:87], v[60:63]
    ds_read_b128 v[92:95], v5 offset:16384
    v_mfma_f32_16x16x32_bf16 v[52:55], a[116:119], v[80:83], v[52:55]
    v_mfma_f32_16x16x32_bf16 v[64:67], a[120:123], v[80:83], v[64:67]
    buffer_load_dwordx4 v[136:139], v1, s[16:19], s48 offen offset:2048 sc1
    v_mfma_f32_16x16x32_bf16 v[72:75], a[120:123], v[84:87], v[72:75]
    v_mfma_f32_16x16x32_bf16 v[76:79], a[124:127], v[84:87], v[76:79]
    v_mfma_f32_16x16x32_bf16 v[68:71], a[124:127], v[80:83], v[68:71]
    s_waitcnt lgkmcnt(0)
    v_mfma_f32_16x16x32_bf16 v[48:51], a[128:131], v[88:91], v[48:51]
    ds_read_b128 v[80:83], v4 offset:18432
    v_mfma_f32_16x16x32_bf16 v[56:59], a[128:131], v[92:95], v[56:59]
    buffer_load_dwordx4 v[140:143], v1, s[16:19], s48 offen offset:3072 sc1
    v_mfma_f32_16x16x32_bf16 v[60:63], a[132:135], v[92:95], v[60:63]
    s_sub_u32 s47, s36, 2
    ds_read_b128 v[84:87], v5 offset:18432
    s_cmp_lt_u32 s47, 16
    v_mfma_f32_16x16x32_bf16 v[52:55], a[132:135], v[88:91], v[52:55]
    s_cselect_b32 s48, 0x5000000, s52
    s_add_u32 s20, s84, s48
    s_addc_u32 s21, s85, 0
    v_mfma_f32_16x16x32_bf16 v[64:67], a[136:139], v[88:91], v[64:67]
    s_cmp_ge_i32 s47, 16
    s_cselect_b32 s20, s80, s20
    s_cselect_b32 s21, s81, s21
    v_mfma_f32_16x16x32_bf16 v[72:75], a[136:139], v[92:95], v[72:75]
    s_and_b32 s48, s47, 15
    s_lshl_b32 s48, s48, 1
    s_sub_u32 s48, s50, s48
    v_mfma_f32_16x16x32_bf16 v[76:79], a[140:143], v[92:95], v[76:79]
    s_lshl_b32 s46, s48, 10
    s_sub_u32 s46, s55, s46
    s_cmp_lt_u32 s47, 16
    v_mfma_f32_16x16x32_bf16 v[68:71], a[140:143], v[88:91], v[68:71]
    s_waitcnt lgkmcnt(0)
    s_cselect_b32 s46, s46, s52
    s_lshl_b32 s48, s48, 15
    v_mfma_f32_16x16x32_bf16 v[48:51], a[144:147], v[80:83], v[48:51]
    s_waitcnt vmcnt(9)
    ds_read_b128 v[88:91], v4 offset:20480
    v_lshlrev_b32 v120, 16, v116
    v_mfma_f32_16x16x32_bf16 v[56:59], a[144:147], v[84:87], v[56:59]
    v_and_b32 v121, s86, v116
    v_add_f32 v16, v16, v120
    v_mfma_f32_16x16x32_bf16 v[60:63], a[148:151], v[84:87], v[60:63]
    ds_read_b128 v[92:95], v5 offset:20480
    v_add_f32 v17, v17, v121
    v_mfma_f32_16x16x32_bf16 v[52:55], a[148:151], v[80:83], v[52:55]
    v_lshlrev_b32 v122, 16, v117
    v_and_b32 v123, s86, v117
    v_mfma_f32_16x16x32_bf16 v[64:67], a[152:155], v[80:83], v[64:67]
    v_add_f32 v18, v18, v122
    v_add_f32 v19, v19, v123
    v_mfma_f32_16x16x32_bf16 v[72:75], a[152:155], v[84:87], v[72:75]
    v_lshlrev_b32 v120, 16, v118
    v_and_b32 v121, s86, v118
    v_mfma_f32_16x16x32_bf16 v[76:79], a[156:159], v[84:87], v[76:79]
    v_add_f32 v20, v20, v120
    v_add_f32 v21, v21, v121
    v_mfma_f32_16x16x32_bf16 v[68:71], a[156:159], v[80:83], v[68:71]
    s_waitcnt lgkmcnt(0)
    v_lshlrev_b32 v122, 16, v119
    v_and_b32 v123, s86, v119
    v_mfma_f32_16x16x32_bf16 v[48:51], a[160:163], v[88:91], v[48:51]
    ds_read_b128 v[80:83], v4 offset:22528
    v_add_f32 v22, v22, v122
    v_mfma_f32_16x16x32_bf16 v[56:59], a[160:163], v[92:95], v[56:59]
    v_add_f32 v23, v23, v123
    v_mfma_f32_16x16x32_bf16 v[60:63], a[164:167], v[92:95], v[60:63]
    ds_read_b128 v[84:87], v5 offset:22528
    v_mfma_f32_16x16x32_bf16 v[52:55], a[164:167], v[88:91], v[52:55]
    v_mfma_f32_16x16x32_bf16 v[64:67], a[168:171], v[88:91], v[64:67]
    v_mfma_f32_16x16x32_bf16 v[72:75], a[168:171], v[92:95], v[72:75]
    v_mfma_f32_16x16x32_bf16 v[76:79], a[172:175], v[92:95], v[76:79]
    v_mfma_f32_16x16x32_bf16 v[68:71], a[172:175], v[88:91], v[68:71]
    s_waitcnt lgkmcnt(0)
    v_mfma_f32_16x16x32_bf16 v[48:51], a[176:179], v[80:83], v[48:51]
    ds_read_b128 v[88:91], v4 offset:24576
    v_mfma_f32_16x16x32_bf16 v[56:59], a[176:179], v[84:87], v[56:59]
    v_mfma_f32_16x16x32_bf16 v[60:63], a[180:183], v[84:87], v[60:63]
    ds_read_b128 v[92:95], v5 offset:24576
    v_mfma_f32_16x16x32_bf16 v[52:55], a[180:183], v[80:83], v[52:55]
    v_mfma_f32_16x16x32_bf16 v[64:67], a[184:187], v[80:83], v[64:67]
    s_waitcnt vmcnt(4)
    v_cmp_ne_u32 vcc, 0, v96
    s_waitcnt vmcnt(3)
    v_mfma_f32_16x16x32_bf16 v[72:75], a[184:187], v[84:87], v[72:75]
    v_lshlrev_b32 v120, 16, v128
    v_and_b32 v121, s86, v128
    v_mfma_f32_16x16x32_bf16 v[76:79], a[188:191], v[84:87], v[76:79]
    s_cbranch_vccnz L_spin69
L_back70:
    v_add_f32 v108, v108, v120
    v_add_f32 v109, v109, v121
    v_mfma_f32_16x16x32_bf16 v[68:71], a[188:191], v[80:83], v[68:71]
    s_waitcnt lgkmcnt(0)
    v_lshlrev_b32 v122, 16, v129
    v_and_b32 v123, s86, v129
    v_mfma_f32_16x16x32_bf16 v[48:51], a[192:195], v[88:91], v[48:51]
    s_barrier
    ds_read_b128 v[80:83], v4 offset:26624
    v_add_f32 v110, v110, v122
    v_mfma_f32_16x16x32_bf16 v[56:59], a[192:195], v[92:95], v[56:59]
    buffer_load_dwordx4 v1, s[16:19], s42 offen offset:0 sc1 lds
    v_mfma_f32_16x16x32_bf16 v[60:63], a[196:199], v[92:95], v[60:63]
    ds_read_b128 v[84:87], v5 offset:26624
    v_add_f32 v111, v111, v123
    v_mfma_f32_16x16x32_bf16 v[52:55], a[196:199], v[88:91], v[52:55]
    v_lshlrev_b32 v120, 16, v130
    v_and_b32 v121, s86, v130
    v_mfma_f32_16x16x32_bf16 v[64:67], a[200:203], v[88:91], v[64:67]
    v_add_f32 v112, v112, v120
    v_add_f32 v113, v113, v121
    v_mfma_f32_16x16x32_bf16 v[72:75], a[200:203], v[92:95], v[72:75]
    buffer_load_dwordx4 v1, s[16:19], s42 offen offset:1024 sc1 lds
    v_mfma_f32_16x16x32_bf16 v[76:79], a[204:207], v[92:95], v[76:79]
    v_lshlrev_b32 v122, 16, v131
    v_and_b32 v123, s86, v131
    v_mfma_f32_16x16x32_bf16 v[68:71], a[204:207], v[88:91], v[68:71]
    s_waitcnt lgkmcnt(0)
    v_add_f32 v114, v114, v122
    v_add_f32 v115, v115, v123
    v_mfma_f32_16x16x32_bf16 v[48:51], a[208:211], v[80:83], v[48:51]
    s_waitcnt vmcnt(4)
    ds_read_b128 v[88:91], v4 offset:28672
    v_lshlrev_b32 v120, 16, v132
    v_mfma_f32_16x16x32_bf16 v[56:59], a[208:211], v[84:87], v[56:59]
    buffer_load_dwordx4 v1, s[16:19], s42 offen offset:2048 sc1 lds
    v_mfma_f32_16x16x32_bf16 v[60:63], a[212:215], v[84:87], v[60:63]
    ds_read_b128 v[92:95], v5 offset:28672
    v_and_b32 v121, s86, v132
    v_mfma_f32_16x16x32_bf16 v[52:55], a[212:215], v[80:83], v[52:55]
    v_add_f32 v108, v108, v120
    v_add_f32 v109, v109, v121
    v_mfma_f32_16x16x32_bf16 v[64:67], a[216:219], v[80:83], v[64:67]
    v_lshlrev_b32 v122, 16, v133
    v_and_b32 v123, s86, v133
    v_mfma_f32_16x16x32_bf16 v[72:75], a[216:219], v[84:87], v[72:75]
    buffer_load_dwordx4 v1, s[16:19], s42 offen offset:3072 sc1 lds
    v_mfma_f32_16x16x32_bf16 v[76:79], a[220:223], v[84:87], v[76:79]
    s_add_u32 m0, s43, 16384
    v_add_f32 v110, v110, v122
    v_add_f32 v111, v111, v123
    v_mfma_f32_16x16x32_bf16 v[68:71], a[220:223], v[80:83], v[68:71]
    s_waitcnt lgkmcnt(0)
    v_lshlrev_b32 v120, 16, v134
    v_and_b32 v121, s86, v134
    v_mfma_f32_16x16x32_bf16 v[48:51], a[224:227], v[88:91], v[48:51]
    s_add_u32 s42, s41, 16384
    ds_read_b128 v[80:83], v4 offset:30720
    v_add_f32 v112, v112, v120
    v_mfma_f32_16x16x32_bf16 v[56:59], a[224:227], v[92:95], v[56:59]
    buffer_load_dwordx4 v1, s[16:19], s42 offen offset:0 sc1 lds
    v_mfma_f32_16x16x32_bf16 v[60:63], a[228:231], v[92:95], v[60:63]
    ds_read_b128 v[84:87], v5 offset:30720
    v_add_f32 v113, v113, v121
    v_mfma_f32_16x16x32_bf16 v[52:55], a[228:231], v[88:91], v[52:55]
    v_lshlrev_b32 v122, 16, v135
    v_and_b32 v123, s86, v135
    v_mfma_f32_16x16x32_bf16 v[64:67], a[232:235], v[88:91], v[64:67]
    v_add_f32 v114, v114, v122
    v_add_f32 v115, v115, v123
    v_mfma_f32_16x16x32_bf16 v[72:75], a[232:235], v[92:95], v[72:75]
    buffer_load_dwordx4 v1, s[16:19], s42 offen offset:1024 sc1 lds
    v_mfma_f32_16x16x32_bf16 v[76:79], a[236:239], v[92:95], v[76:79]
    s_waitcnt vmcnt(7)
    v_lshlrev_b32 v120, 16, v136
    v_and_b32 v121, s86, v136
    v_mfma_f32_16x16x32_bf16 v[68:71], a[236:239], v[88:91], v[68:71]
    s_waitcnt lgkmcnt(0)
    v_add_f32 v108, v108, v120
    v_add_f32 v109, v109, v121
    v_mfma_f32_16x16x32_bf16 v[48:51], a[240:243], v[80:83], v[48:51]
    ds_read_b128 v[88:91], v4 offset:32768
    v_lshlrev_b32 v122, 16, v137
    v_mfma_f32_16x16x32_bf16 v[56:59], a[240:243], v[84:87], v[56:59]
    buffer_load_dwordx4 v1, s[16:19], s42 offen offset:2048 sc1 lds
    v_mfma_f32_16x16x32_bf16 v[60:63], a[244:247], v[84:87], v[60:63]
    ds_read_b128 v[92:95], v5 offset:32768
    v_and_b32 v123, s86, v137
    v_mfma_f32_16x16x32_bf16 v[52:55], a[244:247], v[80:83], v[52:55]
    v_add_f32 v110, v110, v122
    v_add_f32 v111, v111, v123
    v_mfma_f32_16x16x32_bf16 v[64:67], a[248:251], v[80:83], v[64:67]
    v_lshlrev_b32 v120, 16, v138
    v_and_b32 v121, s86, v138
    v_mfma_f32_16x16x32_bf16 v[72:75], a[248:251], v[84:87], v[72:75]
    buffer_load_dwordx4 v1, s[16:19], s42 offen offset:3072 sc1 lds
    v_mfma_f32_16x16x32_bf16 v[76:79], a[252:255], v[84:87], v[76:79]
    v_add_f32 v112, v112, v120
    v_add_f32 v113, v113, v121
    v_mfma_f32_16x16x32_bf16 v[68:71], a[252:255], v[80:83], v[68:71]
    s_waitcnt lgkmcnt(0)
    v_lshlrev_b32 v122, 16, v139
    v_and_b32 v123, s86, v139
    v_mfma_f32_16x16x32_bf16 v[48:51], v[144:147], v[88:91], v[48:51]
    ds_read_b128 v[80:83], v4 offset:34816
    v_add_f32 v114, v114, v122
    v_mfma_f32_16x16x32_bf16 v[56:59], v[144:147], v[92:95], v[56:59]
    buffer_store_dword v124, v124, s[16:19], s91 offen sc1
    v_mfma_f32_16x16x32_bf16 v[60:63], v[148:151], v[92:95], v[60:63]
    s_add_u32 s91, s91, 65536
    ds_read_b128 v[84:87], v5 offset:34816
    v_add_f32 v115, v115, v123
    v_mfma_f32_16x16x32_bf16 v[52:55], v[148:151], v[88:91], v[52:55]
    s_add_u32 s39, s91, -163840
    s_waitcnt vmcnt(9)
    v_lshlrev_b32 v120, 16, v140
    v_mfma_f32_16x16x32_bf16 v[64:67], v[152:155], v[88:91], v[64:67]
    buffer_store_dword v124, v124, s[16:19], s39 offen sc1
    v_mfma_f32_16x16x32_bf16 v[72:75], v[152:155], v[92:95], v[72:75]
    v_and_b32 v121, s86, v140
    v_add_f32 v108, v108, v120
    v_mfma_f32_16x16x32_bf16 v[76:79], v[156:159], v[92:95], v[76:79]
    v_add_f32 v109, v109, v121
    v_lshlrev_b32 v122, 16, v141
    v_mfma_f32_16x16x32_bf16 v[68:71], v[156:159], v[88:91], v[68:71]
    s_waitcnt lgkmcnt(0)
    v_and_b32 v123, s86, v141
    v_add_f32 v110, v110, v122
    v_mfma_f32_16x16x32_bf16 v[48:51], v[160:163], v[80:83], v[48:51]
    ds_read_b128 v[88:91], v4 offset:36864
    v_add_f32 v111, v111, v123
    v_mfma_f32_16x16x32_bf16 v[56:59], v[160:163], v[84:87], v[56:59]
    v_lshlrev_b32 v120, 16, v142
    v_and_b32 v121, s86, v142
    v_mfma_f32_16x16x32_bf16 v[60:63], v[164:167], v[84:87], v[60:63]
    ds_read_b128 v[92:95], v5 offset:36864
    v_add_f32 v112, v112, v120
    v_mfma_f32_16x16x32_bf16 v[52:55], v[164:167], v[80:83], v[52:55]
    v_add_f32 v113, v113, v121
    v_lshlrev_b32 v122, 16, v143
    v_mfma_f32_16x16x32_bf16 v[64:67], v[168:171], v[80:83], v[64:67]
    v_and_b32 v123, s86, v143
    v_add_f32 v114, v114, v122
    v_mfma_f32_16x16x32_bf16 v[72:75], v[168:171], v[84:87], v[72:75]
    v_add_f32 v115, v115, v123
    v_cvt_pk_bf16_f32 v128, v108, v109
    v_mfma_f32_16x16x32_bf16 v[76:79], v[172:175], v[84:87], v[76:79]
    v_cvt_pk_bf16_f32 v129, v110, v111
    v_cvt_pk_bf16_f32 v130, v112, v113
    v_mfma_f32_16x16x32_bf16 v[68:71], v[172:175], v[80:83], v[68:71]
    s_waitcnt lgkmcnt(0)
    v_cvt_pk_bf16_f32 v131, v114, v115
    v_add_f32 v97, v108, v109
    v_mfma_f32_16x16x32_bf16 v[48:51], v[176:179], v[88:91], v[48:51]
    s_add_u32 m0, s43, 32768
    ds_read_b128 v[80:83], v4 offset:38912
    v_mul_f32 v98, v108, v108
    v_mfma_f32_16x16x32_bf16 v[56:59], v[176:179], v[92:95], v[56:59]
    buffer_store_dwordx4 v[128:131], v9, s[20:23], s48 offen sc1
    v_mfma_f32_16x16x32_bf16 v[60:63], v[180:183], v[92:95], v[60:63]
    s_add_u32 s42, s41, 32768
    ds_read_b128 v[84:87], v5 offset:38912
    v_fmac_f32 v98, v109, v109
    v_mfma_f32_16x16x32_bf16 v[52:55], v[180:183], v[88:91], v[52:55]
    v_add_f32 v97, v97, v110
    v_fmac_f32 v98, v110, v110
    v_mfma_f32_16x16x32_bf16 v[64:67], v[184:187], v[88:91], v[64:67]
    buffer_load_dwordx4 v1, s[16:19], s42 offen offset:0 sc1 lds
    v_mfma_f32_16x16x32_bf16 v[72:75], v[184:187], v[92:95], v[72:75]
    v_add_f32 v97, v97, v111
    v_fmac_f32 v98, v111, v111
    v_mfma_f32_16x16x32_bf16 v[76:79], v[188:191], v[92:95], v[76:79]
    v_add_f32 v97, v97, v112
    v_fmac_f32 v98, v112, v112
    v_mfma_f32_16x16x32_bf16 v[68:71], v[188:191], v[88:91], v[68:71]
    s_waitcnt lgkmcnt(0)
    v_add_f32 v97, v97, v113
    v_fmac_f32 v98, v113, v113
    v_mfma_f32_16x16x32_bf16 v[48:51], v[192:195], v[80:83], v[48:51]
    ds_read_b128 v[88:91], v4 offset:40960
    v_add_f32 v97, v97, v114
    v_mfma_f32_16x16x32_bf16 v[56:59], v[192:195], v[84:87], v[56:59]
    buffer_load_dwordx4 v1, s[16:19], s42 offen offset:1024 sc1 lds
    v_mfma_f32_16x16x32_bf16 v[60:63], v[196:199], v[84:87], v[60:63]
    ds_read_b128 v[92:95], v5 offset:40960
    v_fmac_f32 v98, v114, v114
    v_mfma_f32_16x16x32_bf16 v[52:55], v[196:199], v[80:83], v[52:55]
    v_add_f32 v97, v97, v115
    v_fmac_f32 v98, v115, v115
    v_mfma_f32_16x16x32_bf16 v[64:67], v[200:203], v[80:83], v[64:67]
    v_permlane16_swap_b32 v97, v98
    v_mfma_f32_16x16x32_bf16 v[72:75], v[200:203], v[84:87], v[72:75]
    v_add_f32 v97, v97, v98
    v_mov_b32 v99, v97
    v_mfma_f32_16x16x32_bf16 v[76:79], v[204:207], v[84:87], v[76:79]
    buffer_load_dwordx4 v1, s[16:19], s42 offen offset:2048 sc1 lds
    v_mfma_f32_16x16x32_bf16 v[68:71], v[204:207], v[80:83], v[68:71]
    s_waitcnt lgkmcnt(0)
    v_permlane32_swap_b32 v97, v99
    v_mfma_f32_16x16x32_bf16 v[48:51], v[208:211], v[88:91], v[48:51]
    ds_read_b128 v[80:83], v4 offset:43008
    v_add_f32 v97, v97, v99
    v_mfma_f32_16x16x32_bf16 v[56:59], v[208:211], v[92:95], v[56:59]
    ds_write_b32 v10, v97 offset:0
    v_mfma_f32_16x16x32_bf16 v[60:63], v[212:215], v[92:95], v[60:63]
    ds_read_b128 v[84:87], v5 offset:43008
    v_mov_b32 v108, v16
    v_mfma_f32_16x16x32_bf16 v[52:55], v[212:215], v[88:91], v[52:55]
    buffer_load_dwordx4 v1, s[16:19], s42 offen offset:3072 sc1 lds
    v_mfma_f32_16x16x32_bf16 v[64:67], v[216:219], v[88:91], v[64:67]
    s_add_u32 s45, s45, 65536
    v_mov_b32 v109, v17
    v_mov_b32 v110, v18
    v_mfma_f32_16x16x32_bf16 v[72:75], v[216:219], v[92:95], v[72:75]
    v_mov_b32 v111, v19
    v_mov_b32 v112, v20
    v_mfma_f32_16x16x32_bf16 v[76:79], v[220:223], v[92:95], v[76:79]
    v_mov_b32 v113, v21
    v_mov_b32 v114, v22
    v_mfma_f32_16x16x32_bf16 v[68:71], v[220:223], v[88:91], v[68:71]
    s_waitcnt lgkmcnt(0)
    v_mov_b32 v115, v23
    v_mfma_f32_16x16x32_bf16 v[48:51], v[224:227], v[80:83], v[48:51]
    ds_read_b128 v[88:91], v4 offset:45056
    v_mfma_f32_16x16x32_bf16 v[56:59], v[224:227], v[84:87], v[56:59]
    v_mfma_f32_16x16x32_bf16 v[60:63], v[228:231], v[84:87], v[60:63]
    ds_read_b128 v[92:95], v5 offset:45056
    v_mfma_f32_16x16x32_bf16 v[52:55], v[228:231], v[80:83], v[52:55]
    v_mfma_f32_16x16x32_bf16 v[64:67], v[232:235], v[80:83], v[64:67]
    v_mfma_f32_16x16x32_bf16 v[72:75], v[232:235], v[84:87], v[72:75]
    v_mfma_f32_16x16x32_bf16 v[76:79], v[236:239], v[84:87], v[76:79]
    v_mfma_f32_16x16x32_bf16 v[68:71], v[236:239], v[80:83], v[68:71]
    s_waitcnt vmcnt(7) lgkmcnt(0)
    s_barrier
    v_mfma_f32_16x16x32_bf16 v[48:51], v[240:243], v[88:91], v[48:51]
    ds_read_b128 v[80:83], v2 offset:0
    v_mfma_f32_16x16x32_bf16 v[56:59], v[240:243], v[92:95], v[56:59]
    v_mfma_f32_16x16x32_bf16 v[60:63], v[244:247], v[92:95], v[60:63]
    ds_read_b128 v[84:87], v3 offset:0
    v_mfma_f32_16x16x32_bf16 v[52:55], v[244:247], v[88:91], v[52:55]
    v_mfma_f32_16x16x32_bf16 v[64:67], v[248:251], v[88:91], v[64:67]
    v_mfma_f32_16x16x32_bf16 v[72:75], v[248:251], v[92:95], v[72:75]
    v_mfma_f32_16x16x32_bf16 v[76:79], v[252:255], v[92:95], v[76:79]
    s_add_u32 s36, s36, 1
    v_mfma_f32_16x16x32_bf16 v[68:71], v[252:255], v[88:91], v[68:71]
    s_waitcnt lgkmcnt(0)
    s_cmp_lt_u32 s36, 32
    s_cbranch_scc1 L_bf_b0
    s_nop 7
    s_sub_u32 s47, s45, 196608
    s_max_u32 s47, s47, 0x5500000
    buffer_load_dword v13, v8, s[16:19], s47 offen sc1
    s_and_b32 s38, s53, 0xffffffff
    s_cmp_lt_i32 s36, 1
    s_cselect_b32 s38, 0x5e00000, s38
    buffer_load_dwordx4 v[116:119], v1, s[16:19], s38 offen sc1
    s_add_u32 s53, s53, 65536
    s_and_b32 s44, s90, 0xffffffff
    s_cmp_lt_i32 s36, 1
    s_cselect_b32 s44, 0x5e00000, s44
    s_xor_b32 s49, s44, 16384
    v_cvt_pk_bf16_f32 v56, v56, v57
    v_cvt_pk_bf16_f32 v57, v58, v59
    v_cvt_pk_bf16_f32 v58, v60, v61
    v_cvt_pk_bf16_f32 v59, v62, v63
    v_min_u32 v56, -2, v56
    v_min_u32 v57, -2, v57
    v_min_u32 v58, -2, v58
    v_min_u32 v59, -2, v59
    buffer_store_dwordx4 v[56:59], v1, s[16:19], s49 offen offset:0 sc1
    s_xor_b32 s49, s44, 32768
    v_cvt_pk_bf16_f32 v64, v64, v65
    v_cvt_pk_bf16_f32 v65, v66, v67
    v_cvt_pk_bf16_f32 v66, v68, v69
    v_cvt_pk_bf16_f32 v67, v70, v71
    v_min_u32 v64, -2, v64
    v_min_u32 v65, -2, v65
    v_min_u32 v66, -2, v66
    v_min_u32 v67, -2, v67
    buffer_store_dwordx4 v[64:67], v1, s[16:19], s49 offen offset:1024 sc1
    s_xor_b32 s49, s44, 49152
    v_cvt_pk_bf16_f32 v72, v72, v73
    v_cvt_pk_bf16_f32 v73, v74, v75
    v_cvt_pk_bf16_f32 v74, v76, v77
    v_cvt_pk_bf16_f32 v75, v78, v79
    v_min_u32 v72, -2, v72
    v_min_u32 v73, -2, v73
    v_min_u32 v74, -2, v74
    v_min_u32 v75, -2, v75
    buffer_store_dwordx4 v[72:75], v1, s[16:19], s49 offen offset:2048 sc1
    s_add_u32 s90, s90, 262144
    s_waitcnt vmcnt(4)
    v_cmp_ne_u32 vcc, 0, v13
    s_cbranch_vccnz L_spin71
L_back72:
    s_barrier
    s_sub_u32 s48, s90, 524288
    s_and_b32 s48, s48, 0xffffffff
    s_cmp_lt_i32 s36, 2
    s_cselect_b32 s48, s52, s48
    buffer_load_dwordx4 v[128:131], v1, s[16:19], s48 offen offset:0 sc1
    buffer_load_dwordx4 v[132:135], v1, s[16:19], s48 offen offset:1024 sc1
    buffer_load_dwordx4 v[136:139], v1, s[16:19], s48 offen offset:2048 sc1
    buffer_load_dwordx4 v[140:143], v1, s[16:19], s48 offen offset:3072 sc1
    s_sub_u32 s47, s36, 2
    s_cmp_lt_u32 s47, 16
    s_cselect_b32 s48, 0x5000000, s52
    s_add_u32 s20, s84, s48
    s_addc_u32 s21, s85, 0
    s_cmp_ge_i32 s47, 16
    s_cselect_b32 s20, s80, s20
    s_cselect_b32 s21, s81, s21
    s_and_b32 s48, s47, 15
    s_lshl_b32 s48, s48, 1
    s_sub_u32 s48, s50, s48
    s_lshl_b32 s46, s48, 10
    s_sub_u32 s46, s55, s46
    s_cmp_lt_u32 s47, 16
    s_cselect_b32 s46, s46, s52
    s_lshl_b32 s48, s48, 15
    v_mov_b32 v184, 0
    v_mov_b32 v185, 0
    v_mov_b32 v186, 0
    v_mov_b32 v187, 0
    v_mov_b32 v188, 0
    v_mov_b32 v189, 0
    v_mov_b32 v190, 0
    v_mov_b32 v191, 0
    v_mov_b32 v193, 0x3f80
    v_and_b32 v192, 1, v0
    v_lshlrev_b32 v192, 4, v192
    v_lshlrev_b32 v192, v192, v193
    s_mov_b32 exec_lo, 0x300003
    s_mov_b32 exec_hi, 0x30000300
    v_mov_b32 v184, v192
    v_mov_b32 v190, v192
    s_mov_b32 exec_lo, 0xc0000c
    s_mov_b32 exec_hi, 0xc0000c00
    v_mov_b32 v185, v192
    v_mov_b32 v191, v192
    s_mov_b64 exec, -1
    s_waitcnt vmcnt(7)
    v_mfma_f32_16x16x32_bf16 v[48:51], v[184:187], v[116:119], v[48:51]
    v_mfma_f32_16x16x32_bf16 v[52:55], v[188:191], v[116:119], v[52:55]
    s_waitcnt vmcnt(4)
    buffer_load_dwordx4 v[160:163], v1, s[16:19], s44 offen offset:0 sc1
    buffer_load_dwordx4 v[164:167], v1, s[16:19], s44 offen offset:1024 sc1
    buffer_load_dwordx4 v[168:171], v1, s[16:19], s44 offen offset:2048 sc1
    buffer_load_dwordx4 v[172:175], v1, s[16:19], s44 offen offset:3072 sc1
    s_waitcnt vmcnt(4)
    v_lshlrev_b32 v120, 16, v128
    v_and_b32 v121, s86, v128
    v_add_f32 v108, v108, v120
    v_add_f32 v109, v109, v121
    v_lshlrev_b32 v122, 16, v129
    v_and_b32 v123, s86, v129
    v_add_f32 v110, v110, v122
    v_add_f32 v111, v111, v123
    v_lshlrev_b32 v120, 16, v130
    v_and_b32 v121, s86, v130
    v_add_f32 v112, v112, v120
    v_add_f32 v113, v113, v121
    v_lshlrev_b32 v122, 16, v131
    v_and_b32 v123, s86, v131
    v_add_f32 v114, v114, v122
    v_add_f32 v115, v115, v123
    v_lshlrev_b32 v120, 16, v132
    v_and_b32 v121, s86, v132
    v_add_f32 v108, v108, v120
    v_add_f32 v109, v109, v121
    v_lshlrev_b32 v122, 16, v133
    v_and_b32 v123, s86, v133
    v_add_f32 v110, v110, v122
    v_add_f32 v111, v111, v123
    v_lshlrev_b32 v120, 16, v134
    v_and_b32 v121, s86, v134
    v_add_f32 v112, v112, v120
    v_add_f32 v113, v113, v121
    v_lshlrev_b32 v122, 16, v135
    v_and_b32 v123, s86, v135
    v_add_f32 v114, v114, v122
    v_add_f32 v115, v115, v123
    v_lshlrev_b32 v120, 16, v136
    v_and_b32 v121, s86, v136
    v_add_f32 v108, v108, v120
    v_add_f32 v109, v109, v121
    v_lshlrev_b32 v122, 16, v137
    v_and_b32 v123, s86, v137
    v_add_f32 v110, v110, v122
    v_add_f32 v111, v111, v123
    v_lshlrev_b32 v120, 16, v138
    v_and_b32 v121, s86, v138
    v_add_f32 v112, v112, v120
    v_add_f32 v113, v113, v121
    v_lshlrev_b32 v122, 16, v139
    v_and_b32 v123, s86, v139
    v_add_f32 v114, v114, v122
    v_add_f32 v115, v115, v123
    v_lshlrev_b32 v120, 16, v140
    v_and_b32 v121, s86, v140
    v_add_f32 v108, v108, v120
    v_add_f32 v109, v109, v121
    v_lshlrev_b32 v122, 16, v141
    v_and_b32 v123, s86, v141
    v_add_f32 v110, v110, v122
    v_add_f32 v111, v111, v123
    v_lshlrev_b32 v120, 16, v142
    v_and_b32 v121, s86, v142
    v_add_f32 v112, v112, v120
    v_add_f32 v113, v113, v121
    v_lshlrev_b32 v122, 16, v143
    v_and_b32 v123, s86, v143
    v_add_f32 v114, v114, v122
    v_add_f32 v115, v115, v123
    v_cvt_pk_bf16_f32 v128, v108, v109
    v_cvt_pk_bf16_f32 v129, v110, v111
    v_cvt_pk_bf16_f32 v130, v112, v113
    v_cvt_pk_bf16_f32 v131, v114, v115
    s_waitcnt vmcnt(0)
    v_max3_u32 v176, v160, v161, v162
    v_max3_u32 v177, v163, v164, v165
    v_max3_u32 v178, v166, v167, v168
    v_max3_u32 v179, v169, v170, v171
    v_max3_u32 v180, v172, v173, v174
    v_max3_u32 v176, v176, v177, v178
    v_max3_u32 v179, v179, v180, v175
    v_max_u32 v176, v176, v179
    v_cmp_eq_u32 vcc, -1, v176
    s_cbranch_vccnz L_gspin73
L_gback74:
    buffer_store_dwordx4 v[128:131], v9, s[20:23], s48 offen sc1
    v_mfma_f32_16x16x32_bf16 v[48:51], v[184:187], v[160:163], v[48:51]
    v_mfma_f32_16x16x32_bf16 v[52:55], v[188:191], v[160:163], v[52:55]
    v_mfma_f32_16x16x32_bf16 v[48:51], v[184:187], v[164:167], v[48:51]
    v_mfma_f32_16x16x32_bf16 v[52:55], v[188:191], v[164:167], v[52:55]
    v_mfma_f32_16x16x32_bf16 v[48:51], v[184:187], v[168:171], v[48:51]
    v_mfma_f32_16x16x32_bf16 v[52:55], v[188:191], v[168:171], v[52:55]
    v_mfma_f32_16x16x32_bf16 v[48:51], v[184:187], v[172:175], v[48:51]
    v_mfma_f32_16x16x32_bf16 v[52:55], v[188:191], v[172:175], v[52:55]
    s_sub_u32 s48, s48, 65536
    s_nop 4
    v_cvt_pk_bf16_f32 v160, v48, v49
    v_cvt_pk_bf16_f32 v161, v50, v51
    v_cvt_pk_bf16_f32 v162, v52, v53
    v_cvt_pk_bf16_f32 v163, v54, v55
    buffer_store_dwordx4 v[160:163], v9, s[20:23], s48 offen sc1
    s_waitcnt vmcnt(0)
    s_endpgm
L_spin56:
    s_mov_b32 s40, 0x20000
L_spin56_l:
    buffer_load_dword v8, v124, s[20:23], 0 offen sc1
    s_sub_u32 s40, s40, 1
    s_waitcnt vmcnt(0)
    v_cmp_eq_u32 vcc, v124, v8
    s_cbranch_scc1 L_back57
    s_cbranch_vccz L_back57
    s_sleep 8
    s_branch L_spin56_l
L_spin59:
    s_mov_b32 s40, 0x20000
L_spin59_l:
    buffer_load_dword v80, v124, s[20:23], 0 offen sc1
    s_sub_u32 s40, s40, 1
    s_waitcnt vmcnt(0)
    v_cmp_eq_u32 vcc, v124, v80
    s_cbranch_scc1 L_back60
    s_cbranch_vccz L_back60
    s_sleep 8
    s_branch L_spin59_l
L_spin61:
    s_mov_b32 s40, 0x20000
L_spin61_l:
    buffer_load_dword v96, v6, s[16:19], s45 offen sc1
    s_sub_u32 s40, s40, 1
    s_waitcnt vmcnt(0)
    v_cmp_ne_u32 vcc, 0, v96
    s_cbranch_scc1 L_back62
    s_cbranch_vccz L_back62
    s_sleep 2
    s_branch L_spin61_l
L_spin63:
    s_mov_b32 s40, 0x20000
L_spin63_l:
    buffer_load_dword v13, v8, s[16:19], s47 offen sc1
    s_sub_u32 s40, s40, 1
    s_waitcnt vmcnt(0)
    v_cmp_ne_u32 vcc, 0, v13
    s_cbranch_scc1 L_back64
    s_cbranch_vccz L_back64
    s_sleep 2
    s_branch L_spin63_l
L_spin65:
    s_mov_b32 s40, 0x20000
L_spin65_l:
    buffer_load_dword v96, v6, s[16:19], s45 offen sc1
    s_sub_u32 s40, s40, 1
    s_waitcnt vmcnt(0)
    v_cmp_ne_u32 vcc, 0, v96
    s_cbranch_scc1 L_back66
    s_cbranch_vccz L_back66
    s_sleep 2
    s_branch L_spin65_l
L_spin67:
    s_mov_b32 s40, 0x20000
L_spin67_l:
    buffer_load_dword v13, v8, s[16:19], s47 offen sc1
    s_sub_u32 s40, s40, 1
    s_waitcnt vmcnt(0)
    v_cmp_ne_u32 vcc, 0, v13
    s_cbranch_scc1 L_back68
    s_cbranch_vccz L_back68
    s_sleep 2
    s_branch L_spin67_l
L_spin69:
    s_mov_b32 s40, 0x20000
L_spin69_l:
    buffer_load_dword v96, v6, s[16:19], s45 offen sc1
    s_sub_u32 s40, s40, 1
    s_waitcnt vmcnt(0)
    v_cmp_ne_u32 vcc, 0, v96
    s_cbranch_scc1 L_back70
    s_cbranch_vccz L_back70
    s_sleep 2
    s_branch L_spin69_l
L_spin71:
    s_mov_b32 s40, 0x20000
L_spin71_l:
    buffer_load_dword v13, v8, s[16:19], s47 offen sc1
    s_sub_u32 s40, s40, 1
    s_waitcnt vmcnt(0)
    v_cmp_ne_u32 vcc, 0, v13
    s_cbranch_scc1 L_back72
    s_cbranch_vccz L_back72
    s_sleep 2
    s_branch L_spin71_l
L_gspin73:
    s_mov_b32 s40, 0x20000
L_gspin73_l:
    buffer_load_dwordx4 v[160:163], v1, s[16:19], s44 offen offset:0 sc1
    buffer_load_dwordx4 v[164:167], v1, s[16:19], s44 offen offset:1024 sc1
    buffer_load_dwordx4 v[168:171], v1, s[16:19], s44 offen offset:2048 sc1
    buffer_load_dwordx4 v[172:175], v1, s[16:19], s44 offen offset:3072 sc1
    s_sub_u32 s40, s40, 1
    s_waitcnt vmcnt(0)
    v_max3_u32 v176, v160, v161, v162
    v_max3_u32 v177, v163, v164, v165
    v_max3_u32 v178, v166, v167, v168
    v_max3_u32 v179, v169, v170, v171
    v_max3_u32 v180, v172, v173, v174
    v_max3_u32 v176, v176, v177, v178
    v_max3_u32 v179, v179, v180, v175
    v_max_u32 v176, v176, v179
    v_cmp_eq_u32 vcc, -1, v176
    s_cbranch_scc1 L_gback74
    s_cbranch_vccz L_gback74
    s_sleep 2
    s_branch L_gspin73_l
L_role_60:
    s_sub_u32 s35, s34, 44
    s_barrier
    s_add_u32 s12, s72, 0x400000
    s_addc_u32 s13, s73, 0
    s_mov_b32 s14, 0x300000
    s_mov_b32 s15, 0x00020000
    s_sub_u32 s37, s35, 12
    s_lshl2_add_u32 s37, s37, s33
    s_lshl2_add_u32 s37, s37, s32
    s_lshl_b32 s37, s37, 13
    v_lshlrev_b32 v6, 7, v0
    buffer_load_dword v240, v6, s[12:15], s37 offen
    s_add_u32 s37, s37, 1048576
    buffer_load_dword v241, v6, s[12:15], s37 offen
    s_add_u32 s37, s37, 1048576
    buffer_load_dword v242, v6, s[12:15], s37 offen
    s_add_u32 s37, s37, 1048576
    s_lshr_b32 s51, s35, 2
    s_and_b32 s87, s35, 3
    s_mul_i32 s54, s51, 1507328
    s_lshl_b32 s37, s87, 9
    s_add_u32 s54, s54, s37
    s_mov_b32 s12, s76
    s_mov_b32 s13, s77
    s_mov_b32 s14, 0x700000
    s_mov_b32 s15, 0x00020000
    s_mov_b32 s39, 2048
    v_lshrrev_b32 v64, 3, v0
    v_lshlrev_b32 v65, 2, v0
    v_and_b32 v65, 64, v65
    v_and_b32 v66, 0x70, v1
    v_xor_b32 v65, v65, v66
    v_mad_u32_u24 v48, v64, s39, v65
    v_add_u32 v49, 16384, v48
    v_add_u32 v50, 128, v48
    v_add_u32 v51, 16512, v48
    v_add_u32 v52, 256, v48
    v_add_u32 v53, 16640, v48
    v_add_u32 v54, 384, v48
    v_add_u32 v55, 16768, v48
    s_mul_i32 s38, s32, 32768
    s_add_u32 s54, s54, s38
    s_lshl_b32 s42, s32, 11
    s_add_u32 m0, s42, 0
    s_nop 0
    buffer_load_dwordx4 v48, s[12:15], s54 offen lds
    s_add_u32 m0, s42, 1024
    s_nop 0
    buffer_load_dwordx4 v49, s[12:15], s54 offen lds
    s_add_u32 m0, s42, 8192
    s_nop 0
    buffer_load_dwordx4 v50, s[12:15], s54 offen lds
    s_add_u32 m0, s42, 9216
    s_nop 0
    buffer_load_dwordx4 v51, s[12:15], s54 offen lds
    s_add_u32 m0, s42, 16384
    s_nop 0
    buffer_load_dwordx4 v52, s[12:15], s54 offen lds
    s_add_u32 m0, s42, 17408
    s_nop 0
    buffer_load_dwordx4 v53, s[12:15], s54 offen lds
    s_add_u32 m0, s42, 24576
    s_nop 0
    buffer_load_dwordx4 v54, s[12:15], s54 offen lds
    s_add_u32 m0, s42, 25600
    s_nop 0
    buffer_load_dwordx4 v55, s[12:15], s54 offen lds
    s_add_u32 s54, s54, 131072
    s_add_u32 m0, s42, 32768
    s_nop 0
    buffer_load_dwordx4 v48, s[12:15], s54 offen lds
    s_add_u32 m0, s42, 33792
    s_nop 0
    buffer_load_dwordx4 v49, s[12:15], s54 offen lds
    s_add_u32 m0, s42, 40960
    s_nop 0
    buffer_load_dwordx4 v50, s[12:15], s54 offen lds
    s_add_u32 m0, s42, 41984
    s_nop 0
    buffer_load_dwordx4 v51, s[12:15], s54 offen lds
    s_add_u32 m0, s42, 49152
    s_nop 0
    buffer_load_dwordx4 v52, s[12:15], s54 offen lds
    s_add_u32 m0, s42, 50176
    s_nop 0
    buffer_load_dwordx4 v53, s[12:15], s54 offen lds
    s_add_u32 m0, s42, 57344
    s_nop 0
    buffer_load_dwordx4 v54, s[12:15], s54 offen lds
    s_add_u32 m0, s42, 58368
    s_nop 0
    buffer_load_dwordx4 v55, s[12:15], s54 offen lds
    s_add_u32 s54, s54, 131072
    s_add_u32 m0, s42, 65536
    s_nop 0
    buffer_load_dwordx4 v48, s[12:15], s54 offen lds
    s_add_u32 m0, s42, 66560
    s_nop 0
    buffer_load_dwordx4 v49, s[12:15], s54 offen lds
    s_add_u32 m0, s42, 73728
    s_nop 0
    buffer_load_dwordx4 v50, s[12:15], s54 offen lds
    s_add_u32 m0, s42, 74752
    s_nop 0
    buffer_load_dwordx4 v51, s[12:15], s54 offen lds
    s_add_u32 m0, s42, 81920
    s_nop 0
    buffer_load_dwordx4 v52, s[12:15], s54 offen lds
    s_add_u32 m0, s42, 82944
    s_nop 0
    buffer_load_dwordx4 v53, s[12:15], s54 offen lds
    s_add_u32 m0, s42, 90112
    s_nop 0
    buffer_load_dwordx4 v54, s[12:15], s54 offen lds
    s_add_u32 m0, s42, 91136
    s_nop 0
    buffer_load_dwordx4 v55, s[12:15], s54 offen lds
    s_add_u32 s54, s54, 131072
    s_add_u32 m0, s42, 98304
    s_nop 0
    buffer_load_dwordx4 v48, s[12:15], s54 offen lds
    s_add_u32 m0, s42, 99328
    s_nop 0
    buffer_load_dwordx4 v49, s[12:15], s54 offen lds
    s_add_u32 m0, s42, 106496
    s_nop 0
    buffer_load_dwordx4 v50, s[12:15], s54 offen lds
    s_add_u32 m0, s42, 107520
    s_nop 0
    buffer_load_dwordx4 v51, s[12:15], s54 offen lds
    s_add_u32 m0, s42, 114688
    s_nop 0
    buffer_load_dwordx4 v52, s[12:15], s54 offen lds
    s_add_u32 m0, s42, 115712
    s_nop 0
    buffer_load_dwordx4 v53, s[12:15], s54 offen lds
    s_add_u32 m0, s42, 122880
    s_nop 0
    buffer_load_dwordx4 v54, s[12:15], s54 offen lds
    s_add_u32 m0, s42, 123904
    s_nop 0
    buffer_load_dwordx4 v55, s[12:15], s54 offen lds
    s_add_u32 s54, s54, 131072
    v_lshrrev_b32 v64, 4, v0
    v_bfe_u32 v65, v0, 2, 2
    v_lshl_add_u32 v64, v64, 3, v65
    v_lshlrev_b32 v64, 7, v64
    v_lshrrev_b32 v65, 1, v65
    v_lshl_add_u32 v64, v65, 6, v64
    v_and_b32 v65, 3, v0
    v_lshl_add_u32 v64, v65, 4, v64
    s_lshl_b32 s37, s32, 13
    s_and_b32 s38, s51, 2
    s_lshl_b32 s38, s38, 5
    s_xor_b32 s38, s38, 0
    s_add_u32 s37, s37, s38
    v_xor_b32 v56, s37, v64
    s_lshl_b32 s37, s32, 13
    s_and_b32 s38, s51, 2
    s_lshl_b32 s38, s38, 5
    s_xor_b32 s38, s38, 8
    s_add_u32 s37, s37, s38
    v_xor_b32 v57, s37, v64
    s_lshl_b32 s37, s32, 13
    s_and_b32 s38, s51, 2
    s_lshl_b32 s38, s38, 5
    s_xor_b32 s38, s38, 64
    s_add_u32 s37, s37, s38
    v_xor_b32 v58, s37, v64
    s_lshl_b32 s37, s32, 13
    s_and_b32 s38, s51, 2
    s_lshl_b32 s38, s38, 5
    s_xor_b32 s38, s38, 72
    s_add_u32 s37, s37, s38
    v_xor_b32 v59, s37, v64
    s_and_b32 s39, s51, 1
    s_lshl_b32 s37, s39, 10
    v_add_u32 v2, s37, v1
    v_xor_b32 v3, 1024, v2
    v_add_u32 v4, 98304, v2
    v_add_u32 v5, 98304, v3
    s_mul_i32 s38, s51, 11*43
    s_lshr_b32 s38, s38, 7
    s_add_u32 s38, s38, 24
    s_lshl_b32 s37, s33, 6
    s_add_u32 s37, s37, s38
    s_lshl_b32 s37, s37, 7
    v_lshl_add_u32 v6, v0, 7, s37
    s_cmp_eq_u32 s32, 0
    s_cselect_b32 s37, 6, 0
    v_cmp_le_u32 vcc, s37, v0
    s_nop 1
    v_cndmask_b32 v6, v6, 2.0, vcc
    s_mul_i32 s43, s32, 4096
    s_mul_i32 s88, s32, 2048
    s_sub_u32 s89, s88, s43
    s_mul_i32 s41, s33, 8388608
    s_add_u32 s41, s41, 0x1000000
    s_mul_i32 s37, s51, 47104
    s_add_u32 s41, s41, s37
    s_add_u32 s41, s41, s43
    s_mul_i32 s90, s33, 8388608
    s_add_u32 s90, s90, 0x2fc0000
    s_lshl_b32 s37, s87, 16
    s_add_u32 s90, s90, s37
    s_lshl_b32 s37, s32, 12
    s_add_u32 s90, s90, s37
    s_and_b32 s37, s51, 3
    s_lshl_b32 s37, s37, 14
    s_add_u32 s90, s90, s37
    v_add_u32 v60, 0, v56
    v_add_u32 v61, 0, v57
    v_add_u32 v62, 0, v58
    v_add_u32 v63, 0, v59
    s_waitcnt vmcnt(24)
    s_barrier
    ds_read_b64_tr_b16 a[0:1], v60 offset:0
    ds_read_b64_tr_b16 a[2:3], v60 offset:512
    ds_read_b64_tr_b16 a[4:5], v61 offset:0
    ds_read_b64_tr_b16 a[6:7], v61 offset:512
    ds_read_b64_tr_b16 a[8:9], v62 offset:0
    ds_read_b64_tr_b16 a[10:11], v62 offset:512
    ds_read_b64_tr_b16 a[12:13], v63 offset:0
    ds_read_b64_tr_b16 a[14:15], v63 offset:512
    ds_read_b64_tr_b16 a[16:17], v60 offset:4096
    ds_read_b64_tr_b16 a[18:19], v60 offset:4608
    ds_read_b64_tr_b16 a[20:21], v61 offset:4096
    ds_read_b64_tr_b16 a[22:23], v61 offset:4608
    ds_read_b64_tr_b16 a[24:25], v62 offset:4096
    ds_read_b64_tr_b16 a[26:27], v62 offset:4608
    ds_read_b64_tr_b16 a[28:29], v63 offset:4096
    ds_read_b64_tr_b16 a[30:31], v63 offset:4608
    s_add_u32 m0, s42, 131072
    s_nop 0
    buffer_load_dwordx4 v48, s[12:15], s54 offen lds
    s_add_u32 m0, s42, 132096
    s_nop 0
    buffer_load_dwordx4 v49, s[12:15], s54 offen lds
    s_add_u32 m0, s42, 139264
    s_nop 0
    buffer_load_dwordx4 v50, s[12:15], s54 offen lds
    s_add_u32 m0, s42, 140288
    s_nop 0
    buffer_load_dwordx4 v51, s[12:15], s54 offen lds
    s_add_u32 m0, s42, 147456
    s_nop 0
    buffer_load_dwordx4 v52, s[12:15], s54 offen lds
    s_add_u32 m0, s42, 148480
    s_nop 0
    buffer_load_dwordx4 v53, s[12:15], s54 offen lds
    s_add_u32 m0, s42, 155648
    s_nop 0
    buffer_load_dwordx4 v54, s[12:15], s54 offen lds
    s_add_u32 m0, s42, 156672
    s_nop 0
    buffer_load_dwordx4 v55, s[12:15], s54 offen lds
    s_add_u32 s54, s54, 131072
    s_waitcnt lgkmcnt(0)
    v_add_u32 v60, 32768, v56
    v_add_u32 v61, 32768, v57
    v_add_u32 v62, 32768, v58
    v_add_u32 v63, 32768, v59
    s_waitcnt vmcnt(24)
    s_barrier
    ds_read_b64_tr_b16 a[32:33], v60 offset:0
    ds_read_b64_tr_b16 a[34:35], v60 offset:512
    ds_read_b64_tr_b16 a[36:37], v61 offset:0
    ds_read_b64_tr_b16 a[38:39], v61 offset:512
    ds_read_b64_tr_b16 a[40:41], v62 offset:0
    ds_read_b64_tr_b16 a[42:43], v62 offset:512
    ds_read_b64_tr_b16 a[44:45], v63 offset:0
    ds_read_b64_tr_b16 a[46:47], v63 offset:512
    ds_read_b64_tr_b16 a[48:49], v60 offset:4096
    ds_read_b64_tr_b16 a[50:51], v60 offset:4608
    ds_read_b64_tr_b16 a[52:53], v61 offset:4096
    ds_read_b64_tr_b16 a[54:55], v61 offset:4608
    ds_read_b64_tr_b16 a[56:57], v62 offset:4096
    ds_read_b64_tr_b16 a[58:59], v62 offset:4608
    ds_read_b64_tr_b16 a[60:61], v63 offset:4096
    ds_read_b64_tr_b16 a[62:63], v63 offset:4608
    s_add_u32 m0, s42, 0
    s_nop 0
    buffer_load_dwordx4 v48, s[12:15], s54 offen lds
    s_add_u32 m0, s42, 1024
    s_nop 0
    buffer_load_dwordx4 v49, s[12:15], s54 offen lds
    s_add_u32 m0, s42, 8192
    s_nop 0
    buffer_load_dwordx4 v50, s[12:15], s54 offen lds
    s_add_u32 m0, s42, 9216
    s_nop 0
    buffer_load_dwordx4 v51, s[12:15], s54 offen lds
    s_add_u32 m0, s42, 16384
    s_nop 0
    buffer_load_dwordx4 v52, s[12:15], s54 offen lds
    s_add_u32 m0, s42, 17408
    s_nop 0
    buffer_load_dwordx4 v53, s[12:15], s54 offen lds
    s_add_u32 m0, s42, 24576
    s_nop 0
    buffer_load_dwordx4 v54, s[12:15], s54 offen lds
    s_add_u32 m0, s42, 25600
    s_nop 0
    buffer_load_dwordx4 v55, s[12:15], s54 offen lds
    s_add_u32 s54, s54, 131072
    s_waitcnt lgkmcnt(0)
    v_add_u32 v60, 65536, v56
    v_add_u32 v61, 65536, v57
    v_add_u32 v62, 65536, v58
    v_add_u32 v63, 65536, v59
    s_waitcnt vmcnt(24)
    s_barrier
    ds_read_b64_tr_b16 a[64:65], v60 offset:0
    ds_read_b64_tr_b16 a[66:67], v60 offset:512
    ds_read_b64_tr_b16 a[68:69], v61 offset:0
    ds_read_b64_tr_b16 a[70:71], v61 offset:512
    ds_read_b64_tr_b16 a[72:73], v62 offset:0
    ds_read_b64_tr_b16 a[74:75], v62 offset:512
    ds_read_b64_tr_b16 a[76:77], v63 offset:0
    ds_read_b64_tr_b16 a[78:79], v63 offset:512
    ds_read_b64_tr_b16 a[80:81], v60 offset:4096
    ds_read_b64_tr_b16 a[82:83], v60 offset:4608
    ds_read_b64_tr_b16 a[84:85], v61 offset:4096
    ds_read_b64_tr_b16 a[86:87], v61 offset:4608
    ds_read_b64_tr_b16 a[88:89], v62 offset:4096
    ds_read_b64_tr_b16 a[90:91], v62 offset:4608
    ds_read_b64_tr_b16 a[92:93], v63 offset:4096
    ds_read_b64_tr_b16 a[94:95], v63 offset:4608
    s_add_u32 m0, s42, 32768
    s_nop 0
    buffer_load_dwordx4 v48, s[12:15], s54 offen lds
    s_add_u32 m0, s42, 33792
    s_nop 0
    buffer_load_dwordx4 v49, s[12:15], s54 offen lds
    s_add_u32 m0, s42, 40960
    s_nop 0
    buffer_load_dwordx4 v50, s[12:15], s54 offen lds
    s_add_u32 m0, s42, 41984
    s_nop 0
    buffer_load_dwordx4 v51, s[12:15], s54 offen lds
    s_add_u32 m0, s42, 49152
    s_nop 0
    buffer_load_dwordx4 v52, s[12:15], s54 offen lds
    s_add_u32 m0, s42, 50176
    s_nop 0
    buffer_load_dwordx4 v53, s[12:15], s54 offen lds
    s_add_u32 m0, s42, 57344
    s_nop 0
    buffer_load_dwordx4 v54, s[12:15], s54 offen lds
    s_add_u32 m0, s42, 58368
    s_nop 0
    buffer_load_dwordx4 v55, s[12:15], s54 offen lds
    s_add_u32 s54, s54, 131072
    s_waitcnt lgkmcnt(0)
    v_add_u32 v60, 98304, v56
    v_add_u32 v61, 98304, v57
    v_add_u32 v62, 98304, v58
    v_add_u32 v63, 98304, v59
    s_waitcnt vmcnt(24)
    s_barrier
    ds_read_b64_tr_b16 a[96:97], v60 offset:0
    ds_read_b64_tr_b16 a[98:99], v60 offset:512
    ds_read_b64_tr_b16 a[100:101], v61 offset:0
    ds_read_b64_tr_b16 a[102:103], v61 offset:512
    ds_read_b64_tr_b16 a[104:105], v62 offset:0
    ds_read_b64_tr_b16 a[106:107], v62 offset:512
    ds_read_b64_tr_b16 a[108:109], v63 offset:0
    ds_read_b64_tr_b16 a[110:111], v63 offset:512
    ds_read_b64_tr_b16 a[112:113], v60 offset:4096
    ds_read_b64_tr_b16 a[114:115], v60 offset:4608
    ds_read_b64_tr_b16 a[116:117], v61 offset:4096
    ds_read_b64_tr_b16 a[118:119], v61 offset:4608
    ds_read_b64_tr_b16 a[120:121], v62 offset:4096
    ds_read_b64_tr_b16 a[122:123], v62 offset:4608
    ds_read_b64_tr_b16 a[124:125], v63 offset:4096
    ds_read_b64_tr_b16 a[126:127], v63 offset:4608
    s_add_u32 m0, s42, 65536
    s_nop 0
    buffer_load_dwordx4 v48, s[12:15], s54 offen lds
    s_add_u32 m0, s42, 66560
    s_nop 0
    buffer_load_dwordx4 v49, s[12:15], s54 offen lds
    s_add_u32 m0, s42, 73728
    s_nop 0
    buffer_load_dwordx4 v50, s[12:15], s54 offen lds
    s_add_u32 m0, s42, 74752
    s_nop 0
    buffer_load_dwordx4 v51, s[12:15], s54 offen lds
    s_add_u32 m0, s42, 81920
    s_nop 0
    buffer_load_dwordx4 v52, s[12:15], s54 offen lds
    s_add_u32 m0, s42, 82944
    s_nop 0
    buffer_load_dwordx4 v53, s[12:15], s54 offen lds
    s_add_u32 m0, s42, 90112
    s_nop 0
    buffer_load_dwordx4 v54, s[12:15], s54 offen lds
    s_add_u32 m0, s42, 91136
    s_nop 0
    buffer_load_dwordx4 v55, s[12:15], s54 offen lds
    s_add_u32 s54, s54, 131072
    s_waitcnt lgkmcnt(0)
    v_add_u32 v60, 131072, v56
    v_add_u32 v61, 131072, v57
    v_add_u32 v62, 131072, v58
    v_add_u32 v63, 131072, v59
    s_waitcnt vmcnt(24)
    s_barrier
    ds_read_b64_tr_b16 a[128:129], v60 offset:0
    ds_read_b64_tr_b16 a[130:131], v60 offset:512
    ds_read_b64_tr_b16 a[132:133], v61 offset:0
    ds_read_b64_tr_b16 a[134:135], v61 offset:512
    ds_read_b64_tr_b16 a[136:137], v62 offset:0
    ds_read_b64_tr_b16 a[138:139], v62 offset:512
    ds_read_b64_tr_b16 a[140:141], v63 offset:0
    ds_read_b64_tr_b16 a[142:143], v63 offset:512
    ds_read_b64_tr_b16 a[144:145], v60 offset:4096
    ds_read_b64_tr_b16 a[146:147], v60 offset:4608
    ds_read_b64_tr_b16 a[148:149], v61 offset:4096
    ds_read_b64_tr_b16 a[150:151], v61 offset:4608
    ds_read_b64_tr_b16 a[152:153], v62 offset:4096
    ds_read_b64_tr_b16 a[154:155], v62 offset:4608
    ds_read_b64_tr_b16 a[156:157], v63 offset:4096
    ds_read_b64_tr_b16 a[158:159], v63 offset:4608
    s_add_u32 m0, s42, 98304
    s_nop 0
    buffer_load_dwordx4 v48, s[12:15], s54 offen lds
    s_add_u32 m0, s42, 99328
    s_nop 0
    buffer_load_dwordx4 v49, s[12:15], s54 offen lds
    s_add_u32 m0, s42, 106496
    s_nop 0
    buffer_load_dwordx4 v50, s[12:15], s54 offen lds
    s_add_u32 m0, s42, 107520
    s_nop 0
    buffer_load_dwordx4 v51, s[12:15], s54 offen lds
    s_add_u32 m0, s42, 114688
    s_nop 0
    buffer_load_dwordx4 v52, s[12:15], s54 offen lds
    s_add_u32 m0, s42, 115712
    s_nop 0
    buffer_load_dwordx4 v53, s[12:15], s54 offen lds
    s_add_u32 m0, s42, 122880
    s_nop 0
    buffer_load_dwordx4 v54, s[12:15], s54 offen lds
    s_add_u32 m0, s42, 123904
    s_nop 0
    buffer_load_dwordx4 v55, s[12:15], s54 offen lds
    s_add_u32 s54, s54, 131072
    s_waitcnt lgkmcnt(0)
    v_add_u32 v60, 0, v56
    v_add_u32 v61, 0, v57
    v_add_u32 v62, 0, v58
    v_add_u32 v63, 0, v59
    s_waitcnt vmcnt(24)
    s_barrier
    ds_read_b64_tr_b16 a[160:161], v60 offset:0
    ds_read_b64_tr_b16 a[162:163], v60 offset:512
    ds_read_b64_tr_b16 a[164:165], v61 offset:0
    ds_read_b64_tr_b16 a[166:167], v61 offset:512
    ds_read_b64_tr_b16 a[168:169], v62 offset:0
    ds_read_b64_tr_b16 a[170:171], v62 offset:512
    ds_read_b64_tr_b16 a[172:173], v63 offset:0
    ds_read_b64_tr_b16 a[174:175], v63 offset:512
    ds_read_b64_tr_b16 a[176:177], v60 offset:4096
    ds_read_b64_tr_b16 a[178:179], v60 offset:4608
    ds_read_b64_tr_b16 a[180:181], v61 offset:4096
    ds_read_b64_tr_b16 a[182:183], v61 offset:4608
    ds_read_b64_tr_b16 a[184:185], v62 offset:4096
    ds_read_b64_tr_b16 a[186:187], v62 offset:4608
    ds_read_b64_tr_b16 a[188:189], v63 offset:4096
    ds_read_b64_tr_b16 a[190:191], v63 offset:4608
    s_add_u32 m0, s42, 131072
    s_nop 0
    buffer_load_dwordx4 v48, s[12:15], s54 offen lds
    s_add_u32 m0, s42, 132096
    s_nop 0
    buffer_load_dwordx4 v49, s[12:15], s54 offen lds
    s_add_u32 m0, s42, 139264
    s_nop 0
    buffer_load_dwordx4 v50, s[12:15], s54 offen lds
    s_add_u32 m0, s42, 140288
    s_nop 0
    buffer_load_dwordx4 v51, s[12:15], s54 offen lds
    s_add_u32 m0, s42, 147456
    s_nop 0
    buffer_load_dwordx4 v52, s[12:15], s54 offen lds
    s_add_u32 m0, s42, 148480
    s_nop 0
    buffer_load_dwordx4 v53, s[12:15], s54 offen lds
    s_add_u32 m0, s42, 155648
    s_nop 0
    buffer_load_dwordx4 v54, s[12:15], s54 offen lds
    s_add_u32 m0, s42, 156672
    s_nop 0
    buffer_load_dwordx4 v55, s[12:15], s54 offen lds
    s_add_u32 s54, s54, 131072
    s_waitcnt lgkmcnt(0)
    v_add_u32 v60, 32768, v56
    v_add_u32 v61, 32768, v57
    v_add_u32 v62, 32768, v58
    v_add_u32 v63, 32768, v59
    s_waitcnt vmcnt(24)
    s_barrier
    ds_read_b64_tr_b16 a[192:193], v60 offset:0
    ds_read_b64_tr_b16 a[194:195], v60 offset:512
    ds_read_b64_tr_b16 a[196:197], v61 offset:0
    ds_read_b64_tr_b16 a[198:199], v61 offset:512
    ds_read_b64_tr_b16 a[200:201], v62 offset:0
    ds_read_b64_tr_b16 a[202:203], v62 offset:512
    ds_read_b64_tr_b16 a[204:205], v63 offset:0
    ds_read_b64_tr_b16 a[206:207], v63 offset:512
    ds_read_b64_tr_b16 a[208:209], v60 offset:4096
    ds_read_b64_tr_b16 a[210:211], v60 offset:4608
    ds_read_b64_tr_b16 a[212:213], v61 offset:4096
    ds_read_b64_tr_b16 a[214:215], v61 offset:4608
    ds_read_b64_tr_b16 a[216:217], v62 offset:4096
    ds_read_b64_tr_b16 a[218:219], v62 offset:4608
    ds_read_b64_tr_b16 a[220:221], v63 offset:4096
    ds_read_b64_tr_b16 a[222:223], v63 offset:4608
    s_waitcnt lgkmcnt(0)
    v_add_u32 v60, 65536, v56
    v_add_u32 v61, 65536, v57
    v_add_u32 v62, 65536, v58
    v_add_u32 v63, 65536, v59
    s_waitcnt vmcnt(16)
    s_barrier
    ds_read_b64_tr_b16 a[224:225], v60 offset:0
    ds_read_b64_tr_b16 a[226:227], v60 offset:512
    ds_read_b64_tr_b16 a[228:229], v61 offset:0
    ds_read_b64_tr_b16 a[230:231], v61 offset:512
    ds_read_b64_tr_b16 a[232:233], v62 offset:0
    ds_read_b64_tr_b16 a[234:235], v62 offset:512
    ds_read_b64_tr_b16 a[236:237], v63 offset:0
    ds_read_b64_tr_b16 a[238:239], v63 offset:512
    ds_read_b64_tr_b16 a[240:241], v60 offset:4096
    ds_read_b64_tr_b16 a[242:243], v60 offset:4608
    ds_read_b64_tr_b16 a[244:245], v61 offset:4096
    ds_read_b64_tr_b16 a[246:247], v61 offset:4608
    ds_read_b64_tr_b16 a[248:249], v62 offset:4096
    ds_read_b64_tr_b16 a[250:251], v62 offset:4608
    ds_read_b64_tr_b16 a[252:253], v63 offset:4096
    ds_read_b64_tr_b16 a[254:255], v63 offset:4608
    s_waitcnt lgkmcnt(0)
    v_add_u32 v60, 98304, v56
    v_add_u32 v61, 98304, v57
    v_add_u32 v62, 98304, v58
    v_add_u32 v63, 98304, v59
    s_waitcnt vmcnt(8)
    s_barrier
    ds_read_b64_tr_b16 v[128:129], v60 offset:0
    ds_read_b64_tr_b16 v[130:131], v60 offset:512
    ds_read_b64_tr_b16 v[132:133], v61 offset:0
    ds_read_b64_tr_b16 v[134:135], v61 offset:512
    ds_read_b64_tr_b16 v[136:137], v62 offset:0
    ds_read_b64_tr_b16 v[138:139], v62 offset:512
    ds_read_b64_tr_b16 v[140:141], v63 offset:0
    ds_read_b64_tr_b16 v[142:143], v63 offset:512
    ds_read_b64_tr_b16 v[144:145], v60 offset:4096
    ds_read_b64_tr_b16 v[146:147], v60 offset:4608
    ds_read_b64_tr_b16 v[148:149], v61 offset:4096
    ds_read_b64_tr_b16 v[150:151], v61 offset:4608
    ds_read_b64_tr_b16 v[152:153], v62 offset:4096
    ds_read_b64_tr_b16 v[154:155], v62 offset:4608
    ds_read_b64_tr_b16 v[156:157], v63 offset:4096
    ds_read_b64_tr_b16 v[158:159], v63 offset:4608
    s_waitcnt lgkmcnt(0)
    v_add_u32 v60, 131072, v56
    v_add_u32 v61, 131072, v57
    v_add_u32 v62, 131072, v58
    v_add_u32 v63, 131072, v59
    s_waitcnt vmcnt(0)
    s_barrier
    ds_read_b64_tr_b16 v[160:161], v60 offset:0
    ds_read_b64_tr_b16 v[162:163], v60 offset:512
    ds_read_b64_tr_b16 v[164:165], v61 offset:0
    ds_read_b64_tr_b16 v[166:167], v61 offset:512
    ds_read_b64_tr_b16 v[168:169], v62 offset:0
    ds_read_b64_tr_b16 v[170:171], v62 offset:512
    ds_read_b64_tr_b16 v[172:173], v63 offset:0
    ds_read_b64_tr_b16 v[174:175], v63 offset:512
    ds_read_b64_tr_b16 v[176:177], v60 offset:4096
    ds_read_b64_tr_b16 v[178:179], v60 offset:4608
    ds_read_b64_tr_b16 v[180:181], v61 offset:4096
    ds_read_b64_tr_b16 v[182:183], v61 offset:4608
    ds_read_b64_tr_b16 v[184:185], v62 offset:4096
    ds_read_b64_tr_b16 v[186:187], v62 offset:4608
    ds_read_b64_tr_b16 v[188:189], v63 offset:4096
    ds_read_b64_tr_b16 v[190:191], v63 offset:4608
    s_waitcnt lgkmcnt(0)
    s_barrier
    s_cmp_lg_u32 s32, 0
    s_cbranch_scc1 L_arv75
    s_add_u32 s20, s82, 0x80
    s_addc_u32 s21, s83, 0
    s_mov_b32 s22, 0x4
    s_mov_b32 s23, 0x00020000
    buffer_load_dword v80, v124, s[20:23], 0 offen sc1
    s_waitcnt vmcnt(0)
    v_cmp_eq_u32 vcc, v124, v80
    s_cbranch_vccnz L_spin76
L_back77:
L_arv75:
    s_add_u32 s96, s41, 8126464
    s_mov_b32 s98, s41
    s_mov_b32 s45, 0x5530000
    buffer_load_dword v96, v6, s[16:19], s45 offen sc1
    s_waitcnt vmcnt(0)
    v_cmp_ne_u32 vcc, 0, v96
    s_cbranch_vccnz L_spin78
L_back79:
    s_barrier
    s_mov_b32 s39, 0x5e00000
    s_add_u32 m0, s43, 0
    s_add_u32 s42, s41, 0
    buffer_load_dwordx4 v1, s[16:19], s42 offen offset:0 sc1 lds
    buffer_load_dwordx4 v1, s[16:19], s42 offen offset:1024 sc1 lds
    buffer_load_dwordx4 v1, s[16:19], s42 offen offset:2048 sc1 lds
    buffer_load_dwordx4 v1, s[16:19], s42 offen offset:3072 sc1 lds
    s_add_u32 m0, s88, 16384
    s_add_u32 s42, s41, 16384
    s_add_u32 s42, s42, s89
    buffer_load_dwordx4 v1, s[16:19], s42 offen offset:0 sc1 lds
    buffer_load_dwordx4 v1, s[16:19], s42 offen offset:1024 sc1 lds
    buffer_store_dword v124, v124, s[16:19], s39 offen
    s_add_u32 m0, s43, 24576
    s_add_u32 s42, s41, 24576
    buffer_load_dwordx4 v1, s[16:19], s42 offen offset:0 sc1 lds
    buffer_load_dwordx4 v1, s[16:19], s42 offen offset:1024 sc1 lds
    buffer_load_dwordx4 v1, s[16:19], s42 offen offset:2048 sc1 lds
    buffer_load_dwordx4 v1, s[16:19], s42 offen offset:3072 sc1 lds
    s_add_u32 s45, s45, 65536
    s_waitcnt vmcnt(5) lgkmcnt(0)
    s_barrier
    s_mov_b32 s52, 0x5e00000
    s_mov_b32 s46, 0x5e00000
    s_add_u32 s20, s84, 0x5e00000
    s_addc_u32 s21, s85, 0
    s_mov_b32 s22, 0x400000
    s_mov_b32 s23, 0x00020000
    v_mov_b32 v13, 0
    ds_read_b128 v[80:83], v2 offset:0
    ds_read_b128 v[84:87], v3 offset:0
    s_mov_b32 s36, 0
    s_waitcnt lgkmcnt(0)
    s_nop 7
L_bs_b0:
    v_mfma_f32_16x16x32_bf16 v[16:19], a[0:3], v[80:83], 0
    s_and_b32 s44, s90, 0xffffffff
    ds_read_b128 v[88:91], v2 offset:2048
    s_cmp_lt_i32 s36, 1
    v_mfma_f32_16x16x32_bf16 v[24:27], a[0:3], v[84:87], 0
    s_cselect_b32 s44, 0x5e00000, s44
    s_xor_b32 s49, s44, 0
    v_cvt_pk_bf16_f32 v48, v48, v49
    v_mfma_f32_16x16x32_bf16 v[28:31], a[4:7], v[84:87], 0
    ds_read_b128 v[92:95], v3 offset:2048
    v_cvt_pk_bf16_f32 v49, v50, v51
    v_mfma_f32_16x16x32_bf16 v[20:23], a[4:7], v[80:83], 0
    v_cvt_pk_bf16_f32 v50, v52, v53
    v_cvt_pk_bf16_f32 v51, v54, v55
    v_mfma_f32_16x16x32_bf16 v[32:35], a[8:11], v[80:83], 0
    buffer_store_dwordx4 v[48:51], v1, s[16:19], s49 offen offset:3072 sc1
    v_mfma_f32_16x16x32_bf16 v[40:43], a[8:11], v[84:87], 0
    s_xor_b32 s49, s44, 16384
    v_cvt_pk_bf16_f32 v56, v56, v57
    v_cvt_pk_bf16_f32 v57, v58, v59
    v_mfma_f32_16x16x32_bf16 v[44:47], a[12:15], v[84:87], 0
    v_cvt_pk_bf16_f32 v58, v60, v61
    v_cvt_pk_bf16_f32 v59, v62, v63
    v_mfma_f32_16x16x32_bf16 v[36:39], a[12:15], v[80:83], 0
    s_waitcnt lgkmcnt(0)
    v_mfma_f32_16x16x32_bf16 v[16:19], a[16:19], v[88:91], v[16:19]
    ds_read_b128 v[80:83], v2 offset:4096
    v_mfma_f32_16x16x32_bf16 v[24:27], a[16:19], v[92:95], v[24:27]
    buffer_store_dwordx4 v[56:59], v1, s[16:19], s49 offen offset:3072 sc1
    v_mfma_f32_16x16x32_bf16 v[28:31], a[20:23], v[92:95], v[28:31]
    s_xor_b32 s49, s44, 32768
    ds_read_b128 v[84:87], v3 offset:4096
    v_cvt_pk_bf16_f32 v64, v64, v65
    v_mfma_f32_16x16x32_bf16 v[20:23], a[20:23], v[88:91], v[20:23]
    v_cvt_pk_bf16_f32 v65, v66, v67
    v_cvt_pk_bf16_f32 v66, v68, v69
    v_mfma_f32_16x16x32_bf16 v[32:35], a[24:27], v[88:91], v[32:35]
    v_cvt_pk_bf16_f32 v67, v70, v71
    v_mfma_f32_16x16x32_bf16 v[40:43], a[24:27], v[92:95], v[40:43]
    buffer_store_dwordx4 v[64:67], v1, s[16:19], s49 offen offset:3072 sc1
    v_mfma_f32_16x16x32_bf16 v[44:47], a[28:31], v[92:95], v[44:47]
    s_xor_b32 s49, s44, 49152
    v_cvt_pk_bf16_f32 v72, v72, v73
    v_cvt_pk_bf16_f32 v73, v74, v75
    v_mfma_f32_16x16x32_bf16 v[36:39], a[28:31], v[88:91], v[36:39]
    s_waitcnt lgkmcnt(0)
    v_cvt_pk_bf16_f32 v74, v76, v77
    v_cvt_pk_bf16_f32 v75, v78, v79
    v_mfma_f32_16x16x32_bf16 v[16:19], a[32:35], v[80:83], v[16:19]
    ds_read_b128 v[88:91], v2 offset:6144
    v_mfma_f32_16x16x32_bf16 v[24:27], a[32:35], v[84:87], v[24:27]
    buffer_store_dwordx4 v[72:75], v1, s[16:19], s49 offen offset:3072 sc1
    v_mfma_f32_16x16x32_bf16 v[28:31], a[36:39], v[84:87], v[28:31]
    s_add_u32 s90, s90, 262144
    ds_read_b128 v[92:95], v3 offset:6144
    v_mfma_f32_16x16x32_bf16 v[20:23], a[36:39], v[80:83], v[20:23]
    v_mfma_f32_16x16x32_bf16 v[32:35], a[40:43], v[80:83], v[32:35]
    v_mfma_f32_16x16x32_bf16 v[40:43], a[40:43], v[84:87], v[40:43]
    v_mfma_f32_16x16x32_bf16 v[44:47], a[44:47], v[84:87], v[44:47]
    v_mfma_f32_16x16x32_bf16 v[36:39], a[44:47], v[80:83], v[36:39]
    s_waitcnt lgkmcnt(0)
    v_mfma_f32_16x16x32_bf16 v[16:19], a[48:51], v[88:91], v[16:19]
    s_add_u32 s98, s98, 262144
    ds_read_b128 v[80:83], v2 offset:8192
    s_min_i32 s98, s98, s96
    v_mfma_f32_16x16x32_bf16 v[24:27], a[48:51], v[92:95], v[24:27]
    s_and_b32 s41, s98, 0xffffffff
    s_add_u32 m0, s43, 98304
    s_add_u32 s42, s41, 0
    v_mfma_f32_16x16x32_bf16 v[28:31], a[52:55], v[92:95], v[28:31]
    ds_read_b128 v[84:87], v3 offset:8192
    v_mfma_f32_16x16x32_bf16 v[20:23], a[52:55], v[88:91], v[20:23]
    v_mfma_f32_16x16x32_bf16 v[32:35], a[56:59], v[88:91], v[32:35]
    v_mfma_f32_16x16x32_bf16 v[40:43], a[56:59], v[92:95], v[40:43]
    v_mfma_f32_16x16x32_bf16 v[44:47], a[60:63], v[92:95], v[44:47]
    v_mfma_f32_16x16x32_bf16 v[36:39], a[60:63], v[88:91], v[36:39]
    s_waitcnt lgkmcnt(0)
    v_mfma_f32_16x16x32_bf16 v[16:19], a[64:67], v[80:83], v[16:19]
    ds_read_b128 v[88:91], v2 offset:10240
    v_mfma_f32_16x16x32_bf16 v[24:27], a[64:67], v[84:87], v[24:27]
    buffer_load_dword v96, v6, s[16:19], s45 offen sc1
    v_mfma_f32_16x16x32_bf16 v[28:31], a[68:71], v[84:87], v[28:31]
    ds_read_b128 v[92:95], v3 offset:10240
    v_mfma_f32_16x16x32_bf16 v[20:23], a[68:71], v[80:83], v[20:23]
    v_mfma_f32_16x16x32_bf16 v[32:35], a[72:75], v[80:83], v[32:35]
    v_mfma_f32_16x16x32_bf16 v[40:43], a[72:75], v[84:87], v[40:43]
    v_mfma_f32_16x16x32_bf16 v[44:47], a[76:79], v[84:87], v[44:47]
    v_mfma_f32_16x16x32_bf16 v[36:39], a[76:79], v[80:83], v[36:39]
    s_waitcnt lgkmcnt(0)
    v_mfma_f32_16x16x32_bf16 v[16:19], a[80:83], v[88:91], v[16:19]
    ds_read_b128 v[80:83], v2 offset:12288
    v_mfma_f32_16x16x32_bf16 v[24:27], a[80:83], v[92:95], v[24:27]
    v_mfma_f32_16x16x32_bf16 v[28:31], a[84:87], v[92:95], v[28:31]
    ds_read_b128 v[84:87], v3 offset:12288
    v_mfma_f32_16x16x32_bf16 v[20:23], a[84:87], v[88:91], v[20:23]
    v_mfma_f32_16x16x32_bf16 v[32:35], a[88:91], v[88:91], v[32:35]
    v_mfma_f32_16x16x32_bf16 v[40:43], a[88:91], v[92:95], v[40:43]
    v_mfma_f32_16x16x32_bf16 v[44:47], a[92:95], v[92:95], v[44:47]
    v_mfma_f32_16x16x32_bf16 v[36:39], a[92:95], v[88:91], v[36:39]
    s_waitcnt lgkmcnt(0)
    v_mfma_f32_16x16x32_bf16 v[16:19], a[96:99], v[80:83], v[16:19]
    ds_read_b128 v[88:91], v2 offset:14336
    v_mfma_f32_16x16x32_bf16 v[24:27], a[96:99], v[84:87], v[24:27]
    v_mfma_f32_16x16x32_bf16 v[28:31], a[100:103], v[84:87], v[28:31]
    ds_read_b128 v[92:95], v3 offset:14336
    v_mfma_f32_16x16x32_bf16 v[20:23], a[100:103], v[80:83], v[20:23]
    v_mfma_f32_16x16x32_bf16 v[32:35], a[104:107], v[80:83], v[32:35]
    v_mfma_f32_16x16x32_bf16 v[40:43], a[104:107], v[84:87], v[40:43]
    v_mfma_f32_16x16x32_bf16 v[44:47], a[108:111], v[84:87], v[44:47]
    v_mfma_f32_16x16x32_bf16 v[36:39], a[108:111], v[80:83], v[36:39]
    s_waitcnt lgkmcnt(0)
    v_mfma_f32_16x16x32_bf16 v[16:19], a[112:115], v[88:91], v[16:19]
    ds_read_b128 v[80:83], v2 offset:16384
    v_mfma_f32_16x16x32_bf16 v[24:27], a[112:115], v[92:95], v[24:27]
    v_mfma_f32_16x16x32_bf16 v[28:31], a[116:119], v[92:95], v[28:31]
    ds_read_b128 v[84:87], v3 offset:16384
    v_mfma_f32_16x16x32_bf16 v[20:23], a[116:119], v[88:91], v[20:23]
    v_mfma_f32_16x16x32_bf16 v[32:35], a[120:123], v[88:91], v[32:35]
    v_mfma_f32_16x16x32_bf16 v[40:43], a[120:123], v[92:95], v[40:43]
    v_mfma_f32_16x16x32_bf16 v[44:47], a[124:127], v[92:95], v[44:47]
    v_mfma_f32_16x16x32_bf16 v[36:39], a[124:127], v[88:91], v[36:39]
    s_waitcnt lgkmcnt(0)
    v_mfma_f32_16x16x32_bf16 v[16:19], a[128:131], v[80:83], v[16:19]
    ds_read_b128 v[88:91], v2 offset:18432
    v_mfma_f32_16x16x32_bf16 v[24:27], a[128:131], v[84:87], v[24:27]
    v_mfma_f32_16x16x32_bf16 v[28:31], a[132:135], v[84:87], v[28:31]
    ds_read_b128 v[92:95], v3 offset:18432
    v_mfma_f32_16x16x32_bf16 v[20:23], a[132:135], v[80:83], v[20:23]
    v_mfma_f32_16x16x32_bf16 v[32:35], a[136:139], v[80:83], v[32:35]
    v_mfma_f32_16x16x32_bf16 v[40:43], a[136:139], v[84:87], v[40:43]
    v_mfma_f32_16x16x32_bf16 v[44:47], a[140:143], v[84:87], v[44:47]
    v_mfma_f32_16x16x32_bf16 v[36:39], a[140:143], v[80:83], v[36:39]
    s_waitcnt lgkmcnt(0)
    v_mfma_f32_16x16x32_bf16 v[16:19], a[144:147], v[88:91], v[16:19]
    ds_read_b128 v[80:83], v2 offset:20480
    v_mfma_f32_16x16x32_bf16 v[24:27], a[144:147], v[92:95], v[24:27]
    v_mfma_f32_16x16x32_bf16 v[28:31], a[148:151], v[92:95], v[28:31]
    ds_read_b128 v[84:87], v3 offset:20480
    v_mfma_f32_16x16x32_bf16 v[20:23], a[148:151], v[88:91], v[20:23]
    v_mfma_f32_16x16x32_bf16 v[32:35], a[152:155], v[88:91], v[32:35]
    s_waitcnt vmcnt(0)
    v_cmp_ne_u32 vcc, 0, v96
    v_mfma_f32_16x16x32_bf16 v[40:43], a[152:155], v[92:95], v[40:43]
    v_mfma_f32_16x16x32_bf16 v[44:47], a[156:159], v[92:95], v[44:47]
    s_cbranch_vccnz L_spin80
L_back81:
    s_barrier
    v_mfma_f32_16x16x32_bf16 v[36:39], a[156:159], v[88:91], v[36:39]
    s_waitcnt lgkmcnt(0)
    v_mfma_f32_16x16x32_bf16 v[16:19], a[160:163], v[80:83], v[16:19]
    ds_read_b128 v[88:91], v2 offset:22528
    v_mfma_f32_16x16x32_bf16 v[24:27], a[160:163], v[84:87], v[24:27]
    buffer_load_dwordx4 v1, s[16:19], s42 offen offset:0 sc1 lds
    v_mfma_f32_16x16x32_bf16 v[28:31], a[164:167], v[84:87], v[28:31]
    ds_read_b128 v[92:95], v3 offset:22528
    v_mfma_f32_16x16x32_bf16 v[20:23], a[164:167], v[80:83], v[20:23]
    v_mfma_f32_16x16x32_bf16 v[32:35], a[168:171], v[80:83], v[32:35]
    v_mfma_f32_16x16x32_bf16 v[40:43], a[168:171], v[84:87], v[40:43]
    buffer_load_dwordx4 v1, s[16:19], s42 offen offset:1024 sc1 lds
    v_mfma_f32_16x16x32_bf16 v[44:47], a[172:175], v[84:87], v[44:47]
    v_mfma_f32_16x16x32_bf16 v[36:39], a[172:175], v[80:83], v[36:39]
    s_waitcnt lgkmcnt(0)
    v_mfma_f32_16x16x32_bf16 v[16:19], a[176:179], v[88:91], v[16:19]
    ds_read_b128 v[80:83], v2 offset:24576
    v_mfma_f32_16x16x32_bf16 v[24:27], a[176:179], v[92:95], v[24:27]
    buffer_load_dwordx4 v1, s[16:19], s42 offen offset:2048 sc1 lds
    v_mfma_f32_16x16x32_bf16 v[28:31], a[180:183], v[92:95], v[28:31]
    ds_read_b128 v[84:87], v3 offset:24576
    v_mfma_f32_16x16x32_bf16 v[20:23], a[180:183], v[88:91], v[20:23]
    v_mfma_f32_16x16x32_bf16 v[32:35], a[184:187], v[88:91], v[32:35]
    v_mfma_f32_16x16x32_bf16 v[40:43], a[184:187], v[92:95], v[40:43]
    buffer_load_dwordx4 v1, s[16:19], s42 offen offset:3072 sc1 lds
    v_mfma_f32_16x16x32_bf16 v[44:47], a[188:191], v[92:95], v[44:47]
    s_add_u32 m0, s88, 114688
    s_add_u32 s42, s41, 16384
    s_add_u32 s42, s42, s89
    v_mfma_f32_16x16x32_bf16 v[36:39], a[188:191], v[88:91], v[36:39]
    s_waitcnt lgkmcnt(0)
    v_mfma_f32_16x16x32_bf16 v[16:19], a[192:195], v[80:83], v[16:19]
    ds_read_b128 v[88:91], v2 offset:26624
    v_mfma_f32_16x16x32_bf16 v[24:27], a[192:195], v[84:87], v[24:27]
    buffer_load_dwordx4 v1, s[16:19], s42 offen offset:0 sc1 lds
    v_mfma_f32_16x16x32_bf16 v[28:31], a[196:199], v[84:87], v[28:31]
    ds_read_b128 v[92:95], v3 offset:26624
    v_mfma_f32_16x16x32_bf16 v[20:23], a[196:199], v[80:83], v[20:23]
    v_mfma_f32_16x16x32_bf16 v[32:35], a[200:203], v[80:83], v[32:35]
    v_mfma_f32_16x16x32_bf16 v[40:43], a[200:203], v[84:87], v[40:43]
    buffer_load_dwordx4 v1, s[16:19], s42 offen offset:1024 sc1 lds
    v_mfma_f32_16x16x32_bf16 v[44:47], a[204:207], v[84:87], v[44:47]
    v_mfma_f32_16x16x32_bf16 v[36:39], a[204:207], v[80:83], v[36:39]
    s_waitcnt lgkmcnt(0)
    v_mfma_f32_16x16x32_bf16 v[16:19], a[208:211], v[88:91], v[16:19]
    ds_read_b128 v[80:83], v2 offset:28672
    v_mfma_f32_16x16x32_bf16 v[24:27], a[208:211], v[92:95], v[24:27]
    buffer_store_dword v124, v124, s[16:19], s91 offen sc1
    v_mfma_f32_16x16x32_bf16 v[28:31], a[212:215], v[92:95], v[28:31]
    s_add_u32 s91, s91, 65536
    ds_read_b128 v[84:87], v3 offset:28672
    v_mfma_f32_16x16x32_bf16 v[20:23], a[212:215], v[88:91], v[20:23]
    v_mfma_f32_16x16x32_bf16 v[32:35], a[216:219], v[88:91], v[32:35]
    v_mfma_f32_16x16x32_bf16 v[40:43], a[216:219], v[92:95], v[40:43]
    v_mfma_f32_16x16x32_bf16 v[44:47], a[220:223], v[92:95], v[44:47]
    v_mfma_f32_16x16x32_bf16 v[36:39], a[220:223], v[88:91], v[36:39]
    s_waitcnt lgkmcnt(0)
    v_mfma_f32_16x16x32_bf16 v[16:19], a[224:227], v[80:83], v[16:19]
    ds_read_b128 v[88:91], v2 offset:30720
    v_mfma_f32_16x16x32_bf16 v[24:27], a[224:227], v[84:87], v[24:27]
    v_mfma_f32_16x16x32_bf16 v[28:31], a[228:231], v[84:87], v[28:31]
    ds_read_b128 v[92:95], v3 offset:30720
    v_mfma_f32_16x16x32_bf16 v[20:23], a[228:231], v[80:83], v[20:23]
    v_mfma_f32_16x16x32_bf16 v[32:35], a[232:235], v[80:83], v[32:35]
    v_mfma_f32_16x16x32_bf16 v[40:43], a[232:235], v[84:87], v[40:43]
    v_mfma_f32_16x16x32_bf16 v[44:47], a[236:239], v[84:87], v[44:47]
    v_mfma_f32_16x16x32_bf16 v[36:39], a[236:239], v[80:83], v[36:39]
    s_waitcnt lgkmcnt(0)
    v_mfma_f32_16x16x32_bf16 v[16:19], a[240:243], v[88:91], v[16:19]
    ds_read_b128 v[80:83], v2 offset:32768
    v_mfma_f32_16x16x32_bf16 v[24:27], a[240:243], v[92:95], v[24:27]
    v_mfma_f32_16x16x32_bf16 v[28:31], a[244:247], v[92:95], v[28:31]
    ds_read_b128 v[84:87], v3 offset:32768
    v_mfma_f32_16x16x32_bf16 v[20:23], a[244:247], v[88:91], v[20:23]
    v_mfma_f32_16x16x32_bf16 v[32:35], a[248:251], v[88:91], v[32:35]
    v_mfma_f32_16x16x32_bf16 v[40:43], a[248:251], v[92:95], v[40:43]
    v_mfma_f32_16x16x32_bf16 v[44:47], a[252:255], v[92:95], v[44:47]
    v_mfma_f32_16x16x32_bf16 v[36:39], a[252:255], v[88:91], v[36:39]
    s_waitcnt lgkmcnt(0)
    v_mfma_f32_16x16x32_bf16 v[16:19], v[128:131], v[80:83], v[16:19]
    s_add_u32 m0, s43, 122880
    ds_read_b128 v[88:91], v2 offset:34816
    s_add_u32 s42, s41, 24576
    v_mfma_f32_16x16x32_bf16 v[24:27], v[128:131], v[84:87], v[24:27]
    buffer_load_dwordx4 v1, s[16:19], s42 offen offset:0 sc1 lds
    v_mfma_f32_16x16x32_bf16 v[28:31], v[132:135], v[84:87], v[28:31]
    ds_read_b128 v[92:95], v3 offset:34816
    v_mfma_f32_16x16x32_bf16 v[20:23], v[132:135], v[80:83], v[20:23]
    v_mfma_f32_16x16x32_bf16 v[32:35], v[136:139], v[80:83], v[32:35]
    v_mfma_f32_16x16x32_bf16 v[40:43], v[136:139], v[84:87], v[40:43]
    v_mfma_f32_16x16x32_bf16 v[44:47], v[140:143], v[84:87], v[44:47]
    buffer_load_dwordx4 v1, s[16:19], s42 offen offset:1024 sc1 lds
    v_mfma_f32_16x16x32_bf16 v[36:39], v[140:143], v[80:83], v[36:39]
    s_waitcnt lgkmcnt(0)
    v_mfma_f32_16x16x32_bf16 v[16:19], v[144:147], v[88:91], v[16:19]
    ds_read_b128 v[80:83], v2 offset:36864
    v_mfma_f32_16x16x32_bf16 v[24:27], v[144:147], v[92:95], v[24:27]
    v_mfma_f32_16x16x32_bf16 v[28:31], v[148:151], v[92:95], v[28:31]
    ds_read_b128 v[84:87], v3 offset:36864
    v_mfma_f32_16x16x32_bf16 v[20:23], v[148:151], v[88:91], v[20:23]
    buffer_load_dwordx4 v1, s[16:19], s42 offen offset:2048 sc1 lds
    v_mfma_f32_16x16x32_bf16 v[32:35], v[152:155], v[88:91], v[32:35]
    v_mfma_f32_16x16x32_bf16 v[40:43], v[152:155], v[92:95], v[40:43]
    v_mfma_f32_16x16x32_bf16 v[44:47], v[156:159], v[92:95], v[44:47]
    v_mfma_f32_16x16x32_bf16 v[36:39], v[156:159], v[88:91], v[36:39]
    s_waitcnt lgkmcnt(0)
    v_mfma_f32_16x16x32_bf16 v[16:19], v[160:163], v[80:83], v[16:19]
    ds_read_b128 v[88:91], v2 offset:38912
    v_mfma_f32_16x16x32_bf16 v[24:27], v[160:163], v[84:87], v[24:27]
    buffer_load_dwordx4 v1, s[16:19], s42 offen offset:3072 sc1 lds
    v_mfma_f32_16x16x32_bf16 v[28:31], v[164:167], v[84:87], v[28:31]
    s_add_u32 s45, s45, 65536
    ds_read_b128 v[92:95], v3 offset:38912
    v_mfma_f32_16x16x32_bf16 v[20:23], v[164:167], v[80:83], v[20:23]
    v_mfma_f32_16x16x32_bf16 v[32:35], v[168:171], v[80:83], v[32:35]
    v_mfma_f32_16x16x32_bf16 v[40:43], v[168:171], v[84:87], v[40:43]
    v_mfma_f32_16x16x32_bf16 v[44:47], v[172:175], v[84:87], v[44:47]
    v_mfma_f32_16x16x32_bf16 v[36:39], v[172:175], v[80:83], v[36:39]
    s_waitcnt vmcnt(5) lgkmcnt(0)
    s_barrier
    v_mfma_f32_16x16x32_bf16 v[16:19], v[176:179], v[88:91], v[16:19]
    ds_read_b128 v[80:83], v4 offset:0
    v_mfma_f32_16x16x32_bf16 v[24:27], v[176:179], v[92:95], v[24:27]
    v_mfma_f32_16x16x32_bf16 v[28:31], v[180:183], v[92:95], v[28:31]
    ds_read_b128 v[84:87], v5 offset:0
    v_mfma_f32_16x16x32_bf16 v[20:23], v[180:183], v[88:91], v[20:23]
    v_mfma_f32_16x16x32_bf16 v[32:35], v[184:187], v[88:91], v[32:35]
    v_mfma_f32_16x16x32_bf16 v[40:43], v[184:187], v[92:95], v[40:43]
    v_mfma_f32_16x16x32_bf16 v[44:47], v[188:191], v[92:95], v[44:47]
    s_add_u32 s36, s36, 1
    v_mfma_f32_16x16x32_bf16 v[36:39], v[188:191], v[88:91], v[36:39]
    s_waitcnt lgkmcnt(0)
L_bs_b1:
    v_mfma_f32_16x16x32_bf16 v[48:51], a[0:3], v[80:83], 0
    s_and_b32 s44, s90, 0xffffffff
    ds_read_b128 v[88:91], v4 offset:2048
    s_cmp_lt_i32 s36, 1
    v_mfma_f32_16x16x32_bf16 v[56:59], a[0:3], v[84:87], 0
    s_cselect_b32 s44, 0x5e00000, s44
    s_xor_b32 s49, s44, 0
    v_cvt_pk_bf16_f32 v16, v16, v17
    v_mfma_f32_16x16x32_bf16 v[60:63], a[4:7], v[84:87], 0
    ds_read_b128 v[92:95], v5 offset:2048
    v_cvt_pk_bf16_f32 v17, v18, v19
    v_mfma_f32_16x16x32_bf16 v[52:55], a[4:7], v[80:83], 0
    v_cvt_pk_bf16_f32 v18, v20, v21
    v_cvt_pk_bf16_f32 v19, v22, v23
    v_mfma_f32_16x16x32_bf16 v[64:67], a[8:11], v[80:83], 0
    buffer_store_dwordx4 v[16:19], v1, s[16:19], s49 offen offset:3072 sc1
    v_mfma_f32_16x16x32_bf16 v[72:75], a[8:11], v[84:87], 0
    s_xor_b32 s49, s44, 16384
    v_cvt_pk_bf16_f32 v24, v24, v25
    v_cvt_pk_bf16_f32 v25, v26, v27
    v_mfma_f32_16x16x32_bf16 v[76:79], a[12:15], v[84:87], 0
    v_cvt_pk_bf16_f32 v26, v28, v29
    v_cvt_pk_bf16_f32 v27, v30, v31
    v_mfma_f32_16x16x32_bf16 v[68:71], a[12:15], v[80:83], 0
    s_waitcnt lgkmcnt(0)
    v_mfma_f32_16x16x32_bf16 v[48:51], a[16:19], v[88:91], v[48:51]
    ds_read_b128 v[80:83], v4 offset:4096
    v_mfma_f32_16x16x32_bf16 v[56:59], a[16:19], v[92:95], v[56:59]
    buffer_store_dwordx4 v[24:27], v1, s[16:19], s49 offen offset:3072 sc1
    v_mfma_f32_16x16x32_bf16 v[60:63], a[20:23], v[92:95], v[60:63]
    s_xor_b32 s49, s44, 32768
    ds_read_b128 v[84:87], v5 offset:4096
    v_cvt_pk_bf16_f32 v32, v32, v33
    v_mfma_f32_16x16x32_bf16 v[52:55], a[20:23], v[88:91], v[52:55]
    v_cvt_pk_bf16_f32 v33, v34, v35
    v_cvt_pk_bf16_f32 v34, v36, v37
    v_mfma_f32_16x16x32_bf16 v[64:67], a[24:27], v[88:91], v[64:67]
    v_cvt_pk_bf16_f32 v35, v38, v39
    v_mfma_f32_16x16x32_bf16 v[72:75], a[24:27], v[92:95], v[72:75]
    buffer_store_dwordx4 v[32:35], v1, s[16:19], s49 offen offset:3072 sc1
    v_mfma_f32_16x16x32_bf16 v[76:79], a[28:31], v[92:95], v[76:79]
    s_xor_b32 s49, s44, 49152
    v_cvt_pk_bf16_f32 v40, v40, v41
    v_cvt_pk_bf16_f32 v41, v42, v43
    v_mfma_f32_16x16x32_bf16 v[68:71], a[28:31], v[88:91], v[68:71]
    s_waitcnt lgkmcnt(0)
    v_cvt_pk_bf16_f32 v42, v44, v45
    v_cvt_pk_bf16_f32 v43, v46, v47
    v_mfma_f32_16x16x32_bf16 v[48:51], a[32:35], v[80:83], v[48:51]
    ds_read_b128 v[88:91], v4 offset:6144
    v_mfma_f32_16x16x32_bf16 v[56:59], a[32:35], v[84:87], v[56:59]
    buffer_store_dwordx4 v[40:43], v1, s[16:19], s49 offen offset:3072 sc1
    v_mfma_f32_16x16x32_bf16 v[60:63], a[36:39], v[84:87], v[60:63]
    s_add_u32 s90, s90, 262144
    ds_read_b128 v[92:95], v5 offset:6144
    v_mfma_f32_16x16x32_bf16 v[52:55], a[36:39], v[80:83], v[52:55]
    v_mfma_f32_16x16x32_bf16 v[64:67], a[40:43], v[80:83], v[64:67]
    v_mfma_f32_16x16x32_bf16 v[72:75], a[40:43], v[84:87], v[72:75]
    v_mfma_f32_16x16x32_bf16 v[76:79], a[44:47], v[84:87], v[76:79]
    v_mfma_f32_16x16x32_bf16 v[68:71], a[44:47], v[80:83], v[68:71]
    s_waitcnt lgkmcnt(0)
    v_mfma_f32_16x16x32_bf16 v[48:51], a[48:51], v[88:91], v[48:51]
    s_add_u32 s98, s98, 262144
    ds_read_b128 v[80:83], v4 offset:8192
    s_min_i32 s98, s98, s96
    v_mfma_f32_16x16x32_bf16 v[56:59], a[48:51], v[92:95], v[56:59]
    s_and_b32 s41, s98, 0xffffffff
    s_add_u32 m0, s43, 0
    s_add_u32 s42, s41, 0
    v_mfma_f32_16x16x32_bf16 v[60:63], a[52:55], v[92:95], v[60:63]
    ds_read_b128 v[84:87], v5 offset:8192
    v_mfma_f32_16x16x32_bf16 v[52:55], a[52:55], v[88:91], v[52:55]
    v_mfma_f32_16x16x32_bf16 v[64:67], a[56:59], v[88:91], v[64:67]
    v_mfma_f32_16x16x32_bf16 v[72:75], a[56:59], v[92:95], v[72:75]
    v_mfma_f32_16x16x32_bf16 v[76:79], a[60:63], v[92:95], v[76:79]
    v_mfma_f32_16x16x32_bf16 v[68:71], a[60:63], v[88:91], v[68:71]
    s_waitcnt lgkmcnt(0)
    v_mfma_f32_16x16x32_bf16 v[48:51], a[64:67], v[80:83], v[48:51]
    ds_read_b128 v[88:91], v4 offset:10240
    v_mfma_f32_16x16x32_bf16 v[56:59], a[64:67], v[84:87], v[56:59]
    buffer_load_dword v96, v6, s[16:19], s45 offen sc1
    v_mfma_f32_16x16x32_bf16 v[60:63], a[68:71], v[84:87], v[60:63]
    ds_read_b128 v[92:95], v5 offset:10240
    v_mfma_f32_16x16x32_bf16 v[52:55], a[68:71], v[80:83], v[52:55]
    v_mfma_f32_16x16x32_bf16 v[64:67], a[72:75], v[80:83], v[64:67]
    v_mfma_f32_16x16x32_bf16 v[72:75], a[72:75], v[84:87], v[72:75]
    v_mfma_f32_16x16x32_bf16 v[76:79], a[76:79], v[84:87], v[76:79]
    v_mfma_f32_16x16x32_bf16 v[68:71], a[76:79], v[80:83], v[68:71]
    s_waitcnt lgkmcnt(0)
    v_mfma_f32_16x16x32_bf16 v[48:51], a[80:83], v[88:91], v[48:51]
    ds_read_b128 v[80:83], v4 offset:12288
    v_mfma_f32_16x16x32_bf16 v[56:59], a[80:83], v[92:95], v[56:59]
    v_mfma_f32_16x16x32_bf16 v[60:63], a[84:87], v[92:95], v[60:63]
    ds_read_b128 v[84:87], v5 offset:12288
    v_mfma_f32_16x16x32_bf16 v[52:55], a[84:87], v[88:91], v[52:55]
    v_mfma_f32_16x16x32_bf16 v[64:67], a[88:91], v[88:91], v[64:67]
    v_mfma_f32_16x16x32_bf16 v[72:75], a[88:91], v[92:95], v[72:75]
    v_mfma_f32_16x16x32_bf16 v[76:79], a[92:95], v[92:95], v[76:79]
    v_mfma_f32_16x16x32_bf16 v[68:71], a[92:95], v[88:91], v[68:71]
    s_waitcnt lgkmcnt(0)
    v_mfma_f32_16x16x32_bf16 v[48:51], a[96:99], v[80:83], v[48:51]
    ds_read_b128 v[88:91], v4 offset:14336
    v_mfma_f32_16x16x32_bf16 v[56:59], a[96:99], v[84:87], v[56:59]
    v_mfma_f32_16x16x32_bf16 v[60:63], a[100:103], v[84:87], v[60:63]
    ds_read_b128 v[92:95], v5 offset:14336
    v_mfma_f32_16x16x32_bf16 v[52:55], a[100:103], v[80:83], v[52:55]
    v_mfma_f32_16x16x32_bf16 v[64:67], a[104:107], v[80:83], v[64:67]
    v_mfma_f32_16x16x32_bf16 v[72:75], a[104:107], v[84:87], v[72:75]
    v_mfma_f32_16x16x32_bf16 v[76:79], a[108:111], v[84:87], v[76:79]
    v_mfma_f32_16x16x32_bf16 v[68:71], a[108:111], v[80:83], v[68:71]
    s_waitcnt lgkmcnt(0)
    v_mfma_f32_16x16x32_bf16 v[48:51], a[112:115], v[88:91], v[48:51]
    ds_read_b128 v[80:83], v4 offset:16384
    v_mfma_f32_16x16x32_bf16 v[56:59], a[112:115], v[92:95], v[56:59]
    v_mfma_f32_16x16x32_bf16 v[60:63], a[116:119], v[92:95], v[60:63]
    ds_read_b128 v[84:87], v5 offset:16384
    v_mfma_f32_16x16x32_bf16 v[52:55], a[116:119], v[88:91], v[52:55]
    v_mfma_f32_16x16x32_bf16 v[64:67], a[120:123], v[88:91], v[64:67]
    v_mfma_f32_16x16x32_bf16 v[72:75], a[120:123], v[92:95], v[72:75]
    v_mfma_f32_16x16x32_bf16 v[76:79], a[124:127], v[92:95], v[76:79]
    v_mfma_f32_16x16x32_bf16 v[68:71], a[124:127], v[88:91], v[68:71]
    s_waitcnt lgkmcnt(0)
    v_mfma_f32_16x16x32_bf16 v[48:51], a[128:131], v[80:83], v[48:51]
    ds_read_b128 v[88:91], v4 offset:18432
    v_mfma_f32_16x16x32_bf16 v[56:59], a[128:131], v[84:87], v[56:59]
    v_mfma_f32_16x16x32_bf16 v[60:63], a[132:135], v[84:87], v[60:63]
    ds_read_b128 v[92:95], v5 offset:18432
    v_mfma_f32_16x16x32_bf16 v[52:55], a[132:135], v[80:83], v[52:55]
    v_mfma_f32_16x16x32_bf16 v[64:67], a[136:139], v[80:83], v[64:67]
    v_mfma_f32_16x16x32_bf16 v[72:75], a[136:139], v[84:87], v[72:75]
    v_mfma_f32_16x16x32_bf16 v[76:79], a[140:143], v[84:87], v[76:79]
    v_mfma_f32_16x16x32_bf16 v[68:71], a[140:143], v[80:83], v[68:71]
    s_waitcnt lgkmcnt(0)
    v_mfma_f32_16x16x32_bf16 v[48:51], a[144:147], v[88:91], v[48:51]
    ds_read_b128 v[80:83], v4 offset:20480
    v_mfma_f32_16x16x32_bf16 v[56:59], a[144:147], v[92:95], v[56:59]
    v_mfma_f32_16x16x32_bf16 v[60:63], a[148:151], v[92:95], v[60:63]
    ds_read_b128 v[84:87], v5 offset:20480
    v_mfma_f32_16x16x32_bf16 v[52:55], a[148:151], v[88:91], v[52:55]
    v_mfma_f32_16x16x32_bf16 v[64:67], a[152:155], v[88:91], v[64:67]
    s_waitcnt vmcnt(0)
    v_cmp_ne_u32 vcc, 0, v96
    v_mfma_f32_16x16x32_bf16 v[72:75], a[152:155], v[92:95], v[72:75]
    v_mfma_f32_16x16x32_bf16 v[76:79], a[156:159], v[92:95], v[76:79]
    s_cbranch_vccnz L_spin82
L_back83:
    s_barrier
    v_mfma_f32_16x16x32_bf16 v[68:71], a[156:159], v[88:91], v[68:71]
    s_waitcnt lgkmcnt(0)
    v_mfma_f32_16x16x32_bf16 v[48:51], a[160:163], v[80:83], v[48:51]
    ds_read_b128 v[88:91], v4 offset:22528
    v_mfma_f32_16x16x32_bf16 v[56:59], a[160:163], v[84:87], v[56:59]
    buffer_load_dwordx4 v1, s[16:19], s42 offen offset:0 sc1 lds
    v_mfma_f32_16x16x32_bf16 v[60:63], a[164:167], v[84:87], v[60:63]
    ds_read_b128 v[92:95], v5 offset:22528
    v_mfma_f32_16x16x32_bf16 v[52:55], a[164:167], v[80:83], v[52:55]
    v_mfma_f32_16x16x32_bf16 v[64:67], a[168:171], v[80:83], v[64:67]
    v_mfma_f32_16x16x32_bf16 v[72:75], a[168:171], v[84:87], v[72:75]
    buffer_load_dwordx4 v1, s[16:19], s42 offen offset:1024 sc1 lds
    v_mfma_f32_16x16x32_bf16 v[76:79], a[172:175], v[84:87], v[76:79]
    v_mfma_f32_16x16x32_bf16 v[68:71], a[172:175], v[80:83], v[68:71]
    s_waitcnt lgkmcnt(0)
    v_mfma_f32_16x16x32_bf16 v[48:51], a[176:179], v[88:91], v[48:51]
    ds_read_b128 v[80:83], v4 offset:24576
    v_mfma_f32_16x16x32_bf16 v[56:59], a[176:179], v[92:95], v[56:59]
    buffer_load_dwordx4 v1, s[16:19], s42 offen offset:2048 sc1 lds
    v_mfma_f32_16x16x32_bf16 v[60:63], a[180:183], v[92:95], v[60:63]
    ds_read_b128 v[84:87], v5 offset:24576
    v_mfma_f32_16x16x32_bf16 v[52:55], a[180:183], v[88:91], v[52:55]
    v_mfma_f32_16x16x32_bf16 v[64:67], a[184:187], v[88:91], v[64:67]
    v_mfma_f32_16x16x32_bf16 v[72:75], a[184:187], v[92:95], v[72:75]
    buffer_load_dwordx4 v1, s[16:19], s42 offen offset:3072 sc1 lds
    v_mfma_f32_16x16x32_bf16 v[76:79], a[188:191], v[92:95], v[76:79]
    s_add_u32 m0, s88, 16384
    s_add_u32 s42, s41, 16384
    s_add_u32 s42, s42, s89
    v_mfma_f32_16x16x32_bf16 v[68:71], a[188:191], v[88:91], v[68:71]
    s_waitcnt lgkmcnt(0)
    v_mfma_f32_16x16x32_bf16 v[48:51], a[192:195], v[80:83], v[48:51]
    ds_read_b128 v[88:91], v4 offset:26624
    v_mfma_f32_16x16x32_bf16 v[56:59], a[192:195], v[84:87], v[56:59]
    buffer_load_dwordx4 v1, s[16:19], s42 offen offset:0 sc1 lds
    v_mfma_f32_16x16x32_bf16 v[60:63], a[196:199], v[84:87], v[60:63]
    ds_read_b128 v[92:95], v5 offset:26624
    v_mfma_f32_16x16x32_bf16 v[52:55], a[196:199], v[80:83], v[52:55]
    v_mfma_f32_16x16x32_bf16 v[64:67], a[200:203], v[80:83], v[64:67]
    v_mfma_f32_16x16x32_bf16 v[72:75], a[200:203], v[84:87], v[72:75]
    buffer_load_dwordx4 v1, s[16:19], s42 offen offset:1024 sc1 lds
    v_mfma_f32_16x16x32_bf16 v[76:79], a[204:207], v[84:87], v[76:79]
    v_mfma_f32_16x16x32_bf16 v[68:71], a[204:207], v[80:83], v[68:71]
    s_waitcnt lgkmcnt(0)
    v_mfma_f32_16x16x32_bf16 v[48:51], a[208:211], v[88:91], v[48:51]
    ds_read_b128 v[80:83], v4 offset:28672
    v_mfma_f32_16x16x32_bf16 v[56:59], a[208:211], v[92:95], v[56:59]
    buffer_store_dword v124, v124, s[16:19], s91 offen sc1
    v_mfma_f32_16x16x32_bf16 v[60:63], a[212:215], v[92:95], v[60:63]
    s_add_u32 s91, s91, 65536
    ds_read_b128 v[84:87], v5 offset:28672
    v_mfma_f32_16x16x32_bf16 v[52:55], a[212:215], v[88:91], v[52:55]
    v_mfma_f32_16x16x32_bf16 v[64:67], a[216:219], v[88:91], v[64:67]
    v_mfma_f32_16x16x32_bf16 v[72:75], a[216:219], v[92:95], v[72:75]
    v_mfma_f32_16x16x32_bf16 v[76:79], a[220:223], v[92:95], v[76:79]
    v_mfma_f32_16x16x32_bf16 v[68:71], a[220:223], v[88:91], v[68:71]
    s_waitcnt lgkmcnt(0)
    v_mfma_f32_16x16x32_bf16 v[48:51], a[224:227], v[80:83], v[48:51]
    ds_read_b128 v[88:91], v4 offset:30720
    v_mfma_f32_16x16x32_bf16 v[56:59], a[224:227], v[84:87], v[56:59]
    v_mfma_f32_16x16x32_bf16 v[60:63], a[228:231], v[84:87], v[60:63]
    ds_read_b128 v[92:95], v5 offset:30720
    v_mfma_f32_16x16x32_bf16 v[52:55], a[228:231], v[80:83], v[52:55]
    v_mfma_f32_16x16x32_bf16 v[64:67], a[232:235], v[80:83], v[64:67]
    v_mfma_f32_16x16x32_bf16 v[72:75], a[232:235], v[84:87], v[72:75]
    v_mfma_f32_16x16x32_bf16 v[76:79], a[236:239], v[84:87], v[76:79]
    v_mfma_f32_16x16x32_bf16 v[68:71], a[236:239], v[80:83], v[68:71]
    s_waitcnt lgkmcnt(0)
    v_mfma_f32_16x16x32_bf16 v[48:51], a[240:243], v[88:91], v[48:51]
    ds_read_b128 v[80:83], v4 offset:32768
    v_mfma_f32_16x16x32_bf16 v[56:59], a[240:243], v[92:95], v[56:59]
    v_mfma_f32_16x16x32_bf16 v[60:63], a[244:247], v[92:95], v[60:63]
    ds_read_b128 v[84:87], v5 offset:32768
    v_mfma_f32_16x16x32_bf16 v[52:55], a[244:247], v[88:91], v[52:55]
    v_mfma_f32_16x16x32_bf16 v[64:67], a[248:251], v[88:91], v[64:67]
    v_mfma_f32_16x16x32_bf16 v[72:75], a[248:251], v[92:95], v[72:75]
    v_mfma_f32_16x16x32_bf16 v[76:79], a[252:255], v[92:95], v[76:79]
    v_mfma_f32_16x16x32_bf16 v[68:71], a[252:255], v[88:91], v[68:71]
    s_waitcnt lgkmcnt(0)
    v_mfma_f32_16x16x32_bf16 v[48:51], v[128:131], v[80:83], v[48:51]
    s_add_u32 m0, s43, 24576
    ds_read_b128 v[88:91], v4 offset:34816
    s_add_u32 s42, s41, 24576
    v_mfma_f32_16x16x32_bf16 v[56:59], v[128:131], v[84:87], v[56:59]
    buffer_load_dwordx4 v1, s[16:19], s42 offen offset:0 sc1 lds
    v_mfma_f32_16x16x32_bf16 v[60:63], v[132:135], v[84:87], v[60:63]
    ds_read_b128 v[92:95], v5 offset:34816
    v_mfma_f32_16x16x32_bf16 v[52:55], v[132:135], v[80:83], v[52:55]
    v_mfma_f32_16x16x32_bf16 v[64:67], v[136:139], v[80:83], v[64:67]
    v_mfma_f32_16x16x32_bf16 v[72:75], v[136:139], v[84:87], v[72:75]
    v_mfma_f32_16x16x32_bf16 v[76:79], v[140:143], v[84:87], v[76:79]
    buffer_load_dwordx4 v1, s[16:19], s42 offen offset:1024 sc1 lds
    v_mfma_f32_16x16x32_bf16 v[68:71], v[140:143], v[80:83], v[68:71]
    s_waitcnt lgkmcnt(0)
    v_mfma_f32_16x16x32_bf16 v[48:51], v[144:147], v[88:91], v[48:51]
    ds_read_b128 v[80:83], v4 offset:36864
    v_mfma_f32_16x16x32_bf16 v[56:59], v[144:147], v[92:95], v[56:59]
    v_mfma_f32_16x16x32_bf16 v[60:63], v[148:151], v[92:95], v[60:63]
    ds_read_b128 v[84:87], v5 offset:36864
    v_mfma_f32_16x16x32_bf16 v[52:55], v[148:151], v[88:91], v[52:55]
    buffer_load_dwordx4 v1, s[16:19], s42 offen offset:2048 sc1 lds
    v_mfma_f32_16x16x32_bf16 v[64:67], v[152:155], v[88:91], v[64:67]
    v_mfma_f32_16x16x32_bf16 v[72:75], v[152:155], v[92:95], v[72:75]
    v_mfma_f32_16x16x32_bf16 v[76:79], v[156:159], v[92:95], v[76:79]
    v_mfma_f32_16x16x32_bf16 v[68:71], v[156:159], v[88:91], v[68:71]
    s_waitcnt lgkmcnt(0)
    v_mfma_f32_16x16x32_bf16 v[48:51], v[160:163], v[80:83], v[48:51]
    ds_read_b128 v[88:91], v4 offset:38912
    v_mfma_f32_16x16x32_bf16 v[56:59], v[160:163], v[84:87], v[56:59]
    buffer_load_dwordx4 v1, s[16:19], s42 offen offset:3072 sc1 lds
    v_mfma_f32_16x16x32_bf16 v[60:63], v[164:167], v[84:87], v[60:63]
    s_add_u32 s45, s45, 65536
    ds_read_b128 v[92:95], v5 offset:38912
    v_mfma_f32_16x16x32_bf16 v[52:55], v[164:167], v[80:83], v[52:55]
    v_mfma_f32_16x16x32_bf16 v[64:67], v[168:171], v[80:83], v[64:67]
    v_mfma_f32_16x16x32_bf16 v[72:75], v[168:171], v[84:87], v[72:75]
    v_mfma_f32_16x16x32_bf16 v[76:79], v[172:175], v[84:87], v[76:79]
    v_mfma_f32_16x16x32_bf16 v[68:71], v[172:175], v[80:83], v[68:71]
    s_waitcnt vmcnt(5) lgkmcnt(0)
    s_barrier
    v_mfma_f32_16x16x32_bf16 v[48:51], v[176:179], v[88:91], v[48:51]
    ds_read_b128 v[80:83], v2 offset:0
    v_mfma_f32_16x16x32_bf16 v[56:59], v[176:179], v[92:95], v[56:59]
    v_mfma_f32_16x16x32_bf16 v[60:63], v[180:183], v[92:95], v[60:63]
    ds_read_b128 v[84:87], v3 offset:0
    v_mfma_f32_16x16x32_bf16 v[52:55], v[180:183], v[88:91], v[52:55]
    v_mfma_f32_16x16x32_bf16 v[64:67], v[184:187], v[88:91], v[64:67]
    v_mfma_f32_16x16x32_bf16 v[72:75], v[184:187], v[92:95], v[72:75]
    v_mfma_f32_16x16x32_bf16 v[76:79], v[188:191], v[92:95], v[76:79]
    s_add_u32 s36, s36, 1
    v_mfma_f32_16x16x32_bf16 v[68:71], v[188:191], v[88:91], v[68:71]
    s_waitcnt lgkmcnt(0)
    s_cmp_lt_u32 s36, 32
    s_cbranch_scc1 L_bs_b0
    s_nop 7
    s_and_b32 s44, s90, 0xffffffff
    s_cmp_lt_i32 s36, 1
    s_cselect_b32 s44, 0x5e00000, s44
    s_xor_b32 s49, s44, 0
    v_cvt_pk_bf16_f32 v48, v48, v49
    v_cvt_pk_bf16_f32 v49, v50, v51
    v_cvt_pk_bf16_f32 v50, v52, v53
    v_cvt_pk_bf16_f32 v51, v54, v55
    v_min_u32 v48, -2, v48
    v_min_u32 v49, -2, v49
    v_min_u32 v50, -2, v50
    v_min_u32 v51, -2, v51
    buffer_store_dwordx4 v[48:51], v1, s[16:19], s49 offen offset:3072 sc1
    s_xor_b32 s49, s44, 16384
    v_cvt_pk_bf16_f32 v56, v56, v57
    v_cvt_pk_bf16_f32 v57, v58, v59
    v_cvt_pk_bf16_f32 v58, v60, v61
    v_cvt_pk_bf16_f32 v59, v62, v63
    v_min_u32 v56, -2, v56
    v_min_u32 v57, -2, v57
    v_min_u32 v58, -2, v58
    v_min_u32 v59, -2, v59
    buffer_store_dwordx4 v[56:59], v1, s[16:19], s49 offen offset:3072 sc1
    s_xor_b32 s49, s44, 32768
    v_cvt_pk_bf16_f32 v64, v64, v65
    v_cvt_pk_bf16_f32 v65, v66, v67
    v_cvt_pk_bf16_f32 v66, v68, v69
    v_cvt_pk_bf16_f32 v67, v70, v71
    v_min_u32 v64, -2, v64
    v_min_u32 v65, -2, v65
    v_min_u32 v66, -2, v66
    v_min_u32 v67, -2, v67
    buffer_store_dwordx4 v[64:67], v1, s[16:19], s49 offen offset:3072 sc1
    s_xor_b32 s49, s44, 49152
    v_cvt_pk_bf16_f32 v72, v72, v73
    v_cvt_pk_bf16_f32 v73, v74, v75
    v_cvt_pk_bf16_f32 v74, v76, v77
    v_cvt_pk_bf16_f32 v75, v78, v79
    v_min_u32 v72, -2, v72
    v_min_u32 v73, -2, v73
    v_min_u32 v74, -2, v74
    v_min_u32 v75, -2, v75
    buffer_store_dwordx4 v[72:75], v1, s[16:19], s49 offen offset:3072 sc1
    s_add_u32 s90, s90, 262144
    s_waitcnt vmcnt(0)
    s_endpgm
L_spin76:
    s_mov_b32 s40, 0x20000
L_spin76_l:
    buffer_load_dword v80, v124, s[20:23], 0 offen sc1
    s_sub_u32 s40, s40, 1
    s_waitcnt vmcnt(0)
    v_cmp_eq_u32 vcc, v124, v80
    s_cbranch_scc1 L_back77
    s_cbranch_vccz L_back77
    s_sleep 8
    s_branch L_spin76_l
L_spin78:
    s_mov_b32 s40, 0x20000
L_spin78_l:
    buffer_load_dword v96, v6, s[16:19], s45 offen sc1
    s_sub_u32 s40, s40, 1
    s_waitcnt vmcnt(0)
    v_cmp_ne_u32 vcc, 0, v96
    s_cbranch_scc1 L_back79
    s_cbranch_vccz L_back79
    s_sleep 2
    s_branch L_spin78_l
L_spin80:
    s_mov_b32 s40, 0x20000
L_spin80_l:
    buffer_load_dword v96, v6, s[16:19], s45 offen sc1
    s_sub_u32 s40, s40, 1
    s_waitcnt vmcnt(0)
    v_cmp_ne_u32 vcc, 0, v96
    s_cbranch_scc1 L_back81
    s_cbranch_vccz L_back81
    s_sleep 2
    s_branch L_spin80_l
L_spin82:
    s_mov_b32 s40, 0x20000
L_spin82_l:
    buffer_load_dword v96, v6, s[16:19], s45 offen sc1
    s_sub_u32 s40, s40, 1
    s_waitcnt vmcnt(0)
    v_cmp_ne_u32 vcc, 0, v96
    s_cbranch_scc1 L_back83
    s_cbranch_vccz L_back83
    s_sleep 2
    s_branch L_spin82_l
L_restart:
    s_waitcnt vmcnt(0) lgkmcnt(0)
    s_barrier
    s_xor_b32 s2, s2, 1
    s_xor_b32 s3, s3, 3
    s_branch L_dispatch
L_code_end:
    s_endpgm
.section .rodata,"a"
.p2align 6
.amdhsa_kernel interleave_layers__sliding_local_dilated__dense_activation_squared_relu__prompt_kernel
  .amdhsa_next_free_vgpr 512
  .amdhsa_next_free_sgpr 102
  .amdhsa_accum_offset 256
  .amdhsa_group_segment_fixed_size 0
  .amdhsa_kernarg_size 88
  .amdhsa_user_sgpr_count 2
  .amdhsa_user_sgpr_kernarg_segment_ptr 1
  .amdhsa_system_sgpr_workgroup_id_x 1
.end_amdhsa_kernel
```

```asm
; @launch grid=(256,1,1) block=(256,1,1) lds=163840
.amdgcn_target "amdgcn-amd-amdhsa--gfx950"
.text
.globl interleave_layers__sliding_local_dilated__dense_activation_squared_relu__prompt_kernel
.p2align 8
.type interleave_layers__sliding_local_dilated__dense_activation_squared_relu__prompt_kernel,@function
interleave_layers__sliding_local_dilated__dense_activation_squared_relu__prompt_kernel:
    s_load_dwordx16 s[64:79], s[0:1], 0x0
    s_load_dwordx4 s[80:83], s[0:1], 0x40
    s_load_dwordx2 s[84:85], s[0:1], 0x50
    v_lshrrev_b32 v1, 6, v0
    s_cmp_ge_u32 s2, 256
    s_cbranch_scc1 L_code_end
    s_getpc_b64 s[20:21]
L_pc:
    s_mov_b32 s22, L_code_end-L_pc
    s_mov_b32 s23, 0x00020000
    v_lshlrev_b32 v7, 12, v0
    s_lshl_b32 s37, s2, 4
    buffer_load_dword v252, v7, s[20:23], s37 offen
    v_readfirstlane_b32 s32, v1
    v_and_b32 v0, 63, v0
    v_lshlrev_b32 v1, 4, v0
    s_getreg_b32 s3, hwreg(HW_REG_XCC_ID)
    s_xor_b32 s3, s3, s2
    s_and_b32 s3, s3, 1
    s_lshl2_add_u32 s37, s2, s32
    s_xor_b32 s2, s2, s3
    s_add_u32 s3, s3, 1
    s_cmp_eq_u32 s37, 514
    s_cbranch_scc0 L_dispatch
    s_waitcnt lgkmcnt(0)
    s_add_u32 s20, s82, 0xa0
    s_addc_u32 s21, s83, 0
    s_mov_b32 s22, 0x4
    s_mov_b32 s23, 0x00020000
    v_mov_b32 v2, s3
    buffer_store_dword v2, v1, s[20:23], 0 offen sc1
L_dispatch:
    s_bfe_u32 s47, s2, 0x20001
    s_and_b32 s37, s2, 0x81
    s_cmp_lg_u32 s37, 0
    s_cbranch_scc1 L_other
    s_bfe_u32 s33, s2, 0x20003
    s_lshr_b32 s34, s2, 5
    s_lshl2_add_u32 s34, s47, s34
    s_mov_b32 s35, s34
    s_movk_i32 s39, 6144
    s_lshl_b32 s54, s35, 7
    v_lshrrev_b32 v32, 3, v0
    v_lshlrev_b32 v33, 2, v0
    v_and_b32 v33, 64, v33
    v_and_b32 v34, 0x70, v1
    v_xor_b32 v33, v33, v34
    v_mad_u32_u24 v20, v32, s39, v33
    v_add_u32 v21, 49152, v20
    v_add_u32 v22, 2048, v20
    v_add_u32 v23, 51200, v20
    v_add_u32 v24, 4096, v20
    v_add_u32 v25, 53248, v20
    s_mul_i32 s38, s32, 98304
    s_add_u32 s54, s54, s38
    s_lshl_b32 s42, s32, 11
    s_lshr_b32 s51, s32, 1
    s_lshl_b32 s50, s33, 5
    s_add_u32 s53, s50, 31
    s_lshl_b32 s53, s53, 8
    s_add_u32 s53, s53, s51
    s_lshl_b32 s53, s53, 7
    s_add_u32 s50, s50, 30
    s_sub_u32 s50, s50, s51
    s_lshl_b32 s41, s50, 15
    s_lshl_b32 s43, s32, 10
    v_lshlrev_b32 v37, 1, v0
    v_and_b32 v37, 0x60, v37
    v_xor_b32 v37, v37, v34
    s_and_b32 s37, s32, 1
    s_lshl_b32 s37, s37, 14
    v_lshl_add_u32 v6, v32, 11, v37
    v_add_u32 v6, s37, v6
    s_waitcnt lgkmcnt(0)
    s_mov_b32 s12, s66
    s_mov_b32 s13, s67
    s_mov_b32 s14, 0x600000
    s_mov_b32 s15, 0x00020000
    s_mov_b32 s8, s64
    s_mov_b32 s9, s65
    s_mov_b32 s10, 0x400000
    s_mov_b32 s11, 0x00020000
    s_add_u32 m0, s43, 131072
    s_nop 0
    buffer_load_dwordx4 v6, s[8:11], s53 offen offset:0 sc1 lds
    s_add_u32 m0, s43, 98304
    s_nop 0
    buffer_load_dwordx4 v6, s[8:11], s41 offen offset:0 sc1 lds
    s_add_u32 m0, s42, 73728
    s_nop 0
    buffer_load_dwordx4 v20, s[12:15], s54 offen lds
    s_add_u32 m0, s42, 74752
    s_nop 0
    buffer_load_dwordx4 v21, s[12:15], s54 offen lds
    s_add_u32 m0, s42, 81920
    s_nop 0
    buffer_load_dwordx4 v22, s[12:15], s54 offen lds
    s_add_u32 m0, s42, 82944
    s_nop 0
    buffer_load_dwordx4 v23, s[12:15], s54 offen lds
    s_add_u32 m0, s42, 90112
    s_nop 0
    buffer_load_dwordx4 v24, s[12:15], s54 offen lds
    s_add_u32 m0, s42, 91136
    s_nop 0
    buffer_load_dwordx4 v25, s[12:15], s54 offen lds
    s_add_u32 s54, s54, 393216
    v_lshrrev_b32 v32, 4, v0
    v_bfe_u32 v33, v0, 2, 2
    v_lshl_add_u32 v32, v32, 3, v33
    v_lshlrev_b32 v32, 7, v32
    v_lshrrev_b32 v33, 1, v33
    v_lshl_add_u32 v32, v33, 6, v32
    v_and_b32 v33, 3, v0
    v_lshl_add_u32 v32, v33, 4, v32
    s_lshl_b32 s37, s51, 6
    s_and_b32 s38, s32, 1
    s_lshl_b32 s38, s38, 3
    s_add_u32 s37, s37, s38
    s_add_u32 s37, s37, 0
    v_xor_b32 v26, s37, v32
    s_lshl_b32 s37, s51, 6
    s_and_b32 s38, s32, 1
    s_lshl_b32 s38, s38, 3
    s_add_u32 s37, s37, s38
    s_add_u32 s37, s37, 8192
    v_xor_b32 v27, s37, v32
    s_lshl_b32 s37, s51, 6
    s_and_b32 s38, s32, 1
    s_lshl_b32 s38, s38, 3
    s_add_u32 s37, s37, s38
    s_add_u32 s37, s37, 16384
    v_xor_b32 v28, s37, v32
    v_mov_b32 v32, 0x3f803f80
    v_mov_b32 v33, 0x3f803f80
    v_mov_b32 v34, 0x3f803f80
    v_mov_b32 v35, 0x3f803f80
    v_and_b32 v36, 15, v0
    v_lshrrev_b32 v37, 4, v0
    v_and_b32 v38, 6, v36
    v_xor_b32 v38, v37, v38
    v_lshlrev_b32 v38, 4, v38
    v_lshl_add_u32 v2, v36, 7, v38
    v_xor_b32 v3, 64, v2
    v_add_u32 v4, 98304, v2
    v_add_u32 v5, 98304, v3
    s_add_u32 m0, s43, 102272
    s_nop 0
    buffer_load_dwordx4 v6, s[8:11], s41 offen offset:128 sc1 lds
    s_add_u32 m0, s42, 0
    s_nop 0
    buffer_load_dwordx4 v20, s[12:15], s54 offen lds
    s_add_u32 m0, s42, 1024
    s_nop 0
    buffer_load_dwordx4 v21, s[12:15], s54 offen lds
    s_add_u32 m0, s42, 8192
    s_nop 0
    buffer_load_dwordx4 v22, s[12:15], s54 offen lds
    s_add_u32 m0, s42, 9216
    s_nop 0
    buffer_load_dwordx4 v23, s[12:15], s54 offen lds
    s_add_u32 m0, s42, 16384
    s_nop 0
    buffer_load_dwordx4 v24, s[12:15], s54 offen lds
    s_add_u32 m0, s42, 17408
    s_nop 0
    buffer_load_dwordx4 v25, s[12:15], s54 offen lds
    s_add_u32 s54, s54, 393216
    s_add_u32 m0, s43, 134912
    s_nop 0
    buffer_load_dwordx4 v6, s[8:11], s53 offen offset:256 sc1 lds
    s_add_u32 m0, s43, 106240
    s_nop 0
    buffer_load_dwordx4 v6, s[8:11], s41 offen offset:256 sc1 lds
    s_add_u32 m0, s42, 24576
    s_nop 0
    buffer_load_dwordx4 v20, s[12:15], s54 offen lds
    s_add_u32 m0, s42, 25600
    s_nop 0
    buffer_load_dwordx4 v21, s[12:15], s54 offen lds
    s_add_u32 m0, s42, 32768
    s_nop 0
    buffer_load_dwordx4 v22, s[12:15], s54 offen lds
    s_add_u32 m0, s42, 33792
    s_nop 0
    buffer_load_dwordx4 v23, s[12:15], s54 offen lds
    s_add_u32 m0, s42, 40960
    s_nop 0
    buffer_load_dwordx4 v24, s[12:15], s54 offen lds
    s_add_u32 m0, s42, 41984
    s_nop 0
    buffer_load_dwordx4 v25, s[12:15], s54 offen lds
    s_add_u32 s54, s54, 393216
    s_mov_b32 s36, -1
    v_add_u32 v29, 73728, v26
    v_add_u32 v30, 73728, v27
    v_add_u32 v31, 73728, v28
    s_waitcnt vmcnt(15) lgkmcnt(0)
    s_barrier
    ds_read_b128 v[68:71], v4 offset:0
    s_add_u32 m0, s43, 110208
    ds_read_b128 v[72:75], v4 offset:2048
    buffer_load_dwordx4 v6, s[8:11], s41 offen offset:384 sc1 lds
    ds_read_b128 v[76:79], v4 offset:32768
    s_add_u32 m0, s42, 49152
    ds_read_b64_tr_b16 a[0:1], v29 offset:0
    buffer_load_dwordx4 v20, s[12:15], s54 offen lds
    ds_read_b64_tr_b16 a[2:3], v29 offset:512
    s_add_u32 m0, s42, 50176
    ds_read_b64_tr_b16 a[4:5], v30 offset:0
    buffer_load_dwordx4 v21, s[12:15], s54 offen lds
    ds_read_b64_tr_b16 a[6:7], v30 offset:512
    s_add_u32 m0, s42, 57344
    ds_read_b64_tr_b16 a[8:9], v31 offset:0
    buffer_load_dwordx4 v22, s[12:15], s54 offen lds
    ds_read_b64_tr_b16 a[10:11], v31 offset:512
    s_waitcnt lgkmcnt(4)
    v_mfma_f32_16x16x32_bf16 v[44:47], a[0:3], v[68:71], 0
    s_add_u32 m0, s42, 58368
    ds_read_b128 v[80:83], v5 offset:0
    v_mfma_f32_16x16x32_bf16 v[48:51], a[0:3], v[72:75], 0
    ds_read_b128 v[84:87], v5 offset:2048
    v_mfma_f32_16x16x32_bf16 v[92:95], a[0:3], v[76:79], 0
    ds_read_b128 v[88:91], v5 offset:32768
    s_waitcnt lgkmcnt(5)
    v_mfma_f32_16x16x32_bf16 v[52:55], a[4:7], v[68:71], 0
    ds_read_b64_tr_b16 a[12:13], v29 offset:4096
    v_mfma_f32_16x16x32_bf16 v[56:59], a[4:7], v[72:75], 0
    ds_read_b64_tr_b16 a[14:15], v29 offset:4608
    v_mfma_f32_16x16x32_bf16 v[96:99], a[4:7], v[76:79], 0
    ds_read_b64_tr_b16 a[16:17], v30 offset:4096
    s_waitcnt lgkmcnt(6)
    v_mfma_f32_16x16x32_bf16 v[60:63], a[8:11], v[68:71], 0
    ds_read_b64_tr_b16 a[18:19], v30 offset:4608
    v_mfma_f32_16x16x32_bf16 v[64:67], a[8:11], v[72:75], 0
    ds_read_b64_tr_b16 a[20:21], v31 offset:4096
    v_mfma_f32_16x16x32_bf16 v[118:121], a[8:11], v[76:79], 0
    ds_read_b64_tr_b16 a[22:23], v31 offset:4608
    v_mfma_f32_16x16x32_bf16 v[100:103], a[0:3], v[32:35], 0
    buffer_load_dwordx4 v23, s[12:15], s54 offen lds
    v_mfma_f32_16x16x32_bf16 v[104:107], a[4:7], v[32:35], 0
    s_add_u32 m0, s42, 65536
    s_nop 0
    buffer_load_dwordx4 v24, s[12:15], s54 offen lds
    v_mfma_f32_16x16x32_bf16 v[108:111], a[8:11], v[32:35], 0
    s_add_u32 m0, s42, 66560
    s_nop 0
    buffer_load_dwordx4 v25, s[12:15], s54 offen lds
    s_add_u32 s54, s54, 393216
    s_mov_b32 s16, s84
    s_mov_b32 s17, s85
    s_mov_b32 s18, 0x5e00000
    s_mov_b32 s19, 0x00020000
    v_min_u32 v124, 1, v0
    v_lshlrev_b32 v124, 30, v124
    s_lshl_b32 s91, s33, 6
    s_add_u32 s91, s91, s34
    s_lshl_b32 s91, s91, 7
    s_add_u32 s91, s91, 0x5520000
    s_cmp_eq_u32 s32, 1
    s_cselect_b32 s91, s91, 0x5f00000
    s_add_u32 s88, s84, 0x5000000
    s_addc_u32 s89, s85, 0
    s_sub_u32 s97, 14, s51
    s_and_b32 s38, s32, 1
    v_lshlrev_b32 v40, 1, v0
    v_and_b32 v40, 0x30, v40
    v_xor_b32 v40, v40, v1
    s_mul_i32 s37, s51, 3072
    s_add_u32 s37, s37, 65536
    s_lshl_b32 s39, s38, 3
    s_add_u32 s39, s39, s37
    v_add_u32 v7, s39, v40
    v_bfe_u32 v38, v0, 1, 2
    v_xor_b32 v38, v38, v37
    v_lshlrev_b32 v38, 4, v38
    v_lshl_add_u32 v38, v36, 6, v38
    v_add_u32 v8, s39, v38
    s_waitcnt vmcnt(15) lgkmcnt(0)
    s_barrier
    v_mfma_f32_16x16x32_bf16 v[44:47], a[12:15], v[80:83], v[44:47]
    s_add_u32 m0, s43, 138752
    ds_read_b128 v[68:71], v4 offset:4096
    ds_read_b128 v[72:75], v4 offset:6144
    v_mfma_f32_16x16x32_bf16 v[48:51], a[12:15], v[84:87], v[48:51]
    ds_read_b128 v[76:79], v4 offset:34816
    ds_read_b64_tr_b16 a[24:25], v26 offset:0
    v_mfma_f32_16x16x32_bf16 v[92:95], a[12:15], v[88:91], v[92:95]
    buffer_load_dwordx4 v6, s[8:11], s53 offen offset:512 sc1 lds
    v_mfma_f32_16x16x32_bf16 v[52:55], a[16:19], v[80:83], v[52:55]
    s_add_u32 m0, s43, 114176
    ds_read_b64_tr_b16 a[26:27], v26 offset:512
    v_mfma_f32_16x16x32_bf16 v[56:59], a[16:19], v[84:87], v[56:59]
    buffer_load_dwordx4 v6, s[8:11], s41 offen offset:512 sc1 lds
    v_mfma_f32_16x16x32_bf16 v[96:99], a[16:19], v[88:91], v[96:99]
    s_add_u32 m0, s42, 73728
    ds_read_b64_tr_b16 a[28:29], v27 offset:0
    v_mfma_f32_16x16x32_bf16 v[60:63], a[20:23], v[80:83], v[60:63]
    ds_read_b64_tr_b16 a[30:31], v27 offset:512
    v_mfma_f32_16x16x32_bf16 v[64:67], a[20:23], v[84:87], v[64:67]
    buffer_load_dwordx4 v20, s[12:15], s54 offen lds
    v_mfma_f32_16x16x32_bf16 v[118:121], a[20:23], v[88:91], v[118:121]
    s_add_u32 m0, s42, 74752
    ds_read_b64_tr_b16 a[32:33], v28 offset:0
    v_mfma_f32_16x16x32_bf16 v[100:103], a[12:15], v[32:35], v[100:103]
    buffer_load_dwordx4 v21, s[12:15], s54 offen lds
    v_mfma_f32_16x16x32_bf16 v[104:107], a[16:19], v[32:35], v[104:107]
    s_add_u32 m0, s42, 81920
    ds_read_b64_tr_b16 a[34:35], v28 offset:512
    v_mfma_f32_16x16x32_bf16 v[108:111], a[20:23], v[32:35], v[108:111]
    buffer_load_dwordx4 v22, s[12:15], s54 offen lds
    s_waitcnt lgkmcnt(4)
    v_mfma_f32_16x16x32_bf16 v[44:47], a[24:27], v[68:71], v[44:47]
    s_add_u32 m0, s42, 82944
    ds_read_b128 v[80:83], v5 offset:4096
    v_mfma_f32_16x16x32_bf16 v[48:51], a[24:27], v[72:75], v[48:51]
    ds_read_b128 v[84:87], v5 offset:6144
    v_mfma_f32_16x16x32_bf16 v[92:95], a[24:27], v[76:79], v[92:95]
    ds_read_b128 v[88:91], v5 offset:34816
    s_waitcnt lgkmcnt(5)
    v_mfma_f32_16x16x32_bf16 v[52:55], a[28:31], v[68:71], v[52:55]
    ds_read_b64_tr_b16 a[36:37], v26 offset:4096
    v_mfma_f32_16x16x32_bf16 v[56:59], a[28:31], v[72:75], v[56:59]
    ds_read_b64_tr_b16 a[38:39], v26 offset:4608
    v_mfma_f32_16x16x32_bf16 v[96:99], a[28:31], v[76:79], v[96:99]
    ds_read_b64_tr_b16 a[40:41], v27 offset:4096
    s_waitcnt lgkmcnt(6)
    v_mfma_f32_16x16x32_bf16 v[60:63], a[32:35], v[68:71], v[60:63]
    ds_read_b64_tr_b16 a[42:43], v27 offset:4608
    v_mfma_f32_16x16x32_bf16 v[64:67], a[32:35], v[72:75], v[64:67]
    ds_read_b64_tr_b16 a[44:45], v28 offset:4096
    v_mfma_f32_16x16x32_bf16 v[118:121], a[32:35], v[76:79], v[118:121]
    ds_read_b64_tr_b16 a[46:47], v28 offset:4608
    v_mfma_f32_16x16x32_bf16 v[100:103], a[24:27], v[32:35], v[100:103]
    buffer_load_dwordx4 v23, s[12:15], s54 offen lds
    v_mfma_f32_16x16x32_bf16 v[104:107], a[28:31], v[32:35], v[104:107]
    s_add_u32 m0, s42, 90112
    s_nop 0
    buffer_load_dwordx4 v24, s[12:15], s54 offen lds
    v_mfma_f32_16x16x32_bf16 v[108:111], a[32:35], v[32:35], v[108:111]
    s_add_u32 m0, s42, 91136
    s_nop 0
    buffer_load_dwordx4 v25, s[12:15], s54 offen lds
    s_add_u32 s54, s54, 393216
    s_mul_i32 s39, s38, 6144
    s_add_u32 s39, s39, s37
    v_add_u32 v9, s39, v40
    s_cmp_eq_u32 s38, 0
    s_cselect_b32 s39, 18432, 0
    s_add_u32 s39, s39, s37
    v_add_u32 v10, s39, v40
    s_sub_u32 s39, s33, 1
    s_max_i32 s39, s39, 0
    v_mov_b32 v38, s33
    v_mov_b32 v39, s39
    v_mov_b32 v12, 1048576
    v_mov_b32 v41, 131072
    v_cmp_lt_u32 vcc, 15, v0
    s_nop 1
    v_cndmask_b32 v38, v38, v39, vcc
    v_cndmask_b32 v12, v12, v41, vcc
    v_lshl_add_u32 v38, v38, 6, v36
    v_add_u32 v38, 697644, v38
    v_lshlrev_b32 v11, 7, v38
    s_cmp_eq_u32 s32, 0
    s_cselect_b32 s37, 32, 0
    v_cmp_le_u32 vcc, s37, v0
    s_nop 1
    v_cndmask_b32 v11, v11, 2.0, vcc
    s_mov_b32 s45, -720896
    v_and_b32 v13, 15, v0
    v_lshlrev_b32 v13, 3, v13
    v_lshrrev_b32 v38, 5, v0
    v_lshl_add_u32 v13, v38, 9, v13
    v_and_b32 v38, 16, v0
    s_waitcnt vmcnt(15) lgkmcnt(0)
    s_barrier
    v_mfma_f32_16x16x32_bf16 v[44:47], a[36:39], v[80:83], v[44:47]
    s_add_u32 m0, s43, 118144
    ds_read_b128 v[68:71], v4 offset:8192
    ds_read_b128 v[72:75], v4 offset:10240
    v_mfma_f32_16x16x32_bf16 v[48:51], a[36:39], v[84:87], v[48:51]
    ds_read_b128 v[76:79], v4 offset:36864
    v_mfma_f32_16x16x32_bf16 v[92:95], a[36:39], v[88:91], v[92:95]
    buffer_load_dwordx4 v6, s[8:11], s41 offen offset:640 sc1 lds
    v_mfma_f32_16x16x32_bf16 v[52:55], a[40:43], v[80:83], v[52:55]
    s_add_u32 m0, s42, 0
    ds_read_b64_tr_b16 a[48:49], v26 offset:24576
    v_mfma_f32_16x16x32_bf16 v[56:59], a[40:43], v[84:87], v[56:59]
    buffer_load_dwordx4 v20, s[12:15], s54 offen lds
    v_mfma_f32_16x16x32_bf16 v[96:99], a[40:43], v[88:91], v[96:99]
    s_add_u32 m0, s42, 1024
    ds_read_b64_tr_b16 a[50:51], v26 offset:25088
    v_mfma_f32_16x16x32_bf16 v[60:63], a[44:47], v[80:83], v[60:63]
    ds_read_b64_tr_b16 a[52:53], v27 offset:24576
    v_mfma_f32_16x16x32_bf16 v[64:67], a[44:47], v[84:87], v[64:67]
    buffer_load_dwordx4 v21, s[12:15], s54 offen lds
    v_mfma_f32_16x16x32_bf16 v[118:121], a[44:47], v[88:91], v[118:121]
    s_add_u32 m0, s42, 8192
    ds_read_b64_tr_b16 a[54:55], v27 offset:25088
    v_mfma_f32_16x16x32_bf16 v[100:103], a[36:39], v[32:35], v[100:103]
    buffer_load_dwordx4 v22, s[12:15], s54 offen lds
    v_mfma_f32_16x16x32_bf16 v[104:107], a[40:43], v[32:35], v[104:107]
    ds_read_b64_tr_b16 a[56:57], v28 offset:24576
    v_mfma_f32_16x16x32_bf16 v[108:111], a[44:47], v[32:35], v[108:111]
    ds_read_b64_tr_b16 a[58:59], v28 offset:25088
    s_waitcnt lgkmcnt(4)
    v_mfma_f32_16x16x32_bf16 v[44:47], a[48:51], v[68:71], v[44:47]
    s_add_u32 m0, s42, 9216
    ds_read_b128 v[80:83], v5 offset:8192
    v_mfma_f32_16x16x32_bf16 v[48:51], a[48:51], v[72:75], v[48:51]
    ds_read_b128 v[84:87], v5 offset:10240
    v_mfma_f32_16x16x32_bf16 v[92:95], a[48:51], v[76:79], v[92:95]
    ds_read_b128 v[88:91], v5 offset:36864
    s_waitcnt lgkmcnt(5)
    v_mfma_f32_16x16x32_bf16 v[52:55], a[52:55], v[68:71], v[52:55]
    ds_read_b64_tr_b16 a[60:61], v26 offset:28672
    v_mfma_f32_16x16x32_bf16 v[56:59], a[52:55], v[72:75], v[56:59]
    ds_read_b64_tr_b16 a[62:63], v26 offset:29184
    v_mfma_f32_16x16x32_bf16 v[96:99], a[52:55], v[76:79], v[96:99]
    ds_read_b64_tr_b16 a[64:65], v27 offset:28672
    s_waitcnt lgkmcnt(6)
    v_mfma_f32_16x16x32_bf16 v[60:63], a[56:59], v[68:71], v[60:63]
    ds_read_b64_tr_b16 a[66:67], v27 offset:29184
    v_mfma_f32_16x16x32_bf16 v[64:67], a[56:59], v[72:75], v[64:67]
    ds_read_b64_tr_b16 a[68:69], v28 offset:28672
    v_mfma_f32_16x16x32_bf16 v[118:121], a[56:59], v[76:79], v[118:121]
    ds_read_b64_tr_b16 a[70:71], v28 offset:29184
    v_mfma_f32_16x16x32_bf16 v[100:103], a[48:51], v[32:35], v[100:103]
    buffer_load_dwordx4 v23, s[12:15], s54 offen lds
    v_mfma_f32_16x16x32_bf16 v[104:107], a[52:55], v[32:35], v[104:107]
    s_add_u32 m0, s42, 16384
    s_nop 0
    buffer_load_dwordx4 v24, s[12:15], s54 offen lds
    v_mfma_f32_16x16x32_bf16 v[108:111], a[56:59], v[32:35], v[108:111]
    s_add_u32 m0, s42, 17408
    s_nop 0
    buffer_load_dwordx4 v25, s[12:15], s54 offen lds
    s_add_u32 s54, s54, 393216
    v_lshl_add_u32 v13, v38, 6, v13
    v_add_u32 v13, 90112, v13
    s_lshl_b32 s52, s51, 10
    s_or_b32 s96, s50, 31
    s_mov_b32 s55, 0x541fc00
    s_lshl_b32 s46, s50, 10
    s_sub_u32 s46, s55, s46
    s_mov_b32 s56, 0xaaaaaaaa
    s_mov_b32 s57, 0xaaaaaaaa
    s_mov_b32 s58, 0xfff0ffff
    s_mov_b32 s59, 0xf000ff00
    s_mov_b32 s60, 0xffc0fffc
    s_mov_b32 s61, 0xc000fc00
    s_mov_b32 s86, 0x3e8293ee
    v_mov_b32 v38, 0x0c0c0c0c
    v_mov_b32 v36, 0xc0c0100
    v_mov_b32 v37, 0x1000c0c
    v_cndmask_b32 v36, v36, v37, s[56:57]
    v_cndmask_b32 v14, v36, v38, s[58:59]
    v_cndmask_b32 v16, v38, v36, s[58:59]
    v_mov_b32 v36, 0xc0c0302
    v_mov_b32 v37, 0x3020c0c
    v_cndmask_b32 v36, v36, v37, s[56:57]
    v_cndmask_b32 v15, v36, v38, s[60:61]
    v_cndmask_b32 v17, v38, v36, s[60:61]
    v_mov_b32 v18, 0xff800000
    s_mul_i32 s90, s33, 2097152
    s_add_u32 s90, s90, 0xffff0000
    s_lshl_b32 s37, s35, 1
    s_waitcnt vmcnt(15) lgkmcnt(0)
    s_barrier
    v_mfma_f32_16x16x32_bf16 v[44:47], a[60:63], v[80:83], v[44:47]
    s_add_u32 m0, s43, 142592
    ds_read_b128 v[68:71], v4 offset:12288
    ds_read_b128 v[72:75], v4 offset:14336
    v_mfma_f32_16x16x32_bf16 v[48:51], a[60:63], v[84:87], v[48:51]
    ds_read_b128 v[76:79], v4 offset:38912
    ds_read_b64_tr_b16 a[72:73], v26 offset:49152
    v_mfma_f32_16x16x32_bf16 v[92:95], a[60:63], v[88:91], v[92:95]
    buffer_load_dwordx4 v6, s[8:11], s53 offen offset:768 sc1 lds
    v_mfma_f32_16x16x32_bf16 v[52:55], a[64:67], v[80:83], v[52:55]
    s_add_u32 m0, s43, 122112
    ds_read_b64_tr_b16 a[74:75], v26 offset:49664
    v_mfma_f32_16x16x32_bf16 v[56:59], a[64:67], v[84:87], v[56:59]
    buffer_load_dwordx4 v6, s[8:11], s41 offen offset:768 sc1 lds
    v_mfma_f32_16x16x32_bf16 v[96:99], a[64:67], v[88:91], v[96:99]
    s_add_u32 m0, s42, 24576
    ds_read_b64_tr_b16 a[76:77], v27 offset:49152
    v_mfma_f32_16x16x32_bf16 v[60:63], a[68:71], v[80:83], v[60:63]
    ds_read_b64_tr_b16 a[78:79], v27 offset:49664
    v_mfma_f32_16x16x32_bf16 v[64:67], a[68:71], v[84:87], v[64:67]
    buffer_load_dwordx4 v20, s[12:15], s54 offen lds
    v_mfma_f32_16x16x32_bf16 v[118:121], a[68:71], v[88:91], v[118:121]
    s_add_u32 m0, s42, 25600
    ds_read_b64_tr_b16 a[80:81], v28 offset:49152
    v_mfma_f32_16x16x32_bf16 v[100:103], a[60:63], v[32:35], v[100:103]
    buffer_load_dwordx4 v21, s[12:15], s54 offen lds
    v_mfma_f32_16x16x32_bf16 v[104:107], a[64:67], v[32:35], v[104:107]
    s_add_u32 m0, s42, 32768
    ds_read_b64_tr_b16 a[82:83], v28 offset:49664
    v_mfma_f32_16x16x32_bf16 v[108:111], a[68:71], v[32:35], v[108:111]
    buffer_load_dwordx4 v22, s[12:15], s54 offen lds
    s_waitcnt lgkmcnt(4)
    v_mfma_f32_16x16x32_bf16 v[44:47], a[72:75], v[68:71], v[44:47]
    s_add_u32 m0, s42, 33792
    ds_read_b128 v[80:83], v5 offset:12288
    v_mfma_f32_16x16x32_bf16 v[48:51], a[72:75], v[72:75], v[48:51]
    ds_read_b128 v[84:87], v5 offset:14336
    v_mfma_f32_16x16x32_bf16 v[92:95], a[72:75], v[76:79], v[92:95]
    ds_read_b128 v[88:91], v5 offset:38912
    s_waitcnt lgkmcnt(5)
    v_mfma_f32_16x16x32_bf16 v[52:55], a[76:79], v[68:71], v[52:55]
    ds_read_b64_tr_b16 a[84:85], v26 offset:53248
    v_mfma_f32_16x16x32_bf16 v[56:59], a[76:79], v[72:75], v[56:59]
    ds_read_b64_tr_b16 a[86:87], v26 offset:53760
    v_mfma_f32_16x16x32_bf16 v[96:99], a[76:79], v[76:79], v[96:99]
    ds_read_b64_tr_b16 a[88:89], v27 offset:53248
    s_waitcnt lgkmcnt(6)
    v_mfma_f32_16x16x32_bf16 v[60:63], a[80:83], v[68:71], v[60:63]
    ds_read_b64_tr_b16 a[90:91], v27 offset:53760
    v_mfma_f32_16x16x32_bf16 v[64:67], a[80:83], v[72:75], v[64:67]
    ds_read_b64_tr_b16 a[92:93], v28 offset:53248
    v_mfma_f32_16x16x32_bf16 v[118:121], a[80:83], v[76:79], v[118:121]
    ds_read_b64_tr_b16 a[94:95], v28 offset:53760
    v_mfma_f32_16x16x32_bf16 v[100:103], a[72:75], v[32:35], v[100:103]
    buffer_load_dwordx4 v23, s[12:15], s54 offen lds
    v_mfma_f32_16x16x32_bf16 v[104:107], a[76:79], v[32:35], v[104:107]
    s_add_u32 m0, s42, 40960
    s_nop 0
    buffer_load_dwordx4 v24, s[12:15], s54 offen lds
    v_mfma_f32_16x16x32_bf16 v[108:111], a[80:83], v[32:35], v[108:111]
    s_add_u32 m0, s42, 41984
    s_nop 0
    buffer_load_dwordx4 v25, s[12:15], s54 offen lds
    s_add_u32 s54, s54, 393216
    s_add_u32 s37, s37, s51
    s_lshl_b32 s37, s37, 11
    s_add_u32 s90, s90, s37
    s_mul_i32 s37, s38, 1024
    s_add_u32 s90, s90, s37
    s_mul_i32 s26, s38, 0x80008000
    s_mul_i32 s87, s51, -1024
    s_add_u32 s87, s87, 21504
    s_mul_i32 s87, s87, s38
    s_sub_u32 s87, s87, 1024
    s_sub_u32 s39, s33, 1
    s_max_i32 s39, s39, 0
    s_lshl_b32 s24, s39, 4
    s_add_u32 s24, s24, s35
    s_lshl_b32 s24, s24, 12
    s_add_u32 s24, s24, s43
    s_add_u32 s24, s24, 0x5b00000
    s_lshl_b32 s25, s33, 4
    s_add_u32 s25, s25, s35
    s_lshl_b32 s25, s25, 12
    s_add_u32 s25, s25, s43
    s_add_u32 s25, s25, 0x5b00000
    s_add_u32 s87, s87, 1024
    s_cmp_eq_u32 s33, 0
    s_cselect_b64 s[26:27], s[26:27], 0
    s_add_u32 s20, s82, 0x80
    s_addc_u32 s21, s83, 0
    s_mov_b32 s22, 0x80
    s_mov_b32 s23, 0x00020000
    v_lshl_add_u32 v36, s32, 7, v124
    v_mov_b32 v116, v36
    s_waitcnt vmcnt(15) lgkmcnt(0)
    s_barrier
    v_mfma_f32_16x16x32_bf16 v[44:47], a[84:87], v[80:83], v[44:47]
    s_add_u32 m0, s43, 126080
    ds_read_b128 v[68:71], v4 offset:16384
    ds_read_b128 v[72:75], v4 offset:18432
    v_mfma_f32_16x16x32_bf16 v[48:51], a[84:87], v[84:87], v[48:51]
    ds_read_b128 v[76:79], v4 offset:40960
    v_mfma_f32_16x16x32_bf16 v[92:95], a[84:87], v[88:91], v[92:95]
    buffer_load_dwordx4 v6, s[8:11], s41 offen offset:896 sc1 lds
    v_mfma_f32_16x16x32_bf16 v[52:55], a[88:91], v[80:83], v[52:55]
    s_add_u32 m0, s42, 49152
    ds_read_b64_tr_b16 a[96:97], v29 offset:0
    v_mfma_f32_16x16x32_bf16 v[56:59], a[88:91], v[84:87], v[56:59]
    buffer_load_dwordx4 v20, s[12:15], s54 offen lds
    v_mfma_f32_16x16x32_bf16 v[96:99], a[88:91], v[88:91], v[96:99]
    s_add_u32 m0, s42, 50176
    ds_read_b64_tr_b16 a[98:99], v29 offset:512
    v_mfma_f32_16x16x32_bf16 v[60:63], a[92:95], v[80:83], v[60:63]
    ds_read_b64_tr_b16 a[100:101], v30 offset:0
    v_mfma_f32_16x16x32_bf16 v[64:67], a[92:95], v[84:87], v[64:67]
    buffer_load_dwordx4 v21, s[12:15], s54 offen lds
    v_mfma_f32_16x16x32_bf16 v[118:121], a[92:95], v[88:91], v[118:121]
    s_add_u32 m0, s42, 57344
    ds_read_b64_tr_b16 a[102:103], v30 offset:512
    v_mfma_f32_16x16x32_bf16 v[100:103], a[84:87], v[32:35], v[100:103]
    buffer_load_dwordx4 v22, s[12:15], s54 offen lds
    v_mfma_f32_16x16x32_bf16 v[104:107], a[88:91], v[32:35], v[104:107]
    ds_read_b64_tr_b16 a[104:105], v31 offset:0
    v_mfma_f32_16x16x32_bf16 v[108:111], a[92:95], v[32:35], v[108:111]
    ds_read_b64_tr_b16 a[106:107], v31 offset:512
    s_waitcnt lgkmcnt(4)
    v_mfma_f32_16x16x32_bf16 v[44:47], a[96:99], v[68:71], v[44:47]
    s_add_u32 m0, s42, 58368
    ds_read_b128 v[80:83], v5 offset:16384
    v_mfma_f32_16x16x32_bf16 v[48:51], a[96:99], v[72:75], v[48:51]
    ds_read_b128 v[84:87], v5 offset:18432
    v_mfma_f32_16x16x32_bf16 v[92:95], a[96:99], v[76:79], v[92:95]
    ds_read_b128 v[88:91], v5 offset:40960
    s_waitcnt lgkmcnt(5)
    v_mfma_f32_16x16x32_bf16 v[52:55], a[100:103], v[68:71], v[52:55]
    ds_read_b64_tr_b16 a[108:109], v29 offset:4096
    v_mfma_f32_16x16x32_bf16 v[56:59], a[100:103], v[72:75], v[56:59]
    ds_read_b64_tr_b16 a[110:111], v29 offset:4608
    v_mfma_f32_16x16x32_bf16 v[96:99], a[100:103], v[76:79], v[96:99]
    ds_read_b64_tr_b16 a[112:113], v30 offset:4096
    s_waitcnt lgkmcnt(6)
    v_mfma_f32_16x16x32_bf16 v[60:63], a[104:107], v[68:71], v[60:63]
    ds_read_b64_tr_b16 a[114:115], v30 offset:4608
    v_mfma_f32_16x16x32_bf16 v[64:67], a[104:107], v[72:75], v[64:67]
    ds_read_b64_tr_b16 a[116:117], v31 offset:4096
    v_mfma_f32_16x16x32_bf16 v[118:121], a[104:107], v[76:79], v[118:121]
    ds_read_b64_tr_b16 a[118:119], v31 offset:4608
    v_mfma_f32_16x16x32_bf16 v[100:103], a[96:99], v[32:35], v[100:103]
    buffer_load_dwordx4 v23, s[12:15], s54 offen lds
    v_mfma_f32_16x16x32_bf16 v[104:107], a[100:103], v[32:35], v[104:107]
    s_add_u32 m0, s42, 65536
    s_nop 0
    buffer_load_dwordx4 v24, s[12:15], s54 offen lds
    v_mfma_f32_16x16x32_bf16 v[108:111], a[104:107], v[32:35], v[108:111]
    s_add_u32 m0, s42, 66560
    s_nop 0
    buffer_load_dwordx4 v25, s[12:15], s54 offen lds
    s_add_u32 s54, s54, 393216
    s_waitcnt vmcnt(15) lgkmcnt(0)
    s_barrier
    v_mfma_f32_16x16x32_bf16 v[44:47], a[108:111], v[80:83], v[44:47]
    s_add_u32 m0, s43, 146432
    ds_read_b128 v[68:71], v4 offset:20480
    ds_read_b128 v[72:75], v4 offset:22528
    v_mfma_f32_16x16x32_bf16 v[48:51], a[108:111], v[84:87], v[48:51]
    ds_read_b128 v[76:79], v4 offset:43008
    ds_read_b64_tr_b16 a[120:121], v26 offset:0
    v_mfma_f32_16x16x32_bf16 v[92:95], a[108:111], v[88:91], v[92:95]
    buffer_load_dwordx4 v6, s[8:11], s53 offen offset:1024 sc1 lds
    v_mfma_f32_16x16x32_bf16 v[52:55], a[112:115], v[80:83], v[52:55]
    s_add_u32 m0, s43, 97280
    ds_read_b64_tr_b16 a[122:123], v26 offset:512
    v_mfma_f32_16x16x32_bf16 v[56:59], a[112:115], v[84:87], v[56:59]
    buffer_load_dwordx4 v6, s[8:11], s41 offen offset:1024 sc1 lds
    v_mfma_f32_16x16x32_bf16 v[96:99], a[112:115], v[88:91], v[96:99]
    s_add_u32 m0, s42, 73728
    ds_read_b64_tr_b16 a[124:125], v27 offset:0
    v_mfma_f32_16x16x32_bf16 v[60:63], a[116:119], v[80:83], v[60:63]
    ds_read_b64_tr_b16 a[126:127], v27 offset:512
    v_mfma_f32_16x16x32_bf16 v[64:67], a[116:119], v[84:87], v[64:67]
    buffer_load_dwordx4 v20, s[12:15], s54 offen lds
    v_mfma_f32_16x16x32_bf16 v[118:121], a[116:119], v[88:91], v[118:121]
    s_add_u32 m0, s42, 74752
    ds_read_b64_tr_b16 a[128:129], v28 offset:0
    v_mfma_f32_16x16x32_bf16 v[100:103], a[108:111], v[32:35], v[100:103]
    buffer_load_dwordx4 v21, s[12:15], s54 offen lds
    v_mfma_f32_16x16x32_bf16 v[104:107], a[112:115], v[32:35], v[104:107]
    s_add_u32 m0, s42, 81920
    ds_read_b64_tr_b16 a[130:131], v28 offset:512
    v_mfma_f32_16x16x32_bf16 v[108:111], a[116:119], v[32:35], v[108:111]
    buffer_load_dwordx4 v22, s[12:15], s54 offen lds
    s_waitcnt lgkmcnt(4)
    v_mfma_f32_16x16x32_bf16 v[44:47], a[120:123], v[68:71], v[44:47]
    s_add_u32 m0, s42, 82944
    ds_read_b128 v[80:83], v5 offset:20480
    v_mfma_f32_16x16x32_bf16 v[48:51], a[120:123], v[72:75], v[48:51]
    ds_read_b128 v[84:87], v5 offset:22528
    v_mfma_f32_16x16x32_bf16 v[92:95], a[120:123], v[76:79], v[92:95]
    ds_read_b128 v[88:91], v5 offset:43008
    s_waitcnt lgkmcnt(5)
    v_mfma_f32_16x16x32_bf16 v[52:55], a[124:127], v[68:71], v[52:55]
    ds_read_b64_tr_b16 a[132:133], v26 offset:4096
    v_mfma_f32_16x16x32_bf16 v[56:59], a[124:127], v[72:75], v[56:59]
    ds_read_b64_tr_b16 a[134:135], v26 offset:4608
    v_mfma_f32_16x16x32_bf16 v[96:99], a[124:127], v[76:79], v[96:99]
    ds_read_b64_tr_b16 a[136:137], v27 offset:4096
    s_waitcnt lgkmcnt(6)
    v_mfma_f32_16x16x32_bf16 v[60:63], a[128:131], v[68:71], v[60:63]
    ds_read_b64_tr_b16 a[138:139], v27 offset:4608
    v_mfma_f32_16x16x32_bf16 v[64:67], a[128:131], v[72:75], v[64:67]
    ds_read_b64_tr_b16 a[140:141], v28 offset:4096
    v_mfma_f32_16x16x32_bf16 v[118:121], a[128:131], v[76:79], v[118:121]
    ds_read_b64_tr_b16 a[142:143], v28 offset:4608
    v_mfma_f32_16x16x32_bf16 v[100:103], a[120:123], v[32:35], v[100:103]
    buffer_load_dwordx4 v23, s[12:15], s54 offen lds
    v_mfma_f32_16x16x32_bf16 v[104:107], a[124:127], v[32:35], v[104:107]
    s_add_u32 m0, s42, 90112
    s_nop 0
    buffer_load_dwordx4 v24, s[12:15], s54 offen lds
    v_mfma_f32_16x16x32_bf16 v[108:111], a[128:131], v[32:35], v[108:111]
    s_add_u32 m0, s42, 91136
    s_nop 0
    buffer_load_dwordx4 v25, s[12:15], s54 offen lds
    s_add_u32 s54, s54, 393216
    s_waitcnt vmcnt(15) lgkmcnt(0)
    s_barrier
    v_mfma_f32_16x16x32_bf16 v[44:47], a[132:135], v[80:83], v[44:47]
    s_add_u32 m0, s43, 101248
    ds_read_b128 v[68:71], v4 offset:24576
    ds_read_b128 v[72:75], v4 offset:26624
    v_mfma_f32_16x16x32_bf16 v[48:51], a[132:135], v[84:87], v[48:51]
    ds_read_b128 v[76:79], v4 offset:45056
    v_mfma_f32_16x16x32_bf16 v[92:95], a[132:135], v[88:91], v[92:95]
    buffer_load_dwordx4 v6, s[8:11], s41 offen offset:1152 sc1 lds
    v_mfma_f32_16x16x32_bf16 v[52:55], a[136:139], v[80:83], v[52:55]
    s_add_u32 m0, s42, 0
    ds_read_b64_tr_b16 a[144:145], v26 offset:24576
    v_mfma_f32_16x16x32_bf16 v[56:59], a[136:139], v[84:87], v[56:59]
    buffer_load_dwordx4 v20, s[12:15], s54 offen lds
    v_mfma_f32_16x16x32_bf16 v[96:99], a[136:139], v[88:91], v[96:99]
    s_add_u32 m0, s42, 1024
    ds_read_b64_tr_b16 a[146:147], v26 offset:25088
    v_mfma_f32_16x16x32_bf16 v[60:63], a[140:143], v[80:83], v[60:63]
    ds_read_b64_tr_b16 a[148:149], v27 offset:24576
    v_mfma_f32_16x16x32_bf16 v[64:67], a[140:143], v[84:87], v[64:67]
    buffer_load_dwordx4 v21, s[12:15], s54 offen lds
    v_mfma_f32_16x16x32_bf16 v[118:121], a[140:143], v[88:91], v[118:121]
    s_add_u32 m0, s42, 8192
    ds_read_b64_tr_b16 a[150:151], v27 offset:25088
    v_mfma_f32_16x16x32_bf16 v[100:103], a[132:135], v[32:35], v[100:103]
    buffer_load_dwordx4 v22, s[12:15], s54 offen lds
    v_mfma_f32_16x16x32_bf16 v[104:107], a[136:139], v[32:35], v[104:107]
    ds_read_b64_tr_b16 a[152:153], v28 offset:24576
    v_mfma_f32_16x16x32_bf16 v[108:111], a[140:143], v[32:35], v[108:111]
    ds_read_b64_tr_b16 a[154:155], v28 offset:25088
    s_waitcnt lgkmcnt(4)
    v_mfma_f32_16x16x32_bf16 v[44:47], a[144:147], v[68:71], v[44:47]
    s_add_u32 m0, s42, 9216
    ds_read_b128 v[80:83], v5 offset:24576
    v_mfma_f32_16x16x32_bf16 v[48:51], a[144:147], v[72:75], v[48:51]
    ds_read_b128 v[84:87], v5 offset:26624
    v_mfma_f32_16x16x32_bf16 v[92:95], a[144:147], v[76:79], v[92:95]
    ds_read_b128 v[88:91], v5 offset:45056
    s_waitcnt lgkmcnt(5)
    v_mfma_f32_16x16x32_bf16 v[52:55], a[148:151], v[68:71], v[52:55]
    ds_read_b64_tr_b16 a[156:157], v26 offset:28672
    v_mfma_f32_16x16x32_bf16 v[56:59], a[148:151], v[72:75], v[56:59]
    ds_read_b64_tr_b16 a[158:159], v26 offset:29184
    v_mfma_f32_16x16x32_bf16 v[96:99], a[148:151], v[76:79], v[96:99]
    ds_read_b64_tr_b16 a[160:161], v27 offset:28672
    s_waitcnt lgkmcnt(6)
    v_mfma_f32_16x16x32_bf16 v[60:63], a[152:155], v[68:71], v[60:63]
    ds_read_b64_tr_b16 a[162:163], v27 offset:29184
    v_mfma_f32_16x16x32_bf16 v[64:67], a[152:155], v[72:75], v[64:67]
    ds_read_b64_tr_b16 a[164:165], v28 offset:28672
    v_mfma_f32_16x16x32_bf16 v[118:121], a[152:155], v[76:79], v[118:121]
    ds_read_b64_tr_b16 a[166:167], v28 offset:29184
    v_mfma_f32_16x16x32_bf16 v[100:103], a[144:147], v[32:35], v[100:103]
    buffer_load_dwordx4 v23, s[12:15], s54 offen lds
    v_mfma_f32_16x16x32_bf16 v[104:107], a[148:151], v[32:35], v[104:107]
    s_add_u32 m0, s42, 16384
    s_nop 0
    buffer_load_dwordx4 v24, s[12:15], s54 offen lds
    v_mfma_f32_16x16x32_bf16 v[108:111], a[152:155], v[32:35], v[108:111]
    s_add_u32 m0, s42, 17408
    s_nop 0
    buffer_load_dwordx4 v25, s[12:15], s54 offen lds
    s_add_u32 s54, s54, 393216
    s_waitcnt vmcnt(15) lgkmcnt(0)
    s_barrier
    v_mfma_f32_16x16x32_bf16 v[44:47], a[156:159], v[80:83], v[44:47]
    s_add_u32 m0, s43, 150272
    ds_read_b128 v[68:71], v4 offset:28672
    ds_read_b128 v[72:75], v4 offset:30720
    v_mfma_f32_16x16x32_bf16 v[48:51], a[156:159], v[84:87], v[48:51]
    ds_read_b128 v[76:79], v4 offset:47104
    ds_read_b64_tr_b16 a[168:169], v26 offset:49152
    v_mfma_f32_16x16x32_bf16 v[92:95], a[156:159], v[88:91], v[92:95]
    buffer_load_dwordx4 v6, s[8:11], s53 offen offset:1280 sc1 lds
    v_mfma_f32_16x16x32_bf16 v[52:55], a[160:163], v[80:83], v[52:55]
    s_add_u32 m0, s43, 105216
    ds_read_b64_tr_b16 a[170:171], v26 offset:49664
    v_mfma_f32_16x16x32_bf16 v[56:59], a[160:163], v[84:87], v[56:59]
    buffer_load_dwordx4 v6, s[8:11], s41 offen offset:1280 sc1 lds
    v_mfma_f32_16x16x32_bf16 v[96:99], a[160:163], v[88:91], v[96:99]
    s_add_u32 m0, s42, 24576
    ds_read_b64_tr_b16 a[172:173], v27 offset:49152
    v_mfma_f32_16x16x32_bf16 v[60:63], a[164:167], v[80:83], v[60:63]
    ds_read_b64_tr_b16 a[174:175], v27 offset:49664
    v_mfma_f32_16x16x32_bf16 v[64:67], a[164:167], v[84:87], v[64:67]
    buffer_load_dwordx4 v20, s[12:15], s54 offen lds
    v_mfma_f32_16x16x32_bf16 v[118:121], a[164:167], v[88:91], v[118:121]
    s_add_u32 m0, s42, 25600
    ds_read_b64_tr_b16 a[176:177], v28 offset:49152
    v_mfma_f32_16x16x32_bf16 v[100:103], a[156:159], v[32:35], v[100:103]
    buffer_load_dwordx4 v21, s[12:15], s54 offen lds
    v_mfma_f32_16x16x32_bf16 v[104:107], a[160:163], v[32:35], v[104:107]
    s_add_u32 m0, s42, 32768
    ds_read_b64_tr_b16 a[178:179], v28 offset:49664
    v_mfma_f32_16x16x32_bf16 v[108:111], a[164:167], v[32:35], v[108:111]
    buffer_load_dwordx4 v22, s[12:15], s54 offen lds
    s_waitcnt lgkmcnt(4)
    v_mfma_f32_16x16x32_bf16 v[44:47], a[168:171], v[68:71], v[44:47]
    s_add_u32 m0, s42, 33792
    ds_read_b128 v[80:83], v5 offset:28672
    v_mfma_f32_16x16x32_bf16 v[48:51], a[168:171], v[72:75], v[48:51]
    ds_read_b128 v[84:87], v5 offset:30720
    v_mfma_f32_16x16x32_bf16 v[92:95], a[168:171], v[76:79], v[92:95]
    ds_read_b128 v[88:91], v5 offset:47104
    s_waitcnt lgkmcnt(5)
    v_mfma_f32_16x16x32_bf16 v[52:55], a[172:175], v[68:71], v[52:55]
    ds_read_b64_tr_b16 a[180:181], v26 offset:53248
    v_mfma_f32_16x16x32_bf16 v[56:59], a[172:175], v[72:75], v[56:59]
    ds_read_b64_tr_b16 a[182:183], v26 offset:53760
    v_mfma_f32_16x16x32_bf16 v[96:99], a[172:175], v[76:79], v[96:99]
    ds_read_b64_tr_b16 a[184:185], v27 offset:53248
    s_waitcnt lgkmcnt(6)
    v_mfma_f32_16x16x32_bf16 v[60:63], a[176:179], v[68:71], v[60:63]
    ds_read_b64_tr_b16 a[186:187], v27 offset:53760
    v_mfma_f32_16x16x32_bf16 v[64:67], a[176:179], v[72:75], v[64:67]
    ds_read_b64_tr_b16 a[188:189], v28 offset:53248
    v_mfma_f32_16x16x32_bf16 v[118:121], a[176:179], v[76:79], v[118:121]
    ds_read_b64_tr_b16 a[190:191], v28 offset:53760
    v_mfma_f32_16x16x32_bf16 v[100:103], a[168:171], v[32:35], v[100:103]
    buffer_load_dwordx4 v23, s[12:15], s54 offen lds
    v_mfma_f32_16x16x32_bf16 v[104:107], a[172:175], v[32:35], v[104:107]
    s_add_u32 m0, s42, 40960
    s_nop 0
    buffer_load_dwordx4 v24, s[12:15], s54 offen lds
    v_mfma_f32_16x16x32_bf16 v[108:111], a[176:179], v[32:35], v[108:111]
    s_add_u32 m0, s42, 41984
    s_nop 0
    buffer_load_dwordx4 v25, s[12:15], s54 offen lds
    s_add_u32 s54, s54, 393216
    s_waitcnt vmcnt(15) lgkmcnt(0)
    s_barrier
    v_mfma_f32_16x16x32_bf16 v[44:47], a[180:183], v[80:83], v[44:47]
    ds_read_b128 v[68:71], v4 offset:0
    ds_read_b128 v[72:75], v4 offset:2048
    v_mfma_f32_16x16x32_bf16 v[48:51], a[180:183], v[84:87], v[48:51]
    ds_read_b128 v[76:79], v4 offset:49152
    ds_read_b64_tr_b16 a[192:193], v29 offset:0
    v_mfma_f32_16x16x32_bf16 v[92:95], a[180:183], v[88:91], v[92:95]
    buffer_load_dword v38, v124, s[20:23], 0 offen offset:32 sc1
    v_mfma_f32_16x16x32_bf16 v[52:55], a[184:187], v[80:83], v[52:55]
    s_add_u32 m0, s43, 109184
    ds_read_b64_tr_b16 a[194:195], v29 offset:512
    v_mfma_f32_16x16x32_bf16 v[56:59], a[184:187], v[84:87], v[56:59]
    buffer_load_dwordx4 v6, s[8:11], s41 offen offset:1408 sc1 lds
    v_mfma_f32_16x16x32_bf16 v[96:99], a[184:187], v[88:91], v[96:99]
    s_add_u32 m0, s42, 49152
    ds_read_b64_tr_b16 a[196:197], v30 offset:0
    v_mfma_f32_16x16x32_bf16 v[60:63], a[188:191], v[80:83], v[60:63]
    ds_read_b64_tr_b16 a[198:199], v30 offset:512
    v_mfma_f32_16x16x32_bf16 v[64:67], a[188:191], v[84:87], v[64:67]
    buffer_load_dwordx4 v20, s[12:15], s54 offen lds
    v_mfma_f32_16x16x32_bf16 v[118:121], a[188:191], v[88:91], v[118:121]
    s_add_u32 m0, s42, 50176
    ds_read_b64_tr_b16 a[200:201], v31 offset:0
    v_mfma_f32_16x16x32_bf16 v[100:103], a[180:183], v[32:35], v[100:103]
    buffer_load_dwordx4 v21, s[12:15], s54 offen lds
    v_mfma_f32_16x16x32_bf16 v[104:107], a[184:187], v[32:35], v[104:107]
    s_add_u32 m0, s42, 57344
    ds_read_b64_tr_b16 a[202:203], v31 offset:512
    v_mfma_f32_16x16x32_bf16 v[108:111], a[188:191], v[32:35], v[108:111]
    buffer_load_dwordx4 v22, s[12:15], s54 offen lds
    s_waitcnt lgkmcnt(4)
    v_mfma_f32_16x16x32_bf16 v[44:47], a[192:195], v[68:71], v[44:47]
    s_add_u32 m0, s42, 58368
    ds_read_b128 v[80:83], v5 offset:0
    v_mfma_f32_16x16x32_bf16 v[48:51], a[192:195], v[72:75], v[48:51]
    ds_read_b128 v[84:87], v5 offset:2048
    v_mfma_f32_16x16x32_bf16 v[92:95], a[192:195], v[76:79], v[92:95]
    ds_read_b128 v[88:91], v5 offset:49152
    s_waitcnt lgkmcnt(5)
    v_mfma_f32_16x16x32_bf16 v[52:55], a[196:199], v[68:71], v[52:55]
    ds_read_b64_tr_b16 a[204:205], v29 offset:4096
    v_mfma_f32_16x16x32_bf16 v[56:59], a[196:199], v[72:75], v[56:59]
    ds_read_b64_tr_b16 a[206:207], v29 offset:4608
    v_mfma_f32_16x16x32_bf16 v[96:99], a[196:199], v[76:79], v[96:99]
    ds_read_b64_tr_b16 a[208:209], v30 offset:4096
    s_waitcnt lgkmcnt(6)
    v_mfma_f32_16x16x32_bf16 v[60:63], a[200:203], v[68:71], v[60:63]
    ds_read_b64_tr_b16 a[210:211], v30 offset:4608
    v_mfma_f32_16x16x32_bf16 v[64:67], a[200:203], v[72:75], v[64:67]
    ds_read_b64_tr_b16 a[212:213], v31 offset:4096
    v_mfma_f32_16x16x32_bf16 v[118:121], a[200:203], v[76:79], v[118:121]
    ds_read_b64_tr_b16 a[214:215], v31 offset:4608
    v_mfma_f32_16x16x32_bf16 v[100:103], a[192:195], v[32:35], v[100:103]
    buffer_load_dwordx4 v23, s[12:15], s54 offen lds
    v_mfma_f32_16x16x32_bf16 v[104:107], a[196:199], v[32:35], v[104:107]
    s_add_u32 m0, s42, 65536
    s_nop 0
    buffer_load_dwordx4 v24, s[12:15], s54 offen lds
    v_mfma_f32_16x16x32_bf16 v[108:111], a[200:203], v[32:35], v[108:111]
    s_add_u32 m0, s42, 66560
    s_nop 0
    buffer_load_dwordx4 v25, s[12:15], s54 offen lds
    s_add_u32 s54, s54, 393216
    s_waitcnt vmcnt(16) lgkmcnt(0)
    s_barrier
    v_mfma_f32_16x16x32_bf16 v[44:47], a[204:207], v[80:83], v[44:47]
    s_add_u32 m0, s43, 154112
    ds_read_b128 v[68:71], v4 offset:4096
    ds_read_b128 v[72:75], v4 offset:6144
    v_mfma_f32_16x16x32_bf16 v[48:51], a[204:207], v[84:87], v[48:51]
    ds_read_b128 v[76:79], v4 offset:51200
    ds_read_b64_tr_b16 a[216:217], v26 offset:0
    v_mfma_f32_16x16x32_bf16 v[92:95], a[204:207], v[88:91], v[92:95]
    buffer_load_dwordx4 v6, s[8:11], s53 offen offset:1536 sc1 lds
    v_mfma_f32_16x16x32_bf16 v[52:55], a[208:211], v[80:83], v[52:55]
    s_add_u32 m0, s43, 113152
    ds_read_b64_tr_b16 a[218:219], v26 offset:512
    v_mfma_f32_16x16x32_bf16 v[56:59], a[208:211], v[84:87], v[56:59]
    buffer_load_dwordx4 v6, s[8:11], s41 offen offset:1536 sc1 lds
    v_mfma_f32_16x16x32_bf16 v[96:99], a[208:211], v[88:91], v[96:99]
    s_add_u32 m0, s42, 73728
    ds_read_b64_tr_b16 a[220:221], v27 offset:0
    v_mfma_f32_16x16x32_bf16 v[60:63], a[212:215], v[80:83], v[60:63]
    ds_read_b64_tr_b16 a[222:223], v27 offset:512
    v_mfma_f32_16x16x32_bf16 v[64:67], a[212:215], v[84:87], v[64:67]
    buffer_load_dwordx4 v20, s[12:15], s54 offen lds
    v_mfma_f32_16x16x32_bf16 v[118:121], a[212:215], v[88:91], v[118:121]
    s_add_u32 m0, s42, 74752
    ds_read_b64_tr_b16 a[224:225], v28 offset:0
    v_mfma_f32_16x16x32_bf16 v[100:103], a[204:207], v[32:35], v[100:103]
    buffer_load_dwordx4 v21, s[12:15], s54 offen lds
    v_mfma_f32_16x16x32_bf16 v[104:107], a[208:211], v[32:35], v[104:107]
    s_add_u32 m0, s42, 81920
    ds_read_b64_tr_b16 a[226:227], v28 offset:512
    v_mfma_f32_16x16x32_bf16 v[108:111], a[212:215], v[32:35], v[108:111]
    buffer_load_dwordx4 v22, s[12:15], s54 offen lds
    s_waitcnt lgkmcnt(4)
    v_mfma_f32_16x16x32_bf16 v[44:47], a[216:219], v[68:71], v[44:47]
    s_add_u32 m0, s42, 82944
    ds_read_b128 v[80:83], v5 offset:4096
    v_mfma_f32_16x16x32_bf16 v[48:51], a[216:219], v[72:75], v[48:51]
    ds_read_b128 v[84:87], v5 offset:6144
    v_mfma_f32_16x16x32_bf16 v[92:95], a[216:219], v[76:79], v[92:95]
    ds_read_b128 v[88:91], v5 offset:51200
    s_waitcnt lgkmcnt(5)
    v_mfma_f32_16x16x32_bf16 v[52:55], a[220:223], v[68:71], v[52:55]
    ds_read_b64_tr_b16 a[228:229], v26 offset:4096
    v_mfma_f32_16x16x32_bf16 v[56:59], a[220:223], v[72:75], v[56:59]
    ds_read_b64_tr_b16 a[230:231], v26 offset:4608
    v_mfma_f32_16x16x32_bf16 v[96:99], a[220:223], v[76:79], v[96:99]
    ds_read_b64_tr_b16 a[232:233], v27 offset:4096
    s_waitcnt lgkmcnt(6)
    v_mfma_f32_16x16x32_bf16 v[60:63], a[224:227], v[68:71], v[60:63]
    ds_read_b64_tr_b16 a[234:235], v27 offset:4608
    v_mfma_f32_16x16x32_bf16 v[64:67], a[224:227], v[72:75], v[64:67]
    ds_read_b64_tr_b16 a[236:237], v28 offset:4096
    v_mfma_f32_16x16x32_bf16 v[118:121], a[224:227], v[76:79], v[118:121]
    ds_read_b64_tr_b16 a[238:239], v28 offset:4608
    v_mfma_f32_16x16x32_bf16 v[100:103], a[216:219], v[32:35], v[100:103]
    buffer_load_dwordx4 v23, s[12:15], s54 offen lds
    v_mfma_f32_16x16x32_bf16 v[104:107], a[220:223], v[32:35], v[104:107]
    s_add_u32 m0, s42, 90112
    s_nop 0
    buffer_load_dwordx4 v24, s[12:15], s54 offen lds
    v_mfma_f32_16x16x32_bf16 v[108:111], a[224:227], v[32:35], v[108:111]
    s_add_u32 m0, s42, 91136
    s_nop 0
    buffer_load_dwordx4 v25, s[12:15], s54 offen lds
    s_add_u32 s54, s54, 393216
    s_waitcnt vmcnt(16) lgkmcnt(0)
    s_barrier
    v_mfma_f32_16x16x32_bf16 v[44:47], a[228:231], v[80:83], v[44:47]
    s_add_u32 m0, s43, 117120
    ds_read_b128 v[68:71], v4 offset:8192
    ds_read_b128 v[72:75], v4 offset:10240
    v_mfma_f32_16x16x32_bf16 v[48:51], a[228:231], v[84:87], v[48:51]
    ds_read_b128 v[76:79], v4 offset:53248
    v_mfma_f32_16x16x32_bf16 v[92:95], a[228:231], v[88:91], v[92:95]
    buffer_load_dwordx4 v6, s[8:11], s41 offen offset:1664 sc1 lds
    v_mfma_f32_16x16x32_bf16 v[52:55], a[232:235], v[80:83], v[52:55]
    s_add_u32 m0, s42, 0
    ds_read_b64_tr_b16 a[240:241], v26 offset:24576
    v_mfma_f32_16x16x32_bf16 v[56:59], a[232:235], v[84:87], v[56:59]
    buffer_load_dwordx4 v20, s[12:15], s54 offen lds
    v_mfma_f32_16x16x32_bf16 v[96:99], a[232:235], v[88:91], v[96:99]
    s_add_u32 m0, s42, 1024
    ds_read_b64_tr_b16 a[242:243], v26 offset:25088
    v_mfma_f32_16x16x32_bf16 v[60:63], a[236:239], v[80:83], v[60:63]
    ds_read_b64_tr_b16 a[244:245], v27 offset:24576
    v_mfma_f32_16x16x32_bf16 v[64:67], a[236:239], v[84:87], v[64:67]
    buffer_load_dwordx4 v21, s[12:15], s54 offen lds
    v_mfma_f32_16x16x32_bf16 v[118:121], a[236:239], v[88:91], v[118:121]
    s_add_u32 m0, s42, 8192
    ds_read_b64_tr_b16 a[246:247], v27 offset:25088
    v_mfma_f32_16x16x32_bf16 v[100:103], a[228:231], v[32:35], v[100:103]
    buffer_load_dwordx4 v22, s[12:15], s54 offen lds
    v_mfma_f32_16x16x32_bf16 v[104:107], a[232:235], v[32:35], v[104:107]
    ds_read_b64_tr_b16 a[248:249], v28 offset:24576
    v_mfma_f32_16x16x32_bf16 v[108:111], a[236:239], v[32:35], v[108:111]
    ds_read_b64_tr_b16 a[250:251], v28 offset:25088
    s_waitcnt lgkmcnt(4)
    v_mfma_f32_16x16x32_bf16 v[44:47], a[240:243], v[68:71], v[44:47]
    s_add_u32 m0, s42, 9216
    ds_read_b128 v[80:83], v5 offset:8192
    v_mfma_f32_16x16x32_bf16 v[48:51], a[240:243], v[72:75], v[48:51]
    ds_read_b128 v[84:87], v5 offset:10240
    v_mfma_f32_16x16x32_bf16 v[92:95], a[240:243], v[76:79], v[92:95]
    ds_read_b128 v[88:91], v5 offset:53248
    s_waitcnt lgkmcnt(5)
    v_mfma_f32_16x16x32_bf16 v[52:55], a[244:247], v[68:71], v[52:55]
    ds_read_b64_tr_b16 a[252:253], v26 offset:28672
    v_mfma_f32_16x16x32_bf16 v[56:59], a[244:247], v[72:75], v[56:59]
    ds_read_b64_tr_b16 a[254:255], v26 offset:29184
    v_mfma_f32_16x16x32_bf16 v[96:99], a[244:247], v[76:79], v[96:99]
    ds_read_b64_tr_b16 v[128:129], v27 offset:28672
    s_waitcnt lgkmcnt(6)
    v_mfma_f32_16x16x32_bf16 v[60:63], a[248:251], v[68:71], v[60:63]
    ds_read_b64_tr_b16 v[130:131], v27 offset:29184
    v_mfma_f32_16x16x32_bf16 v[64:67], a[248:251], v[72:75], v[64:67]
    ds_read_b64_tr_b16 v[132:133], v28 offset:28672
    v_mfma_f32_16x16x32_bf16 v[118:121], a[248:251], v[76:79], v[118:121]
    ds_read_b64_tr_b16 v[134:135], v28 offset:29184
    v_mfma_f32_16x16x32_bf16 v[100:103], a[240:243], v[32:35], v[100:103]
    buffer_load_dwordx4 v23, s[12:15], s54 offen lds
    v_mfma_f32_16x16x32_bf16 v[104:107], a[244:247], v[32:35], v[104:107]
    s_add_u32 m0, s42, 16384
    s_nop 0
    buffer_load_dwordx4 v24, s[12:15], s54 offen lds
    v_mfma_f32_16x16x32_bf16 v[108:111], a[248:251], v[32:35], v[108:111]
    s_add_u32 m0, s42, 17408
    s_nop 0
    buffer_load_dwordx4 v25, s[12:15], s54 offen lds
    s_add_u32 s54, s54, 393216
    s_waitcnt vmcnt(15) lgkmcnt(0)
    s_barrier
    v_mfma_f32_16x16x32_bf16 v[44:47], a[252:255], v[80:83], v[44:47]
    buffer_load_dword v37, v36, s[20:23], 64 offen sc1
    v_mfma_f32_16x16x32_bf16 v[48:51], a[252:255], v[84:87], v[48:51]
    s_add_u32 m0, s43, 157952
    ds_read_b128 v[68:71], v4 offset:12288
    ds_read_b128 v[72:75], v4 offset:14336
    v_mfma_f32_16x16x32_bf16 v[92:95], a[252:255], v[88:91], v[92:95]
    buffer_load_dwordx4 v6, s[8:11], s53 offen offset:1792 sc1 lds
    v_mfma_f32_16x16x32_bf16 v[52:55], v[128:131], v[80:83], v[52:55]
    s_add_u32 m0, s43, 121088
    ds_read_b128 v[76:79], v4 offset:55296
    ds_read_b64_tr_b16 v[136:137], v26 offset:49152
    v_mfma_f32_16x16x32_bf16 v[56:59], v[128:131], v[84:87], v[56:59]
    buffer_load_dwordx4 v6, s[8:11], s41 offen offset:1792 sc1 lds
    v_mfma_f32_16x16x32_bf16 v[96:99], v[128:131], v[88:91], v[96:99]
    s_add_u32 m0, s42, 24576
    ds_read_b64_tr_b16 v[138:139], v26 offset:49664
    ds_read_b64_tr_b16 v[140:141], v27 offset:49152
    v_mfma_f32_16x16x32_bf16 v[60:63], v[132:135], v[80:83], v[60:63]
    ds_read_b64_tr_b16 v[142:143], v27 offset:49664
    v_mfma_f32_16x16x32_bf16 v[64:67], v[132:135], v[84:87], v[64:67]
    buffer_load_dwordx4 v20, s[12:15], s54 offen lds
    v_mfma_f32_16x16x32_bf16 v[118:121], v[132:135], v[88:91], v[118:121]
    s_add_u32 m0, s42, 25600
    ds_read_b64_tr_b16 v[144:145], v28 offset:49152
    v_mfma_f32_16x16x32_bf16 v[100:103], a[252:255], v[32:35], v[100:103]
    buffer_load_dwordx4 v21, s[12:15], s54 offen lds
    v_mfma_f32_16x16x32_bf16 v[104:107], v[128:131], v[32:35], v[104:107]
    s_add_u32 m0, s42, 32768
    ds_read_b64_tr_b16 v[146:147], v28 offset:49664
    v_mfma_f32_16x16x32_bf16 v[108:111], v[132:135], v[32:35], v[108:111]
    buffer_load_dwordx4 v22, s[12:15], s54 offen lds
    s_waitcnt lgkmcnt(4)
    v_mfma_f32_16x16x32_bf16 v[44:47], v[136:139], v[68:71], v[44:47]
    s_add_u32 m0, s42, 33792
    ds_read_b128 v[80:83], v5 offset:12288
    v_mfma_f32_16x16x32_bf16 v[48:51], v[136:139], v[72:75], v[48:51]
    ds_read_b128 v[84:87], v5 offset:14336
    v_mfma_f32_16x16x32_bf16 v[92:95], v[136:139], v[76:79], v[92:95]
    ds_read_b128 v[88:91], v5 offset:55296
    s_waitcnt lgkmcnt(5)
    v_mfma_f32_16x16x32_bf16 v[52:55], v[140:143], v[68:71], v[52:55]
    ds_read_b64_tr_b16 v[148:149], v26 offset:53248
    v_mfma_f32_16x16x32_bf16 v[56:59], v[140:143], v[72:75], v[56:59]
    ds_read_b64_tr_b16 v[150:151], v26 offset:53760
    v_mfma_f32_16x16x32_bf16 v[96:99], v[140:143], v[76:79], v[96:99]
    ds_read_b64_tr_b16 v[152:153], v27 offset:53248
    s_waitcnt lgkmcnt(6)
    v_mfma_f32_16x16x32_bf16 v[60:63], v[144:147], v[68:71], v[60:63]
    ds_read_b64_tr_b16 v[154:155], v27 offset:53760
    v_mfma_f32_16x16x32_bf16 v[64:67], v[144:147], v[72:75], v[64:67]
    ds_read_b64_tr_b16 v[156:157], v28 offset:53248
    v_mfma_f32_16x16x32_bf16 v[118:121], v[144:147], v[76:79], v[118:121]
    ds_read_b64_tr_b16 v[158:159], v28 offset:53760
    v_mfma_f32_16x16x32_bf16 v[100:103], v[136:139], v[32:35], v[100:103]
    buffer_load_dwordx4 v23, s[12:15], s54 offen lds
    v_mfma_f32_16x16x32_bf16 v[104:107], v[140:143], v[32:35], v[104:107]
    s_add_u32 m0, s42, 40960
    s_nop 0
    buffer_load_dwordx4 v24, s[12:15], s54 offen lds
    v_mfma_f32_16x16x32_bf16 v[108:111], v[144:147], v[32:35], v[108:111]
    s_add_u32 m0, s42, 41984
    s_nop 0
    buffer_load_dwordx4 v25, s[12:15], s54 offen lds
    s_add_u32 s54, s54, 393216
    s_waitcnt vmcnt(16) lgkmcnt(0)
    s_barrier
    v_mfma_f32_16x16x32_bf16 v[44:47], v[148:151], v[80:83], v[44:47]
    s_add_u32 m0, s43, 125056
    ds_read_b128 v[68:71], v4 offset:16384
    ds_read_b128 v[72:75], v4 offset:18432
    v_mfma_f32_16x16x32_bf16 v[48:51], v[148:151], v[84:87], v[48:51]
    ds_read_b128 v[76:79], v4 offset:57344
    v_mfma_f32_16x16x32_bf16 v[92:95], v[148:151], v[88:91], v[92:95]
    buffer_load_dwordx4 v6, s[8:11], s41 offen offset:1920 sc1 lds
    v_mfma_f32_16x16x32_bf16 v[52:55], v[152:155], v[80:83], v[52:55]
    s_add_u32 m0, s42, 49152
    ds_read_b64_tr_b16 v[160:161], v29 offset:0
    v_mfma_f32_16x16x32_bf16 v[56:59], v[152:155], v[84:87], v[56:59]
    buffer_load_dwordx4 v20, s[12:15], s54 offen lds
    v_mfma_f32_16x16x32_bf16 v[96:99], v[152:155], v[88:91], v[96:99]
    s_add_u32 m0, s42, 50176
    ds_read_b64_tr_b16 v[162:163], v29 offset:512
    v_mfma_f32_16x16x32_bf16 v[60:63], v[156:159], v[80:83], v[60:63]
    ds_read_b64_tr_b16 v[164:165], v30 offset:0
    v_mfma_f32_16x16x32_bf16 v[64:67], v[156:159], v[84:87], v[64:67]
    buffer_load_dwordx4 v21, s[12:15], s54 offen lds
    v_mfma_f32_16x16x32_bf16 v[118:121], v[156:159], v[88:91], v[118:121]
    s_add_u32 m0, s42, 57344
    ds_read_b64_tr_b16 v[166:167], v30 offset:512
    v_mfma_f32_16x16x32_bf16 v[100:103], v[148:151], v[32:35], v[100:103]
    buffer_load_dwordx4 v22, s[12:15], s54 offen lds
    v_mfma_f32_16x16x32_bf16 v[104:107], v[152:155], v[32:35], v[104:107]
    ds_read_b64_tr_b16 v[168:169], v31 offset:0
    v_mfma_f32_16x16x32_bf16 v[108:111], v[156:159], v[32:35], v[108:111]
    ds_read_b64_tr_b16 v[170:171], v31 offset:512
    s_waitcnt lgkmcnt(4)
    v_mfma_f32_16x16x32_bf16 v[44:47], v[160:163], v[68:71], v[44:47]
    s_add_u32 m0, s42, 58368
    ds_read_b128 v[80:83], v5 offset:16384
    v_mfma_f32_16x16x32_bf16 v[48:51], v[160:163], v[72:75], v[48:51]
    ds_read_b128 v[84:87], v5 offset:18432
    v_mfma_f32_16x16x32_bf16 v[92:95], v[160:163], v[76:79], v[92:95]
    ds_read_b128 v[88:91], v5 offset:57344
    s_waitcnt lgkmcnt(5)
    v_mfma_f32_16x16x32_bf16 v[52:55], v[164:167], v[68:71], v[52:55]
    ds_read_b64_tr_b16 v[172:173], v29 offset:4096
    v_mfma_f32_16x16x32_bf16 v[56:59], v[164:167], v[72:75], v[56:59]
    ds_read_b64_tr_b16 v[174:175], v29 offset:4608
    v_mfma_f32_16x16x32_bf16 v[96:99], v[164:167], v[76:79], v[96:99]
    ds_read_b64_tr_b16 v[176:177], v30 offset:4096
    s_waitcnt lgkmcnt(6)
    v_mfma_f32_16x16x32_bf16 v[60:63], v[168:171], v[68:71], v[60:63]
    ds_read_b64_tr_b16 v[178:179], v30 offset:4608
    v_mfma_f32_16x16x32_bf16 v[64:67], v[168:171], v[72:75], v[64:67]
    ds_read_b64_tr_b16 v[180:181], v31 offset:4096
    v_mfma_f32_16x16x32_bf16 v[118:121], v[168:171], v[76:79], v[118:121]
    ds_read_b64_tr_b16 v[182:183], v31 offset:4608
    v_mfma_f32_16x16x32_bf16 v[100:103], v[160:163], v[32:35], v[100:103]
    buffer_load_dwordx4 v23, s[12:15], s54 offen lds
    v_mfma_f32_16x16x32_bf16 v[104:107], v[164:167], v[32:35], v[104:107]
    s_add_u32 m0, s42, 65536
    s_nop 0
    buffer_load_dwordx4 v24, s[12:15], s54 offen lds
    v_mfma_f32_16x16x32_bf16 v[108:111], v[168:171], v[32:35], v[108:111]
    s_add_u32 m0, s42, 66560
    s_nop 0
    buffer_load_dwordx4 v25, s[12:15], s54 offen lds
    s_add_u32 s54, s54, 393216
    s_waitcnt vmcnt(15) lgkmcnt(0)
    v_readfirstlane_b32 s37, v38
    s_nop 0
    s_cmp_lg_u32 s37, s3
    s_cbranch_scc1 L_vspin5
L_vback6:
    v_cmp_eq_u32 vcc, v36, v37
    s_cbranch_vccnz L_spin1
L_back2:
    s_barrier
    v_mfma_f32_16x16x32_bf16 v[44:47], v[172:175], v[80:83], v[44:47]
    s_lshl_b32 s53, s33, 15
    s_sub_u32 s53, 0x5418000, s53
    s_add_u32 m0, s52, 94208
    ds_read_b128 v[68:71], v4 offset:20480
    v_mfma_f32_16x16x32_bf16 v[48:51], v[172:175], v[84:87], v[48:51]
    ds_read_b128 v[72:75], v4 offset:22528
    v_mfma_f32_16x16x32_bf16 v[92:95], v[172:175], v[88:91], v[92:95]
    buffer_load_dwordx4 v1, s[16:19], s53 offen sc1 lds
    v_mfma_f32_16x16x32_bf16 v[52:55], v[176:179], v[80:83], v[52:55]
    ds_read_b128 v[76:79], v4 offset:59392
    v_mfma_f32_16x16x32_bf16 v[56:59], v[176:179], v[84:87], v[56:59]
    ds_read_b64_tr_b16 v[184:185], v26 offset:0
    v_mfma_f32_16x16x32_bf16 v[96:99], v[176:179], v[88:91], v[96:99]
    ds_read_b64_tr_b16 v[186:187], v26 offset:512
    v_mfma_f32_16x16x32_bf16 v[60:63], v[180:183], v[80:83], v[60:63]
    ds_read_b64_tr_b16 v[188:189], v27 offset:0
    v_mfma_f32_16x16x32_bf16 v[64:67], v[180:183], v[84:87], v[64:67]
    ds_read_b64_tr_b16 v[190:191], v27 offset:512
    v_mfma_f32_16x16x32_bf16 v[118:121], v[180:183], v[88:91], v[118:121]
    ds_read_b64_tr_b16 v[192:193], v28 offset:0
    v_mfma_f32_16x16x32_bf16 v[100:103], v[172:175], v[32:35], v[100:103]
    ds_read_b64_tr_b16 v[194:195], v28 offset:512
    v_mfma_f32_16x16x32_bf16 v[104:107], v[176:179], v[32:35], v[104:107]
    v_mfma_f32_16x16x32_bf16 v[108:111], v[180:183], v[32:35], v[108:111]
    s_waitcnt lgkmcnt(4)
    v_mfma_f32_16x16x32_bf16 v[44:47], v[184:187], v[68:71], v[44:47]
    s_add_u32 m0, s52, 92160
    ds_read_b128 v[80:83], v5 offset:20480
    v_mfma_f32_16x16x32_bf16 v[48:51], v[184:187], v[72:75], v[48:51]
    ds_read_b128 v[84:87], v5 offset:22528
    v_mfma_f32_16x16x32_bf16 v[92:95], v[184:187], v[76:79], v[92:95]
    ds_read_b128 v[88:91], v5 offset:59392
    s_waitcnt lgkmcnt(5)
    v_mfma_f32_16x16x32_bf16 v[52:55], v[188:191], v[68:71], v[52:55]
    ds_read_b64_tr_b16 v[196:197], v26 offset:4096
    v_mfma_f32_16x16x32_bf16 v[56:59], v[188:191], v[72:75], v[56:59]
    ds_read_b64_tr_b16 v[198:199], v26 offset:4608
    v_mfma_f32_16x16x32_bf16 v[96:99], v[188:191], v[76:79], v[96:99]
    ds_read_b64_tr_b16 v[200:201], v27 offset:4096
    s_waitcnt lgkmcnt(6)
    v_mfma_f32_16x16x32_bf16 v[60:63], v[192:195], v[68:71], v[60:63]
    ds_read_b64_tr_b16 v[202:203], v27 offset:4608
    v_mfma_f32_16x16x32_bf16 v[64:67], v[192:195], v[72:75], v[64:67]
    ds_read_b64_tr_b16 v[204:205], v28 offset:4096
    v_mfma_f32_16x16x32_bf16 v[118:121], v[192:195], v[76:79], v[118:121]
    ds_read_b64_tr_b16 v[206:207], v28 offset:4608
    v_mfma_f32_16x16x32_bf16 v[100:103], v[184:187], v[32:35], v[100:103]
    v_mfma_f32_16x16x32_bf16 v[104:107], v[188:191], v[32:35], v[104:107]
    buffer_load_dwordx4 v1, s[16:19], s46 offen sc1 lds
    v_mfma_f32_16x16x32_bf16 v[108:111], v[192:195], v[32:35], v[108:111]
    s_cmp_eq_u32 s36, s97
    s_cselect_b32 s47, 30, -2
    s_cselect_b64 s[8:9], s[88:89], s[8:9]
    s_cselect_b32 s55, 0x543fc00, s55
    s_add_u32 s50, s50, s47
    s_max_i32 s47, s50, 0
    s_min_i32 s47, s47, s96
    s_lshl_b32 s41, s47, 15
    s_lshl_b32 s46, s47, 10
    s_sub_u32 s46, s55, s46
    s_add_u32 m0, s52, 90112
    s_nop 0
    buffer_load_dwordx4 v1, s[16:19], s46 offen sc1 lds
    s_add_u32 s91, s91, 65536
    s_waitcnt vmcnt(10) lgkmcnt(0)
    s_barrier
    v_mfma_f32_16x16x32_bf16 v[44:47], v[196:199], v[80:83], v[44:47]
    ds_read_b128 v[68:71], v4 offset:24576
    ds_read_b128 v[72:75], v4 offset:26624
    v_mfma_f32_16x16x32_bf16 v[48:51], v[196:199], v[84:87], v[48:51]
    ds_read_b128 v[76:79], v4 offset:61440
    v_mfma_f32_16x16x32_bf16 v[92:95], v[196:199], v[88:91], v[92:95]
    buffer_load_dword v117, v116, s[20:23], 0 offen sc1
    v_mfma_f32_16x16x32_bf16 v[52:55], v[200:203], v[80:83], v[52:55]
    s_add_u32 m0, s43, 0
    ds_read_b64_tr_b16 v[208:209], v26 offset:24576
    v_mfma_f32_16x16x32_bf16 v[56:59], v[200:203], v[84:87], v[56:59]
    buffer_load_dwordx4 v6, s[8:11], s41 offen offset:0 sc1 lds
    v_mfma_f32_16x16x32_bf16 v[96:99], v[200:203], v[88:91], v[96:99]
    s_add_u32 m0, s43, 3968
    ds_read_b64_tr_b16 v[210:211], v26 offset:25088
    v_mfma_f32_16x16x32_bf16 v[60:63], v[204:207], v[80:83], v[60:63]
    ds_read_b64_tr_b16 v[212:213], v27 offset:24576
    v_mfma_f32_16x16x32_bf16 v[64:67], v[204:207], v[84:87], v[64:67]
    buffer_load_dwordx4 v6, s[8:11], s41 offen offset:128 sc1 lds
    v_mfma_f32_16x16x32_bf16 v[118:121], v[204:207], v[88:91], v[118:121]
    s_add_u32 m0, s43, 7936
    ds_read_b64_tr_b16 v[214:215], v27 offset:25088
    v_mfma_f32_16x16x32_bf16 v[100:103], v[196:199], v[32:35], v[100:103]
    buffer_load_dwordx4 v6, s[8:11], s41 offen offset:256 sc1 lds
    v_mfma_f32_16x16x32_bf16 v[104:107], v[200:203], v[32:35], v[104:107]
    ds_read_b64_tr_b16 v[216:217], v28 offset:24576
    v_mfma_f32_16x16x32_bf16 v[108:111], v[204:207], v[32:35], v[108:111]
    ds_read_b64_tr_b16 v[218:219], v28 offset:25088
    s_waitcnt lgkmcnt(4)
    v_mfma_f32_16x16x32_bf16 v[44:47], v[208:211], v[68:71], v[44:47]
    s_add_u32 m0, s43, 11904
    ds_read_b128 v[80:83], v5 offset:24576
    v_mfma_f32_16x16x32_bf16 v[48:51], v[208:211], v[72:75], v[48:51]
    ds_read_b128 v[84:87], v5 offset:26624
    v_mfma_f32_16x16x32_bf16 v[92:95], v[208:211], v[76:79], v[92:95]
    ds_read_b128 v[88:91], v5 offset:61440
    s_waitcnt lgkmcnt(5)
    v_mfma_f32_16x16x32_bf16 v[52:55], v[212:215], v[68:71], v[52:55]
    ds_read_b64_tr_b16 v[220:221], v26 offset:28672
    v_mfma_f32_16x16x32_bf16 v[56:59], v[212:215], v[72:75], v[56:59]
    ds_read_b64_tr_b16 v[222:223], v26 offset:29184
    v_mfma_f32_16x16x32_bf16 v[96:99], v[212:215], v[76:79], v[96:99]
    ds_read_b64_tr_b16 v[224:225], v27 offset:28672
    s_waitcnt lgkmcnt(6)
    v_mfma_f32_16x16x32_bf16 v[60:63], v[216:219], v[68:71], v[60:63]
    ds_read_b64_tr_b16 v[226:227], v27 offset:29184
    v_mfma_f32_16x16x32_bf16 v[64:67], v[216:219], v[72:75], v[64:67]
    ds_read_b64_tr_b16 v[228:229], v28 offset:28672
    v_mfma_f32_16x16x32_bf16 v[118:121], v[216:219], v[76:79], v[118:121]
    ds_read_b64_tr_b16 v[230:231], v28 offset:29184
    v_mfma_f32_16x16x32_bf16 v[100:103], v[208:211], v[32:35], v[100:103]
    buffer_load_dwordx4 v6, s[8:11], s41 offen offset:384 sc1 lds
    v_mfma_f32_16x16x32_bf16 v[104:107], v[212:215], v[32:35], v[104:107]
    s_add_u32 m0, s43, 15872
    s_nop 0
    buffer_load_dwordx4 v6, s[8:11], s41 offen offset:512 sc1 lds
    v_mfma_f32_16x16x32_bf16 v[108:111], v[216:219], v[32:35], v[108:111]
    s_add_u32 m0, s43, 19840
    s_nop 0
    buffer_load_dwordx4 v6, s[8:11], s41 offen offset:640 sc1 lds
    s_waitcnt vmcnt(8) lgkmcnt(0)
    s_barrier
    v_mfma_f32_16x16x32_bf16 v[44:47], v[220:223], v[80:83], v[44:47]
    ds_read_b64 v[20:21], v13 offset:4096
    s_add_u32 m0, s43, 23808
    v_mfma_f32_16x16x32_bf16 v[48:51], v[220:223], v[84:87], v[48:51]
    ds_read_b64 v[22:23], v13 offset:4224
    buffer_load_dwordx4 v6, s[8:11], s41 offen offset:768 sc1 lds
    v_mfma_f32_16x16x32_bf16 v[92:95], v[220:223], v[88:91], v[92:95]
    ds_read_b64 v[24:25], v13 offset:4352
    s_add_u32 m0, s43, 27776
    v_mfma_f32_16x16x32_bf16 v[52:55], v[224:227], v[80:83], v[52:55]
    ds_read_b64 v[36:37], v13 offset:4480
    buffer_load_dwordx4 v6, s[8:11], s41 offen offset:896 sc1 lds
    v_mfma_f32_16x16x32_bf16 v[56:59], v[224:227], v[84:87], v[56:59]
    ds_read_b128 v[68:71], v4 offset:28672
    s_add_u32 m0, s43, 31744
    v_mfma_f32_16x16x32_bf16 v[96:99], v[224:227], v[88:91], v[96:99]
    ds_read_b128 v[72:75], v4 offset:30720
    buffer_load_dwordx4 v6, s[8:11], s41 offen offset:1024 sc1 lds
    v_mfma_f32_16x16x32_bf16 v[60:63], v[228:231], v[80:83], v[60:63]
    ds_read_b128 v[76:79], v4 offset:63488
    v_mfma_f32_16x16x32_bf16 v[64:67], v[228:231], v[84:87], v[64:67]
    ds_read_b64_tr_b16 v[232:233], v26 offset:49152
    v_mfma_f32_16x16x32_bf16 v[118:121], v[228:231], v[88:91], v[118:121]
    ds_read_b64_tr_b16 v[234:235], v26 offset:49664
    v_mfma_f32_16x16x32_bf16 v[100:103], v[220:223], v[32:35], v[100:103]
    ds_read_b64_tr_b16 v[236:237], v27 offset:49152
    v_mfma_f32_16x16x32_bf16 v[104:107], v[224:227], v[32:35], v[104:107]
    ds_read_b64_tr_b16 v[238:239], v27 offset:49664
    v_mfma_f32_16x16x32_bf16 v[108:111], v[228:231], v[32:35], v[108:111]
    ds_read_b64_tr_b16 v[240:241], v28 offset:49152
    ds_read_b64_tr_b16 v[242:243], v28 offset:49664
    s_waitcnt lgkmcnt(0)
    v_mfma_f32_16x16x32_bf16 v[44:47], v[232:235], v[68:71], v[44:47]
    ds_read_b64 v[30:31], v13 offset:2048
    s_add_u32 m0, s43, 35712
    v_add_f32 v42, v24, v36
    v_add_f32 v43, v25, v37
    v_mfma_f32_16x16x32_bf16 v[48:51], v[232:235], v[72:75], v[48:51]
    ds_read_b64 v[112:113], v13 offset:2176
    buffer_load_dwordx4 v6, s[8:11], s41 offen offset:1152 sc1 lds
    v_add_f32 v20, v20, v22
    v_add_f32 v21, v21, v23
    v_mfma_f32_16x16x32_bf16 v[92:95], v[232:235], v[76:79], v[92:95]
    ds_read_b64 v[114:115], v13 offset:2304
    s_add_u32 m0, s43, 39680
    v_add_f32 v20, v20, v42
    v_add_f32 v21, v21, v43
    v_mfma_f32_16x16x32_bf16 v[52:55], v[236:239], v[68:71], v[52:55]
    ds_read_b64 v[122:123], v13 offset:2432
    buffer_load_dwordx4 v6, s[8:11], s41 offen offset:1280 sc1 lds
    v_mov_b32 v42, v20
    v_mov_b32 v43, v21
    v_mfma_f32_16x16x32_bf16 v[56:59], v[236:239], v[72:75], v[56:59]
    ds_read_b128 v[80:83], v5 offset:28672
    s_add_u32 m0, s43, 43648
    v_permlane32_swap_b32 v20, v42
    v_permlane32_swap_b32 v21, v43
    v_mfma_f32_16x16x32_bf16 v[96:99], v[236:239], v[76:79], v[96:99]
    ds_read_b128 v[84:87], v5 offset:30720
    buffer_load_dwordx4 v6, s[8:11], s41 offen offset:1408 sc1 lds
    v_add_f32 v20, v20, v42
    v_add_f32 v21, v21, v43
    v_mfma_f32_16x16x32_bf16 v[60:63], v[240:243], v[68:71], v[60:63]
    ds_read_b128 v[88:91], v5 offset:63488
    v_mul_f32 v38, 0xba800000, v20
    v_mul_f32 v21, 0x3a800000, v21
    v_mfma_f32_16x16x32_bf16 v[64:67], v[240:243], v[72:75], v[64:67]
    ds_read_b64_tr_b16 v[244:245], v26 offset:53248
    v_fma_f32 v21, -v38, v38, v21
    v_mov_b32 v39, v38
    v_mfma_f32_16x16x32_bf16 v[118:121], v[240:243], v[76:79], v[118:121]
    ds_read_b64_tr_b16 v[246:247], v26 offset:53760
    v_max_f32 v21, 0, v21
    v_add_f32 v21, 0x3727c5ac, v21
    v_mfma_f32_16x16x32_bf16 v[100:103], v[232:235], v[32:35], v[100:103]
    ds_read_b64_tr_b16 v[248:249], v27 offset:53248
    v_rsq_f32 v40, v21
    v_permlane16_swap_b32 v38, v39
    v_mfma_f32_16x16x32_bf16 v[104:107], v[236:239], v[32:35], v[104:107]
    ds_read_b64_tr_b16 v[250:251], v27 offset:53760
    v_mov_b32 v41, v40
    s_nop 1
    v_permlane16_swap_b32 v40, v41
    v_mfma_f32_16x16x32_bf16 v[108:111], v[240:243], v[32:35], v[108:111]
    ds_read_b64_tr_b16 v[252:253], v28 offset:53248
    ds_read_b64_tr_b16 v[254:255], v28 offset:53760
    s_waitcnt vmcnt(12) lgkmcnt(0)
    v_cmp_eq_u32 vcc, v116, v117
    s_cbranch_vccnz L_spin3
L_back4:
    s_barrier
    v_mfma_f32_16x16x32_bf16 v[44:47], v[244:247], v[80:83], v[44:47]
    s_add_u32 m0, s43, 47616
    v_add_f32 v29, v114, v122
    v_add_f32 v19, v115, v123
    v_mfma_f32_16x16x32_bf16 v[48:51], v[244:247], v[84:87], v[48:51]
    buffer_load_dwordx4 v6, s[8:11], s41 offen offset:1536 sc1 lds
    v_add_f32 v30, v30, v112
    v_add_f32 v31, v31, v113
    v_mfma_f32_16x16x32_bf16 v[92:95], v[244:247], v[88:91], v[92:95]
    s_add_u32 m0, s43, 51584
    v_add_f32 v30, v30, v29
    v_add_f32 v31, v31, v19
    v_mfma_f32_16x16x32_bf16 v[52:55], v[248:251], v[80:83], v[52:55]
    buffer_load_dwordx4 v6, s[8:11], s41 offen offset:1664 sc1 lds
    v_mov_b32 v29, v30
    v_mov_b32 v19, v31
    v_mfma_f32_16x16x32_bf16 v[56:59], v[248:251], v[84:87], v[56:59]
    s_add_u32 m0, s43, 55552
    v_permlane32_swap_b32 v30, v29
    v_permlane32_swap_b32 v31, v19
    v_mfma_f32_16x16x32_bf16 v[96:99], v[248:251], v[88:91], v[96:99]
    buffer_load_dwordx4 v6, s[8:11], s41 offen offset:1792 sc1 lds
    v_add_f32 v30, v30, v29
    v_add_f32 v31, v31, v19
    v_mfma_f32_16x16x32_bf16 v[60:63], v[252:255], v[80:83], v[60:63]
    s_add_u32 m0, s43, 59520
    v_mul_f32 v112, 0xba800000, v30
    v_mul_f32 v31, 0x3a800000, v31
    v_mfma_f32_16x16x32_bf16 v[64:67], v[252:255], v[84:87], v[64:67]
    buffer_load_dwordx4 v6, s[8:11], s41 offen offset:1920 sc1 lds
    v_fma_f32 v31, -v112, v112, v31
    v_mov_b32 v113, v112
    v_mfma_f32_16x16x32_bf16 v[118:121], v[252:255], v[88:91], v[118:121]
    s_add_u32 s91, s91, 65536
    v_max_f32 v31, 0, v31
    v_add_f32 v31, 0x3727c5ac, v31
    v_mfma_f32_16x16x32_bf16 v[100:103], v[244:247], v[32:35], v[100:103]
    v_rsq_f32 v114, v31
    v_permlane16_swap_b32 v112, v113
    v_mfma_f32_16x16x32_bf16 v[104:107], v[248:251], v[32:35], v[104:107]
    v_mov_b32 v115, v114
    s_nop 1
    v_permlane16_swap_b32 v114, v115
    v_mfma_f32_16x16x32_bf16 v[108:111], v[252:255], v[32:35], v[108:111]
    s_mov_b32 s36, 0
    v_mov_b32 v116, 0
    v_mov_b32 v117, v11
    s_cmp_eq_u32 s36, s97
    s_cselect_b32 s47, 30, -2
    s_cselect_b64 s[8:9], s[88:89], s[8:9]
    s_cselect_b32 s55, 0x543fc00, s55
    s_add_u32 s50, s50, s47
    s_max_i32 s47, s50, 0
    s_min_i32 s47, s47, s96
    s_lshl_b32 s41, s47, 15
    s_lshl_b32 s46, s47, 10
    s_sub_u32 s46, s55, s46
    s_add_u32 s90, s90, 0x10000
    s_and_b32 s44, s90, 0xffffffff
    s_bitcmp1_b32 s26, s36
    s_cselect_b64 s[62:63], 0, -1
    v_fmac_f32 v92, v38, v100
    v_fmac_f32 v93, v38, v101
    v_fmac_f32 v94, v38, v102
    v_fmac_f32 v95, v38, v103
    v_mul_f32 v92, v92, v40
    v_mul_f32 v93, v93, v40
    v_mul_f32 v94, v94, v40
    v_mul_f32 v95, v95, v40
    v_cvt_pk_bf16_f32 v92, v92, v93
    v_cvt_pk_bf16_f32 v93, v94, v95
    ds_write_b64 v7, v[92:93] offset:6144
    v_fmac_f32 v96, v38, v104
    v_fmac_f32 v97, v38, v105
    v_fmac_f32 v98, v38, v106
    v_fmac_f32 v99, v38, v107
    v_mul_f32 v96, v96, v40
    v_mul_f32 v97, v97, v40
    v_mul_f32 v98, v98, v40
    v_mul_f32 v99, v99, v40
    v_cvt_pk_bf16_f32 v96, v96, v97
    v_cvt_pk_bf16_f32 v97, v98, v99
    ds_write_b64 v7, v[96:97] offset:7168
    v_fmac_f32 v118, v38, v108
    v_fmac_f32 v119, v38, v109
    v_fmac_f32 v120, v38, v110
    v_fmac_f32 v121, v38, v111
    v_mul_f32 v118, v118, v40
    v_mul_f32 v119, v119, v40
    v_mul_f32 v120, v120, v40
    v_mul_f32 v121, v121, v40
    v_cvt_pk_bf16_f32 v118, v118, v119
    v_cvt_pk_bf16_f32 v119, v120, v121
    ds_write_b64 v8, v[118:119] offset:8192
    v_fmac_f32 v44, v112, v100
    v_fmac_f32 v45, v112, v101
    v_fmac_f32 v46, v112, v102
    v_fmac_f32 v47, v112, v103
    v_fmac_f32 v48, v113, v100
    v_fmac_f32 v49, v113, v101
    v_fmac_f32 v50, v113, v102
    v_fmac_f32 v51, v113, v103
    v_fmac_f32 v52, v112, v104
    v_fmac_f32 v53, v112, v105
    v_fmac_f32 v54, v112, v106
    v_fmac_f32 v55, v112, v107
    v_fmac_f32 v56, v113, v104
    v_fmac_f32 v57, v113, v105
    v_fmac_f32 v58, v113, v106
    v_fmac_f32 v59, v113, v107
    v_fmac_f32 v60, v112, v108
    v_fmac_f32 v61, v112, v109
    v_fmac_f32 v62, v112, v110
    v_fmac_f32 v63, v112, v111
    v_fmac_f32 v64, v113, v108
    v_fmac_f32 v65, v113, v109
    v_fmac_f32 v66, v113, v110
    v_fmac_f32 v67, v113, v111
    s_waitcnt vmcnt(4) lgkmcnt(0)
    s_barrier
    ds_read_b128 v[68:71], v2 offset:0
    ds_read_b128 v[72:75], v2 offset:2048
    ds_read_b128 v[76:79], v3 offset:0
    ds_read_b128 v[80:83], v3 offset:2048
    s_mul_i32 s37, s51, 1024
    s_add_u32 s37, s37, s43
    s_add_u32 s37, s37, 72704
    v_add_u32 v24, s37, v1
    ds_read_b128 v[118:121], v24
    s_waitcnt lgkmcnt(0)
    buffer_store_dwordx4 v[118:121], v1, s[16:19], s25 offen sc1
    s_mov_b32 s36, 1
    s_waitcnt lgkmcnt(0)
    s_nop 7
L_q_b0:
    v_mfma_f32_16x16x32_bf16 v[20:23], a[0:3], v[68:71], 0
    ds_read_b128 v[84:87], v2 offset:4096
    v_mul_f32 v44, v44, v114
    v_mfma_f32_16x16x32_bf16 v[24:27], a[0:3], v[72:75], 0
    v_mul_f32 v45, v45, v114
    v_mul_f32 v46, v46, v114
    v_mfma_f32_16x16x32_bf16 v[32:35], a[4:7], v[72:75], 0
    v_mul_f32 v47, v47, v114
    v_cvt_pk_bf16_f32 v44, v44, v45
    v_mfma_f32_16x16x32_bf16 v[28:31], a[4:7], v[68:71], 0
    ds_read_b128 v[88:91], v2 offset:6144
    v_cvt_pk_bf16_f32 v45, v46, v47
    v_mfma_f32_16x16x32_bf16 v[36:39], a[8:11], v[68:71], 0
    ds_write_b64 v7, v[44:45] offset:12288
    v_mfma_f32_16x16x32_bf16 v[40:43], a[8:11], v[72:75], 0
    s_waitcnt lgkmcnt(3)
    v_mul_f32 v48, v48, v115
    v_mul_f32 v49, v49, v115
    v_mfma_f32_16x16x32_bf16 v[20:23], a[12:15], v[76:79], v[20:23]
    ds_read_b128 v[92:95], v3 offset:4096
    v_mul_f32 v50, v50, v115
    v_mfma_f32_16x16x32_bf16 v[24:27], a[12:15], v[80:83], v[24:27]
    v_mul_f32 v51, v51, v115
    v_cvt_pk_bf16_f32 v48, v48, v49
    v_mfma_f32_16x16x32_bf16 v[32:35], a[16:19], v[80:83], v[32:35]
    v_cvt_pk_bf16_f32 v49, v50, v51
    v_mfma_f32_16x16x32_bf16 v[28:31], a[16:19], v[76:79], v[28:31]
    ds_read_b128 v[96:99], v3 offset:6144
    v_mfma_f32_16x16x32_bf16 v[36:39], a[20:23], v[76:79], v[36:39]
    ds_write_b64 v7, v[48:49] offset:18432
    v_mfma_f32_16x16x32_bf16 v[40:43], a[20:23], v[80:83], v[40:43]
    s_waitcnt lgkmcnt(4)
    v_mul_f32 v52, v52, v114
    v_mul_f32 v53, v53, v114
    v_mfma_f32_16x16x32_bf16 v[20:23], a[24:27], v[84:87], v[20:23]
    ds_read_b128 v[68:71], v2 offset:8192
    v_mul_f32 v54, v54, v114
    v_mfma_f32_16x16x32_bf16 v[24:27], a[24:27], v[88:91], v[24:27]
    v_mul_f32 v55, v55, v114
    v_cvt_pk_bf16_f32 v52, v52, v53
    v_mfma_f32_16x16x32_bf16 v[32:35], a[28:31], v[88:91], v[32:35]
    v_cvt_pk_bf16_f32 v53, v54, v55
    v_mfma_f32_16x16x32_bf16 v[28:31], a[28:31], v[84:87], v[28:31]
    ds_read_b128 v[72:75], v2 offset:10240
    v_mfma_f32_16x16x32_bf16 v[36:39], a[32:35], v[84:87], v[36:39]
    ds_write_b64 v7, v[52:53] offset:13312
    v_mfma_f32_16x16x32_bf16 v[40:43], a[32:35], v[88:91], v[40:43]
    s_waitcnt lgkmcnt(4)
    v_mul_f32 v56, v56, v115
    v_mul_f32 v57, v57, v115
    v_mfma_f32_16x16x32_bf16 v[20:23], a[36:39], v[92:95], v[20:23]
    ds_read_b128 v[76:79], v3 offset:8192
    v_mul_f32 v58, v58, v115
    v_mfma_f32_16x16x32_bf16 v[24:27], a[36:39], v[96:99], v[24:27]
    v_mul_f32 v59, v59, v115
    v_cvt_pk_bf16_f32 v56, v56, v57
    v_mfma_f32_16x16x32_bf16 v[32:35], a[40:43], v[96:99], v[32:35]
    v_cvt_pk_bf16_f32 v57, v58, v59
    v_mfma_f32_16x16x32_bf16 v[28:31], a[40:43], v[92:95], v[28:31]
    ds_read_b128 v[80:83], v3 offset:10240
    v_mfma_f32_16x16x32_bf16 v[36:39], a[44:47], v[92:95], v[36:39]
    ds_write_b64 v7, v[56:57] offset:19456
    v_mfma_f32_16x16x32_bf16 v[40:43], a[44:47], v[96:99], v[40:43]
    s_waitcnt lgkmcnt(4)
    v_mul_f32 v60, v60, v114
    v_mul_f32 v61, v61, v114
    v_mfma_f32_16x16x32_bf16 v[20:23], a[48:51], v[68:71], v[20:23]
    s_waitcnt vmcnt(1)
    ds_read_b128 v[84:87], v2 offset:12288
    v_cmp_ne_u32 vcc, 0, v116
    v_mfma_f32_16x16x32_bf16 v[24:27], a[48:51], v[72:75], v[24:27]
    v_mul_f32 v62, v62, v114
    v_mul_f32 v63, v63, v114
    v_mfma_f32_16x16x32_bf16 v[32:35], a[52:55], v[72:75], v[32:35]
    s_cbranch_vccnz L_spin7
L_back8:
    v_cvt_pk_bf16_f32 v60, v60, v61
    v_cvt_pk_bf16_f32 v61, v62, v63
    v_mfma_f32_16x16x32_bf16 v[28:31], a[52:55], v[68:71], v[28:31]
    ds_read_b128 v[88:91], v2 offset:14336
    v_mfma_f32_16x16x32_bf16 v[36:39], a[56:59], v[68:71], v[36:39]
    ds_write_b64 v8, v[60:61] offset:14336
    v_mfma_f32_16x16x32_bf16 v[40:43], a[56:59], v[72:75], v[40:43]
    s_waitcnt lgkmcnt(4)
    v_mul_f32 v64, v64, v115
    v_mul_f32 v65, v65, v115
    v_mfma_f32_16x16x32_bf16 v[20:23], a[60:63], v[76:79], v[20:23]
    ds_read_b128 v[92:95], v3 offset:12288
    v_mul_f32 v66, v66, v115
    v_mfma_f32_16x16x32_bf16 v[24:27], a[60:63], v[80:83], v[24:27]
    v_mul_f32 v67, v67, v115
    v_cvt_pk_bf16_f32 v64, v64, v65
    v_mfma_f32_16x16x32_bf16 v[32:35], a[64:67], v[80:83], v[32:35]
    v_cvt_pk_bf16_f32 v65, v66, v67
    v_mfma_f32_16x16x32_bf16 v[28:31], a[64:67], v[76:79], v[28:31]
    ds_read_b128 v[96:99], v3 offset:14336
    v_mfma_f32_16x16x32_bf16 v[36:39], a[68:71], v[76:79], v[36:39]
    ds_write_b64 v8, v[64:65] offset:20480
    v_mfma_f32_16x16x32_bf16 v[40:43], a[68:71], v[80:83], v[40:43]
    s_waitcnt lgkmcnt(4)
    v_mfma_f32_16x16x32_bf16 v[20:23], a[72:75], v[84:87], v[20:23]
    ds_read_b128 v[68:71], v2 offset:16384
    v_mfma_f32_16x16x32_bf16 v[24:27], a[72:75], v[88:91], v[24:27]
    v_mfma_f32_16x16x32_bf16 v[32:35], a[76:79], v[88:91], v[32:35]
    s_waitcnt lgkmcnt(1)
    s_barrier
    v_mfma_f32_16x16x32_bf16 v[28:31], a[76:79], v[84:87], v[28:31]
    ds_read_b128 v[72:75], v2 offset:18432
    v_mfma_f32_16x16x32_bf16 v[36:39], a[80:83], v[84:87], v[36:39]
    ds_read_b128 v[44:47], v9 offset:6144
    v_mfma_f32_16x16x32_bf16 v[40:43], a[80:83], v[88:91], v[40:43]
    s_waitcnt lgkmcnt(4)
    ds_read_b128 v[48:51], v9 offset:13312
    v_mfma_f32_16x16x32_bf16 v[20:23], a[84:87], v[92:95], v[20:23]
    ds_read_b128 v[76:79], v3 offset:16384
    v_mfma_f32_16x16x32_bf16 v[24:27], a[84:87], v[96:99], v[24:27]
    ds_read_b128 v[52:55], v9 offset:7168
    s_add_u32 m0, s43, 98304
    v_mfma_f32_16x16x32_bf16 v[32:35], a[88:91], v[96:99], v[32:35]
    buffer_load_dwordx4 v6, s[8:11], s41 offen offset:0 sc1 lds
    v_mfma_f32_16x16x32_bf16 v[28:31], a[88:91], v[92:95], v[28:31]
    s_add_u32 m0, s43, 102272
    ds_read_b128 v[80:83], v3 offset:18432
    v_mfma_f32_16x16x32_bf16 v[36:39], a[92:95], v[92:95], v[36:39]
    ds_read_b64_tr_b16 v[56:57], v9 offset:14336
    v_mfma_f32_16x16x32_bf16 v[40:43], a[92:95], v[96:99], v[40:43]
    s_waitcnt lgkmcnt(6)
    ds_read_b64_tr_b16 v[58:59], v9 offset:8192
    s_waitcnt lgkmcnt(3)
    v_mfma_f32_16x16x32_bf16 v[20:23], a[96:99], v[68:71], v[20:23]
    ds_read_b128 v[84:87], v2 offset:20480
    v_mfma_f32_16x16x32_bf16 v[64:67], v[48:51], v[44:47], 0
    ds_read_b64_tr_b16 v[60:61], v9 offset:14344
    v_mfma_f32_16x16x32_bf16 v[118:121], v[52:55], v[44:47], 0
    ds_read_b64_tr_b16 v[62:63], v9 offset:8200
    v_mfma_f32_16x16x32_bf16 v[24:27], a[96:99], v[72:75], v[24:27]
    v_mfma_f32_16x16x32_bf16 v[32:35], a[100:103], v[72:75], v[32:35]
    buffer_load_dwordx4 v6, s[8:11], s41 offen offset:128 sc1 lds
    v_mfma_f32_16x16x32_bf16 v[28:31], a[100:103], v[68:71], v[28:31]
    s_add_u32 m0, s43, 106240
    ds_read_b128 v[88:91], v2 offset:22528
    v_cndmask_b32 v64, v64, v65, s[56:57]
    v_mfma_f32_16x16x32_bf16 v[36:39], a[104:107], v[68:71], v[36:39]
    v_cndmask_b32 v66, v66, v67, s[56:57]
    v_cndmask_b32 v118, v118, v119, s[56:57]
    v_mfma_f32_16x16x32_bf16 v[40:43], a[104:107], v[72:75], v[40:43]
    s_waitcnt lgkmcnt(6)
    v_cndmask_b32 v120, v120, v121, s[56:57]
    v_cndmask_b32 v64, v18, v64, s[62:63]
    v_mfma_f32_16x16x32_bf16 v[20:23], a[108:111], v[76:79], v[20:23]
    ds_read_b128 v[92:95], v3 offset:20480
    v_cndmask_b32 v66, v18, v66, s[62:63]
    v_mfma_f32_16x16x32_bf16 v[24:27], a[108:111], v[80:83], v[24:27]
    v_cndmask_b32 v46, v64, v118, s[58:59]
    v_cndmask_b32 v47, v66, v120, s[60:61]
    v_mfma_f32_16x16x32_bf16 v[32:35], a[112:115], v[80:83], v[32:35]
    buffer_load_dwordx4 v6, s[8:11], s41 offen offset:256 sc1 lds
    v_mfma_f32_16x16x32_bf16 v[28:31], a[112:115], v[76:79], v[28:31]
    s_add_u32 m0, s43, 110208
    ds_read_b128 v[96:99], v3 offset:22528
    v_max_f32 v44, v46, v47
    v_mfma_f32_16x16x32_bf16 v[36:39], a[116:119], v[76:79], v[36:39]
    v_mov_b32 v45, v44
    v_mfma_f32_16x16x32_bf16 v[40:43], a[116:119], v[80:83], v[40:43]
    s_waitcnt lgkmcnt(2)
    v_permlane16_swap_b32 v44, v45
    v_mfma_f32_16x16x32_bf16 v[20:23], a[120:123], v[84:87], v[20:23]
    ds_read_b128 v[68:71], v2 offset:24576
    v_max_f32 v44, v44, v45
    v_mfma_f32_16x16x32_bf16 v[24:27], a[120:123], v[88:91], v[24:27]
    v_mov_b32 v45, v44
    v_mfma_f32_16x16x32_bf16 v[32:35], a[124:127], v[88:91], v[32:35]
    buffer_load_dwordx4 v6, s[8:11], s41 offen offset:384 sc1 lds
    v_mfma_f32_16x16x32_bf16 v[28:31], a[124:127], v[84:87], v[28:31]
    s_add_u32 m0, s43, 114176
    ds_read_b128 v[72:75], v2 offset:26624
    v_mfma_f32_16x16x32_bf16 v[36:39], a[128:131], v[84:87], v[36:39]
    v_permlane32_swap_b32 v44, v45
    v_mfma_f32_16x16x32_bf16 v[40:43], a[128:131], v[88:91], v[40:43]
    s_waitcnt lgkmcnt(2)
    v_max_f32 v44, v44, v45
    v_mul_f32 v44, s86, v44
    v_mfma_f32_16x16x32_bf16 v[20:23], a[132:135], v[92:95], v[20:23]
    ds_read_b128 v[76:79], v3 offset:24576
    v_fma_f32 v46, v46, s86, -v44
    v_mfma_f32_16x16x32_bf16 v[24:27], a[132:135], v[96:99], v[24:27]
    v_fma_f32 v47, v47, s86, -v44
    v_mfma_f32_16x16x32_bf16 v[32:35], a[136:139], v[96:99], v[32:35]
    buffer_load_dwordx4 v6, s[8:11], s41 offen offset:512 sc1 lds
    v_mfma_f32_16x16x32_bf16 v[28:31], a[136:139], v[92:95], v[28:31]
    s_add_u32 m0, s43, 118144
    ds_read_b128 v[80:83], v3 offset:26624
    v_mfma_f32_16x16x32_bf16 v[36:39], a[140:143], v[92:95], v[36:39]
    v_exp_f32 v46, v46
    v_mfma_f32_16x16x32_bf16 v[40:43], a[140:143], v[96:99], v[40:43]
    s_waitcnt lgkmcnt(2)
    v_exp_f32 v47, v47
    v_mfma_f32_16x16x32_bf16 v[20:23], a[144:147], v[68:71], v[20:23]
    ds_read_b128 v[84:87], v2 offset:28672
    v_cvt_pk_bf16_f32 v52, v46, v47
    v_mfma_f32_16x16x32_bf16 v[24:27], a[144:147], v[72:75], v[24:27]
    v_perm_b32 v48, v52, v52, v14
    v_perm_b32 v49, v52, v52, v15
    v_mfma_f32_16x16x32_bf16 v[32:35], a[148:151], v[72:75], v[32:35]
    buffer_load_dwordx4 v6, s[8:11], s41 offen offset:640 sc1 lds
    v_mfma_f32_16x16x32_bf16 v[28:31], a[148:151], v[68:71], v[28:31]
    s_add_u32 m0, s43, 122112
    ds_read_b128 v[88:91], v2 offset:30720
    v_perm_b32 v50, v52, v52, v16
    v_mfma_f32_16x16x32_bf16 v[36:39], a[152:155], v[68:71], v[36:39]
    v_perm_b32 v51, v52, v52, v17
    v_add_f32 v44, v46, v47
    v_mfma_f32_16x16x32_bf16 v[40:43], a[152:155], v[72:75], v[40:43]
    s_waitcnt lgkmcnt(2)
    v_mov_b32 v45, v44
    s_waitcnt lgkmcnt(9)
    v_mfma_f32_16x16x32_bf16 v[20:23], a[156:159], v[76:79], v[20:23]
    ds_read_b128 v[92:95], v3 offset:28672
    v_mfma_f32_16x16x32_bf16 v[64:67], v[56:59], v[48:51], 0
    v_mfma_f32_16x16x32_bf16 v[118:121], v[60:63], v[48:51], 0
    v_permlane16_swap_b32 v44, v45
    v_mfma_f32_16x16x32_bf16 v[24:27], a[156:159], v[80:83], v[24:27]
    v_add_f32 v44, v44, v45
    v_mov_b32 v45, v44
    v_mfma_f32_16x16x32_bf16 v[32:35], a[160:163], v[80:83], v[32:35]
    buffer_load_dwordx4 v6, s[8:11], s41 offen offset:768 sc1 lds
    v_mfma_f32_16x16x32_bf16 v[28:31], a[160:163], v[76:79], v[28:31]
    s_add_u32 m0, s43, 126080
    ds_read_b128 v[96:99], v3 offset:30720
    v_mfma_f32_16x16x32_bf16 v[36:39], a[164:167], v[76:79], v[36:39]
    v_permlane32_swap_b32 v44, v45
    v_mfma_f32_16x16x32_bf16 v[40:43], a[164:167], v[80:83], v[40:43]
    s_waitcnt lgkmcnt(2)
    v_add_f32 v44, v44, v45
    v_mfma_f32_16x16x32_bf16 v[20:23], a[168:171], v[84:87], v[20:23]
    ds_read_b128 v[68:71], v2 offset:32768
    v_mfma_f32_16x16x32_bf16 v[24:27], a[168:171], v[88:91], v[24:27]
    v_rcp_f32 v44, v44
    v_mfma_f32_16x16x32_bf16 v[32:35], a[172:175], v[88:91], v[32:35]
    buffer_load_dwordx4 v6, s[8:11], s41 offen offset:896 sc1 lds
    v_mfma_f32_16x16x32_bf16 v[28:31], a[172:175], v[84:87], v[28:31]
    s_add_u32 m0, s43, 130048
    ds_read_b128 v[72:75], v2 offset:34816
    v_mul_f32 v64, v64, v44
    v_mfma_f32_16x16x32_bf16 v[36:39], a[176:179], v[84:87], v[36:39]
    v_mul_f32 v65, v65, v44
    v_mul_f32 v66, v66, v44
    v_mfma_f32_16x16x32_bf16 v[40:43], a[176:179], v[88:91], v[40:43]
    s_waitcnt lgkmcnt(2)
    v_mul_f32 v67, v67, v44
    v_cvt_pk_bf16_f32 v52, v64, v65
    v_mfma_f32_16x16x32_bf16 v[20:23], a[180:183], v[92:95], v[20:23]
    ds_read_b128 v[76:79], v3 offset:32768
    v_cvt_pk_bf16_f32 v53, v66, v67
    v_mfma_f32_16x16x32_bf16 v[24:27], a[180:183], v[96:99], v[24:27]
    v_mul_f32 v118, v118, v44
    v_mul_f32 v119, v119, v44
    v_mfma_f32_16x16x32_bf16 v[32:35], a[184:187], v[96:99], v[32:35]
    buffer_load_dwordx4 v6, s[8:11], s41 offen offset:1024 sc1 lds
    v_mfma_f32_16x16x32_bf16 v[28:31], a[184:187], v[92:95], v[28:31]
    s_add_u32 m0, s43, 134016
    ds_read_b128 v[80:83], v3 offset:34816
    v_mul_f32 v120, v120, v44
    v_mfma_f32_16x16x32_bf16 v[36:39], a[188:191], v[92:95], v[36:39]
    v_mul_f32 v121, v121, v44
    v_cvt_pk_bf16_f32 v54, v118, v119
    v_mfma_f32_16x16x32_bf16 v[40:43], a[188:191], v[96:99], v[40:43]
    s_waitcnt lgkmcnt(2)
    v_cvt_pk_bf16_f32 v55, v120, v121
    v_mfma_f32_16x16x32_bf16 v[20:23], a[192:195], v[68:71], v[20:23]
    ds_read_b128 v[84:87], v2 offset:36864
    v_mfma_f32_16x16x32_bf16 v[24:27], a[192:195], v[72:75], v[24:27]
    buffer_store_dwordx4 v[52:55], v1, s[16:19], s44 offen sc1
    v_mfma_f32_16x16x32_bf16 v[32:35], a[196:199], v[72:75], v[32:35]
    buffer_load_dwordx4 v6, s[8:11], s41 offen offset:1152 sc1 lds
    v_mfma_f32_16x16x32_bf16 v[28:31], a[196:199], v[68:71], v[28:31]
    s_add_u32 m0, s43, 137984
    ds_read_b128 v[88:91], v2 offset:38912
    s_add_u32 s90, s90, 0x10000
    v_mfma_f32_16x16x32_bf16 v[36:39], a[200:203], v[68:71], v[36:39]
    s_and_b32 s44, s90, 0xffffffff
    ds_read_b64 v[56:57], v13 offset:0
    s_bitcmp1_b32 s26, s36
    v_mfma_f32_16x16x32_bf16 v[40:43], a[200:203], v[72:75], v[40:43]
    s_waitcnt lgkmcnt(3)
    ds_read_b64 v[58:59], v13 offset:128
    s_cselect_b64 s[62:63], 0, -1
    v_mfma_f32_16x16x32_bf16 v[20:23], a[204:207], v[76:79], v[20:23]
    s_cmp_eq_u32 s36, 15
    ds_read_b128 v[92:95], v3 offset:36864
    s_cselect_b32 s49, s87, 0
    v_mfma_f32_16x16x32_bf16 v[24:27], a[204:207], v[80:83], v[24:27]
    ds_read_b64 v[60:61], v13 offset:256
    v_add_u32 v9, s49, v9
    v_mfma_f32_16x16x32_bf16 v[32:35], a[208:211], v[80:83], v[32:35]
    buffer_load_dwordx4 v6, s[8:11], s41 offen offset:1280 sc1 lds
    v_mfma_f32_16x16x32_bf16 v[28:31], a[208:211], v[76:79], v[28:31]
    s_add_u32 m0, s43, 141952
    ds_read_b128 v[96:99], v3 offset:38912
    v_mfma_f32_16x16x32_bf16 v[36:39], a[212:215], v[76:79], v[36:39]
    ds_read_b64 v[62:63], v13 offset:384
    v_mfma_f32_16x16x32_bf16 v[40:43], a[212:215], v[80:83], v[40:43]
    s_waitcnt lgkmcnt(6)
    v_mfma_f32_16x16x32_bf16 v[20:23], a[216:219], v[84:87], v[20:23]
    ds_read_b128 v[68:71], v2 offset:40960
    v_mfma_f32_16x16x32_bf16 v[24:27], a[216:219], v[88:91], v[24:27]
    v_mfma_f32_16x16x32_bf16 v[32:35], a[220:223], v[88:91], v[32:35]
    buffer_load_dwordx4 v6, s[8:11], s41 offen offset:1408 sc1 lds
    v_mfma_f32_16x16x32_bf16 v[28:31], a[220:223], v[84:87], v[28:31]
    s_add_u32 m0, s43, 145920
    ds_read_b128 v[72:75], v2 offset:43008
    s_waitcnt lgkmcnt(2)
    v_mfma_f32_16x16x32_bf16 v[36:39], a[224:227], v[84:87], v[36:39]
    v_add_f32 v64, v60, v62
    v_add_f32 v65, v61, v63
    v_mfma_f32_16x16x32_bf16 v[40:43], a[224:227], v[88:91], v[40:43]
    s_waitcnt lgkmcnt(3)
    v_add_f32 v56, v56, v58
    v_add_f32 v57, v57, v59
    v_mfma_f32_16x16x32_bf16 v[20:23], a[228:231], v[92:95], v[20:23]
    ds_read_b128 v[76:79], v3 offset:40960
    v_add_f32 v56, v56, v64
    v_mfma_f32_16x16x32_bf16 v[24:27], a[228:231], v[96:99], v[24:27]
    v_add_f32 v57, v57, v65
    v_mov_b32 v64, v56
    v_mfma_f32_16x16x32_bf16 v[32:35], a[232:235], v[96:99], v[32:35]
    buffer_load_dwordx4 v6, s[8:11], s41 offen offset:1536 sc1 lds
    v_mfma_f32_16x16x32_bf16 v[28:31], a[232:235], v[92:95], v[28:31]
    s_add_u32 m0, s43, 149888
    ds_read_b128 v[80:83], v3 offset:43008
    v_mov_b32 v65, v57
    v_mfma_f32_16x16x32_bf16 v[36:39], a[236:239], v[92:95], v[36:39]
    v_permlane32_swap_b32 v56, v64
    v_mfma_f32_16x16x32_bf16 v[40:43], a[236:239], v[96:99], v[40:43]
    s_waitcnt lgkmcnt(2)
    v_permlane32_swap_b32 v57, v65
    v_mfma_f32_16x16x32_bf16 v[20:23], a[240:243], v[68:71], v[20:23]
    ds_read_b128 v[84:87], v2 offset:45056
    v_add_f32 v56, v56, v64
    v_mfma_f32_16x16x32_bf16 v[24:27], a[240:243], v[72:75], v[24:27]
    v_add_f32 v57, v57, v65
    v_mul_f32 v112, 0xba800000, v56
    v_mfma_f32_16x16x32_bf16 v[32:35], a[244:247], v[72:75], v[32:35]
    buffer_load_dwordx4 v6, s[8:11], s41 offen offset:1664 sc1 lds
    v_mfma_f32_16x16x32_bf16 v[28:31], a[244:247], v[68:71], v[28:31]
    s_add_u32 m0, s43, 153856
    ds_read_b128 v[88:91], v2 offset:47104
    v_mul_f32 v57, 0x3a800000, v57
    v_mfma_f32_16x16x32_bf16 v[36:39], a[248:251], v[68:71], v[36:39]
    v_fma_f32 v57, -v112, v112, v57
    v_mov_b32 v113, v112
    v_mfma_f32_16x16x32_bf16 v[40:43], a[248:251], v[72:75], v[40:43]
    s_waitcnt lgkmcnt(2)
    v_max_f32 v57, 0, v57
    v_add_f32 v57, 0x3727c5ac, v57
    v_mfma_f32_16x16x32_bf16 v[20:23], a[252:255], v[76:79], v[20:23]
    ds_read_b128 v[92:95], v3 offset:45056
    v_mfma_f32_16x16x32_bf16 v[24:27], a[252:255], v[80:83], v[24:27]
    v_rsq_f32 v114, v57
    v_mfma_f32_16x16x32_bf16 v[32:35], v[128:131], v[80:83], v[32:35]
    buffer_load_dwordx4 v6, s[8:11], s41 offen offset:1792 sc1 lds
    v_mfma_f32_16x16x32_bf16 v[28:31], v[128:131], v[76:79], v[28:31]
    s_add_u32 m0, s43, 157824
    ds_read_b128 v[96:99], v3 offset:47104
    v_mfma_f32_16x16x32_bf16 v[36:39], v[132:135], v[76:79], v[36:39]
    v_permlane16_swap_b32 v112, v113
    v_mfma_f32_16x16x32_bf16 v[40:43], v[132:135], v[80:83], v[40:43]
    s_waitcnt lgkmcnt(2)
    v_mov_b32 v115, v114
    v_fmac_f32 v24, v113, v100
    v_mfma_f32_16x16x32_bf16 v[20:23], v[136:139], v[84:87], v[20:23]
    ds_read_b128 v[68:71], v2 offset:49152
    v_fmac_f32 v28, v112, v104
    v_mfma_f32_16x16x32_bf16 v[24:27], v[136:139], v[88:91], v[24:27]
    v_permlane16_swap_b32 v114, v115
    v_mfma_f32_16x16x32_bf16 v[32:35], v[140:143], v[88:91], v[32:35]
    buffer_load_dwordx4 v6, s[8:11], s41 offen offset:1920 sc1 lds
    v_mfma_f32_16x16x32_bf16 v[28:31], v[140:143], v[84:87], v[28:31]
    s_add_u32 m0, s52, 92160
    ds_read_b128 v[72:75], v2 offset:51200
    v_fmac_f32 v20, v112, v100
    v_mfma_f32_16x16x32_bf16 v[36:39], v[144:147], v[84:87], v[36:39]
    v_fmac_f32 v21, v112, v101
    v_fmac_f32 v22, v112, v102
    v_mfma_f32_16x16x32_bf16 v[40:43], v[144:147], v[88:91], v[40:43]
    s_waitcnt lgkmcnt(2)
    v_fmac_f32 v25, v113, v101
    v_fmac_f32 v26, v113, v102
    v_mfma_f32_16x16x32_bf16 v[20:23], v[148:151], v[92:95], v[20:23]
    ds_read_b128 v[76:79], v3 offset:49152
    v_fmac_f32 v29, v112, v105
    v_mfma_f32_16x16x32_bf16 v[24:27], v[148:151], v[96:99], v[24:27]
    v_fmac_f32 v30, v112, v106
    v_fmac_f32 v31, v112, v107
    v_mfma_f32_16x16x32_bf16 v[32:35], v[152:155], v[96:99], v[32:35]
    buffer_load_dwordx4 v1, s[16:19], s46 offen sc1 lds
    v_mfma_f32_16x16x32_bf16 v[28:31], v[152:155], v[92:95], v[28:31]
    s_add_u32 m0, s43, 94208
    ds_read_b128 v[80:83], v3 offset:51200
    v_fmac_f32 v23, v112, v103
    v_mfma_f32_16x16x32_bf16 v[36:39], v[156:159], v[92:95], v[36:39]
    s_cmp_eq_u32 s36, 15
    v_fmac_f32 v27, v113, v103
    v_fmac_f32 v32, v113, v104
    v_mfma_f32_16x16x32_bf16 v[40:43], v[156:159], v[96:99], v[40:43]
    s_waitcnt lgkmcnt(2)
    v_fmac_f32 v33, v113, v105
    v_fmac_f32 v34, v113, v106
    v_mfma_f32_16x16x32_bf16 v[20:23], v[160:163], v[68:71], v[20:23]
    s_cselect_b32 s38, s24, 0x5e00000
    ds_read_b128 v[84:87], v2 offset:53248
    v_fmac_f32 v35, v113, v107
    v_mfma_f32_16x16x32_bf16 v[24:27], v[160:163], v[72:75], v[24:27]
    buffer_load_dwordx4 v1, s[16:19], s38 offen sc1 lds
    v_mfma_f32_16x16x32_bf16 v[32:35], v[164:167], v[72:75], v[32:35]
    s_cmp_eq_u32 s36, s97
    v_med3_i32 v117, s45, 0, v12
    v_add_u32 v117, v117, v11
    v_mfma_f32_16x16x32_bf16 v[28:31], v[164:167], v[68:71], v[28:31]
    s_cselect_b32 s47, 30, -2
    ds_read_b128 v[88:91], v2 offset:55296
    v_fmac_f32 v40, v113, v108
    v_mfma_f32_16x16x32_bf16 v[36:39], v[168:171], v[68:71], v[36:39]
    s_cselect_b64 s[8:9], s[88:89], s[8:9]
    s_cselect_b32 s55, 0x543fc00, s55
    s_add_u32 s45, s45, 65536
    v_mfma_f32_16x16x32_bf16 v[40:43], v[168:171], v[72:75], v[40:43]
    s_waitcnt lgkmcnt(2)
    s_add_u32 s50, s50, s47
    s_max_i32 s47, s50, 0
    v_mfma_f32_16x16x32_bf16 v[20:23], v[172:175], v[76:79], v[20:23]
    s_min_i32 s47, s47, s96
    ds_read_b128 v[92:95], v3 offset:53248
    v_fmac_f32 v36, v112, v108
    v_mfma_f32_16x16x32_bf16 v[24:27], v[172:175], v[80:83], v[24:27]
    buffer_load_dword v116, v117, s[16:19], 0 offen sc1
    v_mfma_f32_16x16x32_bf16 v[32:35], v[176:179], v[80:83], v[32:35]
    s_lshl_b32 s41, s47, 15
    v_fmac_f32 v37, v112, v109
    v_fmac_f32 v38, v112, v110
    v_mfma_f32_16x16x32_bf16 v[28:31], v[176:179], v[76:79], v[28:31]
    s_lshl_b32 s46, s47, 10
    ds_read_b128 v[96:99], v3 offset:55296
    v_fmac_f32 v41, v113, v109
    v_mfma_f32_16x16x32_bf16 v[36:39], v[180:183], v[76:79], v[36:39]
    s_sub_u32 s46, s55, s46
    v_mfma_f32_16x16x32_bf16 v[40:43], v[180:183], v[80:83], v[40:43]
    s_waitcnt lgkmcnt(2)
    v_mfma_f32_16x16x32_bf16 v[20:23], v[184:187], v[84:87], v[20:23]
    s_nop 0
    ds_read_b128 v[68:71], v2 offset:57344
    v_fmac_f32 v39, v112, v111
    v_mfma_f32_16x16x32_bf16 v[24:27], v[184:187], v[88:91], v[24:27]
    v_fmac_f32 v42, v113, v110
    v_fmac_f32 v43, v113, v111
    v_mfma_f32_16x16x32_bf16 v[32:35], v[188:191], v[88:91], v[32:35]
    v_mfma_f32_16x16x32_bf16 v[28:31], v[188:191], v[84:87], v[28:31]
    ds_read_b128 v[72:75], v2 offset:59392
    v_mfma_f32_16x16x32_bf16 v[36:39], v[192:195], v[84:87], v[36:39]
    s_waitcnt vmcnt(10)
    s_barrier
    v_mfma_f32_16x16x32_bf16 v[40:43], v[192:195], v[88:91], v[40:43]
    s_waitcnt lgkmcnt(2)
    v_mfma_f32_16x16x32_bf16 v[20:23], v[196:199], v[92:95], v[20:23]
    ds_read_b128 v[76:79], v3 offset:57344
    v_mfma_f32_16x16x32_bf16 v[24:27], v[196:199], v[96:99], v[24:27]
    buffer_store_dword v124, v124, s[16:19], s91 offen sc1
    v_mfma_f32_16x16x32_bf16 v[32:35], v[200:203], v[96:99], v[32:35]
    s_add_u32 s91, s91, 65536
    v_mfma_f32_16x16x32_bf16 v[28:31], v[200:203], v[92:95], v[28:31]
    ds_read_b128 v[80:83], v3 offset:59392
    v_mfma_f32_16x16x32_bf16 v[36:39], v[204:207], v[92:95], v[36:39]
    v_mfma_f32_16x16x32_bf16 v[40:43], v[204:207], v[96:99], v[40:43]
    s_waitcnt lgkmcnt(2)
    v_mfma_f32_16x16x32_bf16 v[20:23], v[208:211], v[68:71], v[20:23]
    ds_read_b128 v[84:87], v2 offset:61440
    v_mfma_f32_16x16x32_bf16 v[24:27], v[208:211], v[72:75], v[24:27]
    v_mfma_f32_16x16x32_bf16 v[32:35], v[212:215], v[72:75], v[32:35]
    v_mfma_f32_16x16x32_bf16 v[28:31], v[212:215], v[68:71], v[28:31]
    ds_read_b128 v[88:91], v2 offset:63488
    v_mfma_f32_16x16x32_bf16 v[36:39], v[216:219], v[68:71], v[36:39]
    v_mfma_f32_16x16x32_bf16 v[40:43], v[216:219], v[72:75], v[40:43]
    s_waitcnt lgkmcnt(2)
    v_mfma_f32_16x16x32_bf16 v[20:23], v[220:223], v[76:79], v[20:23]
    ds_read_b128 v[92:95], v3 offset:61440
    v_mfma_f32_16x16x32_bf16 v[24:27], v[220:223], v[80:83], v[24:27]
    v_mfma_f32_16x16x32_bf16 v[32:35], v[224:227], v[80:83], v[32:35]
    v_mfma_f32_16x16x32_bf16 v[28:31], v[224:227], v[76:79], v[28:31]
    ds_read_b128 v[96:99], v3 offset:63488
    v_mfma_f32_16x16x32_bf16 v[36:39], v[228:231], v[76:79], v[36:39]
    v_mfma_f32_16x16x32_bf16 v[40:43], v[228:231], v[80:83], v[40:43]
    s_waitcnt lgkmcnt(2)
    v_mfma_f32_16x16x32_bf16 v[20:23], v[232:235], v[84:87], v[20:23]
    ds_read_b128 v[68:71], v4 offset:0
    v_mfma_f32_16x16x32_bf16 v[24:27], v[232:235], v[88:91], v[24:27]
    v_mfma_f32_16x16x32_bf16 v[32:35], v[236:239], v[88:91], v[32:35]
    v_mfma_f32_16x16x32_bf16 v[28:31], v[236:239], v[84:87], v[28:31]
    ds_read_b128 v[72:75], v4 offset:2048
    v_mfma_f32_16x16x32_bf16 v[36:39], v[240:243], v[84:87], v[36:39]
    v_mfma_f32_16x16x32_bf16 v[40:43], v[240:243], v[88:91], v[40:43]
    s_waitcnt lgkmcnt(2)
    v_mfma_f32_16x16x32_bf16 v[20:23], v[244:247], v[92:95], v[20:23]
    ds_read_b128 v[76:79], v5 offset:0
    v_mfma_f32_16x16x32_bf16 v[24:27], v[244:247], v[96:99], v[24:27]
    v_mfma_f32_16x16x32_bf16 v[32:35], v[248:251], v[96:99], v[32:35]
    v_mfma_f32_16x16x32_bf16 v[28:31], v[248:251], v[92:95], v[28:31]
    ds_read_b128 v[80:83], v5 offset:2048
    v_mfma_f32_16x16x32_bf16 v[36:39], v[252:255], v[92:95], v[36:39]
    s_add_u32 s36, s36, 1
    v_mfma_f32_16x16x32_bf16 v[40:43], v[252:255], v[96:99], v[40:43]
    s_waitcnt lgkmcnt(2)
    s_cmp_eq_u32 s36, 32
    s_cbranch_scc1 L_q_done
L_q_b1:
    v_mfma_f32_16x16x32_bf16 v[44:47], a[0:3], v[68:71], 0
    ds_read_b128 v[84:87], v4 offset:4096
    v_mul_f32 v20, v20, v114
    v_mfma_f32_16x16x32_bf16 v[48:51], a[0:3], v[72:75], 0
    v_mul_f32 v21, v21, v114
    v_mul_f32 v22, v22, v114
    v_mfma_f32_16x16x32_bf16 v[56:59], a[4:7], v[72:75], 0
    v_mul_f32 v23, v23, v114
    v_cvt_pk_bf16_f32 v20, v20, v21
    v_mfma_f32_16x16x32_bf16 v[52:55], a[4:7], v[68:71], 0
    ds_read_b128 v[88:91], v4 offset:6144
    v_cvt_pk_bf16_f32 v21, v22, v23
    v_mfma_f32_16x16x32_bf16 v[60:63], a[8:11], v[68:71], 0
    ds_write_b64 v7, v[20:21] offset:0
    v_mfma_f32_16x16x32_bf16 v[64:67], a[8:11], v[72:75], 0
    s_waitcnt lgkmcnt(3)
    v_mul_f32 v24, v24, v115
    v_mul_f32 v25, v25, v115
    v_mfma_f32_16x16x32_bf16 v[44:47], a[12:15], v[76:79], v[44:47]
    ds_read_b128 v[92:95], v5 offset:4096
    v_mul_f32 v26, v26, v115
    v_mfma_f32_16x16x32_bf16 v[48:51], a[12:15], v[80:83], v[48:51]
    v_mul_f32 v27, v27, v115
    v_cvt_pk_bf16_f32 v24, v24, v25
    v_mfma_f32_16x16x32_bf16 v[56:59], a[16:19], v[80:83], v[56:59]
    v_cvt_pk_bf16_f32 v25, v26, v27
    v_mfma_f32_16x16x32_bf16 v[52:55], a[16:19], v[76:79], v[52:55]
    ds_read_b128 v[96:99], v5 offset:6144
    v_mfma_f32_16x16x32_bf16 v[60:63], a[20:23], v[76:79], v[60:63]
    ds_write_b64 v7, v[24:25] offset:6144
    v_mfma_f32_16x16x32_bf16 v[64:67], a[20:23], v[80:83], v[64:67]
    s_waitcnt lgkmcnt(4)
    v_mul_f32 v28, v28, v114
    v_mul_f32 v29, v29, v114
    v_mfma_f32_16x16x32_bf16 v[44:47], a[24:27], v[84:87], v[44:47]
    ds_read_b128 v[68:71], v4 offset:8192
    v_mul_f32 v30, v30, v114
    v_mfma_f32_16x16x32_bf16 v[48:51], a[24:27], v[88:91], v[48:51]
    v_mul_f32 v31, v31, v114
    v_cvt_pk_bf16_f32 v28, v28, v29
    v_mfma_f32_16x16x32_bf16 v[56:59], a[28:31], v[88:91], v[56:59]
    v_cvt_pk_bf16_f32 v29, v30, v31
    v_mfma_f32_16x16x32_bf16 v[52:55], a[28:31], v[84:87], v[52:55]
    ds_read_b128 v[72:75], v4 offset:10240
    v_mfma_f32_16x16x32_bf16 v[60:63], a[32:35], v[84:87], v[60:63]
    ds_write_b64 v7, v[28:29] offset:1024
    v_mfma_f32_16x16x32_bf16 v[64:67], a[32:35], v[88:91], v[64:67]
    s_waitcnt lgkmcnt(4)
    v_mul_f32 v32, v32, v115
    v_mul_f32 v33, v33, v115
    v_mfma_f32_16x16x32_bf16 v[44:47], a[36:39], v[92:95], v[44:47]
    ds_read_b128 v[76:79], v5 offset:8192
    v_mul_f32 v34, v34, v115
    v_mfma_f32_16x16x32_bf16 v[48:51], a[36:39], v[96:99], v[48:51]
    v_mul_f32 v35, v35, v115
    v_cvt_pk_bf16_f32 v32, v32, v33
    v_mfma_f32_16x16x32_bf16 v[56:59], a[40:43], v[96:99], v[56:59]
    v_cvt_pk_bf16_f32 v33, v34, v35
    v_mfma_f32_16x16x32_bf16 v[52:55], a[40:43], v[92:95], v[52:55]
    ds_read_b128 v[80:83], v5 offset:10240
    v_mfma_f32_16x16x32_bf16 v[60:63], a[44:47], v[92:95], v[60:63]
    ds_write_b64 v7, v[32:33] offset:7168
    v_mfma_f32_16x16x32_bf16 v[64:67], a[44:47], v[96:99], v[64:67]
    s_waitcnt lgkmcnt(4)
    v_mul_f32 v36, v36, v114
    v_mul_f32 v37, v37, v114
    v_mfma_f32_16x16x32_bf16 v[44:47], a[48:51], v[68:71], v[44:47]
    s_waitcnt vmcnt(1)
    ds_read_b128 v[84:87], v4 offset:12288
    v_cmp_ne_u32 vcc, 0, v116
    v_mfma_f32_16x16x32_bf16 v[48:51], a[48:51], v[72:75], v[48:51]
    v_mul_f32 v38, v38, v114
    v_mul_f32 v39, v39, v114
    v_mfma_f32_16x16x32_bf16 v[56:59], a[52:55], v[72:75], v[56:59]
    s_cbranch_vccnz L_spin9
L_back10:
    v_cvt_pk_bf16_f32 v36, v36, v37
    v_cvt_pk_bf16_f32 v37, v38, v39
    v_mfma_f32_16x16x32_bf16 v[52:55], a[52:55], v[68:71], v[52:55]
    ds_read_b128 v[88:91], v4 offset:14336
    v_mfma_f32_16x16x32_bf16 v[60:63], a[56:59], v[68:71], v[60:63]
    ds_write_b64 v8, v[36:37] offset:2048
    v_mfma_f32_16x16x32_bf16 v[64:67], a[56:59], v[72:75], v[64:67]
    s_waitcnt lgkmcnt(4)
    v_mul_f32 v40, v40, v115
    v_mul_f32 v41, v41, v115
    v_mfma_f32_16x16x32_bf16 v[44:47], a[60:63], v[76:79], v[44:47]
    ds_read_b128 v[92:95], v5 offset:12288
    v_mul_f32 v42, v42, v115
    v_mfma_f32_16x16x32_bf16 v[48:51], a[60:63], v[80:83], v[48:51]
    v_mul_f32 v43, v43, v115
    v_cvt_pk_bf16_f32 v40, v40, v41
    v_mfma_f32_16x16x32_bf16 v[56:59], a[64:67], v[80:83], v[56:59]
    v_cvt_pk_bf16_f32 v41, v42, v43
    v_mfma_f32_16x16x32_bf16 v[52:55], a[64:67], v[76:79], v[52:55]
    ds_read_b128 v[96:99], v5 offset:14336
    v_mfma_f32_16x16x32_bf16 v[60:63], a[68:71], v[76:79], v[60:63]
    ds_write_b64 v8, v[40:41] offset:8192
    v_mfma_f32_16x16x32_bf16 v[64:67], a[68:71], v[80:83], v[64:67]
    s_waitcnt lgkmcnt(4)
    v_mfma_f32_16x16x32_bf16 v[44:47], a[72:75], v[84:87], v[44:47]
    ds_read_b128 v[68:71], v4 offset:16384
    v_mfma_f32_16x16x32_bf16 v[48:51], a[72:75], v[88:91], v[48:51]
    v_mfma_f32_16x16x32_bf16 v[56:59], a[76:79], v[88:91], v[56:59]
    s_waitcnt lgkmcnt(1)
    s_barrier
    v_mfma_f32_16x16x32_bf16 v[52:55], a[76:79], v[84:87], v[52:55]
    ds_read_b128 v[72:75], v4 offset:18432
    v_mfma_f32_16x16x32_bf16 v[60:63], a[80:83], v[84:87], v[60:63]
    ds_read_b128 v[20:23], v10 offset:0
    v_mfma_f32_16x16x32_bf16 v[64:67], a[80:83], v[88:91], v[64:67]
    s_waitcnt lgkmcnt(4)
    ds_read_b128 v[24:27], v9 offset:1024
    v_mfma_f32_16x16x32_bf16 v[44:47], a[84:87], v[92:95], v[44:47]
    ds_read_b128 v[76:79], v5 offset:16384
    v_mfma_f32_16x16x32_bf16 v[48:51], a[84:87], v[96:99], v[48:51]
    ds_read_b128 v[28:31], v10 offset:1024
    s_add_u32 m0, s43, 0
    v_mfma_f32_16x16x32_bf16 v[56:59], a[88:91], v[96:99], v[56:59]
    buffer_load_dwordx4 v6, s[8:11], s41 offen offset:0 sc1 lds
    v_mfma_f32_16x16x32_bf16 v[52:55], a[88:91], v[92:95], v[52:55]
    s_add_u32 m0, s43, 3968
    ds_read_b128 v[80:83], v5 offset:18432
    v_mfma_f32_16x16x32_bf16 v[60:63], a[92:95], v[92:95], v[60:63]
    ds_read_b64_tr_b16 v[32:33], v9 offset:2048
    v_mfma_f32_16x16x32_bf16 v[64:67], a[92:95], v[96:99], v[64:67]
    s_waitcnt lgkmcnt(6)
    ds_read_b64_tr_b16 v[34:35], v10 offset:2048
    s_waitcnt lgkmcnt(3)
    v_mfma_f32_16x16x32_bf16 v[44:47], a[96:99], v[68:71], v[44:47]
    ds_read_b128 v[84:87], v4 offset:20480
    v_mfma_f32_16x16x32_bf16 v[40:43], v[24:27], v[20:23], 0
    ds_read_b64_tr_b16 v[36:37], v9 offset:2056
    v_mfma_f32_16x16x32_bf16 v[118:121], v[28:31], v[20:23], 0
    ds_read_b64_tr_b16 v[38:39], v10 offset:2056
    v_mfma_f32_16x16x32_bf16 v[48:51], a[96:99], v[72:75], v[48:51]
    v_mfma_f32_16x16x32_bf16 v[56:59], a[100:103], v[72:75], v[56:59]
    buffer_load_dwordx4 v6, s[8:11], s41 offen offset:128 sc1 lds
    v_mfma_f32_16x16x32_bf16 v[52:55], a[100:103], v[68:71], v[52:55]
    s_add_u32 m0, s43, 7936
    ds_read_b128 v[88:91], v4 offset:22528
    v_cndmask_b32 v40, v40, v41, s[56:57]
    v_mfma_f32_16x16x32_bf16 v[60:63], a[104:107], v[68:71], v[60:63]
    v_cndmask_b32 v42, v42, v43, s[56:57]
    v_cndmask_b32 v118, v118, v119, s[56:57]
    v_mfma_f32_16x16x32_bf16 v[64:67], a[104:107], v[72:75], v[64:67]
    s_waitcnt lgkmcnt(6)
    v_cndmask_b32 v120, v120, v121, s[56:57]
    v_cndmask_b32 v40, v18, v40, s[62:63]
    v_mfma_f32_16x16x32_bf16 v[44:47], a[108:111], v[76:79], v[44:47]
    ds_read_b128 v[92:95], v5 offset:20480
    v_cndmask_b32 v42, v18, v42, s[62:63]
    v_mfma_f32_16x16x32_bf16 v[48:51], a[108:111], v[80:83], v[48:51]
    v_cndmask_b32 v22, v40, v118, s[58:59]
    v_cndmask_b32 v23, v42, v120, s[60:61]
    v_mfma_f32_16x16x32_bf16 v[56:59], a[112:115], v[80:83], v[56:59]
    buffer_load_dwordx4 v6, s[8:11], s41 offen offset:256 sc1 lds
    v_mfma_f32_16x16x32_bf16 v[52:55], a[112:115], v[76:79], v[52:55]
    s_add_u32 m0, s43, 11904
    ds_read_b128 v[96:99], v5 offset:22528
    v_max_f32 v20, v22, v23
    v_mfma_f32_16x16x32_bf16 v[60:63], a[116:119], v[76:79], v[60:63]
    v_mov_b32 v21, v20
    v_mfma_f32_16x16x32_bf16 v[64:67], a[116:119], v[80:83], v[64:67]
    s_waitcnt lgkmcnt(2)
    v_permlane16_swap_b32 v20, v21
    v_mfma_f32_16x16x32_bf16 v[44:47], a[120:123], v[84:87], v[44:47]
    ds_read_b128 v[68:71], v4 offset:24576
    v_max_f32 v20, v20, v21
    v_mfma_f32_16x16x32_bf16 v[48:51], a[120:123], v[88:91], v[48:51]
    v_mov_b32 v21, v20
    v_mfma_f32_16x16x32_bf16 v[56:59], a[124:127], v[88:91], v[56:59]
    buffer_load_dwordx4 v6, s[8:11], s41 offen offset:384 sc1 lds
    v_mfma_f32_16x16x32_bf16 v[52:55], a[124:127], v[84:87], v[52:55]
    s_add_u32 m0, s43, 15872
    ds_read_b128 v[72:75], v4 offset:26624
    v_mfma_f32_16x16x32_bf16 v[60:63], a[128:131], v[84:87], v[60:63]
    v_permlane32_swap_b32 v20, v21
    v_mfma_f32_16x16x32_bf16 v[64:67], a[128:131], v[88:91], v[64:67]
    s_waitcnt lgkmcnt(2)
    v_max_f32 v20, v20, v21
    v_mul_f32 v20, s86, v20
    v_mfma_f32_16x16x32_bf16 v[44:47], a[132:135], v[92:95], v[44:47]
    ds_read_b128 v[76:79], v5 offset:24576
    v_fma_f32 v22, v22, s86, -v20
    v_mfma_f32_16x16x32_bf16 v[48:51], a[132:135], v[96:99], v[48:51]
    v_fma_f32 v23, v23, s86, -v20
    v_mfma_f32_16x16x32_bf16 v[56:59], a[136:139], v[96:99], v[56:59]
    buffer_load_dwordx4 v6, s[8:11], s41 offen offset:512 sc1 lds
    v_mfma_f32_16x16x32_bf16 v[52:55], a[136:139], v[92:95], v[52:55]
    s_add_u32 m0, s43, 19840
    ds_read_b128 v[80:83], v5 offset:26624
    v_mfma_f32_16x16x32_bf16 v[60:63], a[140:143], v[92:95], v[60:63]
    v_exp_f32 v22, v22
    v_mfma_f32_16x16x32_bf16 v[64:67], a[140:143], v[96:99], v[64:67]
    s_waitcnt lgkmcnt(2)
    v_exp_f32 v23, v23
    v_mfma_f32_16x16x32_bf16 v[44:47], a[144:147], v[68:71], v[44:47]
    ds_read_b128 v[84:87], v4 offset:28672
    v_cvt_pk_bf16_f32 v28, v22, v23
    v_mfma_f32_16x16x32_bf16 v[48:51], a[144:147], v[72:75], v[48:51]
    v_perm_b32 v24, v28, v28, v14
    v_perm_b32 v25, v28, v28, v15
    v_mfma_f32_16x16x32_bf16 v[56:59], a[148:151], v[72:75], v[56:59]
    buffer_load_dwordx4 v6, s[8:11], s41 offen offset:640 sc1 lds
    v_mfma_f32_16x16x32_bf16 v[52:55], a[148:151], v[68:71], v[52:55]
    s_add_u32 m0, s43, 23808
    ds_read_b128 v[88:91], v4 offset:30720
    v_perm_b32 v26, v28, v28, v16
    v_mfma_f32_16x16x32_bf16 v[60:63], a[152:155], v[68:71], v[60:63]
    v_perm_b32 v27, v28, v28, v17
    v_add_f32 v20, v22, v23
    v_mfma_f32_16x16x32_bf16 v[64:67], a[152:155], v[72:75], v[64:67]
    s_waitcnt lgkmcnt(2)
    v_mov_b32 v21, v20
    s_waitcnt lgkmcnt(9)
    v_mfma_f32_16x16x32_bf16 v[44:47], a[156:159], v[76:79], v[44:47]
    ds_read_b128 v[92:95], v5 offset:28672
    v_mfma_f32_16x16x32_bf16 v[40:43], v[32:35], v[24:27], 0
    v_mfma_f32_16x16x32_bf16 v[118:121], v[36:39], v[24:27], 0
    v_permlane16_swap_b32 v20, v21
    v_mfma_f32_16x16x32_bf16 v[48:51], a[156:159], v[80:83], v[48:51]
    v_add_f32 v20, v20, v21
    v_mov_b32 v21, v20
    v_mfma_f32_16x16x32_bf16 v[56:59], a[160:163], v[80:83], v[56:59]
    buffer_load_dwordx4 v6, s[8:11], s41 offen offset:768 sc1 lds
    v_mfma_f32_16x16x32_bf16 v[52:55], a[160:163], v[76:79], v[52:55]
    s_add_u32 m0, s43, 27776
    ds_read_b128 v[96:99], v5 offset:30720
    v_mfma_f32_16x16x32_bf16 v[60:63], a[164:167], v[76:79], v[60:63]
    v_permlane32_swap_b32 v20, v21
    v_mfma_f32_16x16x32_bf16 v[64:67], a[164:167], v[80:83], v[64:67]
    s_waitcnt lgkmcnt(2)
    v_add_f32 v20, v20, v21
    v_mfma_f32_16x16x32_bf16 v[44:47], a[168:171], v[84:87], v[44:47]
    ds_read_b128 v[68:71], v4 offset:32768
    v_mfma_f32_16x16x32_bf16 v[48:51], a[168:171], v[88:91], v[48:51]
    v_rcp_f32 v20, v20
    v_mfma_f32_16x16x32_bf16 v[56:59], a[172:175], v[88:91], v[56:59]
    buffer_load_dwordx4 v6, s[8:11], s41 offen offset:896 sc1 lds
    v_mfma_f32_16x16x32_bf16 v[52:55], a[172:175], v[84:87], v[52:55]
    s_add_u32 m0, s43, 31744
    ds_read_b128 v[72:75], v4 offset:34816
    v_mul_f32 v40, v40, v20
    v_mfma_f32_16x16x32_bf16 v[60:63], a[176:179], v[84:87], v[60:63]
    v_mul_f32 v41, v41, v20
    v_mul_f32 v42, v42, v20
    v_mfma_f32_16x16x32_bf16 v[64:67], a[176:179], v[88:91], v[64:67]
    s_waitcnt lgkmcnt(2)
    v_mul_f32 v43, v43, v20
    v_cvt_pk_bf16_f32 v28, v40, v41
    v_mfma_f32_16x16x32_bf16 v[44:47], a[180:183], v[92:95], v[44:47]
    ds_read_b128 v[76:79], v5 offset:32768
    v_cvt_pk_bf16_f32 v29, v42, v43
    v_mfma_f32_16x16x32_bf16 v[48:51], a[180:183], v[96:99], v[48:51]
    v_mul_f32 v118, v118, v20
    v_mul_f32 v119, v119, v20
    v_mfma_f32_16x16x32_bf16 v[56:59], a[184:187], v[96:99], v[56:59]
    buffer_load_dwordx4 v6, s[8:11], s41 offen offset:1024 sc1 lds
    v_mfma_f32_16x16x32_bf16 v[52:55], a[184:187], v[92:95], v[52:55]
    s_add_u32 m0, s43, 35712
    ds_read_b128 v[80:83], v5 offset:34816
    v_mul_f32 v120, v120, v20
    v_mfma_f32_16x16x32_bf16 v[60:63], a[188:191], v[92:95], v[60:63]
    v_mul_f32 v121, v121, v20
    v_cvt_pk_bf16_f32 v30, v118, v119
    v_mfma_f32_16x16x32_bf16 v[64:67], a[188:191], v[96:99], v[64:67]
    s_waitcnt lgkmcnt(2)
    v_cvt_pk_bf16_f32 v31, v120, v121
    v_mfma_f32_16x16x32_bf16 v[44:47], a[192:195], v[68:71], v[44:47]
    ds_read_b128 v[84:87], v4 offset:36864
    v_mfma_f32_16x16x32_bf16 v[48:51], a[192:195], v[72:75], v[48:51]
    buffer_store_dwordx4 v[28:31], v1, s[16:19], s44 offen sc1
    v_mfma_f32_16x16x32_bf16 v[56:59], a[196:199], v[72:75], v[56:59]
    buffer_load_dwordx4 v6, s[8:11], s41 offen offset:1152 sc1 lds
    v_mfma_f32_16x16x32_bf16 v[52:55], a[196:199], v[68:71], v[52:55]
    s_add_u32 m0, s43, 39680
    ds_read_b128 v[88:91], v4 offset:38912
    s_add_u32 s90, s90, 0x10000
    v_mfma_f32_16x16x32_bf16 v[60:63], a[200:203], v[68:71], v[60:63]
    s_and_b32 s44, s90, 0xffffffff
    ds_read_b64 v[32:33], v13 offset:2048
    s_bitcmp1_b32 s26, s36
    v_mfma_f32_16x16x32_bf16 v[64:67], a[200:203], v[72:75], v[64:67]
    s_waitcnt lgkmcnt(3)
    ds_read_b64 v[34:35], v13 offset:2176
    s_cselect_b64 s[62:63], 0, -1
    v_mfma_f32_16x16x32_bf16 v[44:47], a[204:207], v[76:79], v[44:47]
    s_cmp_eq_u32 s36, 16
    ds_read_b128 v[92:95], v5 offset:36864
    s_cselect_b32 s49, s87, 0
    v_mfma_f32_16x16x32_bf16 v[48:51], a[204:207], v[80:83], v[48:51]
    ds_read_b64 v[36:37], v13 offset:2304
    v_subrev_u32 v9, s49, v9
    v_mfma_f32_16x16x32_bf16 v[56:59], a[208:211], v[80:83], v[56:59]
    buffer_load_dwordx4 v6, s[8:11], s41 offen offset:1280 sc1 lds
    v_mfma_f32_16x16x32_bf16 v[52:55], a[208:211], v[76:79], v[52:55]
    s_add_u32 m0, s43, 43648
    ds_read_b128 v[96:99], v5 offset:38912
    v_mfma_f32_16x16x32_bf16 v[60:63], a[212:215], v[76:79], v[60:63]
    ds_read_b64 v[38:39], v13 offset:2432
    v_mfma_f32_16x16x32_bf16 v[64:67], a[212:215], v[80:83], v[64:67]
    s_waitcnt lgkmcnt(6)
    v_mfma_f32_16x16x32_bf16 v[44:47], a[216:219], v[84:87], v[44:47]
    ds_read_b128 v[68:71], v4 offset:40960
    v_mfma_f32_16x16x32_bf16 v[48:51], a[216:219], v[88:91], v[48:51]
    v_mfma_f32_16x16x32_bf16 v[56:59], a[220:223], v[88:91], v[56:59]
    buffer_load_dwordx4 v6, s[8:11], s41 offen offset:1408 sc1 lds
    v_mfma_f32_16x16x32_bf16 v[52:55], a[220:223], v[84:87], v[52:55]
    s_add_u32 m0, s43, 47616
    ds_read_b128 v[72:75], v4 offset:43008
    s_waitcnt lgkmcnt(2)
    v_mfma_f32_16x16x32_bf16 v[60:63], a[224:227], v[84:87], v[60:63]
    v_add_f32 v40, v36, v38
    v_add_f32 v41, v37, v39
    v_mfma_f32_16x16x32_bf16 v[64:67], a[224:227], v[88:91], v[64:67]
    s_waitcnt lgkmcnt(3)
    v_add_f32 v32, v32, v34
    v_add_f32 v33, v33, v35
    v_mfma_f32_16x16x32_bf16 v[44:47], a[228:231], v[92:95], v[44:47]
    ds_read_b128 v[76:79], v5 offset:40960
    v_add_f32 v32, v32, v40
    v_mfma_f32_16x16x32_bf16 v[48:51], a[228:231], v[96:99], v[48:51]
    v_add_f32 v33, v33, v41
    v_mov_b32 v40, v32
    v_mfma_f32_16x16x32_bf16 v[56:59], a[232:235], v[96:99], v[56:59]
    buffer_load_dwordx4 v6, s[8:11], s41 offen offset:1536 sc1 lds
    v_mfma_f32_16x16x32_bf16 v[52:55], a[232:235], v[92:95], v[52:55]
    s_add_u32 m0, s43, 51584
    ds_read_b128 v[80:83], v5 offset:43008
    v_mov_b32 v41, v33
    v_mfma_f32_16x16x32_bf16 v[60:63], a[236:239], v[92:95], v[60:63]
    v_permlane32_swap_b32 v32, v40
    v_mfma_f32_16x16x32_bf16 v[64:67], a[236:239], v[96:99], v[64:67]
    s_waitcnt lgkmcnt(2)
    v_permlane32_swap_b32 v33, v41
    v_mfma_f32_16x16x32_bf16 v[44:47], a[240:243], v[68:71], v[44:47]
    ds_read_b128 v[84:87], v4 offset:45056
    v_add_f32 v32, v32, v40
    v_mfma_f32_16x16x32_bf16 v[48:51], a[240:243], v[72:75], v[48:51]
    v_add_f32 v33, v33, v41
    v_mul_f32 v112, 0xba800000, v32
    v_mfma_f32_16x16x32_bf16 v[56:59], a[244:247], v[72:75], v[56:59]
    buffer_load_dwordx4 v6, s[8:11], s41 offen offset:1664 sc1 lds
    v_mfma_f32_16x16x32_bf16 v[52:55], a[244:247], v[68:71], v[52:55]
    s_add_u32 m0, s43, 55552
    ds_read_b128 v[88:91], v4 offset:47104
    v_mul_f32 v33, 0x3a800000, v33
    v_mfma_f32_16x16x32_bf16 v[60:63], a[248:251], v[68:71], v[60:63]
    v_fma_f32 v33, -v112, v112, v33
    v_mov_b32 v113, v112
    v_mfma_f32_16x16x32_bf16 v[64:67], a[248:251], v[72:75], v[64:67]
    s_waitcnt lgkmcnt(2)
    v_max_f32 v33, 0, v33
    v_add_f32 v33, 0x3727c5ac, v33
    v_mfma_f32_16x16x32_bf16 v[44:47], a[252:255], v[76:79], v[44:47]
    ds_read_b128 v[92:95], v5 offset:45056
    v_mfma_f32_16x16x32_bf16 v[48:51], a[252:255], v[80:83], v[48:51]
    v_rsq_f32 v114, v33
    v_mfma_f32_16x16x32_bf16 v[56:59], v[128:131], v[80:83], v[56:59]
    buffer_load_dwordx4 v6, s[8:11], s41 offen offset:1792 sc1 lds
    v_mfma_f32_16x16x32_bf16 v[52:55], v[128:131], v[76:79], v[52:55]
    s_add_u32 m0, s43, 59520
    ds_read_b128 v[96:99], v5 offset:47104
    v_mfma_f32_16x16x32_bf16 v[60:63], v[132:135], v[76:79], v[60:63]
    v_permlane16_swap_b32 v112, v113
    v_mfma_f32_16x16x32_bf16 v[64:67], v[132:135], v[80:83], v[64:67]
    s_waitcnt lgkmcnt(2)
    v_mov_b32 v115, v114
    v_fmac_f32 v48, v113, v100
    v_mfma_f32_16x16x32_bf16 v[44:47], v[136:139], v[84:87], v[44:47]
    ds_read_b128 v[68:71], v4 offset:49152
    v_fmac_f32 v52, v112, v104
    v_mfma_f32_16x16x32_bf16 v[48:51], v[136:139], v[88:91], v[48:51]
    v_permlane16_swap_b32 v114, v115
    v_mfma_f32_16x16x32_bf16 v[56:59], v[140:143], v[88:91], v[56:59]
    buffer_load_dwordx4 v6, s[8:11], s41 offen offset:1920 sc1 lds
    v_mfma_f32_16x16x32_bf16 v[52:55], v[140:143], v[84:87], v[52:55]
    s_add_u32 m0, s52, 90112
    ds_read_b128 v[72:75], v4 offset:51200
    v_fmac_f32 v44, v112, v100
    v_mfma_f32_16x16x32_bf16 v[60:63], v[144:147], v[84:87], v[60:63]
    v_fmac_f32 v45, v112, v101
    v_fmac_f32 v46, v112, v102
    v_mfma_f32_16x16x32_bf16 v[64:67], v[144:147], v[88:91], v[64:67]
    s_waitcnt lgkmcnt(2)
    v_fmac_f32 v49, v113, v101
    v_fmac_f32 v50, v113, v102
    v_mfma_f32_16x16x32_bf16 v[44:47], v[148:151], v[92:95], v[44:47]
    ds_read_b128 v[76:79], v5 offset:49152
    v_fmac_f32 v53, v112, v105
    v_mfma_f32_16x16x32_bf16 v[48:51], v[148:151], v[96:99], v[48:51]
    v_fmac_f32 v54, v112, v106
    v_fmac_f32 v55, v112, v107
    v_mfma_f32_16x16x32_bf16 v[56:59], v[152:155], v[96:99], v[56:59]
    buffer_load_dwordx4 v1, s[16:19], s46 offen sc1 lds
    v_mfma_f32_16x16x32_bf16 v[52:55], v[152:155], v[92:95], v[52:55]
    s_cmp_eq_u32 s36, s97
    ds_read_b128 v[80:83], v5 offset:51200
    v_med3_i32 v117, s45, 0, v12
    v_mfma_f32_16x16x32_bf16 v[60:63], v[156:159], v[92:95], v[60:63]
    s_cselect_b32 s47, 30, -2
    v_add_u32 v117, v117, v11
    v_fmac_f32 v47, v112, v103
    v_mfma_f32_16x16x32_bf16 v[64:67], v[156:159], v[96:99], v[64:67]
    s_waitcnt lgkmcnt(2)
    v_fmac_f32 v51, v113, v103
    v_fmac_f32 v56, v113, v104
    v_mfma_f32_16x16x32_bf16 v[44:47], v[160:163], v[68:71], v[44:47]
    s_cselect_b64 s[8:9], s[88:89], s[8:9]
    ds_read_b128 v[84:87], v4 offset:53248
    v_fmac_f32 v57, v113, v105
    v_mfma_f32_16x16x32_bf16 v[48:51], v[160:163], v[72:75], v[48:51]
    s_cselect_b32 s55, 0x543fc00, s55
    v_fmac_f32 v60, v112, v108
    v_fmac_f32 v61, v112, v109
    v_mfma_f32_16x16x32_bf16 v[56:59], v[164:167], v[72:75], v[56:59]
    s_add_u32 s45, s45, 65536
    v_fmac_f32 v62, v112, v110
    v_fmac_f32 v63, v112, v111
    v_mfma_f32_16x16x32_bf16 v[52:55], v[164:167], v[68:71], v[52:55]
    s_add_u32 s50, s50, s47
    ds_read_b128 v[88:91], v4 offset:55296
    v_fmac_f32 v64, v113, v108
    v_mfma_f32_16x16x32_bf16 v[60:63], v[168:171], v[68:71], v[60:63]
    buffer_load_dword v116, v117, s[16:19], 0 offen sc1
    v_mfma_f32_16x16x32_bf16 v[64:67], v[168:171], v[72:75], v[64:67]
    s_waitcnt lgkmcnt(2)
    v_fmac_f32 v58, v113, v106
    v_fmac_f32 v59, v113, v107
    v_mfma_f32_16x16x32_bf16 v[44:47], v[172:175], v[76:79], v[44:47]
    s_max_i32 s47, s50, 0
    ds_read_b128 v[92:95], v5 offset:53248
    s_min_i32 s47, s47, s96
    v_mfma_f32_16x16x32_bf16 v[48:51], v[172:175], v[80:83], v[48:51]
    s_lshl_b32 s41, s47, 15
    v_fmac_f32 v65, v113, v109
    v_fmac_f32 v66, v113, v110
    v_mfma_f32_16x16x32_bf16 v[56:59], v[176:179], v[80:83], v[56:59]
    s_lshl_b32 s46, s47, 10
    v_fmac_f32 v67, v113, v111
    s_sub_u32 s46, s55, s46
    v_mfma_f32_16x16x32_bf16 v[52:55], v[176:179], v[76:79], v[52:55]
    ds_read_b128 v[96:99], v5 offset:55296
    v_mfma_f32_16x16x32_bf16 v[60:63], v[180:183], v[76:79], v[60:63]
    v_mfma_f32_16x16x32_bf16 v[64:67], v[180:183], v[80:83], v[64:67]
    s_waitcnt lgkmcnt(2)
    v_mfma_f32_16x16x32_bf16 v[44:47], v[184:187], v[84:87], v[44:47]
    ds_read_b128 v[68:71], v4 offset:57344
    v_mfma_f32_16x16x32_bf16 v[48:51], v[184:187], v[88:91], v[48:51]
    v_mfma_f32_16x16x32_bf16 v[56:59], v[188:191], v[88:91], v[56:59]
    v_mfma_f32_16x16x32_bf16 v[52:55], v[188:191], v[84:87], v[52:55]
    ds_read_b128 v[72:75], v4 offset:59392
    v_mfma_f32_16x16x32_bf16 v[60:63], v[192:195], v[84:87], v[60:63]
    s_waitcnt vmcnt(9)
    s_barrier
    v_mfma_f32_16x16x32_bf16 v[64:67], v[192:195], v[88:91], v[64:67]
    s_waitcnt lgkmcnt(2)
    v_mfma_f32_16x16x32_bf16 v[44:47], v[196:199], v[92:95], v[44:47]
    ds_read_b128 v[76:79], v5 offset:57344
    v_mfma_f32_16x16x32_bf16 v[48:51], v[196:199], v[96:99], v[48:51]
    buffer_store_dword v124, v124, s[16:19], s91 offen sc1
    v_mfma_f32_16x16x32_bf16 v[56:59], v[200:203], v[96:99], v[56:59]
    s_add_u32 s91, s91, 65536
    v_mfma_f32_16x16x32_bf16 v[52:55], v[200:203], v[92:95], v[52:55]
    ds_read_b128 v[80:83], v5 offset:59392
    v_mfma_f32_16x16x32_bf16 v[60:63], v[204:207], v[92:95], v[60:63]
    v_mfma_f32_16x16x32_bf16 v[64:67], v[204:207], v[96:99], v[64:67]
    s_waitcnt lgkmcnt(2)
    v_mfma_f32_16x16x32_bf16 v[44:47], v[208:211], v[68:71], v[44:47]
    ds_read_b128 v[84:87], v4 offset:61440
    v_mfma_f32_16x16x32_bf16 v[48:51], v[208:211], v[72:75], v[48:51]
    v_mfma_f32_16x16x32_bf16 v[56:59], v[212:215], v[72:75], v[56:59]
    v_mfma_f32_16x16x32_bf16 v[52:55], v[212:215], v[68:71], v[52:55]
    ds_read_b128 v[88:91], v4 offset:63488
    v_mfma_f32_16x16x32_bf16 v[60:63], v[216:219], v[68:71], v[60:63]
    v_mfma_f32_16x16x32_bf16 v[64:67], v[216:219], v[72:75], v[64:67]
    s_waitcnt lgkmcnt(2)
    v_mfma_f32_16x16x32_bf16 v[44:47], v[220:223], v[76:79], v[44:47]
    ds_read_b128 v[92:95], v5 offset:61440
    v_mfma_f32_16x16x32_bf16 v[48:51], v[220:223], v[80:83], v[48:51]
    v_mfma_f32_16x16x32_bf16 v[56:59], v[224:227], v[80:83], v[56:59]
    v_mfma_f32_16x16x32_bf16 v[52:55], v[224:227], v[76:79], v[52:55]
    ds_read_b128 v[96:99], v5 offset:63488
    v_mfma_f32_16x16x32_bf16 v[60:63], v[228:231], v[76:79], v[60:63]
    v_mfma_f32_16x16x32_bf16 v[64:67], v[228:231], v[80:83], v[64:67]
    s_waitcnt lgkmcnt(2)
    v_mfma_f32_16x16x32_bf16 v[44:47], v[232:235], v[84:87], v[44:47]
    ds_read_b128 v[68:71], v2 offset:0
    v_mfma_f32_16x16x32_bf16 v[48:51], v[232:235], v[88:91], v[48:51]
    v_mfma_f32_16x16x32_bf16 v[56:59], v[236:239], v[88:91], v[56:59]
    v_mfma_f32_16x16x32_bf16 v[52:55], v[236:239], v[84:87], v[52:55]
    ds_read_b128 v[72:75], v2 offset:2048
    v_mfma_f32_16x16x32_bf16 v[60:63], v[240:243], v[84:87], v[60:63]
    v_mfma_f32_16x16x32_bf16 v[64:67], v[240:243], v[88:91], v[64:67]
    s_waitcnt lgkmcnt(2)
    v_mfma_f32_16x16x32_bf16 v[44:47], v[244:247], v[92:95], v[44:47]
    ds_read_b128 v[76:79], v3 offset:0
    v_mfma_f32_16x16x32_bf16 v[48:51], v[244:247], v[96:99], v[48:51]
    v_mfma_f32_16x16x32_bf16 v[56:59], v[248:251], v[96:99], v[56:59]
    v_mfma_f32_16x16x32_bf16 v[52:55], v[248:251], v[92:95], v[52:55]
    ds_read_b128 v[80:83], v3 offset:2048
    v_mfma_f32_16x16x32_bf16 v[60:63], v[252:255], v[92:95], v[60:63]
    s_add_u32 s36, s36, 1
    v_mfma_f32_16x16x32_bf16 v[64:67], v[252:255], v[96:99], v[64:67]
    s_waitcnt lgkmcnt(2)
    s_cmp_lt_u32 s36, 32
    s_cbranch_scc1 L_q_b0
L_q_done:
    s_nop 7
    v_mul_f32 v20, v20, v114
    v_mul_f32 v21, v21, v114
    v_mul_f32 v22, v22, v114
    v_mul_f32 v23, v23, v114
    v_cvt_pk_bf16_f32 v20, v20, v21
    v_cvt_pk_bf16_f32 v21, v22, v23
    ds_write_b64 v7, v[20:21] offset:0
    v_mul_f32 v24, v24, v115
    v_mul_f32 v25, v25, v115
    v_mul_f32 v26, v26, v115
    v_mul_f32 v27, v27, v115
    v_cvt_pk_bf16_f32 v24, v24, v25
    v_cvt_pk_bf16_f32 v25, v26, v27
    ds_write_b64 v7, v[24:25] offset:6144
    v_mul_f32 v28, v28, v114
    v_mul_f32 v29, v29, v114
    v_mul_f32 v30, v30, v114
    v_mul_f32 v31, v31, v114
    v_cvt_pk_bf16_f32 v28, v28, v29
    v_cvt_pk_bf16_f32 v29, v30, v31
    ds_write_b64 v7, v[28:29] offset:1024
    v_mul_f32 v32, v32, v115
    v_mul_f32 v33, v33, v115
    v_mul_f32 v34, v34, v115
    v_mul_f32 v35, v35, v115
    v_cvt_pk_bf16_f32 v32, v32, v33
    v_cvt_pk_bf16_f32 v33, v34, v35
    ds_write_b64 v7, v[32:33] offset:7168
    v_mul_f32 v36, v36, v114
    v_mul_f32 v37, v37, v114
    v_mul_f32 v38, v38, v114
    v_mul_f32 v39, v39, v114
    v_cvt_pk_bf16_f32 v36, v36, v37
    v_cvt_pk_bf16_f32 v37, v38, v39
    ds_write_b64 v8, v[36:37] offset:2048
    v_mul_f32 v40, v40, v115
    v_mul_f32 v41, v41, v115
    v_mul_f32 v42, v42, v115
    v_mul_f32 v43, v43, v115
    v_cvt_pk_bf16_f32 v40, v40, v41
    v_cvt_pk_bf16_f32 v41, v42, v43
    ds_write_b64 v8, v[40:41] offset:8192
    s_waitcnt lgkmcnt(0)
    s_barrier
    ds_read_b128 v[20:23], v10 offset:0
    ds_read_b128 v[24:27], v9 offset:1024
    ds_read_b128 v[28:31], v10 offset:1024
    ds_read_b64_tr_b16 v[32:33], v9 offset:2048
    ds_read_b64_tr_b16 v[34:35], v10 offset:2048
    ds_read_b64_tr_b16 v[36:37], v9 offset:2056
    ds_read_b64_tr_b16 v[38:39], v10 offset:2056
    s_waitcnt lgkmcnt(4)
    v_mfma_f32_16x16x32_bf16 v[40:43], v[24:27], v[20:23], 0
    v_mfma_f32_16x16x32_bf16 v[118:121], v[28:31], v[20:23], 0
    s_nop 5
    v_cndmask_b32 v40, v40, v41, s[56:57]
    v_cndmask_b32 v42, v42, v43, s[56:57]
    v_cndmask_b32 v118, v118, v119, s[56:57]
    v_cndmask_b32 v120, v120, v121, s[56:57]
    v_cndmask_b32 v40, v18, v40, s[62:63]
    v_cndmask_b32 v42, v18, v42, s[62:63]
    v_cndmask_b32 v22, v40, v118, s[58:59]
    v_cndmask_b32 v23, v42, v120, s[60:61]
    v_max_f32 v20, v22, v23
    v_mov_b32 v21, v20
    s_nop 1
    v_permlane16_swap_b32 v20, v21
    v_max_f32 v20, v20, v21
    v_mov_b32 v21, v20
    s_nop 1
    v_permlane32_swap_b32 v20, v21
    v_max_f32 v20, v20, v21
    v_mul_f32 v20, s86, v20
    v_fma_f32 v22, v22, s86, -v20
    v_fma_f32 v23, v23, s86, -v20
    v_exp_f32 v22, v22
    v_exp_f32 v23, v23
    s_nop 0
    v_cvt_pk_bf16_f32 v28, v22, v23
    v_perm_b32 v24, v28, v28, v14
    v_perm_b32 v25, v28, v28, v15
    v_perm_b32 v26, v28, v28, v16
    v_perm_b32 v27, v28, v28, v17
    s_waitcnt lgkmcnt(0)
    v_add_f32 v20, v22, v23
    v_mfma_f32_16x16x32_bf16 v[40:43], v[32:35], v[24:27], 0
    v_mfma_f32_16x16x32_bf16 v[118:121], v[36:39], v[24:27], 0
    v_mov_b32 v21, v20
    s_nop 1
    v_permlane16_swap_b32 v20, v21
    v_add_f32 v20, v20, v21
    v_mov_b32 v21, v20
    s_nop 1
    v_permlane32_swap_b32 v20, v21
    v_add_f32 v20, v20, v21
    v_rcp_f32 v20, v20
    s_nop 0
    v_mul_f32 v40, v40, v20
    v_mul_f32 v41, v41, v20
    v_mul_f32 v42, v42, v20
    v_mul_f32 v43, v43, v20
    v_cvt_pk_bf16_f32 v28, v40, v41
    v_cvt_pk_bf16_f32 v29, v42, v43
    v_mul_f32 v118, v118, v20
    v_mul_f32 v119, v119, v20
    v_mul_f32 v120, v120, v20
    v_mul_f32 v121, v121, v20
    v_cvt_pk_bf16_f32 v30, v118, v119
    v_cvt_pk_bf16_f32 v31, v120, v121
    buffer_store_dwordx4 v[28:31], v1, s[16:19], s44 offen sc1
    s_waitcnt vmcnt(0)
    s_barrier
    buffer_store_dword v124, v124, s[16:19], s91 offen sc1
    s_add_u32 s91, s91, 65536
    s_waitcnt vmcnt(0)
    s_endpgm
L_spin1:
    s_mov_b32 s40, 0x20000
L_spin1_l:
    buffer_load_dword v37, v36, s[20:23], 64 offen sc1
    s_sub_u32 s40, s40, 1
    s_waitcnt vmcnt(0)
    v_cmp_eq_u32 vcc, v36, v37
    s_cbranch_scc1 L_back2
    s_cbranch_vccz L_back2
    s_sleep 8
    s_branch L_spin1_l
L_spin3:
    s_mov_b32 s40, 0x20000
L_spin3_l:
    buffer_load_dword v117, v116, s[20:23], 0 offen sc1
    s_sub_u32 s40, s40, 1
    s_waitcnt vmcnt(0)
    v_cmp_eq_u32 vcc, v116, v117
    s_cbranch_scc1 L_back4
    s_cbranch_vccz L_back4
    s_sleep 8
    s_branch L_spin3_l
L_vspin5:
    s_mov_b32 s40, 0x20000
L_vspin5_l:
    s_cmp_lg_u32 s37, 0
    s_cbranch_scc1 L_restart
    s_sleep 4
    buffer_load_dword v38, v124, s[20:23], 0 offen offset:32 sc1
    s_waitcnt vmcnt(0)
    v_readfirstlane_b32 s37, v38
    s_sub_u32 s40, s40, 1
    s_cbranch_scc1 L_vback6
    s_cmp_lg_u32 s37, s3
    s_cbranch_scc1 L_vspin5_l
    s_branch L_vback6
L_spin7:
    s_mov_b32 s40, 0x20000
L_spin7_l:
    buffer_load_dword v116, v117, s[16:19], 0 offen sc1
    s_sub_u32 s40, s40, 1
    s_waitcnt vmcnt(0)
    v_cmp_ne_u32 vcc, 0, v116
    s_cbranch_scc1 L_back8
    s_cbranch_vccz L_back8
    s_sleep 2
    s_branch L_spin7_l
L_spin9:
    s_mov_b32 s40, 0x20000
L_spin9_l:
    buffer_load_dword v116, v117, s[16:19], 0 offen sc1
    s_sub_u32 s40, s40, 1
    s_waitcnt vmcnt(0)
    v_cmp_ne_u32 vcc, 0, v116
    s_cbranch_scc1 L_back10
    s_cbranch_vccz L_back10
    s_sleep 2
    s_branch L_spin9_l
L_other:
    s_lshr_b32 s48, s2, 3
    s_bitcmp1_b32 s2, 0
    s_cbranch_scc1 L_odd
    v_lshrrev_b32 v6, 2, v0
    v_and_b32 v7, 3, v0
    v_lshlrev_b32 v7, 7, v7
    v_lshl_add_u32 v6, v6, 11, v7
    s_and_b32 s48, s48, 15
    s_lshl2_add_u32 s39, s48, s32
    s_lshl_b32 s39, s39, 15
    s_lshl_b32 s37, s47, 9
    s_add_u32 s39, s39, s37
    s_lshr_b32 s37, s48, 2
    s_lshl_b32 s37, s37, 20
    s_and_b32 s38, s48, 3
    s_lshl2_add_u32 s38, s38, s32
    s_lshl_b32 s38, s38, 13
    s_add_u32 s37, s37, s38
    v_lshlrev_b32 v5, 7, v0
    s_waitcnt lgkmcnt(0)
    s_add_u32 s8, s64, 0xe0000
    s_addc_u32 s9, s65, 0
    s_mov_b32 s10, 0x320000
    s_mov_b32 s11, 0x00020000
    buffer_load_dword v251, v5, s[8:11], s37 offen
    s_mov_b32 s12, s66
    s_mov_b32 s13, s67
    s_mov_b32 s14, 0x600000
    s_mov_b32 s15, 0x00020000
    buffer_load_dword v248, v6, s[12:15], s39 offen
    s_add_u32 s39, s39, 2097152
    buffer_load_dword v249, v6, s[12:15], s39 offen
    s_add_u32 s39, s39, 2097152
    buffer_load_dword v250, v6, s[12:15], s39 offen
    s_add_u32 s39, s39, 2097152
    s_mov_b32 s16, s84
    s_mov_b32 s17, s85
    s_mov_b32 s18, 0x5e00000
    s_mov_b32 s19, 0x00020000
    v_min_u32 v124, 1, v0
    v_lshlrev_b32 v124, 30, v124
    s_lshr_b32 s33, s47, 1
    s_lshl_b32 s33, s33, 1
    s_and_b32 s37, s48, 1
    s_add_u32 s33, s33, s37
    s_and_b32 s35, s47, 1
    s_lshl_b32 s35, s35, 3
    s_lshr_b32 s37, s48, 1
    s_add_u32 s35, s35, s37
    s_add_u32 s34, s35, 24
    s_lshl_b32 s91, s33, 6
    s_add_u32 s91, s91, s34
    s_lshl_b32 s91, s91, 7
    s_add_u32 s91, s91, 0x5520000
    s_cmp_eq_u32 s32, 1
    s_cselect_b32 s91, s91, 0x5f00000
    s_mul_i32 s51, s35, 6
    s_min_u32 s51, s51, 106
    s_lshl_b32 s54, s51, 6
    s_mov_b32 s12, s72
    s_mov_b32 s13, s73
    s_mov_b32 s14, 0x700000
    s_mov_b32 s15, 0x00020000
    s_mov_b32 s39, 7168
    v_lshrrev_b32 v68, 3, v0
    v_lshlrev_b32 v69, 2, v0
    v_and_b32 v69, 64, v69
    v_and_b32 v70, 0x70, v1
    v_xor_b32 v69, v69, v70
    v_mad_u32_u24 v56, v68, s39, v69
    v_add_u32 v57, 57344, v56
    v_add_u32 v58, 128, v56
    v_add_u32 v59, 57472, v56
    v_add_u32 v60, 256, v56
    v_add_u32 v61, 57600, v56
    s_mul_i32 s38, s32, 114688
    s_add_u32 s54, s54, s38
    s_lshl_b32 s42, s32, 11
    s_add_u32 m0, s42, 0
    s_nop 0
    buffer_load_dwordx4 v56, s[12:15], s54 offen lds
    s_add_u32 m0, s42, 1024
    s_nop 0
    buffer_load_dwordx4 v57, s[12:15], s54 offen lds
    s_add_u32 m0, s42, 8192
    s_nop 0
    buffer_load_dwordx4 v58, s[12:15], s54 offen lds
    s_add_u32 m0, s42, 9216
    s_nop 0
    buffer_load_dwordx4 v59, s[12:15], s54 offen lds
    s_add_u32 m0, s42, 16384
    s_nop 0
    buffer_load_dwordx4 v60, s[12:15], s54 offen lds
    s_add_u32 m0, s42, 17408
    s_nop 0
    buffer_load_dwordx4 v61, s[12:15], s54 offen lds
    s_add_u32 s54, s54, 458752
    s_add_u32 m0, s42, 24576
    s_nop 0
    buffer_load_dwordx4 v56, s[12:15], s54 offen lds
    s_add_u32 m0, s42, 25600
    s_nop 0
    buffer_load_dwordx4 v57, s[12:15], s54 offen lds
    s_add_u32 m0, s42, 32768
    s_nop 0
    buffer_load_dwordx4 v58, s[12:15], s54 offen lds
    s_add_u32 m0, s42, 33792
    s_nop 0
    buffer_load_dwordx4 v59, s[12:15], s54 offen lds
    s_add_u32 m0, s42, 40960
    s_nop 0
    buffer_load_dwordx4 v60, s[12:15], s54 offen lds
    s_add_u32 m0, s42, 41984
    s_nop 0
    buffer_load_dwordx4 v61, s[12:15], s54 offen lds
    s_add_u32 s54, s54, 458752
    s_add_u32 m0, s42, 49152
    s_nop 0
    buffer_load_dwordx4 v56, s[12:15], s54 offen lds
    s_add_u32 m0, s42, 50176
    s_nop 0
    buffer_load_dwordx4 v57, s[12:15], s54 offen lds
    s_add_u32 m0, s42, 57344
    s_nop 0
    buffer_load_dwordx4 v58, s[12:15], s54 offen lds
    s_add_u32 m0, s42, 58368
    s_nop 0
    buffer_load_dwordx4 v59, s[12:15], s54 offen lds
    s_add_u32 m0, s42, 65536
    s_nop 0
    buffer_load_dwordx4 v60, s[12:15], s54 offen lds
    s_add_u32 m0, s42, 66560
    s_nop 0
    buffer_load_dwordx4 v61, s[12:15], s54 offen lds
    s_add_u32 s54, s54, 458752
    s_add_u32 m0, s42, 73728
    s_nop 0
    buffer_load_dwordx4 v56, s[12:15], s54 offen lds
    s_add_u32 m0, s42, 74752
    s_nop 0
    buffer_load_dwordx4 v57, s[12:15], s54 offen lds
    s_add_u32 m0, s42, 81920
    s_nop 0
    buffer_load_dwordx4 v58, s[12:15], s54 offen lds
    s_add_u32 m0, s42, 82944
    s_nop 0
    buffer_load_dwordx4 v59, s[12:15], s54 offen lds
    s_add_u32 m0, s42, 90112
    s_nop 0
    buffer_load_dwordx4 v60, s[12:15], s54 offen lds
    s_add_u32 m0, s42, 91136
    s_nop 0
    buffer_load_dwordx4 v61, s[12:15], s54 offen lds
    s_add_u32 s54, s54, 458752
    s_add_u32 m0, s42, 98304
    s_nop 0
    buffer_load_dwordx4 v56, s[12:15], s54 offen lds
    s_add_u32 m0, s42, 99328
    s_nop 0
    buffer_load_dwordx4 v57, s[12:15], s54 offen lds
    s_add_u32 m0, s42, 106496
    s_nop 0
    buffer_load_dwordx4 v58, s[12:15], s54 offen lds
    s_add_u32 m0, s42, 107520
    s_nop 0
    buffer_load_dwordx4 v59, s[12:15], s54 offen lds
    s_add_u32 m0, s42, 114688
    s_nop 0
    buffer_load_dwordx4 v60, s[12:15], s54 offen lds
    s_add_u32 m0, s42, 115712
    s_nop 0
    buffer_load_dwordx4 v61, s[12:15], s54 offen lds
    s_add_u32 s54, s54, 458752
    v_lshrrev_b32 v68, 4, v0
    v_bfe_u32 v69, v0, 2, 2
    v_lshl_add_u32 v68, v68, 3, v69
    v_lshlrev_b32 v68, 7, v68
    v_lshrrev_b32 v69, 1, v69
    v_lshl_add_u32 v68, v69, 6, v68
    v_and_b32 v69, 3, v0
    v_lshl_add_u32 v68, v69, 4, v68
    s_lshr_b32 s37, s32, 1
    s_lshl_b32 s37, s37, 13
    s_and_b32 s38, s32, 1
    s_lshl_b32 s38, s38, 6
    s_add_u32 s37, s37, s38
    s_add_u32 s37, s37, 0
    v_xor_b32 v62, s37, v68
    s_lshr_b32 s37, s32, 1
    s_lshl_b32 s37, s37, 13
    s_and_b32 s38, s32, 1
    s_lshl_b32 s38, s38, 6
    s_add_u32 s37, s37, s38
    s_add_u32 s37, s37, 8
    v_xor_b32 v63, s37, v68
    s_lshr_b32 s37, s32, 1
    s_lshl_b32 s37, s37, 6
    s_and_b32 s38, s32, 1
    s_lshl_b32 s38, s38, 3
    s_add_u32 s37, s37, s38
    s_add_u32 s37, s37, 16384
    v_xor_b32 v64, s37, v68
    v_mov_b32 v68, 0x3f803f80
    v_mov_b32 v69, 0x3f803f80
    v_mov_b32 v70, 0x3f803f80
    v_mov_b32 v71, 0x3f803f80
    v_add_u32 v2, 98304, v1
    s_lshl_b32 s37, s33, 6
    s_add_u32 s37, s37, 16
    s_lshl_b32 s37, s37, 7
    v_lshl_add_u32 v5, v0, 7, s37
    s_cmp_eq_u32 s32, 0
    s_cselect_b32 s37, 8, 0
    v_cmp_le_u32 vcc, s37, v0
    s_nop 1
    v_cndmask_b32 v5, v5, 2.0, vcc
    s_lshl_b32 s43, s32, 12
    s_mul_i32 s41, s33, 2097152
    s_add_u32 s41, s41, 0x800000
    s_add_u32 s41, s41, s43
    s_mul_i32 s90, s33, 8388608
    s_add_u32 s90, s90, 0xfc0000
    s_add_u32 s37, s51, s32
    s_lshl_b32 s37, s37, 11
    s_add_u32 s90, s90, s37
    s_lshl_b32 s37, s32, 10
    s_sub_u32 s87, 8192, s37
    s_lshl_b32 s38, s35, 1
    s_lshr_b32 s39, s32, 1
    s_add_u32 s38, s38, s39
    s_cmp_eq_u32 s38, 36
    s_cselect_b32 s88, 0x5e00000, 0
    s_and_b32 s38, s32, 1
    s_lshl_b32 s38, s38, 3
    s_and_b32 s39, s32, 2
    s_lshl_b32 s39, s39, 10
    s_add_u32 s38, s38, s39
    s_add_u32 s38, s38, 65536
    v_add_u32 v3, s38, v1
    s_add_u32 s37, s37, 65536
    v_add_u32 v4, s37, v1
    v_and_b32 v6, 15, v0
    v_lshlrev_b32 v6, 3, v6
    v_lshrrev_b32 v8, 5, v0
    v_lshl_add_u32 v6, v8, 9, v6
    v_and_b32 v8, 16, v0
    v_lshl_add_u32 v6, v8, 6, v6
    v_add_u32 v118, 73728, v6
    s_mul_i32 s46, s33, 65536
    s_add_u32 s46, s46, 0x5440000
    s_add_u32 s55, s46, 63488
    s_and_b32 s52, s32, 1
    s_lshl_b32 s52, s52, 10
    s_mov_b32 s8, s74
    s_mov_b32 s9, s75
    s_mov_b32 s10, 0x1c00
    s_mov_b32 s11, 0x00020000
    v_and_b32 v8, 0x30, v0
    s_add_u32 s37, s51, s32
    s_lshl_b32 s37, s37, 6
    buffer_load_dwordx4 v[16:19], v8, s[8:11], s37 offen
    s_lshr_b32 s37, s32, 1
    s_add_u32 s37, s37, s51
    s_lshl_b32 s37, s37, 6
    s_and_b32 s38, s32, 1
    s_lshl_b32 s38, s38, 3
    s_add_u32 s37, s37, s38
    buffer_load_dwordx2 v[20:21], v8, s[8:11], s37 offen offset:256
    s_add_u32 s20, s82, 0x80
    s_addc_u32 s21, s83, 0
    s_mov_b32 s22, 0x80
    s_mov_b32 s23, 0x00020000
    v_lshl_add_u32 v72, s32, 7, v124
    v_add_u32 v65, 0, v62
    v_add_u32 v66, 0, v63
    v_add_u32 v67, 0, v64
    s_waitcnt vmcnt(26)
    s_barrier
    ds_read_b64_tr_b16 a[0:1], v65 offset:0
    ds_read_b64_tr_b16 a[2:3], v65 offset:512
    ds_read_b64_tr_b16 a[4:5], v66 offset:0
    ds_read_b64_tr_b16 a[6:7], v66 offset:512
    ds_read_b64_tr_b16 a[8:9], v67 offset:0
    ds_read_b64_tr_b16 a[10:11], v67 offset:512
    ds_read_b64_tr_b16 a[12:13], v65 offset:4096
    ds_read_b64_tr_b16 a[14:15], v65 offset:4608
    ds_read_b64_tr_b16 a[16:17], v66 offset:4096
    ds_read_b64_tr_b16 a[18:19], v66 offset:4608
    ds_read_b64_tr_b16 a[20:21], v67 offset:4096
    ds_read_b64_tr_b16 a[22:23], v67 offset:4608
    s_add_u32 m0, s42, 122880
    s_nop 0
    buffer_load_dwordx4 v56, s[12:15], s54 offen lds
    s_add_u32 m0, s42, 123904
    s_nop 0
    buffer_load_dwordx4 v57, s[12:15], s54 offen lds
    s_add_u32 m0, s42, 131072
    s_nop 0
    buffer_load_dwordx4 v58, s[12:15], s54 offen lds
    s_add_u32 m0, s42, 132096
    s_nop 0
    buffer_load_dwordx4 v59, s[12:15], s54 offen lds
    s_add_u32 m0, s42, 139264
    s_nop 0
    buffer_load_dwordx4 v60, s[12:15], s54 offen lds
    s_add_u32 m0, s42, 140288
    s_nop 0
    buffer_load_dwordx4 v61, s[12:15], s54 offen lds
    s_add_u32 s54, s54, 458752
    s_waitcnt lgkmcnt(0)
    v_mfma_f32_16x16x32_bf16 v[88:91], a[0:3], v[68:71], 0
    v_mfma_f32_16x16x32_bf16 v[92:95], a[4:7], v[68:71], 0
    v_mfma_f32_16x16x32_bf16 v[96:99], a[8:11], v[68:71], 0
    v_mfma_f32_16x16x32_bf16 v[88:91], a[12:15], v[68:71], v[88:91]
    v_mfma_f32_16x16x32_bf16 v[92:95], a[16:19], v[68:71], v[92:95]
    v_mfma_f32_16x16x32_bf16 v[96:99], a[20:23], v[68:71], v[96:99]
    v_add_u32 v65, 24576, v62
    v_add_u32 v66, 24576, v63
    v_add_u32 v67, 24576, v64
    s_waitcnt vmcnt(26)
    s_barrier
    ds_read_b64_tr_b16 a[24:25], v65 offset:0
    ds_read_b64_tr_b16 a[26:27], v65 offset:512
    ds_read_b64_tr_b16 a[28:29], v66 offset:0
    ds_read_b64_tr_b16 a[30:31], v66 offset:512
    ds_read_b64_tr_b16 a[32:33], v67 offset:0
    ds_read_b64_tr_b16 a[34:35], v67 offset:512
    ds_read_b64_tr_b16 a[36:37], v65 offset:4096
    ds_read_b64_tr_b16 a[38:39], v65 offset:4608
    ds_read_b64_tr_b16 a[40:41], v66 offset:4096
    ds_read_b64_tr_b16 a[42:43], v66 offset:4608
    ds_read_b64_tr_b16 a[44:45], v67 offset:4096
    ds_read_b64_tr_b16 a[46:47], v67 offset:4608
    s_add_u32 m0, s42, 0
    s_nop 0
    buffer_load_dwordx4 v56, s[12:15], s54 offen lds
    s_add_u32 m0, s42, 1024
    s_nop 0
    buffer_load_dwordx4 v57, s[12:15], s54 offen lds
    s_add_u32 m0, s42, 8192
    s_nop 0
    buffer_load_dwordx4 v58, s[12:15], s54 offen lds
    s_add_u32 m0, s42, 9216
    s_nop 0
    buffer_load_dwordx4 v59, s[12:15], s54 offen lds
    s_add_u32 m0, s42, 16384
    s_nop 0
    buffer_load_dwordx4 v60, s[12:15], s54 offen lds
    s_add_u32 m0, s42, 17408
    s_nop 0
    buffer_load_dwordx4 v61, s[12:15], s54 offen lds
    s_add_u32 s54, s54, 458752
    s_waitcnt lgkmcnt(0)
    v_mfma_f32_16x16x32_bf16 v[88:91], a[24:27], v[68:71], v[88:91]
    v_mfma_f32_16x16x32_bf16 v[92:95], a[28:31], v[68:71], v[92:95]
    v_mfma_f32_16x16x32_bf16 v[96:99], a[32:35], v[68:71], v[96:99]
    v_mfma_f32_16x16x32_bf16 v[88:91], a[36:39], v[68:71], v[88:91]
    v_mfma_f32_16x16x32_bf16 v[92:95], a[40:43], v[68:71], v[92:95]
    v_mfma_f32_16x16x32_bf16 v[96:99], a[44:47], v[68:71], v[96:99]
    v_add_u32 v65, 49152, v62
    v_add_u32 v66, 49152, v63
    v_add_u32 v67, 49152, v64
    s_waitcnt vmcnt(26)
    s_barrier
    ds_read_b64_tr_b16 a[48:49], v65 offset:0
    ds_read_b64_tr_b16 a[50:51], v65 offset:512
    ds_read_b64_tr_b16 a[52:53], v66 offset:0
    ds_read_b64_tr_b16 a[54:55], v66 offset:512
    ds_read_b64_tr_b16 a[56:57], v67 offset:0
    ds_read_b64_tr_b16 a[58:59], v67 offset:512
    ds_read_b64_tr_b16 a[60:61], v65 offset:4096
    ds_read_b64_tr_b16 a[62:63], v65 offset:4608
    ds_read_b64_tr_b16 a[64:65], v66 offset:4096
    ds_read_b64_tr_b16 a[66:67], v66 offset:4608
    ds_read_b64_tr_b16 a[68:69], v67 offset:4096
    ds_read_b64_tr_b16 a[70:71], v67 offset:4608
    s_add_u32 m0, s42, 24576
    s_nop 0
    buffer_load_dwordx4 v56, s[12:15], s54 offen lds
    s_add_u32 m0, s42, 25600
    s_nop 0
    buffer_load_dwordx4 v57, s[12:15], s54 offen lds
    s_add_u32 m0, s42, 32768
    s_nop 0
    buffer_load_dwordx4 v58, s[12:15], s54 offen lds
    s_add_u32 m0, s42, 33792
    s_nop 0
    buffer_load_dwordx4 v59, s[12:15], s54 offen lds
    s_add_u32 m0, s42, 40960
    s_nop 0
    buffer_load_dwordx4 v60, s[12:15], s54 offen lds
    s_add_u32 m0, s42, 41984
    s_nop 0
    buffer_load_dwordx4 v61, s[12:15], s54 offen lds
    s_add_u32 s54, s54, 458752
    s_waitcnt lgkmcnt(0)
    v_mfma_f32_16x16x32_bf16 v[88:91], a[48:51], v[68:71], v[88:91]
    v_mfma_f32_16x16x32_bf16 v[92:95], a[52:55], v[68:71], v[92:95]
    v_mfma_f32_16x16x32_bf16 v[96:99], a[56:59], v[68:71], v[96:99]
    v_mfma_f32_16x16x32_bf16 v[88:91], a[60:63], v[68:71], v[88:91]
    v_mfma_f32_16x16x32_bf16 v[92:95], a[64:67], v[68:71], v[92:95]
    v_mfma_f32_16x16x32_bf16 v[96:99], a[68:71], v[68:71], v[96:99]
    v_add_u32 v65, 73728, v62
    v_add_u32 v66, 73728, v63
    v_add_u32 v67, 73728, v64
    s_waitcnt vmcnt(26)
    s_barrier
    ds_read_b64_tr_b16 a[72:73], v65 offset:0
    ds_read_b64_tr_b16 a[74:75], v65 offset:512
    ds_read_b64_tr_b16 a[76:77], v66 offset:0
    ds_read_b64_tr_b16 a[78:79], v66 offset:512
    ds_read_b64_tr_b16 a[80:81], v67 offset:0
    ds_read_b64_tr_b16 a[82:83], v67 offset:512
    ds_read_b64_tr_b16 a[84:85], v65 offset:4096
    ds_read_b64_tr_b16 a[86:87], v65 offset:4608
    ds_read_b64_tr_b16 a[88:89], v66 offset:4096
    ds_read_b64_tr_b16 a[90:91], v66 offset:4608
    ds_read_b64_tr_b16 a[92:93], v67 offset:4096
    ds_read_b64_tr_b16 a[94:95], v67 offset:4608
    s_add_u32 m0, s42, 49152
    s_nop 0
    buffer_load_dwordx4 v56, s[12:15], s54 offen lds
    s_add_u32 m0, s42, 50176
    s_nop 0
    buffer_load_dwordx4 v57, s[12:15], s54 offen lds
    s_add_u32 m0, s42, 57344
    s_nop 0
    buffer_load_dwordx4 v58, s[12:15], s54 offen lds
    s_add_u32 m0, s42, 58368
    s_nop 0
    buffer_load_dwordx4 v59, s[12:15], s54 offen lds
    s_add_u32 m0, s42, 65536
    s_nop 0
    buffer_load_dwordx4 v60, s[12:15], s54 offen lds
    s_add_u32 m0, s42, 66560
    s_nop 0
    buffer_load_dwordx4 v61, s[12:15], s54 offen lds
    s_add_u32 s54, s54, 458752
    s_waitcnt lgkmcnt(0)
    v_mfma_f32_16x16x32_bf16 v[88:91], a[72:75], v[68:71], v[88:91]
    v_mfma_f32_16x16x32_bf16 v[92:95], a[76:79], v[68:71], v[92:95]
    v_mfma_f32_16x16x32_bf16 v[96:99], a[80:83], v[68:71], v[96:99]
    v_mfma_f32_16x16x32_bf16 v[88:91], a[84:87], v[68:71], v[88:91]
    v_mfma_f32_16x16x32_bf16 v[92:95], a[88:91], v[68:71], v[92:95]
    v_mfma_f32_16x16x32_bf16 v[96:99], a[92:95], v[68:71], v[96:99]
    v_add_u32 v65, 98304, v62
    v_add_u32 v66, 98304, v63
    v_add_u32 v67, 98304, v64
    s_waitcnt vmcnt(26)
    s_barrier
    ds_read_b64_tr_b16 a[96:97], v65 offset:0
    ds_read_b64_tr_b16 a[98:99], v65 offset:512
    ds_read_b64_tr_b16 a[100:101], v66 offset:0
    ds_read_b64_tr_b16 a[102:103], v66 offset:512
    ds_read_b64_tr_b16 a[104:105], v67 offset:0
    ds_read_b64_tr_b16 a[106:107], v67 offset:512
    ds_read_b64_tr_b16 a[108:109], v65 offset:4096
    ds_read_b64_tr_b16 a[110:111], v65 offset:4608
    ds_read_b64_tr_b16 a[112:113], v66 offset:4096
    ds_read_b64_tr_b16 a[114:115], v66 offset:4608
    ds_read_b64_tr_b16 a[116:117], v67 offset:4096
    ds_read_b64_tr_b16 a[118:119], v67 offset:4608
    s_add_u32 m0, s42, 73728
    s_nop 0
    buffer_load_dwordx4 v56, s[12:15], s54 offen lds
    s_add_u32 m0, s42, 74752
    s_nop 0
    buffer_load_dwordx4 v57, s[12:15], s54 offen lds
    s_add_u32 m0, s42, 81920
    s_nop 0
    buffer_load_dwordx4 v58, s[12:15], s54 offen lds
    s_add_u32 m0, s42, 82944
    s_nop 0
    buffer_load_dwordx4 v59, s[12:15], s54 offen lds
    s_add_u32 m0, s42, 90112
    s_nop 0
    buffer_load_dwordx4 v60, s[12:15], s54 offen lds
    s_add_u32 m0, s42, 91136
    s_nop 0
    buffer_load_dwordx4 v61, s[12:15], s54 offen lds
    s_add_u32 s54, s54, 458752
    s_waitcnt lgkmcnt(0)
    v_mfma_f32_16x16x32_bf16 v[88:91], a[96:99], v[68:71], v[88:91]
    v_mfma_f32_16x16x32_bf16 v[92:95], a[100:103], v[68:71], v[92:95]
    v_mfma_f32_16x16x32_bf16 v[96:99], a[104:107], v[68:71], v[96:99]
    v_mfma_f32_16x16x32_bf16 v[88:91], a[108:111], v[68:71], v[88:91]
    v_mfma_f32_16x16x32_bf16 v[92:95], a[112:115], v[68:71], v[92:95]
    v_mfma_f32_16x16x32_bf16 v[96:99], a[116:119], v[68:71], v[96:99]
    v_add_u32 v65, 122880, v62
    v_add_u32 v66, 122880, v63
    v_add_u32 v67, 122880, v64
    s_waitcnt vmcnt(24)
    s_barrier
    ds_read_b64_tr_b16 a[120:121], v65 offset:0
    ds_read_b64_tr_b16 a[122:123], v65 offset:512
    ds_read_b64_tr_b16 a[124:125], v66 offset:0
    ds_read_b64_tr_b16 a[126:127], v66 offset:512
    ds_read_b64_tr_b16 a[128:129], v67 offset:0
    ds_read_b64_tr_b16 a[130:131], v67 offset:512
    ds_read_b64_tr_b16 a[132:133], v65 offset:4096
    ds_read_b64_tr_b16 a[134:135], v65 offset:4608
    ds_read_b64_tr_b16 a[136:137], v66 offset:4096
    ds_read_b64_tr_b16 a[138:139], v66 offset:4608
    ds_read_b64_tr_b16 a[140:141], v67 offset:4096
    ds_read_b64_tr_b16 a[142:143], v67 offset:4608
    s_add_u32 m0, s42, 98304
    s_nop 0
    buffer_load_dwordx4 v56, s[12:15], s54 offen lds
    s_add_u32 m0, s42, 99328
    s_nop 0
    buffer_load_dwordx4 v57, s[12:15], s54 offen lds
    s_add_u32 m0, s42, 106496
    s_nop 0
    buffer_load_dwordx4 v58, s[12:15], s54 offen lds
    s_add_u32 m0, s42, 107520
    s_nop 0
    buffer_load_dwordx4 v59, s[12:15], s54 offen lds
    s_add_u32 m0, s42, 114688
    s_nop 0
    buffer_load_dwordx4 v60, s[12:15], s54 offen lds
    s_add_u32 m0, s42, 115712
    s_nop 0
    buffer_load_dwordx4 v61, s[12:15], s54 offen lds
    s_add_u32 s54, s54, 458752
    s_waitcnt lgkmcnt(0)
    v_mfma_f32_16x16x32_bf16 v[88:91], a[120:123], v[68:71], v[88:91]
    v_mfma_f32_16x16x32_bf16 v[92:95], a[124:127], v[68:71], v[92:95]
    v_mfma_f32_16x16x32_bf16 v[96:99], a[128:131], v[68:71], v[96:99]
    v_mfma_f32_16x16x32_bf16 v[88:91], a[132:135], v[68:71], v[88:91]
    v_mfma_f32_16x16x32_bf16 v[92:95], a[136:139], v[68:71], v[92:95]
    v_mfma_f32_16x16x32_bf16 v[96:99], a[140:143], v[68:71], v[96:99]
    v_add_u32 v65, 0, v62
    v_add_u32 v66, 0, v63
    v_add_u32 v67, 0, v64
    s_waitcnt vmcnt(24)
    s_barrier
    ds_read_b64_tr_b16 a[144:145], v65 offset:0
    ds_read_b64_tr_b16 a[146:147], v65 offset:512
    ds_read_b64_tr_b16 a[148:149], v66 offset:0
    ds_read_b64_tr_b16 a[150:151], v66 offset:512
    ds_read_b64_tr_b16 a[152:153], v67 offset:0
    ds_read_b64_tr_b16 a[154:155], v67 offset:512
    ds_read_b64_tr_b16 a[156:157], v65 offset:4096
    ds_read_b64_tr_b16 a[158:159], v65 offset:4608
    ds_read_b64_tr_b16 a[160:161], v66 offset:4096
    ds_read_b64_tr_b16 a[162:163], v66 offset:4608
    ds_read_b64_tr_b16 a[164:165], v67 offset:4096
    ds_read_b64_tr_b16 a[166:167], v67 offset:4608
    s_add_u32 m0, s42, 122880
    s_nop 0
    buffer_load_dwordx4 v56, s[12:15], s54 offen lds
    s_add_u32 m0, s42, 123904
    s_nop 0
    buffer_load_dwordx4 v57, s[12:15], s54 offen lds
    s_add_u32 m0, s42, 131072
    s_nop 0
    buffer_load_dwordx4 v58, s[12:15], s54 offen lds
    s_add_u32 m0, s42, 132096
    s_nop 0
    buffer_load_dwordx4 v59, s[12:15], s54 offen lds
    s_add_u32 m0, s42, 139264
    s_nop 0
    buffer_load_dwordx4 v60, s[12:15], s54 offen lds
    s_add_u32 m0, s42, 140288
    s_nop 0
    buffer_load_dwordx4 v61, s[12:15], s54 offen lds
    s_add_u32 s54, s54, 458752
    s_waitcnt lgkmcnt(0)
    v_mfma_f32_16x16x32_bf16 v[88:91], a[144:147], v[68:71], v[88:91]
    v_mfma_f32_16x16x32_bf16 v[92:95], a[148:151], v[68:71], v[92:95]
    v_mfma_f32_16x16x32_bf16 v[96:99], a[152:155], v[68:71], v[96:99]
    v_mfma_f32_16x16x32_bf16 v[88:91], a[156:159], v[68:71], v[88:91]
    v_mfma_f32_16x16x32_bf16 v[92:95], a[160:163], v[68:71], v[92:95]
    v_mfma_f32_16x16x32_bf16 v[96:99], a[164:167], v[68:71], v[96:99]
    v_add_u32 v65, 24576, v62
    v_add_u32 v66, 24576, v63
    v_add_u32 v67, 24576, v64
    s_waitcnt vmcnt(24)
    s_barrier
    ds_read_b64_tr_b16 a[168:169], v65 offset:0
    ds_read_b64_tr_b16 a[170:171], v65 offset:512
    ds_read_b64_tr_b16 a[172:173], v66 offset:0
    ds_read_b64_tr_b16 a[174:175], v66 offset:512
    ds_read_b64_tr_b16 a[176:177], v67 offset:0
    ds_read_b64_tr_b16 a[178:179], v67 offset:512
    ds_read_b64_tr_b16 a[180:181], v65 offset:4096
    ds_read_b64_tr_b16 a[182:183], v65 offset:4608
    ds_read_b64_tr_b16 a[184:185], v66 offset:4096
    ds_read_b64_tr_b16 a[186:187], v66 offset:4608
    ds_read_b64_tr_b16 a[188:189], v67 offset:4096
    ds_read_b64_tr_b16 a[190:191], v67 offset:4608
    s_add_u32 m0, s42, 0
    s_nop 0
    buffer_load_dwordx4 v56, s[12:15], s54 offen lds
    s_add_u32 m0, s42, 1024
    s_nop 0
    buffer_load_dwordx4 v57, s[12:15], s54 offen lds
    s_add_u32 m0, s42, 8192
    s_nop 0
    buffer_load_dwordx4 v58, s[12:15], s54 offen lds
    s_add_u32 m0, s42, 9216
    s_nop 0
    buffer_load_dwordx4 v59, s[12:15], s54 offen lds
    s_add_u32 m0, s42, 16384
    s_nop 0
    buffer_load_dwordx4 v60, s[12:15], s54 offen lds
    s_add_u32 m0, s42, 17408
    s_nop 0
    buffer_load_dwordx4 v61, s[12:15], s54 offen lds
    s_add_u32 s54, s54, 458752
    s_waitcnt lgkmcnt(0)
    v_mfma_f32_16x16x32_bf16 v[88:91], a[168:171], v[68:71], v[88:91]
    v_mfma_f32_16x16x32_bf16 v[92:95], a[172:175], v[68:71], v[92:95]
    v_mfma_f32_16x16x32_bf16 v[96:99], a[176:179], v[68:71], v[96:99]
    v_mfma_f32_16x16x32_bf16 v[88:91], a[180:183], v[68:71], v[88:91]
    v_mfma_f32_16x16x32_bf16 v[92:95], a[184:187], v[68:71], v[92:95]
    v_mfma_f32_16x16x32_bf16 v[96:99], a[188:191], v[68:71], v[96:99]
    v_add_u32 v65, 49152, v62
    v_add_u32 v66, 49152, v63
    v_add_u32 v67, 49152, v64
    s_waitcnt vmcnt(24)
    s_barrier
    ds_read_b64_tr_b16 a[192:193], v65 offset:0
    ds_read_b64_tr_b16 a[194:195], v65 offset:512
    ds_read_b64_tr_b16 a[196:197], v66 offset:0
    ds_read_b64_tr_b16 a[198:199], v66 offset:512
    ds_read_b64_tr_b16 a[200:201], v67 offset:0
    ds_read_b64_tr_b16 a[202:203], v67 offset:512
    ds_read_b64_tr_b16 a[204:205], v65 offset:4096
    ds_read_b64_tr_b16 a[206:207], v65 offset:4608
    ds_read_b64_tr_b16 a[208:209], v66 offset:4096
    ds_read_b64_tr_b16 a[210:211], v66 offset:4608
    ds_read_b64_tr_b16 a[212:213], v67 offset:4096
    ds_read_b64_tr_b16 a[214:215], v67 offset:4608
    s_add_u32 m0, s42, 24576
    s_nop 0
    buffer_load_dwordx4 v56, s[12:15], s54 offen lds
    s_add_u32 m0, s42, 25600
    s_nop 0
    buffer_load_dwordx4 v57, s[12:15], s54 offen lds
    s_add_u32 m0, s42, 32768
    s_nop 0
    buffer_load_dwordx4 v58, s[12:15], s54 offen lds
    s_add_u32 m0, s42, 33792
    s_nop 0
    buffer_load_dwordx4 v59, s[12:15], s54 offen lds
    s_add_u32 m0, s42, 40960
    s_nop 0
    buffer_load_dwordx4 v60, s[12:15], s54 offen lds
    s_add_u32 m0, s42, 41984
    s_nop 0
    buffer_load_dwordx4 v61, s[12:15], s54 offen lds
    s_add_u32 s54, s54, 458752
    s_waitcnt lgkmcnt(0)
    v_mfma_f32_16x16x32_bf16 v[88:91], a[192:195], v[68:71], v[88:91]
    v_mfma_f32_16x16x32_bf16 v[92:95], a[196:199], v[68:71], v[92:95]
    v_mfma_f32_16x16x32_bf16 v[96:99], a[200:203], v[68:71], v[96:99]
    v_mfma_f32_16x16x32_bf16 v[88:91], a[204:207], v[68:71], v[88:91]
    v_mfma_f32_16x16x32_bf16 v[92:95], a[208:211], v[68:71], v[92:95]
    v_mfma_f32_16x16x32_bf16 v[96:99], a[212:215], v[68:71], v[96:99]
    v_add_u32 v65, 73728, v62
    v_add_u32 v66, 73728, v63
    v_add_u32 v67, 73728, v64
    s_waitcnt vmcnt(24)
    s_barrier
    ds_read_b64_tr_b16 a[216:217], v65 offset:0
    ds_read_b64_tr_b16 a[218:219], v65 offset:512
    ds_read_b64_tr_b16 a[220:221], v66 offset:0
    ds_read_b64_tr_b16 a[222:223], v66 offset:512
    ds_read_b64_tr_b16 a[224:225], v67 offset:0
    ds_read_b64_tr_b16 a[226:227], v67 offset:512
    ds_read_b64_tr_b16 a[228:229], v65 offset:4096
    ds_read_b64_tr_b16 a[230:231], v65 offset:4608
    ds_read_b64_tr_b16 a[232:233], v66 offset:4096
    ds_read_b64_tr_b16 a[234:235], v66 offset:4608
    ds_read_b64_tr_b16 a[236:237], v67 offset:4096
    ds_read_b64_tr_b16 a[238:239], v67 offset:4608
    s_add_u32 m0, s42, 49152
    s_nop 0
    buffer_load_dwordx4 v56, s[12:15], s54 offen lds
    s_add_u32 m0, s42, 50176
    s_nop 0
    buffer_load_dwordx4 v57, s[12:15], s54 offen lds
    s_add_u32 m0, s42, 57344
    s_nop 0
    buffer_load_dwordx4 v58, s[12:15], s54 offen lds
    s_add_u32 m0, s42, 58368
    s_nop 0
    buffer_load_dwordx4 v59, s[12:15], s54 offen lds
    s_add_u32 m0, s42, 65536
    s_nop 0
    buffer_load_dwordx4 v60, s[12:15], s54 offen lds
    s_add_u32 m0, s42, 66560
    s_nop 0
    buffer_load_dwordx4 v61, s[12:15], s54 offen lds
    s_add_u32 s54, s54, 458752
    s_waitcnt lgkmcnt(0)
    v_mfma_f32_16x16x32_bf16 v[88:91], a[216:219], v[68:71], v[88:91]
    v_mfma_f32_16x16x32_bf16 v[92:95], a[220:223], v[68:71], v[92:95]
    v_mfma_f32_16x16x32_bf16 v[96:99], a[224:227], v[68:71], v[96:99]
    v_mfma_f32_16x16x32_bf16 v[88:91], a[228:231], v[68:71], v[88:91]
    v_mfma_f32_16x16x32_bf16 v[92:95], a[232:235], v[68:71], v[92:95]
    v_mfma_f32_16x16x32_bf16 v[96:99], a[236:239], v[68:71], v[96:99]
    v_add_u32 v65, 98304, v62
    v_add_u32 v66, 98304, v63
    v_add_u32 v67, 98304, v64
    s_waitcnt vmcnt(24)
    s_barrier
    ds_read_b64_tr_b16 a[240:241], v65 offset:0
    ds_read_b64_tr_b16 a[242:243], v65 offset:512
    ds_read_b64_tr_b16 a[244:245], v66 offset:0
    ds_read_b64_tr_b16 a[246:247], v66 offset:512
    ds_read_b64_tr_b16 a[248:249], v67 offset:0
    ds_read_b64_tr_b16 a[250:251], v67 offset:512
    ds_read_b64_tr_b16 a[252:253], v65 offset:4096
    ds_read_b64_tr_b16 a[254:255], v65 offset:4608
    ds_read_b64_tr_b16 v[128:129], v66 offset:4096
    ds_read_b64_tr_b16 v[130:131], v66 offset:4608
    ds_read_b64_tr_b16 v[132:133], v67 offset:4096
    ds_read_b64_tr_b16 v[134:135], v67 offset:4608
    buffer_load_dword v74, v124, s[20:23], 0 offen offset:32 sc1
    buffer_load_dword v73, v72, s[20:23], 0 offen sc1
    s_add_u32 m0, s42, 73728
    s_nop 0
    buffer_load_dwordx4 v56, s[12:15], s54 offen lds
    s_add_u32 m0, s42, 74752
    s_nop 0
    buffer_load_dwordx4 v57, s[12:15], s54 offen lds
    s_add_u32 m0, s42, 81920
    s_nop 0
    buffer_load_dwordx4 v58, s[12:15], s54 offen lds
    s_add_u32 m0, s42, 82944
    s_nop 0
    buffer_load_dwordx4 v59, s[12:15], s54 offen lds
    s_add_u32 m0, s42, 90112
    s_nop 0
    buffer_load_dwordx4 v60, s[12:15], s54 offen lds
    s_add_u32 m0, s42, 91136
    s_nop 0
    buffer_load_dwordx4 v61, s[12:15], s54 offen lds
    s_add_u32 s54, s54, 458752
    s_waitcnt lgkmcnt(0)
    v_mfma_f32_16x16x32_bf16 v[88:91], a[240:243], v[68:71], v[88:91]
    v_mfma_f32_16x16x32_bf16 v[92:95], a[244:247], v[68:71], v[92:95]
    v_mfma_f32_16x16x32_bf16 v[96:99], a[248:251], v[68:71], v[96:99]
    v_mfma_f32_16x16x32_bf16 v[88:91], a[252:255], v[68:71], v[88:91]
    v_mfma_f32_16x16x32_bf16 v[92:95], v[128:131], v[68:71], v[92:95]
    v_mfma_f32_16x16x32_bf16 v[96:99], v[132:135], v[68:71], v[96:99]
    v_add_u32 v65, 122880, v62
    v_add_u32 v66, 122880, v63
    v_add_u32 v67, 122880, v64
    s_waitcnt vmcnt(26)
    s_barrier
    ds_read_b64_tr_b16 v[136:137], v65 offset:0
    ds_read_b64_tr_b16 v[138:139], v65 offset:512
    ds_read_b64_tr_b16 v[140:141], v66 offset:0
    ds_read_b64_tr_b16 v[142:143], v66 offset:512
    ds_read_b64_tr_b16 v[144:145], v67 offset:0
    ds_read_b64_tr_b16 v[146:147], v67 offset:512
    ds_read_b64_tr_b16 v[148:149], v65 offset:4096
    ds_read_b64_tr_b16 v[150:151], v65 offset:4608
    ds_read_b64_tr_b16 v[152:153], v66 offset:4096
    ds_read_b64_tr_b16 v[154:155], v66 offset:4608
    ds_read_b64_tr_b16 v[156:157], v67 offset:4096
    ds_read_b64_tr_b16 v[158:159], v67 offset:4608
    s_waitcnt lgkmcnt(0)
    v_mfma_f32_16x16x32_bf16 v[88:91], v[136:139], v[68:71], v[88:91]
    v_mfma_f32_16x16x32_bf16 v[92:95], v[140:143], v[68:71], v[92:95]
    v_mfma_f32_16x16x32_bf16 v[96:99], v[144:147], v[68:71], v[96:99]
    v_mfma_f32_16x16x32_bf16 v[88:91], v[148:151], v[68:71], v[88:91]
    v_mfma_f32_16x16x32_bf16 v[92:95], v[152:155], v[68:71], v[92:95]
    v_mfma_f32_16x16x32_bf16 v[96:99], v[156:159], v[68:71], v[96:99]
    v_add_u32 v65, 0, v62
    v_add_u32 v66, 0, v63
    v_add_u32 v67, 0, v64
    s_waitcnt vmcnt(20)
    s_barrier
    ds_read_b64_tr_b16 v[160:161], v65 offset:0
    ds_read_b64_tr_b16 v[162:163], v65 offset:512
    ds_read_b64_tr_b16 v[164:165], v66 offset:0
    ds_read_b64_tr_b16 v[166:167], v66 offset:512
    ds_read_b64_tr_b16 v[168:169], v67 offset:0
    ds_read_b64_tr_b16 v[170:171], v67 offset:512
    ds_read_b64_tr_b16 v[172:173], v65 offset:4096
    ds_read_b64_tr_b16 v[174:175], v65 offset:4608
    ds_read_b64_tr_b16 v[176:177], v66 offset:4096
    ds_read_b64_tr_b16 v[178:179], v66 offset:4608
    ds_read_b64_tr_b16 v[180:181], v67 offset:4096
    ds_read_b64_tr_b16 v[182:183], v67 offset:4608
    s_waitcnt lgkmcnt(0)
    v_mfma_f32_16x16x32_bf16 v[88:91], v[160:163], v[68:71], v[88:91]
    v_mfma_f32_16x16x32_bf16 v[92:95], v[164:167], v[68:71], v[92:95]
    v_mfma_f32_16x16x32_bf16 v[96:99], v[168:171], v[68:71], v[96:99]
    v_mfma_f32_16x16x32_bf16 v[88:91], v[172:175], v[68:71], v[88:91]
    v_mfma_f32_16x16x32_bf16 v[92:95], v[176:179], v[68:71], v[92:95]
    v_mfma_f32_16x16x32_bf16 v[96:99], v[180:183], v[68:71], v[96:99]
    v_add_u32 v65, 24576, v62
    v_add_u32 v66, 24576, v63
    v_add_u32 v67, 24576, v64
    s_waitcnt vmcnt(14)
    s_barrier
    ds_read_b64_tr_b16 v[184:185], v65 offset:0
    ds_read_b64_tr_b16 v[186:187], v65 offset:512
    ds_read_b64_tr_b16 v[188:189], v66 offset:0
    ds_read_b64_tr_b16 v[190:191], v66 offset:512
    ds_read_b64_tr_b16 v[192:193], v67 offset:0
    ds_read_b64_tr_b16 v[194:195], v67 offset:512
    ds_read_b64_tr_b16 v[196:197], v65 offset:4096
    ds_read_b64_tr_b16 v[198:199], v65 offset:4608
    ds_read_b64_tr_b16 v[200:201], v66 offset:4096
    ds_read_b64_tr_b16 v[202:203], v66 offset:4608
    ds_read_b64_tr_b16 v[204:205], v67 offset:4096
    ds_read_b64_tr_b16 v[206:207], v67 offset:4608
    s_waitcnt lgkmcnt(0)
    v_mfma_f32_16x16x32_bf16 v[88:91], v[184:187], v[68:71], v[88:91]
    v_mfma_f32_16x16x32_bf16 v[92:95], v[188:191], v[68:71], v[92:95]
    v_mfma_f32_16x16x32_bf16 v[96:99], v[192:195], v[68:71], v[96:99]
    v_mfma_f32_16x16x32_bf16 v[88:91], v[196:199], v[68:71], v[88:91]
    v_mfma_f32_16x16x32_bf16 v[92:95], v[200:203], v[68:71], v[92:95]
    v_mfma_f32_16x16x32_bf16 v[96:99], v[204:207], v[68:71], v[96:99]
    v_add_u32 v65, 49152, v62
    v_add_u32 v66, 49152, v63
    v_add_u32 v67, 49152, v64
    s_waitcnt vmcnt(8)
    s_barrier
    ds_read_b64_tr_b16 v[208:209], v65 offset:0
    ds_read_b64_tr_b16 v[210:211], v65 offset:512
    ds_read_b64_tr_b16 v[212:213], v66 offset:0
    ds_read_b64_tr_b16 v[214:215], v66 offset:512
    ds_read_b64_tr_b16 v[216:217], v67 offset:0
    ds_read_b64_tr_b16 v[218:219], v67 offset:512
    ds_read_b64_tr_b16 v[220:221], v65 offset:4096
    ds_read_b64_tr_b16 v[222:223], v65 offset:4608
    ds_read_b64_tr_b16 v[224:225], v66 offset:4096
    ds_read_b64_tr_b16 v[226:227], v66 offset:4608
    ds_read_b64_tr_b16 v[228:229], v67 offset:4096
    ds_read_b64_tr_b16 v[230:231], v67 offset:4608
    s_waitcnt lgkmcnt(0)
    v_mfma_f32_16x16x32_bf16 v[88:91], v[208:211], v[68:71], v[88:91]
    v_mfma_f32_16x16x32_bf16 v[92:95], v[212:215], v[68:71], v[92:95]
    v_mfma_f32_16x16x32_bf16 v[96:99], v[216:219], v[68:71], v[96:99]
    v_mfma_f32_16x16x32_bf16 v[88:91], v[220:223], v[68:71], v[88:91]
    v_mfma_f32_16x16x32_bf16 v[92:95], v[224:227], v[68:71], v[92:95]
    v_mfma_f32_16x16x32_bf16 v[96:99], v[228:231], v[68:71], v[96:99]
    v_add_u32 v65, 73728, v62
    v_add_u32 v66, 73728, v63
    v_add_u32 v67, 73728, v64
    s_waitcnt vmcnt(0)
    v_readfirstlane_b32 s37, v74
    s_nop 0
    s_cmp_lg_u32 s37, s3
    s_cbranch_scc1 L_vspin11
L_vback12:
    v_cmp_eq_u32 vcc, v72, v73
    s_cbranch_vccnz L_spin13
L_back14:
    s_barrier
    ds_read_b64_tr_b16 v[232:233], v65 offset:0
    ds_read_b64_tr_b16 v[234:235], v65 offset:512
    ds_read_b64_tr_b16 v[236:237], v66 offset:0
    ds_read_b64_tr_b16 v[238:239], v66 offset:512
    ds_read_b64_tr_b16 v[240:241], v67 offset:0
    ds_read_b64_tr_b16 v[242:243], v67 offset:512
    ds_read_b64_tr_b16 v[244:245], v65 offset:4096
    ds_read_b64_tr_b16 v[246:247], v65 offset:4608
    ds_read_b64_tr_b16 v[248:249], v66 offset:4096
    ds_read_b64_tr_b16 v[250:251], v66 offset:4608
    ds_read_b64_tr_b16 v[252:253], v67 offset:4096
    ds_read_b64_tr_b16 v[254:255], v67 offset:4608
    s_waitcnt lgkmcnt(0)
    v_mfma_f32_16x16x32_bf16 v[88:91], v[232:235], v[68:71], v[88:91]
    v_mfma_f32_16x16x32_bf16 v[92:95], v[236:239], v[68:71], v[92:95]
    v_mfma_f32_16x16x32_bf16 v[96:99], v[240:243], v[68:71], v[96:99]
    v_mfma_f32_16x16x32_bf16 v[88:91], v[244:247], v[68:71], v[88:91]
    v_mfma_f32_16x16x32_bf16 v[92:95], v[248:251], v[68:71], v[92:95]
    v_mfma_f32_16x16x32_bf16 v[96:99], v[252:255], v[68:71], v[96:99]
    s_barrier
    s_mov_b32 s37, 0xffff0000
    v_lshlrev_b32 v100, 16, v16
    v_and_b32 v101, s37, v16
    v_lshlrev_b32 v102, 16, v17
    v_and_b32 v103, s37, v17
    v_lshlrev_b32 v104, 16, v18
    v_and_b32 v105, s37, v18
    v_lshlrev_b32 v106, 16, v19
    v_and_b32 v107, s37, v19
    v_lshlrev_b32 v108, 16, v20
    v_and_b32 v109, s37, v20
    v_lshlrev_b32 v110, 16, v21
    v_and_b32 v111, s37, v21
    s_add_u32 s96, s41, 2031616
    s_mov_b32 s98, s41
    s_mov_b32 s45, 0x5530000
    buffer_load_dword v7, v5, s[16:19], s45 offen sc1
    s_waitcnt vmcnt(0)
    v_cmp_ne_u32 vcc, 0, v7
    s_cbranch_vccnz L_spin15
L_back16:
    s_barrier
    s_mov_b32 s39, 0x5e00000
    s_add_u32 m0, s43, 0
    s_add_u32 s42, s41, 0
    buffer_load_dwordx4 v1, s[16:19], s42 offen offset:0 sc1 lds
    buffer_load_dwordx4 v1, s[16:19], s42 offen offset:1024 sc1 lds
    buffer_load_dwordx4 v1, s[16:19], s42 offen offset:2048 sc1 lds
    buffer_load_dwordx4 v1, s[16:19], s42 offen offset:3072 sc1 lds
    s_add_u32 m0, s43, 16384
    s_add_u32 s42, s41, 16384
    buffer_load_dwordx4 v1, s[16:19], s42 offen offset:0 sc1 lds
    buffer_load_dwordx4 v1, s[16:19], s42 offen offset:1024 sc1 lds
    buffer_load_dwordx4 v1, s[16:19], s42 offen offset:2048 sc1 lds
    buffer_load_dwordx4 v1, s[16:19], s42 offen offset:3072 sc1 lds
    s_add_u32 m0, s43, 32768
    s_add_u32 s42, s41, 32768
    buffer_load_dwordx4 v1, s[16:19], s42 offen offset:0 sc1 lds
    buffer_load_dwordx4 v1, s[16:19], s42 offen offset:1024 sc1 lds
    buffer_load_dwordx4 v1, s[16:19], s42 offen offset:2048 sc1 lds
    buffer_store_dword v124, v124, s[16:19], s39 offen
    buffer_load_dwordx4 v1, s[16:19], s42 offen offset:3072 sc1 lds
    s_add_u32 m0, s43, 49152
    s_add_u32 s42, s41, 49152
    buffer_load_dwordx4 v1, s[16:19], s42 offen offset:0 sc1 lds
    buffer_load_dwordx4 v1, s[16:19], s42 offen offset:1024 sc1 lds
    buffer_load_dwordx4 v1, s[16:19], s42 offen offset:2048 sc1 lds
    buffer_load_dwordx4 v1, s[16:19], s42 offen offset:3072 sc1 lds
    s_add_u32 m0, s52, 73728
    s_add_u32 s42, s46, s52
    buffer_load_dwordx4 v1, s[16:19], s42 offen sc1 lds
    s_add_u32 s38, s45, 65536
    buffer_load_dword v7, v5, s[16:19], s38 offen sc1
    s_add_u32 s45, s45, 65536
    s_waitcnt vmcnt(15) lgkmcnt(0)
    s_barrier
    ds_read_b128 v[56:59], v1 offset:0
    ds_read_b128 v[60:63], v1 offset:1024
    ds_read_b128 v[64:67], v1 offset:2048
    ds_read_b128 v[68:71], v1 offset:3072
    s_mov_b32 s36, 0
    s_waitcnt lgkmcnt(0)
    s_nop 7
L_a_b0:
    v_mfma_f32_16x16x32_bf16 v[8:11], a[0:3], v[56:59], 0
    s_and_b32 s44, s90, 0xffffffff
    ds_read_b128 v[72:75], v1 offset:4096
    v_mul_f32 v120, v48, v116
    v_mfma_f32_16x16x32_bf16 v[16:19], a[0:3], v[60:63], 0
    s_cmp_lt_i32 s36, 1
    v_mul_f32 v121, v49, v116
    v_mul_f32 v120, v120, abs(v48)
    v_mfma_f32_16x16x32_bf16 v[20:23], a[4:7], v[60:63], 0
    s_cselect_b32 s44, 0x5e00000, s44
    v_mul_f32 v121, v121, abs(v49)
    v_cvt_pk_bf16_f32 v48, v120, v121
    v_mfma_f32_16x16x32_bf16 v[12:15], a[4:7], v[56:59], 0
    s_add_u32 s49, s44, s87
    ds_read_b128 v[76:79], v1 offset:5120
    v_pk_max_i16 v48, v48, 0
    v_mfma_f32_16x16x32_bf16 v[24:27], a[8:11], v[56:59], 0
    s_max_u32 s44, s44, s88
    v_mul_f32 v120, v50, v116
    v_mul_f32 v121, v51, v116
    v_mfma_f32_16x16x32_bf16 v[28:31], a[8:11], v[60:63], 0
    s_waitcnt lgkmcnt(2)
    v_mul_f32 v120, v120, abs(v50)
    v_mul_f32 v121, v121, abs(v51)
    v_mfma_f32_16x16x32_bf16 v[8:11], a[12:15], v[64:67], v[8:11]
    s_add_u32 s90, s90, 262144
    ds_read_b128 v[80:83], v1 offset:6144
    v_cvt_pk_bf16_f32 v49, v120, v121
    v_mfma_f32_16x16x32_bf16 v[16:19], a[12:15], v[68:71], v[16:19]
    s_add_u32 s98, s98, 65536
    v_pk_max_i16 v49, v49, 0
    s_min_i32 s98, s98, s96
    v_mfma_f32_16x16x32_bf16 v[20:23], a[16:19], v[68:71], v[20:23]
    s_and_b32 s41, s98, 0xffffffff
    ds_write_b64 v3, v[48:49] offset:4096
    v_mfma_f32_16x16x32_bf16 v[12:15], a[16:19], v[64:67], v[12:15]
    ds_read_b128 v[84:87], v1 offset:7168
    v_mul_f32 v120, v52, v117
    v_mfma_f32_16x16x32_bf16 v[24:27], a[20:23], v[64:67], v[24:27]
    v_mul_f32 v121, v53, v117
    v_mul_f32 v120, v120, abs(v52)
    v_mfma_f32_16x16x32_bf16 v[28:31], a[20:23], v[68:71], v[28:31]
    s_waitcnt lgkmcnt(3)
    v_mul_f32 v121, v121, abs(v53)
    v_cvt_pk_bf16_f32 v52, v120, v121
    v_mfma_f32_16x16x32_bf16 v[8:11], a[24:27], v[72:75], v[8:11]
    ds_read_b128 v[56:59], v1 offset:8192
    v_pk_max_i16 v52, v52, 0
    v_mfma_f32_16x16x32_bf16 v[16:19], a[24:27], v[76:79], v[16:19]
    v_mul_f32 v120, v54, v117
    v_mul_f32 v121, v55, v117
    v_mfma_f32_16x16x32_bf16 v[20:23], a[28:31], v[76:79], v[20:23]
    v_mul_f32 v120, v120, abs(v54)
    v_mul_f32 v121, v121, abs(v55)
    v_mfma_f32_16x16x32_bf16 v[12:15], a[28:31], v[72:75], v[12:15]
    ds_read_b128 v[60:63], v1 offset:9216
    v_cvt_pk_bf16_f32 v53, v120, v121
    v_mfma_f32_16x16x32_bf16 v[24:27], a[32:35], v[72:75], v[24:27]
    v_pk_max_i16 v53, v53, 0
    v_mfma_f32_16x16x32_bf16 v[28:31], a[32:35], v[76:79], v[28:31]
    s_waitcnt lgkmcnt(2)
    ds_write_b64 v3, v[52:53] offset:5120
    v_mfma_f32_16x16x32_bf16 v[8:11], a[36:39], v[80:83], v[8:11]
    ds_read_b128 v[64:67], v1 offset:10240
    v_mul_f32 v120, v32, v116
    v_mfma_f32_16x16x32_bf16 v[16:19], a[36:39], v[84:87], v[16:19]
    v_mul_f32 v121, v33, v116
    v_mul_f32 v120, v120, abs(v32)
    v_mfma_f32_16x16x32_bf16 v[20:23], a[40:43], v[84:87], v[20:23]
    v_mul_f32 v121, v121, abs(v33)
    v_cvt_pk_bf16_f32 v32, v120, v121
    v_mfma_f32_16x16x32_bf16 v[12:15], a[40:43], v[80:83], v[12:15]
    ds_read_b128 v[68:71], v1 offset:11264
    v_pk_max_i16 v32, v32, 0
    v_mfma_f32_16x16x32_bf16 v[24:27], a[44:47], v[80:83], v[24:27]
    v_mul_f32 v120, v34, v116
    v_mul_f32 v121, v35, v116
    v_mfma_f32_16x16x32_bf16 v[28:31], a[44:47], v[84:87], v[28:31]
    s_waitcnt lgkmcnt(3)
    v_mul_f32 v120, v120, abs(v34)
    v_mul_f32 v121, v121, abs(v35)
    v_mfma_f32_16x16x32_bf16 v[8:11], a[48:51], v[56:59], v[8:11]
    ds_read_b128 v[72:75], v1 offset:12288
    v_cvt_pk_bf16_f32 v33, v120, v121
    v_mfma_f32_16x16x32_bf16 v[16:19], a[48:51], v[60:63], v[16:19]
    s_waitcnt vmcnt(0)
    v_cmp_ne_u32 vcc, 0, v7
    v_pk_max_i16 v33, v33, 0
    v_mfma_f32_16x16x32_bf16 v[20:23], a[52:55], v[60:63], v[20:23]
    v_mul_f32 v120, v36, v116
    v_mul_f32 v121, v37, v116
    v_mfma_f32_16x16x32_bf16 v[12:15], a[52:55], v[56:59], v[12:15]
    s_cbranch_vccnz L_spin17
L_back18:
    ds_read_b128 v[76:79], v1 offset:13312
    v_mul_f32 v120, v120, abs(v36)
    v_mfma_f32_16x16x32_bf16 v[24:27], a[56:59], v[56:59], v[24:27]
    s_waitcnt lgkmcnt(4)
    v_mul_f32 v121, v121, abs(v37)
    v_cvt_pk_bf16_f32 v34, v120, v121
    v_mfma_f32_16x16x32_bf16 v[28:31], a[56:59], v[60:63], v[28:31]
    s_waitcnt lgkmcnt(2)
    v_pk_max_i16 v34, v34, 0
    v_mul_f32 v120, v38, v116
    v_mfma_f32_16x16x32_bf16 v[8:11], a[60:63], v[64:67], v[8:11]
    s_barrier
    ds_read_b128 v[80:83], v1 offset:14336
    v_mul_f32 v121, v39, v116
    v_mfma_f32_16x16x32_bf16 v[16:19], a[60:63], v[68:71], v[16:19]
    s_add_u32 s45, s45, 65536
    ds_read_b128 v[48:51], v4 offset:4096
    v_mul_f32 v120, v120, abs(v38)
    v_mfma_f32_16x16x32_bf16 v[20:23], a[64:67], v[68:71], v[20:23]
    v_mul_f32 v121, v121, abs(v39)
    v_cvt_pk_bf16_f32 v35, v120, v121
    v_mfma_f32_16x16x32_bf16 v[12:15], a[64:67], v[64:67], v[12:15]
    ds_read_b128 v[84:87], v1 offset:15360
    v_pk_max_i16 v35, v35, 0
    v_mfma_f32_16x16x32_bf16 v[24:27], a[68:71], v[64:67], v[24:27]
    buffer_store_dwordx4 v[32:35], v1, s[16:19], s44 offen offset:0 sc1
    v_mfma_f32_16x16x32_bf16 v[28:31], a[68:71], v[68:71], v[28:31]
    s_waitcnt lgkmcnt(3)
    v_mul_f32 v120, v40, v117
    v_mul_f32 v121, v41, v117
    v_mfma_f32_16x16x32_bf16 v[8:11], a[72:75], v[72:75], v[8:11]
    s_waitcnt lgkmcnt(1)
    ds_read_b128 v[56:59], v1 offset:16384
    v_mul_f32 v120, v120, abs(v40)
    v_mfma_f32_16x16x32_bf16 v[16:19], a[72:75], v[76:79], v[16:19]
    buffer_store_dwordx4 v[48:51], v1, s[16:19], s49 offen sc1
    v_mfma_f32_16x16x32_bf16 v[20:23], a[76:79], v[76:79], v[20:23]
    v_mul_f32 v121, v121, abs(v41)
    v_cvt_pk_bf16_f32 v40, v120, v121
    v_mfma_f32_16x16x32_bf16 v[12:15], a[76:79], v[72:75], v[12:15]
    ds_read_b128 v[60:63], v1 offset:17408
    v_pk_max_i16 v40, v40, 0
    v_mfma_f32_16x16x32_bf16 v[24:27], a[80:83], v[72:75], v[24:27]
    v_mul_f32 v120, v42, v117
    v_mul_f32 v121, v43, v117
    v_mfma_f32_16x16x32_bf16 v[28:31], a[80:83], v[76:79], v[28:31]
    s_waitcnt lgkmcnt(2)
    v_mul_f32 v120, v120, abs(v42)
    v_mul_f32 v121, v121, abs(v43)
    v_mfma_f32_16x16x32_bf16 v[8:11], a[84:87], v[80:83], v[8:11]
    ds_read_b128 v[64:67], v1 offset:18432
    v_cvt_pk_bf16_f32 v41, v120, v121
    v_mfma_f32_16x16x32_bf16 v[16:19], a[84:87], v[84:87], v[16:19]
    v_pk_max_i16 v41, v41, 0
    v_mul_f32 v120, v44, v117
    v_mfma_f32_16x16x32_bf16 v[20:23], a[88:91], v[84:87], v[20:23]
    v_mul_f32 v121, v45, v117
    v_mul_f32 v120, v120, abs(v44)
    v_mfma_f32_16x16x32_bf16 v[12:15], a[88:91], v[80:83], v[12:15]
    ds_read_b128 v[68:71], v1 offset:19456
    v_mul_f32 v121, v121, abs(v45)
    v_mfma_f32_16x16x32_bf16 v[24:27], a[92:95], v[80:83], v[24:27]
    v_cvt_pk_bf16_f32 v42, v120, v121
    v_pk_max_i16 v42, v42, 0
    v_mfma_f32_16x16x32_bf16 v[28:31], a[92:95], v[84:87], v[28:31]
    s_waitcnt lgkmcnt(2)
    v_mul_f32 v120, v46, v117
    v_mul_f32 v121, v47, v117
    v_mfma_f32_16x16x32_bf16 v[8:11], a[96:99], v[56:59], v[8:11]
    ds_read_b128 v[72:75], v1 offset:20480
    v_mul_f32 v120, v120, abs(v46)
    v_mfma_f32_16x16x32_bf16 v[16:19], a[96:99], v[60:63], v[16:19]
    v_mul_f32 v121, v121, abs(v47)
    v_cvt_pk_bf16_f32 v43, v120, v121
    v_mfma_f32_16x16x32_bf16 v[20:23], a[100:103], v[60:63], v[20:23]
    v_pk_max_i16 v43, v43, 0
    v_mfma_f32_16x16x32_bf16 v[12:15], a[100:103], v[56:59], v[12:15]
    ds_read_b128 v[76:79], v1 offset:21504
    v_mfma_f32_16x16x32_bf16 v[24:27], a[104:107], v[56:59], v[24:27]
    buffer_store_dwordx4 v[40:43], v1, s[16:19], s44 offen offset:1024 sc1
    v_mfma_f32_16x16x32_bf16 v[28:31], a[104:107], v[60:63], v[28:31]
    s_waitcnt lgkmcnt(2)
    ds_read_b64 v[36:37], v118 offset:0
    s_add_u32 m0, s43, 98304
    v_mfma_f32_16x16x32_bf16 v[8:11], a[108:111], v[64:67], v[8:11]
    s_add_u32 s42, s41, 0
    ds_read_b128 v[80:83], v1 offset:22528
    v_mfma_f32_16x16x32_bf16 v[16:19], a[108:111], v[68:71], v[16:19]
    buffer_load_dwordx4 v1, s[16:19], s42 offen offset:0 sc1 lds
    v_mfma_f32_16x16x32_bf16 v[20:23], a[112:115], v[68:71], v[20:23]
    ds_read_b64 v[38:39], v118 offset:128
    v_mfma_f32_16x16x32_bf16 v[12:15], a[112:115], v[64:67], v[12:15]
    ds_read_b128 v[84:87], v1 offset:23552
    v_mfma_f32_16x16x32_bf16 v[24:27], a[116:119], v[64:67], v[24:27]
    ds_read_b64 v[40:41], v118 offset:256
    v_mfma_f32_16x16x32_bf16 v[28:31], a[116:119], v[68:71], v[28:31]
    s_waitcnt lgkmcnt(5)
    ds_read_b64 v[42:43], v118 offset:384
    v_mfma_f32_16x16x32_bf16 v[8:11], a[120:123], v[72:75], v[8:11]
    ds_read_b128 v[56:59], v1 offset:24576
    v_mfma_f32_16x16x32_bf16 v[16:19], a[120:123], v[76:79], v[16:19]
    buffer_load_dwordx4 v1, s[16:19], s42 offen offset:1024 sc1 lds
    v_mfma_f32_16x16x32_bf16 v[20:23], a[124:127], v[76:79], v[20:23]
    v_mfma_f32_16x16x32_bf16 v[12:15], a[124:127], v[72:75], v[12:15]
    ds_read_b128 v[60:63], v1 offset:25600
    v_mfma_f32_16x16x32_bf16 v[24:27], a[128:131], v[72:75], v[24:27]
    s_waitcnt lgkmcnt(2)
    v_max3_u32 v44, v36, v37, v38
    v_max3_u32 v45, v39, v40, v41
    v_mfma_f32_16x16x32_bf16 v[28:31], a[128:131], v[76:79], v[28:31]
    s_waitcnt lgkmcnt(4)
    v_max3_u32 v44, v44, v42, v43
    v_max_u32 v44, v44, v45
    v_mfma_f32_16x16x32_bf16 v[8:11], a[132:135], v[80:83], v[8:11]
    ds_read_b128 v[64:67], v1 offset:26624
    v_cmp_eq_u32 vcc, -1, v44
    v_mfma_f32_16x16x32_bf16 v[16:19], a[132:135], v[84:87], v[16:19]
    buffer_load_dwordx4 v1, s[16:19], s42 offen offset:2048 sc1 lds
    v_mfma_f32_16x16x32_bf16 v[20:23], a[136:139], v[84:87], v[20:23]
    s_cbranch_vccnz L_sspin19
L_sback20:
    v_add_f32 v44, v40, v42
    v_add_f32 v45, v41, v43
    v_mfma_f32_16x16x32_bf16 v[12:15], a[136:139], v[80:83], v[12:15]
    ds_read_b128 v[68:71], v1 offset:27648
    v_add_f32 v36, v36, v38
    v_mfma_f32_16x16x32_bf16 v[24:27], a[140:143], v[80:83], v[24:27]
    v_add_f32 v37, v37, v39
    v_add_f32 v36, v36, v44
    v_mfma_f32_16x16x32_bf16 v[28:31], a[140:143], v[84:87], v[28:31]
    s_waitcnt lgkmcnt(2)
    v_add_f32 v37, v37, v45
    v_mov_b32 v44, v36
    v_mfma_f32_16x16x32_bf16 v[8:11], a[144:147], v[56:59], v[8:11]
    ds_read_b128 v[72:75], v1 offset:28672
    v_mov_b32 v45, v37
    v_mfma_f32_16x16x32_bf16 v[16:19], a[144:147], v[60:63], v[16:19]
    buffer_load_dwordx4 v1, s[16:19], s42 offen offset:3072 sc1 lds
    v_mfma_f32_16x16x32_bf16 v[20:23], a[148:151], v[60:63], v[20:23]
    s_add_u32 m0, s43, 114688
    v_permlane32_swap_b32 v36, v44
    v_mfma_f32_16x16x32_bf16 v[12:15], a[148:151], v[56:59], v[12:15]
    s_add_u32 s42, s41, 16384
    ds_read_b128 v[76:79], v1 offset:29696
    v_mfma_f32_16x16x32_bf16 v[24:27], a[152:155], v[56:59], v[24:27]
    v_permlane32_swap_b32 v37, v45
    v_mfma_f32_16x16x32_bf16 v[28:31], a[152:155], v[60:63], v[28:31]
    s_waitcnt lgkmcnt(2)
    v_add_f32 v36, v36, v44
    v_add_f32 v37, v37, v45
    v_mfma_f32_16x16x32_bf16 v[8:11], a[156:159], v[64:67], v[8:11]
    ds_read_b128 v[80:83], v1 offset:30720
    v_mul_f32 v112, 0xba800000, v36
    v_mfma_f32_16x16x32_bf16 v[16:19], a[156:159], v[68:71], v[16:19]
    buffer_load_dwordx4 v1, s[16:19], s42 offen offset:0 sc1 lds
    v_mfma_f32_16x16x32_bf16 v[20:23], a[160:163], v[68:71], v[20:23]
    v_mul_f32 v37, 0x3a800000, v37
    v_fma_f32 v37, -v112, v112, v37
    v_mfma_f32_16x16x32_bf16 v[12:15], a[160:163], v[64:67], v[12:15]
    ds_read_b128 v[84:87], v1 offset:31744
    v_mov_b32 v113, v112
    v_mfma_f32_16x16x32_bf16 v[24:27], a[164:167], v[64:67], v[24:27]
    v_max_f32 v37, 0, v37
    v_add_f32 v37, 0x3727c5ac, v37
    v_mfma_f32_16x16x32_bf16 v[28:31], a[164:167], v[68:71], v[28:31]
    s_waitcnt lgkmcnt(2)
    v_rsq_f32 v116, v37
    v_mfma_f32_16x16x32_bf16 v[8:11], a[168:171], v[72:75], v[8:11]
    ds_read_b128 v[56:59], v1 offset:32768
    v_mfma_f32_16x16x32_bf16 v[16:19], a[168:171], v[76:79], v[16:19]
    buffer_load_dwordx4 v1, s[16:19], s42 offen offset:1024 sc1 lds
    v_mfma_f32_16x16x32_bf16 v[20:23], a[172:175], v[76:79], v[20:23]
    v_permlane16_swap_b32 v112, v113
    v_mfma_f32_16x16x32_bf16 v[12:15], a[172:175], v[72:75], v[12:15]
    s_nop 0
    ds_read_b128 v[60:63], v1 offset:33792
    v_mul_f32 v114, v37, v116
    v_mfma_f32_16x16x32_bf16 v[24:27], a[176:179], v[72:75], v[24:27]
    v_mul_f32 v116, v116, v116
    v_mov_b32 v115, v114
    v_mfma_f32_16x16x32_bf16 v[28:31], a[176:179], v[76:79], v[28:31]
    s_waitcnt lgkmcnt(2)
    v_mov_b32 v117, v116
    v_fmac_f32 v16, v113, v88
    v_mfma_f32_16x16x32_bf16 v[8:11], a[180:183], v[80:83], v[8:11]
    ds_read_b128 v[64:67], v1 offset:34816
    v_fmac_f32 v12, v112, v92
    v_mfma_f32_16x16x32_bf16 v[16:19], a[180:183], v[84:87], v[16:19]
    buffer_load_dwordx4 v1, s[16:19], s42 offen offset:2048 sc1 lds
    v_mfma_f32_16x16x32_bf16 v[20:23], a[184:187], v[84:87], v[20:23]
    v_permlane16_swap_b32 v114, v115
    v_mfma_f32_16x16x32_bf16 v[12:15], a[184:187], v[80:83], v[12:15]
    s_nop 0
    ds_read_b128 v[68:71], v1 offset:35840
    v_fmac_f32 v8, v112, v88
    v_mfma_f32_16x16x32_bf16 v[24:27], a[188:191], v[80:83], v[24:27]
    v_permlane16_swap_b32 v116, v117
    v_mfma_f32_16x16x32_bf16 v[28:31], a[188:191], v[84:87], v[28:31]
    s_waitcnt lgkmcnt(2)
    v_fmac_f32 v17, v113, v89
    v_fmac_f32 v18, v113, v90
    v_mfma_f32_16x16x32_bf16 v[8:11], a[192:195], v[56:59], v[8:11]
    s_add_u32 s46, s46, 2048
    ds_read_b128 v[72:75], v1 offset:36864
    v_fmac_f32 v13, v112, v93
    v_mfma_f32_16x16x32_bf16 v[16:19], a[192:195], v[60:63], v[16:19]
    buffer_load_dwordx4 v1, s[16:19], s42 offen offset:3072 sc1 lds
    v_mfma_f32_16x16x32_bf16 v[20:23], a[196:199], v[60:63], v[20:23]
    s_add_u32 m0, s43, 131072
    v_fmac_f32 v9, v112, v89
    v_fmac_f32 v10, v112, v90
    v_mfma_f32_16x16x32_bf16 v[12:15], a[196:199], v[56:59], v[12:15]
    s_add_u32 s42, s41, 32768
    ds_read_b128 v[76:79], v1 offset:37888
    v_fmac_f32 v11, v112, v91
    v_mfma_f32_16x16x32_bf16 v[24:27], a[200:203], v[56:59], v[24:27]
    s_min_u32 s46, s46, s55
    v_fmac_f32 v8, v114, v100
    v_fmac_f32 v9, v114, v101
    v_mfma_f32_16x16x32_bf16 v[28:31], a[200:203], v[60:63], v[28:31]
    s_waitcnt lgkmcnt(2)
    v_fmac_f32 v19, v113, v91
    v_fmac_f32 v16, v115, v100
    v_mfma_f32_16x16x32_bf16 v[8:11], a[204:207], v[64:67], v[8:11]
    ds_read_b128 v[80:83], v1 offset:38912
    v_fmac_f32 v14, v112, v94
    v_mfma_f32_16x16x32_bf16 v[16:19], a[204:207], v[68:71], v[16:19]
    buffer_load_dwordx4 v1, s[16:19], s42 offen offset:0 sc1 lds
    v_mfma_f32_16x16x32_bf16 v[20:23], a[208:211], v[68:71], v[20:23]
    v_fmac_f32 v24, v112, v96
    v_fmac_f32 v10, v114, v102
    v_mfma_f32_16x16x32_bf16 v[12:15], a[208:211], v[64:67], v[12:15]
    ds_read_b128 v[84:87], v1 offset:39936
    v_fmac_f32 v11, v114, v103
    v_mfma_f32_16x16x32_bf16 v[24:27], a[212:215], v[64:67], v[24:27]
    v_fmac_f32 v17, v115, v101
    v_fmac_f32 v18, v115, v102
    v_mfma_f32_16x16x32_bf16 v[28:31], a[212:215], v[68:71], v[28:31]
    s_waitcnt lgkmcnt(2)
    v_fmac_f32 v19, v115, v103
    v_fmac_f32 v15, v112, v95
    v_mfma_f32_16x16x32_bf16 v[8:11], a[216:219], v[72:75], v[8:11]
    ds_read_b128 v[56:59], v1 offset:40960
    v_fmac_f32 v12, v114, v104
    v_mfma_f32_16x16x32_bf16 v[16:19], a[216:219], v[76:79], v[16:19]
    buffer_load_dwordx4 v1, s[16:19], s42 offen offset:1024 sc1 lds
    v_mfma_f32_16x16x32_bf16 v[20:23], a[220:223], v[76:79], v[20:23]
    v_fmac_f32 v25, v112, v97
    v_fmac_f32 v26, v112, v98
    v_mfma_f32_16x16x32_bf16 v[12:15], a[220:223], v[72:75], v[12:15]
    ds_read_b128 v[60:63], v1 offset:41984
    v_fmac_f32 v28, v113, v96
    v_mfma_f32_16x16x32_bf16 v[24:27], a[224:227], v[72:75], v[24:27]
    v_fmac_f32 v20, v113, v92
    v_fmac_f32 v21, v113, v93
    v_mfma_f32_16x16x32_bf16 v[28:31], a[224:227], v[76:79], v[28:31]
    s_waitcnt lgkmcnt(2)
    v_fmac_f32 v13, v114, v105
    v_fmac_f32 v14, v114, v106
    v_mfma_f32_16x16x32_bf16 v[8:11], a[228:231], v[80:83], v[8:11]
    ds_read_b128 v[64:67], v1 offset:43008
    v_fmac_f32 v15, v114, v107
    v_mfma_f32_16x16x32_bf16 v[16:19], a[228:231], v[84:87], v[16:19]
    buffer_load_dwordx4 v1, s[16:19], s42 offen offset:2048 sc1 lds
    v_mfma_f32_16x16x32_bf16 v[20:23], a[232:235], v[84:87], v[20:23]
    v_fmac_f32 v27, v112, v99
    v_fmac_f32 v24, v114, v108
    v_mfma_f32_16x16x32_bf16 v[12:15], a[232:235], v[80:83], v[12:15]
    ds_read_b128 v[68:71], v1 offset:44032
    v_fmac_f32 v29, v113, v97
    v_mfma_f32_16x16x32_bf16 v[24:27], a[236:239], v[80:83], v[24:27]
    s_waitcnt vmcnt(7)
    v_fmac_f32 v22, v113, v94
    v_fmac_f32 v23, v113, v95
    v_mfma_f32_16x16x32_bf16 v[28:31], a[236:239], v[84:87], v[28:31]
    s_waitcnt lgkmcnt(2)
    v_fmac_f32 v20, v115, v104
    v_fmac_f32 v21, v115, v105
    v_mfma_f32_16x16x32_bf16 v[8:11], a[240:243], v[56:59], v[8:11]
    s_barrier
    ds_read_b128 v[72:75], v1 offset:45056
    v_fmac_f32 v22, v115, v106
    v_mfma_f32_16x16x32_bf16 v[16:19], a[240:243], v[60:63], v[16:19]
    buffer_store_dword v124, v124, s[16:19], s91 offen sc1
    v_mfma_f32_16x16x32_bf16 v[20:23], a[244:247], v[60:63], v[20:23]
    buffer_load_dwordx4 v1, s[16:19], s42 offen offset:3072 sc1 lds
    v_mfma_f32_16x16x32_bf16 v[12:15], a[244:247], v[56:59], v[12:15]
    s_add_u32 s91, s91, 65536
    ds_read_b128 v[76:79], v1 offset:46080
    v_fmac_f32 v30, v113, v98
    v_mfma_f32_16x16x32_bf16 v[24:27], a[248:251], v[56:59], v[24:27]
    s_add_u32 m0, s43, 147456
    v_fmac_f32 v23, v115, v107
    s_add_u32 s42, s41, 49152
    v_mfma_f32_16x16x32_bf16 v[28:31], a[248:251], v[60:63], v[28:31]
    s_waitcnt lgkmcnt(2)
    v_mfma_f32_16x16x32_bf16 v[8:11], a[252:255], v[64:67], v[8:11]
    ds_read_b128 v[80:83], v1 offset:47104
    v_fmac_f32 v25, v114, v109
    v_mfma_f32_16x16x32_bf16 v[16:19], a[252:255], v[68:71], v[16:19]
    v_fmac_f32 v26, v114, v110
    v_fmac_f32 v27, v114, v111
    v_mfma_f32_16x16x32_bf16 v[20:23], v[128:131], v[68:71], v[20:23]
    buffer_load_dwordx4 v1, s[16:19], s42 offen offset:0 sc1 lds
    v_mfma_f32_16x16x32_bf16 v[12:15], v[128:131], v[64:67], v[12:15]
    ds_read_b128 v[84:87], v1 offset:48128
    v_fmac_f32 v31, v113, v99
    v_mfma_f32_16x16x32_bf16 v[24:27], v[132:135], v[64:67], v[24:27]
    v_mfma_f32_16x16x32_bf16 v[28:31], v[132:135], v[68:71], v[28:31]
    s_waitcnt lgkmcnt(2)
    v_mfma_f32_16x16x32_bf16 v[8:11], v[136:139], v[72:75], v[8:11]
    ds_read_b128 v[56:59], v1 offset:49152
    v_mfma_f32_16x16x32_bf16 v[16:19], v[136:139], v[76:79], v[16:19]
    v_mfma_f32_16x16x32_bf16 v[20:23], v[140:143], v[76:79], v[20:23]
    buffer_load_dwordx4 v1, s[16:19], s42 offen offset:1024 sc1 lds
    v_mfma_f32_16x16x32_bf16 v[12:15], v[140:143], v[72:75], v[12:15]
    ds_read_b128 v[60:63], v1 offset:50176
    v_fmac_f32 v28, v115, v108
    v_mfma_f32_16x16x32_bf16 v[24:27], v[144:147], v[72:75], v[24:27]
    v_mfma_f32_16x16x32_bf16 v[28:31], v[144:147], v[76:79], v[28:31]
    s_waitcnt lgkmcnt(2)
    v_mfma_f32_16x16x32_bf16 v[8:11], v[148:151], v[80:83], v[8:11]
    ds_read_b128 v[64:67], v1 offset:51200
    v_mfma_f32_16x16x32_bf16 v[16:19], v[148:151], v[84:87], v[16:19]
    v_mfma_f32_16x16x32_bf16 v[20:23], v[152:155], v[84:87], v[20:23]
    buffer_load_dwordx4 v1, s[16:19], s42 offen offset:2048 sc1 lds
    v_mfma_f32_16x16x32_bf16 v[12:15], v[152:155], v[80:83], v[12:15]
    ds_read_b128 v[68:71], v1 offset:52224
    v_fmac_f32 v29, v115, v109
    v_mfma_f32_16x16x32_bf16 v[24:27], v[156:159], v[80:83], v[24:27]
    v_mfma_f32_16x16x32_bf16 v[28:31], v[156:159], v[84:87], v[28:31]
    s_waitcnt lgkmcnt(2)
    v_mfma_f32_16x16x32_bf16 v[8:11], v[160:163], v[56:59], v[8:11]
    ds_read_b128 v[72:75], v1 offset:53248
    v_mfma_f32_16x16x32_bf16 v[16:19], v[160:163], v[60:63], v[16:19]
    v_mfma_f32_16x16x32_bf16 v[20:23], v[164:167], v[60:63], v[20:23]
    buffer_load_dwordx4 v1, s[16:19], s42 offen offset:3072 sc1 lds
    v_mfma_f32_16x16x32_bf16 v[12:15], v[164:167], v[56:59], v[12:15]
    s_add_u32 m0, s52, 73728
    ds_read_b128 v[76:79], v1 offset:54272
    v_fmac_f32 v30, v115, v110
    v_mfma_f32_16x16x32_bf16 v[24:27], v[168:171], v[56:59], v[24:27]
    s_add_u32 s42, s46, s52
    v_mfma_f32_16x16x32_bf16 v[28:31], v[168:171], v[60:63], v[28:31]
    s_waitcnt lgkmcnt(2)
    v_mfma_f32_16x16x32_bf16 v[8:11], v[172:175], v[64:67], v[8:11]
    ds_read_b128 v[80:83], v1 offset:55296
    v_mfma_f32_16x16x32_bf16 v[16:19], v[172:175], v[68:71], v[16:19]
    buffer_load_dwordx4 v1, s[16:19], s42 offen sc1 lds
    v_mfma_f32_16x16x32_bf16 v[20:23], v[176:179], v[68:71], v[20:23]
    v_fmac_f32 v31, v115, v111
    v_mfma_f32_16x16x32_bf16 v[12:15], v[176:179], v[64:67], v[12:15]
    ds_read_b128 v[84:87], v1 offset:56320
    v_mfma_f32_16x16x32_bf16 v[24:27], v[180:183], v[64:67], v[24:27]
    v_mfma_f32_16x16x32_bf16 v[28:31], v[180:183], v[68:71], v[28:31]
    s_waitcnt lgkmcnt(2)
    v_mfma_f32_16x16x32_bf16 v[8:11], v[184:187], v[72:75], v[8:11]
    ds_read_b128 v[56:59], v1 offset:57344
    v_mfma_f32_16x16x32_bf16 v[16:19], v[184:187], v[76:79], v[16:19]
    v_mfma_f32_16x16x32_bf16 v[20:23], v[188:191], v[76:79], v[20:23]
    v_mfma_f32_16x16x32_bf16 v[12:15], v[188:191], v[72:75], v[12:15]
    ds_read_b128 v[60:63], v1 offset:58368
    v_mfma_f32_16x16x32_bf16 v[24:27], v[192:195], v[72:75], v[24:27]
    v_mfma_f32_16x16x32_bf16 v[28:31], v[192:195], v[76:79], v[28:31]
    s_waitcnt lgkmcnt(2)
    v_mfma_f32_16x16x32_bf16 v[8:11], v[196:199], v[80:83], v[8:11]
    ds_read_b128 v[64:67], v1 offset:59392
    v_mfma_f32_16x16x32_bf16 v[16:19], v[196:199], v[84:87], v[16:19]
    v_mfma_f32_16x16x32_bf16 v[20:23], v[200:203], v[84:87], v[20:23]
    v_mfma_f32_16x16x32_bf16 v[12:15], v[200:203], v[80:83], v[12:15]
    ds_read_b128 v[68:71], v1 offset:60416
    v_mfma_f32_16x16x32_bf16 v[24:27], v[204:207], v[80:83], v[24:27]
    v_mfma_f32_16x16x32_bf16 v[28:31], v[204:207], v[84:87], v[28:31]
    s_waitcnt lgkmcnt(2)
    v_mfma_f32_16x16x32_bf16 v[8:11], v[208:211], v[56:59], v[8:11]
    ds_read_b128 v[72:75], v1 offset:61440
    v_mfma_f32_16x16x32_bf16 v[16:19], v[208:211], v[60:63], v[16:19]
    v_mfma_f32_16x16x32_bf16 v[20:23], v[212:215], v[60:63], v[20:23]
    buffer_load_dword v7, v5, s[16:19], s45 offen sc1
    v_mfma_f32_16x16x32_bf16 v[12:15], v[212:215], v[56:59], v[12:15]
    ds_read_b128 v[76:79], v1 offset:62464
    v_mfma_f32_16x16x32_bf16 v[24:27], v[216:219], v[56:59], v[24:27]
    v_mfma_f32_16x16x32_bf16 v[28:31], v[216:219], v[60:63], v[28:31]
    s_waitcnt lgkmcnt(2)
    v_mfma_f32_16x16x32_bf16 v[8:11], v[220:223], v[64:67], v[8:11]
    ds_read_b128 v[80:83], v1 offset:63488
    v_mfma_f32_16x16x32_bf16 v[16:19], v[220:223], v[68:71], v[16:19]
    v_mfma_f32_16x16x32_bf16 v[20:23], v[224:227], v[68:71], v[20:23]
    v_mfma_f32_16x16x32_bf16 v[12:15], v[224:227], v[64:67], v[12:15]
    ds_read_b128 v[84:87], v1 offset:64512
    v_mfma_f32_16x16x32_bf16 v[24:27], v[228:231], v[64:67], v[24:27]
    v_mfma_f32_16x16x32_bf16 v[28:31], v[228:231], v[68:71], v[28:31]
    s_waitcnt lgkmcnt(2)
    v_mfma_f32_16x16x32_bf16 v[8:11], v[232:235], v[72:75], v[8:11]
    ds_read_b128 v[56:59], v2 offset:0
    v_mfma_f32_16x16x32_bf16 v[16:19], v[232:235], v[76:79], v[16:19]
    v_mfma_f32_16x16x32_bf16 v[20:23], v[236:239], v[76:79], v[20:23]
    v_mfma_f32_16x16x32_bf16 v[12:15], v[236:239], v[72:75], v[12:15]
    ds_read_b128 v[60:63], v2 offset:1024
    v_mfma_f32_16x16x32_bf16 v[24:27], v[240:243], v[72:75], v[24:27]
    v_mfma_f32_16x16x32_bf16 v[28:31], v[240:243], v[76:79], v[28:31]
    s_waitcnt lgkmcnt(2)
    v_mfma_f32_16x16x32_bf16 v[8:11], v[244:247], v[80:83], v[8:11]
    ds_read_b128 v[64:67], v2 offset:2048
    v_mfma_f32_16x16x32_bf16 v[16:19], v[244:247], v[84:87], v[16:19]
    v_mfma_f32_16x16x32_bf16 v[20:23], v[248:251], v[84:87], v[20:23]
    v_mfma_f32_16x16x32_bf16 v[12:15], v[248:251], v[80:83], v[12:15]
    ds_read_b128 v[68:71], v2 offset:3072
    v_mfma_f32_16x16x32_bf16 v[24:27], v[252:255], v[80:83], v[24:27]
    s_add_u32 s36, s36, 1
    v_mfma_f32_16x16x32_bf16 v[28:31], v[252:255], v[84:87], v[28:31]
    s_waitcnt lgkmcnt(2)
L_a_b1:
    v_mfma_f32_16x16x32_bf16 v[32:35], a[0:3], v[56:59], 0
    s_and_b32 s44, s90, 0xffffffff
    ds_read_b128 v[72:75], v2 offset:4096
    v_mul_f32 v120, v24, v116
    v_mfma_f32_16x16x32_bf16 v[40:43], a[0:3], v[60:63], 0
    s_cmp_lt_i32 s36, 1
    v_mul_f32 v121, v25, v116
    v_mul_f32 v120, v120, abs(v24)
    v_mfma_f32_16x16x32_bf16 v[44:47], a[4:7], v[60:63], 0
    s_cselect_b32 s44, 0x5e00000, s44
    v_mul_f32 v121, v121, abs(v25)
    v_cvt_pk_bf16_f32 v24, v120, v121
    v_mfma_f32_16x16x32_bf16 v[36:39], a[4:7], v[56:59], 0
    s_add_u32 s49, s44, s87
    ds_read_b128 v[76:79], v2 offset:5120
    v_pk_max_i16 v24, v24, 0
    v_mfma_f32_16x16x32_bf16 v[48:51], a[8:11], v[56:59], 0
    s_max_u32 s44, s44, s88
    v_mul_f32 v120, v26, v116
    v_mul_f32 v121, v27, v116
    v_mfma_f32_16x16x32_bf16 v[52:55], a[8:11], v[60:63], 0
    s_waitcnt lgkmcnt(2)
    v_mul_f32 v120, v120, abs(v26)
    v_mul_f32 v121, v121, abs(v27)
    v_mfma_f32_16x16x32_bf16 v[32:35], a[12:15], v[64:67], v[32:35]
    s_add_u32 s90, s90, 262144
    ds_read_b128 v[80:83], v2 offset:6144
    v_cvt_pk_bf16_f32 v25, v120, v121
    v_mfma_f32_16x16x32_bf16 v[40:43], a[12:15], v[68:71], v[40:43]
    s_add_u32 s98, s98, 65536
    v_pk_max_i16 v25, v25, 0
    s_min_i32 s98, s98, s96
    v_mfma_f32_16x16x32_bf16 v[44:47], a[16:19], v[68:71], v[44:47]
    s_and_b32 s41, s98, 0xffffffff
    ds_write_b64 v3, v[24:25] offset:0
    v_mfma_f32_16x16x32_bf16 v[36:39], a[16:19], v[64:67], v[36:39]
    ds_read_b128 v[84:87], v2 offset:7168
    v_mul_f32 v120, v28, v117
    v_mfma_f32_16x16x32_bf16 v[48:51], a[20:23], v[64:67], v[48:51]
    v_mul_f32 v121, v29, v117
    v_mul_f32 v120, v120, abs(v28)
    v_mfma_f32_16x16x32_bf16 v[52:55], a[20:23], v[68:71], v[52:55]
    s_waitcnt lgkmcnt(3)
    v_mul_f32 v121, v121, abs(v29)
    v_cvt_pk_bf16_f32 v28, v120, v121
    v_mfma_f32_16x16x32_bf16 v[32:35], a[24:27], v[72:75], v[32:35]
    ds_read_b128 v[56:59], v2 offset:8192
    v_pk_max_i16 v28, v28, 0
    v_mfma_f32_16x16x32_bf16 v[40:43], a[24:27], v[76:79], v[40:43]
    v_mul_f32 v120, v30, v117
    v_mul_f32 v121, v31, v117
    v_mfma_f32_16x16x32_bf16 v[44:47], a[28:31], v[76:79], v[44:47]
    v_mul_f32 v120, v120, abs(v30)
    v_mul_f32 v121, v121, abs(v31)
    v_mfma_f32_16x16x32_bf16 v[36:39], a[28:31], v[72:75], v[36:39]
    ds_read_b128 v[60:63], v2 offset:9216
    v_cvt_pk_bf16_f32 v29, v120, v121
    v_mfma_f32_16x16x32_bf16 v[48:51], a[32:35], v[72:75], v[48:51]
    v_pk_max_i16 v29, v29, 0
    v_mfma_f32_16x16x32_bf16 v[52:55], a[32:35], v[76:79], v[52:55]
    s_waitcnt lgkmcnt(2)
    ds_write_b64 v3, v[28:29] offset:1024
    v_mfma_f32_16x16x32_bf16 v[32:35], a[36:39], v[80:83], v[32:35]
    ds_read_b128 v[64:67], v2 offset:10240
    v_mul_f32 v120, v8, v116
    v_mfma_f32_16x16x32_bf16 v[40:43], a[36:39], v[84:87], v[40:43]
    v_mul_f32 v121, v9, v116
    v_mul_f32 v120, v120, abs(v8)
    v_mfma_f32_16x16x32_bf16 v[44:47], a[40:43], v[84:87], v[44:47]
    v_mul_f32 v121, v121, abs(v9)
    v_cvt_pk_bf16_f32 v8, v120, v121
    v_mfma_f32_16x16x32_bf16 v[36:39], a[40:43], v[80:83], v[36:39]
    ds_read_b128 v[68:71], v2 offset:11264
    v_pk_max_i16 v8, v8, 0
    v_mfma_f32_16x16x32_bf16 v[48:51], a[44:47], v[80:83], v[48:51]
    v_mul_f32 v120, v10, v116
    v_mul_f32 v121, v11, v116
    v_mfma_f32_16x16x32_bf16 v[52:55], a[44:47], v[84:87], v[52:55]
    s_waitcnt lgkmcnt(3)
    v_mul_f32 v120, v120, abs(v10)
    v_mul_f32 v121, v121, abs(v11)
    v_mfma_f32_16x16x32_bf16 v[32:35], a[48:51], v[56:59], v[32:35]
    ds_read_b128 v[72:75], v2 offset:12288
    v_cvt_pk_bf16_f32 v9, v120, v121
    v_mfma_f32_16x16x32_bf16 v[40:43], a[48:51], v[60:63], v[40:43]
    s_waitcnt vmcnt(0)
    v_cmp_ne_u32 vcc, 0, v7
    v_pk_max_i16 v9, v9, 0
    v_mfma_f32_16x16x32_bf16 v[44:47], a[52:55], v[60:63], v[44:47]
    v_mul_f32 v120, v12, v116
    v_mul_f32 v121, v13, v116
    v_mfma_f32_16x16x32_bf16 v[36:39], a[52:55], v[56:59], v[36:39]
    s_cbranch_vccnz L_spin21
L_back22:
    ds_read_b128 v[76:79], v2 offset:13312
    v_mul_f32 v120, v120, abs(v12)
    v_mfma_f32_16x16x32_bf16 v[48:51], a[56:59], v[56:59], v[48:51]
    s_waitcnt lgkmcnt(4)
    v_mul_f32 v121, v121, abs(v13)
    v_cvt_pk_bf16_f32 v10, v120, v121
    v_mfma_f32_16x16x32_bf16 v[52:55], a[56:59], v[60:63], v[52:55]
    s_waitcnt lgkmcnt(2)
    v_pk_max_i16 v10, v10, 0
    v_mul_f32 v120, v14, v116
    v_mfma_f32_16x16x32_bf16 v[32:35], a[60:63], v[64:67], v[32:35]
    s_barrier
    ds_read_b128 v[80:83], v2 offset:14336
    v_mul_f32 v121, v15, v116
    v_mfma_f32_16x16x32_bf16 v[40:43], a[60:63], v[68:71], v[40:43]
    s_add_u32 s45, s45, 65536
    ds_read_b128 v[24:27], v4 offset:0
    v_mul_f32 v120, v120, abs(v14)
    v_mfma_f32_16x16x32_bf16 v[44:47], a[64:67], v[68:71], v[44:47]
    v_mul_f32 v121, v121, abs(v15)
    v_cvt_pk_bf16_f32 v11, v120, v121
    v_mfma_f32_16x16x32_bf16 v[36:39], a[64:67], v[64:67], v[36:39]
    ds_read_b128 v[84:87], v2 offset:15360
    v_pk_max_i16 v11, v11, 0
    v_mfma_f32_16x16x32_bf16 v[48:51], a[68:71], v[64:67], v[48:51]
    buffer_store_dwordx4 v[8:11], v1, s[16:19], s44 offen offset:0 sc1
    v_mfma_f32_16x16x32_bf16 v[52:55], a[68:71], v[68:71], v[52:55]
    s_waitcnt lgkmcnt(3)
    v_mul_f32 v120, v16, v117
    v_mul_f32 v121, v17, v117
    v_mfma_f32_16x16x32_bf16 v[32:35], a[72:75], v[72:75], v[32:35]
    s_waitcnt lgkmcnt(1)
    ds_read_b128 v[56:59], v2 offset:16384
    v_mul_f32 v120, v120, abs(v16)
    v_mfma_f32_16x16x32_bf16 v[40:43], a[72:75], v[76:79], v[40:43]
    buffer_store_dwordx4 v[24:27], v1, s[16:19], s49 offen sc1
    v_mfma_f32_16x16x32_bf16 v[44:47], a[76:79], v[76:79], v[44:47]
    v_mul_f32 v121, v121, abs(v17)
    v_cvt_pk_bf16_f32 v16, v120, v121
    v_mfma_f32_16x16x32_bf16 v[36:39], a[76:79], v[72:75], v[36:39]
    ds_read_b128 v[60:63], v2 offset:17408
    v_pk_max_i16 v16, v16, 0
    v_mfma_f32_16x16x32_bf16 v[48:51], a[80:83], v[72:75], v[48:51]
    v_mul_f32 v120, v18, v117
    v_mul_f32 v121, v19, v117
    v_mfma_f32_16x16x32_bf16 v[52:55], a[80:83], v[76:79], v[52:55]
    s_waitcnt lgkmcnt(2)
    v_mul_f32 v120, v120, abs(v18)
    v_mul_f32 v121, v121, abs(v19)
    v_mfma_f32_16x16x32_bf16 v[32:35], a[84:87], v[80:83], v[32:35]
    ds_read_b128 v[64:67], v2 offset:18432
    v_cvt_pk_bf16_f32 v17, v120, v121
    v_mfma_f32_16x16x32_bf16 v[40:43], a[84:87], v[84:87], v[40:43]
    v_pk_max_i16 v17, v17, 0
    v_mul_f32 v120, v20, v117
    v_mfma_f32_16x16x32_bf16 v[44:47], a[88:91], v[84:87], v[44:47]
    v_mul_f32 v121, v21, v117
    v_mul_f32 v120, v120, abs(v20)
    v_mfma_f32_16x16x32_bf16 v[36:39], a[88:91], v[80:83], v[36:39]
    ds_read_b128 v[68:71], v2 offset:19456
    v_mul_f32 v121, v121, abs(v21)
    v_mfma_f32_16x16x32_bf16 v[48:51], a[92:95], v[80:83], v[48:51]
    v_cvt_pk_bf16_f32 v18, v120, v121
    v_pk_max_i16 v18, v18, 0
    v_mfma_f32_16x16x32_bf16 v[52:55], a[92:95], v[84:87], v[52:55]
    s_waitcnt lgkmcnt(2)
    v_mul_f32 v120, v22, v117
    v_mul_f32 v121, v23, v117
    v_mfma_f32_16x16x32_bf16 v[32:35], a[96:99], v[56:59], v[32:35]
    ds_read_b128 v[72:75], v2 offset:20480
    v_mul_f32 v120, v120, abs(v22)
    v_mfma_f32_16x16x32_bf16 v[40:43], a[96:99], v[60:63], v[40:43]
    v_mul_f32 v121, v121, abs(v23)
    v_cvt_pk_bf16_f32 v19, v120, v121
    v_mfma_f32_16x16x32_bf16 v[44:47], a[100:103], v[60:63], v[44:47]
    v_pk_max_i16 v19, v19, 0
    v_mfma_f32_16x16x32_bf16 v[36:39], a[100:103], v[56:59], v[36:39]
    ds_read_b128 v[76:79], v2 offset:21504
    v_mfma_f32_16x16x32_bf16 v[48:51], a[104:107], v[56:59], v[48:51]
    buffer_store_dwordx4 v[16:19], v1, s[16:19], s44 offen offset:1024 sc1
    v_mfma_f32_16x16x32_bf16 v[52:55], a[104:107], v[60:63], v[52:55]
    s_waitcnt lgkmcnt(2)
    ds_read_b64 v[12:13], v118 offset:0
    s_add_u32 m0, s43, 0
    v_mfma_f32_16x16x32_bf16 v[32:35], a[108:111], v[64:67], v[32:35]
    s_add_u32 s42, s41, 0
    ds_read_b128 v[80:83], v2 offset:22528
    v_mfma_f32_16x16x32_bf16 v[40:43], a[108:111], v[68:71], v[40:43]
    buffer_load_dwordx4 v1, s[16:19], s42 offen offset:0 sc1 lds
    v_mfma_f32_16x16x32_bf16 v[44:47], a[112:115], v[68:71], v[44:47]
    ds_read_b64 v[14:15], v118 offset:128
    v_mfma_f32_16x16x32_bf16 v[36:39], a[112:115], v[64:67], v[36:39]
    ds_read_b128 v[84:87], v2 offset:23552
    v_mfma_f32_16x16x32_bf16 v[48:51], a[116:119], v[64:67], v[48:51]
    ds_read_b64 v[16:17], v118 offset:256
    v_mfma_f32_16x16x32_bf16 v[52:55], a[116:119], v[68:71], v[52:55]
    s_waitcnt lgkmcnt(5)
    ds_read_b64 v[18:19], v118 offset:384
    v_mfma_f32_16x16x32_bf16 v[32:35], a[120:123], v[72:75], v[32:35]
    ds_read_b128 v[56:59], v2 offset:24576
    v_mfma_f32_16x16x32_bf16 v[40:43], a[120:123], v[76:79], v[40:43]
    buffer_load_dwordx4 v1, s[16:19], s42 offen offset:1024 sc1 lds
    v_mfma_f32_16x16x32_bf16 v[44:47], a[124:127], v[76:79], v[44:47]
    v_mfma_f32_16x16x32_bf16 v[36:39], a[124:127], v[72:75], v[36:39]
    ds_read_b128 v[60:63], v2 offset:25600
    v_mfma_f32_16x16x32_bf16 v[48:51], a[128:131], v[72:75], v[48:51]
    s_waitcnt lgkmcnt(2)
    v_max3_u32 v20, v12, v13, v14
    v_max3_u32 v21, v15, v16, v17
    v_mfma_f32_16x16x32_bf16 v[52:55], a[128:131], v[76:79], v[52:55]
    s_waitcnt lgkmcnt(4)
    v_max3_u32 v20, v20, v18, v19
    v_max_u32 v20, v20, v21
    v_mfma_f32_16x16x32_bf16 v[32:35], a[132:135], v[80:83], v[32:35]
    ds_read_b128 v[64:67], v2 offset:26624
    v_cmp_eq_u32 vcc, -1, v20
    v_mfma_f32_16x16x32_bf16 v[40:43], a[132:135], v[84:87], v[40:43]
    buffer_load_dwordx4 v1, s[16:19], s42 offen offset:2048 sc1 lds
    v_mfma_f32_16x16x32_bf16 v[44:47], a[136:139], v[84:87], v[44:47]
    s_cbranch_vccnz L_sspin23
L_sback24:
    v_add_f32 v20, v16, v18
    v_add_f32 v21, v17, v19
    v_mfma_f32_16x16x32_bf16 v[36:39], a[136:139], v[80:83], v[36:39]
    ds_read_b128 v[68:71], v2 offset:27648
    v_add_f32 v12, v12, v14
    v_mfma_f32_16x16x32_bf16 v[48:51], a[140:143], v[80:83], v[48:51]
    v_add_f32 v13, v13, v15
    v_add_f32 v12, v12, v20
    v_mfma_f32_16x16x32_bf16 v[52:55], a[140:143], v[84:87], v[52:55]
    s_waitcnt lgkmcnt(2)
    v_add_f32 v13, v13, v21
    v_mov_b32 v20, v12
    v_mfma_f32_16x16x32_bf16 v[32:35], a[144:147], v[56:59], v[32:35]
    ds_read_b128 v[72:75], v2 offset:28672
    v_mov_b32 v21, v13
    v_mfma_f32_16x16x32_bf16 v[40:43], a[144:147], v[60:63], v[40:43]
    buffer_load_dwordx4 v1, s[16:19], s42 offen offset:3072 sc1 lds
    v_mfma_f32_16x16x32_bf16 v[44:47], a[148:151], v[60:63], v[44:47]
    s_add_u32 m0, s43, 16384
    v_permlane32_swap_b32 v12, v20
    v_mfma_f32_16x16x32_bf16 v[36:39], a[148:151], v[56:59], v[36:39]
    s_add_u32 s42, s41, 16384
    ds_read_b128 v[76:79], v2 offset:29696
    v_mfma_f32_16x16x32_bf16 v[48:51], a[152:155], v[56:59], v[48:51]
    v_permlane32_swap_b32 v13, v21
    v_mfma_f32_16x16x32_bf16 v[52:55], a[152:155], v[60:63], v[52:55]
    s_waitcnt lgkmcnt(2)
    v_add_f32 v12, v12, v20
    v_add_f32 v13, v13, v21
    v_mfma_f32_16x16x32_bf16 v[32:35], a[156:159], v[64:67], v[32:35]
    ds_read_b128 v[80:83], v2 offset:30720
    v_mul_f32 v112, 0xba800000, v12
    v_mfma_f32_16x16x32_bf16 v[40:43], a[156:159], v[68:71], v[40:43]
    buffer_load_dwordx4 v1, s[16:19], s42 offen offset:0 sc1 lds
    v_mfma_f32_16x16x32_bf16 v[44:47], a[160:163], v[68:71], v[44:47]
    v_mul_f32 v13, 0x3a800000, v13
    v_fma_f32 v13, -v112, v112, v13
    v_mfma_f32_16x16x32_bf16 v[36:39], a[160:163], v[64:67], v[36:39]
    ds_read_b128 v[84:87], v2 offset:31744
    v_mov_b32 v113, v112
    v_mfma_f32_16x16x32_bf16 v[48:51], a[164:167], v[64:67], v[48:51]
    v_max_f32 v13, 0, v13
    v_add_f32 v13, 0x3727c5ac, v13
    v_mfma_f32_16x16x32_bf16 v[52:55], a[164:167], v[68:71], v[52:55]
    s_waitcnt lgkmcnt(2)
    v_rsq_f32 v116, v13
    v_mfma_f32_16x16x32_bf16 v[32:35], a[168:171], v[72:75], v[32:35]
    ds_read_b128 v[56:59], v2 offset:32768
    v_mfma_f32_16x16x32_bf16 v[40:43], a[168:171], v[76:79], v[40:43]
    buffer_load_dwordx4 v1, s[16:19], s42 offen offset:1024 sc1 lds
    v_mfma_f32_16x16x32_bf16 v[44:47], a[172:175], v[76:79], v[44:47]
    v_permlane16_swap_b32 v112, v113
    v_mfma_f32_16x16x32_bf16 v[36:39], a[172:175], v[72:75], v[36:39]
    s_nop 0
    ds_read_b128 v[60:63], v2 offset:33792
    v_mul_f32 v114, v13, v116
    v_mfma_f32_16x16x32_bf16 v[48:51], a[176:179], v[72:75], v[48:51]
    v_mul_f32 v116, v116, v116
    v_mov_b32 v115, v114
    v_mfma_f32_16x16x32_bf16 v[52:55], a[176:179], v[76:79], v[52:55]
    s_waitcnt lgkmcnt(2)
    v_mov_b32 v117, v116
    v_fmac_f32 v40, v113, v88
    v_mfma_f32_16x16x32_bf16 v[32:35], a[180:183], v[80:83], v[32:35]
    ds_read_b128 v[64:67], v2 offset:34816
    v_fmac_f32 v36, v112, v92
    v_mfma_f32_16x16x32_bf16 v[40:43], a[180:183], v[84:87], v[40:43]
    buffer_load_dwordx4 v1, s[16:19], s42 offen offset:2048 sc1 lds
    v_mfma_f32_16x16x32_bf16 v[44:47], a[184:187], v[84:87], v[44:47]
    v_permlane16_swap_b32 v114, v115
    v_mfma_f32_16x16x32_bf16 v[36:39], a[184:187], v[80:83], v[36:39]
    s_nop 0
    ds_read_b128 v[68:71], v2 offset:35840
    v_fmac_f32 v32, v112, v88
    v_mfma_f32_16x16x32_bf16 v[48:51], a[188:191], v[80:83], v[48:51]
    v_permlane16_swap_b32 v116, v117
    v_mfma_f32_16x16x32_bf16 v[52:55], a[188:191], v[84:87], v[52:55]
    s_waitcnt lgkmcnt(2)
    v_fmac_f32 v41, v113, v89
    v_fmac_f32 v42, v113, v90
    v_mfma_f32_16x16x32_bf16 v[32:35], a[192:195], v[56:59], v[32:35]
    s_add_u32 s46, s46, 2048
    ds_read_b128 v[72:75], v2 offset:36864
    v_fmac_f32 v37, v112, v93
    v_mfma_f32_16x16x32_bf16 v[40:43], a[192:195], v[60:63], v[40:43]
    buffer_load_dwordx4 v1, s[16:19], s42 offen offset:3072 sc1 lds
    v_mfma_f32_16x16x32_bf16 v[44:47], a[196:199], v[60:63], v[44:47]
    s_add_u32 m0, s43, 32768
    v_fmac_f32 v33, v112, v89
    v_fmac_f32 v34, v112, v90
    v_mfma_f32_16x16x32_bf16 v[36:39], a[196:199], v[56:59], v[36:39]
    s_add_u32 s42, s41, 32768
    ds_read_b128 v[76:79], v2 offset:37888
    v_fmac_f32 v35, v112, v91
    v_mfma_f32_16x16x32_bf16 v[48:51], a[200:203], v[56:59], v[48:51]
    s_min_u32 s46, s46, s55
    v_fmac_f32 v32, v114, v100
    v_fmac_f32 v33, v114, v101
    v_mfma_f32_16x16x32_bf16 v[52:55], a[200:203], v[60:63], v[52:55]
    s_waitcnt lgkmcnt(2)
    v_fmac_f32 v43, v113, v91
    v_fmac_f32 v40, v115, v100
    v_mfma_f32_16x16x32_bf16 v[32:35], a[204:207], v[64:67], v[32:35]
    ds_read_b128 v[80:83], v2 offset:38912
    v_fmac_f32 v38, v112, v94
    v_mfma_f32_16x16x32_bf16 v[40:43], a[204:207], v[68:71], v[40:43]
    buffer_load_dwordx4 v1, s[16:19], s42 offen offset:0 sc1 lds
    v_mfma_f32_16x16x32_bf16 v[44:47], a[208:211], v[68:71], v[44:47]
    v_fmac_f32 v48, v112, v96
    v_fmac_f32 v34, v114, v102
    v_mfma_f32_16x16x32_bf16 v[36:39], a[208:211], v[64:67], v[36:39]
    ds_read_b128 v[84:87], v2 offset:39936
    v_fmac_f32 v35, v114, v103
    v_mfma_f32_16x16x32_bf16 v[48:51], a[212:215], v[64:67], v[48:51]
    v_fmac_f32 v41, v115, v101
    v_fmac_f32 v42, v115, v102
    v_mfma_f32_16x16x32_bf16 v[52:55], a[212:215], v[68:71], v[52:55]
    s_waitcnt lgkmcnt(2)
    v_fmac_f32 v43, v115, v103
    v_fmac_f32 v39, v112, v95
    v_mfma_f32_16x16x32_bf16 v[32:35], a[216:219], v[72:75], v[32:35]
    ds_read_b128 v[56:59], v2 offset:40960
    v_fmac_f32 v36, v114, v104
    v_mfma_f32_16x16x32_bf16 v[40:43], a[216:219], v[76:79], v[40:43]
    buffer_load_dwordx4 v1, s[16:19], s42 offen offset:1024 sc1 lds
    v_mfma_f32_16x16x32_bf16 v[44:47], a[220:223], v[76:79], v[44:47]
    v_fmac_f32 v49, v112, v97
    v_fmac_f32 v50, v112, v98
    v_mfma_f32_16x16x32_bf16 v[36:39], a[220:223], v[72:75], v[36:39]
    ds_read_b128 v[60:63], v2 offset:41984
    v_fmac_f32 v52, v113, v96
    v_mfma_f32_16x16x32_bf16 v[48:51], a[224:227], v[72:75], v[48:51]
    v_fmac_f32 v44, v113, v92
    v_fmac_f32 v45, v113, v93
    v_mfma_f32_16x16x32_bf16 v[52:55], a[224:227], v[76:79], v[52:55]
    s_waitcnt lgkmcnt(2)
    v_fmac_f32 v37, v114, v105
    v_fmac_f32 v38, v114, v106
    v_mfma_f32_16x16x32_bf16 v[32:35], a[228:231], v[80:83], v[32:35]
    ds_read_b128 v[64:67], v2 offset:43008
    v_fmac_f32 v39, v114, v107
    v_mfma_f32_16x16x32_bf16 v[40:43], a[228:231], v[84:87], v[40:43]
    buffer_load_dwordx4 v1, s[16:19], s42 offen offset:2048 sc1 lds
    v_mfma_f32_16x16x32_bf16 v[44:47], a[232:235], v[84:87], v[44:47]
    v_fmac_f32 v51, v112, v99
    v_fmac_f32 v48, v114, v108
    v_mfma_f32_16x16x32_bf16 v[36:39], a[232:235], v[80:83], v[36:39]
    ds_read_b128 v[68:71], v2 offset:44032
    v_fmac_f32 v53, v113, v97
    v_mfma_f32_16x16x32_bf16 v[48:51], a[236:239], v[80:83], v[48:51]
    s_waitcnt vmcnt(7)
    v_fmac_f32 v46, v113, v94
    v_fmac_f32 v47, v113, v95
    v_mfma_f32_16x16x32_bf16 v[52:55], a[236:239], v[84:87], v[52:55]
    s_waitcnt lgkmcnt(2)
    v_fmac_f32 v44, v115, v104
    v_fmac_f32 v45, v115, v105
    v_mfma_f32_16x16x32_bf16 v[32:35], a[240:243], v[56:59], v[32:35]
    s_barrier
    ds_read_b128 v[72:75], v2 offset:45056
    v_fmac_f32 v46, v115, v106
    v_mfma_f32_16x16x32_bf16 v[40:43], a[240:243], v[60:63], v[40:43]
    buffer_store_dword v124, v124, s[16:19], s91 offen sc1
    v_mfma_f32_16x16x32_bf16 v[44:47], a[244:247], v[60:63], v[44:47]
    buffer_load_dwordx4 v1, s[16:19], s42 offen offset:3072 sc1 lds
    v_mfma_f32_16x16x32_bf16 v[36:39], a[244:247], v[56:59], v[36:39]
    s_add_u32 s91, s91, 65536
    ds_read_b128 v[76:79], v2 offset:46080
    v_fmac_f32 v54, v113, v98
    v_mfma_f32_16x16x32_bf16 v[48:51], a[248:251], v[56:59], v[48:51]
    s_add_u32 m0, s43, 49152
    v_fmac_f32 v47, v115, v107
    s_add_u32 s42, s41, 49152
    v_mfma_f32_16x16x32_bf16 v[52:55], a[248:251], v[60:63], v[52:55]
    s_waitcnt lgkmcnt(2)
    v_mfma_f32_16x16x32_bf16 v[32:35], a[252:255], v[64:67], v[32:35]
    ds_read_b128 v[80:83], v2 offset:47104
    v_fmac_f32 v49, v114, v109
    v_mfma_f32_16x16x32_bf16 v[40:43], a[252:255], v[68:71], v[40:43]
    v_fmac_f32 v50, v114, v110
    v_fmac_f32 v51, v114, v111
    v_mfma_f32_16x16x32_bf16 v[44:47], v[128:131], v[68:71], v[44:47]
    buffer_load_dwordx4 v1, s[16:19], s42 offen offset:0 sc1 lds
    v_mfma_f32_16x16x32_bf16 v[36:39], v[128:131], v[64:67], v[36:39]
    ds_read_b128 v[84:87], v2 offset:48128
    v_fmac_f32 v55, v113, v99
    v_mfma_f32_16x16x32_bf16 v[48:51], v[132:135], v[64:67], v[48:51]
    v_mfma_f32_16x16x32_bf16 v[52:55], v[132:135], v[68:71], v[52:55]
    s_waitcnt lgkmcnt(2)
    v_mfma_f32_16x16x32_bf16 v[32:35], v[136:139], v[72:75], v[32:35]
    ds_read_b128 v[56:59], v2 offset:49152
    v_mfma_f32_16x16x32_bf16 v[40:43], v[136:139], v[76:79], v[40:43]
    v_mfma_f32_16x16x32_bf16 v[44:47], v[140:143], v[76:79], v[44:47]
    buffer_load_dwordx4 v1, s[16:19], s42 offen offset:1024 sc1 lds
    v_mfma_f32_16x16x32_bf16 v[36:39], v[140:143], v[72:75], v[36:39]
    ds_read_b128 v[60:63], v2 offset:50176
    v_fmac_f32 v52, v115, v108
    v_mfma_f32_16x16x32_bf16 v[48:51], v[144:147], v[72:75], v[48:51]
    v_mfma_f32_16x16x32_bf16 v[52:55], v[144:147], v[76:79], v[52:55]
    s_waitcnt lgkmcnt(2)
    v_mfma_f32_16x16x32_bf16 v[32:35], v[148:151], v[80:83], v[32:35]
    ds_read_b128 v[64:67], v2 offset:51200
    v_mfma_f32_16x16x32_bf16 v[40:43], v[148:151], v[84:87], v[40:43]
    v_mfma_f32_16x16x32_bf16 v[44:47], v[152:155], v[84:87], v[44:47]
    buffer_load_dwordx4 v1, s[16:19], s42 offen offset:2048 sc1 lds
    v_mfma_f32_16x16x32_bf16 v[36:39], v[152:155], v[80:83], v[36:39]
    ds_read_b128 v[68:71], v2 offset:52224
    v_fmac_f32 v53, v115, v109
    v_mfma_f32_16x16x32_bf16 v[48:51], v[156:159], v[80:83], v[48:51]
    v_mfma_f32_16x16x32_bf16 v[52:55], v[156:159], v[84:87], v[52:55]
    s_waitcnt lgkmcnt(2)
    v_mfma_f32_16x16x32_bf16 v[32:35], v[160:163], v[56:59], v[32:35]
    ds_read_b128 v[72:75], v2 offset:53248
    v_mfma_f32_16x16x32_bf16 v[40:43], v[160:163], v[60:63], v[40:43]
    v_mfma_f32_16x16x32_bf16 v[44:47], v[164:167], v[60:63], v[44:47]
    buffer_load_dwordx4 v1, s[16:19], s42 offen offset:3072 sc1 lds
    v_mfma_f32_16x16x32_bf16 v[36:39], v[164:167], v[56:59], v[36:39]
    s_add_u32 m0, s52, 73728
    ds_read_b128 v[76:79], v2 offset:54272
    v_fmac_f32 v54, v115, v110
    v_mfma_f32_16x16x32_bf16 v[48:51], v[168:171], v[56:59], v[48:51]
    s_add_u32 s42, s46, s52
    v_mfma_f32_16x16x32_bf16 v[52:55], v[168:171], v[60:63], v[52:55]
    s_waitcnt lgkmcnt(2)
    v_mfma_f32_16x16x32_bf16 v[32:35], v[172:175], v[64:67], v[32:35]
    ds_read_b128 v[80:83], v2 offset:55296
    v_mfma_f32_16x16x32_bf16 v[40:43], v[172:175], v[68:71], v[40:43]
    buffer_load_dwordx4 v1, s[16:19], s42 offen sc1 lds
    v_mfma_f32_16x16x32_bf16 v[44:47], v[176:179], v[68:71], v[44:47]
    v_fmac_f32 v55, v115, v111
    v_mfma_f32_16x16x32_bf16 v[36:39], v[176:179], v[64:67], v[36:39]
    ds_read_b128 v[84:87], v2 offset:56320
    v_mfma_f32_16x16x32_bf16 v[48:51], v[180:183], v[64:67], v[48:51]
    v_mfma_f32_16x16x32_bf16 v[52:55], v[180:183], v[68:71], v[52:55]
    s_waitcnt lgkmcnt(2)
    v_mfma_f32_16x16x32_bf16 v[32:35], v[184:187], v[72:75], v[32:35]
    ds_read_b128 v[56:59], v2 offset:57344
    v_mfma_f32_16x16x32_bf16 v[40:43], v[184:187], v[76:79], v[40:43]
    v_mfma_f32_16x16x32_bf16 v[44:47], v[188:191], v[76:79], v[44:47]
    v_mfma_f32_16x16x32_bf16 v[36:39], v[188:191], v[72:75], v[36:39]
    ds_read_b128 v[60:63], v2 offset:58368
    v_mfma_f32_16x16x32_bf16 v[48:51], v[192:195], v[72:75], v[48:51]
    v_mfma_f32_16x16x32_bf16 v[52:55], v[192:195], v[76:79], v[52:55]
    s_waitcnt lgkmcnt(2)
    v_mfma_f32_16x16x32_bf16 v[32:35], v[196:199], v[80:83], v[32:35]
    ds_read_b128 v[64:67], v2 offset:59392
    v_mfma_f32_16x16x32_bf16 v[40:43], v[196:199], v[84:87], v[40:43]
    v_mfma_f32_16x16x32_bf16 v[44:47], v[200:203], v[84:87], v[44:47]
    v_mfma_f32_16x16x32_bf16 v[36:39], v[200:203], v[80:83], v[36:39]
    ds_read_b128 v[68:71], v2 offset:60416
    v_mfma_f32_16x16x32_bf16 v[48:51], v[204:207], v[80:83], v[48:51]
    v_mfma_f32_16x16x32_bf16 v[52:55], v[204:207], v[84:87], v[52:55]
    s_waitcnt lgkmcnt(2)
    v_mfma_f32_16x16x32_bf16 v[32:35], v[208:211], v[56:59], v[32:35]
    ds_read_b128 v[72:75], v2 offset:61440
    v_mfma_f32_16x16x32_bf16 v[40:43], v[208:211], v[60:63], v[40:43]
    v_mfma_f32_16x16x32_bf16 v[44:47], v[212:215], v[60:63], v[44:47]
    buffer_load_dword v7, v5, s[16:19], s45 offen sc1
    v_mfma_f32_16x16x32_bf16 v[36:39], v[212:215], v[56:59], v[36:39]
    ds_read_b128 v[76:79], v2 offset:62464
    v_mfma_f32_16x16x32_bf16 v[48:51], v[216:219], v[56:59], v[48:51]
    v_mfma_f32_16x16x32_bf16 v[52:55], v[216:219], v[60:63], v[52:55]
    s_waitcnt lgkmcnt(2)
    v_mfma_f32_16x16x32_bf16 v[32:35], v[220:223], v[64:67], v[32:35]
    ds_read_b128 v[80:83], v2 offset:63488
    v_mfma_f32_16x16x32_bf16 v[40:43], v[220:223], v[68:71], v[40:43]
    v_mfma_f32_16x16x32_bf16 v[44:47], v[224:227], v[68:71], v[44:47]
    v_mfma_f32_16x16x32_bf16 v[36:39], v[224:227], v[64:67], v[36:39]
    ds_read_b128 v[84:87], v2 offset:64512
    v_mfma_f32_16x16x32_bf16 v[48:51], v[228:231], v[64:67], v[48:51]
    v_mfma_f32_16x16x32_bf16 v[52:55], v[228:231], v[68:71], v[52:55]
    s_waitcnt lgkmcnt(2)
    v_mfma_f32_16x16x32_bf16 v[32:35], v[232:235], v[72:75], v[32:35]
    ds_read_b128 v[56:59], v1 offset:0
    v_mfma_f32_16x16x32_bf16 v[40:43], v[232:235], v[76:79], v[40:43]
    v_mfma_f32_16x16x32_bf16 v[44:47], v[236:239], v[76:79], v[44:47]
    v_mfma_f32_16x16x32_bf16 v[36:39], v[236:239], v[72:75], v[36:39]
    ds_read_b128 v[60:63], v1 offset:1024
    v_mfma_f32_16x16x32_bf16 v[48:51], v[240:243], v[72:75], v[48:51]
    v_mfma_f32_16x16x32_bf16 v[52:55], v[240:243], v[76:79], v[52:55]
    s_waitcnt lgkmcnt(2)
    v_mfma_f32_16x16x32_bf16 v[32:35], v[244:247], v[80:83], v[32:35]
    ds_read_b128 v[64:67], v1 offset:2048
    v_mfma_f32_16x16x32_bf16 v[40:43], v[244:247], v[84:87], v[40:43]
    v_mfma_f32_16x16x32_bf16 v[44:47], v[248:251], v[84:87], v[44:47]
    v_mfma_f32_16x16x32_bf16 v[36:39], v[248:251], v[80:83], v[36:39]
    ds_read_b128 v[68:71], v1 offset:3072
    v_mfma_f32_16x16x32_bf16 v[48:51], v[252:255], v[80:83], v[48:51]
    s_add_u32 s36, s36, 1
    v_mfma_f32_16x16x32_bf16 v[52:55], v[252:255], v[84:87], v[52:55]
    s_waitcnt lgkmcnt(2)
    s_cmp_lt_u32 s36, 32
    s_cbranch_scc1 L_a_b0
    s_nop 7
    s_and_b32 s44, s90, 0xffffffff
    s_cmp_lt_i32 s36, 1
    s_cselect_b32 s44, 0x5e00000, s44
    s_add_u32 s49, s44, s87
    s_max_u32 s44, s44, s88
    s_add_u32 s90, s90, 262144
    v_mul_f32 v120, v48, v116
    v_mul_f32 v121, v49, v116
    v_mul_f32 v120, v120, abs(v48)
    v_mul_f32 v121, v121, abs(v49)
    v_cvt_pk_bf16_f32 v48, v120, v121
    v_pk_max_i16 v48, v48, 0
    v_mul_f32 v120, v50, v116
    v_mul_f32 v121, v51, v116
    v_mul_f32 v120, v120, abs(v50)
    v_mul_f32 v121, v121, abs(v51)
    v_cvt_pk_bf16_f32 v49, v120, v121
    v_pk_max_i16 v49, v49, 0
    ds_write_b64 v3, v[48:49] offset:4096
    v_mul_f32 v120, v52, v117
    v_mul_f32 v121, v53, v117
    v_mul_f32 v120, v120, abs(v52)
    v_mul_f32 v121, v121, abs(v53)
    v_cvt_pk_bf16_f32 v52, v120, v121
    v_pk_max_i16 v52, v52, 0
    v_mul_f32 v120, v54, v117
    v_mul_f32 v121, v55, v117
    v_mul_f32 v120, v120, abs(v54)
    v_mul_f32 v121, v121, abs(v55)
    v_cvt_pk_bf16_f32 v53, v120, v121
    v_pk_max_i16 v53, v53, 0
    ds_write_b64 v3, v[52:53] offset:5120
    v_mul_f32 v120, v32, v116
    v_mul_f32 v121, v33, v116
    v_mul_f32 v120, v120, abs(v32)
    v_mul_f32 v121, v121, abs(v33)
    v_cvt_pk_bf16_f32 v32, v120, v121
    v_pk_max_i16 v32, v32, 0
    v_mul_f32 v120, v34, v116
    v_mul_f32 v121, v35, v116
    v_mul_f32 v120, v120, abs(v34)
    v_mul_f32 v121, v121, abs(v35)
    v_cvt_pk_bf16_f32 v33, v120, v121
    v_pk_max_i16 v33, v33, 0
    v_mul_f32 v120, v36, v116
    v_mul_f32 v121, v37, v116
    v_mul_f32 v120, v120, abs(v36)
    v_mul_f32 v121, v121, abs(v37)
    v_cvt_pk_bf16_f32 v34, v120, v121
    v_pk_max_i16 v34, v34, 0
    v_mul_f32 v120, v38, v116
    v_mul_f32 v121, v39, v116
    v_mul_f32 v120, v120, abs(v38)
    v_mul_f32 v121, v121, abs(v39)
    v_cvt_pk_bf16_f32 v35, v120, v121
    v_pk_max_i16 v35, v35, 0
    buffer_store_dwordx4 v[32:35], v1, s[16:19], s44 offen offset:0 sc1
    v_mul_f32 v120, v40, v117
    v_mul_f32 v121, v41, v117
    v_mul_f32 v120, v120, abs(v40)
    s_waitcnt lgkmcnt(0)
    s_barrier
    ds_read_b128 v[48:51], v4 offset:4096
    v_mul_f32 v121, v121, abs(v41)
    v_cvt_pk_bf16_f32 v40, v120, v121
    v_pk_max_i16 v40, v40, 0
    v_mul_f32 v120, v42, v117
    v_mul_f32 v121, v43, v117
    v_mul_f32 v120, v120, abs(v42)
    v_mul_f32 v121, v121, abs(v43)
    v_cvt_pk_bf16_f32 v41, v120, v121
    v_pk_max_i16 v41, v41, 0
    s_waitcnt lgkmcnt(0)
    buffer_store_dwordx4 v[48:51], v1, s[16:19], s49 offen sc1
    v_mul_f32 v120, v44, v117
    v_mul_f32 v121, v45, v117
    v_mul_f32 v120, v120, abs(v44)
    v_mul_f32 v121, v121, abs(v45)
    v_cvt_pk_bf16_f32 v42, v120, v121
    v_pk_max_i16 v42, v42, 0
    v_mul_f32 v120, v46, v117
    v_mul_f32 v121, v47, v117
    v_mul_f32 v120, v120, abs(v46)
    v_mul_f32 v121, v121, abs(v47)
    v_cvt_pk_bf16_f32 v43, v120, v121
    v_pk_max_i16 v43, v43, 0
    buffer_store_dwordx4 v[40:43], v1, s[16:19], s44 offen offset:1024 sc1
    s_waitcnt vmcnt(0)
    s_barrier
    buffer_store_dword v124, v124, s[16:19], s91 offen sc1
    s_add_u32 s91, s91, 65536
    s_waitcnt vmcnt(0)
    s_endpgm
L_vspin11:
    s_mov_b32 s40, 0x20000
L_vspin11_l:
    s_cmp_lg_u32 s37, 0
    s_cbranch_scc1 L_restart
    s_sleep 4
    buffer_load_dword v74, v124, s[20:23], 0 offen offset:32 sc1
    s_waitcnt vmcnt(0)
    v_readfirstlane_b32 s37, v74
    s_sub_u32 s40, s40, 1
    s_cbranch_scc1 L_vback12
    s_cmp_lg_u32 s37, s3
    s_cbranch_scc1 L_vspin11_l
    s_branch L_vback12
L_spin13:
    s_mov_b32 s40, 0x20000
L_spin13_l:
    buffer_load_dword v73, v72, s[20:23], 0 offen sc1
    s_sub_u32 s40, s40, 1
    s_waitcnt vmcnt(0)
    v_cmp_eq_u32 vcc, v72, v73
    s_cbranch_scc1 L_back14
    s_cbranch_vccz L_back14
    s_sleep 8
    s_branch L_spin13_l
L_spin15:
    s_mov_b32 s40, 0x20000
L_spin15_l:
    buffer_load_dword v7, v5, s[16:19], s45 offen sc1
    s_sub_u32 s40, s40, 1
    s_waitcnt vmcnt(0)
    v_cmp_ne_u32 vcc, 0, v7
    s_cbranch_scc1 L_back16
    s_cbranch_vccz L_back16
    s_sleep 2
    s_branch L_spin15_l
L_spin17:
    s_mov_b32 s40, 0x20000
L_spin17_l:
    buffer_load_dword v7, v5, s[16:19], s45 offen sc1
    s_sub_u32 s40, s40, 1
    s_waitcnt vmcnt(0)
    v_cmp_ne_u32 vcc, 0, v7
    s_cbranch_scc1 L_back18
    s_cbranch_vccz L_back18
    s_sleep 2
    s_branch L_spin17_l
L_sspin19:
    s_mov_b32 s40, 0x20000
L_sspin19_l:
    buffer_load_dwordx2 v[36:37], v6, s[16:19], s46 offen offset:0 sc1
    buffer_load_dwordx2 v[38:39], v6, s[16:19], s46 offen offset:128 sc1
    buffer_load_dwordx2 v[40:41], v6, s[16:19], s46 offen offset:256 sc1
    buffer_load_dwordx2 v[42:43], v6, s[16:19], s46 offen offset:384 sc1
    s_sub_u32 s40, s40, 1
    s_waitcnt vmcnt(0)
    v_max3_u32 v44, v36, v37, v38
    v_max3_u32 v45, v39, v40, v41
    v_max3_u32 v44, v44, v42, v43
    v_max_u32 v44, v44, v45
    v_cmp_eq_u32 vcc, -1, v44
    s_cbranch_scc1 L_sback20
    s_cbranch_vccz L_sback20
    s_sleep 4
    s_branch L_sspin19_l
L_spin21:
    s_mov_b32 s40, 0x20000
L_spin21_l:
    buffer_load_dword v7, v5, s[16:19], s45 offen sc1
    s_sub_u32 s40, s40, 1
    s_waitcnt vmcnt(0)
    v_cmp_ne_u32 vcc, 0, v7
    s_cbranch_scc1 L_back22
    s_cbranch_vccz L_back22
    s_sleep 2
    s_branch L_spin21_l
L_sspin23:
    s_mov_b32 s40, 0x20000
L_sspin23_l:
    buffer_load_dwordx2 v[12:13], v6, s[16:19], s46 offen offset:0 sc1
    buffer_load_dwordx2 v[14:15], v6, s[16:19], s46 offen offset:128 sc1
    buffer_load_dwordx2 v[16:17], v6, s[16:19], s46 offen offset:256 sc1
    buffer_load_dwordx2 v[18:19], v6, s[16:19], s46 offen offset:384 sc1
    s_sub_u32 s40, s40, 1
    s_waitcnt vmcnt(0)
    v_max3_u32 v20, v12, v13, v14
    v_max3_u32 v21, v15, v16, v17
    v_max3_u32 v20, v20, v18, v19
    v_max_u32 v20, v20, v21
    v_cmp_eq_u32 vcc, -1, v20
    s_cbranch_scc1 L_sback24
    s_cbranch_vccz L_sback24
    s_sleep 4
    s_branch L_sspin23_l
L_odd:
    s_mov_b32 s33, s47
    s_lshl2_add_u32 s53, s48, s47
    s_cmp_lt_u32 s48, 8
    s_cselect_b32 s34, 16, 32
    s_add_u32 s34, s34, s48
    s_sub_u32 s37, s48, 8
    s_cmp_lt_u32 s37, 20
    s_cselect_b32 s44, -16, 0
    s_cmp_lt_u32 s37, 4
    s_cselect_b32 s44, 64, s44
    s_add_u32 s44, s44, s53
    s_lshl2_add_u32 s44, s44, s32
    s_lshl_b32 s44, s44, 13
    v_lshlrev_b32 v6, 7, v0
    s_waitcnt lgkmcnt(0)
    s_mov_b32 s12, s66
    s_mov_b32 s13, s67
    s_mov_b32 s14, 0x400000
    s_mov_b32 s15, 0x00020000
    s_mov_b32 s16, s84
    s_mov_b32 s17, s85
    s_mov_b32 s18, 0x5e00000
    s_mov_b32 s19, 0x00020000
    v_min_u32 v124, 1, v0
    v_lshlrev_b32 v124, 30, v124
    s_cmp_lt_u32 s48, 8
    s_cbranch_scc1 L_touch
    s_sub_u32 s37, s48, 12
    s_cmp_lt_u32 s37, 16
    s_cbranch_scc1 L_lines
    s_lshl_b32 s50, s33, 5
    s_or_b32 s37, s48, 16
    s_add_u32 s50, s50, s37
    s_lshl_b32 s46, s50, 15
    s_lshl_b32 s37, s32, 9
    s_add_u32 s46, s46, s37
    v_lshrrev_b32 v48, 3, v0
    v_and_b32 v49, 0x70, v1
    v_lshl_add_u32 v48, v48, 11, v49
    v_add_u32 v49, 16384, v48
    s_mov_b32 s8, s64
    s_mov_b32 s9, s65
    s_mov_b32 s10, 0x400000
    s_mov_b32 s11, 0x00020000
    buffer_load_dwordx4 v[16:19], v48, s[8:11], s46 offen offset:0
    buffer_load_dwordx4 v[20:23], v48, s[8:11], s46 offen offset:128
    buffer_load_dwordx4 v[24:27], v48, s[8:11], s46 offen offset:256
    buffer_load_dwordx4 v[28:31], v48, s[8:11], s46 offen offset:384
    buffer_load_dwordx4 v[32:35], v49, s[8:11], s46 offen offset:0
    buffer_load_dwordx4 v[36:39], v49, s[8:11], s46 offen offset:128
    buffer_load_dwordx4 v[40:43], v49, s[8:11], s46 offen offset:256
    buffer_load_dwordx4 v[44:47], v49, s[8:11], s46 offen offset:384
    s_mov_b32 s86, 0x3f803f80
    v_and_b32 v56, 1, v0
    v_lshlrev_b32 v56, 7, v56
    v_bfe_u32 v57, v0, 1, 1
    v_lshl_add_u32 v56, v57, 6, v56
    v_and_b32 v57, 0x38, v0
    v_add_u32 v56, v57, v56
    s_sub_u32 s46, 127, s50
    s_lshl_b32 s46, s46, 10
    s_lshl_b32 s37, s32, 8
    s_add_u32 s46, s46, s37
    s_add_u32 s46, s46, 0x5400000
    s_waitcnt vmcnt(0)
    v_dot2_f32_bf16 v48, v16, s86, 0
    v_dot2_f32_bf16 v49, v16, v16, 0
    v_dot2_f32_bf16 v50, v24, s86, 0
    v_dot2_f32_bf16 v51, v24, v24, 0
    v_dot2_f32_bf16 v52, v32, s86, 0
    v_dot2_f32_bf16 v53, v32, v32, 0
    v_dot2_f32_bf16 v54, v40, s86, 0
    v_dot2_f32_bf16 v55, v40, v40, 0
    v_dot2_f32_bf16 v48, v17, s86, v48
    v_dot2_f32_bf16 v49, v17, v17, v49
    v_dot2_f32_bf16 v50, v25, s86, v50
    v_dot2_f32_bf16 v51, v25, v25, v51
    v_dot2_f32_bf16 v52, v33, s86, v52
    v_dot2_f32_bf16 v53, v33, v33, v53
    v_dot2_f32_bf16 v54, v41, s86, v54
    v_dot2_f32_bf16 v55, v41, v41, v55
    v_dot2_f32_bf16 v48, v18, s86, v48
    v_dot2_f32_bf16 v49, v18, v18, v49
    v_dot2_f32_bf16 v50, v26, s86, v50
    v_dot2_f32_bf16 v51, v26, v26, v51
    v_dot2_f32_bf16 v52, v34, s86, v52
    v_dot2_f32_bf16 v53, v34, v34, v53
    v_dot2_f32_bf16 v54, v42, s86, v54
    v_dot2_f32_bf16 v55, v42, v42, v55
    v_dot2_f32_bf16 v48, v19, s86, v48
    v_dot2_f32_bf16 v49, v19, v19, v49
    v_dot2_f32_bf16 v50, v27, s86, v50
    v_dot2_f32_bf16 v51, v27, v27, v51
    v_dot2_f32_bf16 v52, v35, s86, v52
    v_dot2_f32_bf16 v53, v35, v35, v53
    v_dot2_f32_bf16 v54, v43, s86, v54
    v_dot2_f32_bf16 v55, v43, v43, v55
    v_dot2_f32_bf16 v48, v20, s86, v48
    v_dot2_f32_bf16 v49, v20, v20, v49
    v_dot2_f32_bf16 v50, v28, s86, v50
    v_dot2_f32_bf16 v51, v28, v28, v51
    v_dot2_f32_bf16 v52, v36, s86, v52
    v_dot2_f32_bf16 v53, v36, v36, v53
    v_dot2_f32_bf16 v54, v44, s86, v54
    v_dot2_f32_bf16 v55, v44, v44, v55
    v_dot2_f32_bf16 v48, v21, s86, v48
    v_dot2_f32_bf16 v49, v21, v21, v49
    v_dot2_f32_bf16 v50, v29, s86, v50
    v_dot2_f32_bf16 v51, v29, v29, v51
    v_dot2_f32_bf16 v52, v37, s86, v52
    v_dot2_f32_bf16 v53, v37, v37, v53
    v_dot2_f32_bf16 v54, v45, s86, v54
    v_dot2_f32_bf16 v55, v45, v45, v55
    v_dot2_f32_bf16 v48, v22, s86, v48
    v_dot2_f32_bf16 v49, v22, v22, v49
    v_dot2_f32_bf16 v50, v30, s86, v50
    v_dot2_f32_bf16 v51, v30, v30, v51
    v_dot2_f32_bf16 v52, v38, s86, v52
    v_dot2_f32_bf16 v53, v38, v38, v53
    v_dot2_f32_bf16 v54, v46, s86, v54
    v_dot2_f32_bf16 v55, v46, v46, v55
    v_dot2_f32_bf16 v48, v23, s86, v48
    v_dot2_f32_bf16 v49, v23, v23, v49
    v_dot2_f32_bf16 v50, v31, s86, v50
    v_dot2_f32_bf16 v51, v31, v31, v51
    v_dot2_f32_bf16 v52, v39, s86, v52
    v_dot2_f32_bf16 v53, v39, v39, v53
    v_dot2_f32_bf16 v54, v47, s86, v54
    v_dot2_f32_bf16 v55, v47, v47, v55
    v_add_f32_dpp v48, v48, v48 quad_perm:[1,0,3,2] row_mask:0xf bank_mask:0xf
    v_add_f32_dpp v49, v49, v49 quad_perm:[1,0,3,2] row_mask:0xf bank_mask:0xf
    v_add_f32_dpp v50, v50, v50 quad_perm:[1,0,3,2] row_mask:0xf bank_mask:0xf
    v_add_f32_dpp v51, v51, v51 quad_perm:[1,0,3,2] row_mask:0xf bank_mask:0xf
    v_add_f32_dpp v52, v52, v52 quad_perm:[1,0,3,2] row_mask:0xf bank_mask:0xf
    v_add_f32_dpp v53, v53, v53 quad_perm:[1,0,3,2] row_mask:0xf bank_mask:0xf
    v_add_f32_dpp v54, v54, v54 quad_perm:[1,0,3,2] row_mask:0xf bank_mask:0xf
    v_add_f32_dpp v55, v55, v55 quad_perm:[1,0,3,2] row_mask:0xf bank_mask:0xf
    v_add_f32_dpp v48, v48, v48 quad_perm:[2,3,0,1] row_mask:0xf bank_mask:0xf
    v_add_f32_dpp v49, v49, v49 quad_perm:[2,3,0,1] row_mask:0xf bank_mask:0xf
    v_add_f32_dpp v50, v50, v50 quad_perm:[2,3,0,1] row_mask:0xf bank_mask:0xf
    v_add_f32_dpp v51, v51, v51 quad_perm:[2,3,0,1] row_mask:0xf bank_mask:0xf
    v_add_f32_dpp v52, v52, v52 quad_perm:[2,3,0,1] row_mask:0xf bank_mask:0xf
    v_add_f32_dpp v53, v53, v53 quad_perm:[2,3,0,1] row_mask:0xf bank_mask:0xf
    v_add_f32_dpp v54, v54, v54 quad_perm:[2,3,0,1] row_mask:0xf bank_mask:0xf
    v_add_f32_dpp v55, v55, v55 quad_perm:[2,3,0,1] row_mask:0xf bank_mask:0xf
    v_add_f32_dpp v48, v48, v48 row_half_mirror row_mask:0xf bank_mask:0xf
    v_add_f32_dpp v49, v49, v49 row_half_mirror row_mask:0xf bank_mask:0xf
    v_add_f32_dpp v50, v50, v50 row_half_mirror row_mask:0xf bank_mask:0xf
    v_add_f32_dpp v51, v51, v51 row_half_mirror row_mask:0xf bank_mask:0xf
    v_add_f32_dpp v52, v52, v52 row_half_mirror row_mask:0xf bank_mask:0xf
    v_add_f32_dpp v53, v53, v53 row_half_mirror row_mask:0xf bank_mask:0xf
    v_add_f32_dpp v54, v54, v54 row_half_mirror row_mask:0xf bank_mask:0xf
    v_add_f32_dpp v55, v55, v55 row_half_mirror row_mask:0xf bank_mask:0xf
    s_mov_b32 exec_lo, 0x2020202
    s_mov_b32 exec_hi, 0x2020202
    v_mov_b32 v48, v50
    v_mov_b32 v49, v51
    s_mov_b32 exec_lo, 0x4040404
    s_mov_b32 exec_hi, 0x4040404
    v_mov_b32 v48, v52
    v_mov_b32 v49, v53
    s_mov_b32 exec_lo, 0x8080808
    s_mov_b32 exec_hi, 0x8080808
    v_mov_b32 v48, v54
    v_mov_b32 v49, v55
    s_mov_b32 exec_lo, 0x0f0f0f0f
    s_mov_b32 exec_hi, 0x0f0f0f0f
    buffer_store_dwordx2 v[48:49], v56, s[16:19], s46 offen sc1
    s_mov_b64 exec, -1
    s_add_u32 s20, s82, 128
    s_addc_u32 s21, s83, 0
    s_mov_b32 s22, 128
    s_mov_b32 s23, 0x00020000
    buffer_load_dword v8, v124, s[20:23], 0 offen offset:32 sc1
    s_waitcnt vmcnt(0)
    v_readfirstlane_b32 s37, v8
    s_nop 0
    s_cmp_lg_u32 s37, s3
    s_cbranch_scc1 L_vspin25
L_vback26:
    s_mov_b32 s38, 64
    s_mov_b32 s39, 31
    s_waitcnt vmcnt(0)
    s_branch L_job_end
L_lines:
    s_add_u32 s20, s82, 128
    s_addc_u32 s21, s83, 0
    s_mov_b32 s22, 128
    s_mov_b32 s23, 0x00020000
    buffer_load_dword v8, v124, s[20:23], 0 offen offset:32 sc1
    s_waitcnt vmcnt(0)
    v_readfirstlane_b32 s37, v8
    s_nop 0
    s_cmp_lg_u32 s37, s3
    s_cbranch_scc1 L_vspin27
L_vback28:
    buffer_load_dword v248, v6, s[12:15], s44 offen
    s_mov_b32 s12, s68
    s_mov_b32 s13, s69
    s_mov_b32 s14, 0x200000
    s_mov_b32 s15, 0x00020000
    s_sub_u32 s39, 0x180, s12
    s_and_b32 s39, s39, 0x380
    s_sub_u32 s37, s48, 12
    s_lshl2_add_u32 s37, s37, s32
    s_lshl_b32 s37, s37, 15
    s_add_u32 s39, s39, s37
    v_and_b32 v7, 31, v0
    v_lshlrev_b32 v7, 10, v7
    buffer_load_dword v247, v7, s[12:15], s39 offen
    s_mov_b32 s14, 0
    s_sub_u32 s53, s53, 48
    s_and_b32 s37, s53, 7
    s_cmp_lt_u32 s37, 2
    s_cselect_b32 s87, 2, 3
    s_cselect_b32 s36, 34, 32
    s_cmp_ge_u32 s53, 32
    s_cselect_b32 s87, 2, s87
    s_cselect_b32 s36, 35, s36
    s_cselect_b32 s38, 5, 0
    s_cmp_lt_u32 s37, s38
    s_cselect_b32 s37, 0x5e00000, 0
    s_lshl_b32 s38, s53, 10
    s_add_u32 s37, s37, s38
    s_lshl_b32 s38, s32, 16
    s_add_u32 s37, s37, s38
    s_add_u32 s37, s37, 0x5500000
    s_sub_u32 s87, s32, s87
    s_cmp_lt_u32 s87, s36
    s_cselect_b32 s38, -1, 0
    v_mov_b32 v16, s38
    s_add_u32 s87, s87, 4
    buffer_store_dwordx4 v[16:19], v1, s[16:19], s37 offen sc1
    s_add_u32 s37, s37, 262144
    s_cmp_lt_u32 s87, s36
    s_cselect_b32 s38, -1, 0
    v_mov_b32 v20, s38
    s_add_u32 s87, s87, 4
    buffer_store_dwordx4 v[20:23], v1, s[16:19], s37 offen sc1
    s_add_u32 s37, s37, 262144
    s_cmp_lt_u32 s87, s36
    s_cselect_b32 s38, -1, 0
    v_mov_b32 v24, s38
    s_add_u32 s87, s87, 4
    buffer_store_dwordx4 v[24:27], v1, s[16:19], s37 offen sc1
    s_add_u32 s37, s37, 262144
    s_cmp_lt_u32 s87, s36
    s_cselect_b32 s38, -1, 0
    v_mov_b32 v28, s38
    s_add_u32 s87, s87, 4
    buffer_store_dwordx4 v[28:31], v1, s[16:19], s37 offen sc1
    s_add_u32 s37, s37, 262144
    s_cmp_lt_u32 s87, s36
    s_cselect_b32 s38, -1, 0
    v_mov_b32 v32, s38
    s_add_u32 s87, s87, 4
    buffer_store_dwordx4 v[32:35], v1, s[16:19], s37 offen sc1
    s_add_u32 s37, s37, 262144
    s_cmp_lt_u32 s87, s36
    s_cselect_b32 s38, -1, 0
    v_mov_b32 v36, s38
    s_add_u32 s87, s87, 4
    buffer_store_dwordx4 v[36:39], v1, s[16:19], s37 offen sc1
    s_add_u32 s37, s37, 262144
    s_cmp_lt_u32 s87, s36
    s_cselect_b32 s38, -1, 0
    v_mov_b32 v40, s38
    s_add_u32 s87, s87, 4
    buffer_store_dwordx4 v[40:43], v1, s[16:19], s37 offen sc1
    s_add_u32 s37, s37, 262144
    s_cmp_lt_u32 s87, s36
    s_cselect_b32 s38, -1, 0
    v_mov_b32 v44, s38
    s_add_u32 s87, s87, 4
    buffer_store_dwordx4 v[44:47], v1, s[16:19], s37 offen sc1
    s_add_u32 s37, s37, 262144
    s_cmp_lt_u32 s87, s36
    s_cselect_b32 s38, -1, 0
    v_mov_b32 v48, s38
    s_add_u32 s87, s87, 4
    buffer_store_dwordx4 v[48:51], v1, s[16:19], s37 offen sc1
    s_add_u32 s37, s37, 262144
    s_cmp_lt_u32 s87, s36
    s_cselect_b32 s38, -1, 0
    v_mov_b32 v52, s38
    s_add_u32 s87, s87, 4
    buffer_store_dwordx4 v[52:55], v1, s[16:19], s37 offen sc1
    s_add_u32 s37, s37, 262144
    v_mov_b32 v8, -1
    v_mov_b32 v9, -1
    v_mov_b32 v10, -1
    v_mov_b32 v11, -1
    s_lshl2_add_u32 s38, s53, s32
    s_lshl_b32 s38, s38, 10
    s_add_u32 s38, s38, 0x5440000
    buffer_store_dwordx4 v[8:11], v1, s[16:19], s38 offen sc1
    s_mov_b32 s38, 0
    s_mov_b32 s39, 63
    s_waitcnt vmcnt(0)
L_job_end:
    s_mov_b32 s8, s82
    s_mov_b32 s9, s83
    s_mov_b32 s10, 0x100
    s_mov_b32 s11, 0x00020000
    v_mov_b32 v123, 1
    s_barrier
    s_cmp_lg_u32 s32, 3
    s_cbranch_scc1 L_arr29
    buffer_atomic_add v123, v124, s[8:11], s38 offen sc0
    s_waitcnt vmcnt(0)
    v_readfirstlane_b32 s37, v123
    s_nop 0
    s_cmp_lg_u32 s37, s39
    s_cbranch_scc1 L_arr29
    buffer_store_dword v123, v124, s[8:11], s38 offen offset:128 sc1
L_arr29:
L_touch:
    buffer_load_dword v248, v6, s[12:15], s44 offen
    s_lshl_b32 s91, s33, 6
    s_add_u32 s91, s91, s34
    s_lshl_b32 s91, s91, 7
    s_add_u32 s91, s91, 0x5520000
    s_cmp_eq_u32 s32, 1
    s_cselect_b32 s91, s91, 0x5f00000
    s_cmp_ge_u32 s34, 60
    s_cbranch_scc1 L_role_60
    s_cmp_ge_u32 s34, 44
    s_cbranch_scc1 L_role_44
    s_cmp_ge_u32 s34, 40
    s_cbranch_scc1 L_role_40
L_role_16:
    s_sub_u32 s35, s34, 16
    s_lshl_b32 s54, s35, 8
    s_mov_b32 s12, s68
    s_mov_b32 s13, s69
    s_mov_b32 s14, 0x200000
    s_mov_b32 s15, 0x00020000
    s_mov_b32 s39, 2048
    v_lshrrev_b32 v52, 3, v0
    v_lshlrev_b32 v53, 2, v0
    v_and_b32 v53, 64, v53
    v_and_b32 v54, 0x70, v1
    v_xor_b32 v53, v53, v54
    v_mad_u32_u24 v44, v52, s39, v53
    v_add_u32 v45, 16384, v44
    v_add_u32 v46, 128, v44
    v_add_u32 v47, 16512, v44
    s_mul_i32 s38, s32, 32768
    s_add_u32 s54, s54, s38
    s_lshl_b32 s42, s32, 11
    s_add_u32 m0, s42, 0
    s_nop 0
    buffer_load_dwordx4 v44, s[12:15], s54 offen lds
    s_add_u32 m0, s42, 1024
    s_nop 0
    buffer_load_dwordx4 v45, s[12:15], s54 offen lds
    s_add_u32 m0, s42, 8192
    s_nop 0
    buffer_load_dwordx4 v46, s[12:15], s54 offen lds
    s_add_u32 m0, s42, 9216
    s_nop 0
    buffer_load_dwordx4 v47, s[12:15], s54 offen lds
    s_add_u32 s54, s54, 131072
    s_add_u32 m0, s42, 16384
    s_nop 0
    buffer_load_dwordx4 v44, s[12:15], s54 offen lds
    s_add_u32 m0, s42, 17408
    s_nop 0
    buffer_load_dwordx4 v45, s[12:15], s54 offen lds
    s_add_u32 m0, s42, 24576
    s_nop 0
    buffer_load_dwordx4 v46, s[12:15], s54 offen lds
    s_add_u32 m0, s42, 25600
    s_nop 0
    buffer_load_dwordx4 v47, s[12:15], s54 offen lds
    s_add_u32 s54, s54, 131072
    s_add_u32 m0, s42, 32768
    s_nop 0
    buffer_load_dwordx4 v44, s[12:15], s54 offen lds
    s_add_u32 m0, s42, 33792
    s_nop 0
    buffer_load_dwordx4 v45, s[12:15], s54 offen lds
    s_add_u32 m0, s42, 40960
    s_nop 0
    buffer_load_dwordx4 v46, s[12:15], s54 offen lds
    s_add_u32 m0, s42, 41984
    s_nop 0
    buffer_load_dwordx4 v47, s[12:15], s54 offen lds
    s_add_u32 s54, s54, 131072
    s_add_u32 m0, s42, 49152
    s_nop 0
    buffer_load_dwordx4 v44, s[12:15], s54 offen lds
    s_add_u32 m0, s42, 50176
    s_nop 0
    buffer_load_dwordx4 v45, s[12:15], s54 offen lds
    s_add_u32 m0, s42, 57344
    s_nop 0
    buffer_load_dwordx4 v46, s[12:15], s54 offen lds
    s_add_u32 m0, s42, 58368
    s_nop 0
    buffer_load_dwordx4 v47, s[12:15], s54 offen lds
    s_add_u32 s54, s54, 131072
    s_add_u32 m0, s42, 65536
    s_nop 0
    buffer_load_dwordx4 v44, s[12:15], s54 offen lds
    s_add_u32 m0, s42, 66560
    s_nop 0
    buffer_load_dwordx4 v45, s[12:15], s54 offen lds
    s_add_u32 m0, s42, 73728
    s_nop 0
    buffer_load_dwordx4 v46, s[12:15], s54 offen lds
    s_add_u32 m0, s42, 74752
    s_nop 0
    buffer_load_dwordx4 v47, s[12:15], s54 offen lds
    s_add_u32 s54, s54, 131072
    v_lshrrev_b32 v52, 4, v0
    v_bfe_u32 v53, v0, 2, 2
    v_lshl_add_u32 v52, v52, 3, v53
    v_lshlrev_b32 v52, 7, v52
    v_lshrrev_b32 v53, 1, v53
    v_lshl_add_u32 v52, v53, 6, v52
    v_and_b32 v53, 3, v0
    v_lshl_add_u32 v52, v53, 4, v52
    s_lshr_b32 s37, s32, 1
    s_lshl_b32 s37, s37, 13
    s_and_b32 s38, s32, 1
    s_lshl_b32 s38, s38, 6
    s_add_u32 s37, s37, s38
    s_add_u32 s37, s37, 0
    v_xor_b32 v48, s37, v52
    s_lshr_b32 s37, s32, 1
    s_lshl_b32 s37, s37, 13
    s_and_b32 s38, s32, 1
    s_lshl_b32 s38, s38, 6
    s_add_u32 s37, s37, s38
    s_add_u32 s37, s37, 8
    v_xor_b32 v49, s37, v52
    v_add_u32 v2, 98304, v1
    v_mov_b32 v108, 0
    v_mov_b32 v109, 0
    v_mov_b32 v110, 0
    v_mov_b32 v111, 0
    v_mov_b32 v112, 0
    v_mov_b32 v113, 0
    v_mov_b32 v114, 0
    v_mov_b32 v115, 0
    v_mov_b32 v13, 0x3f80
    v_and_b32 v12, 1, v0
    v_lshlrev_b32 v12, 4, v12
    v_lshlrev_b32 v12, v12, v13
    s_mov_b32 exec_lo, 0x300003
    s_mov_b32 exec_hi, 0x30000300
    v_mov_b32 v108, v12
    v_mov_b32 v114, v12
    s_mov_b32 exec_lo, 0xc0000c
    s_mov_b32 exec_hi, 0xc0000c00
    v_mov_b32 v109, v12
    v_mov_b32 v115, v12
    s_mov_b64 exec, -1
    s_lshl_b32 s37, s33, 6
    s_add_u32 s37, s37, 0
    s_lshl_b32 s37, s37, 7
    v_lshl_add_u32 v4, v0, 7, s37
    s_cmp_eq_u32 s32, 0
    s_cselect_b32 s37, 16, 0
    v_cmp_le_u32 vcc, s37, v0
    s_nop 1
    v_cndmask_b32 v4, v4, 2.0, vcc
    s_mov_b32 s86, 0x3f803f80
    s_lshl_b32 s43, s32, 12
    s_mul_i32 s41, s33, 2097152
    s_add_u32 s41, s41, 0x0
    s_add_u32 s41, s41, s43
    s_lshl_b32 s38, s35, 2
    s_add_u32 s38, s38, s32
    s_mul_i32 s90, s33, 2097152
    s_add_u32 s90, s90, 0x7f0000
    s_lshl_b32 s37, s38, 11
    s_add_u32 s90, s90, s37
    v_and_b32 v12, 15, v0
    v_and_b32 v13, 0x30, v0
    v_lshl_add_u32 v3, v12, 11, v13
    s_lshl_b32 s37, s38, 6
    v_add_u32 v3, s37, v3
    s_lshl_b32 s50, s33, 20
    s_add_u32 s50, s50, 983040
    s_add_u32 s88, s84, 0x5000000
    s_addc_u32 s89, s85, 0
    s_mov_b32 s8, s64
    s_mov_b32 s9, s65
    s_mov_b32 s10, 0x400000
    s_mov_b32 s11, 0x00020000
    v_bfe_u32 v13, v0, 4, 1
    v_lshl_add_u32 v12, v12, 1, v13
    s_lshl_b32 s37, s32, 2
    s_add_u32 s37, s37, 65536
    v_lshl_add_u32 v6, v12, 4, s37
    v_add_u32 v7, 65536, v1
    v_and_b32 v12, 31, v0
    v_lshrrev_b32 v13, 5, v0
    v_lshlrev_b32 v12, 2, v12
    v_lshl_add_u32 v8, v13, 10, v12
    s_mul_i32 s46, s33, 65536
    s_add_u32 s46, s46, 0x543f800
    s_lshl_b32 s37, s35, 7
    s_add_u32 s46, s46, s37
    s_cmp_eq_u32 s32, 2
    s_cselect_b32 s46, s46, 0x5f00000
    s_mov_b32 s36, -1
    s_add_u32 s20, s82, 0x80
    s_addc_u32 s21, s83, 0
    s_mov_b32 s22, 0x80
    s_mov_b32 s23, 0x00020000
    v_lshl_add_u32 v56, s32, 7, v124
    v_add_u32 v50, 0, v48
    v_add_u32 v51, 0, v49
    s_waitcnt vmcnt(16)
    s_barrier
    ds_read_b64_tr_b16 a[0:1], v50 offset:0
    ds_read_b64_tr_b16 a[2:3], v50 offset:512
    ds_read_b64_tr_b16 a[4:5], v51 offset:0
    ds_read_b64_tr_b16 a[6:7], v51 offset:512
    ds_read_b64_tr_b16 a[8:9], v50 offset:4096
    ds_read_b64_tr_b16 a[10:11], v50 offset:4608
    ds_read_b64_tr_b16 a[12:13], v51 offset:4096
    ds_read_b64_tr_b16 a[14:15], v51 offset:4608
    s_add_u32 m0, s42, 81920
    s_nop 0
    buffer_load_dwordx4 v44, s[12:15], s54 offen lds
    s_add_u32 m0, s42, 82944
    s_nop 0
    buffer_load_dwordx4 v45, s[12:15], s54 offen lds
    s_add_u32 m0, s42, 90112
    s_nop 0
    buffer_load_dwordx4 v46, s[12:15], s54 offen lds
    s_add_u32 m0, s42, 91136
    s_nop 0
    buffer_load_dwordx4 v47, s[12:15], s54 offen lds
    s_add_u32 s54, s54, 131072
    s_waitcnt lgkmcnt(0)
    v_add_u32 v50, 16384, v48
    v_add_u32 v51, 16384, v49
    s_waitcnt vmcnt(16)
    s_barrier
    ds_read_b64_tr_b16 a[16:17], v50 offset:0
    ds_read_b64_tr_b16 a[18:19], v50 offset:512
    ds_read_b64_tr_b16 a[20:21], v51 offset:0
    ds_read_b64_tr_b16 a[22:23], v51 offset:512
    ds_read_b64_tr_b16 a[24:25], v50 offset:4096
    ds_read_b64_tr_b16 a[26:27], v50 offset:4608
    ds_read_b64_tr_b16 a[28:29], v51 offset:4096
    ds_read_b64_tr_b16 a[30:31], v51 offset:4608
    s_add_u32 m0, s42, 0
    s_nop 0
    buffer_load_dwordx4 v44, s[12:15], s54 offen lds
    s_add_u32 m0, s42, 1024
    s_nop 0
    buffer_load_dwordx4 v45, s[12:15], s54 offen lds
    s_add_u32 m0, s42, 8192
    s_nop 0
    buffer_load_dwordx4 v46, s[12:15], s54 offen lds
    s_add_u32 m0, s42, 9216
    s_nop 0
    buffer_load_dwordx4 v47, s[12:15], s54 offen lds
    s_add_u32 s54, s54, 131072
    s_waitcnt lgkmcnt(0)
    v_add_u32 v50, 32768, v48
    v_add_u32 v51, 32768, v49
    s_waitcnt vmcnt(16)
    s_barrier
    ds_read_b64_tr_b16 a[32:33], v50 offset:0
    ds_read_b64_tr_b16 a[34:35], v50 offset:512
    ds_read_b64_tr_b16 a[36:37], v51 offset:0
    ds_read_b64_tr_b16 a[38:39], v51 offset:512
    ds_read_b64_tr_b16 a[40:41], v50 offset:4096
    ds_read_b64_tr_b16 a[42:43], v50 offset:4608
    ds_read_b64_tr_b16 a[44:45], v51 offset:4096
    ds_read_b64_tr_b16 a[46:47], v51 offset:4608
    s_add_u32 m0, s42, 16384
    s_nop 0
    buffer_load_dwordx4 v44, s[12:15], s54 offen lds
    s_add_u32 m0, s42, 17408
    s_nop 0
    buffer_load_dwordx4 v45, s[12:15], s54 offen lds
    s_add_u32 m0, s42, 24576
    s_nop 0
    buffer_load_dwordx4 v46, s[12:15], s54 offen lds
    s_add_u32 m0, s42, 25600
    s_nop 0
    buffer_load_dwordx4 v47, s[12:15], s54 offen lds
    s_add_u32 s54, s54, 131072
    s_waitcnt lgkmcnt(0)
    v_add_u32 v50, 49152, v48
    v_add_u32 v51, 49152, v49
    s_waitcnt vmcnt(16)
    s_barrier
    ds_read_b64_tr_b16 a[48:49], v50 offset:0
    ds_read_b64_tr_b16 a[50:51], v50 offset:512
    ds_read_b64_tr_b16 a[52:53], v51 offset:0
    ds_read_b64_tr_b16 a[54:55], v51 offset:512
    ds_read_b64_tr_b16 a[56:57], v50 offset:4096
    ds_read_b64_tr_b16 a[58:59], v50 offset:4608
    ds_read_b64_tr_b16 a[60:61], v51 offset:4096
    ds_read_b64_tr_b16 a[62:63], v51 offset:4608
    s_add_u32 m0, s42, 32768
    s_nop 0
    buffer_load_dwordx4 v44, s[12:15], s54 offen lds
    s_add_u32 m0, s42, 33792
    s_nop 0
    buffer_load_dwordx4 v45, s[12:15], s54 offen lds
    s_add_u32 m0, s42, 40960
    s_nop 0
    buffer_load_dwordx4 v46, s[12:15], s54 offen lds
    s_add_u32 m0, s42, 41984
    s_nop 0
    buffer_load_dwordx4 v47, s[12:15], s54 offen lds
    s_add_u32 s54, s54, 131072
    s_waitcnt lgkmcnt(0)
    v_add_u32 v50, 65536, v48
    v_add_u32 v51, 65536, v49
    s_waitcnt vmcnt(16)
    s_barrier
    ds_read_b64_tr_b16 a[64:65], v50 offset:0
    ds_read_b64_tr_b16 a[66:67], v50 offset:512
    ds_read_b64_tr_b16 a[68:69], v51 offset:0
    ds_read_b64_tr_b16 a[70:71], v51 offset:512
    ds_read_b64_tr_b16 a[72:73], v50 offset:4096
    ds_read_b64_tr_b16 a[74:75], v50 offset:4608
    ds_read_b64_tr_b16 a[76:77], v51 offset:4096
    ds_read_b64_tr_b16 a[78:79], v51 offset:4608
    s_add_u32 m0, s42, 49152
    s_nop 0
    buffer_load_dwordx4 v44, s[12:15], s54 offen lds
    s_add_u32 m0, s42, 50176
    s_nop 0
    buffer_load_dwordx4 v45, s[12:15], s54 offen lds
    s_add_u32 m0, s42, 57344
    s_nop 0
    buffer_load_dwordx4 v46, s[12:15], s54 offen lds
    s_add_u32 m0, s42, 58368
    s_nop 0
    buffer_load_dwordx4 v47, s[12:15], s54 offen lds
    s_add_u32 s54, s54, 131072
    s_waitcnt lgkmcnt(0)
    v_add_u32 v50, 81920, v48
    v_add_u32 v51, 81920, v49
    s_waitcnt vmcnt(16)
    s_barrier
    ds_read_b64_tr_b16 a[80:81], v50 offset:0
    ds_read_b64_tr_b16 a[82:83], v50 offset:512
    ds_read_b64_tr_b16 a[84:85], v51 offset:0
    ds_read_b64_tr_b16 a[86:87], v51 offset:512
    ds_read_b64_tr_b16 a[88:89], v50 offset:4096
    ds_read_b64_tr_b16 a[90:91], v50 offset:4608
    ds_read_b64_tr_b16 a[92:93], v51 offset:4096
    ds_read_b64_tr_b16 a[94:95], v51 offset:4608
    s_add_u32 m0, s42, 65536
    s_nop 0
    buffer_load_dwordx4 v44, s[12:15], s54 offen lds
    s_add_u32 m0, s42, 66560
    s_nop 0
    buffer_load_dwordx4 v45, s[12:15], s54 offen lds
    s_add_u32 m0, s42, 73728
    s_nop 0
    buffer_load_dwordx4 v46, s[12:15], s54 offen lds
    s_add_u32 m0, s42, 74752
    s_nop 0
    buffer_load_dwordx4 v47, s[12:15], s54 offen lds
    s_add_u32 s54, s54, 131072
    s_waitcnt lgkmcnt(0)
    v_add_u32 v50, 0, v48
    v_add_u32 v51, 0, v49
    s_waitcnt vmcnt(16)
    s_barrier
    ds_read_b64_tr_b16 a[96:97], v50 offset:0
    ds_read_b64_tr_b16 a[98:99], v50 offset:512
    ds_read_b64_tr_b16 a[100:101], v51 offset:0
    ds_read_b64_tr_b16 a[102:103], v51 offset:512
    ds_read_b64_tr_b16 a[104:105], v50 offset:4096
    ds_read_b64_tr_b16 a[106:107], v50 offset:4608
    ds_read_b64_tr_b16 a[108:109], v51 offset:4096
    ds_read_b64_tr_b16 a[110:111], v51 offset:4608
    s_add_u32 m0, s42, 81920
    s_nop 0
    buffer_load_dwordx4 v44, s[12:15], s54 offen lds
    s_add_u32 m0, s42, 82944
    s_nop 0
    buffer_load_dwordx4 v45, s[12:15], s54 offen lds
    s_add_u32 m0, s42, 90112
    s_nop 0
    buffer_load_dwordx4 v46, s[12:15], s54 offen lds
    s_add_u32 m0, s42, 91136
    s_nop 0
    buffer_load_dwordx4 v47, s[12:15], s54 offen lds
    s_add_u32 s54, s54, 131072
    s_waitcnt lgkmcnt(0)
    v_add_u32 v50, 16384, v48
    v_add_u32 v51, 16384, v49
    s_waitcnt vmcnt(16)
    s_barrier
    ds_read_b64_tr_b16 a[112:113], v50 offset:0
    ds_read_b64_tr_b16 a[114:115], v50 offset:512
    ds_read_b64_tr_b16 a[116:117], v51 offset:0
    ds_read_b64_tr_b16 a[118:119], v51 offset:512
    ds_read_b64_tr_b16 a[120:121], v50 offset:4096
    ds_read_b64_tr_b16 a[122:123], v50 offset:4608
    ds_read_b64_tr_b16 a[124:125], v51 offset:4096
    ds_read_b64_tr_b16 a[126:127], v51 offset:4608
    s_add_u32 m0, s42, 0
    s_nop 0
    buffer_load_dwordx4 v44, s[12:15], s54 offen lds
    s_add_u32 m0, s42, 1024
    s_nop 0
    buffer_load_dwordx4 v45, s[12:15], s54 offen lds
    s_add_u32 m0, s42, 8192
    s_nop 0
    buffer_load_dwordx4 v46, s[12:15], s54 offen lds
    s_add_u32 m0, s42, 9216
    s_nop 0
    buffer_load_dwordx4 v47, s[12:15], s54 offen lds
    s_add_u32 s54, s54, 131072
    s_waitcnt lgkmcnt(0)
    v_add_u32 v50, 32768, v48
    v_add_u32 v51, 32768, v49
    s_waitcnt vmcnt(16)
    s_barrier
    ds_read_b64_tr_b16 a[128:129], v50 offset:0
    ds_read_b64_tr_b16 a[130:131], v50 offset:512
    ds_read_b64_tr_b16 a[132:133], v51 offset:0
    ds_read_b64_tr_b16 a[134:135], v51 offset:512
    ds_read_b64_tr_b16 a[136:137], v50 offset:4096
    ds_read_b64_tr_b16 a[138:139], v50 offset:4608
    ds_read_b64_tr_b16 a[140:141], v51 offset:4096
    ds_read_b64_tr_b16 a[142:143], v51 offset:4608
    s_add_u32 m0, s42, 16384
    s_nop 0
    buffer_load_dwordx4 v44, s[12:15], s54 offen lds
    s_add_u32 m0, s42, 17408
    s_nop 0
    buffer_load_dwordx4 v45, s[12:15], s54 offen lds
    s_add_u32 m0, s42, 24576
    s_nop 0
    buffer_load_dwordx4 v46, s[12:15], s54 offen lds
    s_add_u32 m0, s42, 25600
    s_nop 0
    buffer_load_dwordx4 v47, s[12:15], s54 offen lds
    s_add_u32 s54, s54, 131072
    s_waitcnt lgkmcnt(0)
    v_add_u32 v50, 49152, v48
    v_add_u32 v51, 49152, v49
    s_waitcnt vmcnt(16)
    s_barrier
    ds_read_b64_tr_b16 a[144:145], v50 offset:0
    ds_read_b64_tr_b16 a[146:147], v50 offset:512
    ds_read_b64_tr_b16 a[148:149], v51 offset:0
    ds_read_b64_tr_b16 a[150:151], v51 offset:512
    ds_read_b64_tr_b16 a[152:153], v50 offset:4096
    ds_read_b64_tr_b16 a[154:155], v50 offset:4608
    ds_read_b64_tr_b16 a[156:157], v51 offset:4096
    ds_read_b64_tr_b16 a[158:159], v51 offset:4608
    s_add_u32 m0, s42, 32768
    s_nop 0
    buffer_load_dwordx4 v44, s[12:15], s54 offen lds
    s_add_u32 m0, s42, 33792
    s_nop 0
    buffer_load_dwordx4 v45, s[12:15], s54 offen lds
    s_add_u32 m0, s42, 40960
    s_nop 0
    buffer_load_dwordx4 v46, s[12:15], s54 offen lds
    s_add_u32 m0, s42, 41984
    s_nop 0
    buffer_load_dwordx4 v47, s[12:15], s54 offen lds
    s_add_u32 s54, s54, 131072
    s_waitcnt lgkmcnt(0)
    v_add_u32 v50, 65536, v48
    v_add_u32 v51, 65536, v49
    s_waitcnt vmcnt(16)
    s_barrier
    ds_read_b64_tr_b16 a[160:161], v50 offset:0
    ds_read_b64_tr_b16 a[162:163], v50 offset:512
    ds_read_b64_tr_b16 a[164:165], v51 offset:0
    ds_read_b64_tr_b16 a[166:167], v51 offset:512
    ds_read_b64_tr_b16 a[168:169], v50 offset:4096
    ds_read_b64_tr_b16 a[170:171], v50 offset:4608
    ds_read_b64_tr_b16 a[172:173], v51 offset:4096
    ds_read_b64_tr_b16 a[174:175], v51 offset:4608
    buffer_load_dword v58, v124, s[20:23], 0 offen offset:32 sc1
    buffer_load_dword v57, v56, s[20:23], 0 offen sc1
    s_add_u32 m0, s42, 49152
    s_nop 0
    buffer_load_dwordx4 v44, s[12:15], s54 offen lds
    s_add_u32 m0, s42, 50176
    s_nop 0
    buffer_load_dwordx4 v45, s[12:15], s54 offen lds
    s_add_u32 m0, s42, 57344
    s_nop 0
    buffer_load_dwordx4 v46, s[12:15], s54 offen lds
    s_add_u32 m0, s42, 58368
    s_nop 0
    buffer_load_dwordx4 v47, s[12:15], s54 offen lds
    s_add_u32 s54, s54, 131072
    s_waitcnt lgkmcnt(0)
    v_add_u32 v50, 81920, v48
    v_add_u32 v51, 81920, v49
    s_waitcnt vmcnt(18)
    s_barrier
    ds_read_b64_tr_b16 a[176:177], v50 offset:0
    ds_read_b64_tr_b16 a[178:179], v50 offset:512
    ds_read_b64_tr_b16 a[180:181], v51 offset:0
    ds_read_b64_tr_b16 a[182:183], v51 offset:512
    ds_read_b64_tr_b16 a[184:185], v50 offset:4096
    ds_read_b64_tr_b16 a[186:187], v50 offset:4608
    ds_read_b64_tr_b16 a[188:189], v51 offset:4096
    ds_read_b64_tr_b16 a[190:191], v51 offset:4608
    s_waitcnt lgkmcnt(0)
    v_add_u32 v50, 0, v48
    v_add_u32 v51, 0, v49
    s_waitcnt vmcnt(14)
    s_barrier
    ds_read_b64_tr_b16 a[192:193], v50 offset:0
    ds_read_b64_tr_b16 a[194:195], v50 offset:512
    ds_read_b64_tr_b16 a[196:197], v51 offset:0
    ds_read_b64_tr_b16 a[198:199], v51 offset:512
    ds_read_b64_tr_b16 a[200:201], v50 offset:4096
    ds_read_b64_tr_b16 a[202:203], v50 offset:4608
    ds_read_b64_tr_b16 a[204:205], v51 offset:4096
    ds_read_b64_tr_b16 a[206:207], v51 offset:4608
    s_waitcnt lgkmcnt(0)
    v_add_u32 v50, 16384, v48
    v_add_u32 v51, 16384, v49
    s_waitcnt vmcnt(10)
    s_barrier
    ds_read_b64_tr_b16 a[208:209], v50 offset:0
    ds_read_b64_tr_b16 a[210:211], v50 offset:512
    ds_read_b64_tr_b16 a[212:213], v51 offset:0
    ds_read_b64_tr_b16 a[214:215], v51 offset:512
    ds_read_b64_tr_b16 a[216:217], v50 offset:4096
    ds_read_b64_tr_b16 a[218:219], v50 offset:4608
    ds_read_b64_tr_b16 a[220:221], v51 offset:4096
    ds_read_b64_tr_b16 a[222:223], v51 offset:4608
    s_waitcnt lgkmcnt(0)
    v_add_u32 v50, 32768, v48
    v_add_u32 v51, 32768, v49
    s_waitcnt vmcnt(6)
    s_barrier
    ds_read_b64_tr_b16 a[224:225], v50 offset:0
    ds_read_b64_tr_b16 a[226:227], v50 offset:512
    ds_read_b64_tr_b16 a[228:229], v51 offset:0
    ds_read_b64_tr_b16 a[230:231], v51 offset:512
    ds_read_b64_tr_b16 a[232:233], v50 offset:4096
    ds_read_b64_tr_b16 a[234:235], v50 offset:4608
    ds_read_b64_tr_b16 a[236:237], v51 offset:4096
    ds_read_b64_tr_b16 a[238:239], v51 offset:4608
    s_waitcnt lgkmcnt(0)
    v_add_u32 v50, 49152, v48
    v_add_u32 v51, 49152, v49
    s_waitcnt vmcnt(0)
    v_readfirstlane_b32 s37, v58
    s_nop 0
    s_cmp_lg_u32 s37, s3
    s_cbranch_scc1 L_vspin30
L_vback31:
    v_cmp_eq_u32 vcc, v56, v57
    s_cbranch_vccnz L_spin32
L_back33:
    s_barrier
    ds_read_b64_tr_b16 a[240:241], v50 offset:0
    ds_read_b64_tr_b16 a[242:243], v50 offset:512
    ds_read_b64_tr_b16 a[244:245], v51 offset:0
    ds_read_b64_tr_b16 a[246:247], v51 offset:512
    ds_read_b64_tr_b16 a[248:249], v50 offset:4096
    ds_read_b64_tr_b16 a[250:251], v50 offset:4608
    ds_read_b64_tr_b16 a[252:253], v51 offset:4096
    ds_read_b64_tr_b16 a[254:255], v51 offset:4608
    s_waitcnt lgkmcnt(0)
    s_barrier
    s_add_u32 s47, s36, 1
    s_min_i32 s47, s47, 31
    s_max_i32 s47, s47, 0
    s_cmp_ge_u32 s47, 16
    s_cselect_b32 s8, s88, s64
    s_cselect_b32 s9, s89, s65
    s_and_b32 s47, s47, 15
    s_lshl_b32 s47, s47, 16
    s_sub_u32 s47, s50, s47
    s_add_u32 s48, s47, 32768
    buffer_load_dwordx4 v[128:131], v3, s[8:11], s48 offen sc1
    buffer_load_dwordx4 v[132:135], v3, s[8:11], s47 offen sc1
    s_add_u32 s96, s41, 2031616
    s_mov_b32 s98, s41
    s_mov_b32 s45, 0x5540000
    buffer_load_dword v136, v4, s[16:19], s45 offen sc1
    s_waitcnt vmcnt(0)
    v_cmp_ne_u32 vcc, 0, v136
    s_cbranch_vccnz L_spin34
L_back35:
    s_barrier
    s_mov_b32 s39, 0x5e00000
    s_add_u32 m0, s43, 0
    s_add_u32 s42, s41, 0
    buffer_load_dwordx4 v1, s[16:19], s42 offen offset:0 sc1 lds
    buffer_load_dwordx4 v1, s[16:19], s42 offen offset:1024 sc1 lds
    buffer_load_dwordx4 v1, s[16:19], s42 offen offset:2048 sc1 lds
    buffer_load_dwordx4 v1, s[16:19], s42 offen offset:3072 sc1 lds
    s_add_u32 m0, s43, 16384
    s_add_u32 s42, s41, 16384
    buffer_load_dwordx4 v1, s[16:19], s42 offen offset:0 sc1 lds
    buffer_load_dwordx4 v1, s[16:19], s42 offen offset:1024 sc1 lds
    buffer_load_dwordx4 v1, s[16:19], s42 offen offset:2048 sc1 lds
    buffer_load_dwordx4 v1, s[16:19], s42 offen offset:3072 sc1 lds
    buffer_store_dword v124, v124, s[16:19], s39 offen
    buffer_store_dword v124, v124, s[16:19], s39 offen
    s_add_u32 m0, s43, 32768
    s_add_u32 s42, s41, 32768
    buffer_load_dwordx4 v1, s[16:19], s42 offen offset:0 sc1 lds
    buffer_load_dwordx4 v1, s[16:19], s42 offen offset:1024 sc1 lds
    buffer_load_dwordx4 v1, s[16:19], s42 offen offset:2048 sc1 lds
    buffer_load_dwordx4 v1, s[16:19], s42 offen offset:3072 sc1 lds
    s_add_u32 s45, s45, 65536
    s_waitcnt vmcnt(10) lgkmcnt(0)
    s_barrier
    v_mfma_f32_16x16x32_bf16 v[12:15], v[108:111], v[128:131], 0
    v_mfma_f32_16x16x32_bf16 v[16:19], v[112:115], v[128:131], 0
    v_mfma_f32_16x16x32_bf16 v[20:23], v[108:111], v[132:135], 0
    v_mfma_f32_16x16x32_bf16 v[24:27], v[112:115], v[132:135], 0
    ds_read_b128 v[44:47], v1 offset:0
    ds_read_b128 v[48:51], v1 offset:1024
    ds_read_b128 v[52:55], v1 offset:2048
    ds_read_b128 v[56:59], v1 offset:3072
    s_mov_b32 s36, 0
    s_waitcnt lgkmcnt(0)
    s_nop 7
L_o_b0:
    s_waitcnt lgkmcnt(2)
    v_mfma_f32_16x16x32_bf16 v[12:15], a[0:3], v[44:47], v[12:15]
    ds_read_b128 v[60:63], v1 offset:4096
    ds_read_b128 v[140:143], v7
    v_mfma_f32_16x16x32_bf16 v[20:23], a[0:3], v[48:51], v[20:23]
    s_cmp_eq_u32 s36, 0
    s_cselect_b32 s49, 0x5e00000, s46
    v_mfma_f32_16x16x32_bf16 v[24:27], a[4:7], v[48:51], v[24:27]
    ds_read_b128 v[64:67], v1 offset:5120
    v_mfma_f32_16x16x32_bf16 v[16:19], a[4:7], v[44:47], v[16:19]
    s_waitcnt lgkmcnt(3)
    v_mfma_f32_16x16x32_bf16 v[12:15], a[8:11], v[52:55], v[12:15]
    s_waitcnt lgkmcnt(1)
    ds_read_b128 v[68:71], v1 offset:6144
    v_add_f32 v140, v140, v141
    v_mfma_f32_16x16x32_bf16 v[20:23], a[8:11], v[56:59], v[20:23]
    v_add_f32 v142, v142, v143
    v_add_f32 v140, v140, v142
    v_mfma_f32_16x16x32_bf16 v[24:27], a[12:15], v[56:59], v[24:27]
    ds_read_b128 v[72:75], v1 offset:7168
    v_min_u32 v140, -2, v140
    v_mfma_f32_16x16x32_bf16 v[16:19], a[12:15], v[52:55], v[16:19]
    s_waitcnt lgkmcnt(2)
    buffer_store_dword v140, v8, s[16:19], s49 offen sc1
    v_mfma_f32_16x16x32_bf16 v[12:15], a[16:19], v[60:63], v[12:15]
    ds_read_b128 v[44:47], v1 offset:8192
    v_mfma_f32_16x16x32_bf16 v[20:23], a[16:19], v[64:67], v[20:23]
    v_mfma_f32_16x16x32_bf16 v[24:27], a[20:23], v[64:67], v[24:27]
    s_add_u32 m0, s43, 49152
    ds_read_b128 v[48:51], v1 offset:9216
    s_add_u32 s42, s41, 49152
    v_mfma_f32_16x16x32_bf16 v[16:19], a[20:23], v[60:63], v[16:19]
    s_waitcnt lgkmcnt(2)
    buffer_load_dwordx4 v1, s[16:19], s42 offen offset:0 sc1 lds
    v_mfma_f32_16x16x32_bf16 v[12:15], a[24:27], v[68:71], v[12:15]
    ds_read_b128 v[52:55], v1 offset:10240
    v_mfma_f32_16x16x32_bf16 v[20:23], a[24:27], v[72:75], v[20:23]
    v_mfma_f32_16x16x32_bf16 v[24:27], a[28:31], v[72:75], v[24:27]
    ds_read_b128 v[56:59], v1 offset:11264
    buffer_load_dwordx4 v1, s[16:19], s42 offen offset:1024 sc1 lds
    v_mfma_f32_16x16x32_bf16 v[16:19], a[28:31], v[68:71], v[16:19]
    s_waitcnt lgkmcnt(2)
    v_mfma_f32_16x16x32_bf16 v[12:15], a[32:35], v[44:47], v[12:15]
    ds_read_b128 v[60:63], v1 offset:12288
    v_mfma_f32_16x16x32_bf16 v[20:23], a[32:35], v[48:51], v[20:23]
    buffer_load_dwordx4 v1, s[16:19], s42 offen offset:2048 sc1 lds
    v_mfma_f32_16x16x32_bf16 v[24:27], a[36:39], v[48:51], v[24:27]
    ds_read_b128 v[64:67], v1 offset:13312
    v_mfma_f32_16x16x32_bf16 v[16:19], a[36:39], v[44:47], v[16:19]
    s_waitcnt lgkmcnt(2)
    v_mfma_f32_16x16x32_bf16 v[12:15], a[40:43], v[52:55], v[12:15]
    ds_read_b128 v[68:71], v1 offset:14336
    buffer_load_dwordx4 v1, s[16:19], s42 offen offset:3072 sc1 lds
    v_mfma_f32_16x16x32_bf16 v[20:23], a[40:43], v[56:59], v[20:23]
    s_add_u32 s98, s98, 65536
    s_min_i32 s98, s98, s96
    s_and_b32 s41, s98, 0xffffffff
    v_mfma_f32_16x16x32_bf16 v[24:27], a[44:47], v[56:59], v[24:27]
    s_add_u32 m0, s43, 98304
    ds_read_b128 v[72:75], v1 offset:15360
    s_add_u32 s42, s41, 0
    v_mfma_f32_16x16x32_bf16 v[16:19], a[44:47], v[52:55], v[16:19]
    s_waitcnt vmcnt(11) lgkmcnt(2)
    s_barrier
    v_mfma_f32_16x16x32_bf16 v[12:15], a[48:51], v[60:63], v[12:15]
    ds_read_b128 v[44:47], v1 offset:16384
    v_mfma_f32_16x16x32_bf16 v[20:23], a[48:51], v[64:67], v[20:23]
    v_mfma_f32_16x16x32_bf16 v[24:27], a[52:55], v[64:67], v[24:27]
    s_add_u32 s47, s36, 1
    ds_read_b128 v[48:51], v1 offset:17408
    s_min_i32 s47, s47, 31
    v_mfma_f32_16x16x32_bf16 v[16:19], a[52:55], v[60:63], v[16:19]
    s_waitcnt lgkmcnt(2)
    s_max_i32 s47, s47, 0
    s_cmp_ge_u32 s47, 16
    v_mfma_f32_16x16x32_bf16 v[12:15], a[56:59], v[68:71], v[12:15]
    s_cselect_b32 s8, s88, s64
    ds_read_b128 v[52:55], v1 offset:18432
    s_cselect_b32 s9, s89, s65
    v_mfma_f32_16x16x32_bf16 v[20:23], a[56:59], v[72:75], v[20:23]
    s_and_b32 s47, s47, 15
    s_lshl_b32 s47, s47, 16
    s_sub_u32 s47, s50, s47
    v_mfma_f32_16x16x32_bf16 v[24:27], a[60:63], v[72:75], v[24:27]
    s_add_u32 s48, s47, 32768
    ds_read_b128 v[56:59], v1 offset:19456
    buffer_load_dwordx4 v[128:131], v3, s[8:11], s48 offen sc1
    v_mfma_f32_16x16x32_bf16 v[16:19], a[60:63], v[68:71], v[16:19]
    s_waitcnt lgkmcnt(2)
    buffer_load_dwordx4 v[132:135], v3, s[8:11], s47 offen sc1
    v_mfma_f32_16x16x32_bf16 v[12:15], a[64:67], v[44:47], v[12:15]
    s_add_u32 s90, s90, 65536
    ds_read_b128 v[60:63], v1 offset:20480
    s_add_u32 s46, s46, 2048
    v_mfma_f32_16x16x32_bf16 v[20:23], a[64:67], v[48:51], v[20:23]
    s_and_b32 s44, s90, 0xffffffff
    v_mfma_f32_16x16x32_bf16 v[24:27], a[68:71], v[48:51], v[24:27]
    ds_read_b128 v[64:67], v1 offset:21504
    buffer_load_dword v136, v4, s[16:19], s45 offen sc1
    v_mfma_f32_16x16x32_bf16 v[16:19], a[68:71], v[44:47], v[16:19]
    s_waitcnt lgkmcnt(2)
    v_mfma_f32_16x16x32_bf16 v[12:15], a[72:75], v[52:55], v[12:15]
    ds_read_b128 v[68:71], v1 offset:22528
    v_mfma_f32_16x16x32_bf16 v[20:23], a[72:75], v[56:59], v[20:23]
    v_mfma_f32_16x16x32_bf16 v[24:27], a[76:79], v[56:59], v[24:27]
    ds_read_b128 v[72:75], v1 offset:23552
    v_mfma_f32_16x16x32_bf16 v[16:19], a[76:79], v[52:55], v[16:19]
    s_waitcnt lgkmcnt(2)
    v_mfma_f32_16x16x32_bf16 v[12:15], a[80:83], v[60:63], v[12:15]
    s_waitcnt vmcnt(12)
    ds_read_b128 v[44:47], v1 offset:24576
    s_barrier
    v_mfma_f32_16x16x32_bf16 v[20:23], a[80:83], v[64:67], v[20:23]
    buffer_store_dword v124, v124, s[16:19], s91 offen sc1
    v_mfma_f32_16x16x32_bf16 v[24:27], a[84:87], v[64:67], v[24:27]
    s_add_u32 s91, s91, 65536
    ds_read_b128 v[48:51], v1 offset:25600
    v_mfma_f32_16x16x32_bf16 v[16:19], a[84:87], v[60:63], v[16:19]
    s_waitcnt lgkmcnt(2)
    v_mfma_f32_16x16x32_bf16 v[12:15], a[88:91], v[68:71], v[12:15]
    ds_read_b128 v[52:55], v1 offset:26624
    v_mfma_f32_16x16x32_bf16 v[20:23], a[88:91], v[72:75], v[20:23]
    v_mfma_f32_16x16x32_bf16 v[24:27], a[92:95], v[72:75], v[24:27]
    ds_read_b128 v[56:59], v1 offset:27648
    v_mfma_f32_16x16x32_bf16 v[16:19], a[92:95], v[68:71], v[16:19]
    s_waitcnt lgkmcnt(2)
    v_mfma_f32_16x16x32_bf16 v[12:15], a[96:99], v[44:47], v[12:15]
    ds_read_b128 v[60:63], v1 offset:28672
    v_mfma_f32_16x16x32_bf16 v[20:23], a[96:99], v[48:51], v[20:23]
    v_mfma_f32_16x16x32_bf16 v[24:27], a[100:103], v[48:51], v[24:27]
    ds_read_b128 v[64:67], v1 offset:29696
    v_mfma_f32_16x16x32_bf16 v[16:19], a[100:103], v[44:47], v[16:19]
    s_waitcnt lgkmcnt(2)
    v_mfma_f32_16x16x32_bf16 v[12:15], a[104:107], v[52:55], v[12:15]
    ds_read_b128 v[68:71], v1 offset:30720
    v_mfma_f32_16x16x32_bf16 v[20:23], a[104:107], v[56:59], v[20:23]
    v_mfma_f32_16x16x32_bf16 v[24:27], a[108:111], v[56:59], v[24:27]
    ds_read_b128 v[72:75], v1 offset:31744
    v_mfma_f32_16x16x32_bf16 v[16:19], a[108:111], v[52:55], v[16:19]
    s_waitcnt vmcnt(9) lgkmcnt(2)
    s_barrier
    v_mfma_f32_16x16x32_bf16 v[12:15], a[112:115], v[60:63], v[12:15]
    ds_read_b128 v[44:47], v1 offset:32768
    v_mfma_f32_16x16x32_bf16 v[20:23], a[112:115], v[64:67], v[20:23]
    v_mfma_f32_16x16x32_bf16 v[24:27], a[116:119], v[64:67], v[24:27]
    ds_read_b128 v[48:51], v1 offset:33792
    v_mfma_f32_16x16x32_bf16 v[16:19], a[116:119], v[60:63], v[16:19]
    s_waitcnt lgkmcnt(2)
    v_mfma_f32_16x16x32_bf16 v[12:15], a[120:123], v[68:71], v[12:15]
    ds_read_b128 v[52:55], v1 offset:34816
    v_mfma_f32_16x16x32_bf16 v[20:23], a[120:123], v[72:75], v[20:23]
    v_mfma_f32_16x16x32_bf16 v[24:27], a[124:127], v[72:75], v[24:27]
    ds_read_b128 v[56:59], v1 offset:35840
    v_mfma_f32_16x16x32_bf16 v[16:19], a[124:127], v[68:71], v[16:19]
    s_waitcnt lgkmcnt(2)
    v_mfma_f32_16x16x32_bf16 v[12:15], a[128:131], v[44:47], v[12:15]
    ds_read_b128 v[60:63], v1 offset:36864
    v_mfma_f32_16x16x32_bf16 v[20:23], a[128:131], v[48:51], v[20:23]
    v_mfma_f32_16x16x32_bf16 v[24:27], a[132:135], v[48:51], v[24:27]
    ds_read_b128 v[64:67], v1 offset:37888
    v_mfma_f32_16x16x32_bf16 v[16:19], a[132:135], v[44:47], v[16:19]
    s_waitcnt lgkmcnt(2)
    v_mfma_f32_16x16x32_bf16 v[12:15], a[136:139], v[52:55], v[12:15]
    ds_read_b128 v[68:71], v1 offset:38912
    v_mfma_f32_16x16x32_bf16 v[20:23], a[136:139], v[56:59], v[20:23]
    v_mfma_f32_16x16x32_bf16 v[24:27], a[140:143], v[56:59], v[24:27]
    ds_read_b128 v[72:75], v1 offset:39936
    v_mfma_f32_16x16x32_bf16 v[16:19], a[140:143], v[52:55], v[16:19]
    s_waitcnt lgkmcnt(2)
    v_mfma_f32_16x16x32_bf16 v[12:15], a[144:147], v[60:63], v[12:15]
    ds_read_b128 v[44:47], v1 offset:40960
    v_mfma_f32_16x16x32_bf16 v[20:23], a[144:147], v[64:67], v[20:23]
    v_mfma_f32_16x16x32_bf16 v[24:27], a[148:151], v[64:67], v[24:27]
    ds_read_b128 v[48:51], v1 offset:41984
    v_mfma_f32_16x16x32_bf16 v[16:19], a[148:151], v[60:63], v[16:19]
    s_waitcnt lgkmcnt(2)
    v_mfma_f32_16x16x32_bf16 v[12:15], a[152:155], v[68:71], v[12:15]
    ds_read_b128 v[52:55], v1 offset:43008
    v_mfma_f32_16x16x32_bf16 v[20:23], a[152:155], v[72:75], v[20:23]
    v_mfma_f32_16x16x32_bf16 v[24:27], a[156:159], v[72:75], v[24:27]
    ds_read_b128 v[56:59], v1 offset:44032
    v_mfma_f32_16x16x32_bf16 v[16:19], a[156:159], v[68:71], v[16:19]
    s_waitcnt lgkmcnt(2)
    v_mfma_f32_16x16x32_bf16 v[12:15], a[160:163], v[44:47], v[12:15]
    ds_read_b128 v[60:63], v1 offset:45056
    v_mfma_f32_16x16x32_bf16 v[20:23], a[160:163], v[48:51], v[20:23]
    v_mfma_f32_16x16x32_bf16 v[24:27], a[164:167], v[48:51], v[24:27]
    ds_read_b128 v[64:67], v1 offset:46080
    v_mfma_f32_16x16x32_bf16 v[16:19], a[164:167], v[44:47], v[16:19]
    s_waitcnt lgkmcnt(2)
    v_mfma_f32_16x16x32_bf16 v[12:15], a[168:171], v[52:55], v[12:15]
    ds_read_b128 v[68:71], v1 offset:47104
    v_mfma_f32_16x16x32_bf16 v[20:23], a[168:171], v[56:59], v[20:23]
    v_mfma_f32_16x16x32_bf16 v[24:27], a[172:175], v[56:59], v[24:27]
    ds_read_b128 v[72:75], v1 offset:48128
    v_mfma_f32_16x16x32_bf16 v[16:19], a[172:175], v[52:55], v[16:19]
    s_waitcnt vmcnt(4) lgkmcnt(2)
    s_barrier
    v_mfma_f32_16x16x32_bf16 v[12:15], a[176:179], v[60:63], v[12:15]
    ds_read_b128 v[44:47], v1 offset:49152
    v_mfma_f32_16x16x32_bf16 v[20:23], a[176:179], v[64:67], v[20:23]
    v_mfma_f32_16x16x32_bf16 v[24:27], a[180:183], v[64:67], v[24:27]
    ds_read_b128 v[48:51], v1 offset:50176
    v_mfma_f32_16x16x32_bf16 v[16:19], a[180:183], v[60:63], v[16:19]
    s_waitcnt lgkmcnt(2)
    v_mfma_f32_16x16x32_bf16 v[12:15], a[184:187], v[68:71], v[12:15]
    s_waitcnt vmcnt(1)
    ds_read_b128 v[52:55], v1 offset:51200
    v_cmp_ne_u32 vcc, 0, v136
    v_mfma_f32_16x16x32_bf16 v[20:23], a[184:187], v[72:75], v[20:23]
    v_mfma_f32_16x16x32_bf16 v[24:27], a[188:191], v[72:75], v[24:27]
    s_cbranch_vccnz L_spin36
L_back37:
    ds_read_b128 v[56:59], v1 offset:52224
    s_barrier
    v_mfma_f32_16x16x32_bf16 v[16:19], a[188:191], v[68:71], v[16:19]
    s_waitcnt lgkmcnt(2)
    s_add_u32 s45, s45, 65536
    buffer_load_dwordx4 v1, s[16:19], s42 offen offset:0 sc1 lds
    v_mfma_f32_16x16x32_bf16 v[12:15], a[192:195], v[44:47], v[12:15]
    s_waitcnt vmcnt(3)
    ds_read_b128 v[60:63], v1 offset:53248
    v_mfma_f32_16x16x32_bf16 v[28:31], v[108:111], v[128:131], 0
    v_mfma_f32_16x16x32_bf16 v[32:35], v[112:115], v[128:131], 0
    v_mfma_f32_16x16x32_bf16 v[36:39], v[108:111], v[132:135], 0
    v_mfma_f32_16x16x32_bf16 v[40:43], v[112:115], v[132:135], 0
    v_mfma_f32_16x16x32_bf16 v[20:23], a[192:195], v[48:51], v[20:23]
    v_mfma_f32_16x16x32_bf16 v[24:27], a[196:199], v[48:51], v[24:27]
    ds_read_b128 v[64:67], v1 offset:54272
    v_mfma_f32_16x16x32_bf16 v[16:19], a[196:199], v[44:47], v[16:19]
    s_waitcnt lgkmcnt(2)
    buffer_load_dwordx4 v1, s[16:19], s42 offen offset:1024 sc1 lds
    v_mfma_f32_16x16x32_bf16 v[12:15], a[200:203], v[52:55], v[12:15]
    ds_read_b128 v[68:71], v1 offset:55296
    v_mfma_f32_16x16x32_bf16 v[20:23], a[200:203], v[56:59], v[20:23]
    v_mfma_f32_16x16x32_bf16 v[24:27], a[204:207], v[56:59], v[24:27]
    ds_read_b128 v[72:75], v1 offset:56320
    v_mfma_f32_16x16x32_bf16 v[16:19], a[204:207], v[52:55], v[16:19]
    s_waitcnt lgkmcnt(2)
    buffer_load_dwordx4 v1, s[16:19], s42 offen offset:2048 sc1 lds
    v_mfma_f32_16x16x32_bf16 v[12:15], a[208:211], v[60:63], v[12:15]
    ds_read_b128 v[44:47], v1 offset:57344
    v_mfma_f32_16x16x32_bf16 v[20:23], a[208:211], v[64:67], v[20:23]
    v_mfma_f32_16x16x32_bf16 v[24:27], a[212:215], v[64:67], v[24:27]
    ds_read_b128 v[48:51], v1 offset:58368
    v_mfma_f32_16x16x32_bf16 v[16:19], a[212:215], v[60:63], v[16:19]
    s_waitcnt lgkmcnt(2)
    buffer_load_dwordx4 v1, s[16:19], s42 offen offset:3072 sc1 lds
    v_mfma_f32_16x16x32_bf16 v[12:15], a[216:219], v[68:71], v[12:15]
    s_add_u32 m0, s43, 114688
    ds_read_b128 v[52:55], v1 offset:59392
    s_add_u32 s42, s41, 16384
    v_mfma_f32_16x16x32_bf16 v[20:23], a[216:219], v[72:75], v[20:23]
    v_mfma_f32_16x16x32_bf16 v[24:27], a[220:223], v[72:75], v[24:27]
    ds_read_b128 v[56:59], v1 offset:60416
    v_mfma_f32_16x16x32_bf16 v[16:19], a[220:223], v[68:71], v[16:19]
    s_waitcnt lgkmcnt(2)
    buffer_load_dwordx4 v1, s[16:19], s42 offen offset:0 sc1 lds
    v_mfma_f32_16x16x32_bf16 v[12:15], a[224:227], v[44:47], v[12:15]
    ds_read_b128 v[60:63], v1 offset:61440
    v_mfma_f32_16x16x32_bf16 v[20:23], a[224:227], v[48:51], v[20:23]
    v_mfma_f32_16x16x32_bf16 v[24:27], a[228:231], v[48:51], v[24:27]
    ds_read_b128 v[64:67], v1 offset:62464
    v_mfma_f32_16x16x32_bf16 v[16:19], a[228:231], v[44:47], v[16:19]
    s_waitcnt lgkmcnt(2)
    buffer_load_dwordx4 v1, s[16:19], s42 offen offset:1024 sc1 lds
    v_mfma_f32_16x16x32_bf16 v[12:15], a[232:235], v[52:55], v[12:15]
    ds_read_b128 v[68:71], v1 offset:63488
    v_mfma_f32_16x16x32_bf16 v[20:23], a[232:235], v[56:59], v[20:23]
    v_mfma_f32_16x16x32_bf16 v[24:27], a[236:239], v[56:59], v[24:27]
    ds_read_b128 v[72:75], v1 offset:64512
    v_mfma_f32_16x16x32_bf16 v[16:19], a[236:239], v[52:55], v[16:19]
    s_waitcnt lgkmcnt(2)
    buffer_load_dwordx4 v1, s[16:19], s42 offen offset:2048 sc1 lds
    v_mfma_f32_16x16x32_bf16 v[12:15], a[240:243], v[60:63], v[12:15]
    v_mfma_f32_16x16x32_bf16 v[20:23], a[240:243], v[64:67], v[20:23]
    v_mfma_f32_16x16x32_bf16 v[24:27], a[244:247], v[64:67], v[24:27]
    v_mfma_f32_16x16x32_bf16 v[16:19], a[244:247], v[60:63], v[16:19]
    s_waitcnt lgkmcnt(0)
    buffer_load_dwordx4 v1, s[16:19], s42 offen offset:3072 sc1 lds
    v_mfma_f32_16x16x32_bf16 v[12:15], a[248:251], v[68:71], v[12:15]
    v_mfma_f32_16x16x32_bf16 v[20:23], a[248:251], v[72:75], v[20:23]
    v_mfma_f32_16x16x32_bf16 v[24:27], a[252:255], v[72:75], v[24:27]
    v_mfma_f32_16x16x32_bf16 v[16:19], a[252:255], v[68:71], v[16:19]
    s_nop 1
    v_cvt_pk_bf16_f32 v148, v12, v13
    v_cvt_pk_bf16_f32 v149, v14, v15
    s_nop 3
    v_cvt_pk_bf16_f32 v150, v16, v17
    v_cvt_pk_bf16_f32 v151, v18, v19
    buffer_store_dwordx4 v[148:151], v1, s[16:19], s44 offen offset:0 sc1
    v_cvt_pk_bf16_f32 v152, v20, v21
    v_cvt_pk_bf16_f32 v153, v22, v23
    v_cvt_pk_bf16_f32 v154, v24, v25
    v_cvt_pk_bf16_f32 v155, v26, v27
    buffer_store_dwordx4 v[152:155], v1, s[16:19], s44 offen offset:1024 sc1
    s_add_u32 m0, s43, 131072
    s_add_u32 s42, s41, 32768
    v_add_f32 v140, v12, v13
    v_add_f32 v144, v20, v21
    v_mul_f32 v141, v12, v12
    v_mul_f32 v145, v20, v20
    buffer_load_dwordx4 v1, s[16:19], s42 offen offset:0 sc1 lds
    v_fmac_f32 v141, v13, v13
    v_fmac_f32 v145, v21, v21
    v_add_f32 v140, v140, v14
    v_add_f32 v144, v144, v22
    v_fmac_f32 v141, v14, v14
    v_fmac_f32 v145, v22, v22
    v_add_f32 v140, v140, v15
    v_add_f32 v144, v144, v23
    buffer_load_dwordx4 v1, s[16:19], s42 offen offset:1024 sc1 lds
    v_fmac_f32 v141, v15, v15
    v_fmac_f32 v145, v23, v23
    v_add_f32 v140, v140, v16
    v_add_f32 v144, v144, v24
    v_fmac_f32 v141, v16, v16
    v_fmac_f32 v145, v24, v24
    v_add_f32 v140, v140, v17
    v_add_f32 v144, v144, v25
    buffer_load_dwordx4 v1, s[16:19], s42 offen offset:2048 sc1 lds
    v_fmac_f32 v141, v17, v17
    v_fmac_f32 v145, v25, v25
    v_add_f32 v140, v140, v18
    v_add_f32 v144, v144, v26
    v_fmac_f32 v141, v18, v18
    v_fmac_f32 v145, v26, v26
    v_add_f32 v140, v140, v19
    v_add_f32 v144, v144, v27
    buffer_load_dwordx4 v1, s[16:19], s42 offen offset:3072 sc1 lds
    v_fmac_f32 v141, v19, v19
    v_fmac_f32 v145, v27, v27
    s_nop 0
    v_permlane16_swap_b32 v140, v141
    v_permlane16_swap_b32 v144, v145
    v_add_f32 v140, v140, v141
    v_add_f32 v144, v144, v145
    v_mov_b32 v142, v140
    v_mov_b32 v146, v144
    s_nop 0
    v_permlane32_swap_b32 v140, v142
    v_permlane32_swap_b32 v144, v146
    v_add_f32 v140, v140, v142
    v_add_f32 v144, v144, v146
    ds_write_b32 v6, v140 offset:0
    ds_write_b32 v6, v144 offset:512
    s_waitcnt vmcnt(10) lgkmcnt(0)
    s_barrier
    ds_read_b128 v[44:47], v2 offset:0
    ds_read_b128 v[48:51], v2 offset:1024
    ds_read_b128 v[52:55], v2 offset:2048
    ds_read_b128 v[56:59], v2 offset:3072
    s_add_u32 s36, s36, 1
L_o_b1:
    s_waitcnt lgkmcnt(2)
    v_mfma_f32_16x16x32_bf16 v[28:31], a[0:3], v[44:47], v[28:31]
    ds_read_b128 v[60:63], v2 offset:4096
    ds_read_b128 v[140:143], v7
    v_mfma_f32_16x16x32_bf16 v[36:39], a[0:3], v[48:51], v[36:39]
    s_cmp_eq_u32 s36, 0
    s_cselect_b32 s49, 0x5e00000, s46
    v_mfma_f32_16x16x32_bf16 v[40:43], a[4:7], v[48:51], v[40:43]
    ds_read_b128 v[64:67], v2 offset:5120
    v_mfma_f32_16x16x32_bf16 v[32:35], a[4:7], v[44:47], v[32:35]
    s_waitcnt lgkmcnt(3)
    v_mfma_f32_16x16x32_bf16 v[28:31], a[8:11], v[52:55], v[28:31]
    s_waitcnt lgkmcnt(1)
    ds_read_b128 v[68:71], v2 offset:6144
    v_add_f32 v140, v140, v141
    v_mfma_f32_16x16x32_bf16 v[36:39], a[8:11], v[56:59], v[36:39]
    v_add_f32 v142, v142, v143
    v_add_f32 v140, v140, v142
    v_mfma_f32_16x16x32_bf16 v[40:43], a[12:15], v[56:59], v[40:43]
    ds_read_b128 v[72:75], v2 offset:7168
    v_min_u32 v140, -2, v140
    v_mfma_f32_16x16x32_bf16 v[32:35], a[12:15], v[52:55], v[32:35]
    s_waitcnt lgkmcnt(2)
    buffer_store_dword v140, v8, s[16:19], s49 offen sc1
    v_mfma_f32_16x16x32_bf16 v[28:31], a[16:19], v[60:63], v[28:31]
    ds_read_b128 v[44:47], v2 offset:8192
    v_mfma_f32_16x16x32_bf16 v[36:39], a[16:19], v[64:67], v[36:39]
    v_mfma_f32_16x16x32_bf16 v[40:43], a[20:23], v[64:67], v[40:43]
    s_add_u32 m0, s43, 147456
    ds_read_b128 v[48:51], v2 offset:9216
    s_add_u32 s42, s41, 49152
    v_mfma_f32_16x16x32_bf16 v[32:35], a[20:23], v[60:63], v[32:35]
    s_waitcnt lgkmcnt(2)
    buffer_load_dwordx4 v1, s[16:19], s42 offen offset:0 sc1 lds
    v_mfma_f32_16x16x32_bf16 v[28:31], a[24:27], v[68:71], v[28:31]
    ds_read_b128 v[52:55], v2 offset:10240
    v_mfma_f32_16x16x32_bf16 v[36:39], a[24:27], v[72:75], v[36:39]
    v_mfma_f32_16x16x32_bf16 v[40:43], a[28:31], v[72:75], v[40:43]
    ds_read_b128 v[56:59], v2 offset:11264
    buffer_load_dwordx4 v1, s[16:19], s42 offen offset:1024 sc1 lds
    v_mfma_f32_16x16x32_bf16 v[32:35], a[28:31], v[68:71], v[32:35]
    s_waitcnt lgkmcnt(2)
    v_mfma_f32_16x16x32_bf16 v[28:31], a[32:35], v[44:47], v[28:31]
    ds_read_b128 v[60:63], v2 offset:12288
    v_mfma_f32_16x16x32_bf16 v[36:39], a[32:35], v[48:51], v[36:39]
    buffer_load_dwordx4 v1, s[16:19], s42 offen offset:2048 sc1 lds
    v_mfma_f32_16x16x32_bf16 v[40:43], a[36:39], v[48:51], v[40:43]
    ds_read_b128 v[64:67], v2 offset:13312
    v_mfma_f32_16x16x32_bf16 v[32:35], a[36:39], v[44:47], v[32:35]
    s_waitcnt lgkmcnt(2)
    v_mfma_f32_16x16x32_bf16 v[28:31], a[40:43], v[52:55], v[28:31]
    ds_read_b128 v[68:71], v2 offset:14336
    buffer_load_dwordx4 v1, s[16:19], s42 offen offset:3072 sc1 lds
    v_mfma_f32_16x16x32_bf16 v[36:39], a[40:43], v[56:59], v[36:39]
    s_add_u32 s98, s98, 65536
    s_min_i32 s98, s98, s96
    s_and_b32 s41, s98, 0xffffffff
    v_mfma_f32_16x16x32_bf16 v[40:43], a[44:47], v[56:59], v[40:43]
    s_add_u32 m0, s43, 0
    ds_read_b128 v[72:75], v2 offset:15360
    s_add_u32 s42, s41, 0
    v_mfma_f32_16x16x32_bf16 v[32:35], a[44:47], v[52:55], v[32:35]
    s_waitcnt vmcnt(11) lgkmcnt(2)
    s_barrier
    v_mfma_f32_16x16x32_bf16 v[28:31], a[48:51], v[60:63], v[28:31]
    ds_read_b128 v[44:47], v2 offset:16384
    v_mfma_f32_16x16x32_bf16 v[36:39], a[48:51], v[64:67], v[36:39]
    v_mfma_f32_16x16x32_bf16 v[40:43], a[52:55], v[64:67], v[40:43]
    s_add_u32 s47, s36, 1
    ds_read_b128 v[48:51], v2 offset:17408
    s_min_i32 s47, s47, 31
    v_mfma_f32_16x16x32_bf16 v[32:35], a[52:55], v[60:63], v[32:35]
    s_waitcnt lgkmcnt(2)
    s_max_i32 s47, s47, 0
    s_cmp_ge_u32 s47, 16
    v_mfma_f32_16x16x32_bf16 v[28:31], a[56:59], v[68:71], v[28:31]
    s_cselect_b32 s8, s88, s64
    ds_read_b128 v[52:55], v2 offset:18432
    s_cselect_b32 s9, s89, s65
    v_mfma_f32_16x16x32_bf16 v[36:39], a[56:59], v[72:75], v[36:39]
    s_and_b32 s47, s47, 15
    s_lshl_b32 s47, s47, 16
    s_sub_u32 s47, s50, s47
    v_mfma_f32_16x16x32_bf16 v[40:43], a[60:63], v[72:75], v[40:43]
    s_add_u32 s48, s47, 32768
    ds_read_b128 v[56:59], v2 offset:19456
    buffer_load_dwordx4 v[128:131], v3, s[8:11], s48 offen sc1
    v_mfma_f32_16x16x32_bf16 v[32:35], a[60:63], v[68:71], v[32:35]
    s_waitcnt lgkmcnt(2)
    buffer_load_dwordx4 v[132:135], v3, s[8:11], s47 offen sc1
    v_mfma_f32_16x16x32_bf16 v[28:31], a[64:67], v[44:47], v[28:31]
    s_add_u32 s90, s90, 65536
    ds_read_b128 v[60:63], v2 offset:20480
    s_add_u32 s46, s46, 2048
    v_mfma_f32_16x16x32_bf16 v[36:39], a[64:67], v[48:51], v[36:39]
    s_and_b32 s44, s90, 0xffffffff
    v_mfma_f32_16x16x32_bf16 v[40:43], a[68:71], v[48:51], v[40:43]
    ds_read_b128 v[64:67], v2 offset:21504
    buffer_load_dword v136, v4, s[16:19], s45 offen sc1
    v_mfma_f32_16x16x32_bf16 v[32:35], a[68:71], v[44:47], v[32:35]
    s_waitcnt lgkmcnt(2)
    v_mfma_f32_16x16x32_bf16 v[28:31], a[72:75], v[52:55], v[28:31]
    ds_read_b128 v[68:71], v2 offset:22528
    v_mfma_f32_16x16x32_bf16 v[36:39], a[72:75], v[56:59], v[36:39]
    v_mfma_f32_16x16x32_bf16 v[40:43], a[76:79], v[56:59], v[40:43]
    ds_read_b128 v[72:75], v2 offset:23552
    v_mfma_f32_16x16x32_bf16 v[32:35], a[76:79], v[52:55], v[32:35]
    s_waitcnt lgkmcnt(2)
    v_mfma_f32_16x16x32_bf16 v[28:31], a[80:83], v[60:63], v[28:31]
    s_waitcnt vmcnt(12)
    ds_read_b128 v[44:47], v2 offset:24576
    s_barrier
    v_mfma_f32_16x16x32_bf16 v[36:39], a[80:83], v[64:67], v[36:39]
    buffer_store_dword v124, v124, s[16:19], s91 offen sc1
    v_mfma_f32_16x16x32_bf16 v[40:43], a[84:87], v[64:67], v[40:43]
    s_add_u32 s91, s91, 65536
    ds_read_b128 v[48:51], v2 offset:25600
    v_mfma_f32_16x16x32_bf16 v[32:35], a[84:87], v[60:63], v[32:35]
    s_waitcnt lgkmcnt(2)
    v_mfma_f32_16x16x32_bf16 v[28:31], a[88:91], v[68:71], v[28:31]
    ds_read_b128 v[52:55], v2 offset:26624
    v_mfma_f32_16x16x32_bf16 v[36:39], a[88:91], v[72:75], v[36:39]
    v_mfma_f32_16x16x32_bf16 v[40:43], a[92:95], v[72:75], v[40:43]
    ds_read_b128 v[56:59], v2 offset:27648
    v_mfma_f32_16x16x32_bf16 v[32:35], a[92:95], v[68:71], v[32:35]
    s_waitcnt lgkmcnt(2)
    v_mfma_f32_16x16x32_bf16 v[28:31], a[96:99], v[44:47], v[28:31]
    ds_read_b128 v[60:63], v2 offset:28672
    v_mfma_f32_16x16x32_bf16 v[36:39], a[96:99], v[48:51], v[36:39]
    v_mfma_f32_16x16x32_bf16 v[40:43], a[100:103], v[48:51], v[40:43]
    ds_read_b128 v[64:67], v2 offset:29696
    v_mfma_f32_16x16x32_bf16 v[32:35], a[100:103], v[44:47], v[32:35]
    s_waitcnt lgkmcnt(2)
    v_mfma_f32_16x16x32_bf16 v[28:31], a[104:107], v[52:55], v[28:31]
    ds_read_b128 v[68:71], v2 offset:30720
    v_mfma_f32_16x16x32_bf16 v[36:39], a[104:107], v[56:59], v[36:39]
    v_mfma_f32_16x16x32_bf16 v[40:43], a[108:111], v[56:59], v[40:43]
    ds_read_b128 v[72:75], v2 offset:31744
    v_mfma_f32_16x16x32_bf16 v[32:35], a[108:111], v[52:55], v[32:35]
    s_waitcnt vmcnt(9) lgkmcnt(2)
    s_barrier
    v_mfma_f32_16x16x32_bf16 v[28:31], a[112:115], v[60:63], v[28:31]
    ds_read_b128 v[44:47], v2 offset:32768
    v_mfma_f32_16x16x32_bf16 v[36:39], a[112:115], v[64:67], v[36:39]
    v_mfma_f32_16x16x32_bf16 v[40:43], a[116:119], v[64:67], v[40:43]
    ds_read_b128 v[48:51], v2 offset:33792
    v_mfma_f32_16x16x32_bf16 v[32:35], a[116:119], v[60:63], v[32:35]
    s_waitcnt lgkmcnt(2)
    v_mfma_f32_16x16x32_bf16 v[28:31], a[120:123], v[68:71], v[28:31]
    ds_read_b128 v[52:55], v2 offset:34816
    v_mfma_f32_16x16x32_bf16 v[36:39], a[120:123], v[72:75], v[36:39]
    v_mfma_f32_16x16x32_bf16 v[40:43], a[124:127], v[72:75], v[40:43]
    ds_read_b128 v[56:59], v2 offset:35840
    v_mfma_f32_16x16x32_bf16 v[32:35], a[124:127], v[68:71], v[32:35]
    s_waitcnt lgkmcnt(2)
    v_mfma_f32_16x16x32_bf16 v[28:31], a[128:131], v[44:47], v[28:31]
    ds_read_b128 v[60:63], v2 offset:36864
    v_mfma_f32_16x16x32_bf16 v[36:39], a[128:131], v[48:51], v[36:39]
    v_mfma_f32_16x16x32_bf16 v[40:43], a[132:135], v[48:51], v[40:43]
    ds_read_b128 v[64:67], v2 offset:37888
    v_mfma_f32_16x16x32_bf16 v[32:35], a[132:135], v[44:47], v[32:35]
    s_waitcnt lgkmcnt(2)
    v_mfma_f32_16x16x32_bf16 v[28:31], a[136:139], v[52:55], v[28:31]
    ds_read_b128 v[68:71], v2 offset:38912
    v_mfma_f32_16x16x32_bf16 v[36:39], a[136:139], v[56:59], v[36:39]
    v_mfma_f32_16x16x32_bf16 v[40:43], a[140:143], v[56:59], v[40:43]
    ds_read_b128 v[72:75], v2 offset:39936
    v_mfma_f32_16x16x32_bf16 v[32:35], a[140:143], v[52:55], v[32:35]
    s_waitcnt lgkmcnt(2)
    v_mfma_f32_16x16x32_bf16 v[28:31], a[144:147], v[60:63], v[28:31]
    ds_read_b128 v[44:47], v2 offset:40960
    v_mfma_f32_16x16x32_bf16 v[36:39], a[144:147], v[64:67], v[36:39]
    v_mfma_f32_16x16x32_bf16 v[40:43], a[148:151], v[64:67], v[40:43]
    ds_read_b128 v[48:51], v2 offset:41984
    v_mfma_f32_16x16x32_bf16 v[32:35], a[148:151], v[60:63], v[32:35]
    s_waitcnt lgkmcnt(2)
    v_mfma_f32_16x16x32_bf16 v[28:31], a[152:155], v[68:71], v[28:31]
    ds_read_b128 v[52:55], v2 offset:43008
    v_mfma_f32_16x16x32_bf16 v[36:39], a[152:155], v[72:75], v[36:39]
    v_mfma_f32_16x16x32_bf16 v[40:43], a[156:159], v[72:75], v[40:43]
    ds_read_b128 v[56:59], v2 offset:44032
    v_mfma_f32_16x16x32_bf16 v[32:35], a[156:159], v[68:71], v[32:35]
    s_waitcnt lgkmcnt(2)
    v_mfma_f32_16x16x32_bf16 v[28:31], a[160:163], v[44:47], v[28:31]
    ds_read_b128 v[60:63], v2 offset:45056
    v_mfma_f32_16x16x32_bf16 v[36:39], a[160:163], v[48:51], v[36:39]
    v_mfma_f32_16x16x32_bf16 v[40:43], a[164:167], v[48:51], v[40:43]
    ds_read_b128 v[64:67], v2 offset:46080
    v_mfma_f32_16x16x32_bf16 v[32:35], a[164:167], v[44:47], v[32:35]
    s_waitcnt lgkmcnt(2)
    v_mfma_f32_16x16x32_bf16 v[28:31], a[168:171], v[52:55], v[28:31]
    ds_read_b128 v[68:71], v2 offset:47104
    v_mfma_f32_16x16x32_bf16 v[36:39], a[168:171], v[56:59], v[36:39]
    v_mfma_f32_16x16x32_bf16 v[40:43], a[172:175], v[56:59], v[40:43]
    ds_read_b128 v[72:75], v2 offset:48128
    v_mfma_f32_16x16x32_bf16 v[32:35], a[172:175], v[52:55], v[32:35]
    s_waitcnt vmcnt(4) lgkmcnt(2)
    s_barrier
    v_mfma_f32_16x16x32_bf16 v[28:31], a[176:179], v[60:63], v[28:31]
    ds_read_b128 v[44:47], v2 offset:49152
    v_mfma_f32_16x16x32_bf16 v[36:39], a[176:179], v[64:67], v[36:39]
    v_mfma_f32_16x16x32_bf16 v[40:43], a[180:183], v[64:67], v[40:43]
    ds_read_b128 v[48:51], v2 offset:50176
    v_mfma_f32_16x16x32_bf16 v[32:35], a[180:183], v[60:63], v[32:35]
    s_waitcnt lgkmcnt(2)
    v_mfma_f32_16x16x32_bf16 v[28:31], a[184:187], v[68:71], v[28:31]
    s_waitcnt vmcnt(1)
    ds_read_b128 v[52:55], v2 offset:51200
    v_cmp_ne_u32 vcc, 0, v136
    v_mfma_f32_16x16x32_bf16 v[36:39], a[184:187], v[72:75], v[36:39]
    v_mfma_f32_16x16x32_bf16 v[40:43], a[188:191], v[72:75], v[40:43]
    s_cbranch_vccnz L_spin38
L_back39:
    ds_read_b128 v[56:59], v2 offset:52224
    s_barrier
    v_mfma_f32_16x16x32_bf16 v[32:35], a[188:191], v[68:71], v[32:35]
    s_waitcnt lgkmcnt(2)
    s_add_u32 s45, s45, 65536
    buffer_load_dwordx4 v1, s[16:19], s42 offen offset:0 sc1 lds
    v_mfma_f32_16x16x32_bf16 v[28:31], a[192:195], v[44:47], v[28:31]
    s_waitcnt vmcnt(3)
    ds_read_b128 v[60:63], v2 offset:53248
    v_mfma_f32_16x16x32_bf16 v[12:15], v[108:111], v[128:131], 0
    v_mfma_f32_16x16x32_bf16 v[16:19], v[112:115], v[128:131], 0
    v_mfma_f32_16x16x32_bf16 v[20:23], v[108:111], v[132:135], 0
    v_mfma_f32_16x16x32_bf16 v[24:27], v[112:115], v[132:135], 0
    v_mfma_f32_16x16x32_bf16 v[36:39], a[192:195], v[48:51], v[36:39]
    v_mfma_f32_16x16x32_bf16 v[40:43], a[196:199], v[48:51], v[40:43]
    ds_read_b128 v[64:67], v2 offset:54272
    v_mfma_f32_16x16x32_bf16 v[32:35], a[196:199], v[44:47], v[32:35]
    s_waitcnt lgkmcnt(2)
    buffer_load_dwordx4 v1, s[16:19], s42 offen offset:1024 sc1 lds
    v_mfma_f32_16x16x32_bf16 v[28:31], a[200:203], v[52:55], v[28:31]
    ds_read_b128 v[68:71], v2 offset:55296
    v_mfma_f32_16x16x32_bf16 v[36:39], a[200:203], v[56:59], v[36:39]
    v_mfma_f32_16x16x32_bf16 v[40:43], a[204:207], v[56:59], v[40:43]
    ds_read_b128 v[72:75], v2 offset:56320
    v_mfma_f32_16x16x32_bf16 v[32:35], a[204:207], v[52:55], v[32:35]
    s_waitcnt lgkmcnt(2)
    buffer_load_dwordx4 v1, s[16:19], s42 offen offset:2048 sc1 lds
    v_mfma_f32_16x16x32_bf16 v[28:31], a[208:211], v[60:63], v[28:31]
    ds_read_b128 v[44:47], v2 offset:57344
    v_mfma_f32_16x16x32_bf16 v[36:39], a[208:211], v[64:67], v[36:39]
    v_mfma_f32_16x16x32_bf16 v[40:43], a[212:215], v[64:67], v[40:43]
    ds_read_b128 v[48:51], v2 offset:58368
    v_mfma_f32_16x16x32_bf16 v[32:35], a[212:215], v[60:63], v[32:35]
    s_waitcnt lgkmcnt(2)
    buffer_load_dwordx4 v1, s[16:19], s42 offen offset:3072 sc1 lds
    v_mfma_f32_16x16x32_bf16 v[28:31], a[216:219], v[68:71], v[28:31]
    s_add_u32 m0, s43, 16384
    ds_read_b128 v[52:55], v2 offset:59392
    s_add_u32 s42, s41, 16384
    v_mfma_f32_16x16x32_bf16 v[36:39], a[216:219], v[72:75], v[36:39]
    v_mfma_f32_16x16x32_bf16 v[40:43], a[220:223], v[72:75], v[40:43]
    ds_read_b128 v[56:59], v2 offset:60416
    v_mfma_f32_16x16x32_bf16 v[32:35], a[220:223], v[68:71], v[32:35]
    s_waitcnt lgkmcnt(2)
    buffer_load_dwordx4 v1, s[16:19], s42 offen offset:0 sc1 lds
    v_mfma_f32_16x16x32_bf16 v[28:31], a[224:227], v[44:47], v[28:31]
    ds_read_b128 v[60:63], v2 offset:61440
    v_mfma_f32_16x16x32_bf16 v[36:39], a[224:227], v[48:51], v[36:39]
    v_mfma_f32_16x16x32_bf16 v[40:43], a[228:231], v[48:51], v[40:43]
    ds_read_b128 v[64:67], v2 offset:62464
    v_mfma_f32_16x16x32_bf16 v[32:35], a[228:231], v[44:47], v[32:35]
    s_waitcnt lgkmcnt(2)
    buffer_load_dwordx4 v1, s[16:19], s42 offen offset:1024 sc1 lds
    v_mfma_f32_16x16x32_bf16 v[28:31], a[232:235], v[52:55], v[28:31]
    ds_read_b128 v[68:71], v2 offset:63488
    v_mfma_f32_16x16x32_bf16 v[36:39], a[232:235], v[56:59], v[36:39]
    v_mfma_f32_16x16x32_bf16 v[40:43], a[236:239], v[56:59], v[40:43]
    ds_read_b128 v[72:75], v2 offset:64512
    v_mfma_f32_16x16x32_bf16 v[32:35], a[236:239], v[52:55], v[32:35]
    s_waitcnt lgkmcnt(2)
    buffer_load_dwordx4 v1, s[16:19], s42 offen offset:2048 sc1 lds
    v_mfma_f32_16x16x32_bf16 v[28:31], a[240:243], v[60:63], v[28:31]
    v_mfma_f32_16x16x32_bf16 v[36:39], a[240:243], v[64:67], v[36:39]
    v_mfma_f32_16x16x32_bf16 v[40:43], a[244:247], v[64:67], v[40:43]
    v_mfma_f32_16x16x32_bf16 v[32:35], a[244:247], v[60:63], v[32:35]
    s_waitcnt lgkmcnt(0)
    buffer_load_dwordx4 v1, s[16:19], s42 offen offset:3072 sc1 lds
    v_mfma_f32_16x16x32_bf16 v[28:31], a[248:251], v[68:71], v[28:31]
    v_mfma_f32_16x16x32_bf16 v[36:39], a[248:251], v[72:75], v[36:39]
    v_mfma_f32_16x16x32_bf16 v[40:43], a[252:255], v[72:75], v[40:43]
    v_mfma_f32_16x16x32_bf16 v[32:35], a[252:255], v[68:71], v[32:35]
    s_nop 1
    v_cvt_pk_bf16_f32 v148, v28, v29
    v_cvt_pk_bf16_f32 v149, v30, v31
    s_nop 3
    v_cvt_pk_bf16_f32 v150, v32, v33
    v_cvt_pk_bf16_f32 v151, v34, v35
    buffer_store_dwordx4 v[148:151], v1, s[16:19], s44 offen offset:0 sc1
    v_cvt_pk_bf16_f32 v152, v36, v37
    v_cvt_pk_bf16_f32 v153, v38, v39
    v_cvt_pk_bf16_f32 v154, v40, v41
    v_cvt_pk_bf16_f32 v155, v42, v43
    buffer_store_dwordx4 v[152:155], v1, s[16:19], s44 offen offset:1024 sc1
    s_add_u32 m0, s43, 32768
    s_add_u32 s42, s41, 32768
    v_add_f32 v140, v28, v29
    v_add_f32 v144, v36, v37
    v_mul_f32 v141, v28, v28
    v_mul_f32 v145, v36, v36
    buffer_load_dwordx4 v1, s[16:19], s42 offen offset:0 sc1 lds
    v_fmac_f32 v141, v29, v29
    v_fmac_f32 v145, v37, v37
    v_add_f32 v140, v140, v30
    v_add_f32 v144, v144, v38
    v_fmac_f32 v141, v30, v30
    v_fmac_f32 v145, v38, v38
    v_add_f32 v140, v140, v31
    v_add_f32 v144, v144, v39
    buffer_load_dwordx4 v1, s[16:19], s42 offen offset:1024 sc1 lds
    v_fmac_f32 v141, v31, v31
    v_fmac_f32 v145, v39, v39
    v_add_f32 v140, v140, v32
    v_add_f32 v144, v144, v40
    v_fmac_f32 v141, v32, v32
    v_fmac_f32 v145, v40, v40
    v_add_f32 v140, v140, v33
    v_add_f32 v144, v144, v41
    buffer_load_dwordx4 v1, s[16:19], s42 offen offset:2048 sc1 lds
    v_fmac_f32 v141, v33, v33
    v_fmac_f32 v145, v41, v41
    v_add_f32 v140, v140, v34
    v_add_f32 v144, v144, v42
    v_fmac_f32 v141, v34, v34
    v_fmac_f32 v145, v42, v42
    v_add_f32 v140, v140, v35
    v_add_f32 v144, v144, v43
    buffer_load_dwordx4 v1, s[16:19], s42 offen offset:3072 sc1 lds
    v_fmac_f32 v141, v35, v35
    v_fmac_f32 v145, v43, v43
    s_nop 0
    v_permlane16_swap_b32 v140, v141
    v_permlane16_swap_b32 v144, v145
    v_add_f32 v140, v140, v141
    v_add_f32 v144, v144, v145
    v_mov_b32 v142, v140
    v_mov_b32 v146, v144
    s_nop 0
    v_permlane32_swap_b32 v140, v142
    v_permlane32_swap_b32 v144, v146
    v_add_f32 v140, v140, v142
    v_add_f32 v144, v144, v146
    ds_write_b32 v6, v140 offset:0
    ds_write_b32 v6, v144 offset:512
    s_waitcnt vmcnt(10) lgkmcnt(0)
    s_barrier
    ds_read_b128 v[44:47], v1 offset:0
    ds_read_b128 v[48:51], v1 offset:1024
    ds_read_b128 v[52:55], v1 offset:2048
    ds_read_b128 v[56:59], v1 offset:3072
    s_add_u32 s36, s36, 1
    s_cmp_lt_u32 s36, 32
    s_cbranch_scc1 L_o_b0
    s_nop 7
    ds_read_b128 v[140:143], v7
    s_cmp_eq_u32 s36, 0
    s_cselect_b32 s49, 0x5e00000, s46
    s_waitcnt lgkmcnt(0)
    v_add_f32 v140, v140, v141
    v_add_f32 v142, v142, v143
    v_add_f32 v140, v140, v142
    v_min_u32 v140, -2, v140
    buffer_store_dword v140, v8, s[16:19], s49 offen sc1
    s_waitcnt vmcnt(5)
    s_barrier
    buffer_store_dword v124, v124, s[16:19], s91 offen sc1
    s_add_u32 s91, s91, 65536
    s_waitcnt vmcnt(0)
    s_endpgm
L_vspin25:
    s_mov_b32 s40, 0x20000
L_vspin25_l:
    s_cmp_lg_u32 s37, 0
    s_cbranch_scc1 L_restart
    s_sleep 4
    buffer_load_dword v8, v124, s[20:23], 0 offen offset:32 sc1
    s_waitcnt vmcnt(0)
    v_readfirstlane_b32 s37, v8
    s_sub_u32 s40, s40, 1
    s_cbranch_scc1 L_vback26
    s_cmp_lg_u32 s37, s3
    s_cbranch_scc1 L_vspin25_l
    s_branch L_vback26
L_vspin27:
    s_mov_b32 s40, 0x20000
L_vspin27_l:
    s_cmp_lg_u32 s37, 0
    s_cbranch_scc1 L_restart
    s_sleep 4
    buffer_load_dword v8, v124, s[20:23], 0 offen offset:32 sc1
    s_waitcnt vmcnt(0)
    v_readfirstlane_b32 s37, v8
    s_sub_u32 s40, s40, 1
    s_cbranch_scc1 L_vback28
    s_cmp_lg_u32 s37, s3
    s_cbranch_scc1 L_vspin27_l
    s_branch L_vback28
L_vspin30:
    s_mov_b32 s40, 0x20000
L_vspin30_l:
    s_cmp_lg_u32 s37, 0
    s_cbranch_scc1 L_restart
    s_sleep 4
    buffer_load_dword v58, v124, s[20:23], 0 offen offset:32 sc1
    s_waitcnt vmcnt(0)
    v_readfirstlane_b32 s37, v58
    s_sub_u32 s40, s40, 1
    s_cbranch_scc1 L_vback31
    s_cmp_lg_u32 s37, s3
    s_cbranch_scc1 L_vspin30_l
    s_branch L_vback31
L_spin32:
    s_mov_b32 s40, 0x20000
L_spin32_l:
    buffer_load_dword v57, v56, s[20:23], 0 offen sc1
    s_sub_u32 s40, s40, 1
    s_waitcnt vmcnt(0)
    v_cmp_eq_u32 vcc, v56, v57
    s_cbranch_scc1 L_back33
    s_cbranch_vccz L_back33
    s_sleep 8
    s_branch L_spin32_l
L_spin34:
    s_mov_b32 s40, 0x20000
L_spin34_l:
    buffer_load_dword v136, v4, s[16:19], s45 offen sc1
    s_sub_u32 s40, s40, 1
    s_waitcnt vmcnt(0)
    v_cmp_ne_u32 vcc, 0, v136
    s_cbranch_scc1 L_back35
    s_cbranch_vccz L_back35
    s_sleep 2
    s_branch L_spin34_l
L_spin36:
    s_mov_b32 s40, 0x20000
L_spin36_l:
    buffer_load_dword v136, v4, s[16:19], s45 offen sc1
    s_sub_u32 s40, s40, 1
    s_waitcnt vmcnt(0)
    v_cmp_ne_u32 vcc, 0, v136
    s_cbranch_scc1 L_back37
    s_cbranch_vccz L_back37
    s_sleep 2
    s_branch L_spin36_l
L_spin38:
    s_mov_b32 s40, 0x20000
L_spin38_l:
    buffer_load_dword v136, v4, s[16:19], s45 offen sc1
    s_sub_u32 s40, s40, 1
    s_waitcnt vmcnt(0)
    v_cmp_ne_u32 vcc, 0, v136
    s_cbranch_scc1 L_back39
    s_cbranch_vccz L_back39
    s_sleep 2
    s_branch L_spin38_l
L_role_40:
    s_sub_u32 s35, s34, 40
    s_lshl_b32 s51, s35, 2
    s_add_u32 s51, s51, 96
    s_lshl_b32 s54, s51, 6
    s_mov_b32 s12, s72
    s_mov_b32 s13, s73
    s_mov_b32 s14, 0x700000
    s_mov_b32 s15, 0x00020000
    s_mov_b32 s39, 7168
    v_lshrrev_b32 v64, 3, v0
    v_lshlrev_b32 v65, 2, v0
    v_and_b32 v65, 64, v65
    v_and_b32 v66, 0x70, v1
    v_xor_b32 v65, v65, v66
    v_mad_u32_u24 v56, v64, s39, v65
    v_add_u32 v57, 57344, v56
    v_add_u32 v58, 128, v56
    v_add_u32 v59, 57472, v56
    s_mul_i32 s38, s32, 114688
    s_add_u32 s54, s54, s38
    s_lshl_b32 s42, s32, 11
    s_add_u32 m0, s42, 0
    s_nop 0
    buffer_load_dwordx4 v56, s[12:15], s54 offen lds
    s_add_u32 m0, s42, 1024
    s_nop 0
    buffer_load_dwordx4 v57, s[12:15], s54 offen lds
    s_add_u32 m0, s42, 8192
    s_nop 0
    buffer_load_dwordx4 v58, s[12:15], s54 offen lds
    s_add_u32 m0, s42, 9216
    s_nop 0
    buffer_load_dwordx4 v59, s[12:15], s54 offen lds
    s_add_u32 s54, s54, 458752
    s_add_u32 m0, s42, 16384
    s_nop 0
    buffer_load_dwordx4 v56, s[12:15], s54 offen lds
    s_add_u32 m0, s42, 17408
    s_nop 0
    buffer_load_dwordx4 v57, s[12:15], s54 offen lds
    s_add_u32 m0, s42, 24576
    s_nop 0
    buffer_load_dwordx4 v58, s[12:15], s54 offen lds
    s_add_u32 m0, s42, 25600
    s_nop 0
    buffer_load_dwordx4 v59, s[12:15], s54 offen lds
    s_add_u32 s54, s54, 458752
    s_add_u32 m0, s42, 32768
    s_nop 0
    buffer_load_dwordx4 v56, s[12:15], s54 offen lds
    s_add_u32 m0, s42, 33792
    s_nop 0
    buffer_load_dwordx4 v57, s[12:15], s54 offen lds
    s_add_u32 m0, s42, 40960
    s_nop 0
    buffer_load_dwordx4 v58, s[12:15], s54 offen lds
    s_add_u32 m0, s42, 41984
    s_nop 0
    buffer_load_dwordx4 v59, s[12:15], s54 offen lds
    s_add_u32 s54, s54, 458752
    s_add_u32 m0, s42, 49152
    s_nop 0
    buffer_load_dwordx4 v56, s[12:15], s54 offen lds
    s_add_u32 m0, s42, 50176
    s_nop 0
    buffer_load_dwordx4 v57, s[12:15], s54 offen lds
    s_add_u32 m0, s42, 57344
    s_nop 0
    buffer_load_dwordx4 v58, s[12:15], s54 offen lds
    s_add_u32 m0, s42, 58368
    s_nop 0
    buffer_load_dwordx4 v59, s[12:15], s54 offen lds
    s_add_u32 s54, s54, 458752
    s_add_u32 m0, s42, 65536
    s_nop 0
    buffer_load_dwordx4 v56, s[12:15], s54 offen lds
    s_add_u32 m0, s42, 66560
    s_nop 0
    buffer_load_dwordx4 v57, s[12:15], s54 offen lds
    s_add_u32 m0, s42, 73728
    s_nop 0
    buffer_load_dwordx4 v58, s[12:15], s54 offen lds
    s_add_u32 m0, s42, 74752
    s_nop 0
    buffer_load_dwordx4 v59, s[12:15], s54 offen lds
    s_add_u32 s54, s54, 458752
    v_lshrrev_b32 v64, 4, v0
    v_bfe_u32 v65, v0, 2, 2
    v_lshl_add_u32 v64, v64, 3, v65
    v_lshlrev_b32 v64, 7, v64
    v_lshrrev_b32 v65, 1, v65
    v_lshl_add_u32 v64, v65, 6, v64
    v_and_b32 v65, 3, v0
    v_lshl_add_u32 v64, v65, 4, v64
    s_lshr_b32 s37, s32, 1
    s_lshl_b32 s37, s37, 13
    s_and_b32 s38, s32, 1
    s_lshl_b32 s38, s38, 6
    s_add_u32 s37, s37, s38
    s_add_u32 s37, s37, 0
    v_xor_b32 v60, s37, v64
    s_lshr_b32 s37, s32, 1
    s_lshl_b32 s37, s37, 13
    s_and_b32 s38, s32, 1
    s_lshl_b32 s38, s38, 6
    s_add_u32 s37, s37, s38
    s_add_u32 s37, s37, 8
    v_xor_b32 v61, s37, v64
    v_mov_b32 v64, 0x3f803f80
    v_mov_b32 v65, 0x3f803f80
    v_mov_b32 v66, 0x3f803f80
    v_mov_b32 v67, 0x3f803f80
    v_add_u32 v2, 98304, v1
    s_lshl_b32 s37, s33, 6
    s_add_u32 s37, s37, 16
    s_lshl_b32 s37, s37, 7
    v_lshl_add_u32 v5, v0, 7, s37
    s_cmp_eq_u32 s32, 0
    s_cselect_b32 s37, 8, 0
    v_cmp_le_u32 vcc, s37, v0
    s_nop 1
    v_cndmask_b32 v5, v5, 2.0, vcc
    s_lshl_b32 s43, s32, 12
    s_mul_i32 s41, s33, 2097152
    s_add_u32 s41, s41, 0x800000
    s_add_u32 s41, s41, s43
    s_mul_i32 s90, s33, 8388608
    s_add_u32 s90, s90, 0xfc0000
    s_add_u32 s37, s51, s32
    s_lshl_b32 s37, s37, 11
    s_add_u32 s90, s90, s37
    s_lshl_b32 s37, s32, 10
    s_sub_u32 s87, 8192, s37
    s_lshl_b32 s38, s35, 1
    s_lshr_b32 s39, s32, 1
    s_add_u32 s38, s38, s39
    s_cmp_eq_u32 s38, 36
    s_cselect_b32 s88, 0x5e00000, 0
    s_and_b32 s38, s32, 1
    s_lshl_b32 s38, s38, 3
    s_and_b32 s39, s32, 2
    s_lshl_b32 s39, s39, 10
    s_add_u32 s38, s38, s39
    s_add_u32 s38, s38, 65536
    v_add_u32 v3, s38, v1
    s_add_u32 s37, s37, 65536
    v_add_u32 v4, s37, v1
    v_and_b32 v6, 15, v0
    v_lshlrev_b32 v6, 3, v6
    v_lshrrev_b32 v8, 5, v0
    v_lshl_add_u32 v6, v8, 9, v6
    v_and_b32 v8, 16, v0
    v_lshl_add_u32 v6, v8, 6, v6
    v_add_u32 v118, 73728, v6
    s_mul_i32 s46, s33, 65536
    s_add_u32 s46, s46, 0x5440000
    s_add_u32 s55, s46, 63488
    s_and_b32 s52, s32, 1
    s_lshl_b32 s52, s52, 10
    s_mov_b32 s8, s74
    s_mov_b32 s9, s75
    s_mov_b32 s10, 0x1c00
    s_mov_b32 s11, 0x00020000
    v_and_b32 v8, 0x30, v0
    s_add_u32 s37, s51, s32
    s_lshl_b32 s37, s37, 6
    buffer_load_dwordx4 v[16:19], v8, s[8:11], s37 offen
    s_lshr_b32 s37, s32, 1
    s_add_u32 s37, s37, s51
    s_lshl_b32 s37, s37, 6
    s_and_b32 s38, s32, 1
    s_lshl_b32 s38, s38, 3
    s_add_u32 s37, s37, s38
    buffer_load_dwordx2 v[20:21], v8, s[8:11], s37 offen offset:256
    s_add_u32 s20, s82, 0x80
    s_addc_u32 s21, s83, 0
    s_mov_b32 s22, 0x80
    s_mov_b32 s23, 0x00020000
    v_lshl_add_u32 v68, s32, 7, v124
    v_add_u32 v62, 0, v60
    v_add_u32 v63, 0, v61
    s_waitcnt vmcnt(18)
    s_barrier
    ds_read_b64_tr_b16 a[0:1], v62 offset:0
    ds_read_b64_tr_b16 a[2:3], v62 offset:512
    ds_read_b64_tr_b16 a[4:5], v63 offset:0
    ds_read_b64_tr_b16 a[6:7], v63 offset:512
    ds_read_b64_tr_b16 a[8:9], v62 offset:4096
    ds_read_b64_tr_b16 a[10:11], v62 offset:4608
    ds_read_b64_tr_b16 a[12:13], v63 offset:4096
    ds_read_b64_tr_b16 a[14:15], v63 offset:4608
    s_add_u32 m0, s42, 81920
    s_nop 0
    buffer_load_dwordx4 v56, s[12:15], s54 offen lds
    s_add_u32 m0, s42, 82944
    s_nop 0
    buffer_load_dwordx4 v57, s[12:15], s54 offen lds
    s_add_u32 m0, s42, 90112
    s_nop 0
    buffer_load_dwordx4 v58, s[12:15], s54 offen lds
    s_add_u32 m0, s42, 91136
    s_nop 0
    buffer_load_dwordx4 v59, s[12:15], s54 offen lds
    s_add_u32 s54, s54, 458752
    s_waitcnt lgkmcnt(0)
    v_mfma_f32_16x16x32_bf16 v[88:91], a[0:3], v[64:67], 0
    v_mfma_f32_16x16x32_bf16 v[92:95], a[4:7], v[64:67], 0
    v_mfma_f32_16x16x32_bf16 v[88:91], a[8:11], v[64:67], v[88:91]
    v_mfma_f32_16x16x32_bf16 v[92:95], a[12:15], v[64:67], v[92:95]
    v_add_u32 v62, 16384, v60
    v_add_u32 v63, 16384, v61
    s_waitcnt vmcnt(18)
    s_barrier
    ds_read_b64_tr_b16 a[16:17], v62 offset:0
    ds_read_b64_tr_b16 a[18:19], v62 offset:512
    ds_read_b64_tr_b16 a[20:21], v63 offset:0
    ds_read_b64_tr_b16 a[22:23], v63 offset:512
    ds_read_b64_tr_b16 a[24:25], v62 offset:4096
    ds_read_b64_tr_b16 a[26:27], v62 offset:4608
    ds_read_b64_tr_b16 a[28:29], v63 offset:4096
    ds_read_b64_tr_b16 a[30:31], v63 offset:4608
    s_add_u32 m0, s42, 0
    s_nop 0
    buffer_load_dwordx4 v56, s[12:15], s54 offen lds
    s_add_u32 m0, s42, 1024
    s_nop 0
    buffer_load_dwordx4 v57, s[12:15], s54 offen lds
    s_add_u32 m0, s42, 8192
    s_nop 0
    buffer_load_dwordx4 v58, s[12:15], s54 offen lds
    s_add_u32 m0, s42, 9216
    s_nop 0
    buffer_load_dwordx4 v59, s[12:15], s54 offen lds
    s_add_u32 s54, s54, 458752
    s_waitcnt lgkmcnt(0)
    v_mfma_f32_16x16x32_bf16 v[88:91], a[16:19], v[64:67], v[88:91]
    v_mfma_f32_16x16x32_bf16 v[92:95], a[20:23], v[64:67], v[92:95]
    v_mfma_f32_16x16x32_bf16 v[88:91], a[24:27], v[64:67], v[88:91]
    v_mfma_f32_16x16x32_bf16 v[92:95], a[28:31], v[64:67], v[92:95]
    v_add_u32 v62, 32768, v60
    v_add_u32 v63, 32768, v61
    s_waitcnt vmcnt(18)
    s_barrier
    ds_read_b64_tr_b16 a[32:33], v62 offset:0
    ds_read_b64_tr_b16 a[34:35], v62 offset:512
    ds_read_b64_tr_b16 a[36:37], v63 offset:0
    ds_read_b64_tr_b16 a[38:39], v63 offset:512
    ds_read_b64_tr_b16 a[40:41], v62 offset:4096
    ds_read_b64_tr_b16 a[42:43], v62 offset:4608
    ds_read_b64_tr_b16 a[44:45], v63 offset:4096
    ds_read_b64_tr_b16 a[46:47], v63 offset:4608
    s_add_u32 m0, s42, 16384
    s_nop 0
    buffer_load_dwordx4 v56, s[12:15], s54 offen lds
    s_add_u32 m0, s42, 17408
    s_nop 0
    buffer_load_dwordx4 v57, s[12:15], s54 offen lds
    s_add_u32 m0, s42, 24576
    s_nop 0
    buffer_load_dwordx4 v58, s[12:15], s54 offen lds
    s_add_u32 m0, s42, 25600
    s_nop 0
    buffer_load_dwordx4 v59, s[12:15], s54 offen lds
    s_add_u32 s54, s54, 458752
    s_waitcnt lgkmcnt(0)
    v_mfma_f32_16x16x32_bf16 v[88:91], a[32:35], v[64:67], v[88:91]
    v_mfma_f32_16x16x32_bf16 v[92:95], a[36:39], v[64:67], v[92:95]
    v_mfma_f32_16x16x32_bf16 v[88:91], a[40:43], v[64:67], v[88:91]
    v_mfma_f32_16x16x32_bf16 v[92:95], a[44:47], v[64:67], v[92:95]
    v_add_u32 v62, 49152, v60
    v_add_u32 v63, 49152, v61
    s_waitcnt vmcnt(18)
    s_barrier
    ds_read_b64_tr_b16 a[48:49], v62 offset:0
    ds_read_b64_tr_b16 a[50:51], v62 offset:512
    ds_read_b64_tr_b16 a[52:53], v63 offset:0
    ds_read_b64_tr_b16 a[54:55], v63 offset:512
    ds_read_b64_tr_b16 a[56:57], v62 offset:4096
    ds_read_b64_tr_b16 a[58:59], v62 offset:4608
    ds_read_b64_tr_b16 a[60:61], v63 offset:4096
    ds_read_b64_tr_b16 a[62:63], v63 offset:4608
    s_add_u32 m0, s42, 32768
    s_nop 0
    buffer_load_dwordx4 v56, s[12:15], s54 offen lds
    s_add_u32 m0, s42, 33792
    s_nop 0
    buffer_load_dwordx4 v57, s[12:15], s54 offen lds
    s_add_u32 m0, s42, 40960
    s_nop 0
    buffer_load_dwordx4 v58, s[12:15], s54 offen lds
    s_add_u32 m0, s42, 41984
    s_nop 0
    buffer_load_dwordx4 v59, s[12:15], s54 offen lds
    s_add_u32 s54, s54, 458752
    s_waitcnt lgkmcnt(0)
    v_mfma_f32_16x16x32_bf16 v[88:91], a[48:51], v[64:67], v[88:91]
    v_mfma_f32_16x16x32_bf16 v[92:95], a[52:55], v[64:67], v[92:95]
    v_mfma_f32_16x16x32_bf16 v[88:91], a[56:59], v[64:67], v[88:91]
    v_mfma_f32_16x16x32_bf16 v[92:95], a[60:63], v[64:67], v[92:95]
    v_add_u32 v62, 65536, v60
    v_add_u32 v63, 65536, v61
    s_waitcnt vmcnt(18)
    s_barrier
    ds_read_b64_tr_b16 a[64:65], v62 offset:0
    ds_read_b64_tr_b16 a[66:67], v62 offset:512
    ds_read_b64_tr_b16 a[68:69], v63 offset:0
    ds_read_b64_tr_b16 a[70:71], v63 offset:512
    ds_read_b64_tr_b16 a[72:73], v62 offset:4096
    ds_read_b64_tr_b16 a[74:75], v62 offset:4608
    ds_read_b64_tr_b16 a[76:77], v63 offset:4096
    ds_read_b64_tr_b16 a[78:79], v63 offset:4608
    s_add_u32 m0, s42, 49152
    s_nop 0
    buffer_load_dwordx4 v56, s[12:15], s54 offen lds
    s_add_u32 m0, s42, 50176
    s_nop 0
    buffer_load_dwordx4 v57, s[12:15], s54 offen lds
    s_add_u32 m0, s42, 57344
    s_nop 0
    buffer_load_dwordx4 v58, s[12:15], s54 offen lds
    s_add_u32 m0, s42, 58368
    s_nop 0
    buffer_load_dwordx4 v59, s[12:15], s54 offen lds
    s_add_u32 s54, s54, 458752
    s_waitcnt lgkmcnt(0)
    v_mfma_f32_16x16x32_bf16 v[88:91], a[64:67], v[64:67], v[88:91]
    v_mfma_f32_16x16x32_bf16 v[92:95], a[68:71], v[64:67], v[92:95]
    v_mfma_f32_16x16x32_bf16 v[88:91], a[72:75], v[64:67], v[88:91]
    v_mfma_f32_16x16x32_bf16 v[92:95], a[76:79], v[64:67], v[92:95]
    v_add_u32 v62, 81920, v60
    v_add_u32 v63, 81920, v61
    s_waitcnt vmcnt(16)
    s_barrier
    ds_read_b64_tr_b16 a[80:81], v62 offset:0
    ds_read_b64_tr_b16 a[82:83], v62 offset:512
    ds_read_b64_tr_b16 a[84:85], v63 offset:0
    ds_read_b64_tr_b16 a[86:87], v63 offset:512
    ds_read_b64_tr_b16 a[88:89], v62 offset:4096
    ds_read_b64_tr_b16 a[90:91], v62 offset:4608
    ds_read_b64_tr_b16 a[92:93], v63 offset:4096
    ds_read_b64_tr_b16 a[94:95], v63 offset:4608
    s_add_u32 m0, s42, 65536
    s_nop 0
    buffer_load_dwordx4 v56, s[12:15], s54 offen lds
    s_add_u32 m0, s42, 66560
    s_nop 0
    buffer_load_dwordx4 v57, s[12:15], s54 offen lds
    s_add_u32 m0, s42, 73728
    s_nop 0
    buffer_load_dwordx4 v58, s[12:15], s54 offen lds
    s_add_u32 m0, s42, 74752
    s_nop 0
    buffer_load_dwordx4 v59, s[12:15], s54 offen lds
    s_add_u32 s54, s54, 458752
    s_waitcnt lgkmcnt(0)
    v_mfma_f32_16x16x32_bf16 v[88:91], a[80:83], v[64:67], v[88:91]
    v_mfma_f32_16x16x32_bf16 v[92:95], a[84:87], v[64:67], v[92:95]
    v_mfma_f32_16x16x32_bf16 v[88:91], a[88:91], v[64:67], v[88:91]
    v_mfma_f32_16x16x32_bf16 v[92:95], a[92:95], v[64:67], v[92:95]
    v_add_u32 v62, 0, v60
    v_add_u32 v63, 0, v61
    s_waitcnt vmcnt(16)
    s_barrier
    ds_read_b64_tr_b16 a[96:97], v62 offset:0
    ds_read_b64_tr_b16 a[98:99], v62 offset:512
    ds_read_b64_tr_b16 a[100:101], v63 offset:0
    ds_read_b64_tr_b16 a[102:103], v63 offset:512
    ds_read_b64_tr_b16 a[104:105], v62 offset:4096
    ds_read_b64_tr_b16 a[106:107], v62 offset:4608
    ds_read_b64_tr_b16 a[108:109], v63 offset:4096
    ds_read_b64_tr_b16 a[110:111], v63 offset:4608
    s_add_u32 m0, s42, 81920
    s_nop 0
    buffer_load_dwordx4 v56, s[12:15], s54 offen lds
    s_add_u32 m0, s42, 82944
    s_nop 0
    buffer_load_dwordx4 v57, s[12:15], s54 offen lds
    s_add_u32 m0, s42, 90112
    s_nop 0
    buffer_load_dwordx4 v58, s[12:15], s54 offen lds
    s_add_u32 m0, s42, 91136
    s_nop 0
    buffer_load_dwordx4 v59, s[12:15], s54 offen lds
    s_add_u32 s54, s54, 458752
    s_waitcnt lgkmcnt(0)
    v_mfma_f32_16x16x32_bf16 v[88:91], a[96:99], v[64:67], v[88:91]
    v_mfma_f32_16x16x32_bf16 v[92:95], a[100:103], v[64:67], v[92:95]
    v_mfma_f32_16x16x32_bf16 v[88:91], a[104:107], v[64:67], v[88:91]
    v_mfma_f32_16x16x32_bf16 v[92:95], a[108:111], v[64:67], v[92:95]
    v_add_u32 v62, 16384, v60
    v_add_u32 v63, 16384, v61
    s_waitcnt vmcnt(16)
    s_barrier
    ds_read_b64_tr_b16 a[112:113], v62 offset:0
    ds_read_b64_tr_b16 a[114:115], v62 offset:512
    ds_read_b64_tr_b16 a[116:117], v63 offset:0
    ds_read_b64_tr_b16 a[118:119], v63 offset:512
    ds_read_b64_tr_b16 a[120:121], v62 offset:4096
    ds_read_b64_tr_b16 a[122:123], v62 offset:4608
    ds_read_b64_tr_b16 a[124:125], v63 offset:4096
    ds_read_b64_tr_b16 a[126:127], v63 offset:4608
    s_add_u32 m0, s42, 0
    s_nop 0
    buffer_load_dwordx4 v56, s[12:15], s54 offen lds
    s_add_u32 m0, s42, 1024
    s_nop 0
    buffer_load_dwordx4 v57, s[12:15], s54 offen lds
    s_add_u32 m0, s42, 8192
    s_nop 0
    buffer_load_dwordx4 v58, s[12:15], s54 offen lds
    s_add_u32 m0, s42, 9216
    s_nop 0
    buffer_load_dwordx4 v59, s[12:15], s54 offen lds
    s_add_u32 s54, s54, 458752
    s_waitcnt lgkmcnt(0)
    v_mfma_f32_16x16x32_bf16 v[88:91], a[112:115], v[64:67], v[88:91]
    v_mfma_f32_16x16x32_bf16 v[92:95], a[116:119], v[64:67], v[92:95]
    v_mfma_f32_16x16x32_bf16 v[88:91], a[120:123], v[64:67], v[88:91]
    v_mfma_f32_16x16x32_bf16 v[92:95], a[124:127], v[64:67], v[92:95]
    v_add_u32 v62, 32768, v60
    v_add_u32 v63, 32768, v61
    s_waitcnt vmcnt(16)
    s_barrier
    ds_read_b64_tr_b16 a[128:129], v62 offset:0
    ds_read_b64_tr_b16 a[130:131], v62 offset:512
    ds_read_b64_tr_b16 a[132:133], v63 offset:0
    ds_read_b64_tr_b16 a[134:135], v63 offset:512
    ds_read_b64_tr_b16 a[136:137], v62 offset:4096
    ds_read_b64_tr_b16 a[138:139], v62 offset:4608
    ds_read_b64_tr_b16 a[140:141], v63 offset:4096
    ds_read_b64_tr_b16 a[142:143], v63 offset:4608
    s_add_u32 m0, s42, 16384
    s_nop 0
    buffer_load_dwordx4 v56, s[12:15], s54 offen lds
    s_add_u32 m0, s42, 17408
    s_nop 0
    buffer_load_dwordx4 v57, s[12:15], s54 offen lds
    s_add_u32 m0, s42, 24576
    s_nop 0
    buffer_load_dwordx4 v58, s[12:15], s54 offen lds
    s_add_u32 m0, s42, 25600
    s_nop 0
    buffer_load_dwordx4 v59, s[12:15], s54 offen lds
    s_add_u32 s54, s54, 458752
    s_waitcnt lgkmcnt(0)
    v_mfma_f32_16x16x32_bf16 v[88:91], a[128:131], v[64:67], v[88:91]
    v_mfma_f32_16x16x32_bf16 v[92:95], a[132:135], v[64:67], v[92:95]
    v_mfma_f32_16x16x32_bf16 v[88:91], a[136:139], v[64:67], v[88:91]
    v_mfma_f32_16x16x32_bf16 v[92:95], a[140:143], v[64:67], v[92:95]
    v_add_u32 v62, 49152, v60
    v_add_u32 v63, 49152, v61
    s_waitcnt vmcnt(16)
    s_barrier
    ds_read_b64_tr_b16 a[144:145], v62 offset:0
    ds_read_b64_tr_b16 a[146:147], v62 offset:512
    ds_read_b64_tr_b16 a[148:149], v63 offset:0
    ds_read_b64_tr_b16 a[150:151], v63 offset:512
    ds_read_b64_tr_b16 a[152:153], v62 offset:4096
    ds_read_b64_tr_b16 a[154:155], v62 offset:4608
    ds_read_b64_tr_b16 a[156:157], v63 offset:4096
    ds_read_b64_tr_b16 a[158:159], v63 offset:4608
    s_add_u32 m0, s42, 32768
    s_nop 0
    buffer_load_dwordx4 v56, s[12:15], s54 offen lds
    s_add_u32 m0, s42, 33792
    s_nop 0
    buffer_load_dwordx4 v57, s[12:15], s54 offen lds
    s_add_u32 m0, s42, 40960
    s_nop 0
    buffer_load_dwordx4 v58, s[12:15], s54 offen lds
    s_add_u32 m0, s42, 41984
    s_nop 0
    buffer_load_dwordx4 v59, s[12:15], s54 offen lds
    s_add_u32 s54, s54, 458752
    s_waitcnt lgkmcnt(0)
    v_mfma_f32_16x16x32_bf16 v[88:91], a[144:147], v[64:67], v[88:91]
    v_mfma_f32_16x16x32_bf16 v[92:95], a[148:151], v[64:67], v[92:95]
    v_mfma_f32_16x16x32_bf16 v[88:91], a[152:155], v[64:67], v[88:91]
    v_mfma_f32_16x16x32_bf16 v[92:95], a[156:159], v[64:67], v[92:95]
    v_add_u32 v62, 65536, v60
    v_add_u32 v63, 65536, v61
    s_waitcnt vmcnt(16)
    s_barrier
    ds_read_b64_tr_b16 a[160:161], v62 offset:0
    ds_read_b64_tr_b16 a[162:163], v62 offset:512
    ds_read_b64_tr_b16 a[164:165], v63 offset:0
    ds_read_b64_tr_b16 a[166:167], v63 offset:512
    ds_read_b64_tr_b16 a[168:169], v62 offset:4096
    ds_read_b64_tr_b16 a[170:171], v62 offset:4608
    ds_read_b64_tr_b16 a[172:173], v63 offset:4096
    ds_read_b64_tr_b16 a[174:175], v63 offset:4608
    buffer_load_dword v69, v68, s[20:23], 0 offen sc1
    s_add_u32 m0, s42, 49152
    s_nop 0
    buffer_load_dwordx4 v56, s[12:15], s54 offen lds
    s_add_u32 m0, s42, 50176
    s_nop 0
    buffer_load_dwordx4 v57, s[12:15], s54 offen lds
    s_add_u32 m0, s42, 57344
    s_nop 0
    buffer_load_dwordx4 v58, s[12:15], s54 offen lds
    s_add_u32 m0, s42, 58368
    s_nop 0
    buffer_load_dwordx4 v59, s[12:15], s54 offen lds
    s_add_u32 s54, s54, 458752
    s_waitcnt lgkmcnt(0)
    v_mfma_f32_16x16x32_bf16 v[88:91], a[160:163], v[64:67], v[88:91]
    v_mfma_f32_16x16x32_bf16 v[92:95], a[164:167], v[64:67], v[92:95]
    v_mfma_f32_16x16x32_bf16 v[88:91], a[168:171], v[64:67], v[88:91]
    v_mfma_f32_16x16x32_bf16 v[92:95], a[172:175], v[64:67], v[92:95]
    v_add_u32 v62, 81920, v60
    v_add_u32 v63, 81920, v61
    s_waitcnt vmcnt(17)
    s_barrier
    ds_read_b64_tr_b16 a[176:177], v62 offset:0
    ds_read_b64_tr_b16 a[178:179], v62 offset:512
    ds_read_b64_tr_b16 a[180:181], v63 offset:0
    ds_read_b64_tr_b16 a[182:183], v63 offset:512
    ds_read_b64_tr_b16 a[184:185], v62 offset:4096
    ds_read_b64_tr_b16 a[186:187], v62 offset:4608
    ds_read_b64_tr_b16 a[188:189], v63 offset:4096
    ds_read_b64_tr_b16 a[190:191], v63 offset:4608
    s_waitcnt lgkmcnt(0)
    v_mfma_f32_16x16x32_bf16 v[88:91], a[176:179], v[64:67], v[88:91]
    v_mfma_f32_16x16x32_bf16 v[92:95], a[180:183], v[64:67], v[92:95]
    v_mfma_f32_16x16x32_bf16 v[88:91], a[184:187], v[64:67], v[88:91]
    v_mfma_f32_16x16x32_bf16 v[92:95], a[188:191], v[64:67], v[92:95]
    v_add_u32 v62, 0, v60
    v_add_u32 v63, 0, v61
    s_waitcnt vmcnt(13)
    s_barrier
    ds_read_b64_tr_b16 a[192:193], v62 offset:0
    ds_read_b64_tr_b16 a[194:195], v62 offset:512
    ds_read_b64_tr_b16 a[196:197], v63 offset:0
    ds_read_b64_tr_b16 a[198:199], v63 offset:512
    ds_read_b64_tr_b16 a[200:201], v62 offset:4096
    ds_read_b64_tr_b16 a[202:203], v62 offset:4608
    ds_read_b64_tr_b16 a[204:205], v63 offset:4096
    ds_read_b64_tr_b16 a[206:207], v63 offset:4608
    s_waitcnt lgkmcnt(0)
    v_mfma_f32_16x16x32_bf16 v[88:91], a[192:195], v[64:67], v[88:91]
    v_mfma_f32_16x16x32_bf16 v[92:95], a[196:199], v[64:67], v[92:95]
    v_mfma_f32_16x16x32_bf16 v[88:91], a[200:203], v[64:67], v[88:91]
    v_mfma_f32_16x16x32_bf16 v[92:95], a[204:207], v[64:67], v[92:95]
    v_add_u32 v62, 16384, v60
    v_add_u32 v63, 16384, v61
    s_waitcnt vmcnt(9)
    s_barrier
    ds_read_b64_tr_b16 a[208:209], v62 offset:0
    ds_read_b64_tr_b16 a[210:211], v62 offset:512
    ds_read_b64_tr_b16 a[212:213], v63 offset:0
    ds_read_b64_tr_b16 a[214:215], v63 offset:512
    ds_read_b64_tr_b16 a[216:217], v62 offset:4096
    ds_read_b64_tr_b16 a[218:219], v62 offset:4608
    ds_read_b64_tr_b16 a[220:221], v63 offset:4096
    ds_read_b64_tr_b16 a[222:223], v63 offset:4608
    s_waitcnt lgkmcnt(0)
    v_mfma_f32_16x16x32_bf16 v[88:91], a[208:211], v[64:67], v[88:91]
    v_mfma_f32_16x16x32_bf16 v[92:95], a[212:215], v[64:67], v[92:95]
    v_mfma_f32_16x16x32_bf16 v[88:91], a[216:219], v[64:67], v[88:91]
    v_mfma_f32_16x16x32_bf16 v[92:95], a[220:223], v[64:67], v[92:95]
    v_add_u32 v62, 32768, v60
    v_add_u32 v63, 32768, v61
    s_waitcnt vmcnt(5)
    s_barrier
    ds_read_b64_tr_b16 a[224:225], v62 offset:0
    ds_read_b64_tr_b16 a[226:227], v62 offset:512
    ds_read_b64_tr_b16 a[228:229], v63 offset:0
    ds_read_b64_tr_b16 a[230:231], v63 offset:512
    ds_read_b64_tr_b16 a[232:233], v62 offset:4096
    ds_read_b64_tr_b16 a[234:235], v62 offset:4608
    ds_read_b64_tr_b16 a[236:237], v63 offset:4096
    ds_read_b64_tr_b16 a[238:239], v63 offset:4608
    s_waitcnt lgkmcnt(0)
    v_mfma_f32_16x16x32_bf16 v[88:91], a[224:227], v[64:67], v[88:91]
    v_mfma_f32_16x16x32_bf16 v[92:95], a[228:231], v[64:67], v[92:95]
    v_mfma_f32_16x16x32_bf16 v[88:91], a[232:235], v[64:67], v[88:91]
    v_mfma_f32_16x16x32_bf16 v[92:95], a[236:239], v[64:67], v[92:95]
    v_add_u32 v62, 49152, v60
    v_add_u32 v63, 49152, v61
    s_waitcnt vmcnt(0)
    v_cmp_eq_u32 vcc, v68, v69
    s_cbranch_vccnz L_spin40
L_back41:
    s_barrier
    ds_read_b64_tr_b16 a[240:241], v62 offset:0
    ds_read_b64_tr_b16 a[242:243], v62 offset:512
    ds_read_b64_tr_b16 a[244:245], v63 offset:0
    ds_read_b64_tr_b16 a[246:247], v63 offset:512
    ds_read_b64_tr_b16 a[248:249], v62 offset:4096
    ds_read_b64_tr_b16 a[250:251], v62 offset:4608
    ds_read_b64_tr_b16 a[252:253], v63 offset:4096
    ds_read_b64_tr_b16 a[254:255], v63 offset:4608
    s_waitcnt lgkmcnt(0)
    v_mfma_f32_16x16x32_bf16 v[88:91], a[240:243], v[64:67], v[88:91]
    v_mfma_f32_16x16x32_bf16 v[92:95], a[244:247], v[64:67], v[92:95]
    v_mfma_f32_16x16x32_bf16 v[88:91], a[248:251], v[64:67], v[88:91]
    v_mfma_f32_16x16x32_bf16 v[92:95], a[252:255], v[64:67], v[92:95]
    s_barrier
    s_mov_b32 s37, 0xffff0000
    v_lshlrev_b32 v100, 16, v16
    v_and_b32 v101, s37, v16
    v_lshlrev_b32 v102, 16, v17
    v_and_b32 v103, s37, v17
    v_lshlrev_b32 v104, 16, v18
    v_and_b32 v105, s37, v18
    v_lshlrev_b32 v106, 16, v19
    v_and_b32 v107, s37, v19
    v_lshlrev_b32 v108, 16, v20
    v_and_b32 v109, s37, v20
    v_lshlrev_b32 v110, 16, v21
    v_and_b32 v111, s37, v21
    s_add_u32 s96, s41, 2031616
    s_mov_b32 s98, s41
    s_mov_b32 s45, 0x5530000
    buffer_load_dword v7, v5, s[16:19], s45 offen sc1
    s_waitcnt vmcnt(0)
    v_cmp_ne_u32 vcc, 0, v7
    s_cbranch_vccnz L_spin42
L_back43:
    s_barrier
    s_mov_b32 s39, 0x5e00000
    s_add_u32 m0, s43, 0
    s_add_u32 s42, s41, 0
    buffer_load_dwordx4 v1, s[16:19], s42 offen offset:0 sc1 lds
    buffer_load_dwordx4 v1, s[16:19], s42 offen offset:1024 sc1 lds
    buffer_load_dwordx4 v1, s[16:19], s42 offen offset:2048 sc1 lds
    buffer_load_dwordx4 v1, s[16:19], s42 offen offset:3072 sc1 lds
    s_add_u32 m0, s43, 16384
    s_add_u32 s42, s41, 16384
    buffer_load_dwordx4 v1, s[16:19], s42 offen offset:0 sc1 lds
    buffer_load_dwordx4 v1, s[16:19], s42 offen offset:1024 sc1 lds
    buffer_load_dwordx4 v1, s[16:19], s42 offen offset:2048 sc1 lds
    buffer_load_dwordx4 v1, s[16:19], s42 offen offset:3072 sc1 lds
    s_add_u32 s45, s45, 65536
    s_waitcnt vmcnt(4) lgkmcnt(0)
    s_barrier
    ds_read_b128 v[56:59], v1 offset:0
    ds_read_b128 v[60:63], v1 offset:1024
    ds_read_b128 v[64:67], v1 offset:2048
    ds_read_b128 v[68:71], v1 offset:3072
    s_mov_b32 s36, 0
    s_waitcnt lgkmcnt(0)
    s_nop 7
L_l_b0:
    s_waitcnt lgkmcnt(2)
    v_mfma_f32_16x16x32_bf16 v[8:11], a[0:3], v[56:59], 0
    s_add_u32 m0, s52, 73728
    ds_read_b128 v[72:75], v1 offset:4096
    s_add_u32 s42, s46, s52
    v_mfma_f32_16x16x32_bf16 v[16:19], a[0:3], v[60:63], 0
    buffer_load_dwordx4 v1, s[16:19], s42 offen sc1 lds
    v_mfma_f32_16x16x32_bf16 v[20:23], a[4:7], v[60:63], 0
    s_add_u32 m0, s43, 32768
    ds_read_b128 v[76:79], v1 offset:5120
    s_add_u32 s42, s41, 32768
    v_mfma_f32_16x16x32_bf16 v[12:15], a[4:7], v[56:59], 0
    s_waitcnt lgkmcnt(2)
    buffer_load_dwordx4 v1, s[16:19], s42 offen offset:0 sc1 lds
    v_mfma_f32_16x16x32_bf16 v[8:11], a[8:11], v[64:67], v[8:11]
    s_and_b32 s44, s90, 0xffffffff
    ds_read_b128 v[80:83], v1 offset:6144
    s_cmp_lt_i32 s36, 1
    v_mfma_f32_16x16x32_bf16 v[16:19], a[8:11], v[68:71], v[16:19]
    buffer_load_dwordx4 v1, s[16:19], s42 offen offset:1024 sc1 lds
    v_mfma_f32_16x16x32_bf16 v[20:23], a[12:15], v[68:71], v[20:23]
    s_cselect_b32 s44, 0x5e00000, s44
    ds_read_b128 v[84:87], v1 offset:7168
    s_add_u32 s90, s90, 262144
    v_mfma_f32_16x16x32_bf16 v[12:15], a[12:15], v[64:67], v[12:15]
    s_waitcnt lgkmcnt(2)
    buffer_load_dwordx4 v1, s[16:19], s42 offen offset:2048 sc1 lds
    v_mfma_f32_16x16x32_bf16 v[8:11], a[16:19], v[72:75], v[8:11]
    ds_read_b128 v[56:59], v1 offset:8192
    v_add_f32 v32, v32, v128
    v_mfma_f32_16x16x32_bf16 v[16:19], a[16:19], v[76:79], v[16:19]
    buffer_load_dwordx4 v1, s[16:19], s42 offen offset:3072 sc1 lds
    v_mfma_f32_16x16x32_bf16 v[20:23], a[20:23], v[76:79], v[20:23]
    s_add_u32 m0, s43, 49152
    ds_read_b128 v[60:63], v1 offset:9216
    v_add_f32 v33, v33, v129
    v_mfma_f32_16x16x32_bf16 v[12:15], a[20:23], v[72:75], v[12:15]
    s_waitcnt lgkmcnt(2)
    v_mul_f32 v120, v32, v116
    v_mul_f32 v121, v33, v116
    v_mfma_f32_16x16x32_bf16 v[8:11], a[24:27], v[80:83], v[8:11]
    s_add_u32 s42, s41, 49152
    ds_read_b128 v[64:67], v1 offset:10240
    buffer_load_dwordx4 v1, s[16:19], s42 offen offset:0 sc1 lds
    v_mfma_f32_16x16x32_bf16 v[16:19], a[24:27], v[84:87], v[16:19]
    v_mul_f32 v120, v120, abs(v32)
    v_mul_f32 v121, v121, abs(v33)
    v_mfma_f32_16x16x32_bf16 v[20:23], a[28:31], v[84:87], v[20:23]
    ds_read_b128 v[68:71], v1 offset:11264
    buffer_load_dwordx4 v1, s[16:19], s42 offen offset:1024 sc1 lds
    v_mfma_f32_16x16x32_bf16 v[12:15], a[28:31], v[80:83], v[12:15]
    s_waitcnt lgkmcnt(2)
    v_cvt_pk_bf16_f32 v32, v120, v121
    v_pk_max_i16 v32, v32, 0
    v_mfma_f32_16x16x32_bf16 v[8:11], a[32:35], v[56:59], v[8:11]
    ds_read_b128 v[72:75], v1 offset:12288
    buffer_load_dwordx4 v1, s[16:19], s42 offen offset:2048 sc1 lds
    v_mfma_f32_16x16x32_bf16 v[16:19], a[32:35], v[60:63], v[16:19]
    v_add_f32 v34, v34, v130
    v_add_f32 v35, v35, v131
    v_mfma_f32_16x16x32_bf16 v[20:23], a[36:39], v[60:63], v[20:23]
    ds_read_b128 v[76:79], v1 offset:13312
    buffer_load_dwordx4 v1, s[16:19], s42 offen offset:3072 sc1 lds
    v_mfma_f32_16x16x32_bf16 v[12:15], a[36:39], v[56:59], v[12:15]
    s_waitcnt lgkmcnt(2)
    v_mul_f32 v120, v34, v116
    v_mul_f32 v121, v35, v116
    v_mfma_f32_16x16x32_bf16 v[8:11], a[40:43], v[64:67], v[8:11]
    s_add_u32 s98, s98, 65536
    ds_read_b128 v[80:83], v1 offset:14336
    v_mul_f32 v120, v120, abs(v34)
    v_mfma_f32_16x16x32_bf16 v[16:19], a[40:43], v[68:71], v[16:19]
    s_min_i32 s98, s98, s96
    v_mul_f32 v121, v121, abs(v35)
    v_cvt_pk_bf16_f32 v33, v120, v121
    v_mfma_f32_16x16x32_bf16 v[20:23], a[44:47], v[68:71], v[20:23]
    s_and_b32 s41, s98, 0xffffffff
    ds_read_b128 v[84:87], v1 offset:15360
    v_pk_max_i16 v33, v33, 0
    v_mfma_f32_16x16x32_bf16 v[12:15], a[44:47], v[64:67], v[12:15]
    s_waitcnt vmcnt(9) lgkmcnt(2)
    s_barrier
    v_add_f32 v36, v36, v132
    v_mfma_f32_16x16x32_bf16 v[8:11], a[48:51], v[72:75], v[8:11]
    ds_read_b128 v[56:59], v1 offset:16384
    v_add_f32 v37, v37, v133
    v_mfma_f32_16x16x32_bf16 v[16:19], a[48:51], v[76:79], v[16:19]
    v_mul_f32 v120, v36, v116
    v_mul_f32 v121, v37, v116
    v_mfma_f32_16x16x32_bf16 v[20:23], a[52:55], v[76:79], v[20:23]
    ds_read_b128 v[60:63], v1 offset:17408
    v_mul_f32 v120, v120, abs(v36)
    v_mfma_f32_16x16x32_bf16 v[12:15], a[52:55], v[72:75], v[12:15]
    s_waitcnt lgkmcnt(2)
    v_mul_f32 v121, v121, abs(v37)
    v_cvt_pk_bf16_f32 v34, v120, v121
    v_mfma_f32_16x16x32_bf16 v[8:11], a[56:59], v[80:83], v[8:11]
    ds_read_b128 v[64:67], v1 offset:18432
    v_pk_max_i16 v34, v34, 0
    v_mfma_f32_16x16x32_bf16 v[16:19], a[56:59], v[84:87], v[16:19]
    v_add_f32 v38, v38, v134
    v_add_f32 v39, v39, v135
    v_mfma_f32_16x16x32_bf16 v[20:23], a[60:63], v[84:87], v[20:23]
    ds_read_b128 v[68:71], v1 offset:19456
    v_mul_f32 v120, v38, v116
    v_mfma_f32_16x16x32_bf16 v[12:15], a[60:63], v[80:83], v[12:15]
    s_waitcnt lgkmcnt(2)
    v_mul_f32 v121, v39, v116
    v_mul_f32 v120, v120, abs(v38)
    v_mfma_f32_16x16x32_bf16 v[8:11], a[64:67], v[56:59], v[8:11]
    ds_read_b128 v[72:75], v1 offset:20480
    v_mul_f32 v121, v121, abs(v39)
    v_mfma_f32_16x16x32_bf16 v[16:19], a[64:67], v[60:63], v[16:19]
    v_cvt_pk_bf16_f32 v35, v120, v121
    v_pk_max_i16 v35, v35, 0
    v_mfma_f32_16x16x32_bf16 v[20:23], a[68:71], v[60:63], v[20:23]
    ds_read_b128 v[76:79], v1 offset:21504
    buffer_store_dwordx4 v[32:35], v1, s[16:19], s44 offen offset:0 sc1
    v_mfma_f32_16x16x32_bf16 v[12:15], a[68:71], v[56:59], v[12:15]
    s_waitcnt lgkmcnt(2)
    v_add_f32 v40, v40, v136
    v_add_f32 v41, v41, v137
    v_mfma_f32_16x16x32_bf16 v[8:11], a[72:75], v[64:67], v[8:11]
    ds_read_b128 v[80:83], v1 offset:22528
    v_mul_f32 v120, v40, v117
    v_mfma_f32_16x16x32_bf16 v[16:19], a[72:75], v[68:71], v[16:19]
    v_mul_f32 v121, v41, v117
    v_mul_f32 v120, v120, abs(v40)
    v_mfma_f32_16x16x32_bf16 v[20:23], a[76:79], v[68:71], v[20:23]
    ds_read_b128 v[84:87], v1 offset:23552
    v_mul_f32 v121, v121, abs(v41)
    v_mfma_f32_16x16x32_bf16 v[12:15], a[76:79], v[64:67], v[12:15]
    s_waitcnt lgkmcnt(2)
    v_cvt_pk_bf16_f32 v40, v120, v121
    v_pk_max_i16 v40, v40, 0
    v_mfma_f32_16x16x32_bf16 v[8:11], a[80:83], v[72:75], v[8:11]
    ds_read_b128 v[56:59], v1 offset:24576
    v_add_f32 v42, v42, v138
    v_mfma_f32_16x16x32_bf16 v[16:19], a[80:83], v[76:79], v[16:19]
    v_add_f32 v43, v43, v139
    v_mul_f32 v120, v42, v117
    v_mfma_f32_16x16x32_bf16 v[20:23], a[84:87], v[76:79], v[20:23]
    ds_read_b128 v[60:63], v1 offset:25600
    v_mul_f32 v121, v43, v117
    v_mfma_f32_16x16x32_bf16 v[12:15], a[84:87], v[72:75], v[12:15]
    s_waitcnt lgkmcnt(2)
    v_mul_f32 v120, v120, abs(v42)
    v_mul_f32 v121, v121, abs(v43)
    v_mfma_f32_16x16x32_bf16 v[8:11], a[88:91], v[80:83], v[8:11]
    ds_read_b128 v[64:67], v1 offset:26624
    v_cvt_pk_bf16_f32 v41, v120, v121
    v_mfma_f32_16x16x32_bf16 v[16:19], a[88:91], v[84:87], v[16:19]
    v_pk_max_i16 v41, v41, 0
    v_add_f32 v44, v44, v140
    v_mfma_f32_16x16x32_bf16 v[20:23], a[92:95], v[84:87], v[20:23]
    ds_read_b128 v[68:71], v1 offset:27648
    v_add_f32 v45, v45, v141
    v_mfma_f32_16x16x32_bf16 v[12:15], a[92:95], v[80:83], v[12:15]
    s_waitcnt lgkmcnt(2)
    v_mul_f32 v120, v44, v117
    v_mul_f32 v121, v45, v117
    v_mfma_f32_16x16x32_bf16 v[8:11], a[96:99], v[56:59], v[8:11]
    ds_read_b128 v[72:75], v1 offset:28672
    v_mul_f32 v120, v120, abs(v44)
    v_mfma_f32_16x16x32_bf16 v[16:19], a[96:99], v[60:63], v[16:19]
    v_mul_f32 v121, v121, abs(v45)
    v_cvt_pk_bf16_f32 v42, v120, v121
    v_mfma_f32_16x16x32_bf16 v[20:23], a[100:103], v[60:63], v[20:23]
    ds_read_b128 v[76:79], v1 offset:29696
    buffer_load_dword v7, v5, s[16:19], s45 offen sc1
    v_mfma_f32_16x16x32_bf16 v[12:15], a[100:103], v[56:59], v[12:15]
    s_waitcnt lgkmcnt(2)
    v_pk_max_i16 v42, v42, 0
    v_add_f32 v46, v46, v142
    v_mfma_f32_16x16x32_bf16 v[8:11], a[104:107], v[64:67], v[8:11]
    ds_read_b128 v[80:83], v1 offset:30720
    v_add_f32 v47, v47, v143
    v_mfma_f32_16x16x32_bf16 v[16:19], a[104:107], v[68:71], v[16:19]
    v_mul_f32 v120, v46, v117
    v_mul_f32 v121, v47, v117
    v_mfma_f32_16x16x32_bf16 v[20:23], a[108:111], v[68:71], v[20:23]
    ds_read_b128 v[84:87], v1 offset:31744
    v_mul_f32 v120, v120, abs(v46)
    v_mfma_f32_16x16x32_bf16 v[12:15], a[108:111], v[64:67], v[12:15]
    s_waitcnt vmcnt(6) lgkmcnt(2)
    s_barrier
    v_mul_f32 v121, v121, abs(v47)
    v_mfma_f32_16x16x32_bf16 v[8:11], a[112:115], v[72:75], v[8:11]
    ds_read_b128 v[56:59], v1 offset:32768
    v_cvt_pk_bf16_f32 v43, v120, v121
    v_mfma_f32_16x16x32_bf16 v[16:19], a[112:115], v[76:79], v[16:19]
    v_pk_max_i16 v43, v43, 0
    buffer_store_dwordx4 v[40:43], v1, s[16:19], s44 offen offset:1024 sc1
    v_mfma_f32_16x16x32_bf16 v[20:23], a[116:119], v[76:79], v[20:23]
    s_add_u32 m0, s43, 98304
    ds_read_b128 v[60:63], v1 offset:33792
    ds_read_b64 v[144:145], v118 offset:0
    v_mfma_f32_16x16x32_bf16 v[12:15], a[116:119], v[72:75], v[12:15]
    s_waitcnt lgkmcnt(3)
    ds_read_b64 v[146:147], v118 offset:128
    ds_read_b64 v[148:149], v118 offset:256
    v_mfma_f32_16x16x32_bf16 v[8:11], a[120:123], v[80:83], v[8:11]
    s_add_u32 s42, s41, 0
    ds_read_b128 v[64:67], v1 offset:34816
    ds_read_b64 v[150:151], v118 offset:384
    v_mfma_f32_16x16x32_bf16 v[16:19], a[120:123], v[84:87], v[16:19]
    v_mfma_f32_16x16x32_bf16 v[20:23], a[124:127], v[84:87], v[20:23]
    ds_read_b128 v[68:71], v1 offset:35840
    v_mfma_f32_16x16x32_bf16 v[12:15], a[124:127], v[80:83], v[12:15]
    s_waitcnt lgkmcnt(6)
    v_mfma_f32_16x16x32_bf16 v[8:11], a[128:131], v[56:59], v[8:11]
    ds_read_b128 v[72:75], v1 offset:36864
    v_mfma_f32_16x16x32_bf16 v[16:19], a[128:131], v[60:63], v[16:19]
    s_waitcnt lgkmcnt(2)
    v_max3_u32 v152, v144, v145, v146
    v_max3_u32 v153, v147, v148, v149
    v_mfma_f32_16x16x32_bf16 v[20:23], a[132:135], v[60:63], v[20:23]
    ds_read_b128 v[76:79], v1 offset:37888
    v_max3_u32 v152, v152, v150, v151
    v_mfma_f32_16x16x32_bf16 v[12:15], a[132:135], v[56:59], v[12:15]
    s_waitcnt lgkmcnt(2)
    v_max_u32 v152, v152, v153
    v_cmp_eq_u32 vcc, -1, v152
    v_mfma_f32_16x16x32_bf16 v[8:11], a[136:139], v[64:67], v[8:11]
    ds_read_b128 v[80:83], v1 offset:38912
    v_mfma_f32_16x16x32_bf16 v[16:19], a[136:139], v[68:71], v[16:19]
    s_cbranch_vccnz L_sspin46
L_sback47:
    v_add_f32 v152, v148, v150
    v_add_f32 v153, v149, v151
    v_mfma_f32_16x16x32_bf16 v[20:23], a[140:143], v[68:71], v[20:23]
    ds_read_b128 v[84:87], v1 offset:39936
    v_add_f32 v144, v144, v146
    v_mfma_f32_16x16x32_bf16 v[12:15], a[140:143], v[64:67], v[12:15]
    s_waitcnt lgkmcnt(2)
    v_add_f32 v145, v145, v147
    v_add_f32 v144, v144, v152
    v_mfma_f32_16x16x32_bf16 v[8:11], a[144:147], v[72:75], v[8:11]
    ds_read_b128 v[56:59], v1 offset:40960
    v_add_f32 v145, v145, v153
    v_mfma_f32_16x16x32_bf16 v[16:19], a[144:147], v[76:79], v[16:19]
    v_mov_b32 v152, v144
    v_mov_b32 v153, v145
    v_mfma_f32_16x16x32_bf16 v[20:23], a[148:151], v[76:79], v[20:23]
    ds_read_b128 v[60:63], v1 offset:41984
    v_permlane32_swap_b32 v144, v152
    v_mfma_f32_16x16x32_bf16 v[12:15], a[148:151], v[72:75], v[12:15]
    s_waitcnt lgkmcnt(2)
    v_permlane32_swap_b32 v145, v153
    v_mfma_f32_16x16x32_bf16 v[8:11], a[152:155], v[80:83], v[8:11]
    ds_read_b128 v[64:67], v1 offset:43008
    v_add_f32 v144, v144, v152
    v_mfma_f32_16x16x32_bf16 v[16:19], a[152:155], v[84:87], v[16:19]
    v_add_f32 v145, v145, v153
    v_mul_f32 v112, 0xba800000, v144
    v_mfma_f32_16x16x32_bf16 v[20:23], a[156:159], v[84:87], v[20:23]
    ds_read_b128 v[68:71], v1 offset:44032
    v_mul_f32 v145, 0x3a800000, v145
    v_mfma_f32_16x16x32_bf16 v[12:15], a[156:159], v[80:83], v[12:15]
    s_waitcnt lgkmcnt(2)
    v_fma_f32 v145, -v112, v112, v145
    v_mov_b32 v113, v112
    v_mfma_f32_16x16x32_bf16 v[8:11], a[160:163], v[56:59], v[8:11]
    ds_read_b128 v[72:75], v1 offset:45056
    v_max_f32 v145, 0, v145
    v_mfma_f32_16x16x32_bf16 v[16:19], a[160:163], v[60:63], v[16:19]
    v_add_f32 v145, 0x3727c5ac, v145
    v_rsq_f32 v116, v145
    v_mfma_f32_16x16x32_bf16 v[20:23], a[164:167], v[60:63], v[20:23]
    ds_read_b128 v[76:79], v1 offset:46080
    v_permlane16_swap_b32 v112, v113
    v_mfma_f32_16x16x32_bf16 v[12:15], a[164:167], v[56:59], v[12:15]
    s_waitcnt lgkmcnt(2)
    v_mul_f32 v114, v145, v116
    v_mul_f32 v116, v116, v116
    v_mfma_f32_16x16x32_bf16 v[8:11], a[168:171], v[64:67], v[8:11]
    s_waitcnt vmcnt(0)
    ds_read_b128 v[80:83], v1 offset:47104
    v_mov_b32 v115, v114
    v_mfma_f32_16x16x32_bf16 v[16:19], a[168:171], v[68:71], v[16:19]
    s_barrier
    buffer_store_dword v124, v124, s[16:19], s91 offen sc1
    v_mfma_f32_16x16x32_bf16 v[20:23], a[172:175], v[68:71], v[20:23]
    s_add_u32 s91, s91, 65536
    ds_read_b128 v[84:87], v1 offset:48128
    v_cmp_ne_u32 vcc, 0, v7
    v_mfma_f32_16x16x32_bf16 v[12:15], a[172:175], v[64:67], v[12:15]
    s_waitcnt lgkmcnt(2)
    v_mov_b32 v117, v116
    v_permlane16_swap_b32 v114, v115
    v_mfma_f32_16x16x32_bf16 v[8:11], a[176:179], v[72:75], v[8:11]
    s_cbranch_vccnz L_spin44
L_back45:
    ds_read_b128 v[56:59], v1 offset:49152
    v_permlane16_swap_b32 v116, v117
    v_mfma_f32_16x16x32_bf16 v[16:19], a[176:179], v[76:79], v[16:19]
    s_barrier
    buffer_load_dwordx4 v1, s[16:19], s42 offen offset:0 sc1 lds
    v_mfma_f32_16x16x32_bf16 v[20:23], a[180:183], v[76:79], v[20:23]
    s_add_u32 s46, s46, 2048
    ds_read_b128 v[60:63], v1 offset:50176
    buffer_load_dwordx4 v1, s[16:19], s42 offen offset:1024 sc1 lds
    v_mfma_f32_16x16x32_bf16 v[12:15], a[180:183], v[72:75], v[12:15]
    s_waitcnt lgkmcnt(2)
    buffer_load_dwordx4 v1, s[16:19], s42 offen offset:2048 sc1 lds
    v_mfma_f32_16x16x32_bf16 v[8:11], a[184:187], v[80:83], v[8:11]
    ds_read_b128 v[64:67], v1 offset:51200
    buffer_load_dwordx4 v1, s[16:19], s42 offen offset:3072 sc1 lds
    v_mfma_f32_16x16x32_bf16 v[16:19], a[184:187], v[84:87], v[16:19]
    s_add_u32 m0, s43, 114688
    v_mul_f32 v128, v112, v88
    v_fmac_f32 v128, v114, v100
    v_mfma_f32_16x16x32_bf16 v[20:23], a[188:191], v[84:87], v[20:23]
    s_add_u32 s42, s41, 16384
    ds_read_b128 v[68:71], v1 offset:52224
    v_mul_f32 v129, v112, v89
    v_mfma_f32_16x16x32_bf16 v[12:15], a[188:191], v[80:83], v[12:15]
    s_waitcnt lgkmcnt(2)
    v_fmac_f32 v129, v114, v101
    v_mul_f32 v130, v112, v90
    v_mfma_f32_16x16x32_bf16 v[8:11], a[192:195], v[56:59], v[8:11]
    ds_read_b128 v[72:75], v1 offset:53248
    buffer_load_dwordx4 v1, s[16:19], s42 offen offset:0 sc1 lds
    v_mfma_f32_16x16x32_bf16 v[16:19], a[192:195], v[60:63], v[16:19]
    v_fmac_f32 v130, v114, v102
    v_mul_f32 v131, v112, v91
    v_mfma_f32_16x16x32_bf16 v[20:23], a[196:199], v[60:63], v[20:23]
    ds_read_b128 v[76:79], v1 offset:54272
    v_fmac_f32 v131, v114, v103
    v_mfma_f32_16x16x32_bf16 v[12:15], a[196:199], v[56:59], v[12:15]
    s_waitcnt lgkmcnt(2)
    v_mul_f32 v132, v112, v92
    v_fmac_f32 v132, v114, v104
    v_mfma_f32_16x16x32_bf16 v[8:11], a[200:203], v[64:67], v[8:11]
    ds_read_b128 v[80:83], v1 offset:55296
    buffer_load_dwordx4 v1, s[16:19], s42 offen offset:1024 sc1 lds
    v_mfma_f32_16x16x32_bf16 v[16:19], a[200:203], v[68:71], v[16:19]
    v_mul_f32 v133, v112, v93
    v_fmac_f32 v133, v114, v105
    v_mfma_f32_16x16x32_bf16 v[20:23], a[204:207], v[68:71], v[20:23]
    ds_read_b128 v[84:87], v1 offset:56320
    v_mul_f32 v134, v112, v94
    v_mfma_f32_16x16x32_bf16 v[12:15], a[204:207], v[64:67], v[12:15]
    s_waitcnt lgkmcnt(2)
    v_fmac_f32 v134, v114, v106
    v_mul_f32 v135, v112, v95
    v_mfma_f32_16x16x32_bf16 v[8:11], a[208:211], v[72:75], v[8:11]
    ds_read_b128 v[56:59], v1 offset:57344
    buffer_load_dwordx4 v1, s[16:19], s42 offen offset:2048 sc1 lds
    v_mfma_f32_16x16x32_bf16 v[16:19], a[208:211], v[76:79], v[16:19]
    v_fmac_f32 v135, v114, v107
    v_mul_f32 v136, v113, v88
    v_mfma_f32_16x16x32_bf16 v[20:23], a[212:215], v[76:79], v[20:23]
    ds_read_b128 v[60:63], v1 offset:58368
    v_fmac_f32 v136, v115, v100
    v_mfma_f32_16x16x32_bf16 v[12:15], a[212:215], v[72:75], v[12:15]
    s_waitcnt lgkmcnt(2)
    v_mul_f32 v137, v113, v89
    v_fmac_f32 v137, v115, v101
    v_mfma_f32_16x16x32_bf16 v[8:11], a[216:219], v[80:83], v[8:11]
    ds_read_b128 v[64:67], v1 offset:59392
    buffer_load_dwordx4 v1, s[16:19], s42 offen offset:3072 sc1 lds
    v_mfma_f32_16x16x32_bf16 v[16:19], a[216:219], v[84:87], v[16:19]
    s_add_u32 s45, s45, 65536
    v_mul_f32 v138, v113, v90
    v_fmac_f32 v138, v115, v102
    v_mfma_f32_16x16x32_bf16 v[20:23], a[220:223], v[84:87], v[20:23]
    ds_read_b128 v[68:71], v1 offset:60416
    v_mul_f32 v139, v113, v91
    v_mfma_f32_16x16x32_bf16 v[12:15], a[220:223], v[80:83], v[12:15]
    s_waitcnt lgkmcnt(2)
    v_fmac_f32 v139, v115, v103
    v_mul_f32 v140, v113, v92
    v_mfma_f32_16x16x32_bf16 v[8:11], a[224:227], v[56:59], v[8:11]
    ds_read_b128 v[72:75], v1 offset:61440
    v_fmac_f32 v140, v115, v104
    v_mfma_f32_16x16x32_bf16 v[16:19], a[224:227], v[60:63], v[16:19]
    v_mul_f32 v141, v113, v93
    v_fmac_f32 v141, v115, v105
    v_mfma_f32_16x16x32_bf16 v[20:23], a[228:231], v[60:63], v[20:23]
    ds_read_b128 v[76:79], v1 offset:62464
    v_mul_f32 v142, v113, v94
    v_mfma_f32_16x16x32_bf16 v[12:15], a[228:231], v[56:59], v[12:15]
    s_waitcnt lgkmcnt(2)
    v_fmac_f32 v142, v115, v106
    v_mul_f32 v143, v113, v95
    v_mfma_f32_16x16x32_bf16 v[8:11], a[232:235], v[64:67], v[8:11]
    ds_read_b128 v[80:83], v1 offset:63488
    v_fmac_f32 v143, v115, v107
    v_mfma_f32_16x16x32_bf16 v[16:19], a[232:235], v[68:71], v[16:19]
    v_mfma_f32_16x16x32_bf16 v[20:23], a[236:239], v[68:71], v[20:23]
    ds_read_b128 v[84:87], v1 offset:64512
    v_mfma_f32_16x16x32_bf16 v[12:15], a[236:239], v[64:67], v[12:15]
    s_waitcnt vmcnt(4) lgkmcnt(2)
    s_barrier
    v_mfma_f32_16x16x32_bf16 v[8:11], a[240:243], v[72:75], v[8:11]
    ds_read_b128 v[56:59], v2 offset:0
    v_mfma_f32_16x16x32_bf16 v[16:19], a[240:243], v[76:79], v[16:19]
    v_mfma_f32_16x16x32_bf16 v[20:23], a[244:247], v[76:79], v[20:23]
    ds_read_b128 v[60:63], v2 offset:1024
    v_mfma_f32_16x16x32_bf16 v[12:15], a[244:247], v[72:75], v[12:15]
    s_waitcnt lgkmcnt(2)
    v_mfma_f32_16x16x32_bf16 v[8:11], a[248:251], v[80:83], v[8:11]
    ds_read_b128 v[64:67], v2 offset:2048
    v_mfma_f32_16x16x32_bf16 v[16:19], a[248:251], v[84:87], v[16:19]
    v_mfma_f32_16x16x32_bf16 v[20:23], a[252:255], v[84:87], v[20:23]
    ds_read_b128 v[68:71], v2 offset:3072
    v_mfma_f32_16x16x32_bf16 v[12:15], a[252:255], v[80:83], v[12:15]
    s_add_u32 s36, s36, 1
L_l_b1:
    s_waitcnt lgkmcnt(2)
    v_mfma_f32_16x16x32_bf16 v[32:35], a[0:3], v[56:59], 0
    s_add_u32 m0, s52, 73728
    ds_read_b128 v[72:75], v2 offset:4096
    s_add_u32 s42, s46, s52
    v_mfma_f32_16x16x32_bf16 v[40:43], a[0:3], v[60:63], 0
    buffer_load_dwordx4 v1, s[16:19], s42 offen sc1 lds
    v_mfma_f32_16x16x32_bf16 v[44:47], a[4:7], v[60:63], 0
    s_add_u32 m0, s43, 131072
    ds_read_b128 v[76:79], v2 offset:5120
    s_add_u32 s42, s41, 32768
    v_mfma_f32_16x16x32_bf16 v[36:39], a[4:7], v[56:59], 0
    s_waitcnt lgkmcnt(2)
    buffer_load_dwordx4 v1, s[16:19], s42 offen offset:0 sc1 lds
    v_mfma_f32_16x16x32_bf16 v[32:35], a[8:11], v[64:67], v[32:35]
    s_and_b32 s44, s90, 0xffffffff
    ds_read_b128 v[80:83], v2 offset:6144
    s_cmp_lt_i32 s36, 1
    v_mfma_f32_16x16x32_bf16 v[40:43], a[8:11], v[68:71], v[40:43]
    buffer_load_dwordx4 v1, s[16:19], s42 offen offset:1024 sc1 lds
    v_mfma_f32_16x16x32_bf16 v[44:47], a[12:15], v[68:71], v[44:47]
    s_cselect_b32 s44, 0x5e00000, s44
    ds_read_b128 v[84:87], v2 offset:7168
    s_add_u32 s90, s90, 262144
    v_mfma_f32_16x16x32_bf16 v[36:39], a[12:15], v[64:67], v[36:39]
    s_waitcnt lgkmcnt(2)
    buffer_load_dwordx4 v1, s[16:19], s42 offen offset:2048 sc1 lds
    v_mfma_f32_16x16x32_bf16 v[32:35], a[16:19], v[72:75], v[32:35]
    ds_read_b128 v[56:59], v2 offset:8192
    v_add_f32 v8, v8, v128
    v_mfma_f32_16x16x32_bf16 v[40:43], a[16:19], v[76:79], v[40:43]
    buffer_load_dwordx4 v1, s[16:19], s42 offen offset:3072 sc1 lds
    v_mfma_f32_16x16x32_bf16 v[44:47], a[20:23], v[76:79], v[44:47]
    s_add_u32 m0, s43, 147456
    ds_read_b128 v[60:63], v2 offset:9216
    v_add_f32 v9, v9, v129
    v_mfma_f32_16x16x32_bf16 v[36:39], a[20:23], v[72:75], v[36:39]
    s_waitcnt lgkmcnt(2)
    v_mul_f32 v120, v8, v116
    v_mul_f32 v121, v9, v116
    v_mfma_f32_16x16x32_bf16 v[32:35], a[24:27], v[80:83], v[32:35]
    s_add_u32 s42, s41, 49152
    ds_read_b128 v[64:67], v2 offset:10240
    buffer_load_dwordx4 v1, s[16:19], s42 offen offset:0 sc1 lds
    v_mfma_f32_16x16x32_bf16 v[40:43], a[24:27], v[84:87], v[40:43]
    v_mul_f32 v120, v120, abs(v8)
    v_mul_f32 v121, v121, abs(v9)
    v_mfma_f32_16x16x32_bf16 v[44:47], a[28:31], v[84:87], v[44:47]
    ds_read_b128 v[68:71], v2 offset:11264
    buffer_load_dwordx4 v1, s[16:19], s42 offen offset:1024 sc1 lds
    v_mfma_f32_16x16x32_bf16 v[36:39], a[28:31], v[80:83], v[36:39]
    s_waitcnt lgkmcnt(2)
    v_cvt_pk_bf16_f32 v8, v120, v121
    v_pk_max_i16 v8, v8, 0
    v_mfma_f32_16x16x32_bf16 v[32:35], a[32:35], v[56:59], v[32:35]
    ds_read_b128 v[72:75], v2 offset:12288
    buffer_load_dwordx4 v1, s[16:19], s42 offen offset:2048 sc1 lds
    v_mfma_f32_16x16x32_bf16 v[40:43], a[32:35], v[60:63], v[40:43]
    v_add_f32 v10, v10, v130
    v_add_f32 v11, v11, v131
    v_mfma_f32_16x16x32_bf16 v[44:47], a[36:39], v[60:63], v[44:47]
    ds_read_b128 v[76:79], v2 offset:13312
    buffer_load_dwordx4 v1, s[16:19], s42 offen offset:3072 sc1 lds
    v_mfma_f32_16x16x32_bf16 v[36:39], a[36:39], v[56:59], v[36:39]
    s_waitcnt lgkmcnt(2)
    v_mul_f32 v120, v10, v116
    v_mul_f32 v121, v11, v116
    v_mfma_f32_16x16x32_bf16 v[32:35], a[40:43], v[64:67], v[32:35]
    s_add_u32 s98, s98, 65536
    ds_read_b128 v[80:83], v2 offset:14336
    v_mul_f32 v120, v120, abs(v10)
    v_mfma_f32_16x16x32_bf16 v[40:43], a[40:43], v[68:71], v[40:43]
    s_min_i32 s98, s98, s96
    v_mul_f32 v121, v121, abs(v11)
    v_cvt_pk_bf16_f32 v9, v120, v121
    v_mfma_f32_16x16x32_bf16 v[44:47], a[44:47], v[68:71], v[44:47]
    s_and_b32 s41, s98, 0xffffffff
    ds_read_b128 v[84:87], v2 offset:15360
    v_pk_max_i16 v9, v9, 0
    v_mfma_f32_16x16x32_bf16 v[36:39], a[44:47], v[64:67], v[36:39]
    s_waitcnt vmcnt(9) lgkmcnt(2)
    s_barrier
    v_add_f32 v12, v12, v132
    v_mfma_f32_16x16x32_bf16 v[32:35], a[48:51], v[72:75], v[32:35]
    ds_read_b128 v[56:59], v2 offset:16384
    v_add_f32 v13, v13, v133
    v_mfma_f32_16x16x32_bf16 v[40:43], a[48:51], v[76:79], v[40:43]
    v_mul_f32 v120, v12, v116
    v_mul_f32 v121, v13, v116
    v_mfma_f32_16x16x32_bf16 v[44:47], a[52:55], v[76:79], v[44:47]
    ds_read_b128 v[60:63], v2 offset:17408
    v_mul_f32 v120, v120, abs(v12)
    v_mfma_f32_16x16x32_bf16 v[36:39], a[52:55], v[72:75], v[36:39]
    s_waitcnt lgkmcnt(2)
    v_mul_f32 v121, v121, abs(v13)
    v_cvt_pk_bf16_f32 v10, v120, v121
    v_mfma_f32_16x16x32_bf16 v[32:35], a[56:59], v[80:83], v[32:35]
    ds_read_b128 v[64:67], v2 offset:18432
    v_pk_max_i16 v10, v10, 0
    v_mfma_f32_16x16x32_bf16 v[40:43], a[56:59], v[84:87], v[40:43]
    v_add_f32 v14, v14, v134
    v_add_f32 v15, v15, v135
    v_mfma_f32_16x16x32_bf16 v[44:47], a[60:63], v[84:87], v[44:47]
    ds_read_b128 v[68:71], v2 offset:19456
    v_mul_f32 v120, v14, v116
    v_mfma_f32_16x16x32_bf16 v[36:39], a[60:63], v[80:83], v[36:39]
    s_waitcnt lgkmcnt(2)
    v_mul_f32 v121, v15, v116
    v_mul_f32 v120, v120, abs(v14)
    v_mfma_f32_16x16x32_bf16 v[32:35], a[64:67], v[56:59], v[32:35]
    ds_read_b128 v[72:75], v2 offset:20480
    v_mul_f32 v121, v121, abs(v15)
    v_mfma_f32_16x16x32_bf16 v[40:43], a[64:67], v[60:63], v[40:43]
    v_cvt_pk_bf16_f32 v11, v120, v121
    v_pk_max_i16 v11, v11, 0
    v_mfma_f32_16x16x32_bf16 v[44:47], a[68:71], v[60:63], v[44:47]
    ds_read_b128 v[76:79], v2 offset:21504
    buffer_store_dwordx4 v[8:11], v1, s[16:19], s44 offen offset:0 sc1
    v_mfma_f32_16x16x32_bf16 v[36:39], a[68:71], v[56:59], v[36:39]
    s_waitcnt lgkmcnt(2)
    v_add_f32 v16, v16, v136
    v_add_f32 v17, v17, v137
    v_mfma_f32_16x16x32_bf16 v[32:35], a[72:75], v[64:67], v[32:35]
    ds_read_b128 v[80:83], v2 offset:22528
    v_mul_f32 v120, v16, v117
    v_mfma_f32_16x16x32_bf16 v[40:43], a[72:75], v[68:71], v[40:43]
    v_mul_f32 v121, v17, v117
    v_mul_f32 v120, v120, abs(v16)
    v_mfma_f32_16x16x32_bf16 v[44:47], a[76:79], v[68:71], v[44:47]
    ds_read_b128 v[84:87], v2 offset:23552
    v_mul_f32 v121, v121, abs(v17)
    v_mfma_f32_16x16x32_bf16 v[36:39], a[76:79], v[64:67], v[36:39]
    s_waitcnt lgkmcnt(2)
    v_cvt_pk_bf16_f32 v16, v120, v121
    v_pk_max_i16 v16, v16, 0
    v_mfma_f32_16x16x32_bf16 v[32:35], a[80:83], v[72:75], v[32:35]
    ds_read_b128 v[56:59], v2 offset:24576
    v_add_f32 v18, v18, v138
    v_mfma_f32_16x16x32_bf16 v[40:43], a[80:83], v[76:79], v[40:43]
    v_add_f32 v19, v19, v139
    v_mul_f32 v120, v18, v117
    v_mfma_f32_16x16x32_bf16 v[44:47], a[84:87], v[76:79], v[44:47]
    ds_read_b128 v[60:63], v2 offset:25600
    v_mul_f32 v121, v19, v117
    v_mfma_f32_16x16x32_bf16 v[36:39], a[84:87], v[72:75], v[36:39]
    s_waitcnt lgkmcnt(2)
    v_mul_f32 v120, v120, abs(v18)
    v_mul_f32 v121, v121, abs(v19)
    v_mfma_f32_16x16x32_bf16 v[32:35], a[88:91], v[80:83], v[32:35]
    ds_read_b128 v[64:67], v2 offset:26624
    v_cvt_pk_bf16_f32 v17, v120, v121
    v_mfma_f32_16x16x32_bf16 v[40:43], a[88:91], v[84:87], v[40:43]
    v_pk_max_i16 v17, v17, 0
    v_add_f32 v20, v20, v140
    v_mfma_f32_16x16x32_bf16 v[44:47], a[92:95], v[84:87], v[44:47]
    ds_read_b128 v[68:71], v2 offset:27648
    v_add_f32 v21, v21, v141
    v_mfma_f32_16x16x32_bf16 v[36:39], a[92:95], v[80:83], v[36:39]
    s_waitcnt lgkmcnt(2)
    v_mul_f32 v120, v20, v117
    v_mul_f32 v121, v21, v117
    v_mfma_f32_16x16x32_bf16 v[32:35], a[96:99], v[56:59], v[32:35]
    ds_read_b128 v[72:75], v2 offset:28672
    v_mul_f32 v120, v120, abs(v20)
    v_mfma_f32_16x16x32_bf16 v[40:43], a[96:99], v[60:63], v[40:43]
    v_mul_f32 v121, v121, abs(v21)
    v_cvt_pk_bf16_f32 v18, v120, v121
    v_mfma_f32_16x16x32_bf16 v[44:47], a[100:103], v[60:63], v[44:47]
    ds_read_b128 v[76:79], v2 offset:29696
    buffer_load_dword v7, v5, s[16:19], s45 offen sc1
    v_mfma_f32_16x16x32_bf16 v[36:39], a[100:103], v[56:59], v[36:39]
    s_waitcnt lgkmcnt(2)
    v_pk_max_i16 v18, v18, 0
    v_add_f32 v22, v22, v142
    v_mfma_f32_16x16x32_bf16 v[32:35], a[104:107], v[64:67], v[32:35]
    ds_read_b128 v[80:83], v2 offset:30720
    v_add_f32 v23, v23, v143
    v_mfma_f32_16x16x32_bf16 v[40:43], a[104:107], v[68:71], v[40:43]
    v_mul_f32 v120, v22, v117
    v_mul_f32 v121, v23, v117
    v_mfma_f32_16x16x32_bf16 v[44:47], a[108:111], v[68:71], v[44:47]
    ds_read_b128 v[84:87], v2 offset:31744
    v_mul_f32 v120, v120, abs(v22)
    v_mfma_f32_16x16x32_bf16 v[36:39], a[108:111], v[64:67], v[36:39]
    s_waitcnt vmcnt(6) lgkmcnt(2)
    s_barrier
    v_mul_f32 v121, v121, abs(v23)
    v_mfma_f32_16x16x32_bf16 v[32:35], a[112:115], v[72:75], v[32:35]
    ds_read_b128 v[56:59], v2 offset:32768
    v_cvt_pk_bf16_f32 v19, v120, v121
    v_mfma_f32_16x16x32_bf16 v[40:43], a[112:115], v[76:79], v[40:43]
    v_pk_max_i16 v19, v19, 0
    buffer_store_dwordx4 v[16:19], v1, s[16:19], s44 offen offset:1024 sc1
    v_mfma_f32_16x16x32_bf16 v[44:47], a[116:119], v[76:79], v[44:47]
    s_add_u32 m0, s43, 0
    ds_read_b128 v[60:63], v2 offset:33792
    ds_read_b64 v[144:145], v118 offset:0
    v_mfma_f32_16x16x32_bf16 v[36:39], a[116:119], v[72:75], v[36:39]
    s_waitcnt lgkmcnt(3)
    ds_read_b64 v[146:147], v118 offset:128
    ds_read_b64 v[148:149], v118 offset:256
    v_mfma_f32_16x16x32_bf16 v[32:35], a[120:123], v[80:83], v[32:35]
    s_add_u32 s42, s41, 0
    ds_read_b128 v[64:67], v2 offset:34816
    ds_read_b64 v[150:151], v118 offset:384
    v_mfma_f32_16x16x32_bf16 v[40:43], a[120:123], v[84:87], v[40:43]
    v_mfma_f32_16x16x32_bf16 v[44:47], a[124:127], v[84:87], v[44:47]
    ds_read_b128 v[68:71], v2 offset:35840
    v_mfma_f32_16x16x32_bf16 v[36:39], a[124:127], v[80:83], v[36:39]
    s_waitcnt lgkmcnt(6)
    v_mfma_f32_16x16x32_bf16 v[32:35], a[128:131], v[56:59], v[32:35]
    ds_read_b128 v[72:75], v2 offset:36864
    v_mfma_f32_16x16x32_bf16 v[40:43], a[128:131], v[60:63], v[40:43]
    s_waitcnt lgkmcnt(2)
    v_max3_u32 v152, v144, v145, v146
    v_max3_u32 v153, v147, v148, v149
    v_mfma_f32_16x16x32_bf16 v[44:47], a[132:135], v[60:63], v[44:47]
    ds_read_b128 v[76:79], v2 offset:37888
    v_max3_u32 v152, v152, v150, v151
    v_mfma_f32_16x16x32_bf16 v[36:39], a[132:135], v[56:59], v[36:39]
    s_waitcnt lgkmcnt(2)
    v_max_u32 v152, v152, v153
    v_cmp_eq_u32 vcc, -1, v152
    v_mfma_f32_16x16x32_bf16 v[32:35], a[136:139], v[64:67], v[32:35]
    ds_read_b128 v[80:83], v2 offset:38912
    v_mfma_f32_16x16x32_bf16 v[40:43], a[136:139], v[68:71], v[40:43]
    s_cbranch_vccnz L_sspin50
L_sback51:
    v_add_f32 v152, v148, v150
    v_add_f32 v153, v149, v151
    v_mfma_f32_16x16x32_bf16 v[44:47], a[140:143], v[68:71], v[44:47]
    ds_read_b128 v[84:87], v2 offset:39936
    v_add_f32 v144, v144, v146
    v_mfma_f32_16x16x32_bf16 v[36:39], a[140:143], v[64:67], v[36:39]
    s_waitcnt lgkmcnt(2)
    v_add_f32 v145, v145, v147
    v_add_f32 v144, v144, v152
    v_mfma_f32_16x16x32_bf16 v[32:35], a[144:147], v[72:75], v[32:35]
    ds_read_b128 v[56:59], v2 offset:40960
    v_add_f32 v145, v145, v153
    v_mfma_f32_16x16x32_bf16 v[40:43], a[144:147], v[76:79], v[40:43]
    v_mov_b32 v152, v144
    v_mov_b32 v153, v145
    v_mfma_f32_16x16x32_bf16 v[44:47], a[148:151], v[76:79], v[44:47]
    ds_read_b128 v[60:63], v2 offset:41984
    v_permlane32_swap_b32 v144, v152
    v_mfma_f32_16x16x32_bf16 v[36:39], a[148:151], v[72:75], v[36:39]
    s_waitcnt lgkmcnt(2)
    v_permlane32_swap_b32 v145, v153
    v_mfma_f32_16x16x32_bf16 v[32:35], a[152:155], v[80:83], v[32:35]
    ds_read_b128 v[64:67], v2 offset:43008
    v_add_f32 v144, v144, v152
    v_mfma_f32_16x16x32_bf16 v[40:43], a[152:155], v[84:87], v[40:43]
    v_add_f32 v145, v145, v153
    v_mul_f32 v112, 0xba800000, v144
    v_mfma_f32_16x16x32_bf16 v[44:47], a[156:159], v[84:87], v[44:47]
    ds_read_b128 v[68:71], v2 offset:44032
    v_mul_f32 v145, 0x3a800000, v145
    v_mfma_f32_16x16x32_bf16 v[36:39], a[156:159], v[80:83], v[36:39]
    s_waitcnt lgkmcnt(2)
    v_fma_f32 v145, -v112, v112, v145
    v_mov_b32 v113, v112
    v_mfma_f32_16x16x32_bf16 v[32:35], a[160:163], v[56:59], v[32:35]
    ds_read_b128 v[72:75], v2 offset:45056
    v_max_f32 v145, 0, v145
    v_mfma_f32_16x16x32_bf16 v[40:43], a[160:163], v[60:63], v[40:43]
    v_add_f32 v145, 0x3727c5ac, v145
    v_rsq_f32 v116, v145
    v_mfma_f32_16x16x32_bf16 v[44:47], a[164:167], v[60:63], v[44:47]
    ds_read_b128 v[76:79], v2 offset:46080
    v_permlane16_swap_b32 v112, v113
    v_mfma_f32_16x16x32_bf16 v[36:39], a[164:167], v[56:59], v[36:39]
    s_waitcnt lgkmcnt(2)
    v_mul_f32 v114, v145, v116
    v_mul_f32 v116, v116, v116
    v_mfma_f32_16x16x32_bf16 v[32:35], a[168:171], v[64:67], v[32:35]
    s_waitcnt vmcnt(0)
    ds_read_b128 v[80:83], v2 offset:47104
    v_mov_b32 v115, v114
    v_mfma_f32_16x16x32_bf16 v[40:43], a[168:171], v[68:71], v[40:43]
    s_barrier
    buffer_store_dword v124, v124, s[16:19], s91 offen sc1
    v_mfma_f32_16x16x32_bf16 v[44:47], a[172:175], v[68:71], v[44:47]
    s_add_u32 s91, s91, 65536
    ds_read_b128 v[84:87], v2 offset:48128
    v_cmp_ne_u32 vcc, 0, v7
    v_mfma_f32_16x16x32_bf16 v[36:39], a[172:175], v[64:67], v[36:39]
    s_waitcnt lgkmcnt(2)
    v_mov_b32 v117, v116
    v_permlane16_swap_b32 v114, v115
    v_mfma_f32_16x16x32_bf16 v[32:35], a[176:179], v[72:75], v[32:35]
    s_cbranch_vccnz L_spin48
L_back49:
    ds_read_b128 v[56:59], v2 offset:49152
    v_permlane16_swap_b32 v116, v117
    v_mfma_f32_16x16x32_bf16 v[40:43], a[176:179], v[76:79], v[40:43]
    s_barrier
    buffer_load_dwordx4 v1, s[16:19], s42 offen offset:0 sc1 lds
    v_mfma_f32_16x16x32_bf16 v[44:47], a[180:183], v[76:79], v[44:47]
    s_add_u32 s46, s46, 2048
    ds_read_b128 v[60:63], v2 offset:50176
    buffer_load_dwordx4 v1, s[16:19], s42 offen offset:1024 sc1 lds
    v_mfma_f32_16x16x32_bf16 v[36:39], a[180:183], v[72:75], v[36:39]
    s_waitcnt lgkmcnt(2)
    buffer_load_dwordx4 v1, s[16:19], s42 offen offset:2048 sc1 lds
    v_mfma_f32_16x16x32_bf16 v[32:35], a[184:187], v[80:83], v[32:35]
    ds_read_b128 v[64:67], v2 offset:51200
    buffer_load_dwordx4 v1, s[16:19], s42 offen offset:3072 sc1 lds
    v_mfma_f32_16x16x32_bf16 v[40:43], a[184:187], v[84:87], v[40:43]
    s_add_u32 m0, s43, 16384
    v_mul_f32 v128, v112, v88
    v_fmac_f32 v128, v114, v100
    v_mfma_f32_16x16x32_bf16 v[44:47], a[188:191], v[84:87], v[44:47]
    s_add_u32 s42, s41, 16384
    ds_read_b128 v[68:71], v2 offset:52224
    v_mul_f32 v129, v112, v89
    v_mfma_f32_16x16x32_bf16 v[36:39], a[188:191], v[80:83], v[36:39]
    s_waitcnt lgkmcnt(2)
    v_fmac_f32 v129, v114, v101
    v_mul_f32 v130, v112, v90
    v_mfma_f32_16x16x32_bf16 v[32:35], a[192:195], v[56:59], v[32:35]
    ds_read_b128 v[72:75], v2 offset:53248
    buffer_load_dwordx4 v1, s[16:19], s42 offen offset:0 sc1 lds
    v_mfma_f32_16x16x32_bf16 v[40:43], a[192:195], v[60:63], v[40:43]
    v_fmac_f32 v130, v114, v102
    v_mul_f32 v131, v112, v91
    v_mfma_f32_16x16x32_bf16 v[44:47], a[196:199], v[60:63], v[44:47]
    ds_read_b128 v[76:79], v2 offset:54272
    v_fmac_f32 v131, v114, v103
    v_mfma_f32_16x16x32_bf16 v[36:39], a[196:199], v[56:59], v[36:39]
    s_waitcnt lgkmcnt(2)
    v_mul_f32 v132, v112, v92
    v_fmac_f32 v132, v114, v104
    v_mfma_f32_16x16x32_bf16 v[32:35], a[200:203], v[64:67], v[32:35]
    ds_read_b128 v[80:83], v2 offset:55296
    buffer_load_dwordx4 v1, s[16:19], s42 offen offset:1024 sc1 lds
    v_mfma_f32_16x16x32_bf16 v[40:43], a[200:203], v[68:71], v[40:43]
    v_mul_f32 v133, v112, v93
    v_fmac_f32 v133, v114, v105
    v_mfma_f32_16x16x32_bf16 v[44:47], a[204:207], v[68:71], v[44:47]
    ds_read_b128 v[84:87], v2 offset:56320
    v_mul_f32 v134, v112, v94
    v_mfma_f32_16x16x32_bf16 v[36:39], a[204:207], v[64:67], v[36:39]
    s_waitcnt lgkmcnt(2)
    v_fmac_f32 v134, v114, v106
    v_mul_f32 v135, v112, v95
    v_mfma_f32_16x16x32_bf16 v[32:35], a[208:211], v[72:75], v[32:35]
    ds_read_b128 v[56:59], v2 offset:57344
    buffer_load_dwordx4 v1, s[16:19], s42 offen offset:2048 sc1 lds
    v_mfma_f32_16x16x32_bf16 v[40:43], a[208:211], v[76:79], v[40:43]
    v_fmac_f32 v135, v114, v107
    v_mul_f32 v136, v113, v88
    v_mfma_f32_16x16x32_bf16 v[44:47], a[212:215], v[76:79], v[44:47]
    ds_read_b128 v[60:63], v2 offset:58368
    v_fmac_f32 v136, v115, v100
    v_mfma_f32_16x16x32_bf16 v[36:39], a[212:215], v[72:75], v[36:39]
    s_waitcnt lgkmcnt(2)
    v_mul_f32 v137, v113, v89
    v_fmac_f32 v137, v115, v101
    v_mfma_f32_16x16x32_bf16 v[32:35], a[216:219], v[80:83], v[32:35]
    ds_read_b128 v[64:67], v2 offset:59392
    buffer_load_dwordx4 v1, s[16:19], s42 offen offset:3072 sc1 lds
    v_mfma_f32_16x16x32_bf16 v[40:43], a[216:219], v[84:87], v[40:43]
    s_add_u32 s45, s45, 65536
    v_mul_f32 v138, v113, v90
    v_fmac_f32 v138, v115, v102
    v_mfma_f32_16x16x32_bf16 v[44:47], a[220:223], v[84:87], v[44:47]
    ds_read_b128 v[68:71], v2 offset:60416
    v_mul_f32 v139, v113, v91
    v_mfma_f32_16x16x32_bf16 v[36:39], a[220:223], v[80:83], v[36:39]
    s_waitcnt lgkmcnt(2)
    v_fmac_f32 v139, v115, v103
    v_mul_f32 v140, v113, v92
    v_mfma_f32_16x16x32_bf16 v[32:35], a[224:227], v[56:59], v[32:35]
    ds_read_b128 v[72:75], v2 offset:61440
    v_fmac_f32 v140, v115, v104
    v_mfma_f32_16x16x32_bf16 v[40:43], a[224:227], v[60:63], v[40:43]
    v_mul_f32 v141, v113, v93
    v_fmac_f32 v141, v115, v105
    v_mfma_f32_16x16x32_bf16 v[44:47], a[228:231], v[60:63], v[44:47]
    ds_read_b128 v[76:79], v2 offset:62464
    v_mul_f32 v142, v113, v94
    v_mfma_f32_16x16x32_bf16 v[36:39], a[228:231], v[56:59], v[36:39]
    s_waitcnt lgkmcnt(2)
    v_fmac_f32 v142, v115, v106
    v_mul_f32 v143, v113, v95
    v_mfma_f32_16x16x32_bf16 v[32:35], a[232:235], v[64:67], v[32:35]
    ds_read_b128 v[80:83], v2 offset:63488
    v_fmac_f32 v143, v115, v107
    v_mfma_f32_16x16x32_bf16 v[40:43], a[232:235], v[68:71], v[40:43]
    v_mfma_f32_16x16x32_bf16 v[44:47], a[236:239], v[68:71], v[44:47]
    ds_read_b128 v[84:87], v2 offset:64512
    v_mfma_f32_16x16x32_bf16 v[36:39], a[236:239], v[64:67], v[36:39]
    s_waitcnt vmcnt(4) lgkmcnt(2)
    s_barrier
    v_mfma_f32_16x16x32_bf16 v[32:35], a[240:243], v[72:75], v[32:35]
    ds_read_b128 v[56:59], v1 offset:0
    v_mfma_f32_16x16x32_bf16 v[40:43], a[240:243], v[76:79], v[40:43]
    v_mfma_f32_16x16x32_bf16 v[44:47], a[244:247], v[76:79], v[44:47]
    ds_read_b128 v[60:63], v1 offset:1024
    v_mfma_f32_16x16x32_bf16 v[36:39], a[244:247], v[72:75], v[36:39]
    s_waitcnt lgkmcnt(2)
    v_mfma_f32_16x16x32_bf16 v[32:35], a[248:251], v[80:83], v[32:35]
    ds_read_b128 v[64:67], v1 offset:2048
    v_mfma_f32_16x16x32_bf16 v[40:43], a[248:251], v[84:87], v[40:43]
    v_mfma_f32_16x16x32_bf16 v[44:47], a[252:255], v[84:87], v[44:47]
    ds_read_b128 v[68:71], v1 offset:3072
    v_mfma_f32_16x16x32_bf16 v[36:39], a[252:255], v[80:83], v[36:39]
    s_add_u32 s36, s36, 1
    s_cmp_lt_u32 s36, 32
    s_cbranch_scc1 L_l_b0
    s_nop 7
    s_and_b32 s44, s90, 0xffffffff
    s_cmp_lt_i32 s36, 1
    s_cselect_b32 s44, 0x5e00000, s44
    s_add_u32 s90, s90, 262144
    v_add_f32 v32, v32, v128
    v_add_f32 v33, v33, v129
    v_mul_f32 v120, v32, v116
    v_mul_f32 v121, v33, v116
    v_mul_f32 v120, v120, abs(v32)
    v_mul_f32 v121, v121, abs(v33)
    v_cvt_pk_bf16_f32 v32, v120, v121
    v_pk_max_i16 v32, v32, 0
    v_add_f32 v34, v34, v130
    v_add_f32 v35, v35, v131
    v_mul_f32 v120, v34, v116
    v_mul_f32 v121, v35, v116
    v_mul_f32 v120, v120, abs(v34)
    v_mul_f32 v121, v121, abs(v35)
    v_cvt_pk_bf16_f32 v33, v120, v121
    v_pk_max_i16 v33, v33, 0
    v_add_f32 v36, v36, v132
    v_add_f32 v37, v37, v133
    v_mul_f32 v120, v36, v116
    v_mul_f32 v121, v37, v116
    v_mul_f32 v120, v120, abs(v36)
    v_mul_f32 v121, v121, abs(v37)
    v_cvt_pk_bf16_f32 v34, v120, v121
    v_pk_max_i16 v34, v34, 0
    v_add_f32 v38, v38, v134
    v_add_f32 v39, v39, v135
    v_mul_f32 v120, v38, v116
    v_mul_f32 v121, v39, v116
    v_mul_f32 v120, v120, abs(v38)
    v_mul_f32 v121, v121, abs(v39)
    v_cvt_pk_bf16_f32 v35, v120, v121
    v_pk_max_i16 v35, v35, 0
    buffer_store_dwordx4 v[32:35], v1, s[16:19], s44 offen offset:0 sc1
    v_add_f32 v40, v40, v136
    v_add_f32 v41, v41, v137
    v_mul_f32 v120, v40, v117
    v_mul_f32 v121, v41, v117
    v_mul_f32 v120, v120, abs(v40)
    v_mul_f32 v121, v121, abs(v41)
    v_cvt_pk_bf16_f32 v40, v120, v121
    v_pk_max_i16 v40, v40, 0
    v_add_f32 v42, v42, v138
    v_add_f32 v43, v43, v139
    v_mul_f32 v120, v42, v117
    v_mul_f32 v121, v43, v117
    v_mul_f32 v120, v120, abs(v42)
    v_mul_f32 v121, v121, abs(v43)
    v_cvt_pk_bf16_f32 v41, v120, v121
    v_pk_max_i16 v41, v41, 0
    v_add_f32 v44, v44, v140
    v_add_f32 v45, v45, v141
    v_mul_f32 v120, v44, v117
    v_mul_f32 v121, v45, v117
    v_mul_f32 v120, v120, abs(v44)
    v_mul_f32 v121, v121, abs(v45)
    v_cvt_pk_bf16_f32 v42, v120, v121
    v_pk_max_i16 v42, v42, 0
    v_add_f32 v46, v46, v142
    v_add_f32 v47, v47, v143
    v_mul_f32 v120, v46, v117
    v_mul_f32 v121, v47, v117
    v_mul_f32 v120, v120, abs(v46)
    v_mul_f32 v121, v121, abs(v47)
    v_cvt_pk_bf16_f32 v43, v120, v121
    v_pk_max_i16 v43, v43, 0
    buffer_store_dwordx4 v[40:43], v1, s[16:19], s44 offen offset:1024 sc1
    s_waitcnt vmcnt(0)
    s_barrier
    buffer_store_dword v124, v124, s[16:19], s91 offen sc1
    s_add_u32 s91, s91, 65536
    s_waitcnt vmcnt(0)
    s_endpgm
L_spin40:
    s_mov_b32 s40, 0x20000
L_spin40_l:
    buffer_load_dword v69, v68, s[20:23], 0 offen sc1
    s_sub_u32 s40, s40, 1
    s_waitcnt vmcnt(0)
    v_cmp_eq_u32 vcc, v68, v69
    s_cbranch_scc1 L_back41
    s_cbranch_vccz L_back41
    s_sleep 8
    s_branch L_spin40_l
L_spin42:
    s_mov_b32 s40, 0x20000
L_spin42_l:
    buffer_load_dword v7, v5, s[16:19], s45 offen sc1
    s_sub_u32 s40, s40, 1
    s_waitcnt vmcnt(0)
    v_cmp_ne_u32 vcc, 0, v7
    s_cbranch_scc1 L_back43
    s_cbranch_vccz L_back43
    s_sleep 2
    s_branch L_spin42_l
L_spin44:
    s_mov_b32 s40, 0x20000
L_spin44_l:
    buffer_load_dword v7, v5, s[16:19], s45 offen sc1
    s_sub_u32 s40, s40, 1
    s_waitcnt vmcnt(0)
    v_cmp_ne_u32 vcc, 0, v7
    s_cbranch_scc1 L_back45
    s_cbranch_vccz L_back45
    s_sleep 2
    s_branch L_spin44_l
L_sspin46:
    s_mov_b32 s40, 0x20000
L_sspin46_l:
    buffer_load_dwordx2 v[144:145], v6, s[16:19], s46 offen offset:0 sc1
    buffer_load_dwordx2 v[146:147], v6, s[16:19], s46 offen offset:128 sc1
    buffer_load_dwordx2 v[148:149], v6, s[16:19], s46 offen offset:256 sc1
    buffer_load_dwordx2 v[150:151], v6, s[16:19], s46 offen offset:384 sc1
    s_sub_u32 s40, s40, 1
    s_waitcnt vmcnt(0)
    v_max3_u32 v152, v144, v145, v146
    v_max3_u32 v153, v147, v148, v149
    v_max3_u32 v152, v152, v150, v151
    v_max_u32 v152, v152, v153
    v_cmp_eq_u32 vcc, -1, v152
    s_cbranch_scc1 L_sback47
    s_cbranch_vccz L_sback47
    s_sleep 4
    s_branch L_sspin46_l
L_spin48:
    s_mov_b32 s40, 0x20000
L_spin48_l:
    buffer_load_dword v7, v5, s[16:19], s45 offen sc1
    s_sub_u32 s40, s40, 1
    s_waitcnt vmcnt(0)
    v_cmp_ne_u32 vcc, 0, v7
    s_cbranch_scc1 L_back49
    s_cbranch_vccz L_back49
    s_sleep 2
    s_branch L_spin48_l
L_sspin50:
    s_mov_b32 s40, 0x20000
L_sspin50_l:
    buffer_load_dwordx2 v[144:145], v6, s[16:19], s46 offen offset:0 sc1
    buffer_load_dwordx2 v[146:147], v6, s[16:19], s46 offen offset:128 sc1
    buffer_load_dwordx2 v[148:149], v6, s[16:19], s46 offen offset:256 sc1
    buffer_load_dwordx2 v[150:151], v6, s[16:19], s46 offen offset:384 sc1
    s_sub_u32 s40, s40, 1
    s_waitcnt vmcnt(0)
    v_max3_u32 v152, v144, v145, v146
    v_max3_u32 v153, v147, v148, v149
    v_max3_u32 v152, v152, v150, v151
    v_max_u32 v152, v152, v153
    v_cmp_eq_u32 vcc, -1, v152
    s_cbranch_scc1 L_sback51
    s_cbranch_vccz L_sback51
    s_sleep 4
    s_branch L_sspin50_l
L_role_44:
    s_sub_u32 s35, s34, 44
    s_cmp_ge_u32 s35, 12
    s_cbranch_scc1 L_bf_nost
    s_lshl_b32 s50, s33, 4
    s_add_u32 s50, s50, s35
    s_lshl_b32 s50, s50, 1
    s_lshl_b32 s46, s50, 15
    s_lshl_b32 s37, s32, 9
    s_add_u32 s46, s46, s37
    v_lshrrev_b32 v48, 3, v0
    v_and_b32 v49, 0x70, v1
    v_lshl_add_u32 v48, v48, 11, v49
    v_add_u32 v49, 16384, v48
    s_mov_b32 s8, s64
    s_mov_b32 s9, s65
    s_mov_b32 s10, 0x400000
    s_mov_b32 s11, 0x00020000
    buffer_load_dwordx4 v[16:19], v48, s[8:11], s46 offen offset:0
    buffer_load_dwordx4 v[20:23], v48, s[8:11], s46 offen offset:128
    buffer_load_dwordx4 v[24:27], v48, s[8:11], s46 offen offset:256
    buffer_load_dwordx4 v[28:31], v48, s[8:11], s46 offen offset:384
    buffer_load_dwordx4 v[32:35], v49, s[8:11], s46 offen offset:0
    buffer_load_dwordx4 v[36:39], v49, s[8:11], s46 offen offset:128
    buffer_load_dwordx4 v[40:43], v49, s[8:11], s46 offen offset:256
    buffer_load_dwordx4 v[44:47], v49, s[8:11], s46 offen offset:384
    s_xor_b32 s50, s50, 1
    s_lshl_b32 s46, s50, 15
    s_lshl_b32 s37, s32, 9
    s_add_u32 s46, s46, s37
    v_lshrrev_b32 v96, 3, v0
    v_and_b32 v97, 0x70, v1
    v_lshl_add_u32 v96, v96, 11, v97
    v_add_u32 v97, 16384, v96
    s_mov_b32 s8, s64
    s_mov_b32 s9, s65
    s_mov_b32 s10, 0x400000
    s_mov_b32 s11, 0x00020000
    buffer_load_dwordx4 v[64:67], v96, s[8:11], s46 offen offset:0
    buffer_load_dwordx4 v[68:71], v96, s[8:11], s46 offen offset:128
    buffer_load_dwordx4 v[72:75], v96, s[8:11], s46 offen offset:256
    buffer_load_dwordx4 v[76:79], v96, s[8:11], s46 offen offset:384
    buffer_load_dwordx4 v[80:83], v97, s[8:11], s46 offen offset:0
    buffer_load_dwordx4 v[84:87], v97, s[8:11], s46 offen offset:128
    buffer_load_dwordx4 v[88:91], v97, s[8:11], s46 offen offset:256
    buffer_load_dwordx4 v[92:95], v97, s[8:11], s46 offen offset:384
    s_xor_b32 s50, s50, 1
    s_mov_b32 s86, 0x3f803f80
    v_and_b32 v56, 1, v0
    v_lshlrev_b32 v56, 7, v56
    v_bfe_u32 v57, v0, 1, 1
    v_lshl_add_u32 v56, v57, 6, v56
    v_and_b32 v57, 0x38, v0
    v_add_u32 v56, v57, v56
    s_sub_u32 s46, 127, s50
    s_lshl_b32 s46, s46, 10
    s_lshl_b32 s37, s32, 8
    s_add_u32 s46, s46, s37
    s_add_u32 s46, s46, 0x5400000
    s_waitcnt vmcnt(8)
    v_dot2_f32_bf16 v48, v16, s86, 0
    v_dot2_f32_bf16 v49, v16, v16, 0
    v_dot2_f32_bf16 v50, v24, s86, 0
    v_dot2_f32_bf16 v51, v24, v24, 0
    v_dot2_f32_bf16 v52, v32, s86, 0
    v_dot2_f32_bf16 v53, v32, v32, 0
    v_dot2_f32_bf16 v54, v40, s86, 0
    v_dot2_f32_bf16 v55, v40, v40, 0
    v_dot2_f32_bf16 v48, v17, s86, v48
    v_dot2_f32_bf16 v49, v17, v17, v49
    v_dot2_f32_bf16 v50, v25, s86, v50
    v_dot2_f32_bf16 v51, v25, v25, v51
    v_dot2_f32_bf16 v52, v33, s86, v52
    v_dot2_f32_bf16 v53, v33, v33, v53
    v_dot2_f32_bf16 v54, v41, s86, v54
    v_dot2_f32_bf16 v55, v41, v41, v55
    v_dot2_f32_bf16 v48, v18, s86, v48
    v_dot2_f32_bf16 v49, v18, v18, v49
    v_dot2_f32_bf16 v50, v26, s86, v50
    v_dot2_f32_bf16 v51, v26, v26, v51
    v_dot2_f32_bf16 v52, v34, s86, v52
    v_dot2_f32_bf16 v53, v34, v34, v53
    v_dot2_f32_bf16 v54, v42, s86, v54
    v_dot2_f32_bf16 v55, v42, v42, v55
    v_dot2_f32_bf16 v48, v19, s86, v48
    v_dot2_f32_bf16 v49, v19, v19, v49
    v_dot2_f32_bf16 v50, v27, s86, v50
    v_dot2_f32_bf16 v51, v27, v27, v51
    v_dot2_f32_bf16 v52, v35, s86, v52
    v_dot2_f32_bf16 v53, v35, v35, v53
    v_dot2_f32_bf16 v54, v43, s86, v54
    v_dot2_f32_bf16 v55, v43, v43, v55
    v_dot2_f32_bf16 v48, v20, s86, v48
    v_dot2_f32_bf16 v49, v20, v20, v49
    v_dot2_f32_bf16 v50, v28, s86, v50
    v_dot2_f32_bf16 v51, v28, v28, v51
    v_dot2_f32_bf16 v52, v36, s86, v52
    v_dot2_f32_bf16 v53, v36, v36, v53
    v_dot2_f32_bf16 v54, v44, s86, v54
    v_dot2_f32_bf16 v55, v44, v44, v55
    v_dot2_f32_bf16 v48, v21, s86, v48
    v_dot2_f32_bf16 v49, v21, v21, v49
    v_dot2_f32_bf16 v50, v29, s86, v50
    v_dot2_f32_bf16 v51, v29, v29, v51
    v_dot2_f32_bf16 v52, v37, s86, v52
    v_dot2_f32_bf16 v53, v37, v37, v53
    v_dot2_f32_bf16 v54, v45, s86, v54
    v_dot2_f32_bf16 v55, v45, v45, v55
    v_dot2_f32_bf16 v48, v22, s86, v48
    v_dot2_f32_bf16 v49, v22, v22, v49
    v_dot2_f32_bf16 v50, v30, s86, v50
    v_dot2_f32_bf16 v51, v30, v30, v51
    v_dot2_f32_bf16 v52, v38, s86, v52
    v_dot2_f32_bf16 v53, v38, v38, v53
    v_dot2_f32_bf16 v54, v46, s86, v54
    v_dot2_f32_bf16 v55, v46, v46, v55
    v_dot2_f32_bf16 v48, v23, s86, v48
    v_dot2_f32_bf16 v49, v23, v23, v49
    v_dot2_f32_bf16 v50, v31, s86, v50
    v_dot2_f32_bf16 v51, v31, v31, v51
    v_dot2_f32_bf16 v52, v39, s86, v52
    v_dot2_f32_bf16 v53, v39, v39, v53
    v_dot2_f32_bf16 v54, v47, s86, v54
    v_dot2_f32_bf16 v55, v47, v47, v55
    v_add_f32_dpp v48, v48, v48 quad_perm:[1,0,3,2] row_mask:0xf bank_mask:0xf
    v_add_f32_dpp v49, v49, v49 quad_perm:[1,0,3,2] row_mask:0xf bank_mask:0xf
    v_add_f32_dpp v50, v50, v50 quad_perm:[1,0,3,2] row_mask:0xf bank_mask:0xf
    v_add_f32_dpp v51, v51, v51 quad_perm:[1,0,3,2] row_mask:0xf bank_mask:0xf
    v_add_f32_dpp v52, v52, v52 quad_perm:[1,0,3,2] row_mask:0xf bank_mask:0xf
    v_add_f32_dpp v53, v53, v53 quad_perm:[1,0,3,2] row_mask:0xf bank_mask:0xf
    v_add_f32_dpp v54, v54, v54 quad_perm:[1,0,3,2] row_mask:0xf bank_mask:0xf
    v_add_f32_dpp v55, v55, v55 quad_perm:[1,0,3,2] row_mask:0xf bank_mask:0xf
    v_add_f32_dpp v48, v48, v48 quad_perm:[2,3,0,1] row_mask:0xf bank_mask:0xf
    v_add_f32_dpp v49, v49, v49 quad_perm:[2,3,0,1] row_mask:0xf bank_mask:0xf
    v_add_f32_dpp v50, v50, v50 quad_perm:[2,3,0,1] row_mask:0xf bank_mask:0xf
    v_add_f32_dpp v51, v51, v51 quad_perm:[2,3,0,1] row_mask:0xf bank_mask:0xf
    v_add_f32_dpp v52, v52, v52 quad_perm:[2,3,0,1] row_mask:0xf bank_mask:0xf
    v_add_f32_dpp v53, v53, v53 quad_perm:[2,3,0,1] row_mask:0xf bank_mask:0xf
    v_add_f32_dpp v54, v54, v54 quad_perm:[2,3,0,1] row_mask:0xf bank_mask:0xf
    v_add_f32_dpp v55, v55, v55 quad_perm:[2,3,0,1] row_mask:0xf bank_mask:0xf
    v_add_f32_dpp v48, v48, v48 row_half_mirror row_mask:0xf bank_mask:0xf
    v_add_f32_dpp v49, v49, v49 row_half_mirror row_mask:0xf bank_mask:0xf
    v_add_f32_dpp v50, v50, v50 row_half_mirror row_mask:0xf bank_mask:0xf
    v_add_f32_dpp v51, v51, v51 row_half_mirror row_mask:0xf bank_mask:0xf
    v_add_f32_dpp v52, v52, v52 row_half_mirror row_mask:0xf bank_mask:0xf
    v_add_f32_dpp v53, v53, v53 row_half_mirror row_mask:0xf bank_mask:0xf
    v_add_f32_dpp v54, v54, v54 row_half_mirror row_mask:0xf bank_mask:0xf
    v_add_f32_dpp v55, v55, v55 row_half_mirror row_mask:0xf bank_mask:0xf
    s_mov_b32 exec_lo, 0x2020202
    s_mov_b32 exec_hi, 0x2020202
    v_mov_b32 v48, v50
    v_mov_b32 v49, v51
    s_mov_b32 exec_lo, 0x4040404
    s_mov_b32 exec_hi, 0x4040404
    v_mov_b32 v48, v52
    v_mov_b32 v49, v53
    s_mov_b32 exec_lo, 0x8080808
    s_mov_b32 exec_hi, 0x8080808
    v_mov_b32 v48, v54
    v_mov_b32 v49, v55
    s_mov_b32 exec_lo, 0x0f0f0f0f
    s_mov_b32 exec_hi, 0x0f0f0f0f
    buffer_store_dwordx2 v[48:49], v56, s[16:19], s46 offen sc1
    s_mov_b64 exec, -1
    s_xor_b32 s50, s50, 1
    s_mov_b32 s86, 0x3f803f80
    v_and_b32 v104, 1, v0
    v_lshlrev_b32 v104, 7, v104
    v_bfe_u32 v105, v0, 1, 1
    v_lshl_add_u32 v104, v105, 6, v104
    v_and_b32 v105, 0x38, v0
    v_add_u32 v104, v105, v104
    s_sub_u32 s46, 127, s50
    s_lshl_b32 s46, s46, 10
    s_lshl_b32 s37, s32, 8
    s_add_u32 s46, s46, s37
    s_add_u32 s46, s46, 0x5400000
    s_waitcnt vmcnt(1)
    v_dot2_f32_bf16 v96, v64, s86, 0
    v_dot2_f32_bf16 v97, v64, v64, 0
    v_dot2_f32_bf16 v98, v72, s86, 0
    v_dot2_f32_bf16 v99, v72, v72, 0
    v_dot2_f32_bf16 v100, v80, s86, 0
    v_dot2_f32_bf16 v101, v80, v80, 0
    v_dot2_f32_bf16 v102, v88, s86, 0
    v_dot2_f32_bf16 v103, v88, v88, 0
    v_dot2_f32_bf16 v96, v65, s86, v96
    v_dot2_f32_bf16 v97, v65, v65, v97
    v_dot2_f32_bf16 v98, v73, s86, v98
    v_dot2_f32_bf16 v99, v73, v73, v99
    v_dot2_f32_bf16 v100, v81, s86, v100
    v_dot2_f32_bf16 v101, v81, v81, v101
    v_dot2_f32_bf16 v102, v89, s86, v102
    v_dot2_f32_bf16 v103, v89, v89, v103
    v_dot2_f32_bf16 v96, v66, s86, v96
    v_dot2_f32_bf16 v97, v66, v66, v97
    v_dot2_f32_bf16 v98, v74, s86, v98
    v_dot2_f32_bf16 v99, v74, v74, v99
    v_dot2_f32_bf16 v100, v82, s86, v100
    v_dot2_f32_bf16 v101, v82, v82, v101
    v_dot2_f32_bf16 v102, v90, s86, v102
    v_dot2_f32_bf16 v103, v90, v90, v103
    v_dot2_f32_bf16 v96, v67, s86, v96
    v_dot2_f32_bf16 v97, v67, v67, v97
    v_dot2_f32_bf16 v98, v75, s86, v98
    v_dot2_f32_bf16 v99, v75, v75, v99
    v_dot2_f32_bf16 v100, v83, s86, v100
    v_dot2_f32_bf16 v101, v83, v83, v101
    v_dot2_f32_bf16 v102, v91, s86, v102
    v_dot2_f32_bf16 v103, v91, v91, v103
    v_dot2_f32_bf16 v96, v68, s86, v96
    v_dot2_f32_bf16 v97, v68, v68, v97
    v_dot2_f32_bf16 v98, v76, s86, v98
    v_dot2_f32_bf16 v99, v76, v76, v99
    v_dot2_f32_bf16 v100, v84, s86, v100
    v_dot2_f32_bf16 v101, v84, v84, v101
    v_dot2_f32_bf16 v102, v92, s86, v102
    v_dot2_f32_bf16 v103, v92, v92, v103
    v_dot2_f32_bf16 v96, v69, s86, v96
    v_dot2_f32_bf16 v97, v69, v69, v97
    v_dot2_f32_bf16 v98, v77, s86, v98
    v_dot2_f32_bf16 v99, v77, v77, v99
    v_dot2_f32_bf16 v100, v85, s86, v100
    v_dot2_f32_bf16 v101, v85, v85, v101
    v_dot2_f32_bf16 v102, v93, s86, v102
    v_dot2_f32_bf16 v103, v93, v93, v103
    v_dot2_f32_bf16 v96, v70, s86, v96
    v_dot2_f32_bf16 v97, v70, v70, v97
    v_dot2_f32_bf16 v98, v78, s86, v98
    v_dot2_f32_bf16 v99, v78, v78, v99
    v_dot2_f32_bf16 v100, v86, s86, v100
    v_dot2_f32_bf16 v101, v86, v86, v101
    v_dot2_f32_bf16 v102, v94, s86, v102
    v_dot2_f32_bf16 v103, v94, v94, v103
    v_dot2_f32_bf16 v96, v71, s86, v96
    v_dot2_f32_bf16 v97, v71, v71, v97
    v_dot2_f32_bf16 v98, v79, s86, v98
    v_dot2_f32_bf16 v99, v79, v79, v99
    v_dot2_f32_bf16 v100, v87, s86, v100
    v_dot2_f32_bf16 v101, v87, v87, v101
    v_dot2_f32_bf16 v102, v95, s86, v102
    v_dot2_f32_bf16 v103, v95, v95, v103
    v_add_f32_dpp v96, v96, v96 quad_perm:[1,0,3,2] row_mask:0xf bank_mask:0xf
    v_add_f32_dpp v97, v97, v97 quad_perm:[1,0,3,2] row_mask:0xf bank_mask:0xf
    v_add_f32_dpp v98, v98, v98 quad_perm:[1,0,3,2] row_mask:0xf bank_mask:0xf
    v_add_f32_dpp v99, v99, v99 quad_perm:[1,0,3,2] row_mask:0xf bank_mask:0xf
    v_add_f32_dpp v100, v100, v100 quad_perm:[1,0,3,2] row_mask:0xf bank_mask:0xf
    v_add_f32_dpp v101, v101, v101 quad_perm:[1,0,3,2] row_mask:0xf bank_mask:0xf
    v_add_f32_dpp v102, v102, v102 quad_perm:[1,0,3,2] row_mask:0xf bank_mask:0xf
    v_add_f32_dpp v103, v103, v103 quad_perm:[1,0,3,2] row_mask:0xf bank_mask:0xf
    v_add_f32_dpp v96, v96, v96 quad_perm:[2,3,0,1] row_mask:0xf bank_mask:0xf
    v_add_f32_dpp v97, v97, v97 quad_perm:[2,3,0,1] row_mask:0xf bank_mask:0xf
    v_add_f32_dpp v98, v98, v98 quad_perm:[2,3,0,1] row_mask:0xf bank_mask:0xf
    v_add_f32_dpp v99, v99, v99 quad_perm:[2,3,0,1] row_mask:0xf bank_mask:0xf
    v_add_f32_dpp v100, v100, v100 quad_perm:[2,3,0,1] row_mask:0xf bank_mask:0xf
    v_add_f32_dpp v101, v101, v101 quad_perm:[2,3,0,1] row_mask:0xf bank_mask:0xf
    v_add_f32_dpp v102, v102, v102 quad_perm:[2,3,0,1] row_mask:0xf bank_mask:0xf
    v_add_f32_dpp v103, v103, v103 quad_perm:[2,3,0,1] row_mask:0xf bank_mask:0xf
    v_add_f32_dpp v96, v96, v96 row_half_mirror row_mask:0xf bank_mask:0xf
    v_add_f32_dpp v97, v97, v97 row_half_mirror row_mask:0xf bank_mask:0xf
    v_add_f32_dpp v98, v98, v98 row_half_mirror row_mask:0xf bank_mask:0xf
    v_add_f32_dpp v99, v99, v99 row_half_mirror row_mask:0xf bank_mask:0xf
    v_add_f32_dpp v100, v100, v100 row_half_mirror row_mask:0xf bank_mask:0xf
    v_add_f32_dpp v101, v101, v101 row_half_mirror row_mask:0xf bank_mask:0xf
    v_add_f32_dpp v102, v102, v102 row_half_mirror row_mask:0xf bank_mask:0xf
    v_add_f32_dpp v103, v103, v103 row_half_mirror row_mask:0xf bank_mask:0xf
    s_mov_b32 exec_lo, 0x2020202
    s_mov_b32 exec_hi, 0x2020202
    v_mov_b32 v96, v98
    v_mov_b32 v97, v99
    s_mov_b32 exec_lo, 0x4040404
    s_mov_b32 exec_hi, 0x4040404
    v_mov_b32 v96, v100
    v_mov_b32 v97, v101
    s_mov_b32 exec_lo, 0x8080808
    s_mov_b32 exec_hi, 0x8080808
    v_mov_b32 v96, v102
    v_mov_b32 v97, v103
    s_mov_b32 exec_lo, 0x0f0f0f0f
    s_mov_b32 exec_hi, 0x0f0f0f0f
    buffer_store_dwordx2 v[96:97], v104, s[16:19], s46 offen sc1
    s_mov_b64 exec, -1
    s_xor_b32 s50, s50, 1
L_bf_nost:
    s_cmp_lg_u32 s32, 0
    s_cbranch_scc1 L_arv52
    s_add_u32 s20, s82, 0x80
    s_addc_u32 s21, s83, 0
    s_mov_b32 s22, 0x4
    s_mov_b32 s23, 0x00020000
    buffer_load_dword v8, v124, s[20:23], 0 offen sc1
    s_waitcnt vmcnt(0)
    v_cmp_eq_u32 vcc, v124, v8
    s_cbranch_vccnz L_spin53
L_back54:
L_arv52:
    s_waitcnt vmcnt(0)
    s_barrier
    s_add_u32 s39, s91, 32768
    buffer_store_dword v124, v124, s[16:19], s39 offen sc1
    s_cmp_lt_u32 s35, 12
    s_cbranch_scc1 L_bf_nopf
    s_add_u32 s12, s72, 0x400000
    s_addc_u32 s13, s73, 0
    s_mov_b32 s14, 0x300000
    s_mov_b32 s15, 0x00020000
    s_sub_u32 s37, s35, 12
    s_lshl2_add_u32 s37, s37, s33
    s_lshl2_add_u32 s37, s37, s32
    s_lshl_b32 s37, s37, 13
    v_lshlrev_b32 v6, 7, v0
    buffer_load_dword v240, v6, s[12:15], s37 offen
    s_add_u32 s37, s37, 1048576
    buffer_load_dword v241, v6, s[12:15], s37 offen
    s_add_u32 s37, s37, 1048576
    buffer_load_dword v242, v6, s[12:15], s37 offen
    s_add_u32 s37, s37, 1048576
L_bf_nopf:
    s_lshr_b32 s51, s35, 2
    s_and_b32 s87, s35, 3
    s_mul_i32 s54, s51, 1507328
    s_lshl_b32 s37, s87, 9
    s_add_u32 s54, s54, s37
    s_mov_b32 s12, s76
    s_mov_b32 s13, s77
    s_mov_b32 s14, 0x700000
    s_mov_b32 s15, 0x00020000
    s_mov_b32 s39, 2048
    v_lshrrev_b32 v64, 3, v0
    v_lshlrev_b32 v65, 2, v0
    v_and_b32 v65, 64, v65
    v_and_b32 v66, 0x70, v1
    v_xor_b32 v65, v65, v66
    v_mad_u32_u24 v48, v64, s39, v65
    v_add_u32 v49, 16384, v48
    v_add_u32 v50, 128, v48
    v_add_u32 v51, 16512, v48
    v_add_u32 v52, 256, v48
    v_add_u32 v53, 16640, v48
    v_add_u32 v54, 384, v48
    v_add_u32 v55, 16768, v48
    s_mul_i32 s38, s32, 32768
    s_add_u32 s54, s54, s38
    s_lshl_b32 s42, s32, 11
    s_add_u32 m0, s42, 0
    s_nop 0
    buffer_load_dwordx4 v48, s[12:15], s54 offen lds
    s_add_u32 m0, s42, 1024
    s_nop 0
    buffer_load_dwordx4 v49, s[12:15], s54 offen lds
    s_add_u32 m0, s42, 8192
    s_nop 0
    buffer_load_dwordx4 v50, s[12:15], s54 offen lds
    s_add_u32 m0, s42, 9216
    s_nop 0
    buffer_load_dwordx4 v51, s[12:15], s54 offen lds
    s_add_u32 m0, s42, 16384
    s_nop 0
    buffer_load_dwordx4 v52, s[12:15], s54 offen lds
    s_add_u32 m0, s42, 17408
    s_nop 0
    buffer_load_dwordx4 v53, s[12:15], s54 offen lds
    s_add_u32 m0, s42, 24576
    s_nop 0
    buffer_load_dwordx4 v54, s[12:15], s54 offen lds
    s_add_u32 m0, s42, 25600
    s_nop 0
    buffer_load_dwordx4 v55, s[12:15], s54 offen lds
    s_add_u32 s54, s54, 131072
    s_add_u32 m0, s42, 32768
    s_nop 0
    buffer_load_dwordx4 v48, s[12:15], s54 offen lds
    s_add_u32 m0, s42, 33792
    s_nop 0
    buffer_load_dwordx4 v49, s[12:15], s54 offen lds
    s_add_u32 m0, s42, 40960
    s_nop 0
    buffer_load_dwordx4 v50, s[12:15], s54 offen lds
    s_add_u32 m0, s42, 41984
    s_nop 0
    buffer_load_dwordx4 v51, s[12:15], s54 offen lds
    s_add_u32 m0, s42, 49152
    s_nop 0
    buffer_load_dwordx4 v52, s[12:15], s54 offen lds
    s_add_u32 m0, s42, 50176
    s_nop 0
    buffer_load_dwordx4 v53, s[12:15], s54 offen lds
    s_add_u32 m0, s42, 57344
    s_nop 0
    buffer_load_dwordx4 v54, s[12:15], s54 offen lds
    s_add_u32 m0, s42, 58368
    s_nop 0
    buffer_load_dwordx4 v55, s[12:15], s54 offen lds
    s_add_u32 s54, s54, 131072
    s_add_u32 m0, s42, 65536
    s_nop 0
    buffer_load_dwordx4 v48, s[12:15], s54 offen lds
    s_add_u32 m0, s42, 66560
    s_nop 0
    buffer_load_dwordx4 v49, s[12:15], s54 offen lds
    s_add_u32 m0, s42, 73728
    s_nop 0
    buffer_load_dwordx4 v50, s[12:15], s54 offen lds
    s_add_u32 m0, s42, 74752
    s_nop 0
    buffer_load_dwordx4 v51, s[12:15], s54 offen lds
    s_add_u32 m0, s42, 81920
    s_nop 0
    buffer_load_dwordx4 v52, s[12:15], s54 offen lds
    s_add_u32 m0, s42, 82944
    s_nop 0
    buffer_load_dwordx4 v53, s[12:15], s54 offen lds
    s_add_u32 m0, s42, 90112
    s_nop 0
    buffer_load_dwordx4 v54, s[12:15], s54 offen lds
    s_add_u32 m0, s42, 91136
    s_nop 0
    buffer_load_dwordx4 v55, s[12:15], s54 offen lds
    s_add_u32 s54, s54, 131072
    s_add_u32 m0, s42, 98304
    s_nop 0
    buffer_load_dwordx4 v48, s[12:15], s54 offen lds
    s_add_u32 m0, s42, 99328
    s_nop 0
    buffer_load_dwordx4 v49, s[12:15], s54 offen lds
    s_add_u32 m0, s42, 106496
    s_nop 0
    buffer_load_dwordx4 v50, s[12:15], s54 offen lds
    s_add_u32 m0, s42, 107520
    s_nop 0
    buffer_load_dwordx4 v51, s[12:15], s54 offen lds
    s_add_u32 m0, s42, 114688
    s_nop 0
    buffer_load_dwordx4 v52, s[12:15], s54 offen lds
    s_add_u32 m0, s42, 115712
    s_nop 0
    buffer_load_dwordx4 v53, s[12:15], s54 offen lds
    s_add_u32 m0, s42, 122880
    s_nop 0
    buffer_load_dwordx4 v54, s[12:15], s54 offen lds
    s_add_u32 m0, s42, 123904
    s_nop 0
    buffer_load_dwordx4 v55, s[12:15], s54 offen lds
    s_add_u32 s54, s54, 131072
    v_lshrrev_b32 v64, 4, v0
    v_bfe_u32 v65, v0, 2, 2
    v_lshl_add_u32 v64, v64, 3, v65
    v_lshlrev_b32 v64, 7, v64
    v_lshrrev_b32 v65, 1, v65
    v_lshl_add_u32 v64, v65, 6, v64
    v_and_b32 v65, 3, v0
    v_lshl_add_u32 v64, v65, 4, v64
    s_lshl_b32 s37, s32, 13
    s_and_b32 s38, s51, 2
    s_lshl_b32 s38, s38, 5
    s_xor_b32 s38, s38, 0
    s_add_u32 s37, s37, s38
    v_xor_b32 v56, s37, v64
    s_lshl_b32 s37, s32, 13
    s_and_b32 s38, s51, 2
    s_lshl_b32 s38, s38, 5
    s_xor_b32 s38, s38, 8
    s_add_u32 s37, s37, s38
    v_xor_b32 v57, s37, v64
    s_lshl_b32 s37, s32, 13
    s_and_b32 s38, s51, 2
    s_lshl_b32 s38, s38, 5
    s_xor_b32 s38, s38, 64
    s_add_u32 s37, s37, s38
    v_xor_b32 v58, s37, v64
    s_lshl_b32 s37, s32, 13
    s_and_b32 s38, s51, 2
    s_lshl_b32 s38, s38, 5
    s_xor_b32 s38, s38, 72
    s_add_u32 s37, s37, s38
    v_xor_b32 v59, s37, v64
    s_and_b32 s39, s51, 1
    s_lshl_b32 s37, s39, 10
    v_add_u32 v2, s37, v1
    v_xor_b32 v3, 1024, v2
    v_add_u32 v4, 98304, v2
    v_add_u32 v5, 98304, v3
    s_mul_i32 s38, s51, 11*43
    s_lshr_b32 s38, s38, 7
    s_add_u32 s38, s38, 24
    s_lshl_b32 s37, s33, 6
    s_add_u32 s37, s37, s38
    s_lshl_b32 s37, s37, 7
    v_lshl_add_u32 v6, v0, 7, s37
    s_cmp_eq_u32 s32, 0
    s_cselect_b32 s37, 5, 0
    v_cmp_le_u32 vcc, s37, v0
    s_nop 1
    v_cndmask_b32 v6, v6, 2.0, vcc
    s_mul_i32 s43, s32, 4096
    s_mul_i32 s88, s32, 4096
    s_sub_u32 s89, s88, s43
    s_mul_i32 s41, s33, 8388608
    s_add_u32 s41, s41, 0x1000000
    s_mul_i32 s37, s51, 47104
    s_add_u32 s41, s41, s37
    s_add_u32 s41, s41, s43
    s_mul_i32 s90, s33, 8388608
    s_add_u32 s90, s90, 0x2fc0000
    s_lshl_b32 s37, s87, 16
    s_add_u32 s90, s90, s37
    s_lshl_b32 s37, s32, 12
    s_add_u32 s90, s90, s37
    s_and_b32 s37, s51, 3
    s_lshl_b32 s37, s37, 14
    s_add_u32 s90, s90, s37
    s_mov_b32 s86, 0xffff0000
    s_add_u32 s38, s87, 44
    s_lshl_b32 s37, s33, 6
    s_add_u32 s37, s37, s38
    s_lshl_b32 s37, s37, 7
    v_lshl_add_u32 v8, v0, 9, s37
    v_cmp_le_u32 vcc, 5, v0
    s_nop 1
    v_cndmask_b32 v8, v8, 2.0, vcc
    s_lshl_b32 s38, s87, 2
    s_add_u32 s38, s38, s32
    s_lshl_b32 s38, s38, 1
    s_lshr_b32 s37, s51, 1
    s_add_u32 s38, s38, s37
    s_mul_i32 s53, s33, 2097152
    s_add_u32 s53, s53, 0x7f0000
    s_lshl_b32 s37, s38, 11
    s_add_u32 s53, s53, s37
    s_lshl_b32 s37, s39, 10
    s_add_u32 s53, s53, s37
    v_and_b32 v16, 15, v0
    v_and_b32 v17, 0x30, v0
    s_lshl_b32 s38, s38, 6
    s_mov_b32 s8, s78
    s_mov_b32 s9, s79
    s_mov_b32 s10, 0x800
    s_mov_b32 s11, 0x00020000
    buffer_load_dwordx4 v[24:27], v17, s[8:11], s38 offen
    v_lshl_add_u32 v9, v16, 11, v17
    v_add_u32 v9, s38, v9
    s_lshl_b32 s50, s33, 5
    s_add_u32 s50, s50, 31
    s_sub_u32 s50, s50, s39
    v_bfe_u32 v17, v0, 4, 1
    v_lshl_add_u32 v16, v16, 1, v17
    s_lshl_b32 s37, s32, 2
    s_add_u32 s37, s37, 65536
    v_lshl_add_u32 v10, v16, 4, s37
    v_and_b32 v16, 31, v0
    v_lshrrev_b32 v12, 5, v0
    v_lshlrev_b32 v12, 30, v12
    v_lshl_add_u32 v12, v16, 2, v12
    v_lshlrev_b32 v16, 4, v16
    v_add_u32 v11, 65536, v16
    s_lshl_b32 s37, s87, 1
    s_lshr_b32 s38, s51, 1
    s_add_u32 s37, s37, s38
    s_lshl_b32 s37, s37, 7
    s_add_u32 s55, s37, 0x543fc00
    s_cmp_eq_u32 s32, 2
    s_cselect_b32 s55, s55, 0x5f00000
    s_add_u32 s20, s82, 0x80
    s_addc_u32 s21, s83, 0
    s_mov_b32 s22, 0x80
    s_mov_b32 s23, 0x00020000
    v_lshl_add_u32 v68, s32, 7, v124
    v_add_u32 v60, 0, v56
    v_add_u32 v61, 0, v57
    v_add_u32 v62, 0, v58
    v_add_u32 v63, 0, v59
    s_waitcnt vmcnt(25)
    s_barrier
    ds_read_b64_tr_b16 a[0:1], v60 offset:0
    ds_read_b64_tr_b16 a[2:3], v60 offset:512
    ds_read_b64_tr_b16 a[4:5], v61 offset:0
    ds_read_b64_tr_b16 a[6:7], v61 offset:512
    ds_read_b64_tr_b16 a[8:9], v62 offset:0
    ds_read_b64_tr_b16 a[10:11], v62 offset:512
    ds_read_b64_tr_b16 a[12:13], v63 offset:0
    ds_read_b64_tr_b16 a[14:15], v63 offset:512
    ds_read_b64_tr_b16 a[16:17], v60 offset:4096
    ds_read_b64_tr_b16 a[18:19], v60 offset:4608
    ds_read_b64_tr_b16 a[20:21], v61 offset:4096
    ds_read_b64_tr_b16 a[22:23], v61 offset:4608
    ds_read_b64_tr_b16 a[24:25], v62 offset:4096
    ds_read_b64_tr_b16 a[26:27], v62 offset:4608
    ds_read_b64_tr_b16 a[28:29], v63 offset:4096
    ds_read_b64_tr_b16 a[30:31], v63 offset:4608
    s_add_u32 m0, s42, 131072
    s_nop 0
    buffer_load_dwordx4 v48, s[12:15], s54 offen lds
    s_add_u32 m0, s42, 132096
    s_nop 0
    buffer_load_dwordx4 v49, s[12:15], s54 offen lds
    s_add_u32 m0, s42, 139264
    s_nop 0
    buffer_load_dwordx4 v50, s[12:15], s54 offen lds
    s_add_u32 m0, s42, 140288
    s_nop 0
    buffer_load_dwordx4 v51, s[12:15], s54 offen lds
    s_add_u32 m0, s42, 147456
    s_nop 0
    buffer_load_dwordx4 v52, s[12:15], s54 offen lds
    s_add_u32 m0, s42, 148480
    s_nop 0
    buffer_load_dwordx4 v53, s[12:15], s54 offen lds
    s_add_u32 m0, s42, 155648
    s_nop 0
    buffer_load_dwordx4 v54, s[12:15], s54 offen lds
    s_add_u32 m0, s42, 156672
    s_nop 0
    buffer_load_dwordx4 v55, s[12:15], s54 offen lds
    s_add_u32 s54, s54, 131072
    s_waitcnt lgkmcnt(0)
    v_add_u32 v60, 32768, v56
    v_add_u32 v61, 32768, v57
    v_add_u32 v62, 32768, v58
    v_add_u32 v63, 32768, v59
    s_waitcnt vmcnt(25)
    s_barrier
    ds_read_b64_tr_b16 a[32:33], v60 offset:0
    ds_read_b64_tr_b16 a[34:35], v60 offset:512
    ds_read_b64_tr_b16 a[36:37], v61 offset:0
    ds_read_b64_tr_b16 a[38:39], v61 offset:512
    ds_read_b64_tr_b16 a[40:41], v62 offset:0
    ds_read_b64_tr_b16 a[42:43], v62 offset:512
    ds_read_b64_tr_b16 a[44:45], v63 offset:0
    ds_read_b64_tr_b16 a[46:47], v63 offset:512
    ds_read_b64_tr_b16 a[48:49], v60 offset:4096
    ds_read_b64_tr_b16 a[50:51], v60 offset:4608
    ds_read_b64_tr_b16 a[52:53], v61 offset:4096
    ds_read_b64_tr_b16 a[54:55], v61 offset:4608
    ds_read_b64_tr_b16 a[56:57], v62 offset:4096
    ds_read_b64_tr_b16 a[58:59], v62 offset:4608
    ds_read_b64_tr_b16 a[60:61], v63 offset:4096
    ds_read_b64_tr_b16 a[62:63], v63 offset:4608
    s_add_u32 m0, s42, 0
    s_nop 0
    buffer_load_dwordx4 v48, s[12:15], s54 offen lds
    s_add_u32 m0, s42, 1024
    s_nop 0
    buffer_load_dwordx4 v49, s[12:15], s54 offen lds
    s_add_u32 m0, s42, 8192
    s_nop 0
    buffer_load_dwordx4 v50, s[12:15], s54 offen lds
    s_add_u32 m0, s42, 9216
    s_nop 0
    buffer_load_dwordx4 v51, s[12:15], s54 offen lds
    s_add_u32 m0, s42, 16384
    s_nop 0
    buffer_load_dwordx4 v52, s[12:15], s54 offen lds
    s_add_u32 m0, s42, 17408
    s_nop 0
    buffer_load_dwordx4 v53, s[12:15], s54 offen lds
    s_add_u32 m0, s42, 24576
    s_nop 0
    buffer_load_dwordx4 v54, s[12:15], s54 offen lds
    s_add_u32 m0, s42, 25600
    s_nop 0
    buffer_load_dwordx4 v55, s[12:15], s54 offen lds
    s_add_u32 s54, s54, 131072
    s_waitcnt lgkmcnt(0)
    v_add_u32 v60, 65536, v56
    v_add_u32 v61, 65536, v57
    v_add_u32 v62, 65536, v58
    v_add_u32 v63, 65536, v59
    s_waitcnt vmcnt(25)
    s_barrier
    ds_read_b64_tr_b16 a[64:65], v60 offset:0
    ds_read_b64_tr_b16 a[66:67], v60 offset:512
    ds_read_b64_tr_b16 a[68:69], v61 offset:0
    ds_read_b64_tr_b16 a[70:71], v61 offset:512
    ds_read_b64_tr_b16 a[72:73], v62 offset:0
    ds_read_b64_tr_b16 a[74:75], v62 offset:512
    ds_read_b64_tr_b16 a[76:77], v63 offset:0
    ds_read_b64_tr_b16 a[78:79], v63 offset:512
    ds_read_b64_tr_b16 a[80:81], v60 offset:4096
    ds_read_b64_tr_b16 a[82:83], v60 offset:4608
    ds_read_b64_tr_b16 a[84:85], v61 offset:4096
    ds_read_b64_tr_b16 a[86:87], v61 offset:4608
    ds_read_b64_tr_b16 a[88:89], v62 offset:4096
    ds_read_b64_tr_b16 a[90:91], v62 offset:4608
    ds_read_b64_tr_b16 a[92:93], v63 offset:4096
    ds_read_b64_tr_b16 a[94:95], v63 offset:4608
    s_add_u32 m0, s42, 32768
    s_nop 0
    buffer_load_dwordx4 v48, s[12:15], s54 offen lds
    s_add_u32 m0, s42, 33792
    s_nop 0
    buffer_load_dwordx4 v49, s[12:15], s54 offen lds
    s_add_u32 m0, s42, 40960
    s_nop 0
    buffer_load_dwordx4 v50, s[12:15], s54 offen lds
    s_add_u32 m0, s42, 41984
    s_nop 0
    buffer_load_dwordx4 v51, s[12:15], s54 offen lds
    s_add_u32 m0, s42, 49152
    s_nop 0
    buffer_load_dwordx4 v52, s[12:15], s54 offen lds
    s_add_u32 m0, s42, 50176
    s_nop 0
    buffer_load_dwordx4 v53, s[12:15], s54 offen lds
    s_add_u32 m0, s42, 57344
    s_nop 0
    buffer_load_dwordx4 v54, s[12:15], s54 offen lds
    s_add_u32 m0, s42, 58368
    s_nop 0
    buffer_load_dwordx4 v55, s[12:15], s54 offen lds
    s_add_u32 s54, s54, 131072
    s_waitcnt lgkmcnt(0)
    v_add_u32 v60, 98304, v56
    v_add_u32 v61, 98304, v57
    v_add_u32 v62, 98304, v58
    v_add_u32 v63, 98304, v59
    s_waitcnt vmcnt(25)
    s_barrier
    ds_read_b64_tr_b16 a[96:97], v60 offset:0
    ds_read_b64_tr_b16 a[98:99], v60 offset:512
    ds_read_b64_tr_b16 a[100:101], v61 offset:0
    ds_read_b64_tr_b16 a[102:103], v61 offset:512
    ds_read_b64_tr_b16 a[104:105], v62 offset:0
    ds_read_b64_tr_b16 a[106:107], v62 offset:512
    ds_read_b64_tr_b16 a[108:109], v63 offset:0
    ds_read_b64_tr_b16 a[110:111], v63 offset:512
    ds_read_b64_tr_b16 a[112:113], v60 offset:4096
    ds_read_b64_tr_b16 a[114:115], v60 offset:4608
    ds_read_b64_tr_b16 a[116:117], v61 offset:4096
    ds_read_b64_tr_b16 a[118:119], v61 offset:4608
    ds_read_b64_tr_b16 a[120:121], v62 offset:4096
    ds_read_b64_tr_b16 a[122:123], v62 offset:4608
    ds_read_b64_tr_b16 a[124:125], v63 offset:4096
    ds_read_b64_tr_b16 a[126:127], v63 offset:4608
    s_add_u32 m0, s42, 65536
    s_nop 0
    buffer_load_dwordx4 v48, s[12:15], s54 offen lds
    s_add_u32 m0, s42, 66560
    s_nop 0
    buffer_load_dwordx4 v49, s[12:15], s54 offen lds
    s_add_u32 m0, s42, 73728
    s_nop 0
    buffer_load_dwordx4 v50, s[12:15], s54 offen lds
    s_add_u32 m0, s42, 74752
    s_nop 0
    buffer_load_dwordx4 v51, s[12:15], s54 offen lds
    s_add_u32 m0, s42, 81920
    s_nop 0
    buffer_load_dwordx4 v52, s[12:15], s54 offen lds
    s_add_u32 m0, s42, 82944
    s_nop 0
    buffer_load_dwordx4 v53, s[12:15], s54 offen lds
    s_add_u32 m0, s42, 90112
    s_nop 0
    buffer_load_dwordx4 v54, s[12:15], s54 offen lds
    s_add_u32 m0, s42, 91136
    s_nop 0
    buffer_load_dwordx4 v55, s[12:15], s54 offen lds
    s_add_u32 s54, s54, 131072
    s_waitcnt lgkmcnt(0)
    v_add_u32 v60, 131072, v56
    v_add_u32 v61, 131072, v57
    v_add_u32 v62, 131072, v58
    v_add_u32 v63, 131072, v59
    s_waitcnt vmcnt(24)
    s_barrier
    ds_read_b64_tr_b16 a[128:129], v60 offset:0
    ds_read_b64_tr_b16 a[130:131], v60 offset:512
    ds_read_b64_tr_b16 a[132:133], v61 offset:0
    ds_read_b64_tr_b16 a[134:135], v61 offset:512
    ds_read_b64_tr_b16 a[136:137], v62 offset:0
    ds_read_b64_tr_b16 a[138:139], v62 offset:512
    ds_read_b64_tr_b16 a[140:141], v63 offset:0
    ds_read_b64_tr_b16 a[142:143], v63 offset:512
    ds_read_b64_tr_b16 a[144:145], v60 offset:4096
    ds_read_b64_tr_b16 a[146:147], v60 offset:4608
    ds_read_b64_tr_b16 a[148:149], v61 offset:4096
    ds_read_b64_tr_b16 a[150:151], v61 offset:4608
    ds_read_b64_tr_b16 a[152:153], v62 offset:4096
    ds_read_b64_tr_b16 a[154:155], v62 offset:4608
    ds_read_b64_tr_b16 a[156:157], v63 offset:4096
    ds_read_b64_tr_b16 a[158:159], v63 offset:4608
    s_add_u32 m0, s42, 98304
    s_nop 0
    buffer_load_dwordx4 v48, s[12:15], s54 offen lds
    s_add_u32 m0, s42, 99328
    s_nop 0
    buffer_load_dwordx4 v49, s[12:15], s54 offen lds
    s_add_u32 m0, s42, 106496
    s_nop 0
    buffer_load_dwordx4 v50, s[12:15], s54 offen lds
    s_add_u32 m0, s42, 107520
    s_nop 0
    buffer_load_dwordx4 v51, s[12:15], s54 offen lds
    s_add_u32 m0, s42, 114688
    s_nop 0
    buffer_load_dwordx4 v52, s[12:15], s54 offen lds
    s_add_u32 m0, s42, 115712
    s_nop 0
    buffer_load_dwordx4 v53, s[12:15], s54 offen lds
    s_add_u32 m0, s42, 122880
    s_nop 0
    buffer_load_dwordx4 v54, s[12:15], s54 offen lds
    s_add_u32 m0, s42, 123904
    s_nop 0
    buffer_load_dwordx4 v55, s[12:15], s54 offen lds
    s_add_u32 s54, s54, 131072
    s_waitcnt lgkmcnt(0)
    v_add_u32 v60, 0, v56
    v_add_u32 v61, 0, v57
    v_add_u32 v62, 0, v58
    v_add_u32 v63, 0, v59
    s_waitcnt vmcnt(24)
    s_barrier
    ds_read_b64_tr_b16 a[160:161], v60 offset:0
    ds_read_b64_tr_b16 a[162:163], v60 offset:512
    ds_read_b64_tr_b16 a[164:165], v61 offset:0
    ds_read_b64_tr_b16 a[166:167], v61 offset:512
    ds_read_b64_tr_b16 a[168:169], v62 offset:0
    ds_read_b64_tr_b16 a[170:171], v62 offset:512
    ds_read_b64_tr_b16 a[172:173], v63 offset:0
    ds_read_b64_tr_b16 a[174:175], v63 offset:512
    ds_read_b64_tr_b16 a[176:177], v60 offset:4096
    ds_read_b64_tr_b16 a[178:179], v60 offset:4608
    ds_read_b64_tr_b16 a[180:181], v61 offset:4096
    ds_read_b64_tr_b16 a[182:183], v61 offset:4608
    ds_read_b64_tr_b16 a[184:185], v62 offset:4096
    ds_read_b64_tr_b16 a[186:187], v62 offset:4608
    ds_read_b64_tr_b16 a[188:189], v63 offset:4096
    ds_read_b64_tr_b16 a[190:191], v63 offset:4608
    s_add_u32 m0, s42, 131072
    s_nop 0
    buffer_load_dwordx4 v48, s[12:15], s54 offen lds
    s_add_u32 m0, s42, 132096
    s_nop 0
    buffer_load_dwordx4 v49, s[12:15], s54 offen lds
    s_add_u32 m0, s42, 139264
    s_nop 0
    buffer_load_dwordx4 v50, s[12:15], s54 offen lds
    s_add_u32 m0, s42, 140288
    s_nop 0
    buffer_load_dwordx4 v51, s[12:15], s54 offen lds
    s_add_u32 m0, s42, 147456
    s_nop 0
    buffer_load_dwordx4 v52, s[12:15], s54 offen lds
    s_add_u32 m0, s42, 148480
    s_nop 0
    buffer_load_dwordx4 v53, s[12:15], s54 offen lds
    s_add_u32 m0, s42, 155648
    s_nop 0
    buffer_load_dwordx4 v54, s[12:15], s54 offen lds
    s_add_u32 m0, s42, 156672
    s_nop 0
    buffer_load_dwordx4 v55, s[12:15], s54 offen lds
    s_add_u32 s54, s54, 131072
    s_waitcnt lgkmcnt(0)
    v_add_u32 v60, 32768, v56
    v_add_u32 v61, 32768, v57
    v_add_u32 v62, 32768, v58
    v_add_u32 v63, 32768, v59
    s_waitcnt vmcnt(24)
    s_barrier
    ds_read_b64_tr_b16 a[192:193], v60 offset:0
    ds_read_b64_tr_b16 a[194:195], v60 offset:512
    ds_read_b64_tr_b16 a[196:197], v61 offset:0
    ds_read_b64_tr_b16 a[198:199], v61 offset:512
    ds_read_b64_tr_b16 a[200:201], v62 offset:0
    ds_read_b64_tr_b16 a[202:203], v62 offset:512
    ds_read_b64_tr_b16 a[204:205], v63 offset:0
    ds_read_b64_tr_b16 a[206:207], v63 offset:512
    ds_read_b64_tr_b16 a[208:209], v60 offset:4096
    ds_read_b64_tr_b16 a[210:211], v60 offset:4608
    ds_read_b64_tr_b16 a[212:213], v61 offset:4096
    ds_read_b64_tr_b16 a[214:215], v61 offset:4608
    ds_read_b64_tr_b16 a[216:217], v62 offset:4096
    ds_read_b64_tr_b16 a[218:219], v62 offset:4608
    ds_read_b64_tr_b16 a[220:221], v63 offset:4096
    ds_read_b64_tr_b16 a[222:223], v63 offset:4608
    s_add_u32 m0, s42, 0
    s_nop 0
    buffer_load_dwordx4 v48, s[12:15], s54 offen lds
    s_add_u32 m0, s42, 1024
    s_nop 0
    buffer_load_dwordx4 v49, s[12:15], s54 offen lds
    s_add_u32 m0, s42, 8192
    s_nop 0
    buffer_load_dwordx4 v50, s[12:15], s54 offen lds
    s_add_u32 m0, s42, 9216
    s_nop 0
    buffer_load_dwordx4 v51, s[12:15], s54 offen lds
    s_add_u32 m0, s42, 16384
    s_nop 0
    buffer_load_dwordx4 v52, s[12:15], s54 offen lds
    s_add_u32 m0, s42, 17408
    s_nop 0
    buffer_load_dwordx4 v53, s[12:15], s54 offen lds
    s_add_u32 m0, s42, 24576
    s_nop 0
    buffer_load_dwordx4 v54, s[12:15], s54 offen lds
    s_add_u32 m0, s42, 25600
    s_nop 0
    buffer_load_dwordx4 v55, s[12:15], s54 offen lds
    s_add_u32 s54, s54, 131072
    s_waitcnt lgkmcnt(0)
    v_add_u32 v60, 65536, v56
    v_add_u32 v61, 65536, v57
    v_add_u32 v62, 65536, v58
    v_add_u32 v63, 65536, v59
    s_waitcnt vmcnt(24)
    s_barrier
    ds_read_b64_tr_b16 a[224:225], v60 offset:0
    ds_read_b64_tr_b16 a[226:227], v60 offset:512
    ds_read_b64_tr_b16 a[228:229], v61 offset:0
    ds_read_b64_tr_b16 a[230:231], v61 offset:512
    ds_read_b64_tr_b16 a[232:233], v62 offset:0
    ds_read_b64_tr_b16 a[234:235], v62 offset:512
    ds_read_b64_tr_b16 a[236:237], v63 offset:0
    ds_read_b64_tr_b16 a[238:239], v63 offset:512
    ds_read_b64_tr_b16 a[240:241], v60 offset:4096
    ds_read_b64_tr_b16 a[242:243], v60 offset:4608
    ds_read_b64_tr_b16 a[244:245], v61 offset:4096
    ds_read_b64_tr_b16 a[246:247], v61 offset:4608
    ds_read_b64_tr_b16 a[248:249], v62 offset:4096
    ds_read_b64_tr_b16 a[250:251], v62 offset:4608
    ds_read_b64_tr_b16 a[252:253], v63 offset:4096
    ds_read_b64_tr_b16 a[254:255], v63 offset:4608
    buffer_load_dword v69, v68, s[20:23], 0 offen sc1
    s_add_u32 m0, s42, 32768
    s_nop 0
    buffer_load_dwordx4 v48, s[12:15], s54 offen lds
    s_add_u32 m0, s42, 33792
    s_nop 0
    buffer_load_dwordx4 v49, s[12:15], s54 offen lds
    s_add_u32 m0, s42, 40960
    s_nop 0
    buffer_load_dwordx4 v50, s[12:15], s54 offen lds
    s_add_u32 m0, s42, 41984
    s_nop 0
    buffer_load_dwordx4 v51, s[12:15], s54 offen lds
    s_add_u32 m0, s42, 49152
    s_nop 0
    buffer_load_dwordx4 v52, s[12:15], s54 offen lds
    s_add_u32 m0, s42, 50176
    s_nop 0
    buffer_load_dwordx4 v53, s[12:15], s54 offen lds
    s_add_u32 m0, s42, 57344
    s_nop 0
    buffer_load_dwordx4 v54, s[12:15], s54 offen lds
    s_add_u32 m0, s42, 58368
    s_nop 0
    buffer_load_dwordx4 v55, s[12:15], s54 offen lds
    s_add_u32 s54, s54, 131072
    s_waitcnt lgkmcnt(0)
    v_add_u32 v60, 98304, v56
    v_add_u32 v61, 98304, v57
    v_add_u32 v62, 98304, v58
    v_add_u32 v63, 98304, v59
    s_waitcnt vmcnt(25)
    s_barrier
    ds_read_b64_tr_b16 v[144:145], v60 offset:0
    ds_read_b64_tr_b16 v[146:147], v60 offset:512
    ds_read_b64_tr_b16 v[148:149], v61 offset:0
    ds_read_b64_tr_b16 v[150:151], v61 offset:512
    ds_read_b64_tr_b16 v[152:153], v62 offset:0
    ds_read_b64_tr_b16 v[154:155], v62 offset:512
    ds_read_b64_tr_b16 v[156:157], v63 offset:0
    ds_read_b64_tr_b16 v[158:159], v63 offset:512
    ds_read_b64_tr_b16 v[160:161], v60 offset:4096
    ds_read_b64_tr_b16 v[162:163], v60 offset:4608
    ds_read_b64_tr_b16 v[164:165], v61 offset:4096
    ds_read_b64_tr_b16 v[166:167], v61 offset:4608
    ds_read_b64_tr_b16 v[168:169], v62 offset:4096
    ds_read_b64_tr_b16 v[170:171], v62 offset:4608
    ds_read_b64_tr_b16 v[172:173], v63 offset:4096
    ds_read_b64_tr_b16 v[174:175], v63 offset:4608
    s_waitcnt lgkmcnt(0)
    v_add_u32 v60, 131072, v56
    v_add_u32 v61, 131072, v57
    v_add_u32 v62, 131072, v58
    v_add_u32 v63, 131072, v59
    s_waitcnt vmcnt(17)
    s_barrier
    ds_read_b64_tr_b16 v[176:177], v60 offset:0
    ds_read_b64_tr_b16 v[178:179], v60 offset:512
    ds_read_b64_tr_b16 v[180:181], v61 offset:0
    ds_read_b64_tr_b16 v[182:183], v61 offset:512
    ds_read_b64_tr_b16 v[184:185], v62 offset:0
    ds_read_b64_tr_b16 v[186:187], v62 offset:512
    ds_read_b64_tr_b16 v[188:189], v63 offset:0
    ds_read_b64_tr_b16 v[190:191], v63 offset:512
    ds_read_b64_tr_b16 v[192:193], v60 offset:4096
    ds_read_b64_tr_b16 v[194:195], v60 offset:4608
    ds_read_b64_tr_b16 v[196:197], v61 offset:4096
    ds_read_b64_tr_b16 v[198:199], v61 offset:4608
    ds_read_b64_tr_b16 v[200:201], v62 offset:4096
    ds_read_b64_tr_b16 v[202:203], v62 offset:4608
    ds_read_b64_tr_b16 v[204:205], v63 offset:4096
    ds_read_b64_tr_b16 v[206:207], v63 offset:4608
    s_waitcnt lgkmcnt(0)
    v_add_u32 v60, 0, v56
    v_add_u32 v61, 0, v57
    v_add_u32 v62, 0, v58
    v_add_u32 v63, 0, v59
    s_waitcnt vmcnt(9)
    s_barrier
    ds_read_b64_tr_b16 v[208:209], v60 offset:0
    ds_read_b64_tr_b16 v[210:211], v60 offset:512
    ds_read_b64_tr_b16 v[212:213], v61 offset:0
    ds_read_b64_tr_b16 v[214:215], v61 offset:512
    ds_read_b64_tr_b16 v[216:217], v62 offset:0
    ds_read_b64_tr_b16 v[218:219], v62 offset:512
    ds_read_b64_tr_b16 v[220:221], v63 offset:0
    ds_read_b64_tr_b16 v[222:223], v63 offset:512
    ds_read_b64_tr_b16 v[224:225], v60 offset:4096
    ds_read_b64_tr_b16 v[226:227], v60 offset:4608
    ds_read_b64_tr_b16 v[228:229], v61 offset:4096
    ds_read_b64_tr_b16 v[230:231], v61 offset:4608
    ds_read_b64_tr_b16 v[232:233], v62 offset:4096
    ds_read_b64_tr_b16 v[234:235], v62 offset:4608
    ds_read_b64_tr_b16 v[236:237], v63 offset:4096
    ds_read_b64_tr_b16 v[238:239], v63 offset:4608
    s_waitcnt lgkmcnt(0)
    v_add_u32 v60, 32768, v56
    v_add_u32 v61, 32768, v57
    v_add_u32 v62, 32768, v58
    v_add_u32 v63, 32768, v59
    s_waitcnt vmcnt(0)
    v_cmp_eq_u32 vcc, v68, v69
    s_cbranch_vccnz L_spin55
L_back56:
    s_barrier
    ds_read_b64_tr_b16 v[240:241], v60 offset:0
    ds_read_b64_tr_b16 v[242:243], v60 offset:512
    ds_read_b64_tr_b16 v[244:245], v61 offset:0
    ds_read_b64_tr_b16 v[246:247], v61 offset:512
    ds_read_b64_tr_b16 v[248:249], v62 offset:0
    ds_read_b64_tr_b16 v[250:251], v62 offset:512
    ds_read_b64_tr_b16 v[252:253], v63 offset:0
    ds_read_b64_tr_b16 v[254:255], v63 offset:512
    s_waitcnt lgkmcnt(0)
    s_barrier
    s_mov_b32 s37, 0xffff0000
    v_lshlrev_b32 v100, 16, v24
    v_and_b32 v101, s37, v24
    v_lshlrev_b32 v102, 16, v25
    v_and_b32 v103, s37, v25
    v_lshlrev_b32 v104, 16, v26
    v_and_b32 v105, s37, v26
    v_lshlrev_b32 v106, 16, v27
    v_and_b32 v107, s37, v27
    s_add_u32 s37, s90, 8388608
    v_mov_b32 v16, -1
    v_mov_b32 v17, -1
    v_mov_b32 v18, -1
    v_mov_b32 v19, -1
    buffer_store_dwordx4 v[16:19], v1, s[16:19], s37 offen offset:0 sc1
    buffer_store_dwordx4 v[16:19], v1, s[16:19], s37 offen offset:1024 sc1
    buffer_store_dwordx4 v[16:19], v1, s[16:19], s37 offen offset:2048 sc1
    buffer_store_dwordx4 v[16:19], v1, s[16:19], s37 offen offset:3072 sc1
    s_add_u32 s96, s41, 8126464
    s_mov_b32 s98, s41
    s_mov_b32 s45, 0x5530000
    buffer_load_dword v96, v6, s[16:19], s45 offen sc1
    s_waitcnt vmcnt(0)
    v_cmp_ne_u32 vcc, 0, v96
    s_cbranch_vccnz L_spin57
L_back58:
    s_barrier
    s_mov_b32 s39, 0x5e00000
    s_add_u32 m0, s43, 0
    s_add_u32 s42, s41, 0
    buffer_load_dwordx4 v1, s[16:19], s42 offen offset:0 sc1 lds
    buffer_load_dwordx4 v1, s[16:19], s42 offen offset:1024 sc1 lds
    buffer_load_dwordx4 v1, s[16:19], s42 offen offset:2048 sc1 lds
    buffer_load_dwordx4 v1, s[16:19], s42 offen offset:3072 sc1 lds
    s_add_u32 m0, s43, 16384
    s_add_u32 s42, s41, 16384
    buffer_load_dwordx4 v1, s[16:19], s42 offen offset:0 sc1 lds
    buffer_load_dwordx4 v1, s[16:19], s42 offen offset:1024 sc1 lds
    buffer_load_dwordx4 v1, s[16:19], s42 offen offset:2048 sc1 lds
    buffer_load_dwordx4 v1, s[16:19], s42 offen offset:3072 sc1 lds
    buffer_store_dword v124, v124, s[16:19], s39 offen
    buffer_store_dword v124, v124, s[16:19], s39 offen
    buffer_store_dword v124, v124, s[16:19], s39 offen
    s_add_u32 m0, s43, 32768
    s_add_u32 s42, s41, 32768
    buffer_load_dwordx4 v1, s[16:19], s42 offen offset:0 sc1 lds
    buffer_load_dwordx4 v1, s[16:19], s42 offen offset:1024 sc1 lds
    buffer_load_dwordx4 v1, s[16:19], s42 offen offset:2048 sc1 lds
    buffer_load_dwordx4 v1, s[16:19], s42 offen offset:3072 sc1 lds
    s_add_u32 s45, s45, 65536
    s_waitcnt vmcnt(7) lgkmcnt(0)
    s_barrier
    s_mov_b32 s52, 0x5e00000
    s_mov_b32 s46, 0x5e00000
    s_add_u32 s20, s84, 0x5e00000
    s_addc_u32 s21, s85, 0
    s_mov_b32 s22, 0x400000
    s_mov_b32 s23, 0x00020000
    v_mov_b32 v13, 0
    ds_read_b128 v[80:83], v2 offset:0
    ds_read_b128 v[84:87], v3 offset:0
    s_mov_b32 s36, 0
    s_waitcnt lgkmcnt(0)
    s_nop 7
L_bf_b0:
    v_mfma_f32_16x16x32_bf16 v[16:19], a[0:3], v[80:83], v[100:103]
    s_sub_u32 s47, s45, 196608
    ds_read_b128 v[88:91], v2 offset:2048
    s_max_u32 s47, s47, 0x5500000
    v_mfma_f32_16x16x32_bf16 v[24:27], a[0:3], v[84:87], 0
    buffer_load_dword v13, v8, s[16:19], s47 offen sc1
    v_mfma_f32_16x16x32_bf16 v[28:31], a[4:7], v[84:87], 0
    s_and_b32 s38, s53, 0xffffffff
    ds_read_b128 v[92:95], v3 offset:2048
    s_cmp_lt_i32 s36, 1
    v_mfma_f32_16x16x32_bf16 v[20:23], a[4:7], v[80:83], v[104:107]
    s_cselect_b32 s38, 0x5e00000, s38
    v_mfma_f32_16x16x32_bf16 v[32:35], a[8:11], v[80:83], 0
    buffer_load_dwordx4 v[116:119], v1, s[16:19], s38 offen sc1
    v_mfma_f32_16x16x32_bf16 v[40:43], a[8:11], v[84:87], 0
    s_add_u32 s53, s53, 65536
    ds_read_b128 v[120:123], v11 offset:0
    s_and_b32 s44, s90, 0xffffffff
    v_mfma_f32_16x16x32_bf16 v[44:47], a[12:15], v[84:87], 0
    s_cmp_lt_i32 s36, 1
    s_cselect_b32 s44, 0x5e00000, s44
    s_xor_b32 s49, s44, 16384
    v_mfma_f32_16x16x32_bf16 v[36:39], a[12:15], v[80:83], 0
    s_waitcnt lgkmcnt(1)
    v_cvt_pk_bf16_f32 v56, v56, v57
    v_cvt_pk_bf16_f32 v57, v58, v59
    v_mfma_f32_16x16x32_bf16 v[16:19], a[16:19], v[88:91], v[16:19]
    ds_read_b128 v[80:83], v2 offset:4096
    v_cvt_pk_bf16_f32 v58, v60, v61
    v_mfma_f32_16x16x32_bf16 v[24:27], a[16:19], v[92:95], v[24:27]
    v_cvt_pk_bf16_f32 v59, v62, v63
    v_mfma_f32_16x16x32_bf16 v[28:31], a[20:23], v[92:95], v[28:31]
    s_waitcnt lgkmcnt(1)
    ds_read_b128 v[84:87], v3 offset:4096
    v_add_f32 v120, v120, v121
    v_mfma_f32_16x16x32_bf16 v[20:23], a[20:23], v[88:91], v[20:23]
    buffer_store_dwordx4 v[56:59], v1, s[16:19], s49 offen offset:0 sc1
    v_mfma_f32_16x16x32_bf16 v[32:35], a[24:27], v[88:91], v[32:35]
    s_xor_b32 s49, s44, 32768
    v_cvt_pk_bf16_f32 v64, v64, v65
    v_cvt_pk_bf16_f32 v65, v66, v67
    v_mfma_f32_16x16x32_bf16 v[40:43], a[24:27], v[92:95], v[40:43]
    v_cvt_pk_bf16_f32 v66, v68, v69
    v_cvt_pk_bf16_f32 v67, v70, v71
    v_mfma_f32_16x16x32_bf16 v[44:47], a[28:31], v[92:95], v[44:47]
    buffer_store_dwordx4 v[64:67], v1, s[16:19], s49 offen offset:1024 sc1
    v_mfma_f32_16x16x32_bf16 v[36:39], a[28:31], v[88:91], v[36:39]
    s_waitcnt lgkmcnt(0)
    v_add_f32 v122, v122, v123
    v_add_f32 v120, v120, v122
    v_mfma_f32_16x16x32_bf16 v[16:19], a[32:35], v[80:83], v[16:19]
    s_xor_b32 s49, s44, 49152
    ds_read_b128 v[88:91], v2 offset:6144
    v_cvt_pk_bf16_f32 v72, v72, v73
    v_mfma_f32_16x16x32_bf16 v[24:27], a[32:35], v[84:87], v[24:27]
    v_cvt_pk_bf16_f32 v73, v74, v75
    v_cvt_pk_bf16_f32 v74, v76, v77
    v_mfma_f32_16x16x32_bf16 v[28:31], a[36:39], v[84:87], v[28:31]
    ds_read_b128 v[92:95], v3 offset:6144
    v_cvt_pk_bf16_f32 v75, v78, v79
    v_mfma_f32_16x16x32_bf16 v[20:23], a[36:39], v[80:83], v[20:23]
    buffer_store_dwordx4 v[72:75], v1, s[16:19], s49 offen offset:2048 sc1
    v_mfma_f32_16x16x32_bf16 v[32:35], a[40:43], v[80:83], v[32:35]
    s_add_u32 s90, s90, 262144
    v_mfma_f32_16x16x32_bf16 v[40:43], a[40:43], v[84:87], v[40:43]
    v_mfma_f32_16x16x32_bf16 v[44:47], a[44:47], v[84:87], v[44:47]
    buffer_store_dword v120, v12, s[16:19], s46 offen sc1
    v_mfma_f32_16x16x32_bf16 v[36:39], a[44:47], v[80:83], v[36:39]
    s_waitcnt lgkmcnt(0)
    v_mfma_f32_16x16x32_bf16 v[16:19], a[48:51], v[88:91], v[16:19]
    s_add_u32 s98, s98, 262144
    ds_read_b128 v[80:83], v2 offset:8192
    s_min_i32 s98, s98, s96
    v_mfma_f32_16x16x32_bf16 v[24:27], a[48:51], v[92:95], v[24:27]
    s_and_b32 s41, s98, 0xffffffff
    s_add_u32 m0, s43, 98304
    s_add_u32 s42, s41, 0
    v_mfma_f32_16x16x32_bf16 v[28:31], a[52:55], v[92:95], v[28:31]
    ds_read_b128 v[84:87], v3 offset:8192
    v_mfma_f32_16x16x32_bf16 v[20:23], a[52:55], v[88:91], v[20:23]
    v_mfma_f32_16x16x32_bf16 v[32:35], a[56:59], v[88:91], v[32:35]
    v_mfma_f32_16x16x32_bf16 v[40:43], a[56:59], v[92:95], v[40:43]
    v_mfma_f32_16x16x32_bf16 v[44:47], a[60:63], v[92:95], v[44:47]
    v_mfma_f32_16x16x32_bf16 v[36:39], a[60:63], v[88:91], v[36:39]
    s_waitcnt lgkmcnt(0)
    v_mfma_f32_16x16x32_bf16 v[16:19], a[64:67], v[80:83], v[16:19]
    ds_read_b128 v[88:91], v2 offset:10240
    v_mfma_f32_16x16x32_bf16 v[24:27], a[64:67], v[84:87], v[24:27]
    v_mfma_f32_16x16x32_bf16 v[28:31], a[68:71], v[84:87], v[28:31]
    ds_read_b128 v[92:95], v3 offset:10240
    v_mfma_f32_16x16x32_bf16 v[20:23], a[68:71], v[80:83], v[20:23]
    v_mfma_f32_16x16x32_bf16 v[32:35], a[72:75], v[80:83], v[32:35]
    v_mfma_f32_16x16x32_bf16 v[40:43], a[72:75], v[84:87], v[40:43]
    v_mfma_f32_16x16x32_bf16 v[44:47], a[76:79], v[84:87], v[44:47]
    v_mfma_f32_16x16x32_bf16 v[36:39], a[76:79], v[80:83], v[36:39]
    s_waitcnt lgkmcnt(0)
    v_mfma_f32_16x16x32_bf16 v[16:19], a[80:83], v[88:91], v[16:19]
    ds_read_b128 v[80:83], v2 offset:12288
    v_mfma_f32_16x16x32_bf16 v[24:27], a[80:83], v[92:95], v[24:27]
    v_mfma_f32_16x16x32_bf16 v[28:31], a[84:87], v[92:95], v[28:31]
    ds_read_b128 v[84:87], v3 offset:12288
    v_mfma_f32_16x16x32_bf16 v[20:23], a[84:87], v[88:91], v[20:23]
    v_mfma_f32_16x16x32_bf16 v[32:35], a[88:91], v[88:91], v[32:35]
    s_waitcnt vmcnt(5)
    v_cmp_ne_u32 vcc, 0, v13
    v_mfma_f32_16x16x32_bf16 v[40:43], a[88:91], v[92:95], v[40:43]
    v_mfma_f32_16x16x32_bf16 v[44:47], a[92:95], v[92:95], v[44:47]
    s_cbranch_vccnz L_spin59
L_back60:
    s_sub_u32 s48, s90, 524288
    s_and_b32 s48, s48, 0xffffffff
    v_mfma_f32_16x16x32_bf16 v[36:39], a[92:95], v[88:91], v[36:39]
    s_waitcnt lgkmcnt(0)
    s_cmp_lt_i32 s36, 2
    s_cselect_b32 s48, s52, s48
    v_mfma_f32_16x16x32_bf16 v[16:19], a[96:99], v[80:83], v[16:19]
    ds_read_b128 v[88:91], v2 offset:14336
    v_mfma_f32_16x16x32_bf16 v[24:27], a[96:99], v[84:87], v[24:27]
    buffer_load_dword v96, v6, s[16:19], s45 offen sc1
    v_mfma_f32_16x16x32_bf16 v[28:31], a[100:103], v[84:87], v[28:31]
    ds_read_b128 v[92:95], v3 offset:14336
    v_mfma_f32_16x16x32_bf16 v[20:23], a[100:103], v[80:83], v[20:23]
    v_mfma_f32_16x16x32_bf16 v[32:35], a[104:107], v[80:83], v[32:35]
    buffer_load_dwordx4 v[128:131], v1, s[16:19], s48 offen offset:0 sc1
    v_mfma_f32_16x16x32_bf16 v[40:43], a[104:107], v[84:87], v[40:43]
    v_mfma_f32_16x16x32_bf16 v[44:47], a[108:111], v[84:87], v[44:47]
    v_mfma_f32_16x16x32_bf16 v[36:39], a[108:111], v[80:83], v[36:39]
    s_waitcnt lgkmcnt(0)
    v_mfma_f32_16x16x32_bf16 v[16:19], a[112:115], v[88:91], v[16:19]
    ds_read_b128 v[80:83], v2 offset:16384
    v_mfma_f32_16x16x32_bf16 v[24:27], a[112:115], v[92:95], v[24:27]
    buffer_load_dwordx4 v[132:135], v1, s[16:19], s48 offen offset:1024 sc1
    v_mfma_f32_16x16x32_bf16 v[28:31], a[116:119], v[92:95], v[28:31]
    ds_read_b128 v[84:87], v3 offset:16384
    v_mfma_f32_16x16x32_bf16 v[20:23], a[116:119], v[88:91], v[20:23]
    v_mfma_f32_16x16x32_bf16 v[32:35], a[120:123], v[88:91], v[32:35]
    buffer_load_dwordx4 v[136:139], v1, s[16:19], s48 offen offset:2048 sc1
    v_mfma_f32_16x16x32_bf16 v[40:43], a[120:123], v[92:95], v[40:43]
    v_mfma_f32_16x16x32_bf16 v[44:47], a[124:127], v[92:95], v[44:47]
    v_mfma_f32_16x16x32_bf16 v[36:39], a[124:127], v[88:91], v[36:39]
    s_waitcnt lgkmcnt(0)
    v_mfma_f32_16x16x32_bf16 v[16:19], a[128:131], v[80:83], v[16:19]
    ds_read_b128 v[88:91], v2 offset:18432
    v_mfma_f32_16x16x32_bf16 v[24:27], a[128:131], v[84:87], v[24:27]
    buffer_load_dwordx4 v[140:143], v1, s[16:19], s48 offen offset:3072 sc1
    v_mfma_f32_16x16x32_bf16 v[28:31], a[132:135], v[84:87], v[28:31]
    s_sub_u32 s47, s36, 2
    ds_read_b128 v[92:95], v3 offset:18432
    s_cmp_lt_u32 s47, 16
    v_mfma_f32_16x16x32_bf16 v[20:23], a[132:135], v[80:83], v[20:23]
    s_cselect_b32 s48, 0x5000000, s52
    s_add_u32 s20, s84, s48
    s_addc_u32 s21, s85, 0
    v_mfma_f32_16x16x32_bf16 v[32:35], a[136:139], v[80:83], v[32:35]
    s_cmp_ge_i32 s47, 16
    s_cselect_b32 s20, s80, s20
    s_cselect_b32 s21, s81, s21
    v_mfma_f32_16x16x32_bf16 v[40:43], a[136:139], v[84:87], v[40:43]
    s_and_b32 s48, s47, 15
    s_lshl_b32 s48, s48, 1
    s_sub_u32 s48, s50, s48
    v_mfma_f32_16x16x32_bf16 v[44:47], a[140:143], v[84:87], v[44:47]
    s_lshl_b32 s46, s48, 10
    s_sub_u32 s46, s55, s46
    s_cmp_lt_u32 s47, 16
    v_mfma_f32_16x16x32_bf16 v[36:39], a[140:143], v[80:83], v[36:39]
    s_waitcnt lgkmcnt(0)
    s_cselect_b32 s46, s46, s52
    s_lshl_b32 s48, s48, 15
    v_mfma_f32_16x16x32_bf16 v[16:19], a[144:147], v[88:91], v[16:19]
    s_waitcnt vmcnt(9)
    ds_read_b128 v[80:83], v2 offset:20480
    v_lshlrev_b32 v120, 16, v116
    v_mfma_f32_16x16x32_bf16 v[24:27], a[144:147], v[92:95], v[24:27]
    v_and_b32 v121, s86, v116
    v_add_f32 v48, v48, v120
    v_mfma_f32_16x16x32_bf16 v[28:31], a[148:151], v[92:95], v[28:31]
    ds_read_b128 v[84:87], v3 offset:20480
    v_add_f32 v49, v49, v121
    v_mfma_f32_16x16x32_bf16 v[20:23], a[148:151], v[88:91], v[20:23]
    v_lshlrev_b32 v122, 16, v117
    v_and_b32 v123, s86, v117
    v_mfma_f32_16x16x32_bf16 v[32:35], a[152:155], v[88:91], v[32:35]
    v_add_f32 v50, v50, v122
    v_add_f32 v51, v51, v123
    v_mfma_f32_16x16x32_bf16 v[40:43], a[152:155], v[92:95], v[40:43]
    v_lshlrev_b32 v120, 16, v118
    v_and_b32 v121, s86, v118
    v_mfma_f32_16x16x32_bf16 v[44:47], a[156:159], v[92:95], v[44:47]
    v_add_f32 v52, v52, v120
    v_add_f32 v53, v53, v121
    v_mfma_f32_16x16x32_bf16 v[36:39], a[156:159], v[88:91], v[36:39]
    s_waitcnt lgkmcnt(0)
    v_lshlrev_b32 v122, 16, v119
    v_and_b32 v123, s86, v119
    v_mfma_f32_16x16x32_bf16 v[16:19], a[160:163], v[80:83], v[16:19]
    ds_read_b128 v[88:91], v2 offset:22528
    v_add_f32 v54, v54, v122
    v_mfma_f32_16x16x32_bf16 v[24:27], a[160:163], v[84:87], v[24:27]
    v_add_f32 v55, v55, v123
    v_mfma_f32_16x16x32_bf16 v[28:31], a[164:167], v[84:87], v[28:31]
    ds_read_b128 v[92:95], v3 offset:22528
    v_mfma_f32_16x16x32_bf16 v[20:23], a[164:167], v[80:83], v[20:23]
    v_mfma_f32_16x16x32_bf16 v[32:35], a[168:171], v[80:83], v[32:35]
    v_mfma_f32_16x16x32_bf16 v[40:43], a[168:171], v[84:87], v[40:43]
    v_mfma_f32_16x16x32_bf16 v[44:47], a[172:175], v[84:87], v[44:47]
    v_mfma_f32_16x16x32_bf16 v[36:39], a[172:175], v[80:83], v[36:39]
    s_waitcnt lgkmcnt(0)
    v_mfma_f32_16x16x32_bf16 v[16:19], a[176:179], v[88:91], v[16:19]
    ds_read_b128 v[80:83], v2 offset:24576
    v_mfma_f32_16x16x32_bf16 v[24:27], a[176:179], v[92:95], v[24:27]
    v_mfma_f32_16x16x32_bf16 v[28:31], a[180:183], v[92:95], v[28:31]
    ds_read_b128 v[84:87], v3 offset:24576
    v_mfma_f32_16x16x32_bf16 v[20:23], a[180:183], v[88:91], v[20:23]
    v_mfma_f32_16x16x32_bf16 v[32:35], a[184:187], v[88:91], v[32:35]
    s_waitcnt vmcnt(4)
    v_cmp_ne_u32 vcc, 0, v96
    s_waitcnt vmcnt(3)
    v_mfma_f32_16x16x32_bf16 v[40:43], a[184:187], v[92:95], v[40:43]
    v_lshlrev_b32 v120, 16, v128
    v_and_b32 v121, s86, v128
    v_mfma_f32_16x16x32_bf16 v[44:47], a[188:191], v[92:95], v[44:47]
    s_cbranch_vccnz L_spin61
L_back62:
    v_add_f32 v108, v108, v120
    v_add_f32 v109, v109, v121
    v_mfma_f32_16x16x32_bf16 v[36:39], a[188:191], v[88:91], v[36:39]
    s_waitcnt lgkmcnt(0)
    v_lshlrev_b32 v122, 16, v129
    v_and_b32 v123, s86, v129
    v_mfma_f32_16x16x32_bf16 v[16:19], a[192:195], v[80:83], v[16:19]
    s_barrier
    ds_read_b128 v[88:91], v2 offset:26624
    v_add_f32 v110, v110, v122
    v_mfma_f32_16x16x32_bf16 v[24:27], a[192:195], v[84:87], v[24:27]
    buffer_load_dwordx4 v1, s[16:19], s42 offen offset:0 sc1 lds
    v_mfma_f32_16x16x32_bf16 v[28:31], a[196:199], v[84:87], v[28:31]
    ds_read_b128 v[92:95], v3 offset:26624
    v_add_f32 v111, v111, v123
    v_mfma_f32_16x16x32_bf16 v[20:23], a[196:199], v[80:83], v[20:23]
    v_lshlrev_b32 v120, 16, v130
    v_and_b32 v121, s86, v130
    v_mfma_f32_16x16x32_bf16 v[32:35], a[200:203], v[80:83], v[32:35]
    v_add_f32 v112, v112, v120
    v_add_f32 v113, v113, v121
    v_mfma_f32_16x16x32_bf16 v[40:43], a[200:203], v[84:87], v[40:43]
    buffer_load_dwordx4 v1, s[16:19], s42 offen offset:1024 sc1 lds
    v_mfma_f32_16x16x32_bf16 v[44:47], a[204:207], v[84:87], v[44:47]
    v_lshlrev_b32 v122, 16, v131
    v_and_b32 v123, s86, v131
    v_mfma_f32_16x16x32_bf16 v[36:39], a[204:207], v[80:83], v[36:39]
    s_waitcnt lgkmcnt(0)
    v_add_f32 v114, v114, v122
    v_add_f32 v115, v115, v123
    v_mfma_f32_16x16x32_bf16 v[16:19], a[208:211], v[88:91], v[16:19]
    s_waitcnt vmcnt(4)
    ds_read_b128 v[80:83], v2 offset:28672
    v_lshlrev_b32 v120, 16, v132
    v_mfma_f32_16x16x32_bf16 v[24:27], a[208:211], v[92:95], v[24:27]
    buffer_load_dwordx4 v1, s[16:19], s42 offen offset:2048 sc1 lds
    v_mfma_f32_16x16x32_bf16 v[28:31], a[212:215], v[92:95], v[28:31]
    ds_read_b128 v[84:87], v3 offset:28672
    v_and_b32 v121, s86, v132
    v_mfma_f32_16x16x32_bf16 v[20:23], a[212:215], v[88:91], v[20:23]
    v_add_f32 v108, v108, v120
    v_add_f32 v109, v109, v121
    v_mfma_f32_16x16x32_bf16 v[32:35], a[216:219], v[88:91], v[32:35]
    v_lshlrev_b32 v122, 16, v133
    v_and_b32 v123, s86, v133
    v_mfma_f32_16x16x32_bf16 v[40:43], a[216:219], v[92:95], v[40:43]
    buffer_load_dwordx4 v1, s[16:19], s42 offen offset:3072 sc1 lds
    v_mfma_f32_16x16x32_bf16 v[44:47], a[220:223], v[92:95], v[44:47]
    s_add_u32 m0, s43, 114688
    v_add_f32 v110, v110, v122
    v_add_f32 v111, v111, v123
    v_mfma_f32_16x16x32_bf16 v[36:39], a[220:223], v[88:91], v[36:39]
    s_waitcnt lgkmcnt(0)
    v_lshlrev_b32 v120, 16, v134
    v_and_b32 v121, s86, v134
    v_mfma_f32_16x16x32_bf16 v[16:19], a[224:227], v[80:83], v[16:19]
    s_add_u32 s42, s41, 16384
    ds_read_b128 v[88:91], v2 offset:30720
    v_add_f32 v112, v112, v120
    v_mfma_f32_16x16x32_bf16 v[24:27], a[224:227], v[84:87], v[24:27]
    buffer_load_dwordx4 v1, s[16:19], s42 offen offset:0 sc1 lds
    v_mfma_f32_16x16x32_bf16 v[28:31], a[228:231], v[84:87], v[28:31]
    ds_read_b128 v[92:95], v3 offset:30720
    v_add_f32 v113, v113, v121
    v_mfma_f32_16x16x32_bf16 v[20:23], a[228:231], v[80:83], v[20:23]
    v_lshlrev_b32 v122, 16, v135
    v_and_b32 v123, s86, v135
    v_mfma_f32_16x16x32_bf16 v[32:35], a[232:235], v[80:83], v[32:35]
    v_add_f32 v114, v114, v122
    v_add_f32 v115, v115, v123
    v_mfma_f32_16x16x32_bf16 v[40:43], a[232:235], v[84:87], v[40:43]
    buffer_load_dwordx4 v1, s[16:19], s42 offen offset:1024 sc1 lds
    v_mfma_f32_16x16x32_bf16 v[44:47], a[236:239], v[84:87], v[44:47]
    s_waitcnt vmcnt(7)
    v_lshlrev_b32 v120, 16, v136
    v_and_b32 v121, s86, v136
    v_mfma_f32_16x16x32_bf16 v[36:39], a[236:239], v[80:83], v[36:39]
    s_waitcnt lgkmcnt(0)
    v_add_f32 v108, v108, v120
    v_add_f32 v109, v109, v121
    v_mfma_f32_16x16x32_bf16 v[16:19], a[240:243], v[88:91], v[16:19]
    ds_read_b128 v[80:83], v2 offset:32768
    v_lshlrev_b32 v122, 16, v137
    v_mfma_f32_16x16x32_bf16 v[24:27], a[240:243], v[92:95], v[24:27]
    buffer_load_dwordx4 v1, s[16:19], s42 offen offset:2048 sc1 lds
    v_mfma_f32_16x16x32_bf16 v[28:31], a[244:247], v[92:95], v[28:31]
    ds_read_b128 v[84:87], v3 offset:32768
    v_and_b32 v123, s86, v137
    v_mfma_f32_16x16x32_bf16 v[20:23], a[244:247], v[88:91], v[20:23]
    v_add_f32 v110, v110, v122
    v_add_f32 v111, v111, v123
    v_mfma_f32_16x16x32_bf16 v[32:35], a[248:251], v[88:91], v[32:35]
    v_lshlrev_b32 v120, 16, v138
    v_and_b32 v121, s86, v138
    v_mfma_f32_16x16x32_bf16 v[40:43], a[248:251], v[92:95], v[40:43]
    buffer_load_dwordx4 v1, s[16:19], s42 offen offset:3072 sc1 lds
    v_mfma_f32_16x16x32_bf16 v[44:47], a[252:255], v[92:95], v[44:47]
    v_add_f32 v112, v112, v120
    v_add_f32 v113, v113, v121
    v_mfma_f32_16x16x32_bf16 v[36:39], a[252:255], v[88:91], v[36:39]
    s_waitcnt lgkmcnt(0)
    v_lshlrev_b32 v122, 16, v139
    v_and_b32 v123, s86, v139
    v_mfma_f32_16x16x32_bf16 v[16:19], v[144:147], v[80:83], v[16:19]
    ds_read_b128 v[88:91], v2 offset:34816
    v_add_f32 v114, v114, v122
    v_mfma_f32_16x16x32_bf16 v[24:27], v[144:147], v[84:87], v[24:27]
    buffer_store_dword v124, v124, s[16:19], s91 offen sc1
    v_mfma_f32_16x16x32_bf16 v[28:31], v[148:151], v[84:87], v[28:31]
    s_add_u32 s91, s91, 65536
    ds_read_b128 v[92:95], v3 offset:34816
    v_add_f32 v115, v115, v123
    v_mfma_f32_16x16x32_bf16 v[20:23], v[148:151], v[80:83], v[20:23]
    s_add_u32 s39, s91, -163840
    s_waitcnt vmcnt(9)
    v_lshlrev_b32 v120, 16, v140
    v_mfma_f32_16x16x32_bf16 v[32:35], v[152:155], v[80:83], v[32:35]
    buffer_store_dword v124, v124, s[16:19], s39 offen sc1
    v_mfma_f32_16x16x32_bf16 v[40:43], v[152:155], v[84:87], v[40:43]
    v_and_b32 v121, s86, v140
    v_add_f32 v108, v108, v120
    v_mfma_f32_16x16x32_bf16 v[44:47], v[156:159], v[84:87], v[44:47]
    v_add_f32 v109, v109, v121
    v_lshlrev_b32 v122, 16, v141
    v_mfma_f32_16x16x32_bf16 v[36:39], v[156:159], v[80:83], v[36:39]
    s_waitcnt lgkmcnt(0)
    v_and_b32 v123, s86, v141
    v_add_f32 v110, v110, v122
    v_mfma_f32_16x16x32_bf16 v[16:19], v[160:163], v[88:91], v[16:19]
    ds_read_b128 v[80:83], v2 offset:36864
    v_add_f32 v111, v111, v123
    v_mfma_f32_16x16x32_bf16 v[24:27], v[160:163], v[92:95], v[24:27]
    v_lshlrev_b32 v120, 16, v142
    v_and_b32 v121, s86, v142
    v_mfma_f32_16x16x32_bf16 v[28:31], v[164:167], v[92:95], v[28:31]
    ds_read_b128 v[84:87], v3 offset:36864
    v_add_f32 v112, v112, v120
    v_mfma_f32_16x16x32_bf16 v[20:23], v[164:167], v[88:91], v[20:23]
    v_add_f32 v113, v113, v121
    v_lshlrev_b32 v122, 16, v143
    v_mfma_f32_16x16x32_bf16 v[32:35], v[168:171], v[88:91], v[32:35]
    v_and_b32 v123, s86, v143
    v_add_f32 v114, v114, v122
    v_mfma_f32_16x16x32_bf16 v[40:43], v[168:171], v[92:95], v[40:43]
    v_add_f32 v115, v115, v123
    v_cvt_pk_bf16_f32 v128, v108, v109
    v_mfma_f32_16x16x32_bf16 v[44:47], v[172:175], v[92:95], v[44:47]
    v_cvt_pk_bf16_f32 v129, v110, v111
    v_cvt_pk_bf16_f32 v130, v112, v113
    v_mfma_f32_16x16x32_bf16 v[36:39], v[172:175], v[88:91], v[36:39]
    s_waitcnt lgkmcnt(0)
    v_cvt_pk_bf16_f32 v131, v114, v115
    v_add_f32 v97, v108, v109
    v_mfma_f32_16x16x32_bf16 v[16:19], v[176:179], v[80:83], v[16:19]
    s_add_u32 m0, s43, 131072
    ds_read_b128 v[88:91], v2 offset:38912
    v_mul_f32 v98, v108, v108
    v_mfma_f32_16x16x32_bf16 v[24:27], v[176:179], v[84:87], v[24:27]
    buffer_store_dwordx4 v[128:131], v9, s[20:23], s48 offen sc1
    v_mfma_f32_16x16x32_bf16 v[28:31], v[180:183], v[84:87], v[28:31]
    s_add_u32 s42, s41, 32768
    ds_read_b128 v[92:95], v3 offset:38912
    v_fmac_f32 v98, v109, v109
    v_mfma_f32_16x16x32_bf16 v[20:23], v[180:183], v[80:83], v[20:23]
    v_add_f32 v97, v97, v110
    v_fmac_f32 v98, v110, v110
    v_mfma_f32_16x16x32_bf16 v[32:35], v[184:187], v[80:83], v[32:35]
    buffer_load_dwordx4 v1, s[16:19], s42 offen offset:0 sc1 lds
    v_mfma_f32_16x16x32_bf16 v[40:43], v[184:187], v[84:87], v[40:43]
    v_add_f32 v97, v97, v111
    v_fmac_f32 v98, v111, v111
    v_mfma_f32_16x16x32_bf16 v[44:47], v[188:191], v[84:87], v[44:47]
    v_add_f32 v97, v97, v112
    v_fmac_f32 v98, v112, v112
    v_mfma_f32_16x16x32_bf16 v[36:39], v[188:191], v[80:83], v[36:39]
    s_waitcnt lgkmcnt(0)
    v_add_f32 v97, v97, v113
    v_fmac_f32 v98, v113, v113
    v_mfma_f32_16x16x32_bf16 v[16:19], v[192:195], v[88:91], v[16:19]
    ds_read_b128 v[80:83], v2 offset:40960
    v_add_f32 v97, v97, v114
    v_mfma_f32_16x16x32_bf16 v[24:27], v[192:195], v[92:95], v[24:27]
    buffer_load_dwordx4 v1, s[16:19], s42 offen offset:1024 sc1 lds
    v_mfma_f32_16x16x32_bf16 v[28:31], v[196:199], v[92:95], v[28:31]
    ds_read_b128 v[84:87], v3 offset:40960
    v_fmac_f32 v98, v114, v114
    v_mfma_f32_16x16x32_bf16 v[20:23], v[196:199], v[88:91], v[20:23]
    v_add_f32 v97, v97, v115
    v_fmac_f32 v98, v115, v115
    v_mfma_f32_16x16x32_bf16 v[32:35], v[200:203], v[88:91], v[32:35]
    v_permlane16_swap_b32 v97, v98
    v_mfma_f32_16x16x32_bf16 v[40:43], v[200:203], v[92:95], v[40:43]
    v_add_f32 v97, v97, v98
    v_mov_b32 v99, v97
    v_mfma_f32_16x16x32_bf16 v[44:47], v[204:207], v[92:95], v[44:47]
    buffer_load_dwordx4 v1, s[16:19], s42 offen offset:2048 sc1 lds
    v_mfma_f32_16x16x32_bf16 v[36:39], v[204:207], v[88:91], v[36:39]
    s_waitcnt lgkmcnt(0)
    v_permlane32_swap_b32 v97, v99
    v_mfma_f32_16x16x32_bf16 v[16:19], v[208:211], v[80:83], v[16:19]
    ds_read_b128 v[88:91], v2 offset:43008
    v_add_f32 v97, v97, v99
    v_mfma_f32_16x16x32_bf16 v[24:27], v[208:211], v[84:87], v[24:27]
    ds_write_b32 v10, v97 offset:512
    v_mfma_f32_16x16x32_bf16 v[28:31], v[212:215], v[84:87], v[28:31]
    ds_read_b128 v[92:95], v3 offset:43008
    v_mov_b32 v108, v48
    v_mfma_f32_16x16x32_bf16 v[20:23], v[212:215], v[80:83], v[20:23]
    buffer_load_dwordx4 v1, s[16:19], s42 offen offset:3072 sc1 lds
    v_mfma_f32_16x16x32_bf16 v[32:35], v[216:219], v[80:83], v[32:35]
    s_add_u32 s45, s45, 65536
    v_mov_b32 v109, v49
    v_mov_b32 v110, v50
    v_mfma_f32_16x16x32_bf16 v[40:43], v[216:219], v[84:87], v[40:43]
    v_mov_b32 v111, v51
    v_mov_b32 v112, v52
    v_mfma_f32_16x16x32_bf16 v[44:47], v[220:223], v[84:87], v[44:47]
    v_mov_b32 v113, v53
    v_mov_b32 v114, v54
    v_mfma_f32_16x16x32_bf16 v[36:39], v[220:223], v[80:83], v[36:39]
    s_waitcnt lgkmcnt(0)
    v_mov_b32 v115, v55
    v_mfma_f32_16x16x32_bf16 v[16:19], v[224:227], v[88:91], v[16:19]
    ds_read_b128 v[80:83], v2 offset:45056
    v_mfma_f32_16x16x32_bf16 v[24:27], v[224:227], v[92:95], v[24:27]
    v_mfma_f32_16x16x32_bf16 v[28:31], v[228:231], v[92:95], v[28:31]
    ds_read_b128 v[84:87], v3 offset:45056
    v_mfma_f32_16x16x32_bf16 v[20:23], v[228:231], v[88:91], v[20:23]
    v_mfma_f32_16x16x32_bf16 v[32:35], v[232:235], v[88:91], v[32:35]
    v_mfma_f32_16x16x32_bf16 v[40:43], v[232:235], v[92:95], v[40:43]
    v_mfma_f32_16x16x32_bf16 v[44:47], v[236:239], v[92:95], v[44:47]
    v_mfma_f32_16x16x32_bf16 v[36:39], v[236:239], v[88:91], v[36:39]
    s_waitcnt vmcnt(7) lgkmcnt(0)
    s_barrier
    v_mfma_f32_16x16x32_bf16 v[16:19], v[240:243], v[80:83], v[16:19]
    ds_read_b128 v[88:91], v4 offset:0
    v_mfma_f32_16x16x32_bf16 v[24:27], v[240:243], v[84:87], v[24:27]
    v_mfma_f32_16x16x32_bf16 v[28:31], v[244:247], v[84:87], v[28:31]
    ds_read_b128 v[92:95], v5 offset:0
    v_mfma_f32_16x16x32_bf16 v[20:23], v[244:247], v[80:83], v[20:23]
    v_mfma_f32_16x16x32_bf16 v[32:35], v[248:251], v[80:83], v[32:35]
    v_mfma_f32_16x16x32_bf16 v[40:43], v[248:251], v[84:87], v[40:43]
    v_mfma_f32_16x16x32_bf16 v[44:47], v[252:255], v[84:87], v[44:47]
    s_add_u32 s36, s36, 1
    v_mfma_f32_16x16x32_bf16 v[36:39], v[252:255], v[80:83], v[36:39]
    s_waitcnt lgkmcnt(0)
L_bf_b1:
    v_mfma_f32_16x16x32_bf16 v[48:51], a[0:3], v[88:91], v[100:103]
    s_sub_u32 s47, s45, 196608
    ds_read_b128 v[80:83], v4 offset:2048
    s_max_u32 s47, s47, 0x5500000
    v_mfma_f32_16x16x32_bf16 v[56:59], a[0:3], v[92:95], 0
    buffer_load_dword v13, v8, s[16:19], s47 offen sc1
    v_mfma_f32_16x16x32_bf16 v[60:63], a[4:7], v[92:95], 0
    s_and_b32 s38, s53, 0xffffffff
    ds_read_b128 v[84:87], v5 offset:2048
    s_cmp_lt_i32 s36, 1
    v_mfma_f32_16x16x32_bf16 v[52:55], a[4:7], v[88:91], v[104:107]
    s_cselect_b32 s38, 0x5e00000, s38
    v_mfma_f32_16x16x32_bf16 v[64:67], a[8:11], v[88:91], 0
    buffer_load_dwordx4 v[116:119], v1, s[16:19], s38 offen sc1
    v_mfma_f32_16x16x32_bf16 v[72:75], a[8:11], v[92:95], 0
    s_add_u32 s53, s53, 65536
    ds_read_b128 v[120:123], v11 offset:512
    s_and_b32 s44, s90, 0xffffffff
    v_mfma_f32_16x16x32_bf16 v[76:79], a[12:15], v[92:95], 0
    s_cmp_lt_i32 s36, 1
    s_cselect_b32 s44, 0x5e00000, s44
    s_xor_b32 s49, s44, 16384
    v_mfma_f32_16x16x32_bf16 v[68:71], a[12:15], v[88:91], 0
    s_waitcnt lgkmcnt(1)
    v_cvt_pk_bf16_f32 v24, v24, v25
    v_cvt_pk_bf16_f32 v25, v26, v27
    v_mfma_f32_16x16x32_bf16 v[48:51], a[16:19], v[80:83], v[48:51]
    ds_read_b128 v[88:91], v4 offset:4096
    v_cvt_pk_bf16_f32 v26, v28, v29
    v_mfma_f32_16x16x32_bf16 v[56:59], a[16:19], v[84:87], v[56:59]
    v_cvt_pk_bf16_f32 v27, v30, v31
    v_mfma_f32_16x16x32_bf16 v[60:63], a[20:23], v[84:87], v[60:63]
    s_waitcnt lgkmcnt(1)
    ds_read_b128 v[92:95], v5 offset:4096
    v_add_f32 v120, v120, v121
    v_mfma_f32_16x16x32_bf16 v[52:55], a[20:23], v[80:83], v[52:55]
    buffer_store_dwordx4 v[24:27], v1, s[16:19], s49 offen offset:0 sc1
    v_mfma_f32_16x16x32_bf16 v[64:67], a[24:27], v[80:83], v[64:67]
    s_xor_b32 s49, s44, 32768
    v_cvt_pk_bf16_f32 v32, v32, v33
    v_cvt_pk_bf16_f32 v33, v34, v35
    v_mfma_f32_16x16x32_bf16 v[72:75], a[24:27], v[84:87], v[72:75]
    v_cvt_pk_bf16_f32 v34, v36, v37
    v_cvt_pk_bf16_f32 v35, v38, v39
    v_mfma_f32_16x16x32_bf16 v[76:79], a[28:31], v[84:87], v[76:79]
    buffer_store_dwordx4 v[32:35], v1, s[16:19], s49 offen offset:1024 sc1
    v_mfma_f32_16x16x32_bf16 v[68:71], a[28:31], v[80:83], v[68:71]
    s_waitcnt lgkmcnt(0)
    v_add_f32 v122, v122, v123
    v_add_f32 v120, v120, v122
    v_mfma_f32_16x16x32_bf16 v[48:51], a[32:35], v[88:91], v[48:51]
    s_xor_b32 s49, s44, 49152
    ds_read_b128 v[80:83], v4 offset:6144
    v_cvt_pk_bf16_f32 v40, v40, v41
    v_mfma_f32_16x16x32_bf16 v[56:59], a[32:35], v[92:95], v[56:59]
    v_cvt_pk_bf16_f32 v41, v42, v43
    v_cvt_pk_bf16_f32 v42, v44, v45
    v_mfma_f32_16x16x32_bf16 v[60:63], a[36:39], v[92:95], v[60:63]
    ds_read_b128 v[84:87], v5 offset:6144
    v_cvt_pk_bf16_f32 v43, v46, v47
    v_mfma_f32_16x16x32_bf16 v[52:55], a[36:39], v[88:91], v[52:55]
    buffer_store_dwordx4 v[40:43], v1, s[16:19], s49 offen offset:2048 sc1
    v_mfma_f32_16x16x32_bf16 v[64:67], a[40:43], v[88:91], v[64:67]
    s_add_u32 s90, s90, 262144
    v_mfma_f32_16x16x32_bf16 v[72:75], a[40:43], v[92:95], v[72:75]
    v_mfma_f32_16x16x32_bf16 v[76:79], a[44:47], v[92:95], v[76:79]
    buffer_store_dword v120, v12, s[16:19], s46 offen sc1
    v_mfma_f32_16x16x32_bf16 v[68:71], a[44:47], v[88:91], v[68:71]
    s_waitcnt lgkmcnt(0)
    v_mfma_f32_16x16x32_bf16 v[48:51], a[48:51], v[80:83], v[48:51]
    s_add_u32 s98, s98, 262144
    ds_read_b128 v[88:91], v4 offset:8192
    s_min_i32 s98, s98, s96
    v_mfma_f32_16x16x32_bf16 v[56:59], a[48:51], v[84:87], v[56:59]
    s_and_b32 s41, s98, 0xffffffff
    s_add_u32 m0, s43, 0
    s_add_u32 s42, s41, 0
    v_mfma_f32_16x16x32_bf16 v[60:63], a[52:55], v[84:87], v[60:63]
    ds_read_b128 v[92:95], v5 offset:8192
    v_mfma_f32_16x16x32_bf16 v[52:55], a[52:55], v[80:83], v[52:55]
    v_mfma_f32_16x16x32_bf16 v[64:67], a[56:59], v[80:83], v[64:67]
    v_mfma_f32_16x16x32_bf16 v[72:75], a[56:59], v[84:87], v[72:75]
    v_mfma_f32_16x16x32_bf16 v[76:79], a[60:63], v[84:87], v[76:79]
    v_mfma_f32_16x16x32_bf16 v[68:71], a[60:63], v[80:83], v[68:71]
    s_waitcnt lgkmcnt(0)
    v_mfma_f32_16x16x32_bf16 v[48:51], a[64:67], v[88:91], v[48:51]
    ds_read_b128 v[80:83], v4 offset:10240
    v_mfma_f32_16x16x32_bf16 v[56:59], a[64:67], v[92:95], v[56:59]
    v_mfma_f32_16x16x32_bf16 v[60:63], a[68:71], v[92:95], v[60:63]
    ds_read_b128 v[84:87], v5 offset:10240
    v_mfma_f32_16x16x32_bf16 v[52:55], a[68:71], v[88:91], v[52:55]
    v_mfma_f32_16x16x32_bf16 v[64:67], a[72:75], v[88:91], v[64:67]
    v_mfma_f32_16x16x32_bf16 v[72:75], a[72:75], v[92:95], v[72:75]
    v_mfma_f32_16x16x32_bf16 v[76:79], a[76:79], v[92:95], v[76:79]
    v_mfma_f32_16x16x32_bf16 v[68:71], a[76:79], v[88:91], v[68:71]
    s_waitcnt lgkmcnt(0)
    v_mfma_f32_16x16x32_bf16 v[48:51], a[80:83], v[80:83], v[48:51]
    ds_read_b128 v[88:91], v4 offset:12288
    v_mfma_f32_16x16x32_bf16 v[56:59], a[80:83], v[84:87], v[56:59]
    v_mfma_f32_16x16x32_bf16 v[60:63], a[84:87], v[84:87], v[60:63]
    ds_read_b128 v[92:95], v5 offset:12288
    v_mfma_f32_16x16x32_bf16 v[52:55], a[84:87], v[80:83], v[52:55]
    v_mfma_f32_16x16x32_bf16 v[64:67], a[88:91], v[80:83], v[64:67]
    s_waitcnt vmcnt(5)
    v_cmp_ne_u32 vcc, 0, v13
    v_mfma_f32_16x16x32_bf16 v[72:75], a[88:91], v[84:87], v[72:75]
    v_mfma_f32_16x16x32_bf16 v[76:79], a[92:95], v[84:87], v[76:79]
    s_cbranch_vccnz L_spin63
L_back64:
    s_sub_u32 s48, s90, 524288
    s_and_b32 s48, s48, 0xffffffff
    v_mfma_f32_16x16x32_bf16 v[68:71], a[92:95], v[80:83], v[68:71]
    s_waitcnt lgkmcnt(0)
    s_cmp_lt_i32 s36, 2
    s_cselect_b32 s48, s52, s48
    v_mfma_f32_16x16x32_bf16 v[48:51], a[96:99], v[88:91], v[48:51]
    ds_read_b128 v[80:83], v4 offset:14336
    v_mfma_f32_16x16x32_bf16 v[56:59], a[96:99], v[92:95], v[56:59]
    buffer_load_dword v96, v6, s[16:19], s45 offen sc1
    v_mfma_f32_16x16x32_bf16 v[60:63], a[100:103], v[92:95], v[60:63]
    ds_read_b128 v[84:87], v5 offset:14336
    v_mfma_f32_16x16x32_bf16 v[52:55], a[100:103], v[88:91], v[52:55]
    v_mfma_f32_16x16x32_bf16 v[64:67], a[104:107], v[88:91], v[64:67]
    buffer_load_dwordx4 v[128:131], v1, s[16:19], s48 offen offset:0 sc1
    v_mfma_f32_16x16x32_bf16 v[72:75], a[104:107], v[92:95], v[72:75]
    v_mfma_f32_16x16x32_bf16 v[76:79], a[108:111], v[92:95], v[76:79]
    v_mfma_f32_16x16x32_bf16 v[68:71], a[108:111], v[88:91], v[68:71]
    s_waitcnt lgkmcnt(0)
    v_mfma_f32_16x16x32_bf16 v[48:51], a[112:115], v[80:83], v[48:51]
    ds_read_b128 v[88:91], v4 offset:16384
    v_mfma_f32_16x16x32_bf16 v[56:59], a[112:115], v[84:87], v[56:59]
    buffer_load_dwordx4 v[132:135], v1, s[16:19], s48 offen offset:1024 sc1
    v_mfma_f32_16x16x32_bf16 v[60:63], a[116:119], v[84:87], v[60:63]
    ds_read_b128 v[92:95], v5 offset:16384
    v_mfma_f32_16x16x32_bf16 v[52:55], a[116:119], v[80:83], v[52:55]
    v_mfma_f32_16x16x32_bf16 v[64:67], a[120:123], v[80:83], v[64:67]
    buffer_load_dwordx4 v[136:139], v1, s[16:19], s48 offen offset:2048 sc1
    v_mfma_f32_16x16x32_bf16 v[72:75], a[120:123], v[84:87], v[72:75]
    v_mfma_f32_16x16x32_bf16 v[76:79], a[124:127], v[84:87], v[76:79]
    v_mfma_f32_16x16x32_bf16 v[68:71], a[124:127], v[80:83], v[68:71]
    s_waitcnt lgkmcnt(0)
    v_mfma_f32_16x16x32_bf16 v[48:51], a[128:131], v[88:91], v[48:51]
    ds_read_b128 v[80:83], v4 offset:18432
    v_mfma_f32_16x16x32_bf16 v[56:59], a[128:131], v[92:95], v[56:59]
    buffer_load_dwordx4 v[140:143], v1, s[16:19], s48 offen offset:3072 sc1
    v_mfma_f32_16x16x32_bf16 v[60:63], a[132:135], v[92:95], v[60:63]
    s_sub_u32 s47, s36, 2
    ds_read_b128 v[84:87], v5 offset:18432
    s_cmp_lt_u32 s47, 16
    v_mfma_f32_16x16x32_bf16 v[52:55], a[132:135], v[88:91], v[52:55]
    s_cselect_b32 s48, 0x5000000, s52
    s_add_u32 s20, s84, s48
    s_addc_u32 s21, s85, 0
    v_mfma_f32_16x16x32_bf16 v[64:67], a[136:139], v[88:91], v[64:67]
    s_cmp_ge_i32 s47, 16
    s_cselect_b32 s20, s80, s20
    s_cselect_b32 s21, s81, s21
    v_mfma_f32_16x16x32_bf16 v[72:75], a[136:139], v[92:95], v[72:75]
    s_and_b32 s48, s47, 15
    s_lshl_b32 s48, s48, 1
    s_sub_u32 s48, s50, s48
    v_mfma_f32_16x16x32_bf16 v[76:79], a[140:143], v[92:95], v[76:79]
    s_lshl_b32 s46, s48, 10
    s_sub_u32 s46, s55, s46
    s_cmp_lt_u32 s47, 16
    v_mfma_f32_16x16x32_bf16 v[68:71], a[140:143], v[88:91], v[68:71]
    s_waitcnt lgkmcnt(0)
    s_cselect_b32 s46, s46, s52
    s_lshl_b32 s48, s48, 15
    v_mfma_f32_16x16x32_bf16 v[48:51], a[144:147], v[80:83], v[48:51]
    s_waitcnt vmcnt(9)
    ds_read_b128 v[88:91], v4 offset:20480
    v_lshlrev_b32 v120, 16, v116
    v_mfma_f32_16x16x32_bf16 v[56:59], a[144:147], v[84:87], v[56:59]
    v_and_b32 v121, s86, v116
    v_add_f32 v16, v16, v120
    v_mfma_f32_16x16x32_bf16 v[60:63], a[148:151], v[84:87], v[60:63]
    ds_read_b128 v[92:95], v5 offset:20480
    v_add_f32 v17, v17, v121
    v_mfma_f32_16x16x32_bf16 v[52:55], a[148:151], v[80:83], v[52:55]
    v_lshlrev_b32 v122, 16, v117
    v_and_b32 v123, s86, v117
    v_mfma_f32_16x16x32_bf16 v[64:67], a[152:155], v[80:83], v[64:67]
    v_add_f32 v18, v18, v122
    v_add_f32 v19, v19, v123
    v_mfma_f32_16x16x32_bf16 v[72:75], a[152:155], v[84:87], v[72:75]
    v_lshlrev_b32 v120, 16, v118
    v_and_b32 v121, s86, v118
    v_mfma_f32_16x16x32_bf16 v[76:79], a[156:159], v[84:87], v[76:79]
    v_add_f32 v20, v20, v120
    v_add_f32 v21, v21, v121
    v_mfma_f32_16x16x32_bf16 v[68:71], a[156:159], v[80:83], v[68:71]
    s_waitcnt lgkmcnt(0)
    v_lshlrev_b32 v122, 16, v119
    v_and_b32 v123, s86, v119
    v_mfma_f32_16x16x32_bf16 v[48:51], a[160:163], v[88:91], v[48:51]
    ds_read_b128 v[80:83], v4 offset:22528
    v_add_f32 v22, v22, v122
    v_mfma_f32_16x16x32_bf16 v[56:59], a[160:163], v[92:95], v[56:59]
    v_add_f32 v23, v23, v123
    v_mfma_f32_16x16x32_bf16 v[60:63], a[164:167], v[92:95], v[60:63]
    ds_read_b128 v[84:87], v5 offset:22528
    v_mfma_f32_16x16x32_bf16 v[52:55], a[164:167], v[88:91], v[52:55]
    v_mfma_f32_16x16x32_bf16 v[64:67], a[168:171], v[88:91], v[64:67]
    v_mfma_f32_16x16x32_bf16 v[72:75], a[168:171], v[92:95], v[72:75]
    v_mfma_f32_16x16x32_bf16 v[76:79], a[172:175], v[92:95], v[76:79]
    v_mfma_f32_16x16x32_bf16 v[68:71], a[172:175], v[88:91], v[68:71]
    s_waitcnt lgkmcnt(0)
    v_mfma_f32_16x16x32_bf16 v[48:51], a[176:179], v[80:83], v[48:51]
    ds_read_b128 v[88:91], v4 offset:24576
    v_mfma_f32_16x16x32_bf16 v[56:59], a[176:179], v[84:87], v[56:59]
    v_mfma_f32_16x16x32_bf16 v[60:63], a[180:183], v[84:87], v[60:63]
    ds_read_b128 v[92:95], v5 offset:24576
    v_mfma_f32_16x16x32_bf16 v[52:55], a[180:183], v[80:83], v[52:55]
    v_mfma_f32_16x16x32_bf16 v[64:67], a[184:187], v[80:83], v[64:67]
    s_waitcnt vmcnt(4)
    v_cmp_ne_u32 vcc, 0, v96
    s_waitcnt vmcnt(3)
    v_mfma_f32_16x16x32_bf16 v[72:75], a[184:187], v[84:87], v[72:75]
    v_lshlrev_b32 v120, 16, v128
    v_and_b32 v121, s86, v128
    v_mfma_f32_16x16x32_bf16 v[76:79], a[188:191], v[84:87], v[76:79]
    s_cbranch_vccnz L_spin65
L_back66:
    v_add_f32 v108, v108, v120
    v_add_f32 v109, v109, v121
    v_mfma_f32_16x16x32_bf16 v[68:71], a[188:191], v[80:83], v[68:71]
    s_waitcnt lgkmcnt(0)
    v_lshlrev_b32 v122, 16, v129
    v_and_b32 v123, s86, v129
    v_mfma_f32_16x16x32_bf16 v[48:51], a[192:195], v[88:91], v[48:51]
    s_barrier
    ds_read_b128 v[80:83], v4 offset:26624
    v_add_f32 v110, v110, v122
    v_mfma_f32_16x16x32_bf16 v[56:59], a[192:195], v[92:95], v[56:59]
    buffer_load_dwordx4 v1, s[16:19], s42 offen offset:0 sc1 lds
    v_mfma_f32_16x16x32_bf16 v[60:63], a[196:199], v[92:95], v[60:63]
    ds_read_b128 v[84:87], v5 offset:26624
    v_add_f32 v111, v111, v123
    v_mfma_f32_16x16x32_bf16 v[52:55], a[196:199], v[88:91], v[52:55]
    v_lshlrev_b32 v120, 16, v130
    v_and_b32 v121, s86, v130
    v_mfma_f32_16x16x32_bf16 v[64:67], a[200:203], v[88:91], v[64:67]
    v_add_f32 v112, v112, v120
    v_add_f32 v113, v113, v121
    v_mfma_f32_16x16x32_bf16 v[72:75], a[200:203], v[92:95], v[72:75]
    buffer_load_dwordx4 v1, s[16:19], s42 offen offset:1024 sc1 lds
    v_mfma_f32_16x16x32_bf16 v[76:79], a[204:207], v[92:95], v[76:79]
    v_lshlrev_b32 v122, 16, v131
    v_and_b32 v123, s86, v131
    v_mfma_f32_16x16x32_bf16 v[68:71], a[204:207], v[88:91], v[68:71]
    s_waitcnt lgkmcnt(0)
    v_add_f32 v114, v114, v122
    v_add_f32 v115, v115, v123
    v_mfma_f32_16x16x32_bf16 v[48:51], a[208:211], v[80:83], v[48:51]
    s_waitcnt vmcnt(4)
    ds_read_b128 v[88:91], v4 offset:28672
    v_lshlrev_b32 v120, 16, v132
    v_mfma_f32_16x16x32_bf16 v[56:59], a[208:211], v[84:87], v[56:59]
    buffer_load_dwordx4 v1, s[16:19], s42 offen offset:2048 sc1 lds
    v_mfma_f32_16x16x32_bf16 v[60:63], a[212:215], v[84:87], v[60:63]
    ds_read_b128 v[92:95], v5 offset:28672
    v_and_b32 v121, s86, v132
    v_mfma_f32_16x16x32_bf16 v[52:55], a[212:215], v[80:83], v[52:55]
    v_add_f32 v108, v108, v120
    v_add_f32 v109, v109, v121
    v_mfma_f32_16x16x32_bf16 v[64:67], a[216:219], v[80:83], v[64:67]
    v_lshlrev_b32 v122, 16, v133
    v_and_b32 v123, s86, v133
    v_mfma_f32_16x16x32_bf16 v[72:75], a[216:219], v[84:87], v[72:75]
    buffer_load_dwordx4 v1, s[16:19], s42 offen offset:3072 sc1 lds
    v_mfma_f32_16x16x32_bf16 v[76:79], a[220:223], v[84:87], v[76:79]
    s_add_u32 m0, s43, 16384
    v_add_f32 v110, v110, v122
    v_add_f32 v111, v111, v123
    v_mfma_f32_16x16x32_bf16 v[68:71], a[220:223], v[80:83], v[68:71]
    s_waitcnt lgkmcnt(0)
    v_lshlrev_b32 v120, 16, v134
    v_and_b32 v121, s86, v134
    v_mfma_f32_16x16x32_bf16 v[48:51], a[224:227], v[88:91], v[48:51]
    s_add_u32 s42, s41, 16384
    ds_read_b128 v[80:83], v4 offset:30720
    v_add_f32 v112, v112, v120
    v_mfma_f32_16x16x32_bf16 v[56:59], a[224:227], v[92:95], v[56:59]
    buffer_load_dwordx4 v1, s[16:19], s42 offen offset:0 sc1 lds
    v_mfma_f32_16x16x32_bf16 v[60:63], a[228:231], v[92:95], v[60:63]
    ds_read_b128 v[84:87], v5 offset:30720
    v_add_f32 v113, v113, v121
    v_mfma_f32_16x16x32_bf16 v[52:55], a[228:231], v[88:91], v[52:55]
    v_lshlrev_b32 v122, 16, v135
    v_and_b32 v123, s86, v135
    v_mfma_f32_16x16x32_bf16 v[64:67], a[232:235], v[88:91], v[64:67]
    v_add_f32 v114, v114, v122
    v_add_f32 v115, v115, v123
    v_mfma_f32_16x16x32_bf16 v[72:75], a[232:235], v[92:95], v[72:75]
    buffer_load_dwordx4 v1, s[16:19], s42 offen offset:1024 sc1 lds
    v_mfma_f32_16x16x32_bf16 v[76:79], a[236:239], v[92:95], v[76:79]
    s_waitcnt vmcnt(7)
    v_lshlrev_b32 v120, 16, v136
    v_and_b32 v121, s86, v136
    v_mfma_f32_16x16x32_bf16 v[68:71], a[236:239], v[88:91], v[68:71]
    s_waitcnt lgkmcnt(0)
    v_add_f32 v108, v108, v120
    v_add_f32 v109, v109, v121
    v_mfma_f32_16x16x32_bf16 v[48:51], a[240:243], v[80:83], v[48:51]
    ds_read_b128 v[88:91], v4 offset:32768
    v_lshlrev_b32 v122, 16, v137
    v_mfma_f32_16x16x32_bf16 v[56:59], a[240:243], v[84:87], v[56:59]
    buffer_load_dwordx4 v1, s[16:19], s42 offen offset:2048 sc1 lds
    v_mfma_f32_16x16x32_bf16 v[60:63], a[244:247], v[84:87], v[60:63]
    ds_read_b128 v[92:95], v5 offset:32768
    v_and_b32 v123, s86, v137
    v_mfma_f32_16x16x32_bf16 v[52:55], a[244:247], v[80:83], v[52:55]
    v_add_f32 v110, v110, v122
    v_add_f32 v111, v111, v123
    v_mfma_f32_16x16x32_bf16 v[64:67], a[248:251], v[80:83], v[64:67]
    v_lshlrev_b32 v120, 16, v138
    v_and_b32 v121, s86, v138
    v_mfma_f32_16x16x32_bf16 v[72:75], a[248:251], v[84:87], v[72:75]
    buffer_load_dwordx4 v1, s[16:19], s42 offen offset:3072 sc1 lds
    v_mfma_f32_16x16x32_bf16 v[76:79], a[252:255], v[84:87], v[76:79]
    v_add_f32 v112, v112, v120
    v_add_f32 v113, v113, v121
    v_mfma_f32_16x16x32_bf16 v[68:71], a[252:255], v[80:83], v[68:71]
    s_waitcnt lgkmcnt(0)
    v_lshlrev_b32 v122, 16, v139
    v_and_b32 v123, s86, v139
    v_mfma_f32_16x16x32_bf16 v[48:51], v[144:147], v[88:91], v[48:51]
    ds_read_b128 v[80:83], v4 offset:34816
    v_add_f32 v114, v114, v122
    v_mfma_f32_16x16x32_bf16 v[56:59], v[144:147], v[92:95], v[56:59]
    buffer_store_dword v124, v124, s[16:19], s91 offen sc1
    v_mfma_f32_16x16x32_bf16 v[60:63], v[148:151], v[92:95], v[60:63]
    s_add_u32 s91, s91, 65536
    ds_read_b128 v[84:87], v5 offset:34816
    v_add_f32 v115, v115, v123
    v_mfma_f32_16x16x32_bf16 v[52:55], v[148:151], v[88:91], v[52:55]
    s_add_u32 s39, s91, -163840
    s_waitcnt vmcnt(9)
    v_lshlrev_b32 v120, 16, v140
    v_mfma_f32_16x16x32_bf16 v[64:67], v[152:155], v[88:91], v[64:67]
    buffer_store_dword v124, v124, s[16:19], s39 offen sc1
    v_mfma_f32_16x16x32_bf16 v[72:75], v[152:155], v[92:95], v[72:75]
    v_and_b32 v121, s86, v140
    v_add_f32 v108, v108, v120
    v_mfma_f32_16x16x32_bf16 v[76:79], v[156:159], v[92:95], v[76:79]
    v_add_f32 v109, v109, v121
    v_lshlrev_b32 v122, 16, v141
    v_mfma_f32_16x16x32_bf16 v[68:71], v[156:159], v[88:91], v[68:71]
    s_waitcnt lgkmcnt(0)
    v_and_b32 v123, s86, v141
    v_add_f32 v110, v110, v122
    v_mfma_f32_16x16x32_bf16 v[48:51], v[160:163], v[80:83], v[48:51]
    ds_read_b128 v[88:91], v4 offset:36864
    v_add_f32 v111, v111, v123
    v_mfma_f32_16x16x32_bf16 v[56:59], v[160:163], v[84:87], v[56:59]
    v_lshlrev_b32 v120, 16, v142
    v_and_b32 v121, s86, v142
    v_mfma_f32_16x16x32_bf16 v[60:63], v[164:167], v[84:87], v[60:63]
    ds_read_b128 v[92:95], v5 offset:36864
    v_add_f32 v112, v112, v120
    v_mfma_f32_16x16x32_bf16 v[52:55], v[164:167], v[80:83], v[52:55]
    v_add_f32 v113, v113, v121
    v_lshlrev_b32 v122, 16, v143
    v_mfma_f32_16x16x32_bf16 v[64:67], v[168:171], v[80:83], v[64:67]
    v_and_b32 v123, s86, v143
    v_add_f32 v114, v114, v122
    v_mfma_f32_16x16x32_bf16 v[72:75], v[168:171], v[84:87], v[72:75]
    v_add_f32 v115, v115, v123
    v_cvt_pk_bf16_f32 v128, v108, v109
    v_mfma_f32_16x16x32_bf16 v[76:79], v[172:175], v[84:87], v[76:79]
    v_cvt_pk_bf16_f32 v129, v110, v111
    v_cvt_pk_bf16_f32 v130, v112, v113
    v_mfma_f32_16x16x32_bf16 v[68:71], v[172:175], v[80:83], v[68:71]
    s_waitcnt lgkmcnt(0)
    v_cvt_pk_bf16_f32 v131, v114, v115
    v_add_f32 v97, v108, v109
    v_mfma_f32_16x16x32_bf16 v[48:51], v[176:179], v[88:91], v[48:51]
    s_add_u32 m0, s43, 32768
    ds_read_b128 v[80:83], v4 offset:38912
    v_mul_f32 v98, v108, v108
    v_mfma_f32_16x16x32_bf16 v[56:59], v[176:179], v[92:95], v[56:59]
    buffer_store_dwordx4 v[128:131], v9, s[20:23], s48 offen sc1
    v_mfma_f32_16x16x32_bf16 v[60:63], v[180:183], v[92:95], v[60:63]
    s_add_u32 s42, s41, 32768
    ds_read_b128 v[84:87], v5 offset:38912
    v_fmac_f32 v98, v109, v109
    v_mfma_f32_16x16x32_bf16 v[52:55], v[180:183], v[88:91], v[52:55]
    v_add_f32 v97, v97, v110
    v_fmac_f32 v98, v110, v110
    v_mfma_f32_16x16x32_bf16 v[64:67], v[184:187], v[88:91], v[64:67]
    buffer_load_dwordx4 v1, s[16:19], s42 offen offset:0 sc1 lds
    v_mfma_f32_16x16x32_bf16 v[72:75], v[184:187], v[92:95], v[72:75]
    v_add_f32 v97, v97, v111
    v_fmac_f32 v98, v111, v111
    v_mfma_f32_16x16x32_bf16 v[76:79], v[188:191], v[92:95], v[76:79]
    v_add_f32 v97, v97, v112
    v_fmac_f32 v98, v112, v112
    v_mfma_f32_16x16x32_bf16 v[68:71], v[188:191], v[88:91], v[68:71]
    s_waitcnt lgkmcnt(0)
    v_add_f32 v97, v97, v113
    v_fmac_f32 v98, v113, v113
    v_mfma_f32_16x16x32_bf16 v[48:51], v[192:195], v[80:83], v[48:51]
    ds_read_b128 v[88:91], v4 offset:40960
    v_add_f32 v97, v97, v114
    v_mfma_f32_16x16x32_bf16 v[56:59], v[192:195], v[84:87], v[56:59]
    buffer_load_dwordx4 v1, s[16:19], s42 offen offset:1024 sc1 lds
    v_mfma_f32_16x16x32_bf16 v[60:63], v[196:199], v[84:87], v[60:63]
    ds_read_b128 v[92:95], v5 offset:40960
    v_fmac_f32 v98, v114, v114
    v_mfma_f32_16x16x32_bf16 v[52:55], v[196:199], v[80:83], v[52:55]
    v_add_f32 v97, v97, v115
    v_fmac_f32 v98, v115, v115
    v_mfma_f32_16x16x32_bf16 v[64:67], v[200:203], v[80:83], v[64:67]
    v_permlane16_swap_b32 v97, v98
    v_mfma_f32_16x16x32_bf16 v[72:75], v[200:203], v[84:87], v[72:75]
    v_add_f32 v97, v97, v98
    v_mov_b32 v99, v97
    v_mfma_f32_16x16x32_bf16 v[76:79], v[204:207], v[84:87], v[76:79]
    buffer_load_dwordx4 v1, s[16:19], s42 offen offset:2048 sc1 lds
    v_mfma_f32_16x16x32_bf16 v[68:71], v[204:207], v[80:83], v[68:71]
    s_waitcnt lgkmcnt(0)
    v_permlane32_swap_b32 v97, v99
    v_mfma_f32_16x16x32_bf16 v[48:51], v[208:211], v[88:91], v[48:51]
    ds_read_b128 v[80:83], v4 offset:43008
    v_add_f32 v97, v97, v99
    v_mfma_f32_16x16x32_bf16 v[56:59], v[208:211], v[92:95], v[56:59]
    ds_write_b32 v10, v97 offset:0
    v_mfma_f32_16x16x32_bf16 v[60:63], v[212:215], v[92:95], v[60:63]
    ds_read_b128 v[84:87], v5 offset:43008
    v_mov_b32 v108, v16
    v_mfma_f32_16x16x32_bf16 v[52:55], v[212:215], v[88:91], v[52:55]
    buffer_load_dwordx4 v1, s[16:19], s42 offen offset:3072 sc1 lds
    v_mfma_f32_16x16x32_bf16 v[64:67], v[216:219], v[88:91], v[64:67]
    s_add_u32 s45, s45, 65536
    v_mov_b32 v109, v17
    v_mov_b32 v110, v18
    v_mfma_f32_16x16x32_bf16 v[72:75], v[216:219], v[92:95], v[72:75]
    v_mov_b32 v111, v19
    v_mov_b32 v112, v20
    v_mfma_f32_16x16x32_bf16 v[76:79], v[220:223], v[92:95], v[76:79]
    v_mov_b32 v113, v21
    v_mov_b32 v114, v22
    v_mfma_f32_16x16x32_bf16 v[68:71], v[220:223], v[88:91], v[68:71]
    s_waitcnt lgkmcnt(0)
    v_mov_b32 v115, v23
    v_mfma_f32_16x16x32_bf16 v[48:51], v[224:227], v[80:83], v[48:51]
    ds_read_b128 v[88:91], v4 offset:45056
    v_mfma_f32_16x16x32_bf16 v[56:59], v[224:227], v[84:87], v[56:59]
    v_mfma_f32_16x16x32_bf16 v[60:63], v[228:231], v[84:87], v[60:63]
    ds_read_b128 v[92:95], v5 offset:45056
    v_mfma_f32_16x16x32_bf16 v[52:55], v[228:231], v[80:83], v[52:55]
    v_mfma_f32_16x16x32_bf16 v[64:67], v[232:235], v[80:83], v[64:67]
    v_mfma_f32_16x16x32_bf16 v[72:75], v[232:235], v[84:87], v[72:75]
    v_mfma_f32_16x16x32_bf16 v[76:79], v[236:239], v[84:87], v[76:79]
    v_mfma_f32_16x16x32_bf16 v[68:71], v[236:239], v[80:83], v[68:71]
    s_waitcnt vmcnt(7) lgkmcnt(0)
    s_barrier
    v_mfma_f32_16x16x32_bf16 v[48:51], v[240:243], v[88:91], v[48:51]
    ds_read_b128 v[80:83], v2 offset:0
    v_mfma_f32_16x16x32_bf16 v[56:59], v[240:243], v[92:95], v[56:59]
    v_mfma_f32_16x16x32_bf16 v[60:63], v[244:247], v[92:95], v[60:63]
    ds_read_b128 v[84:87], v3 offset:0
    v_mfma_f32_16x16x32_bf16 v[52:55], v[244:247], v[88:91], v[52:55]
    v_mfma_f32_16x16x32_bf16 v[64:67], v[248:251], v[88:91], v[64:67]
    v_mfma_f32_16x16x32_bf16 v[72:75], v[248:251], v[92:95], v[72:75]
    v_mfma_f32_16x16x32_bf16 v[76:79], v[252:255], v[92:95], v[76:79]
    s_add_u32 s36, s36, 1
    v_mfma_f32_16x16x32_bf16 v[68:71], v[252:255], v[88:91], v[68:71]
    s_waitcnt lgkmcnt(0)
    s_cmp_lt_u32 s36, 32
    s_cbranch_scc1 L_bf_b0
    s_nop 7
    s_sub_u32 s47, s45, 196608
    s_max_u32 s47, s47, 0x5500000
    buffer_load_dword v13, v8, s[16:19], s47 offen sc1
    s_and_b32 s38, s53, 0xffffffff
    s_cmp_lt_i32 s36, 1
    s_cselect_b32 s38, 0x5e00000, s38
    buffer_load_dwordx4 v[116:119], v1, s[16:19], s38 offen sc1
    s_add_u32 s53, s53, 65536
    s_and_b32 s44, s90, 0xffffffff
    s_cmp_lt_i32 s36, 1
    s_cselect_b32 s44, 0x5e00000, s44
    s_xor_b32 s49, s44, 16384
    v_cvt_pk_bf16_f32 v56, v56, v57
    v_cvt_pk_bf16_f32 v57, v58, v59
    v_cvt_pk_bf16_f32 v58, v60, v61
    v_cvt_pk_bf16_f32 v59, v62, v63
    v_min_u32 v56, -2, v56
    v_min_u32 v57, -2, v57
    v_min_u32 v58, -2, v58
    v_min_u32 v59, -2, v59
    buffer_store_dwordx4 v[56:59], v1, s[16:19], s49 offen offset:0 sc1
    s_xor_b32 s49, s44, 32768
    v_cvt_pk_bf16_f32 v64, v64, v65
    v_cvt_pk_bf16_f32 v65, v66, v67
    v_cvt_pk_bf16_f32 v66, v68, v69
    v_cvt_pk_bf16_f32 v67, v70, v71
    v_min_u32 v64, -2, v64
    v_min_u32 v65, -2, v65
    v_min_u32 v66, -2, v66
    v_min_u32 v67, -2, v67
    buffer_store_dwordx4 v[64:67], v1, s[16:19], s49 offen offset:1024 sc1
    s_xor_b32 s49, s44, 49152
    v_cvt_pk_bf16_f32 v72, v72, v73
    v_cvt_pk_bf16_f32 v73, v74, v75
    v_cvt_pk_bf16_f32 v74, v76, v77
    v_cvt_pk_bf16_f32 v75, v78, v79
    v_min_u32 v72, -2, v72
    v_min_u32 v73, -2, v73
    v_min_u32 v74, -2, v74
    v_min_u32 v75, -2, v75
    buffer_store_dwordx4 v[72:75], v1, s[16:19], s49 offen offset:2048 sc1
    s_add_u32 s90, s90, 262144
    s_waitcnt vmcnt(4)
    v_cmp_ne_u32 vcc, 0, v13
    s_cbranch_vccnz L_spin67
L_back68:
    s_barrier
    s_sub_u32 s48, s90, 524288
    s_and_b32 s48, s48, 0xffffffff
    s_cmp_lt_i32 s36, 2
    s_cselect_b32 s48, s52, s48
    buffer_load_dwordx4 v[128:131], v1, s[16:19], s48 offen offset:0 sc1
    buffer_load_dwordx4 v[132:135], v1, s[16:19], s48 offen offset:1024 sc1
    buffer_load_dwordx4 v[136:139], v1, s[16:19], s48 offen offset:2048 sc1
    buffer_load_dwordx4 v[140:143], v1, s[16:19], s48 offen offset:3072 sc1
    s_sub_u32 s47, s36, 2
    s_cmp_lt_u32 s47, 16
    s_cselect_b32 s48, 0x5000000, s52
    s_add_u32 s20, s84, s48
    s_addc_u32 s21, s85, 0
    s_cmp_ge_i32 s47, 16
    s_cselect_b32 s20, s80, s20
    s_cselect_b32 s21, s81, s21
    s_and_b32 s48, s47, 15
    s_lshl_b32 s48, s48, 1
    s_sub_u32 s48, s50, s48
    s_lshl_b32 s46, s48, 10
    s_sub_u32 s46, s55, s46
    s_cmp_lt_u32 s47, 16
    s_cselect_b32 s46, s46, s52
    s_lshl_b32 s48, s48, 15
    v_mov_b32 v184, 0
    v_mov_b32 v185, 0
    v_mov_b32 v186, 0
    v_mov_b32 v187, 0
    v_mov_b32 v188, 0
    v_mov_b32 v189, 0
    v_mov_b32 v190, 0
    v_mov_b32 v191, 0
    v_mov_b32 v193, 0x3f80
    v_and_b32 v192, 1, v0
    v_lshlrev_b32 v192, 4, v192
    v_lshlrev_b32 v192, v192, v193
    s_mov_b32 exec_lo, 0x300003
    s_mov_b32 exec_hi, 0x30000300
    v_mov_b32 v184, v192
    v_mov_b32 v190, v192
    s_mov_b32 exec_lo, 0xc0000c
    s_mov_b32 exec_hi, 0xc0000c00
    v_mov_b32 v185, v192
    v_mov_b32 v191, v192
    s_mov_b64 exec, -1
    s_waitcnt vmcnt(7)
    v_mfma_f32_16x16x32_bf16 v[48:51], v[184:187], v[116:119], v[48:51]
    v_mfma_f32_16x16x32_bf16 v[52:55], v[188:191], v[116:119], v[52:55]
    s_waitcnt vmcnt(4)
    buffer_load_dwordx4 v[160:163], v1, s[16:19], s44 offen offset:0 sc1
    buffer_load_dwordx4 v[164:167], v1, s[16:19], s44 offen offset:1024 sc1
    buffer_load_dwordx4 v[168:171], v1, s[16:19], s44 offen offset:2048 sc1
    buffer_load_dwordx4 v[172:175], v1, s[16:19], s44 offen offset:3072 sc1
    s_waitcnt vmcnt(4)
    v_lshlrev_b32 v120, 16, v128
    v_and_b32 v121, s86, v128
    v_add_f32 v108, v108, v120
    v_add_f32 v109, v109, v121
    v_lshlrev_b32 v122, 16, v129
    v_and_b32 v123, s86, v129
    v_add_f32 v110, v110, v122
    v_add_f32 v111, v111, v123
    v_lshlrev_b32 v120, 16, v130
    v_and_b32 v121, s86, v130
    v_add_f32 v112, v112, v120
    v_add_f32 v113, v113, v121
    v_lshlrev_b32 v122, 16, v131
    v_and_b32 v123, s86, v131
    v_add_f32 v114, v114, v122
    v_add_f32 v115, v115, v123
    v_lshlrev_b32 v120, 16, v132
    v_and_b32 v121, s86, v132
    v_add_f32 v108, v108, v120
    v_add_f32 v109, v109, v121
    v_lshlrev_b32 v122, 16, v133
    v_and_b32 v123, s86, v133
    v_add_f32 v110, v110, v122
    v_add_f32 v111, v111, v123
    v_lshlrev_b32 v120, 16, v134
    v_and_b32 v121, s86, v134
    v_add_f32 v112, v112, v120
    v_add_f32 v113, v113, v121
    v_lshlrev_b32 v122, 16, v135
    v_and_b32 v123, s86, v135
    v_add_f32 v114, v114, v122
    v_add_f32 v115, v115, v123
    v_lshlrev_b32 v120, 16, v136
    v_and_b32 v121, s86, v136
    v_add_f32 v108, v108, v120
    v_add_f32 v109, v109, v121
    v_lshlrev_b32 v122, 16, v137
    v_and_b32 v123, s86, v137
    v_add_f32 v110, v110, v122
    v_add_f32 v111, v111, v123
    v_lshlrev_b32 v120, 16, v138
    v_and_b32 v121, s86, v138
    v_add_f32 v112, v112, v120
    v_add_f32 v113, v113, v121
    v_lshlrev_b32 v122, 16, v139
    v_and_b32 v123, s86, v139
    v_add_f32 v114, v114, v122
    v_add_f32 v115, v115, v123
    v_lshlrev_b32 v120, 16, v140
    v_and_b32 v121, s86, v140
    v_add_f32 v108, v108, v120
    v_add_f32 v109, v109, v121
    v_lshlrev_b32 v122, 16, v141
    v_and_b32 v123, s86, v141
    v_add_f32 v110, v110, v122
    v_add_f32 v111, v111, v123
    v_lshlrev_b32 v120, 16, v142
    v_and_b32 v121, s86, v142
    v_add_f32 v112, v112, v120
    v_add_f32 v113, v113, v121
    v_lshlrev_b32 v122, 16, v143
    v_and_b32 v123, s86, v143
    v_add_f32 v114, v114, v122
    v_add_f32 v115, v115, v123
    v_cvt_pk_bf16_f32 v128, v108, v109
    v_cvt_pk_bf16_f32 v129, v110, v111
    v_cvt_pk_bf16_f32 v130, v112, v113
    v_cvt_pk_bf16_f32 v131, v114, v115
    s_waitcnt vmcnt(0)
    v_max3_u32 v176, v160, v161, v162
    v_max3_u32 v177, v163, v164, v165
    v_max3_u32 v178, v166, v167, v168
    v_max3_u32 v179, v169, v170, v171
    v_max3_u32 v180, v172, v173, v174
    v_max3_u32 v176, v176, v177, v178
    v_max3_u32 v179, v179, v180, v175
    v_max_u32 v176, v176, v179
    v_cmp_eq_u32 vcc, -1, v176
    s_cbranch_vccnz L_gspin69
L_gback70:
    buffer_store_dwordx4 v[128:131], v9, s[20:23], s48 offen sc1
    v_mfma_f32_16x16x32_bf16 v[48:51], v[184:187], v[160:163], v[48:51]
    v_mfma_f32_16x16x32_bf16 v[52:55], v[188:191], v[160:163], v[52:55]
    v_mfma_f32_16x16x32_bf16 v[48:51], v[184:187], v[164:167], v[48:51]
    v_mfma_f32_16x16x32_bf16 v[52:55], v[188:191], v[164:167], v[52:55]
    v_mfma_f32_16x16x32_bf16 v[48:51], v[184:187], v[168:171], v[48:51]
    v_mfma_f32_16x16x32_bf16 v[52:55], v[188:191], v[168:171], v[52:55]
    v_mfma_f32_16x16x32_bf16 v[48:51], v[184:187], v[172:175], v[48:51]
    v_mfma_f32_16x16x32_bf16 v[52:55], v[188:191], v[172:175], v[52:55]
    s_sub_u32 s48, s48, 65536
    s_nop 4
    v_cvt_pk_bf16_f32 v160, v48, v49
    v_cvt_pk_bf16_f32 v161, v50, v51
    v_cvt_pk_bf16_f32 v162, v52, v53
    v_cvt_pk_bf16_f32 v163, v54, v55
    buffer_store_dwordx4 v[160:163], v9, s[20:23], s48 offen sc1
    s_waitcnt vmcnt(0)
    s_endpgm
L_spin53:
    s_mov_b32 s40, 0x20000
L_spin53_l:
    buffer_load_dword v8, v124, s[20:23], 0 offen sc1
    s_sub_u32 s40, s40, 1
    s_waitcnt vmcnt(0)
    v_cmp_eq_u32 vcc, v124, v8
    s_cbranch_scc1 L_back54
    s_cbranch_vccz L_back54
    s_sleep 8
    s_branch L_spin53_l
L_spin55:
    s_mov_b32 s40, 0x20000
L_spin55_l:
    buffer_load_dword v69, v68, s[20:23], 0 offen sc1
    s_sub_u32 s40, s40, 1
    s_waitcnt vmcnt(0)
    v_cmp_eq_u32 vcc, v68, v69
    s_cbranch_scc1 L_back56
    s_cbranch_vccz L_back56
    s_sleep 8
    s_branch L_spin55_l
L_spin57:
    s_mov_b32 s40, 0x20000
L_spin57_l:
    buffer_load_dword v96, v6, s[16:19], s45 offen sc1
    s_sub_u32 s40, s40, 1
    s_waitcnt vmcnt(0)
    v_cmp_ne_u32 vcc, 0, v96
    s_cbranch_scc1 L_back58
    s_cbranch_vccz L_back58
    s_sleep 2
    s_branch L_spin57_l
L_spin59:
    s_mov_b32 s40, 0x20000
L_spin59_l:
    buffer_load_dword v13, v8, s[16:19], s47 offen sc1
    s_sub_u32 s40, s40, 1
    s_waitcnt vmcnt(0)
    v_cmp_ne_u32 vcc, 0, v13
    s_cbranch_scc1 L_back60
    s_cbranch_vccz L_back60
    s_sleep 2
    s_branch L_spin59_l
L_spin61:
    s_mov_b32 s40, 0x20000
L_spin61_l:
    buffer_load_dword v96, v6, s[16:19], s45 offen sc1
    s_sub_u32 s40, s40, 1
    s_waitcnt vmcnt(0)
    v_cmp_ne_u32 vcc, 0, v96
    s_cbranch_scc1 L_back62
    s_cbranch_vccz L_back62
    s_sleep 2
    s_branch L_spin61_l
L_spin63:
    s_mov_b32 s40, 0x20000
L_spin63_l:
    buffer_load_dword v13, v8, s[16:19], s47 offen sc1
    s_sub_u32 s40, s40, 1
    s_waitcnt vmcnt(0)
    v_cmp_ne_u32 vcc, 0, v13
    s_cbranch_scc1 L_back64
    s_cbranch_vccz L_back64
    s_sleep 2
    s_branch L_spin63_l
L_spin65:
    s_mov_b32 s40, 0x20000
L_spin65_l:
    buffer_load_dword v96, v6, s[16:19], s45 offen sc1
    s_sub_u32 s40, s40, 1
    s_waitcnt vmcnt(0)
    v_cmp_ne_u32 vcc, 0, v96
    s_cbranch_scc1 L_back66
    s_cbranch_vccz L_back66
    s_sleep 2
    s_branch L_spin65_l
L_spin67:
    s_mov_b32 s40, 0x20000
L_spin67_l:
    buffer_load_dword v13, v8, s[16:19], s47 offen sc1
    s_sub_u32 s40, s40, 1
    s_waitcnt vmcnt(0)
    v_cmp_ne_u32 vcc, 0, v13
    s_cbranch_scc1 L_back68
    s_cbranch_vccz L_back68
    s_sleep 2
    s_branch L_spin67_l
L_gspin69:
    s_mov_b32 s40, 0x20000
L_gspin69_l:
    buffer_load_dwordx4 v[160:163], v1, s[16:19], s44 offen offset:0 sc1
    buffer_load_dwordx4 v[164:167], v1, s[16:19], s44 offen offset:1024 sc1
    buffer_load_dwordx4 v[168:171], v1, s[16:19], s44 offen offset:2048 sc1
    buffer_load_dwordx4 v[172:175], v1, s[16:19], s44 offen offset:3072 sc1
    s_sub_u32 s40, s40, 1
    s_waitcnt vmcnt(0)
    v_max3_u32 v176, v160, v161, v162
    v_max3_u32 v177, v163, v164, v165
    v_max3_u32 v178, v166, v167, v168
    v_max3_u32 v179, v169, v170, v171
    v_max3_u32 v180, v172, v173, v174
    v_max3_u32 v176, v176, v177, v178
    v_max3_u32 v179, v179, v180, v175
    v_max_u32 v176, v176, v179
    v_cmp_eq_u32 vcc, -1, v176
    s_cbranch_scc1 L_gback70
    s_cbranch_vccz L_gback70
    s_sleep 2
    s_branch L_gspin69_l
L_role_60:
    s_sub_u32 s35, s34, 44
    s_barrier
    s_add_u32 s12, s72, 0x400000
    s_addc_u32 s13, s73, 0
    s_mov_b32 s14, 0x300000
    s_mov_b32 s15, 0x00020000
    s_sub_u32 s37, s35, 12
    s_lshl2_add_u32 s37, s37, s33
    s_lshl2_add_u32 s37, s37, s32
    s_lshl_b32 s37, s37, 13
    v_lshlrev_b32 v6, 7, v0
    buffer_load_dword v240, v6, s[12:15], s37 offen
    s_add_u32 s37, s37, 1048576
    buffer_load_dword v241, v6, s[12:15], s37 offen
    s_add_u32 s37, s37, 1048576
    buffer_load_dword v242, v6, s[12:15], s37 offen
    s_add_u32 s37, s37, 1048576
    s_lshr_b32 s51, s35, 2
    s_and_b32 s87, s35, 3
    s_mul_i32 s54, s51, 1507328
    s_lshl_b32 s37, s87, 9
    s_add_u32 s54, s54, s37
    s_mov_b32 s12, s76
    s_mov_b32 s13, s77
    s_mov_b32 s14, 0x700000
    s_mov_b32 s15, 0x00020000
    s_mov_b32 s39, 2048
    v_lshrrev_b32 v64, 3, v0
    v_lshlrev_b32 v65, 2, v0
    v_and_b32 v65, 64, v65
    v_and_b32 v66, 0x70, v1
    v_xor_b32 v65, v65, v66
    v_mad_u32_u24 v48, v64, s39, v65
    v_add_u32 v49, 16384, v48
    v_add_u32 v50, 128, v48
    v_add_u32 v51, 16512, v48
    v_add_u32 v52, 256, v48
    v_add_u32 v53, 16640, v48
    v_add_u32 v54, 384, v48
    v_add_u32 v55, 16768, v48
    s_mul_i32 s38, s32, 32768
    s_add_u32 s54, s54, s38
    s_lshl_b32 s42, s32, 11
    s_add_u32 m0, s42, 0
    s_nop 0
    buffer_load_dwordx4 v48, s[12:15], s54 offen lds
    s_add_u32 m0, s42, 1024
    s_nop 0
    buffer_load_dwordx4 v49, s[12:15], s54 offen lds
    s_add_u32 m0, s42, 8192
    s_nop 0
    buffer_load_dwordx4 v50, s[12:15], s54 offen lds
    s_add_u32 m0, s42, 9216
    s_nop 0
    buffer_load_dwordx4 v51, s[12:15], s54 offen lds
    s_add_u32 m0, s42, 16384
    s_nop 0
    buffer_load_dwordx4 v52, s[12:15], s54 offen lds
    s_add_u32 m0, s42, 17408
    s_nop 0
    buffer_load_dwordx4 v53, s[12:15], s54 offen lds
    s_add_u32 m0, s42, 24576
    s_nop 0
    buffer_load_dwordx4 v54, s[12:15], s54 offen lds
    s_add_u32 m0, s42, 25600
    s_nop 0
    buffer_load_dwordx4 v55, s[12:15], s54 offen lds
    s_add_u32 s54, s54, 131072
    s_add_u32 m0, s42, 32768
    s_nop 0
    buffer_load_dwordx4 v48, s[12:15], s54 offen lds
    s_add_u32 m0, s42, 33792
    s_nop 0
    buffer_load_dwordx4 v49, s[12:15], s54 offen lds
    s_add_u32 m0, s42, 40960
    s_nop 0
    buffer_load_dwordx4 v50, s[12:15], s54 offen lds
    s_add_u32 m0, s42, 41984
    s_nop 0
    buffer_load_dwordx4 v51, s[12:15], s54 offen lds
    s_add_u32 m0, s42, 49152
    s_nop 0
    buffer_load_dwordx4 v52, s[12:15], s54 offen lds
    s_add_u32 m0, s42, 50176
    s_nop 0
    buffer_load_dwordx4 v53, s[12:15], s54 offen lds
    s_add_u32 m0, s42, 57344
    s_nop 0
    buffer_load_dwordx4 v54, s[12:15], s54 offen lds
    s_add_u32 m0, s42, 58368
    s_nop 0
    buffer_load_dwordx4 v55, s[12:15], s54 offen lds
    s_add_u32 s54, s54, 131072
    s_add_u32 m0, s42, 65536
    s_nop 0
    buffer_load_dwordx4 v48, s[12:15], s54 offen lds
    s_add_u32 m0, s42, 66560
    s_nop 0
    buffer_load_dwordx4 v49, s[12:15], s54 offen lds
    s_add_u32 m0, s42, 73728
    s_nop 0
    buffer_load_dwordx4 v50, s[12:15], s54 offen lds
    s_add_u32 m0, s42, 74752
    s_nop 0
    buffer_load_dwordx4 v51, s[12:15], s54 offen lds
    s_add_u32 m0, s42, 81920
    s_nop 0
    buffer_load_dwordx4 v52, s[12:15], s54 offen lds
    s_add_u32 m0, s42, 82944
    s_nop 0
    buffer_load_dwordx4 v53, s[12:15], s54 offen lds
    s_add_u32 m0, s42, 90112
    s_nop 0
    buffer_load_dwordx4 v54, s[12:15], s54 offen lds
    s_add_u32 m0, s42, 91136
    s_nop 0
    buffer_load_dwordx4 v55, s[12:15], s54 offen lds
    s_add_u32 s54, s54, 131072
    s_add_u32 m0, s42, 98304
    s_nop 0
    buffer_load_dwordx4 v48, s[12:15], s54 offen lds
    s_add_u32 m0, s42, 99328
    s_nop 0
    buffer_load_dwordx4 v49, s[12:15], s54 offen lds
    s_add_u32 m0, s42, 106496
    s_nop 0
    buffer_load_dwordx4 v50, s[12:15], s54 offen lds
    s_add_u32 m0, s42, 107520
    s_nop 0
    buffer_load_dwordx4 v51, s[12:15], s54 offen lds
    s_add_u32 m0, s42, 114688
    s_nop 0
    buffer_load_dwordx4 v52, s[12:15], s54 offen lds
    s_add_u32 m0, s42, 115712
    s_nop 0
    buffer_load_dwordx4 v53, s[12:15], s54 offen lds
    s_add_u32 m0, s42, 122880
    s_nop 0
    buffer_load_dwordx4 v54, s[12:15], s54 offen lds
    s_add_u32 m0, s42, 123904
    s_nop 0
    buffer_load_dwordx4 v55, s[12:15], s54 offen lds
    s_add_u32 s54, s54, 131072
    v_lshrrev_b32 v64, 4, v0
    v_bfe_u32 v65, v0, 2, 2
    v_lshl_add_u32 v64, v64, 3, v65
    v_lshlrev_b32 v64, 7, v64
    v_lshrrev_b32 v65, 1, v65
    v_lshl_add_u32 v64, v65, 6, v64
    v_and_b32 v65, 3, v0
    v_lshl_add_u32 v64, v65, 4, v64
    s_lshl_b32 s37, s32, 13
    s_and_b32 s38, s51, 2
    s_lshl_b32 s38, s38, 5
    s_xor_b32 s38, s38, 0
    s_add_u32 s37, s37, s38
    v_xor_b32 v56, s37, v64
    s_lshl_b32 s37, s32, 13
    s_and_b32 s38, s51, 2
    s_lshl_b32 s38, s38, 5
    s_xor_b32 s38, s38, 8
    s_add_u32 s37, s37, s38
    v_xor_b32 v57, s37, v64
    s_lshl_b32 s37, s32, 13
    s_and_b32 s38, s51, 2
    s_lshl_b32 s38, s38, 5
    s_xor_b32 s38, s38, 64
    s_add_u32 s37, s37, s38
    v_xor_b32 v58, s37, v64
    s_lshl_b32 s37, s32, 13
    s_and_b32 s38, s51, 2
    s_lshl_b32 s38, s38, 5
    s_xor_b32 s38, s38, 72
    s_add_u32 s37, s37, s38
    v_xor_b32 v59, s37, v64
    s_and_b32 s39, s51, 1
    s_lshl_b32 s37, s39, 10
    v_add_u32 v2, s37, v1
    v_xor_b32 v3, 1024, v2
    v_add_u32 v4, 98304, v2
    v_add_u32 v5, 98304, v3
    s_mul_i32 s38, s51, 11*43
    s_lshr_b32 s38, s38, 7
    s_add_u32 s38, s38, 24
    s_lshl_b32 s37, s33, 6
    s_add_u32 s37, s37, s38
    s_lshl_b32 s37, s37, 7
    v_lshl_add_u32 v6, v0, 7, s37
    s_cmp_eq_u32 s32, 0
    s_cselect_b32 s37, 6, 0
    v_cmp_le_u32 vcc, s37, v0
    s_nop 1
    v_cndmask_b32 v6, v6, 2.0, vcc
    s_mul_i32 s43, s32, 4096
    s_mul_i32 s88, s32, 2048
    s_sub_u32 s89, s88, s43
    s_mul_i32 s41, s33, 8388608
    s_add_u32 s41, s41, 0x1000000
    s_mul_i32 s37, s51, 47104
    s_add_u32 s41, s41, s37
    s_add_u32 s41, s41, s43
    s_mul_i32 s90, s33, 8388608
    s_add_u32 s90, s90, 0x2fc0000
    s_lshl_b32 s37, s87, 16
    s_add_u32 s90, s90, s37
    s_lshl_b32 s37, s32, 12
    s_add_u32 s90, s90, s37
    s_and_b32 s37, s51, 3
    s_lshl_b32 s37, s37, 14
    s_add_u32 s90, s90, s37
    s_add_u32 s20, s82, 0x80
    s_addc_u32 s21, s83, 0
    s_mov_b32 s22, 0x80
    s_mov_b32 s23, 0x00020000
    v_lshl_add_u32 v68, s32, 7, v124
    v_add_u32 v60, 0, v56
    v_add_u32 v61, 0, v57
    v_add_u32 v62, 0, v58
    v_add_u32 v63, 0, v59
    s_waitcnt vmcnt(24)
    s_barrier
    ds_read_b64_tr_b16 a[0:1], v60 offset:0
    ds_read_b64_tr_b16 a[2:3], v60 offset:512
    ds_read_b64_tr_b16 a[4:5], v61 offset:0
    ds_read_b64_tr_b16 a[6:7], v61 offset:512
    ds_read_b64_tr_b16 a[8:9], v62 offset:0
    ds_read_b64_tr_b16 a[10:11], v62 offset:512
    ds_read_b64_tr_b16 a[12:13], v63 offset:0
    ds_read_b64_tr_b16 a[14:15], v63 offset:512
    ds_read_b64_tr_b16 a[16:17], v60 offset:4096
    ds_read_b64_tr_b16 a[18:19], v60 offset:4608
    ds_read_b64_tr_b16 a[20:21], v61 offset:4096
    ds_read_b64_tr_b16 a[22:23], v61 offset:4608
    ds_read_b64_tr_b16 a[24:25], v62 offset:4096
    ds_read_b64_tr_b16 a[26:27], v62 offset:4608
    ds_read_b64_tr_b16 a[28:29], v63 offset:4096
    ds_read_b64_tr_b16 a[30:31], v63 offset:4608
    s_add_u32 m0, s42, 131072
    s_nop 0
    buffer_load_dwordx4 v48, s[12:15], s54 offen lds
    s_add_u32 m0, s42, 132096
    s_nop 0
    buffer_load_dwordx4 v49, s[12:15], s54 offen lds
    s_add_u32 m0, s42, 139264
    s_nop 0
    buffer_load_dwordx4 v50, s[12:15], s54 offen lds
    s_add_u32 m0, s42, 140288
    s_nop 0
    buffer_load_dwordx4 v51, s[12:15], s54 offen lds
    s_add_u32 m0, s42, 147456
    s_nop 0
    buffer_load_dwordx4 v52, s[12:15], s54 offen lds
    s_add_u32 m0, s42, 148480
    s_nop 0
    buffer_load_dwordx4 v53, s[12:15], s54 offen lds
    s_add_u32 m0, s42, 155648
    s_nop 0
    buffer_load_dwordx4 v54, s[12:15], s54 offen lds
    s_add_u32 m0, s42, 156672
    s_nop 0
    buffer_load_dwordx4 v55, s[12:15], s54 offen lds
    s_add_u32 s54, s54, 131072
    s_waitcnt lgkmcnt(0)
    v_add_u32 v60, 32768, v56
    v_add_u32 v61, 32768, v57
    v_add_u32 v62, 32768, v58
    v_add_u32 v63, 32768, v59
    s_waitcnt vmcnt(24)
    s_barrier
    ds_read_b64_tr_b16 a[32:33], v60 offset:0
    ds_read_b64_tr_b16 a[34:35], v60 offset:512
    ds_read_b64_tr_b16 a[36:37], v61 offset:0
    ds_read_b64_tr_b16 a[38:39], v61 offset:512
    ds_read_b64_tr_b16 a[40:41], v62 offset:0
    ds_read_b64_tr_b16 a[42:43], v62 offset:512
    ds_read_b64_tr_b16 a[44:45], v63 offset:0
    ds_read_b64_tr_b16 a[46:47], v63 offset:512
    ds_read_b64_tr_b16 a[48:49], v60 offset:4096
    ds_read_b64_tr_b16 a[50:51], v60 offset:4608
    ds_read_b64_tr_b16 a[52:53], v61 offset:4096
    ds_read_b64_tr_b16 a[54:55], v61 offset:4608
    ds_read_b64_tr_b16 a[56:57], v62 offset:4096
    ds_read_b64_tr_b16 a[58:59], v62 offset:4608
    ds_read_b64_tr_b16 a[60:61], v63 offset:4096
    ds_read_b64_tr_b16 a[62:63], v63 offset:4608
    s_add_u32 m0, s42, 0
    s_nop 0
    buffer_load_dwordx4 v48, s[12:15], s54 offen lds
    s_add_u32 m0, s42, 1024
    s_nop 0
    buffer_load_dwordx4 v49, s[12:15], s54 offen lds
    s_add_u32 m0, s42, 8192
    s_nop 0
    buffer_load_dwordx4 v50, s[12:15], s54 offen lds
    s_add_u32 m0, s42, 9216
    s_nop 0
    buffer_load_dwordx4 v51, s[12:15], s54 offen lds
    s_add_u32 m0, s42, 16384
    s_nop 0
    buffer_load_dwordx4 v52, s[12:15], s54 offen lds
    s_add_u32 m0, s42, 17408
    s_nop 0
    buffer_load_dwordx4 v53, s[12:15], s54 offen lds
    s_add_u32 m0, s42, 24576
    s_nop 0
    buffer_load_dwordx4 v54, s[12:15], s54 offen lds
    s_add_u32 m0, s42, 25600
    s_nop 0
    buffer_load_dwordx4 v55, s[12:15], s54 offen lds
    s_add_u32 s54, s54, 131072
    s_waitcnt lgkmcnt(0)
    v_add_u32 v60, 65536, v56
    v_add_u32 v61, 65536, v57
    v_add_u32 v62, 65536, v58
    v_add_u32 v63, 65536, v59
    s_waitcnt vmcnt(24)
    s_barrier
    ds_read_b64_tr_b16 a[64:65], v60 offset:0
    ds_read_b64_tr_b16 a[66:67], v60 offset:512
    ds_read_b64_tr_b16 a[68:69], v61 offset:0
    ds_read_b64_tr_b16 a[70:71], v61 offset:512
    ds_read_b64_tr_b16 a[72:73], v62 offset:0
    ds_read_b64_tr_b16 a[74:75], v62 offset:512
    ds_read_b64_tr_b16 a[76:77], v63 offset:0
    ds_read_b64_tr_b16 a[78:79], v63 offset:512
    ds_read_b64_tr_b16 a[80:81], v60 offset:4096
    ds_read_b64_tr_b16 a[82:83], v60 offset:4608
    ds_read_b64_tr_b16 a[84:85], v61 offset:4096
    ds_read_b64_tr_b16 a[86:87], v61 offset:4608
    ds_read_b64_tr_b16 a[88:89], v62 offset:4096
    ds_read_b64_tr_b16 a[90:91], v62 offset:4608
    ds_read_b64_tr_b16 a[92:93], v63 offset:4096
    ds_read_b64_tr_b16 a[94:95], v63 offset:4608
    s_add_u32 m0, s42, 32768
    s_nop 0
    buffer_load_dwordx4 v48, s[12:15], s54 offen lds
    s_add_u32 m0, s42, 33792
    s_nop 0
    buffer_load_dwordx4 v49, s[12:15], s54 offen lds
    s_add_u32 m0, s42, 40960
    s_nop 0
    buffer_load_dwordx4 v50, s[12:15], s54 offen lds
    s_add_u32 m0, s42, 41984
    s_nop 0
    buffer_load_dwordx4 v51, s[12:15], s54 offen lds
    s_add_u32 m0, s42, 49152
    s_nop 0
    buffer_load_dwordx4 v52, s[12:15], s54 offen lds
    s_add_u32 m0, s42, 50176
    s_nop 0
    buffer_load_dwordx4 v53, s[12:15], s54 offen lds
    s_add_u32 m0, s42, 57344
    s_nop 0
    buffer_load_dwordx4 v54, s[12:15], s54 offen lds
    s_add_u32 m0, s42, 58368
    s_nop 0
    buffer_load_dwordx4 v55, s[12:15], s54 offen lds
    s_add_u32 s54, s54, 131072
    s_waitcnt lgkmcnt(0)
    v_add_u32 v60, 98304, v56
    v_add_u32 v61, 98304, v57
    v_add_u32 v62, 98304, v58
    v_add_u32 v63, 98304, v59
    s_waitcnt vmcnt(24)
    s_barrier
    ds_read_b64_tr_b16 a[96:97], v60 offset:0
    ds_read_b64_tr_b16 a[98:99], v60 offset:512
    ds_read_b64_tr_b16 a[100:101], v61 offset:0
    ds_read_b64_tr_b16 a[102:103], v61 offset:512
    ds_read_b64_tr_b16 a[104:105], v62 offset:0
    ds_read_b64_tr_b16 a[106:107], v62 offset:512
    ds_read_b64_tr_b16 a[108:109], v63 offset:0
    ds_read_b64_tr_b16 a[110:111], v63 offset:512
    ds_read_b64_tr_b16 a[112:113], v60 offset:4096
    ds_read_b64_tr_b16 a[114:115], v60 offset:4608
    ds_read_b64_tr_b16 a[116:117], v61 offset:4096
    ds_read_b64_tr_b16 a[118:119], v61 offset:4608
    ds_read_b64_tr_b16 a[120:121], v62 offset:4096
    ds_read_b64_tr_b16 a[122:123], v62 offset:4608
    ds_read_b64_tr_b16 a[124:125], v63 offset:4096
    ds_read_b64_tr_b16 a[126:127], v63 offset:4608
    s_add_u32 m0, s42, 65536
    s_nop 0
    buffer_load_dwordx4 v48, s[12:15], s54 offen lds
    s_add_u32 m0, s42, 66560
    s_nop 0
    buffer_load_dwordx4 v49, s[12:15], s54 offen lds
    s_add_u32 m0, s42, 73728
    s_nop 0
    buffer_load_dwordx4 v50, s[12:15], s54 offen lds
    s_add_u32 m0, s42, 74752
    s_nop 0
    buffer_load_dwordx4 v51, s[12:15], s54 offen lds
    s_add_u32 m0, s42, 81920
    s_nop 0
    buffer_load_dwordx4 v52, s[12:15], s54 offen lds
    s_add_u32 m0, s42, 82944
    s_nop 0
    buffer_load_dwordx4 v53, s[12:15], s54 offen lds
    s_add_u32 m0, s42, 90112
    s_nop 0
    buffer_load_dwordx4 v54, s[12:15], s54 offen lds
    s_add_u32 m0, s42, 91136
    s_nop 0
    buffer_load_dwordx4 v55, s[12:15], s54 offen lds
    s_add_u32 s54, s54, 131072
    s_waitcnt lgkmcnt(0)
    v_add_u32 v60, 131072, v56
    v_add_u32 v61, 131072, v57
    v_add_u32 v62, 131072, v58
    v_add_u32 v63, 131072, v59
    s_waitcnt vmcnt(24)
    s_barrier
    ds_read_b64_tr_b16 a[128:129], v60 offset:0
    ds_read_b64_tr_b16 a[130:131], v60 offset:512
    ds_read_b64_tr_b16 a[132:133], v61 offset:0
    ds_read_b64_tr_b16 a[134:135], v61 offset:512
    ds_read_b64_tr_b16 a[136:137], v62 offset:0
    ds_read_b64_tr_b16 a[138:139], v62 offset:512
    ds_read_b64_tr_b16 a[140:141], v63 offset:0
    ds_read_b64_tr_b16 a[142:143], v63 offset:512
    ds_read_b64_tr_b16 a[144:145], v60 offset:4096
    ds_read_b64_tr_b16 a[146:147], v60 offset:4608
    ds_read_b64_tr_b16 a[148:149], v61 offset:4096
    ds_read_b64_tr_b16 a[150:151], v61 offset:4608
    ds_read_b64_tr_b16 a[152:153], v62 offset:4096
    ds_read_b64_tr_b16 a[154:155], v62 offset:4608
    ds_read_b64_tr_b16 a[156:157], v63 offset:4096
    ds_read_b64_tr_b16 a[158:159], v63 offset:4608
    s_add_u32 m0, s42, 98304
    s_nop 0
    buffer_load_dwordx4 v48, s[12:15], s54 offen lds
    s_add_u32 m0, s42, 99328
    s_nop 0
    buffer_load_dwordx4 v49, s[12:15], s54 offen lds
    s_add_u32 m0, s42, 106496
    s_nop 0
    buffer_load_dwordx4 v50, s[12:15], s54 offen lds
    s_add_u32 m0, s42, 107520
    s_nop 0
    buffer_load_dwordx4 v51, s[12:15], s54 offen lds
    s_add_u32 m0, s42, 114688
    s_nop 0
    buffer_load_dwordx4 v52, s[12:15], s54 offen lds
    s_add_u32 m0, s42, 115712
    s_nop 0
    buffer_load_dwordx4 v53, s[12:15], s54 offen lds
    s_add_u32 m0, s42, 122880
    s_nop 0
    buffer_load_dwordx4 v54, s[12:15], s54 offen lds
    s_add_u32 m0, s42, 123904
    s_nop 0
    buffer_load_dwordx4 v55, s[12:15], s54 offen lds
    s_add_u32 s54, s54, 131072
    s_waitcnt lgkmcnt(0)
    v_add_u32 v60, 0, v56
    v_add_u32 v61, 0, v57
    v_add_u32 v62, 0, v58
    v_add_u32 v63, 0, v59
    s_waitcnt vmcnt(24)
    s_barrier
    ds_read_b64_tr_b16 a[160:161], v60 offset:0
    ds_read_b64_tr_b16 a[162:163], v60 offset:512
    ds_read_b64_tr_b16 a[164:165], v61 offset:0
    ds_read_b64_tr_b16 a[166:167], v61 offset:512
    ds_read_b64_tr_b16 a[168:169], v62 offset:0
    ds_read_b64_tr_b16 a[170:171], v62 offset:512
    ds_read_b64_tr_b16 a[172:173], v63 offset:0
    ds_read_b64_tr_b16 a[174:175], v63 offset:512
    ds_read_b64_tr_b16 a[176:177], v60 offset:4096
    ds_read_b64_tr_b16 a[178:179], v60 offset:4608
    ds_read_b64_tr_b16 a[180:181], v61 offset:4096
    ds_read_b64_tr_b16 a[182:183], v61 offset:4608
    ds_read_b64_tr_b16 a[184:185], v62 offset:4096
    ds_read_b64_tr_b16 a[186:187], v62 offset:4608
    ds_read_b64_tr_b16 a[188:189], v63 offset:4096
    ds_read_b64_tr_b16 a[190:191], v63 offset:4608
    buffer_load_dword v69, v68, s[20:23], 0 offen sc1
    s_add_u32 m0, s42, 131072
    s_nop 0
    buffer_load_dwordx4 v48, s[12:15], s54 offen lds
    s_add_u32 m0, s42, 132096
    s_nop 0
    buffer_load_dwordx4 v49, s[12:15], s54 offen lds
    s_add_u32 m0, s42, 139264
    s_nop 0
    buffer_load_dwordx4 v50, s[12:15], s54 offen lds
    s_add_u32 m0, s42, 140288
    s_nop 0
    buffer_load_dwordx4 v51, s[12:15], s54 offen lds
    s_add_u32 m0, s42, 147456
    s_nop 0
    buffer_load_dwordx4 v52, s[12:15], s54 offen lds
    s_add_u32 m0, s42, 148480
    s_nop 0
    buffer_load_dwordx4 v53, s[12:15], s54 offen lds
    s_add_u32 m0, s42, 155648
    s_nop 0
    buffer_load_dwordx4 v54, s[12:15], s54 offen lds
    s_add_u32 m0, s42, 156672
    s_nop 0
    buffer_load_dwordx4 v55, s[12:15], s54 offen lds
    s_add_u32 s54, s54, 131072
    s_waitcnt lgkmcnt(0)
    v_add_u32 v60, 32768, v56
    v_add_u32 v61, 32768, v57
    v_add_u32 v62, 32768, v58
    v_add_u32 v63, 32768, v59
    s_waitcnt vmcnt(25)
    s_barrier
    ds_read_b64_tr_b16 a[192:193], v60 offset:0
    ds_read_b64_tr_b16 a[194:195], v60 offset:512
    ds_read_b64_tr_b16 a[196:197], v61 offset:0
    ds_read_b64_tr_b16 a[198:199], v61 offset:512
    ds_read_b64_tr_b16 a[200:201], v62 offset:0
    ds_read_b64_tr_b16 a[202:203], v62 offset:512
    ds_read_b64_tr_b16 a[204:205], v63 offset:0
    ds_read_b64_tr_b16 a[206:207], v63 offset:512
    ds_read_b64_tr_b16 a[208:209], v60 offset:4096
    ds_read_b64_tr_b16 a[210:211], v60 offset:4608
    ds_read_b64_tr_b16 a[212:213], v61 offset:4096
    ds_read_b64_tr_b16 a[214:215], v61 offset:4608
    ds_read_b64_tr_b16 a[216:217], v62 offset:4096
    ds_read_b64_tr_b16 a[218:219], v62 offset:4608
    ds_read_b64_tr_b16 a[220:221], v63 offset:4096
    ds_read_b64_tr_b16 a[222:223], v63 offset:4608
    s_waitcnt lgkmcnt(0)
    v_add_u32 v60, 65536, v56
    v_add_u32 v61, 65536, v57
    v_add_u32 v62, 65536, v58
    v_add_u32 v63, 65536, v59
    s_waitcnt vmcnt(17)
    s_barrier
    ds_read_b64_tr_b16 a[224:225], v60 offset:0
    ds_read_b64_tr_b16 a[226:227], v60 offset:512
    ds_read_b64_tr_b16 a[228:229], v61 offset:0
    ds_read_b64_tr_b16 a[230:231], v61 offset:512
    ds_read_b64_tr_b16 a[232:233], v62 offset:0
    ds_read_b64_tr_b16 a[234:235], v62 offset:512
    ds_read_b64_tr_b16 a[236:237], v63 offset:0
    ds_read_b64_tr_b16 a[238:239], v63 offset:512
    ds_read_b64_tr_b16 a[240:241], v60 offset:4096
    ds_read_b64_tr_b16 a[242:243], v60 offset:4608
    ds_read_b64_tr_b16 a[244:245], v61 offset:4096
    ds_read_b64_tr_b16 a[246:247], v61 offset:4608
    ds_read_b64_tr_b16 a[248:249], v62 offset:4096
    ds_read_b64_tr_b16 a[250:251], v62 offset:4608
    ds_read_b64_tr_b16 a[252:253], v63 offset:4096
    ds_read_b64_tr_b16 a[254:255], v63 offset:4608
    s_waitcnt lgkmcnt(0)
    v_add_u32 v60, 98304, v56
    v_add_u32 v61, 98304, v57
    v_add_u32 v62, 98304, v58
    v_add_u32 v63, 98304, v59
    s_waitcnt vmcnt(9)
    s_barrier
    ds_read_b64_tr_b16 v[128:129], v60 offset:0
    ds_read_b64_tr_b16 v[130:131], v60 offset:512
    ds_read_b64_tr_b16 v[132:133], v61 offset:0
    ds_read_b64_tr_b16 v[134:135], v61 offset:512
    ds_read_b64_tr_b16 v[136:137], v62 offset:0
    ds_read_b64_tr_b16 v[138:139], v62 offset:512
    ds_read_b64_tr_b16 v[140:141], v63 offset:0
    ds_read_b64_tr_b16 v[142:143], v63 offset:512
    ds_read_b64_tr_b16 v[144:145], v60 offset:4096
    ds_read_b64_tr_b16 v[146:147], v60 offset:4608
    ds_read_b64_tr_b16 v[148:149], v61 offset:4096
    ds_read_b64_tr_b16 v[150:151], v61 offset:4608
    ds_read_b64_tr_b16 v[152:153], v62 offset:4096
    ds_read_b64_tr_b16 v[154:155], v62 offset:4608
    ds_read_b64_tr_b16 v[156:157], v63 offset:4096
    ds_read_b64_tr_b16 v[158:159], v63 offset:4608
    s_waitcnt lgkmcnt(0)
    v_add_u32 v60, 131072, v56
    v_add_u32 v61, 131072, v57
    v_add_u32 v62, 131072, v58
    v_add_u32 v63, 131072, v59
    s_waitcnt vmcnt(0)
    v_cmp_eq_u32 vcc, v68, v69
    s_cbranch_vccnz L_spin71
L_back72:
    s_barrier
    ds_read_b64_tr_b16 v[160:161], v60 offset:0
    ds_read_b64_tr_b16 v[162:163], v60 offset:512
    ds_read_b64_tr_b16 v[164:165], v61 offset:0
    ds_read_b64_tr_b16 v[166:167], v61 offset:512
    ds_read_b64_tr_b16 v[168:169], v62 offset:0
    ds_read_b64_tr_b16 v[170:171], v62 offset:512
    ds_read_b64_tr_b16 v[172:173], v63 offset:0
    ds_read_b64_tr_b16 v[174:175], v63 offset:512
    ds_read_b64_tr_b16 v[176:177], v60 offset:4096
    ds_read_b64_tr_b16 v[178:179], v60 offset:4608
    ds_read_b64_tr_b16 v[180:181], v61 offset:4096
    ds_read_b64_tr_b16 v[182:183], v61 offset:4608
    ds_read_b64_tr_b16 v[184:185], v62 offset:4096
    ds_read_b64_tr_b16 v[186:187], v62 offset:4608
    ds_read_b64_tr_b16 v[188:189], v63 offset:4096
    ds_read_b64_tr_b16 v[190:191], v63 offset:4608
    s_waitcnt lgkmcnt(0)
    s_barrier
    s_add_u32 s96, s41, 8126464
    s_mov_b32 s98, s41
    s_mov_b32 s45, 0x5530000
    buffer_load_dword v96, v6, s[16:19], s45 offen sc1
    s_waitcnt vmcnt(0)
    v_cmp_ne_u32 vcc, 0, v96
    s_cbranch_vccnz L_spin73
L_back74:
    s_barrier
    s_mov_b32 s39, 0x5e00000
    s_add_u32 m0, s43, 0
    s_add_u32 s42, s41, 0
    buffer_load_dwordx4 v1, s[16:19], s42 offen offset:0 sc1 lds
    buffer_load_dwordx4 v1, s[16:19], s42 offen offset:1024 sc1 lds
    buffer_load_dwordx4 v1, s[16:19], s42 offen offset:2048 sc1 lds
    buffer_load_dwordx4 v1, s[16:19], s42 offen offset:3072 sc1 lds
    s_add_u32 m0, s88, 16384
    s_add_u32 s42, s41, 16384
    s_add_u32 s42, s42, s89
    buffer_load_dwordx4 v1, s[16:19], s42 offen offset:0 sc1 lds
    buffer_load_dwordx4 v1, s[16:19], s42 offen offset:1024 sc1 lds
    buffer_store_dword v124, v124, s[16:19], s39 offen
    s_add_u32 m0, s43, 24576
    s_add_u32 s42, s41, 24576
    buffer_load_dwordx4 v1, s[16:19], s42 offen offset:0 sc1 lds
    buffer_load_dwordx4 v1, s[16:19], s42 offen offset:1024 sc1 lds
    buffer_load_dwordx4 v1, s[16:19], s42 offen offset:2048 sc1 lds
    buffer_load_dwordx4 v1, s[16:19], s42 offen offset:3072 sc1 lds
    s_add_u32 s45, s45, 65536
    s_waitcnt vmcnt(5) lgkmcnt(0)
    s_barrier
    s_mov_b32 s52, 0x5e00000
    s_mov_b32 s46, 0x5e00000
    s_add_u32 s20, s84, 0x5e00000
    s_addc_u32 s21, s85, 0
    s_mov_b32 s22, 0x400000
    s_mov_b32 s23, 0x00020000
    v_mov_b32 v13, 0
    ds_read_b128 v[80:83], v2 offset:0
    ds_read_b128 v[84:87], v3 offset:0
    s_mov_b32 s36, 0
    s_waitcnt lgkmcnt(0)
    s_nop 7
L_bs_b0:
    v_mfma_f32_16x16x32_bf16 v[16:19], a[0:3], v[80:83], 0
    s_and_b32 s44, s90, 0xffffffff
    ds_read_b128 v[88:91], v2 offset:2048
    s_cmp_lt_i32 s36, 1
    v_mfma_f32_16x16x32_bf16 v[24:27], a[0:3], v[84:87], 0
    s_cselect_b32 s44, 0x5e00000, s44
    s_xor_b32 s49, s44, 0
    v_cvt_pk_bf16_f32 v48, v48, v49
    v_mfma_f32_16x16x32_bf16 v[28:31], a[4:7], v[84:87], 0
    ds_read_b128 v[92:95], v3 offset:2048
    v_cvt_pk_bf16_f32 v49, v50, v51
    v_mfma_f32_16x16x32_bf16 v[20:23], a[4:7], v[80:83], 0
    v_cvt_pk_bf16_f32 v50, v52, v53
    v_cvt_pk_bf16_f32 v51, v54, v55
    v_mfma_f32_16x16x32_bf16 v[32:35], a[8:11], v[80:83], 0
    buffer_store_dwordx4 v[48:51], v1, s[16:19], s49 offen offset:3072 sc1
    v_mfma_f32_16x16x32_bf16 v[40:43], a[8:11], v[84:87], 0
    s_xor_b32 s49, s44, 16384
    v_cvt_pk_bf16_f32 v56, v56, v57
    v_cvt_pk_bf16_f32 v57, v58, v59
    v_mfma_f32_16x16x32_bf16 v[44:47], a[12:15], v[84:87], 0
    v_cvt_pk_bf16_f32 v58, v60, v61
    v_cvt_pk_bf16_f32 v59, v62, v63
    v_mfma_f32_16x16x32_bf16 v[36:39], a[12:15], v[80:83], 0
    s_waitcnt lgkmcnt(0)
    v_mfma_f32_16x16x32_bf16 v[16:19], a[16:19], v[88:91], v[16:19]
    ds_read_b128 v[80:83], v2 offset:4096
    v_mfma_f32_16x16x32_bf16 v[24:27], a[16:19], v[92:95], v[24:27]
    buffer_store_dwordx4 v[56:59], v1, s[16:19], s49 offen offset:3072 sc1
    v_mfma_f32_16x16x32_bf16 v[28:31], a[20:23], v[92:95], v[28:31]
    s_xor_b32 s49, s44, 32768
    ds_read_b128 v[84:87], v3 offset:4096
    v_cvt_pk_bf16_f32 v64, v64, v65
    v_mfma_f32_16x16x32_bf16 v[20:23], a[20:23], v[88:91], v[20:23]
    v_cvt_pk_bf16_f32 v65, v66, v67
    v_cvt_pk_bf16_f32 v66, v68, v69
    v_mfma_f32_16x16x32_bf16 v[32:35], a[24:27], v[88:91], v[32:35]
    v_cvt_pk_bf16_f32 v67, v70, v71
    v_mfma_f32_16x16x32_bf16 v[40:43], a[24:27], v[92:95], v[40:43]
    buffer_store_dwordx4 v[64:67], v1, s[16:19], s49 offen offset:3072 sc1
    v_mfma_f32_16x16x32_bf16 v[44:47], a[28:31], v[92:95], v[44:47]
    s_xor_b32 s49, s44, 49152
    v_cvt_pk_bf16_f32 v72, v72, v73
    v_cvt_pk_bf16_f32 v73, v74, v75
    v_mfma_f32_16x16x32_bf16 v[36:39], a[28:31], v[88:91], v[36:39]
    s_waitcnt lgkmcnt(0)
    v_cvt_pk_bf16_f32 v74, v76, v77
    v_cvt_pk_bf16_f32 v75, v78, v79
    v_mfma_f32_16x16x32_bf16 v[16:19], a[32:35], v[80:83], v[16:19]
    ds_read_b128 v[88:91], v2 offset:6144
    v_mfma_f32_16x16x32_bf16 v[24:27], a[32:35], v[84:87], v[24:27]
    buffer_store_dwordx4 v[72:75], v1, s[16:19], s49 offen offset:3072 sc1
    v_mfma_f32_16x16x32_bf16 v[28:31], a[36:39], v[84:87], v[28:31]
    s_add_u32 s90, s90, 262144
    ds_read_b128 v[92:95], v3 offset:6144
    v_mfma_f32_16x16x32_bf16 v[20:23], a[36:39], v[80:83], v[20:23]
    v_mfma_f32_16x16x32_bf16 v[32:35], a[40:43], v[80:83], v[32:35]
    v_mfma_f32_16x16x32_bf16 v[40:43], a[40:43], v[84:87], v[40:43]
    v_mfma_f32_16x16x32_bf16 v[44:47], a[44:47], v[84:87], v[44:47]
    v_mfma_f32_16x16x32_bf16 v[36:39], a[44:47], v[80:83], v[36:39]
    s_waitcnt lgkmcnt(0)
    v_mfma_f32_16x16x32_bf16 v[16:19], a[48:51], v[88:91], v[16:19]
    s_add_u32 s98, s98, 262144
    ds_read_b128 v[80:83], v2 offset:8192
    s_min_i32 s98, s98, s96
    v_mfma_f32_16x16x32_bf16 v[24:27], a[48:51], v[92:95], v[24:27]
    s_and_b32 s41, s98, 0xffffffff
    s_add_u32 m0, s43, 98304
    s_add_u32 s42, s41, 0
    v_mfma_f32_16x16x32_bf16 v[28:31], a[52:55], v[92:95], v[28:31]
    ds_read_b128 v[84:87], v3 offset:8192
    v_mfma_f32_16x16x32_bf16 v[20:23], a[52:55], v[88:91], v[20:23]
    v_mfma_f32_16x16x32_bf16 v[32:35], a[56:59], v[88:91], v[32:35]
    v_mfma_f32_16x16x32_bf16 v[40:43], a[56:59], v[92:95], v[40:43]
    v_mfma_f32_16x16x32_bf16 v[44:47], a[60:63], v[92:95], v[44:47]
    v_mfma_f32_16x16x32_bf16 v[36:39], a[60:63], v[88:91], v[36:39]
    s_waitcnt lgkmcnt(0)
    v_mfma_f32_16x16x32_bf16 v[16:19], a[64:67], v[80:83], v[16:19]
    ds_read_b128 v[88:91], v2 offset:10240
    v_mfma_f32_16x16x32_bf16 v[24:27], a[64:67], v[84:87], v[24:27]
    buffer_load_dword v96, v6, s[16:19], s45 offen sc1
    v_mfma_f32_16x16x32_bf16 v[28:31], a[68:71], v[84:87], v[28:31]
    ds_read_b128 v[92:95], v3 offset:10240
    v_mfma_f32_16x16x32_bf16 v[20:23], a[68:71], v[80:83], v[20:23]
    v_mfma_f32_16x16x32_bf16 v[32:35], a[72:75], v[80:83], v[32:35]
    v_mfma_f32_16x16x32_bf16 v[40:43], a[72:75], v[84:87], v[40:43]
    v_mfma_f32_16x16x32_bf16 v[44:47], a[76:79], v[84:87], v[44:47]
    v_mfma_f32_16x16x32_bf16 v[36:39], a[76:79], v[80:83], v[36:39]
    s_waitcnt lgkmcnt(0)
    v_mfma_f32_16x16x32_bf16 v[16:19], a[80:83], v[88:91], v[16:19]
    ds_read_b128 v[80:83], v2 offset:12288
    v_mfma_f32_16x16x32_bf16 v[24:27], a[80:83], v[92:95], v[24:27]
    v_mfma_f32_16x16x32_bf16 v[28:31], a[84:87], v[92:95], v[28:31]
    ds_read_b128 v[84:87], v3 offset:12288
    v_mfma_f32_16x16x32_bf16 v[20:23], a[84:87], v[88:91], v[20:23]
    v_mfma_f32_16x16x32_bf16 v[32:35], a[88:91], v[88:91], v[32:35]
    v_mfma_f32_16x16x32_bf16 v[40:43], a[88:91], v[92:95], v[40:43]
    v_mfma_f32_16x16x32_bf16 v[44:47], a[92:95], v[92:95], v[44:47]
    v_mfma_f32_16x16x32_bf16 v[36:39], a[92:95], v[88:91], v[36:39]
    s_waitcnt lgkmcnt(0)
    v_mfma_f32_16x16x32_bf16 v[16:19], a[96:99], v[80:83], v[16:19]
    ds_read_b128 v[88:91], v2 offset:14336
    v_mfma_f32_16x16x32_bf16 v[24:27], a[96:99], v[84:87], v[24:27]
    v_mfma_f32_16x16x32_bf16 v[28:31], a[100:103], v[84:87], v[28:31]
    ds_read_b128 v[92:95], v3 offset:14336
    v_mfma_f32_16x16x32_bf16 v[20:23], a[100:103], v[80:83], v[20:23]
    v_mfma_f32_16x16x32_bf16 v[32:35], a[104:107], v[80:83], v[32:35]
    v_mfma_f32_16x16x32_bf16 v[40:43], a[104:107], v[84:87], v[40:43]
    v_mfma_f32_16x16x32_bf16 v[44:47], a[108:111], v[84:87], v[44:47]
    v_mfma_f32_16x16x32_bf16 v[36:39], a[108:111], v[80:83], v[36:39]
    s_waitcnt lgkmcnt(0)
    v_mfma_f32_16x16x32_bf16 v[16:19], a[112:115], v[88:91], v[16:19]
    ds_read_b128 v[80:83], v2 offset:16384
    v_mfma_f32_16x16x32_bf16 v[24:27], a[112:115], v[92:95], v[24:27]
    v_mfma_f32_16x16x32_bf16 v[28:31], a[116:119], v[92:95], v[28:31]
    ds_read_b128 v[84:87], v3 offset:16384
    v_mfma_f32_16x16x32_bf16 v[20:23], a[116:119], v[88:91], v[20:23]
    v_mfma_f32_16x16x32_bf16 v[32:35], a[120:123], v[88:91], v[32:35]
    v_mfma_f32_16x16x32_bf16 v[40:43], a[120:123], v[92:95], v[40:43]
    v_mfma_f32_16x16x32_bf16 v[44:47], a[124:127], v[92:95], v[44:47]
    v_mfma_f32_16x16x32_bf16 v[36:39], a[124:127], v[88:91], v[36:39]
    s_waitcnt lgkmcnt(0)
    v_mfma_f32_16x16x32_bf16 v[16:19], a[128:131], v[80:83], v[16:19]
    ds_read_b128 v[88:91], v2 offset:18432
    v_mfma_f32_16x16x32_bf16 v[24:27], a[128:131], v[84:87], v[24:27]
    v_mfma_f32_16x16x32_bf16 v[28:31], a[132:135], v[84:87], v[28:31]
    ds_read_b128 v[92:95], v3 offset:18432
    v_mfma_f32_16x16x32_bf16 v[20:23], a[132:135], v[80:83], v[20:23]
    v_mfma_f32_16x16x32_bf16 v[32:35], a[136:139], v[80:83], v[32:35]
    v_mfma_f32_16x16x32_bf16 v[40:43], a[136:139], v[84:87], v[40:43]
    v_mfma_f32_16x16x32_bf16 v[44:47], a[140:143], v[84:87], v[44:47]
    v_mfma_f32_16x16x32_bf16 v[36:39], a[140:143], v[80:83], v[36:39]
    s_waitcnt lgkmcnt(0)
    v_mfma_f32_16x16x32_bf16 v[16:19], a[144:147], v[88:91], v[16:19]
    ds_read_b128 v[80:83], v2 offset:20480
    v_mfma_f32_16x16x32_bf16 v[24:27], a[144:147], v[92:95], v[24:27]
    v_mfma_f32_16x16x32_bf16 v[28:31], a[148:151], v[92:95], v[28:31]
    ds_read_b128 v[84:87], v3 offset:20480
    v_mfma_f32_16x16x32_bf16 v[20:23], a[148:151], v[88:91], v[20:23]
    v_mfma_f32_16x16x32_bf16 v[32:35], a[152:155], v[88:91], v[32:35]
    s_waitcnt vmcnt(0)
    v_cmp_ne_u32 vcc, 0, v96
    v_mfma_f32_16x16x32_bf16 v[40:43], a[152:155], v[92:95], v[40:43]
    v_mfma_f32_16x16x32_bf16 v[44:47], a[156:159], v[92:95], v[44:47]
    s_cbranch_vccnz L_spin75
L_back76:
    s_barrier
    v_mfma_f32_16x16x32_bf16 v[36:39], a[156:159], v[88:91], v[36:39]
    s_waitcnt lgkmcnt(0)
    v_mfma_f32_16x16x32_bf16 v[16:19], a[160:163], v[80:83], v[16:19]
    ds_read_b128 v[88:91], v2 offset:22528
    v_mfma_f32_16x16x32_bf16 v[24:27], a[160:163], v[84:87], v[24:27]
    buffer_load_dwordx4 v1, s[16:19], s42 offen offset:0 sc1 lds
    v_mfma_f32_16x16x32_bf16 v[28:31], a[164:167], v[84:87], v[28:31]
    ds_read_b128 v[92:95], v3 offset:22528
    v_mfma_f32_16x16x32_bf16 v[20:23], a[164:167], v[80:83], v[20:23]
    v_mfma_f32_16x16x32_bf16 v[32:35], a[168:171], v[80:83], v[32:35]
    v_mfma_f32_16x16x32_bf16 v[40:43], a[168:171], v[84:87], v[40:43]
    buffer_load_dwordx4 v1, s[16:19], s42 offen offset:1024 sc1 lds
    v_mfma_f32_16x16x32_bf16 v[44:47], a[172:175], v[84:87], v[44:47]
    v_mfma_f32_16x16x32_bf16 v[36:39], a[172:175], v[80:83], v[36:39]
    s_waitcnt lgkmcnt(0)
    v_mfma_f32_16x16x32_bf16 v[16:19], a[176:179], v[88:91], v[16:19]
    ds_read_b128 v[80:83], v2 offset:24576
    v_mfma_f32_16x16x32_bf16 v[24:27], a[176:179], v[92:95], v[24:27]
    buffer_load_dwordx4 v1, s[16:19], s42 offen offset:2048 sc1 lds
    v_mfma_f32_16x16x32_bf16 v[28:31], a[180:183], v[92:95], v[28:31]
    ds_read_b128 v[84:87], v3 offset:24576
    v_mfma_f32_16x16x32_bf16 v[20:23], a[180:183], v[88:91], v[20:23]
    v_mfma_f32_16x16x32_bf16 v[32:35], a[184:187], v[88:91], v[32:35]
    v_mfma_f32_16x16x32_bf16 v[40:43], a[184:187], v[92:95], v[40:43]
    buffer_load_dwordx4 v1, s[16:19], s42 offen offset:3072 sc1 lds
    v_mfma_f32_16x16x32_bf16 v[44:47], a[188:191], v[92:95], v[44:47]
    s_add_u32 m0, s88, 114688
    s_add_u32 s42, s41, 16384
    s_add_u32 s42, s42, s89
    v_mfma_f32_16x16x32_bf16 v[36:39], a[188:191], v[88:91], v[36:39]
    s_waitcnt lgkmcnt(0)
    v_mfma_f32_16x16x32_bf16 v[16:19], a[192:195], v[80:83], v[16:19]
    ds_read_b128 v[88:91], v2 offset:26624
    v_mfma_f32_16x16x32_bf16 v[24:27], a[192:195], v[84:87], v[24:27]
    buffer_load_dwordx4 v1, s[16:19], s42 offen offset:0 sc1 lds
    v_mfma_f32_16x16x32_bf16 v[28:31], a[196:199], v[84:87], v[28:31]
    ds_read_b128 v[92:95], v3 offset:26624
    v_mfma_f32_16x16x32_bf16 v[20:23], a[196:199], v[80:83], v[20:23]
    v_mfma_f32_16x16x32_bf16 v[32:35], a[200:203], v[80:83], v[32:35]
    v_mfma_f32_16x16x32_bf16 v[40:43], a[200:203], v[84:87], v[40:43]
    buffer_load_dwordx4 v1, s[16:19], s42 offen offset:1024 sc1 lds
    v_mfma_f32_16x16x32_bf16 v[44:47], a[204:207], v[84:87], v[44:47]
    v_mfma_f32_16x16x32_bf16 v[36:39], a[204:207], v[80:83], v[36:39]
    s_waitcnt lgkmcnt(0)
    v_mfma_f32_16x16x32_bf16 v[16:19], a[208:211], v[88:91], v[16:19]
    ds_read_b128 v[80:83], v2 offset:28672
    v_mfma_f32_16x16x32_bf16 v[24:27], a[208:211], v[92:95], v[24:27]
    buffer_store_dword v124, v124, s[16:19], s91 offen sc1
    v_mfma_f32_16x16x32_bf16 v[28:31], a[212:215], v[92:95], v[28:31]
    s_add_u32 s91, s91, 65536
    ds_read_b128 v[84:87], v3 offset:28672
    v_mfma_f32_16x16x32_bf16 v[20:23], a[212:215], v[88:91], v[20:23]
    v_mfma_f32_16x16x32_bf16 v[32:35], a[216:219], v[88:91], v[32:35]
    v_mfma_f32_16x16x32_bf16 v[40:43], a[216:219], v[92:95], v[40:43]
    v_mfma_f32_16x16x32_bf16 v[44:47], a[220:223], v[92:95], v[44:47]
    v_mfma_f32_16x16x32_bf16 v[36:39], a[220:223], v[88:91], v[36:39]
    s_waitcnt lgkmcnt(0)
    v_mfma_f32_16x16x32_bf16 v[16:19], a[224:227], v[80:83], v[16:19]
    ds_read_b128 v[88:91], v2 offset:30720
    v_mfma_f32_16x16x32_bf16 v[24:27], a[224:227], v[84:87], v[24:27]
    v_mfma_f32_16x16x32_bf16 v[28:31], a[228:231], v[84:87], v[28:31]
    ds_read_b128 v[92:95], v3 offset:30720
    v_mfma_f32_16x16x32_bf16 v[20:23], a[228:231], v[80:83], v[20:23]
    v_mfma_f32_16x16x32_bf16 v[32:35], a[232:235], v[80:83], v[32:35]
    v_mfma_f32_16x16x32_bf16 v[40:43], a[232:235], v[84:87], v[40:43]
    v_mfma_f32_16x16x32_bf16 v[44:47], a[236:239], v[84:87], v[44:47]
    v_mfma_f32_16x16x32_bf16 v[36:39], a[236:239], v[80:83], v[36:39]
    s_waitcnt lgkmcnt(0)
    v_mfma_f32_16x16x32_bf16 v[16:19], a[240:243], v[88:91], v[16:19]
    ds_read_b128 v[80:83], v2 offset:32768
    v_mfma_f32_16x16x32_bf16 v[24:27], a[240:243], v[92:95], v[24:27]
    v_mfma_f32_16x16x32_bf16 v[28:31], a[244:247], v[92:95], v[28:31]
    ds_read_b128 v[84:87], v3 offset:32768
    v_mfma_f32_16x16x32_bf16 v[20:23], a[244:247], v[88:91], v[20:23]
    v_mfma_f32_16x16x32_bf16 v[32:35], a[248:251], v[88:91], v[32:35]
    v_mfma_f32_16x16x32_bf16 v[40:43], a[248:251], v[92:95], v[40:43]
    v_mfma_f32_16x16x32_bf16 v[44:47], a[252:255], v[92:95], v[44:47]
    v_mfma_f32_16x16x32_bf16 v[36:39], a[252:255], v[88:91], v[36:39]
    s_waitcnt lgkmcnt(0)
    v_mfma_f32_16x16x32_bf16 v[16:19], v[128:131], v[80:83], v[16:19]
    s_add_u32 m0, s43, 122880
    ds_read_b128 v[88:91], v2 offset:34816
    s_add_u32 s42, s41, 24576
    v_mfma_f32_16x16x32_bf16 v[24:27], v[128:131], v[84:87], v[24:27]
    buffer_load_dwordx4 v1, s[16:19], s42 offen offset:0 sc1 lds
    v_mfma_f32_16x16x32_bf16 v[28:31], v[132:135], v[84:87], v[28:31]
    ds_read_b128 v[92:95], v3 offset:34816
    v_mfma_f32_16x16x32_bf16 v[20:23], v[132:135], v[80:83], v[20:23]
    v_mfma_f32_16x16x32_bf16 v[32:35], v[136:139], v[80:83], v[32:35]
    v_mfma_f32_16x16x32_bf16 v[40:43], v[136:139], v[84:87], v[40:43]
    v_mfma_f32_16x16x32_bf16 v[44:47], v[140:143], v[84:87], v[44:47]
    buffer_load_dwordx4 v1, s[16:19], s42 offen offset:1024 sc1 lds
    v_mfma_f32_16x16x32_bf16 v[36:39], v[140:143], v[80:83], v[36:39]
    s_waitcnt lgkmcnt(0)
    v_mfma_f32_16x16x32_bf16 v[16:19], v[144:147], v[88:91], v[16:19]
    ds_read_b128 v[80:83], v2 offset:36864
    v_mfma_f32_16x16x32_bf16 v[24:27], v[144:147], v[92:95], v[24:27]
    v_mfma_f32_16x16x32_bf16 v[28:31], v[148:151], v[92:95], v[28:31]
    ds_read_b128 v[84:87], v3 offset:36864
    v_mfma_f32_16x16x32_bf16 v[20:23], v[148:151], v[88:91], v[20:23]
    buffer_load_dwordx4 v1, s[16:19], s42 offen offset:2048 sc1 lds
    v_mfma_f32_16x16x32_bf16 v[32:35], v[152:155], v[88:91], v[32:35]
    v_mfma_f32_16x16x32_bf16 v[40:43], v[152:155], v[92:95], v[40:43]
    v_mfma_f32_16x16x32_bf16 v[44:47], v[156:159], v[92:95], v[44:47]
    v_mfma_f32_16x16x32_bf16 v[36:39], v[156:159], v[88:91], v[36:39]
    s_waitcnt lgkmcnt(0)
    v_mfma_f32_16x16x32_bf16 v[16:19], v[160:163], v[80:83], v[16:19]
    ds_read_b128 v[88:91], v2 offset:38912
    v_mfma_f32_16x16x32_bf16 v[24:27], v[160:163], v[84:87], v[24:27]
    buffer_load_dwordx4 v1, s[16:19], s42 offen offset:3072 sc1 lds
    v_mfma_f32_16x16x32_bf16 v[28:31], v[164:167], v[84:87], v[28:31]
    s_add_u32 s45, s45, 65536
    ds_read_b128 v[92:95], v3 offset:38912
    v_mfma_f32_16x16x32_bf16 v[20:23], v[164:167], v[80:83], v[20:23]
    v_mfma_f32_16x16x32_bf16 v[32:35], v[168:171], v[80:83], v[32:35]
    v_mfma_f32_16x16x32_bf16 v[40:43], v[168:171], v[84:87], v[40:43]
    v_mfma_f32_16x16x32_bf16 v[44:47], v[172:175], v[84:87], v[44:47]
    v_mfma_f32_16x16x32_bf16 v[36:39], v[172:175], v[80:83], v[36:39]
    s_waitcnt vmcnt(5) lgkmcnt(0)
    s_barrier
    v_mfma_f32_16x16x32_bf16 v[16:19], v[176:179], v[88:91], v[16:19]
    ds_read_b128 v[80:83], v4 offset:0
    v_mfma_f32_16x16x32_bf16 v[24:27], v[176:179], v[92:95], v[24:27]
    v_mfma_f32_16x16x32_bf16 v[28:31], v[180:183], v[92:95], v[28:31]
    ds_read_b128 v[84:87], v5 offset:0
    v_mfma_f32_16x16x32_bf16 v[20:23], v[180:183], v[88:91], v[20:23]
    v_mfma_f32_16x16x32_bf16 v[32:35], v[184:187], v[88:91], v[32:35]
    v_mfma_f32_16x16x32_bf16 v[40:43], v[184:187], v[92:95], v[40:43]
    v_mfma_f32_16x16x32_bf16 v[44:47], v[188:191], v[92:95], v[44:47]
    s_add_u32 s36, s36, 1
    v_mfma_f32_16x16x32_bf16 v[36:39], v[188:191], v[88:91], v[36:39]
    s_waitcnt lgkmcnt(0)
L_bs_b1:
    v_mfma_f32_16x16x32_bf16 v[48:51], a[0:3], v[80:83], 0
    s_and_b32 s44, s90, 0xffffffff
    ds_read_b128 v[88:91], v4 offset:2048
    s_cmp_lt_i32 s36, 1
    v_mfma_f32_16x16x32_bf16 v[56:59], a[0:3], v[84:87], 0
    s_cselect_b32 s44, 0x5e00000, s44
    s_xor_b32 s49, s44, 0
    v_cvt_pk_bf16_f32 v16, v16, v17
    v_mfma_f32_16x16x32_bf16 v[60:63], a[4:7], v[84:87], 0
    ds_read_b128 v[92:95], v5 offset:2048
    v_cvt_pk_bf16_f32 v17, v18, v19
    v_mfma_f32_16x16x32_bf16 v[52:55], a[4:7], v[80:83], 0
    v_cvt_pk_bf16_f32 v18, v20, v21
    v_cvt_pk_bf16_f32 v19, v22, v23
    v_mfma_f32_16x16x32_bf16 v[64:67], a[8:11], v[80:83], 0
    buffer_store_dwordx4 v[16:19], v1, s[16:19], s49 offen offset:3072 sc1
    v_mfma_f32_16x16x32_bf16 v[72:75], a[8:11], v[84:87], 0
    s_xor_b32 s49, s44, 16384
    v_cvt_pk_bf16_f32 v24, v24, v25
    v_cvt_pk_bf16_f32 v25, v26, v27
    v_mfma_f32_16x16x32_bf16 v[76:79], a[12:15], v[84:87], 0
    v_cvt_pk_bf16_f32 v26, v28, v29
    v_cvt_pk_bf16_f32 v27, v30, v31
    v_mfma_f32_16x16x32_bf16 v[68:71], a[12:15], v[80:83], 0
    s_waitcnt lgkmcnt(0)
    v_mfma_f32_16x16x32_bf16 v[48:51], a[16:19], v[88:91], v[48:51]
    ds_read_b128 v[80:83], v4 offset:4096
    v_mfma_f32_16x16x32_bf16 v[56:59], a[16:19], v[92:95], v[56:59]
    buffer_store_dwordx4 v[24:27], v1, s[16:19], s49 offen offset:3072 sc1
    v_mfma_f32_16x16x32_bf16 v[60:63], a[20:23], v[92:95], v[60:63]
    s_xor_b32 s49, s44, 32768
    ds_read_b128 v[84:87], v5 offset:4096
    v_cvt_pk_bf16_f32 v32, v32, v33
    v_mfma_f32_16x16x32_bf16 v[52:55], a[20:23], v[88:91], v[52:55]
    v_cvt_pk_bf16_f32 v33, v34, v35
    v_cvt_pk_bf16_f32 v34, v36, v37
    v_mfma_f32_16x16x32_bf16 v[64:67], a[24:27], v[88:91], v[64:67]
    v_cvt_pk_bf16_f32 v35, v38, v39
    v_mfma_f32_16x16x32_bf16 v[72:75], a[24:27], v[92:95], v[72:75]
    buffer_store_dwordx4 v[32:35], v1, s[16:19], s49 offen offset:3072 sc1
    v_mfma_f32_16x16x32_bf16 v[76:79], a[28:31], v[92:95], v[76:79]
    s_xor_b32 s49, s44, 49152
    v_cvt_pk_bf16_f32 v40, v40, v41
    v_cvt_pk_bf16_f32 v41, v42, v43
    v_mfma_f32_16x16x32_bf16 v[68:71], a[28:31], v[88:91], v[68:71]
    s_waitcnt lgkmcnt(0)
    v_cvt_pk_bf16_f32 v42, v44, v45
    v_cvt_pk_bf16_f32 v43, v46, v47
    v_mfma_f32_16x16x32_bf16 v[48:51], a[32:35], v[80:83], v[48:51]
    ds_read_b128 v[88:91], v4 offset:6144
    v_mfma_f32_16x16x32_bf16 v[56:59], a[32:35], v[84:87], v[56:59]
    buffer_store_dwordx4 v[40:43], v1, s[16:19], s49 offen offset:3072 sc1
    v_mfma_f32_16x16x32_bf16 v[60:63], a[36:39], v[84:87], v[60:63]
    s_add_u32 s90, s90, 262144
    ds_read_b128 v[92:95], v5 offset:6144
    v_mfma_f32_16x16x32_bf16 v[52:55], a[36:39], v[80:83], v[52:55]
    v_mfma_f32_16x16x32_bf16 v[64:67], a[40:43], v[80:83], v[64:67]
    v_mfma_f32_16x16x32_bf16 v[72:75], a[40:43], v[84:87], v[72:75]
    v_mfma_f32_16x16x32_bf16 v[76:79], a[44:47], v[84:87], v[76:79]
    v_mfma_f32_16x16x32_bf16 v[68:71], a[44:47], v[80:83], v[68:71]
    s_waitcnt lgkmcnt(0)
    v_mfma_f32_16x16x32_bf16 v[48:51], a[48:51], v[88:91], v[48:51]
    s_add_u32 s98, s98, 262144
    ds_read_b128 v[80:83], v4 offset:8192
    s_min_i32 s98, s98, s96
    v_mfma_f32_16x16x32_bf16 v[56:59], a[48:51], v[92:95], v[56:59]
    s_and_b32 s41, s98, 0xffffffff
    s_add_u32 m0, s43, 0
    s_add_u32 s42, s41, 0
    v_mfma_f32_16x16x32_bf16 v[60:63], a[52:55], v[92:95], v[60:63]
    ds_read_b128 v[84:87], v5 offset:8192
    v_mfma_f32_16x16x32_bf16 v[52:55], a[52:55], v[88:91], v[52:55]
    v_mfma_f32_16x16x32_bf16 v[64:67], a[56:59], v[88:91], v[64:67]
    v_mfma_f32_16x16x32_bf16 v[72:75], a[56:59], v[92:95], v[72:75]
    v_mfma_f32_16x16x32_bf16 v[76:79], a[60:63], v[92:95], v[76:79]
    v_mfma_f32_16x16x32_bf16 v[68:71], a[60:63], v[88:91], v[68:71]
    s_waitcnt lgkmcnt(0)
    v_mfma_f32_16x16x32_bf16 v[48:51], a[64:67], v[80:83], v[48:51]
    ds_read_b128 v[88:91], v4 offset:10240
    v_mfma_f32_16x16x32_bf16 v[56:59], a[64:67], v[84:87], v[56:59]
    buffer_load_dword v96, v6, s[16:19], s45 offen sc1
    v_mfma_f32_16x16x32_bf16 v[60:63], a[68:71], v[84:87], v[60:63]
    ds_read_b128 v[92:95], v5 offset:10240
    v_mfma_f32_16x16x32_bf16 v[52:55], a[68:71], v[80:83], v[52:55]
    v_mfma_f32_16x16x32_bf16 v[64:67], a[72:75], v[80:83], v[64:67]
    v_mfma_f32_16x16x32_bf16 v[72:75], a[72:75], v[84:87], v[72:75]
    v_mfma_f32_16x16x32_bf16 v[76:79], a[76:79], v[84:87], v[76:79]
    v_mfma_f32_16x16x32_bf16 v[68:71], a[76:79], v[80:83], v[68:71]
    s_waitcnt lgkmcnt(0)
    v_mfma_f32_16x16x32_bf16 v[48:51], a[80:83], v[88:91], v[48:51]
    ds_read_b128 v[80:83], v4 offset:12288
    v_mfma_f32_16x16x32_bf16 v[56:59], a[80:83], v[92:95], v[56:59]
    v_mfma_f32_16x16x32_bf16 v[60:63], a[84:87], v[92:95], v[60:63]
    ds_read_b128 v[84:87], v5 offset:12288
    v_mfma_f32_16x16x32_bf16 v[52:55], a[84:87], v[88:91], v[52:55]
    v_mfma_f32_16x16x32_bf16 v[64:67], a[88:91], v[88:91], v[64:67]
    v_mfma_f32_16x16x32_bf16 v[72:75], a[88:91], v[92:95], v[72:75]
    v_mfma_f32_16x16x32_bf16 v[76:79], a[92:95], v[92:95], v[76:79]
    v_mfma_f32_16x16x32_bf16 v[68:71], a[92:95], v[88:91], v[68:71]
    s_waitcnt lgkmcnt(0)
    v_mfma_f32_16x16x32_bf16 v[48:51], a[96:99], v[80:83], v[48:51]
    ds_read_b128 v[88:91], v4 offset:14336
    v_mfma_f32_16x16x32_bf16 v[56:59], a[96:99], v[84:87], v[56:59]
    v_mfma_f32_16x16x32_bf16 v[60:63], a[100:103], v[84:87], v[60:63]
    ds_read_b128 v[92:95], v5 offset:14336
    v_mfma_f32_16x16x32_bf16 v[52:55], a[100:103], v[80:83], v[52:55]
    v_mfma_f32_16x16x32_bf16 v[64:67], a[104:107], v[80:83], v[64:67]
    v_mfma_f32_16x16x32_bf16 v[72:75], a[104:107], v[84:87], v[72:75]
    v_mfma_f32_16x16x32_bf16 v[76:79], a[108:111], v[84:87], v[76:79]
    v_mfma_f32_16x16x32_bf16 v[68:71], a[108:111], v[80:83], v[68:71]
    s_waitcnt lgkmcnt(0)
    v_mfma_f32_16x16x32_bf16 v[48:51], a[112:115], v[88:91], v[48:51]
    ds_read_b128 v[80:83], v4 offset:16384
    v_mfma_f32_16x16x32_bf16 v[56:59], a[112:115], v[92:95], v[56:59]
    v_mfma_f32_16x16x32_bf16 v[60:63], a[116:119], v[92:95], v[60:63]
    ds_read_b128 v[84:87], v5 offset:16384
    v_mfma_f32_16x16x32_bf16 v[52:55], a[116:119], v[88:91], v[52:55]
    v_mfma_f32_16x16x32_bf16 v[64:67], a[120:123], v[88:91], v[64:67]
    v_mfma_f32_16x16x32_bf16 v[72:75], a[120:123], v[92:95], v[72:75]
    v_mfma_f32_16x16x32_bf16 v[76:79], a[124:127], v[92:95], v[76:79]
    v_mfma_f32_16x16x32_bf16 v[68:71], a[124:127], v[88:91], v[68:71]
    s_waitcnt lgkmcnt(0)
    v_mfma_f32_16x16x32_bf16 v[48:51], a[128:131], v[80:83], v[48:51]
    ds_read_b128 v[88:91], v4 offset:18432
    v_mfma_f32_16x16x32_bf16 v[56:59], a[128:131], v[84:87], v[56:59]
    v_mfma_f32_16x16x32_bf16 v[60:63], a[132:135], v[84:87], v[60:63]
    ds_read_b128 v[92:95], v5 offset:18432
    v_mfma_f32_16x16x32_bf16 v[52:55], a[132:135], v[80:83], v[52:55]
    v_mfma_f32_16x16x32_bf16 v[64:67], a[136:139], v[80:83], v[64:67]
    v_mfma_f32_16x16x32_bf16 v[72:75], a[136:139], v[84:87], v[72:75]
    v_mfma_f32_16x16x32_bf16 v[76:79], a[140:143], v[84:87], v[76:79]
    v_mfma_f32_16x16x32_bf16 v[68:71], a[140:143], v[80:83], v[68:71]
    s_waitcnt lgkmcnt(0)
    v_mfma_f32_16x16x32_bf16 v[48:51], a[144:147], v[88:91], v[48:51]
    ds_read_b128 v[80:83], v4 offset:20480
    v_mfma_f32_16x16x32_bf16 v[56:59], a[144:147], v[92:95], v[56:59]
    v_mfma_f32_16x16x32_bf16 v[60:63], a[148:151], v[92:95], v[60:63]
    ds_read_b128 v[84:87], v5 offset:20480
    v_mfma_f32_16x16x32_bf16 v[52:55], a[148:151], v[88:91], v[52:55]
    v_mfma_f32_16x16x32_bf16 v[64:67], a[152:155], v[88:91], v[64:67]
    s_waitcnt vmcnt(0)
    v_cmp_ne_u32 vcc, 0, v96
    v_mfma_f32_16x16x32_bf16 v[72:75], a[152:155], v[92:95], v[72:75]
    v_mfma_f32_16x16x32_bf16 v[76:79], a[156:159], v[92:95], v[76:79]
    s_cbranch_vccnz L_spin77
L_back78:
    s_barrier
    v_mfma_f32_16x16x32_bf16 v[68:71], a[156:159], v[88:91], v[68:71]
    s_waitcnt lgkmcnt(0)
    v_mfma_f32_16x16x32_bf16 v[48:51], a[160:163], v[80:83], v[48:51]
    ds_read_b128 v[88:91], v4 offset:22528
    v_mfma_f32_16x16x32_bf16 v[56:59], a[160:163], v[84:87], v[56:59]
    buffer_load_dwordx4 v1, s[16:19], s42 offen offset:0 sc1 lds
    v_mfma_f32_16x16x32_bf16 v[60:63], a[164:167], v[84:87], v[60:63]
    ds_read_b128 v[92:95], v5 offset:22528
    v_mfma_f32_16x16x32_bf16 v[52:55], a[164:167], v[80:83], v[52:55]
    v_mfma_f32_16x16x32_bf16 v[64:67], a[168:171], v[80:83], v[64:67]
    v_mfma_f32_16x16x32_bf16 v[72:75], a[168:171], v[84:87], v[72:75]
    buffer_load_dwordx4 v1, s[16:19], s42 offen offset:1024 sc1 lds
    v_mfma_f32_16x16x32_bf16 v[76:79], a[172:175], v[84:87], v[76:79]
    v_mfma_f32_16x16x32_bf16 v[68:71], a[172:175], v[80:83], v[68:71]
    s_waitcnt lgkmcnt(0)
    v_mfma_f32_16x16x32_bf16 v[48:51], a[176:179], v[88:91], v[48:51]
    ds_read_b128 v[80:83], v4 offset:24576
    v_mfma_f32_16x16x32_bf16 v[56:59], a[176:179], v[92:95], v[56:59]
    buffer_load_dwordx4 v1, s[16:19], s42 offen offset:2048 sc1 lds
    v_mfma_f32_16x16x32_bf16 v[60:63], a[180:183], v[92:95], v[60:63]
    ds_read_b128 v[84:87], v5 offset:24576
    v_mfma_f32_16x16x32_bf16 v[52:55], a[180:183], v[88:91], v[52:55]
    v_mfma_f32_16x16x32_bf16 v[64:67], a[184:187], v[88:91], v[64:67]
    v_mfma_f32_16x16x32_bf16 v[72:75], a[184:187], v[92:95], v[72:75]
    buffer_load_dwordx4 v1, s[16:19], s42 offen offset:3072 sc1 lds
    v_mfma_f32_16x16x32_bf16 v[76:79], a[188:191], v[92:95], v[76:79]
    s_add_u32 m0, s88, 16384
    s_add_u32 s42, s41, 16384
    s_add_u32 s42, s42, s89
    v_mfma_f32_16x16x32_bf16 v[68:71], a[188:191], v[88:91], v[68:71]
    s_waitcnt lgkmcnt(0)
    v_mfma_f32_16x16x32_bf16 v[48:51], a[192:195], v[80:83], v[48:51]
    ds_read_b128 v[88:91], v4 offset:26624
    v_mfma_f32_16x16x32_bf16 v[56:59], a[192:195], v[84:87], v[56:59]
    buffer_load_dwordx4 v1, s[16:19], s42 offen offset:0 sc1 lds
    v_mfma_f32_16x16x32_bf16 v[60:63], a[196:199], v[84:87], v[60:63]
    ds_read_b128 v[92:95], v5 offset:26624
    v_mfma_f32_16x16x32_bf16 v[52:55], a[196:199], v[80:83], v[52:55]
    v_mfma_f32_16x16x32_bf16 v[64:67], a[200:203], v[80:83], v[64:67]
    v_mfma_f32_16x16x32_bf16 v[72:75], a[200:203], v[84:87], v[72:75]
    buffer_load_dwordx4 v1, s[16:19], s42 offen offset:1024 sc1 lds
    v_mfma_f32_16x16x32_bf16 v[76:79], a[204:207], v[84:87], v[76:79]
    v_mfma_f32_16x16x32_bf16 v[68:71], a[204:207], v[80:83], v[68:71]
    s_waitcnt lgkmcnt(0)
    v_mfma_f32_16x16x32_bf16 v[48:51], a[208:211], v[88:91], v[48:51]
    ds_read_b128 v[80:83], v4 offset:28672
    v_mfma_f32_16x16x32_bf16 v[56:59], a[208:211], v[92:95], v[56:59]
    buffer_store_dword v124, v124, s[16:19], s91 offen sc1
    v_mfma_f32_16x16x32_bf16 v[60:63], a[212:215], v[92:95], v[60:63]
    s_add_u32 s91, s91, 65536
    ds_read_b128 v[84:87], v5 offset:28672
    v_mfma_f32_16x16x32_bf16 v[52:55], a[212:215], v[88:91], v[52:55]
    v_mfma_f32_16x16x32_bf16 v[64:67], a[216:219], v[88:91], v[64:67]
    v_mfma_f32_16x16x32_bf16 v[72:75], a[216:219], v[92:95], v[72:75]
    v_mfma_f32_16x16x32_bf16 v[76:79], a[220:223], v[92:95], v[76:79]
    v_mfma_f32_16x16x32_bf16 v[68:71], a[220:223], v[88:91], v[68:71]
    s_waitcnt lgkmcnt(0)
    v_mfma_f32_16x16x32_bf16 v[48:51], a[224:227], v[80:83], v[48:51]
    ds_read_b128 v[88:91], v4 offset:30720
    v_mfma_f32_16x16x32_bf16 v[56:59], a[224:227], v[84:87], v[56:59]
    v_mfma_f32_16x16x32_bf16 v[60:63], a[228:231], v[84:87], v[60:63]
    ds_read_b128 v[92:95], v5 offset:30720
    v_mfma_f32_16x16x32_bf16 v[52:55], a[228:231], v[80:83], v[52:55]
    v_mfma_f32_16x16x32_bf16 v[64:67], a[232:235], v[80:83], v[64:67]
    v_mfma_f32_16x16x32_bf16 v[72:75], a[232:235], v[84:87], v[72:75]
    v_mfma_f32_16x16x32_bf16 v[76:79], a[236:239], v[84:87], v[76:79]
    v_mfma_f32_16x16x32_bf16 v[68:71], a[236:239], v[80:83], v[68:71]
    s_waitcnt lgkmcnt(0)
    v_mfma_f32_16x16x32_bf16 v[48:51], a[240:243], v[88:91], v[48:51]
    ds_read_b128 v[80:83], v4 offset:32768
    v_mfma_f32_16x16x32_bf16 v[56:59], a[240:243], v[92:95], v[56:59]
    v_mfma_f32_16x16x32_bf16 v[60:63], a[244:247], v[92:95], v[60:63]
    ds_read_b128 v[84:87], v5 offset:32768
    v_mfma_f32_16x16x32_bf16 v[52:55], a[244:247], v[88:91], v[52:55]
    v_mfma_f32_16x16x32_bf16 v[64:67], a[248:251], v[88:91], v[64:67]
    v_mfma_f32_16x16x32_bf16 v[72:75], a[248:251], v[92:95], v[72:75]
    v_mfma_f32_16x16x32_bf16 v[76:79], a[252:255], v[92:95], v[76:79]
    v_mfma_f32_16x16x32_bf16 v[68:71], a[252:255], v[88:91], v[68:71]
    s_waitcnt lgkmcnt(0)
    v_mfma_f32_16x16x32_bf16 v[48:51], v[128:131], v[80:83], v[48:51]
    s_add_u32 m0, s43, 24576
    ds_read_b128 v[88:91], v4 offset:34816
    s_add_u32 s42, s41, 24576
    v_mfma_f32_16x16x32_bf16 v[56:59], v[128:131], v[84:87], v[56:59]
    buffer_load_dwordx4 v1, s[16:19], s42 offen offset:0 sc1 lds
    v_mfma_f32_16x16x32_bf16 v[60:63], v[132:135], v[84:87], v[60:63]
    ds_read_b128 v[92:95], v5 offset:34816
    v_mfma_f32_16x16x32_bf16 v[52:55], v[132:135], v[80:83], v[52:55]
    v_mfma_f32_16x16x32_bf16 v[64:67], v[136:139], v[80:83], v[64:67]
    v_mfma_f32_16x16x32_bf16 v[72:75], v[136:139], v[84:87], v[72:75]
    v_mfma_f32_16x16x32_bf16 v[76:79], v[140:143], v[84:87], v[76:79]
    buffer_load_dwordx4 v1, s[16:19], s42 offen offset:1024 sc1 lds
    v_mfma_f32_16x16x32_bf16 v[68:71], v[140:143], v[80:83], v[68:71]
    s_waitcnt lgkmcnt(0)
    v_mfma_f32_16x16x32_bf16 v[48:51], v[144:147], v[88:91], v[48:51]
    ds_read_b128 v[80:83], v4 offset:36864
    v_mfma_f32_16x16x32_bf16 v[56:59], v[144:147], v[92:95], v[56:59]
    v_mfma_f32_16x16x32_bf16 v[60:63], v[148:151], v[92:95], v[60:63]
    ds_read_b128 v[84:87], v5 offset:36864
    v_mfma_f32_16x16x32_bf16 v[52:55], v[148:151], v[88:91], v[52:55]
    buffer_load_dwordx4 v1, s[16:19], s42 offen offset:2048 sc1 lds
    v_mfma_f32_16x16x32_bf16 v[64:67], v[152:155], v[88:91], v[64:67]
    v_mfma_f32_16x16x32_bf16 v[72:75], v[152:155], v[92:95], v[72:75]
    v_mfma_f32_16x16x32_bf16 v[76:79], v[156:159], v[92:95], v[76:79]
    v_mfma_f32_16x16x32_bf16 v[68:71], v[156:159], v[88:91], v[68:71]
    s_waitcnt lgkmcnt(0)
    v_mfma_f32_16x16x32_bf16 v[48:51], v[160:163], v[80:83], v[48:51]
    ds_read_b128 v[88:91], v4 offset:38912
    v_mfma_f32_16x16x32_bf16 v[56:59], v[160:163], v[84:87], v[56:59]
    buffer_load_dwordx4 v1, s[16:19], s42 offen offset:3072 sc1 lds
    v_mfma_f32_16x16x32_bf16 v[60:63], v[164:167], v[84:87], v[60:63]
    s_add_u32 s45, s45, 65536
    ds_read_b128 v[92:95], v5 offset:38912
    v_mfma_f32_16x16x32_bf16 v[52:55], v[164:167], v[80:83], v[52:55]
    v_mfma_f32_16x16x32_bf16 v[64:67], v[168:171], v[80:83], v[64:67]
    v_mfma_f32_16x16x32_bf16 v[72:75], v[168:171], v[84:87], v[72:75]
    v_mfma_f32_16x16x32_bf16 v[76:79], v[172:175], v[84:87], v[76:79]
    v_mfma_f32_16x16x32_bf16 v[68:71], v[172:175], v[80:83], v[68:71]
    s_waitcnt vmcnt(5) lgkmcnt(0)
    s_barrier
    v_mfma_f32_16x16x32_bf16 v[48:51], v[176:179], v[88:91], v[48:51]
    ds_read_b128 v[80:83], v2 offset:0
    v_mfma_f32_16x16x32_bf16 v[56:59], v[176:179], v[92:95], v[56:59]
    v_mfma_f32_16x16x32_bf16 v[60:63], v[180:183], v[92:95], v[60:63]
    ds_read_b128 v[84:87], v3 offset:0
    v_mfma_f32_16x16x32_bf16 v[52:55], v[180:183], v[88:91], v[52:55]
    v_mfma_f32_16x16x32_bf16 v[64:67], v[184:187], v[88:91], v[64:67]
    v_mfma_f32_16x16x32_bf16 v[72:75], v[184:187], v[92:95], v[72:75]
    v_mfma_f32_16x16x32_bf16 v[76:79], v[188:191], v[92:95], v[76:79]
    s_add_u32 s36, s36, 1
    v_mfma_f32_16x16x32_bf16 v[68:71], v[188:191], v[88:91], v[68:71]
    s_waitcnt lgkmcnt(0)
    s_cmp_lt_u32 s36, 32
    s_cbranch_scc1 L_bs_b0
    s_nop 7
    s_and_b32 s44, s90, 0xffffffff
    s_cmp_lt_i32 s36, 1
    s_cselect_b32 s44, 0x5e00000, s44
    s_xor_b32 s49, s44, 0
    v_cvt_pk_bf16_f32 v48, v48, v49
    v_cvt_pk_bf16_f32 v49, v50, v51
    v_cvt_pk_bf16_f32 v50, v52, v53
    v_cvt_pk_bf16_f32 v51, v54, v55
    v_min_u32 v48, -2, v48
    v_min_u32 v49, -2, v49
    v_min_u32 v50, -2, v50
    v_min_u32 v51, -2, v51
    buffer_store_dwordx4 v[48:51], v1, s[16:19], s49 offen offset:3072 sc1
    s_xor_b32 s49, s44, 16384
    v_cvt_pk_bf16_f32 v56, v56, v57
    v_cvt_pk_bf16_f32 v57, v58, v59
    v_cvt_pk_bf16_f32 v58, v60, v61
    v_cvt_pk_bf16_f32 v59, v62, v63
    v_min_u32 v56, -2, v56
    v_min_u32 v57, -2, v57
    v_min_u32 v58, -2, v58
    v_min_u32 v59, -2, v59
    buffer_store_dwordx4 v[56:59], v1, s[16:19], s49 offen offset:3072 sc1
    s_xor_b32 s49, s44, 32768
    v_cvt_pk_bf16_f32 v64, v64, v65
    v_cvt_pk_bf16_f32 v65, v66, v67
    v_cvt_pk_bf16_f32 v66, v68, v69
    v_cvt_pk_bf16_f32 v67, v70, v71
    v_min_u32 v64, -2, v64
    v_min_u32 v65, -2, v65
    v_min_u32 v66, -2, v66
    v_min_u32 v67, -2, v67
    buffer_store_dwordx4 v[64:67], v1, s[16:19], s49 offen offset:3072 sc1
    s_xor_b32 s49, s44, 49152
    v_cvt_pk_bf16_f32 v72, v72, v73
    v_cvt_pk_bf16_f32 v73, v74, v75
    v_cvt_pk_bf16_f32 v74, v76, v77
    v_cvt_pk_bf16_f32 v75, v78, v79
    v_min_u32 v72, -2, v72
    v_min_u32 v73, -2, v73
    v_min_u32 v74, -2, v74
    v_min_u32 v75, -2, v75
    buffer_store_dwordx4 v[72:75], v1, s[16:19], s49 offen offset:3072 sc1
    s_add_u32 s90, s90, 262144
    s_waitcnt vmcnt(0)
    s_endpgm
L_spin71:
    s_mov_b32 s40, 0x20000
L_spin71_l:
    buffer_load_dword v69, v68, s[20:23], 0 offen sc1
    s_sub_u32 s40, s40, 1
    s_waitcnt vmcnt(0)
    v_cmp_eq_u32 vcc, v68, v69
    s_cbranch_scc1 L_back72
    s_cbranch_vccz L_back72
    s_sleep 8
    s_branch L_spin71_l
L_spin73:
    s_mov_b32 s40, 0x20000
L_spin73_l:
    buffer_load_dword v96, v6, s[16:19], s45 offen sc1
    s_sub_u32 s40, s40, 1
    s_waitcnt vmcnt(0)
    v_cmp_ne_u32 vcc, 0, v96
    s_cbranch_scc1 L_back74
    s_cbranch_vccz L_back74
    s_sleep 2
    s_branch L_spin73_l
L_spin75:
    s_mov_b32 s40, 0x20000
L_spin75_l:
    buffer_load_dword v96, v6, s[16:19], s45 offen sc1
    s_sub_u32 s40, s40, 1
    s_waitcnt vmcnt(0)
    v_cmp_ne_u32 vcc, 0, v96
    s_cbranch_scc1 L_back76
    s_cbranch_vccz L_back76
    s_sleep 2
    s_branch L_spin75_l
L_spin77:
    s_mov_b32 s40, 0x20000
L_spin77_l:
    buffer_load_dword v96, v6, s[16:19], s45 offen sc1
    s_sub_u32 s40, s40, 1
    s_waitcnt vmcnt(0)
    v_cmp_ne_u32 vcc, 0, v96
    s_cbranch_scc1 L_back78
    s_cbranch_vccz L_back78
    s_sleep 2
    s_branch L_spin77_l
L_restart:
    s_waitcnt vmcnt(0) lgkmcnt(0)
    s_barrier
    s_xor_b32 s2, s2, 1
    s_xor_b32 s3, s3, 3
    s_branch L_dispatch
L_code_end:
    s_endpgm
.section .rodata,"a"
.p2align 6
.amdhsa_kernel interleave_layers__sliding_local_dilated__dense_activation_squared_relu__prompt_kernel
  .amdhsa_next_free_vgpr 512
  .amdhsa_next_free_sgpr 102
  .amdhsa_accum_offset 256
  .amdhsa_group_segment_fixed_size 0
  .amdhsa_kernarg_size 88
  .amdhsa_user_sgpr_count 2
  .amdhsa_user_sgpr_kernarg_segment_ptr 1
  .amdhsa_system_sgpr_workgroup_id_x 1
.end_amdhsa_kernel
```
